```python
import torch

def _softmax(x, axis=-1):
    return torch.softmax(x, dim=axis)
def _gelu(x):
    return torch.nn.functional.gelu(x, approximate="tanh")
def _silu(x):
    return torch.nn.functional.silu(x)
def _sigmoid(x):
    return torch.sigmoid(x)
def _layernorm(x, axis=-1, eps=1e-5):
    m = x.mean(dim=axis, keepdim=True)
    v = x.var(dim=axis, keepdim=True, unbiased=False)
    return (x - m) / torch.sqrt(v + eps)
def _scatter_add(tgt, idx, src, axis=0):
    return tgt.clone().index_add_(axis, idx, src)
def _segment_sum(src, seg, n):
    out = torch.zeros((n,) + src.shape[1:], dtype=src.dtype)
    return out.index_add_(0, seg, src)
def _pad(x, pw):
    flat = tuple(v for pair in reversed(pw) for v in pair)
    return torch.nn.functional.pad(x, flat)

kernel_name = 'concat_heads__mha_block_cached__mha_block_cached__near_ridge'

def setup_inputs():

    _w = (lambda a: (lambda t: t.to(torch.bfloat16) if t.is_floating_point() else t)(torch.as_tensor(a)))
    def _A_setup():
        B, Sq, D = 16, 224, 640
        H, Sk, Dh = 32, 1024, 128
        return {
            "x": _w((lambda *s: torch.randn(*s, dtype=torch.bfloat16) * 0.8)(B, Sq, D)),
            "k_cache": _w((lambda *s: torch.randn(*s, dtype=torch.bfloat16) * 0.8)(B, H, Sk, Dh)),
            "v_cache": _w((lambda *s: torch.randn(*s, dtype=torch.bfloat16) * 0.05)(B, H, Sk, Dh)),
            "wq": _w((lambda *s: torch.randn(*s, dtype=torch.bfloat16) * 0.8)(D, H * Dh) * (D ** -0.5)),
            "wo": _w((lambda *s: torch.randn(*s, dtype=torch.bfloat16) * 0.05)(H * Dh, D) * ((H * Dh) ** -0.5)),
        }
    _A_in = _A_setup()

    def _B_setup():
        B, Sq, D = 16, 224, 640
        H, Sk, Dh = 32, 1024, 128
        return {
            "x": _w((lambda *s: torch.randn(*s, dtype=torch.bfloat16) * 0.8)(B, Sq, D)),
            "k_cache": _w((lambda *s: torch.randn(*s, dtype=torch.bfloat16) * 0.8)(B, H, Sk, Dh)),
            "v_cache": _w((lambda *s: torch.randn(*s, dtype=torch.bfloat16) * 0.05)(B, H, Sk, Dh)),
            "wq": _w((lambda *s: torch.randn(*s, dtype=torch.bfloat16) * 0.8)(D, H * Dh) * (D ** -0.5)),
            "wo": _w((lambda *s: torch.randn(*s, dtype=torch.bfloat16) * 0.05)(H * Dh, D) * ((H * Dh) ** -0.5)),
        }
    _B_in = _B_setup()

    return {
        "A_x": _A_in["x"],
        "A_k_cache": _A_in["k_cache"],
        "A_v_cache": _A_in["v_cache"],
        "A_wq": _A_in["wq"],
        "A_wo": _A_in["wo"],
        "B_x": _B_in["x"],
        "B_k_cache": _B_in["k_cache"],
        "B_v_cache": _B_in["v_cache"],
        "B_wq": _B_in["wq"],
        "B_wo": _B_in["wo"],
    }

def reference(A_x, A_k_cache, A_v_cache, A_wq, A_wo, B_x, B_k_cache, B_v_cache, B_wq, B_wo):
    def _A_ref(x, k_cache, v_cache, wq, wo):
        B, Sq, D = x.shape
        H, Dh = 32, 128
        q = (lambda x, *d: x.permute(*d))((x @ wq).reshape(B, Sq, H, Dh), 0, 2, 1, 3)
        scores = torch.einsum("bhqd,bhkd->bhqk", q, k_cache) * (Dh ** -0.5)
        p = _softmax(scores, axis=-1)
        o = torch.einsum("bhqk,bhkd->bhqd", p, v_cache)
        return (lambda x, *d: x.permute(*d))(o, 0, 2, 1, 3).reshape(B, Sq, H * Dh) @ wo

    def _B_ref(x, k_cache, v_cache, wq, wo):
        B, Sq, D = x.shape
        H, Dh = 32, 128
        q = (lambda x, *d: x.permute(*d))((x @ wq).reshape(B, Sq, H, Dh), 0, 2, 1, 3)
        scores = torch.einsum("bhqd,bhkd->bhqk", q, k_cache) * (Dh ** -0.5)
        p = _softmax(scores, axis=-1)
        o = torch.einsum("bhqk,bhkd->bhqd", p, v_cache)
        return (lambda x, *d: x.permute(*d))(o, 0, 2, 1, 3).reshape(B, Sq, H * Dh) @ wo

    a = _A_ref(A_x, A_k_cache, A_v_cache, A_wq, A_wo)
    b = _B_ref(B_x, B_k_cache, B_v_cache, B_wq, B_wo)
    return torch.concatenate([a, b], axis=-1)
```

```asm
; @launch kernel=fused_kernel grid=(256,1,1) block=(256,1,1) lds=163840
; @launch kernel=op_kernel grid=(256,1,1) block=(256,1,1) lds=163840
.amdgcn_target "amdgcn-amd-amdhsa--gfx950"
.text
.globl fused_kernel
.p2align 8
.type fused_kernel,@function
fused_kernel:
    s_cmp_ge_u32 s2, 256
    s_cbranch_scc1 L_at_end
    s_and_b32 s3, s2, 7
    s_lshl_b32 s3, s3, 5
    s_lshr_b32 s36, s2, 6
    s_lshl_b32 s36, s36, 3
    s_or_b32 s3, s3, s36
    s_bfe_u32 s36, s2, 0x30003
    s_or_b32 s2, s3, s36
    s_load_dwordx8 s[36:43], s[0:1], 0
    s_load_dwordx8 s[56:63], s[0:1], 40
    s_load_dwordx2 s[44:45], s[0:1], 96
    s_load_dwordx2 s[84:85], s[0:1], 32
    s_load_dwordx2 s[86:87], s[0:1], 72
    v_and_b32 v1, 63, v0
    v_lshrrev_b32 v2, 6, v0
    s_nop 0
    v_readfirstlane_b32 s20, v2
    s_waitcnt lgkmcnt(0)
    s_and_b32 s48, s20, 1
    s_lshr_b32 s35, s20, 1
    s_cmp_ge_u32 s2, 128
    s_cselect_b32 s36, s56, s36
    s_cselect_b32 s37, s57, s37
    s_cselect_b32 s38, s58, s38
    s_cselect_b32 s39, s59, s39
    s_cselect_b32 s40, s60, s40
    s_cselect_b32 s41, s61, s41
    s_cselect_b32 s42, s62, s42
    s_cselect_b32 s43, s63, s43
    s_cselect_b32 s84, s86, s84
    s_cselect_b32 s85, s87, s85
    s_mov_b32 s86, 5242880
    s_mov_b32 s87, 0x20000
    s_and_b32 s28, s2, 127
    s_lshl_b32 s29, s28, 20
    s_lshl_b32 s30, s35, 18
    s_add_u32 s29, s29, s30
    s_add_u32 s38, s38, s29
    s_addc_u32 s39, s39, 0
    s_add_u32 s40, s40, s29
    s_addc_u32 s41, s41, 0
    s_sub_u32 s30, 0x100000, s30
    s_mov_b32 s8, s38
    s_mov_b32 s9, s39
    s_mov_b32 s10, s30
    s_mov_b32 s11, 0x20000
    s_cmp_eq_u32 s48, 0
    s_cselect_b32 s4, s38, s40
    s_cselect_b32 s5, s39, s41
    s_mov_b32 s6, s30
    s_mov_b32 s7, 0x20000
    s_cselect_b32 s16, s42, s36
    s_cselect_b32 s17, s43, s37
    s_mov_b32 s28, 5242880
    s_mov_b32 s29, 4587520
    s_cselect_b32 s18, s28, s29
    s_mov_b32 s19, 0x20000
    s_mov_b32 s28, 262144
    s_mov_b32 s29, 64
    s_cselect_b32 s51, s28, s29
    s_cselect_b32 s52, 512, 0
    s_mov_b32 s28, 1056
    s_mov_b32 s29, 1024
    s_cselect_b32 s53, s28, s29
    s_mov_b32 s28, 0
    s_mov_b32 s29, 0
    s_cselect_b32 s88, s28, s29
    s_mov_b32 s28, 8192
    s_mov_b32 s29, 20480
    s_cselect_b32 s89, s28, s29
    s_mov_b32 s28, 16384
    s_mov_b32 s29, 40960
    s_cselect_b32 s90, s28, s29
    s_mov_b32 s28, 24576
    s_mov_b32 s29, 61440
    s_cselect_b32 s91, s28, s29
    s_mov_b32 s28, 65536
    s_mov_b32 s29, 81920
    s_cselect_b32 s92, s28, s29
    s_mov_b32 s28, 73728
    s_mov_b32 s29, 102400
    s_cselect_b32 s93, s28, s29
    s_mov_b32 s28, 81920
    s_mov_b32 s29, 122880
    s_cselect_b32 s94, s28, s29
    s_mov_b32 s28, 90112
    s_mov_b32 s29, 1073741824
    s_cselect_b32 s95, s28, s29
    s_and_b32 s28, s2, 7
    s_lshl_b32 s28, s28, 2
    s_add_u32 s28, s28, s35
    s_lshl_b32 s28, s28, 8
    s_bfe_u32 s29, s2, 262147
    s_lshl_b32 s29, s29, 1
    s_add_u32 s29, s29, s35
    s_mul_i32 s29, s29, 143360
    s_cmp_eq_u32 s48, 0
    s_cselect_b32 s55, s28, s29
    s_add_u32 s12, s44, 0
    s_addc_u32 s13, s45, 0
    s_mov_b32 s14, 127926272
    s_mov_b32 s15, 0x20000
    s_lshl_b32 s28, s2, 2
    s_add_u32 s28, s28, s35
    s_mul_i32 s24, s28, 57344
    s_mul_i32 s28, s48, 28672
    s_add_u32 s24, s24, s28
    s_add_u32 s24, s24, 58720256
    s_mov_b32 s23, -1
    s_mov_b32 s60, s42
    s_mov_b32 s61, s43
    s_mov_b32 s62, 5242880
    s_mov_b32 s63, 0x20000
    s_mov_b32 s27, 0
    s_mov_b32 s25, 0
    s_mov_b32 s68, 0
    s_mov_b32 s71, 0
    s_lshr_b32 s26, s2, 3
    s_lshr_b32 s28, s2, 1
    s_add_u32 s26, s26, s28
    s_and_b32 s26, s26, 3
    s_mul_i32 s26, s26, 5
    s_mul_i32 s83, s51, 20
    s_and_b32 s69, s2, 1
    s_min_u32 s69, s69, 1
    s_bfe_u32 s3, s2, 0x10005
    s_xor_b32 s3, s3, 1
    s_and_b32 s69, s2, s3
    s_nop 0
    s_mov_b32 s70, s69
    s_mov_b32 s32, 0x4e800000
    s_mov_b32 s54, 0x3e0293ee
    s_lshl_b32 s28, s48, 1
    s_add_u32 s28, s28, s35
    s_mul_i32 s33, s28, 33792
    v_lshlrev_b32 v6, 4, v1
    v_lshrrev_b32 v2, 4, v1
    v_and_b32 v3, 15, v1
    v_lshlrev_b32 v4, 4, v3
    v_lshl_add_u32 v7, v2, 14, v4
    v_bfe_u32 v5, v1, 4, 1
    v_lshl_add_u32 v26, v5, 15, v4
    v_bfe_u32 v5, v1, 5, 1
    v_lshl_add_u32 v26, v5, 17, v26
    v_mul_u32_u24 v27, 1280, v3
    v_lshl_add_u32 v27, v2, 4, v27
    v_lshrrev_b32 v5, 4, v1
    v_and_b32 v27, 1, v5
    v_lshlrev_b32 v27, 1, v27
    v_lshrrev_b32 v5, 1, v5
    v_mul_u32_u24 v5, 3, v5
    v_xor_b32 v27, v27, v5
    v_and_b32 v5, 3, v1
    v_xor_b32 v27, v27, v5
    v_lshlrev_b32 v27, 4, v27
    v_lshrrev_b32 v5, 2, v1
    v_mul_u32_u24 v5, 1280, v5
    v_add_u32 v27, v27, v5
    s_cmp_eq_u32 s48, 0
    s_cselect_b64 vcc, -1, 0
    s_nop 1
    v_cndmask_b32 v26, v27, v26, vcc
    s_add_u32 s28, s48, 2
    s_mul_i32 s28, s28, 33792
    v_bfe_u32 v5, v1, 2, 2
    v_and_b32 v27, 1, v5
    v_lshlrev_b32 v27, 1, v27
    v_lshrrev_b32 v5, 1, v5
    v_mul_u32_u24 v5, 3, v5
    v_xor_b32 v27, v27, v5
    v_xor_b32 v27, v27, v2
    v_lshlrev_b32 v27, 4, v27
    v_lshl_add_u32 v27, v3, 6, v27
    v_add_u32 v27, s28, v27
    v_bfe_u32 v5, v1, 4, 1
    v_lshl_add_u32 v4, v5, 9, v4
    v_bfe_u32 v5, v1, 5, 1
    v_lshl_add_u32 v10, v5, 8, v4
    v_and_b32 v4, 7, v3
    v_lshlrev_b32 v8, 10, v4
    v_and_b32 v5, 1, v3
    v_lshl_add_u32 v8, v5, 4, v8
    v_bfe_u32 v5, v3, 1, 2
    v_lshl_add_u32 v8, v5, 6, v8
    v_lshrrev_b32 v5, 3, v3
    v_lshl_add_u32 v8, v5, 8, v8
    v_bfe_u32 v5, v1, 4, 1
    v_lshl_add_u32 v8, v5, 5, v8
    v_bfe_u32 v5, v1, 5, 1
    v_lshl_add_u32 v8, v5, 4, v8
    s_mul_i32 s28, s35, 33792
    v_add_u32 v8, s28, v8
    v_bfe_u32 v3, v1, 2, 2
    v_bfe_u32 v5, v1, 4, 1
    v_lshl_add_u32 v4, v5, 2, v3
    v_mul_u32_u24 v4, 1056, v4
    v_bfe_u32 v5, v1, 5, 1
    v_lshl_add_u32 v4, v5, 9, v4
    v_and_b32 v5, 3, v1
    v_lshl_add_u32 v4, v5, 3, v4
    v_add_u32 v11, s28, v4
    v_lshl_add_u32 v3, v2, 2, v3
    v_and_b32 v4, 7, v3
    v_mul_u32_u24 v4, 1056, v4
    v_lshrrev_b32 v5, 3, v3
    v_lshl_add_u32 v4, v5, 8, v4
    v_and_b32 v5, 3, v1
    v_lshl_add_u32 v4, v5, 3, v4
    s_add_u32 s28, s28, 67584
    v_add_u32 v9, s28, v4
    v_mov_b32 v12, 0xff800000
    v_mov_b32 v14, 0xff800000
    v_mov_b32 v16, 0xff800000
    v_mov_b32 v18, 0xff800000
    v_mov_b32 v20, 0xff800000
    v_mov_b32 v22, 0xff800000
    v_mov_b32 v24, 0xff800000
    v_mov_b32 v2, 0x3f803f80
    v_accvgpr_write_b32 a252, v2
    v_accvgpr_write_b32 a253, v2
    v_accvgpr_write_b32 a254, v2
    v_accvgpr_write_b32 a255, v2
    v_and_b32 v2, 3, v1
    v_lshlrev_b32 v2, 2, v2
    v_add_u32 v2, 76000, v2
    v_mov_b32 v3, 0
    ds_write_b32 v2, v3
    s_cmp_eq_u32 s48, 0
    s_mov_b32 s28, 784
    s_mov_b32 s29, 800
    s_cselect_b32 s96, s28, s29
    s_mov_b32 s28, 816
    s_cselect_b32 s97, s28, s29
    v_lshrrev_b32 v2, 1, v1
    v_lshlrev_b32 v2, 13, v2
    v_and_b32 v3, 1, v1
    v_lshl_add_u32 v2, v3, 7, v2
    v_lshlrev_b32 v3, 7, v1
    s_bfe_u32 s28, s2, 0x20003
    s_lshl_b32 s28, s28, 18
    s_and_b32 s29, s2, 7
    s_mul_i32 s29, s29, 17920
    s_cmp_eq_u32 s48, 0
    s_cselect_b64 vcc, -1, 0
    s_cselect_b32 s100, s28, s29
    s_add_u32 s100, s100, s55
    s_cmp_eq_u32 s48, 0
    s_mov_b32 s28, 1048576
    s_mov_b32 s29, 8192
    s_cselect_b32 s99, s28, s29
    v_cndmask_b32 v6, v3, v2, vcc
    s_mul_i32 s100, s2, 11
    s_lshr_b32 s28, s2, 5
    s_mul_i32 s28, s28, 7
    s_add_u32 s100, s100, s28
    s_lshl_b32 s28, s35, 4
    s_add_u32 s100, s100, s28
    s_and_b32 s100, s100, 31
L_at_start:
    s_mov_b32 s21, s27
    s_lshl_b32 s34, s27, 5
    s_add_u32 s31, s21, s70
    s_mul_i32 s50, s31, s52
    s_mov_b32 s101, s31
    s_add_u32 s50, s50, s55
    s_cmp_ge_u32 s31, 2
    s_cselect_b32 s28, 0x40000000, 0
    s_add_u32 s50, s50, s28
    s_mov_b32 s82, s26
    s_mul_i32 s28, s26, s51
    s_add_u32 s50, s50, s28
    s_add_u32 m0, s33, 0
    s_mov_b32 s49, s50
    s_add_u32 s50, s50, s51
    s_add_u32 s82, s82, 1
    s_cmp_eq_u32 s82, 20
    s_cselect_b32 s29, s83, 0
    s_sub_u32 s50, s50, s29
    s_add_u32 s28, s49, s88
    buffer_load_dwordx4 v26, s[16:19], s28 offen lds
    s_add_u32 m0, m0, s53
    s_add_u32 s28, s49, s89
    buffer_load_dwordx4 v26, s[16:19], s28 offen lds
    s_add_u32 m0, m0, s53
    s_add_u32 s28, s49, s90
    buffer_load_dwordx4 v26, s[16:19], s28 offen lds
    s_add_u32 m0, m0, s53
    s_add_u32 s28, s49, s91
    buffer_load_dwordx4 v26, s[16:19], s28 offen lds
    s_add_u32 m0, m0, s53
    s_add_u32 s28, s49, s92
    buffer_load_dwordx4 v26, s[16:19], s28 offen lds
    s_add_u32 m0, m0, s53
    s_add_u32 s28, s49, s93
    buffer_load_dwordx4 v26, s[16:19], s28 offen lds
    s_add_u32 m0, m0, s53
    s_add_u32 s28, s49, s94
    buffer_load_dwordx4 v26, s[16:19], s28 offen lds
    s_add_u32 m0, m0, s53
    s_add_u32 s28, s49, s95
    buffer_load_dwordx4 v26, s[16:19], s28 offen lds
    s_add_u32 m0, s33, 8448
    s_mov_b32 s49, s50
    s_add_u32 s50, s50, s51
    s_add_u32 s82, s82, 1
    s_cmp_eq_u32 s82, 20
    s_cselect_b32 s29, s83, 0
    s_sub_u32 s50, s50, s29
    s_add_u32 s28, s49, s88
    buffer_load_dwordx4 v26, s[16:19], s28 offen lds
    s_add_u32 m0, m0, s53
    s_add_u32 s28, s49, s89
    buffer_load_dwordx4 v26, s[16:19], s28 offen lds
    s_add_u32 m0, m0, s53
    s_add_u32 s28, s49, s90
    buffer_load_dwordx4 v26, s[16:19], s28 offen lds
    s_add_u32 m0, m0, s53
    s_add_u32 s28, s49, s91
    buffer_load_dwordx4 v26, s[16:19], s28 offen lds
    s_add_u32 m0, m0, s53
    s_add_u32 s28, s49, s92
    buffer_load_dwordx4 v26, s[16:19], s28 offen lds
    s_add_u32 m0, m0, s53
    s_add_u32 s28, s49, s93
    buffer_load_dwordx4 v26, s[16:19], s28 offen lds
    s_add_u32 m0, m0, s53
    s_add_u32 s28, s49, s94
    buffer_load_dwordx4 v26, s[16:19], s28 offen lds
    s_add_u32 m0, m0, s53
    s_add_u32 s28, s49, s95
    buffer_load_dwordx4 v26, s[16:19], s28 offen lds
    s_add_u32 m0, s33, 16896
    s_mov_b32 s49, s50
    s_add_u32 s50, s50, s51
    s_add_u32 s82, s82, 1
    s_cmp_eq_u32 s82, 20
    s_cselect_b32 s29, s83, 0
    s_sub_u32 s50, s50, s29
    s_add_u32 s28, s49, s88
    buffer_load_dwordx4 v26, s[16:19], s28 offen lds
    s_add_u32 m0, m0, s53
    s_add_u32 s28, s49, s89
    buffer_load_dwordx4 v26, s[16:19], s28 offen lds
    s_add_u32 m0, m0, s53
    s_add_u32 s28, s49, s90
    buffer_load_dwordx4 v26, s[16:19], s28 offen lds
    s_add_u32 m0, m0, s53
    s_add_u32 s28, s49, s91
    buffer_load_dwordx4 v26, s[16:19], s28 offen lds
    s_add_u32 m0, m0, s53
    s_add_u32 s28, s49, s92
    buffer_load_dwordx4 v26, s[16:19], s28 offen lds
    s_add_u32 m0, m0, s53
    s_add_u32 s28, s49, s93
    buffer_load_dwordx4 v26, s[16:19], s28 offen lds
    s_add_u32 m0, m0, s53
    s_add_u32 s28, s49, s94
    buffer_load_dwordx4 v26, s[16:19], s28 offen lds
    s_add_u32 m0, m0, s53
    s_add_u32 s28, s49, s95
    buffer_load_dwordx4 v26, s[16:19], s28 offen lds
    s_add_u32 m0, s33, 25344
    s_mov_b32 s49, s50
    s_add_u32 s50, s50, s51
    s_add_u32 s82, s82, 1
    s_cmp_eq_u32 s82, 20
    s_cselect_b32 s29, s83, 0
    s_sub_u32 s50, s50, s29
    s_add_u32 s28, s49, s88
    buffer_load_dwordx4 v26, s[16:19], s28 offen lds
    s_add_u32 m0, m0, s53
    s_add_u32 s28, s49, s89
    buffer_load_dwordx4 v26, s[16:19], s28 offen lds
    s_add_u32 m0, m0, s53
    s_add_u32 s28, s49, s90
    buffer_load_dwordx4 v26, s[16:19], s28 offen lds
    s_add_u32 m0, m0, s53
    s_add_u32 s28, s49, s91
    buffer_load_dwordx4 v26, s[16:19], s28 offen lds
    s_add_u32 m0, m0, s53
    s_add_u32 s28, s49, s92
    buffer_load_dwordx4 v26, s[16:19], s28 offen lds
    s_add_u32 m0, m0, s53
    s_add_u32 s28, s49, s93
    buffer_load_dwordx4 v26, s[16:19], s28 offen lds
    s_add_u32 m0, m0, s53
    s_add_u32 s28, s49, s94
    buffer_load_dwordx4 v26, s[16:19], s28 offen lds
    s_add_u32 m0, m0, s53
    s_add_u32 s28, s49, s95
    buffer_load_dwordx4 v26, s[16:19], s28 offen lds
    s_waitcnt vmcnt(24) lgkmcnt(0)
    s_barrier
L_at_round:
    ds_read_b64_tr_b16 v[112:113], v11 offset:0
    ds_read_b64_tr_b16 v[114:115], v11 offset:256
    ds_read_b64_tr_b16 v[116:117], v11 offset:32
    ds_read_b64_tr_b16 v[118:119], v11 offset:288
    ds_read_b64_tr_b16 v[120:121], v11 offset:64
    ds_read_b64_tr_b16 v[122:123], v11 offset:320
    ds_read_b64_tr_b16 v[124:125], v11 offset:96
    ds_read_b64_tr_b16 v[126:127], v11 offset:352
    ds_read_b64_tr_b16 v[128:129], v11 offset:128
    ds_read_b64_tr_b16 v[130:131], v11 offset:384
    ds_read_b64_tr_b16 v[132:133], v11 offset:160
    ds_read_b64_tr_b16 v[134:135], v11 offset:416
    ds_read_b64_tr_b16 v[136:137], v11 offset:192
    ds_read_b64_tr_b16 v[138:139], v11 offset:448
    ds_read_b64_tr_b16 v[140:141], v11 offset:224
    ds_read_b64_tr_b16 v[142:143], v11 offset:480
    ds_read_b128 v[56:59], v27 offset:0
    ds_read_b128 v[60:63], v27 offset:1024
    ds_read_b128 v[64:67], v27 offset:2048
    ds_read_b128 v[68:71], v27 offset:3072
    ds_read_b128 v[72:75], v27 offset:4096
    ds_read_b128 v[76:79], v27 offset:5120
    ds_read_b128 v[80:83], v27 offset:6144
    s_waitcnt lgkmcnt(0)
    s_waitcnt lgkmcnt(14)
    v_mfma_f32_16x16x32_bf16 v[144:147], v[112:115], v[56:59], 0
    s_add_u32 m0, s33, 0
    v_mfma_f32_16x16x32_bf16 v[148:151], v[112:115], v[60:63], 0
    s_mov_b32 s49, s50
    v_mfma_f32_16x16x32_bf16 v[152:155], v[112:115], v[64:67], 0
    s_add_u32 s50, s50, s51
    v_mfma_f32_16x16x32_bf16 v[156:159], v[112:115], v[68:71], 0
    s_add_u32 s82, s82, 1
    v_mfma_f32_16x16x32_bf16 v[160:163], v[112:115], v[72:75], 0
    s_cmp_eq_u32 s82, 20
    v_mfma_f32_16x16x32_bf16 v[164:167], v[112:115], v[76:79], 0
    s_cselect_b32 s29, s83, 0
    v_mfma_f32_16x16x32_bf16 v[168:171], v[112:115], v[80:83], 0
    s_sub_u32 s50, s50, s29
    s_cmp_eq_u32 s68, 0
    s_cbranch_scc1 L_bw1_434
    s_sub_u32 s68, s68, 1
    s_waitcnt vmcnt(44) lgkmcnt(0)
    s_branch L_bw2_434
L_bw1_434:
    s_waitcnt vmcnt(16) lgkmcnt(0)
L_bw2_434:
    s_barrier
    s_cmp_le_u32 s21, s27
    s_cbranch_scc1 L_at_nofb_443
    s_sub_u32 s28, s21, 1
    s_cmp_eq_u32 s28, s23
    s_cbranch_scc1 L_at_nofb_443
    s_lshl_b32 s29, s28, 2
    s_add_u32 s29, s29, 76000
    v_mov_b32 v4, s29
    ds_read_b32 v4, v4
    s_waitcnt lgkmcnt(0)
    v_readfirstlane_b32 s29, v4
    s_nop 3
    s_cmp_lg_u32 s29, 0
    s_cbranch_scc1 L_at_fallback
L_at_nofb_443:
    ds_read_b64_tr_b16 v[112:113], v11 offset:8448
    v_mfma_f32_16x16x32_bf16 v[172:175], v[116:119], v[56:59], 0
    ds_read_b64_tr_b16 v[114:115], v11 offset:8704
    v_mfma_f32_16x16x32_bf16 v[176:179], v[116:119], v[60:63], 0
    ds_read_b128 v[28:31], v27 offset:8448
    v_mfma_f32_16x16x32_bf16 v[180:183], v[116:119], v[64:67], 0
    s_add_u32 s28, s49, s88
    buffer_load_dwordx4 v26, s[16:19], s28 offen lds
    v_mfma_f32_16x16x32_bf16 v[184:187], v[116:119], v[68:71], 0
    s_add_u32 m0, m0, s53
    ds_read_b128 v[32:35], v27 offset:9472
    v_mfma_f32_16x16x32_bf16 v[188:191], v[116:119], v[72:75], 0
    ds_read_b128 v[36:39], v27 offset:10496
    v_mfma_f32_16x16x32_bf16 v[192:195], v[116:119], v[76:79], 0
    ds_read_b128 v[40:43], v27 offset:11520
    v_mfma_f32_16x16x32_bf16 v[196:199], v[116:119], v[80:83], 0
    ds_read_b128 v[44:47], v27 offset:12544
    v_mfma_f32_16x16x32_bf16 v[200:203], v[120:123], v[56:59], 0
    ds_read_b128 v[48:51], v27 offset:13568
    v_mfma_f32_16x16x32_bf16 v[204:207], v[120:123], v[60:63], 0
    s_add_u32 s28, s49, s89
    buffer_load_dwordx4 v26, s[16:19], s28 offen lds
    v_mfma_f32_16x16x32_bf16 v[208:211], v[120:123], v[64:67], 0
    s_add_u32 m0, m0, s53
    ds_read_b128 v[52:55], v27 offset:14592
    v_mfma_f32_16x16x32_bf16 v[212:215], v[120:123], v[68:71], 0
    ds_read_b64_tr_b16 v[116:117], v11 offset:8480
    v_mfma_f32_16x16x32_bf16 v[216:219], v[120:123], v[72:75], 0
    ds_read_b64_tr_b16 v[118:119], v11 offset:8736
    v_mfma_f32_16x16x32_bf16 v[220:223], v[120:123], v[76:79], 0
    v_mfma_f32_16x16x32_bf16 v[224:227], v[120:123], v[80:83], 0
    ds_read_b64_tr_b16 v[120:121], v11 offset:8512
    v_mfma_f32_16x16x32_bf16 v[228:231], v[124:127], v[56:59], 0
    s_add_u32 s28, s49, s90
    buffer_load_dwordx4 v26, s[16:19], s28 offen lds
    v_mfma_f32_16x16x32_bf16 v[232:235], v[124:127], v[60:63], 0
    s_add_u32 m0, m0, s53
    ds_read_b64_tr_b16 v[122:123], v11 offset:8768
    v_mfma_f32_16x16x32_bf16 v[236:239], v[124:127], v[64:67], 0
    v_mfma_f32_16x16x32_bf16 v[240:243], v[124:127], v[68:71], 0
    v_mfma_f32_16x16x32_bf16 v[244:247], v[124:127], v[72:75], 0
    v_mfma_f32_16x16x32_bf16 v[248:251], v[124:127], v[76:79], 0
    v_mfma_f32_16x16x32_bf16 v[252:255], v[124:127], v[80:83], 0
    s_add_u32 s28, s49, s91
    buffer_load_dwordx4 v26, s[16:19], s28 offen lds
    v_mfma_f32_16x16x32_bf16 a[112:115], v[128:131], v[56:59], 0
    s_add_u32 m0, m0, s53
    ds_read_b64_tr_b16 v[124:125], v11 offset:8544
    v_mfma_f32_16x16x32_bf16 a[116:119], v[128:131], v[60:63], 0
    ds_read_b64_tr_b16 v[126:127], v11 offset:8800
    v_mfma_f32_16x16x32_bf16 a[120:123], v[128:131], v[64:67], 0
    v_mfma_f32_16x16x32_bf16 a[124:127], v[128:131], v[68:71], 0
    v_mfma_f32_16x16x32_bf16 a[128:131], v[128:131], v[72:75], 0
    v_mfma_f32_16x16x32_bf16 a[132:135], v[128:131], v[76:79], 0
    s_add_u32 s28, s49, s92
    buffer_load_dwordx4 v26, s[16:19], s28 offen lds
    v_mfma_f32_16x16x32_bf16 a[136:139], v[128:131], v[80:83], 0
    s_add_u32 m0, m0, s53
    ds_read_b64_tr_b16 v[128:129], v11 offset:8576
    v_mfma_f32_16x16x32_bf16 a[140:143], v[132:135], v[56:59], 0
    ds_read_b64_tr_b16 v[130:131], v11 offset:8832
    v_mfma_f32_16x16x32_bf16 a[144:147], v[132:135], v[60:63], 0
    v_mfma_f32_16x16x32_bf16 a[148:151], v[132:135], v[64:67], 0
    v_mfma_f32_16x16x32_bf16 a[152:155], v[132:135], v[68:71], 0
    v_mfma_f32_16x16x32_bf16 a[156:159], v[132:135], v[72:75], 0
    s_add_u32 s28, s49, s93
    buffer_load_dwordx4 v26, s[16:19], s28 offen lds
    v_mfma_f32_16x16x32_bf16 a[160:163], v[132:135], v[76:79], 0
    s_add_u32 m0, m0, s53
    v_mfma_f32_16x16x32_bf16 a[164:167], v[132:135], v[80:83], 0
    ds_read_b64_tr_b16 v[132:133], v11 offset:8608
    v_mfma_f32_16x16x32_bf16 a[168:171], v[136:139], v[56:59], 0
    ds_read_b64_tr_b16 v[134:135], v11 offset:8864
    v_mfma_f32_16x16x32_bf16 a[172:175], v[136:139], v[60:63], 0
    v_mfma_f32_16x16x32_bf16 a[176:179], v[136:139], v[64:67], 0
    v_mfma_f32_16x16x32_bf16 a[180:183], v[136:139], v[68:71], 0
    s_add_u32 s28, s49, s94
    buffer_load_dwordx4 v26, s[16:19], s28 offen lds
    v_mfma_f32_16x16x32_bf16 a[184:187], v[136:139], v[72:75], 0
    s_add_u32 m0, m0, s53
    v_mfma_f32_16x16x32_bf16 a[188:191], v[136:139], v[76:79], 0
    v_mfma_f32_16x16x32_bf16 a[192:195], v[136:139], v[80:83], 0
    ds_read_b64_tr_b16 v[136:137], v11 offset:8640
    v_mfma_f32_16x16x32_bf16 a[196:199], v[140:143], v[56:59], 0
    ds_read_b64_tr_b16 v[138:139], v11 offset:8896
    v_mfma_f32_16x16x32_bf16 a[200:203], v[140:143], v[60:63], 0
    v_mfma_f32_16x16x32_bf16 a[204:207], v[140:143], v[64:67], 0
    s_add_u32 s28, s49, s95
    buffer_load_dwordx4 v26, s[16:19], s28 offen lds
    v_mfma_f32_16x16x32_bf16 a[208:211], v[140:143], v[68:71], 0
    v_mfma_f32_16x16x32_bf16 a[212:215], v[140:143], v[72:75], 0
    v_mfma_f32_16x16x32_bf16 a[216:219], v[140:143], v[76:79], 0
    v_mfma_f32_16x16x32_bf16 a[220:223], v[140:143], v[80:83], 0
    ds_read_b64_tr_b16 v[140:141], v11 offset:8672
    ds_read_b64_tr_b16 v[142:143], v11 offset:8928
    s_waitcnt lgkmcnt(14)
    v_mfma_f32_16x16x32_bf16 v[144:147], v[112:115], v[28:31], v[144:147]
    s_add_u32 m0, s33, 8448
    v_mfma_f32_16x16x32_bf16 v[148:151], v[112:115], v[32:35], v[148:151]
    s_mov_b32 s49, s50
    v_mfma_f32_16x16x32_bf16 v[152:155], v[112:115], v[36:39], v[152:155]
    s_add_u32 s50, s50, s51
    v_mfma_f32_16x16x32_bf16 v[156:159], v[112:115], v[40:43], v[156:159]
    s_add_u32 s82, s82, 1
    v_mfma_f32_16x16x32_bf16 v[160:163], v[112:115], v[44:47], v[160:163]
    s_cmp_eq_u32 s82, 20
    v_mfma_f32_16x16x32_bf16 v[164:167], v[112:115], v[48:51], v[164:167]
    s_cselect_b32 s29, s83, 0
    v_mfma_f32_16x16x32_bf16 v[168:171], v[112:115], v[52:55], v[168:171]
    s_sub_u32 s50, s50, s29
    s_cmp_eq_u32 s68, 0
    s_cbranch_scc1 L_bw1_568
    s_sub_u32 s68, s68, 1
    s_waitcnt vmcnt(44) lgkmcnt(0)
    s_branch L_bw2_568
L_bw1_568:
    s_waitcnt vmcnt(16) lgkmcnt(0)
L_bw2_568:
    s_barrier
    ds_read_b64_tr_b16 v[112:113], v11 offset:16896
    v_mfma_f32_16x16x32_bf16 v[172:175], v[116:119], v[28:31], v[172:175]
    ds_read_b64_tr_b16 v[114:115], v11 offset:17152
    v_mfma_f32_16x16x32_bf16 v[176:179], v[116:119], v[32:35], v[176:179]
    ds_read_b128 v[56:59], v27 offset:16896
    v_mfma_f32_16x16x32_bf16 v[180:183], v[116:119], v[36:39], v[180:183]
    s_add_u32 s28, s49, s88
    buffer_load_dwordx4 v26, s[16:19], s28 offen lds
    v_mfma_f32_16x16x32_bf16 v[184:187], v[116:119], v[40:43], v[184:187]
    s_add_u32 m0, m0, s53
    ds_read_b128 v[60:63], v27 offset:17920
    v_mfma_f32_16x16x32_bf16 v[188:191], v[116:119], v[44:47], v[188:191]
    ds_read_b128 v[64:67], v27 offset:18944
    v_mfma_f32_16x16x32_bf16 v[192:195], v[116:119], v[48:51], v[192:195]
    ds_read_b128 v[68:71], v27 offset:19968
    v_mfma_f32_16x16x32_bf16 v[196:199], v[116:119], v[52:55], v[196:199]
    ds_read_b128 v[72:75], v27 offset:20992
    v_mfma_f32_16x16x32_bf16 v[200:203], v[120:123], v[28:31], v[200:203]
    ds_read_b128 v[76:79], v27 offset:22016
    v_mfma_f32_16x16x32_bf16 v[204:207], v[120:123], v[32:35], v[204:207]
    s_add_u32 s28, s49, s89
    buffer_load_dwordx4 v26, s[16:19], s28 offen lds
    v_mfma_f32_16x16x32_bf16 v[208:211], v[120:123], v[36:39], v[208:211]
    s_add_u32 m0, m0, s53
    ds_read_b128 v[80:83], v27 offset:23040
    v_mfma_f32_16x16x32_bf16 v[212:215], v[120:123], v[40:43], v[212:215]
    ds_read_b64_tr_b16 v[116:117], v11 offset:16928
    v_mfma_f32_16x16x32_bf16 v[216:219], v[120:123], v[44:47], v[216:219]
    ds_read_b64_tr_b16 v[118:119], v11 offset:17184
    v_mfma_f32_16x16x32_bf16 v[220:223], v[120:123], v[48:51], v[220:223]
    v_mfma_f32_16x16x32_bf16 v[224:227], v[120:123], v[52:55], v[224:227]
    ds_read_b64_tr_b16 v[120:121], v11 offset:16960
    v_mfma_f32_16x16x32_bf16 v[228:231], v[124:127], v[28:31], v[228:231]
    s_add_u32 s28, s49, s90
    buffer_load_dwordx4 v26, s[16:19], s28 offen lds
    v_mfma_f32_16x16x32_bf16 v[232:235], v[124:127], v[32:35], v[232:235]
    s_add_u32 m0, m0, s53
    ds_read_b64_tr_b16 v[122:123], v11 offset:17216
    v_mfma_f32_16x16x32_bf16 v[236:239], v[124:127], v[36:39], v[236:239]
    v_mfma_f32_16x16x32_bf16 v[240:243], v[124:127], v[40:43], v[240:243]
    v_mfma_f32_16x16x32_bf16 v[244:247], v[124:127], v[44:47], v[244:247]
    v_mfma_f32_16x16x32_bf16 v[248:251], v[124:127], v[48:51], v[248:251]
    v_mfma_f32_16x16x32_bf16 v[252:255], v[124:127], v[52:55], v[252:255]
    s_add_u32 s28, s49, s91
    buffer_load_dwordx4 v26, s[16:19], s28 offen lds
    v_mfma_f32_16x16x32_bf16 a[112:115], v[128:131], v[28:31], a[112:115]
    s_add_u32 m0, m0, s53
    ds_read_b64_tr_b16 v[124:125], v11 offset:16992
    v_mfma_f32_16x16x32_bf16 a[116:119], v[128:131], v[32:35], a[116:119]
    ds_read_b64_tr_b16 v[126:127], v11 offset:17248
    v_mfma_f32_16x16x32_bf16 a[120:123], v[128:131], v[36:39], a[120:123]
    v_mfma_f32_16x16x32_bf16 a[124:127], v[128:131], v[40:43], a[124:127]
    v_mfma_f32_16x16x32_bf16 a[128:131], v[128:131], v[44:47], a[128:131]
    v_mfma_f32_16x16x32_bf16 a[132:135], v[128:131], v[48:51], a[132:135]
    s_add_u32 s28, s49, s92
    buffer_load_dwordx4 v26, s[16:19], s28 offen lds
    v_mfma_f32_16x16x32_bf16 a[136:139], v[128:131], v[52:55], a[136:139]
    s_add_u32 m0, m0, s53
    ds_read_b64_tr_b16 v[128:129], v11 offset:17024
    v_mfma_f32_16x16x32_bf16 a[140:143], v[132:135], v[28:31], a[140:143]
    ds_read_b64_tr_b16 v[130:131], v11 offset:17280
    v_mfma_f32_16x16x32_bf16 a[144:147], v[132:135], v[32:35], a[144:147]
    v_mfma_f32_16x16x32_bf16 a[148:151], v[132:135], v[36:39], a[148:151]
    v_mfma_f32_16x16x32_bf16 a[152:155], v[132:135], v[40:43], a[152:155]
    v_mfma_f32_16x16x32_bf16 a[156:159], v[132:135], v[44:47], a[156:159]
    s_add_u32 s28, s49, s93
    buffer_load_dwordx4 v26, s[16:19], s28 offen lds
    v_mfma_f32_16x16x32_bf16 a[160:163], v[132:135], v[48:51], a[160:163]
    s_add_u32 m0, m0, s53
    v_mfma_f32_16x16x32_bf16 a[164:167], v[132:135], v[52:55], a[164:167]
    ds_read_b64_tr_b16 v[132:133], v11 offset:17056
    v_mfma_f32_16x16x32_bf16 a[168:171], v[136:139], v[28:31], a[168:171]
    ds_read_b64_tr_b16 v[134:135], v11 offset:17312
    v_mfma_f32_16x16x32_bf16 a[172:175], v[136:139], v[32:35], a[172:175]
    v_mfma_f32_16x16x32_bf16 a[176:179], v[136:139], v[36:39], a[176:179]
    v_mfma_f32_16x16x32_bf16 a[180:183], v[136:139], v[40:43], a[180:183]
    s_add_u32 s28, s49, s94
    buffer_load_dwordx4 v26, s[16:19], s28 offen lds
    v_mfma_f32_16x16x32_bf16 a[184:187], v[136:139], v[44:47], a[184:187]
    s_add_u32 m0, m0, s53
    v_mfma_f32_16x16x32_bf16 a[188:191], v[136:139], v[48:51], a[188:191]
    v_mfma_f32_16x16x32_bf16 a[192:195], v[136:139], v[52:55], a[192:195]
    ds_read_b64_tr_b16 v[136:137], v11 offset:17088
    v_mfma_f32_16x16x32_bf16 a[196:199], v[140:143], v[28:31], a[196:199]
    ds_read_b64_tr_b16 v[138:139], v11 offset:17344
    v_mfma_f32_16x16x32_bf16 a[200:203], v[140:143], v[32:35], a[200:203]
    v_mfma_f32_16x16x32_bf16 a[204:207], v[140:143], v[36:39], a[204:207]
    s_add_u32 s28, s49, s95
    buffer_load_dwordx4 v26, s[16:19], s28 offen lds
    v_mfma_f32_16x16x32_bf16 a[208:211], v[140:143], v[40:43], a[208:211]
    v_mfma_f32_16x16x32_bf16 a[212:215], v[140:143], v[44:47], a[212:215]
    v_mfma_f32_16x16x32_bf16 a[216:219], v[140:143], v[48:51], a[216:219]
    v_mfma_f32_16x16x32_bf16 a[220:223], v[140:143], v[52:55], a[220:223]
    ds_read_b64_tr_b16 v[140:141], v11 offset:17120
    ds_read_b64_tr_b16 v[142:143], v11 offset:17376
    s_waitcnt lgkmcnt(14)
    v_mfma_f32_16x16x32_bf16 v[144:147], v[112:115], v[56:59], v[144:147]
    s_add_u32 m0, s33, 16896
    v_mfma_f32_16x16x32_bf16 v[148:151], v[112:115], v[60:63], v[148:151]
    s_mov_b32 s49, s50
    v_mfma_f32_16x16x32_bf16 v[152:155], v[112:115], v[64:67], v[152:155]
    s_add_u32 s50, s50, s51
    v_mfma_f32_16x16x32_bf16 v[156:159], v[112:115], v[68:71], v[156:159]
    s_add_u32 s82, s82, 1
    v_mfma_f32_16x16x32_bf16 v[160:163], v[112:115], v[72:75], v[160:163]
    s_cmp_eq_u32 s82, 20
    v_mfma_f32_16x16x32_bf16 v[164:167], v[112:115], v[76:79], v[164:167]
    s_cselect_b32 s29, s83, 0
    v_mfma_f32_16x16x32_bf16 v[168:171], v[112:115], v[80:83], v[168:171]
    s_sub_u32 s50, s50, s29
    s_cmp_eq_u32 s68, 0
    s_cbranch_scc1 L_bw1_687
    s_sub_u32 s68, s68, 1
    s_waitcnt vmcnt(44) lgkmcnt(0)
    s_branch L_bw2_687
L_bw1_687:
    s_waitcnt vmcnt(16) lgkmcnt(0)
L_bw2_687:
    s_barrier
    ds_read_b64_tr_b16 v[112:113], v11 offset:25344
    v_mfma_f32_16x16x32_bf16 v[172:175], v[116:119], v[56:59], v[172:175]
    ds_read_b64_tr_b16 v[114:115], v11 offset:25600
    v_mfma_f32_16x16x32_bf16 v[176:179], v[116:119], v[60:63], v[176:179]
    ds_read_b128 v[28:31], v27 offset:25344
    v_mfma_f32_16x16x32_bf16 v[180:183], v[116:119], v[64:67], v[180:183]
    s_add_u32 s28, s49, s88
    buffer_load_dwordx4 v26, s[16:19], s28 offen lds
    v_mfma_f32_16x16x32_bf16 v[184:187], v[116:119], v[68:71], v[184:187]
    s_add_u32 m0, m0, s53
    ds_read_b128 v[32:35], v27 offset:26368
    v_mfma_f32_16x16x32_bf16 v[188:191], v[116:119], v[72:75], v[188:191]
    ds_read_b128 v[36:39], v27 offset:27392
    v_mfma_f32_16x16x32_bf16 v[192:195], v[116:119], v[76:79], v[192:195]
    ds_read_b128 v[40:43], v27 offset:28416
    v_mfma_f32_16x16x32_bf16 v[196:199], v[116:119], v[80:83], v[196:199]
    ds_read_b128 v[44:47], v27 offset:29440
    v_mfma_f32_16x16x32_bf16 v[200:203], v[120:123], v[56:59], v[200:203]
    ds_read_b128 v[48:51], v27 offset:30464
    v_mfma_f32_16x16x32_bf16 v[204:207], v[120:123], v[60:63], v[204:207]
    s_add_u32 s28, s49, s89
    buffer_load_dwordx4 v26, s[16:19], s28 offen lds
    v_mfma_f32_16x16x32_bf16 v[208:211], v[120:123], v[64:67], v[208:211]
    s_add_u32 m0, m0, s53
    ds_read_b128 v[52:55], v27 offset:31488
    v_mfma_f32_16x16x32_bf16 v[212:215], v[120:123], v[68:71], v[212:215]
    ds_read_b64_tr_b16 v[116:117], v11 offset:25376
    v_mfma_f32_16x16x32_bf16 v[216:219], v[120:123], v[72:75], v[216:219]
    ds_read_b64_tr_b16 v[118:119], v11 offset:25632
    v_mfma_f32_16x16x32_bf16 v[220:223], v[120:123], v[76:79], v[220:223]
    v_mfma_f32_16x16x32_bf16 v[224:227], v[120:123], v[80:83], v[224:227]
    ds_read_b64_tr_b16 v[120:121], v11 offset:25408
    v_mfma_f32_16x16x32_bf16 v[228:231], v[124:127], v[56:59], v[228:231]
    s_add_u32 s28, s49, s90
    buffer_load_dwordx4 v26, s[16:19], s28 offen lds
    v_mfma_f32_16x16x32_bf16 v[232:235], v[124:127], v[60:63], v[232:235]
    s_add_u32 m0, m0, s53
    ds_read_b64_tr_b16 v[122:123], v11 offset:25664
    v_mfma_f32_16x16x32_bf16 v[236:239], v[124:127], v[64:67], v[236:239]
    v_mfma_f32_16x16x32_bf16 v[240:243], v[124:127], v[68:71], v[240:243]
    v_mfma_f32_16x16x32_bf16 v[244:247], v[124:127], v[72:75], v[244:247]
    v_mfma_f32_16x16x32_bf16 v[248:251], v[124:127], v[76:79], v[248:251]
    v_mfma_f32_16x16x32_bf16 v[252:255], v[124:127], v[80:83], v[252:255]
    s_add_u32 s28, s49, s91
    buffer_load_dwordx4 v26, s[16:19], s28 offen lds
    v_mfma_f32_16x16x32_bf16 a[112:115], v[128:131], v[56:59], a[112:115]
    s_add_u32 m0, m0, s53
    ds_read_b64_tr_b16 v[124:125], v11 offset:25440
    v_mfma_f32_16x16x32_bf16 a[116:119], v[128:131], v[60:63], a[116:119]
    ds_read_b64_tr_b16 v[126:127], v11 offset:25696
    v_mfma_f32_16x16x32_bf16 a[120:123], v[128:131], v[64:67], a[120:123]
    v_mfma_f32_16x16x32_bf16 a[124:127], v[128:131], v[68:71], a[124:127]
    v_mfma_f32_16x16x32_bf16 a[128:131], v[128:131], v[72:75], a[128:131]
    v_mfma_f32_16x16x32_bf16 a[132:135], v[128:131], v[76:79], a[132:135]
    s_add_u32 s28, s49, s92
    buffer_load_dwordx4 v26, s[16:19], s28 offen lds
    v_mfma_f32_16x16x32_bf16 a[136:139], v[128:131], v[80:83], a[136:139]
    s_add_u32 m0, m0, s53
    ds_read_b64_tr_b16 v[128:129], v11 offset:25472
    v_mfma_f32_16x16x32_bf16 a[140:143], v[132:135], v[56:59], a[140:143]
    ds_read_b64_tr_b16 v[130:131], v11 offset:25728
    v_mfma_f32_16x16x32_bf16 a[144:147], v[132:135], v[60:63], a[144:147]
    v_mfma_f32_16x16x32_bf16 a[148:151], v[132:135], v[64:67], a[148:151]
    v_mfma_f32_16x16x32_bf16 a[152:155], v[132:135], v[68:71], a[152:155]
    v_mfma_f32_16x16x32_bf16 a[156:159], v[132:135], v[72:75], a[156:159]
    s_add_u32 s28, s49, s93
    buffer_load_dwordx4 v26, s[16:19], s28 offen lds
    v_mfma_f32_16x16x32_bf16 a[160:163], v[132:135], v[76:79], a[160:163]
    s_add_u32 m0, m0, s53
    v_mfma_f32_16x16x32_bf16 a[164:167], v[132:135], v[80:83], a[164:167]
    ds_read_b64_tr_b16 v[132:133], v11 offset:25504
    v_mfma_f32_16x16x32_bf16 a[168:171], v[136:139], v[56:59], a[168:171]
    ds_read_b64_tr_b16 v[134:135], v11 offset:25760
    v_mfma_f32_16x16x32_bf16 a[172:175], v[136:139], v[60:63], a[172:175]
    v_mfma_f32_16x16x32_bf16 a[176:179], v[136:139], v[64:67], a[176:179]
    v_mfma_f32_16x16x32_bf16 a[180:183], v[136:139], v[68:71], a[180:183]
    s_add_u32 s28, s49, s94
    buffer_load_dwordx4 v26, s[16:19], s28 offen lds
    v_mfma_f32_16x16x32_bf16 a[184:187], v[136:139], v[72:75], a[184:187]
    s_add_u32 m0, m0, s53
    v_mfma_f32_16x16x32_bf16 a[188:191], v[136:139], v[76:79], a[188:191]
    v_mfma_f32_16x16x32_bf16 a[192:195], v[136:139], v[80:83], a[192:195]
    ds_read_b64_tr_b16 v[136:137], v11 offset:25536
    v_mfma_f32_16x16x32_bf16 a[196:199], v[140:143], v[56:59], a[196:199]
    ds_read_b64_tr_b16 v[138:139], v11 offset:25792
    v_mfma_f32_16x16x32_bf16 a[200:203], v[140:143], v[60:63], a[200:203]
    v_mfma_f32_16x16x32_bf16 a[204:207], v[140:143], v[64:67], a[204:207]
    s_add_u32 s28, s49, s95
    buffer_load_dwordx4 v26, s[16:19], s28 offen lds
    v_mfma_f32_16x16x32_bf16 a[208:211], v[140:143], v[68:71], a[208:211]
    v_mfma_f32_16x16x32_bf16 a[212:215], v[140:143], v[72:75], a[212:215]
    v_mfma_f32_16x16x32_bf16 a[216:219], v[140:143], v[76:79], a[216:219]
    v_mfma_f32_16x16x32_bf16 a[220:223], v[140:143], v[80:83], a[220:223]
    ds_read_b64_tr_b16 v[140:141], v11 offset:25568
    ds_read_b64_tr_b16 v[142:143], v11 offset:25824
    s_waitcnt lgkmcnt(14)
    v_mfma_f32_16x16x32_bf16 v[144:147], v[112:115], v[28:31], v[144:147]
    s_add_u32 m0, s33, 25344
    v_mfma_f32_16x16x32_bf16 v[148:151], v[112:115], v[32:35], v[148:151]
    s_mov_b32 s49, s50
    v_mfma_f32_16x16x32_bf16 v[152:155], v[112:115], v[36:39], v[152:155]
    s_add_u32 s50, s50, s51
    v_mfma_f32_16x16x32_bf16 v[156:159], v[112:115], v[40:43], v[156:159]
    s_add_u32 s82, s82, 1
    v_mfma_f32_16x16x32_bf16 v[160:163], v[112:115], v[44:47], v[160:163]
    s_cmp_eq_u32 s82, 20
    v_mfma_f32_16x16x32_bf16 v[164:167], v[112:115], v[48:51], v[164:167]
    s_cselect_b32 s29, s83, 0
    v_mfma_f32_16x16x32_bf16 v[168:171], v[112:115], v[52:55], v[168:171]
    s_sub_u32 s50, s50, s29
    s_waitcnt vmcnt(16) lgkmcnt(0)
    s_barrier
    ds_read_b64_tr_b16 v[112:113], v11 offset:0
    v_mfma_f32_16x16x32_bf16 v[172:175], v[116:119], v[28:31], v[172:175]
    ds_read_b64_tr_b16 v[114:115], v11 offset:256
    v_mfma_f32_16x16x32_bf16 v[176:179], v[116:119], v[32:35], v[176:179]
    ds_read_b128 v[56:59], v27 offset:0
    v_mfma_f32_16x16x32_bf16 v[180:183], v[116:119], v[36:39], v[180:183]
    s_add_u32 s28, s49, s88
    buffer_load_dwordx4 v26, s[16:19], s28 offen lds
    v_mfma_f32_16x16x32_bf16 v[184:187], v[116:119], v[40:43], v[184:187]
    s_add_u32 m0, m0, s53
    ds_read_b128 v[60:63], v27 offset:1024
    v_mfma_f32_16x16x32_bf16 v[188:191], v[116:119], v[44:47], v[188:191]
    ds_read_b128 v[64:67], v27 offset:2048
    v_mfma_f32_16x16x32_bf16 v[192:195], v[116:119], v[48:51], v[192:195]
    ds_read_b128 v[68:71], v27 offset:3072
    v_mfma_f32_16x16x32_bf16 v[196:199], v[116:119], v[52:55], v[196:199]
    ds_read_b128 v[72:75], v27 offset:4096
    v_mfma_f32_16x16x32_bf16 v[200:203], v[120:123], v[28:31], v[200:203]
    ds_read_b128 v[76:79], v27 offset:5120
    v_mfma_f32_16x16x32_bf16 v[204:207], v[120:123], v[32:35], v[204:207]
    s_add_u32 s28, s49, s89
    buffer_load_dwordx4 v26, s[16:19], s28 offen lds
    v_mfma_f32_16x16x32_bf16 v[208:211], v[120:123], v[36:39], v[208:211]
    s_add_u32 m0, m0, s53
    ds_read_b128 v[80:83], v27 offset:6144
    v_mfma_f32_16x16x32_bf16 v[212:215], v[120:123], v[40:43], v[212:215]
    ds_read_b64_tr_b16 v[116:117], v11 offset:32
    v_mfma_f32_16x16x32_bf16 v[216:219], v[120:123], v[44:47], v[216:219]
    ds_read_b64_tr_b16 v[118:119], v11 offset:288
    v_mfma_f32_16x16x32_bf16 v[220:223], v[120:123], v[48:51], v[220:223]
    v_mfma_f32_16x16x32_bf16 v[224:227], v[120:123], v[52:55], v[224:227]
    ds_read_b64_tr_b16 v[120:121], v11 offset:64
    v_mfma_f32_16x16x32_bf16 v[228:231], v[124:127], v[28:31], v[228:231]
    s_add_u32 s28, s49, s90
    buffer_load_dwordx4 v26, s[16:19], s28 offen lds
    v_mfma_f32_16x16x32_bf16 v[232:235], v[124:127], v[32:35], v[232:235]
    s_add_u32 m0, m0, s53
    ds_read_b64_tr_b16 v[122:123], v11 offset:320
    v_mfma_f32_16x16x32_bf16 v[236:239], v[124:127], v[36:39], v[236:239]
    v_mfma_f32_16x16x32_bf16 v[240:243], v[124:127], v[40:43], v[240:243]
    v_mfma_f32_16x16x32_bf16 v[244:247], v[124:127], v[44:47], v[244:247]
    v_mfma_f32_16x16x32_bf16 v[248:251], v[124:127], v[48:51], v[248:251]
    v_mfma_f32_16x16x32_bf16 v[252:255], v[124:127], v[52:55], v[252:255]
    s_add_u32 s28, s49, s91
    buffer_load_dwordx4 v26, s[16:19], s28 offen lds
    v_mfma_f32_16x16x32_bf16 a[112:115], v[128:131], v[28:31], a[112:115]
    s_add_u32 m0, m0, s53
    ds_read_b64_tr_b16 v[124:125], v11 offset:96
    v_mfma_f32_16x16x32_bf16 a[116:119], v[128:131], v[32:35], a[116:119]
    ds_read_b64_tr_b16 v[126:127], v11 offset:352
    v_mfma_f32_16x16x32_bf16 a[120:123], v[128:131], v[36:39], a[120:123]
    v_mfma_f32_16x16x32_bf16 a[124:127], v[128:131], v[40:43], a[124:127]
    v_mfma_f32_16x16x32_bf16 a[128:131], v[128:131], v[44:47], a[128:131]
    v_mfma_f32_16x16x32_bf16 a[132:135], v[128:131], v[48:51], a[132:135]
    s_add_u32 s28, s49, s92
    buffer_load_dwordx4 v26, s[16:19], s28 offen lds
    v_mfma_f32_16x16x32_bf16 a[136:139], v[128:131], v[52:55], a[136:139]
    s_add_u32 m0, m0, s53
    ds_read_b64_tr_b16 v[128:129], v11 offset:128
    v_mfma_f32_16x16x32_bf16 a[140:143], v[132:135], v[28:31], a[140:143]
    ds_read_b64_tr_b16 v[130:131], v11 offset:384
    v_mfma_f32_16x16x32_bf16 a[144:147], v[132:135], v[32:35], a[144:147]
    v_mfma_f32_16x16x32_bf16 a[148:151], v[132:135], v[36:39], a[148:151]
    v_mfma_f32_16x16x32_bf16 a[152:155], v[132:135], v[40:43], a[152:155]
    v_mfma_f32_16x16x32_bf16 a[156:159], v[132:135], v[44:47], a[156:159]
    s_add_u32 s28, s49, s93
    buffer_load_dwordx4 v26, s[16:19], s28 offen lds
    v_mfma_f32_16x16x32_bf16 a[160:163], v[132:135], v[48:51], a[160:163]
    s_add_u32 m0, m0, s53
    v_mfma_f32_16x16x32_bf16 a[164:167], v[132:135], v[52:55], a[164:167]
    ds_read_b64_tr_b16 v[132:133], v11 offset:160
    v_mfma_f32_16x16x32_bf16 a[168:171], v[136:139], v[28:31], a[168:171]
    ds_read_b64_tr_b16 v[134:135], v11 offset:416
    v_mfma_f32_16x16x32_bf16 a[172:175], v[136:139], v[32:35], a[172:175]
    v_mfma_f32_16x16x32_bf16 a[176:179], v[136:139], v[36:39], a[176:179]
    v_mfma_f32_16x16x32_bf16 a[180:183], v[136:139], v[40:43], a[180:183]
    s_add_u32 s28, s49, s94
    buffer_load_dwordx4 v26, s[16:19], s28 offen lds
    v_mfma_f32_16x16x32_bf16 a[184:187], v[136:139], v[44:47], a[184:187]
    s_add_u32 m0, m0, s53
    v_mfma_f32_16x16x32_bf16 a[188:191], v[136:139], v[48:51], a[188:191]
    v_mfma_f32_16x16x32_bf16 a[192:195], v[136:139], v[52:55], a[192:195]
    ds_read_b64_tr_b16 v[136:137], v11 offset:192
    v_mfma_f32_16x16x32_bf16 a[196:199], v[140:143], v[28:31], a[196:199]
    ds_read_b64_tr_b16 v[138:139], v11 offset:448
    v_mfma_f32_16x16x32_bf16 a[200:203], v[140:143], v[32:35], a[200:203]
    v_mfma_f32_16x16x32_bf16 a[204:207], v[140:143], v[36:39], a[204:207]
    s_add_u32 s28, s49, s95
    buffer_load_dwordx4 v26, s[16:19], s28 offen lds
    v_mfma_f32_16x16x32_bf16 a[208:211], v[140:143], v[40:43], a[208:211]
    v_mfma_f32_16x16x32_bf16 a[212:215], v[140:143], v[44:47], a[212:215]
    v_mfma_f32_16x16x32_bf16 a[216:219], v[140:143], v[48:51], a[216:219]
    v_mfma_f32_16x16x32_bf16 a[220:223], v[140:143], v[52:55], a[220:223]
    ds_read_b64_tr_b16 v[140:141], v11 offset:224
    ds_read_b64_tr_b16 v[142:143], v11 offset:480
    s_cmp_lg_u32 s71, 0
    s_cbranch_scc1 L_at_nowo0
    s_mov_b32 s71, 1
    s_mov_b32 s28, 6554
    v_add_u32 v2, 0, v1
    v_mul_u32_u24 v3, s28, v2
    v_lshrrev_b32 v3, 16, v3
    v_mul_u32_u24 v4, 10, v3
    v_sub_u32 v4, v2, v4
    v_mul_u32_u24 v3, 1280, v3
    v_lshl_add_u32 v88, v4, 4, v3
    v_add_u32 v2, 64, v1
    v_mul_u32_u24 v3, s28, v2
    v_lshrrev_b32 v3, 16, v3
    v_mul_u32_u24 v4, 10, v3
    v_sub_u32 v4, v2, v4
    v_mul_u32_u24 v3, 1280, v3
    v_lshl_add_u32 v89, v4, 4, v3
    v_add_u32 v2, 128, v1
    v_mul_u32_u24 v3, s28, v2
    v_lshrrev_b32 v3, 16, v3
    v_mul_u32_u24 v4, 10, v3
    v_sub_u32 v4, v2, v4
    v_mul_u32_u24 v3, 1280, v3
    v_lshl_add_u32 v90, v4, 4, v3
    v_add_u32 v2, 192, v1
    v_mul_u32_u24 v3, s28, v2
    v_lshrrev_b32 v3, 16, v3
    v_mul_u32_u24 v4, 10, v3
    v_sub_u32 v4, v2, v4
    v_mul_u32_u24 v3, 1280, v3
    v_lshl_add_u32 v91, v4, 4, v3
    v_add_u32 v2, 256, v1
    v_mul_u32_u24 v3, s28, v2
    v_lshrrev_b32 v3, 16, v3
    v_mul_u32_u24 v4, 10, v3
    v_sub_u32 v4, v2, v4
    v_mul_u32_u24 v3, 1280, v3
    v_lshl_add_u32 v92, v4, 4, v3
    s_and_b32 s28, s2, 127
    s_mul_i32 s28, s28, 40960
    s_mul_i32 s29, s20, 320
    s_add_u32 s28, s28, s29
    s_add_u32 s28, s28, 0
    s_mul_i32 s31, s20, 7168
    s_add_u32 s31, s31, 135168
    s_add_u32 m0, s31, 0
    s_nop 0
    buffer_load_dwordx4 v88, s[84:87], s28 offen lds
    s_add_u32 m0, s31, 1024
    s_nop 0
    buffer_load_dwordx4 v89, s[84:87], s28 offen lds
    s_add_u32 m0, s31, 2048
    s_nop 0
    buffer_load_dwordx4 v90, s[84:87], s28 offen lds
    s_add_u32 m0, s31, 3072
    s_nop 0
    buffer_load_dwordx4 v91, s[84:87], s28 offen lds
    s_add_u32 m0, s31, 4096
    s_nop 0
    buffer_load_dwordx4 v92, s[84:87], s28 offen lds
L_at_nowo0:
    s_mov_b32 s22, 0
L_at_qploop:
    s_waitcnt lgkmcnt(14)
    v_mfma_f32_16x16x32_bf16 v[144:147], v[112:115], v[56:59], v[144:147]
    s_add_u32 m0, s33, 0
    v_mfma_f32_16x16x32_bf16 v[148:151], v[112:115], v[60:63], v[148:151]
    s_mov_b32 s49, s50
    v_mfma_f32_16x16x32_bf16 v[152:155], v[112:115], v[64:67], v[152:155]
    s_add_u32 s50, s50, s51
    v_mfma_f32_16x16x32_bf16 v[156:159], v[112:115], v[68:71], v[156:159]
    s_add_u32 s82, s82, 1
    v_mfma_f32_16x16x32_bf16 v[160:163], v[112:115], v[72:75], v[160:163]
    s_cmp_eq_u32 s82, 20
    v_mfma_f32_16x16x32_bf16 v[164:167], v[112:115], v[76:79], v[164:167]
    s_cselect_b32 s29, s83, 0
    v_mfma_f32_16x16x32_bf16 v[168:171], v[112:115], v[80:83], v[168:171]
    s_sub_u32 s50, s50, s29
    s_waitcnt vmcnt(16) lgkmcnt(0)
    s_barrier
    ds_read_b64_tr_b16 v[112:113], v11 offset:8448
    v_mfma_f32_16x16x32_bf16 v[172:175], v[116:119], v[56:59], v[172:175]
    ds_read_b64_tr_b16 v[114:115], v11 offset:8704
    v_mfma_f32_16x16x32_bf16 v[176:179], v[116:119], v[60:63], v[176:179]
    ds_read_b128 v[28:31], v27 offset:8448
    v_mfma_f32_16x16x32_bf16 v[180:183], v[116:119], v[64:67], v[180:183]
    s_add_u32 s28, s49, s88
    buffer_load_dwordx4 v26, s[16:19], s28 offen lds
    v_mfma_f32_16x16x32_bf16 v[184:187], v[116:119], v[68:71], v[184:187]
    s_add_u32 m0, m0, s53
    ds_read_b128 v[32:35], v27 offset:9472
    v_mfma_f32_16x16x32_bf16 v[188:191], v[116:119], v[72:75], v[188:191]
    ds_read_b128 v[36:39], v27 offset:10496
    v_mfma_f32_16x16x32_bf16 v[192:195], v[116:119], v[76:79], v[192:195]
    ds_read_b128 v[40:43], v27 offset:11520
    v_mfma_f32_16x16x32_bf16 v[196:199], v[116:119], v[80:83], v[196:199]
    ds_read_b128 v[44:47], v27 offset:12544
    v_mfma_f32_16x16x32_bf16 v[200:203], v[120:123], v[56:59], v[200:203]
    ds_read_b128 v[48:51], v27 offset:13568
    v_mfma_f32_16x16x32_bf16 v[204:207], v[120:123], v[60:63], v[204:207]
    s_add_u32 s28, s49, s89
    buffer_load_dwordx4 v26, s[16:19], s28 offen lds
    v_mfma_f32_16x16x32_bf16 v[208:211], v[120:123], v[64:67], v[208:211]
    s_add_u32 m0, m0, s53
    ds_read_b128 v[52:55], v27 offset:14592
    v_mfma_f32_16x16x32_bf16 v[212:215], v[120:123], v[68:71], v[212:215]
    ds_read_b64_tr_b16 v[116:117], v11 offset:8480
    v_mfma_f32_16x16x32_bf16 v[216:219], v[120:123], v[72:75], v[216:219]
    ds_read_b64_tr_b16 v[118:119], v11 offset:8736
    v_mfma_f32_16x16x32_bf16 v[220:223], v[120:123], v[76:79], v[220:223]
    v_mfma_f32_16x16x32_bf16 v[224:227], v[120:123], v[80:83], v[224:227]
    ds_read_b64_tr_b16 v[120:121], v11 offset:8512
    v_mfma_f32_16x16x32_bf16 v[228:231], v[124:127], v[56:59], v[228:231]
    s_add_u32 s28, s49, s90
    buffer_load_dwordx4 v26, s[16:19], s28 offen lds
    v_mfma_f32_16x16x32_bf16 v[232:235], v[124:127], v[60:63], v[232:235]
    s_add_u32 m0, m0, s53
    ds_read_b64_tr_b16 v[122:123], v11 offset:8768
    v_mfma_f32_16x16x32_bf16 v[236:239], v[124:127], v[64:67], v[236:239]
    v_mfma_f32_16x16x32_bf16 v[240:243], v[124:127], v[68:71], v[240:243]
    v_mfma_f32_16x16x32_bf16 v[244:247], v[124:127], v[72:75], v[244:247]
    v_mfma_f32_16x16x32_bf16 v[248:251], v[124:127], v[76:79], v[248:251]
    v_mfma_f32_16x16x32_bf16 v[252:255], v[124:127], v[80:83], v[252:255]
    s_add_u32 s28, s49, s91
    buffer_load_dwordx4 v26, s[16:19], s28 offen lds
    v_mfma_f32_16x16x32_bf16 a[112:115], v[128:131], v[56:59], a[112:115]
    s_add_u32 m0, m0, s53
    ds_read_b64_tr_b16 v[124:125], v11 offset:8544
    v_mfma_f32_16x16x32_bf16 a[116:119], v[128:131], v[60:63], a[116:119]
    ds_read_b64_tr_b16 v[126:127], v11 offset:8800
    v_mfma_f32_16x16x32_bf16 a[120:123], v[128:131], v[64:67], a[120:123]
    v_mfma_f32_16x16x32_bf16 a[124:127], v[128:131], v[68:71], a[124:127]
    v_mfma_f32_16x16x32_bf16 a[128:131], v[128:131], v[72:75], a[128:131]
    v_mfma_f32_16x16x32_bf16 a[132:135], v[128:131], v[76:79], a[132:135]
    s_add_u32 s28, s49, s92
    buffer_load_dwordx4 v26, s[16:19], s28 offen lds
    v_mfma_f32_16x16x32_bf16 a[136:139], v[128:131], v[80:83], a[136:139]
    s_add_u32 m0, m0, s53
    ds_read_b64_tr_b16 v[128:129], v11 offset:8576
    v_mfma_f32_16x16x32_bf16 a[140:143], v[132:135], v[56:59], a[140:143]
    ds_read_b64_tr_b16 v[130:131], v11 offset:8832
    v_mfma_f32_16x16x32_bf16 a[144:147], v[132:135], v[60:63], a[144:147]
    v_mfma_f32_16x16x32_bf16 a[148:151], v[132:135], v[64:67], a[148:151]
    v_mfma_f32_16x16x32_bf16 a[152:155], v[132:135], v[68:71], a[152:155]
    v_mfma_f32_16x16x32_bf16 a[156:159], v[132:135], v[72:75], a[156:159]
    s_add_u32 s28, s49, s93
    buffer_load_dwordx4 v26, s[16:19], s28 offen lds
    v_mfma_f32_16x16x32_bf16 a[160:163], v[132:135], v[76:79], a[160:163]
    s_add_u32 m0, m0, s53
    v_mfma_f32_16x16x32_bf16 a[164:167], v[132:135], v[80:83], a[164:167]
    ds_read_b64_tr_b16 v[132:133], v11 offset:8608
    v_mfma_f32_16x16x32_bf16 a[168:171], v[136:139], v[56:59], a[168:171]
    ds_read_b64_tr_b16 v[134:135], v11 offset:8864
    v_mfma_f32_16x16x32_bf16 a[172:175], v[136:139], v[60:63], a[172:175]
    v_mfma_f32_16x16x32_bf16 a[176:179], v[136:139], v[64:67], a[176:179]
    v_mfma_f32_16x16x32_bf16 a[180:183], v[136:139], v[68:71], a[180:183]
    s_add_u32 s28, s49, s94
    buffer_load_dwordx4 v26, s[16:19], s28 offen lds
    v_mfma_f32_16x16x32_bf16 a[184:187], v[136:139], v[72:75], a[184:187]
    s_add_u32 m0, m0, s53
    v_mfma_f32_16x16x32_bf16 a[188:191], v[136:139], v[76:79], a[188:191]
    v_mfma_f32_16x16x32_bf16 a[192:195], v[136:139], v[80:83], a[192:195]
    ds_read_b64_tr_b16 v[136:137], v11 offset:8640
    v_mfma_f32_16x16x32_bf16 a[196:199], v[140:143], v[56:59], a[196:199]
    ds_read_b64_tr_b16 v[138:139], v11 offset:8896
    v_mfma_f32_16x16x32_bf16 a[200:203], v[140:143], v[60:63], a[200:203]
    v_mfma_f32_16x16x32_bf16 a[204:207], v[140:143], v[64:67], a[204:207]
    s_add_u32 s28, s49, s95
    buffer_load_dwordx4 v26, s[16:19], s28 offen lds
    v_mfma_f32_16x16x32_bf16 a[208:211], v[140:143], v[68:71], a[208:211]
    v_mfma_f32_16x16x32_bf16 a[212:215], v[140:143], v[72:75], a[212:215]
    v_mfma_f32_16x16x32_bf16 a[216:219], v[140:143], v[76:79], a[216:219]
    v_mfma_f32_16x16x32_bf16 a[220:223], v[140:143], v[80:83], a[220:223]
    ds_read_b64_tr_b16 v[140:141], v11 offset:8672
    ds_read_b64_tr_b16 v[142:143], v11 offset:8928
    s_waitcnt lgkmcnt(14)
    v_mfma_f32_16x16x32_bf16 v[144:147], v[112:115], v[28:31], v[144:147]
    s_add_u32 m0, s33, 8448
    v_mfma_f32_16x16x32_bf16 v[148:151], v[112:115], v[32:35], v[148:151]
    s_mov_b32 s49, s50
    v_mfma_f32_16x16x32_bf16 v[152:155], v[112:115], v[36:39], v[152:155]
    s_add_u32 s50, s50, s51
    v_mfma_f32_16x16x32_bf16 v[156:159], v[112:115], v[40:43], v[156:159]
    s_add_u32 s82, s82, 1
    v_mfma_f32_16x16x32_bf16 v[160:163], v[112:115], v[44:47], v[160:163]
    s_cmp_eq_u32 s82, 20
    v_mfma_f32_16x16x32_bf16 v[164:167], v[112:115], v[48:51], v[164:167]
    s_cselect_b32 s29, s83, 0
    v_mfma_f32_16x16x32_bf16 v[168:171], v[112:115], v[52:55], v[168:171]
    s_sub_u32 s50, s50, s29
    s_waitcnt vmcnt(16) lgkmcnt(0)
    s_barrier
    ds_read_b64_tr_b16 v[112:113], v11 offset:16896
    v_mfma_f32_16x16x32_bf16 v[172:175], v[116:119], v[28:31], v[172:175]
    ds_read_b64_tr_b16 v[114:115], v11 offset:17152
    v_mfma_f32_16x16x32_bf16 v[176:179], v[116:119], v[32:35], v[176:179]
    ds_read_b128 v[56:59], v27 offset:16896
    v_mfma_f32_16x16x32_bf16 v[180:183], v[116:119], v[36:39], v[180:183]
    s_add_u32 s28, s49, s88
    buffer_load_dwordx4 v26, s[16:19], s28 offen lds
    v_mfma_f32_16x16x32_bf16 v[184:187], v[116:119], v[40:43], v[184:187]
    s_add_u32 m0, m0, s53
    ds_read_b128 v[60:63], v27 offset:17920
    v_mfma_f32_16x16x32_bf16 v[188:191], v[116:119], v[44:47], v[188:191]
    ds_read_b128 v[64:67], v27 offset:18944
    v_mfma_f32_16x16x32_bf16 v[192:195], v[116:119], v[48:51], v[192:195]
    ds_read_b128 v[68:71], v27 offset:19968
    v_mfma_f32_16x16x32_bf16 v[196:199], v[116:119], v[52:55], v[196:199]
    ds_read_b128 v[72:75], v27 offset:20992
    v_mfma_f32_16x16x32_bf16 v[200:203], v[120:123], v[28:31], v[200:203]
    ds_read_b128 v[76:79], v27 offset:22016
    v_mfma_f32_16x16x32_bf16 v[204:207], v[120:123], v[32:35], v[204:207]
    s_add_u32 s28, s49, s89
    buffer_load_dwordx4 v26, s[16:19], s28 offen lds
    v_mfma_f32_16x16x32_bf16 v[208:211], v[120:123], v[36:39], v[208:211]
    s_add_u32 m0, m0, s53
    ds_read_b128 v[80:83], v27 offset:23040
    v_mfma_f32_16x16x32_bf16 v[212:215], v[120:123], v[40:43], v[212:215]
    ds_read_b64_tr_b16 v[116:117], v11 offset:16928
    v_mfma_f32_16x16x32_bf16 v[216:219], v[120:123], v[44:47], v[216:219]
    ds_read_b64_tr_b16 v[118:119], v11 offset:17184
    v_mfma_f32_16x16x32_bf16 v[220:223], v[120:123], v[48:51], v[220:223]
    v_mfma_f32_16x16x32_bf16 v[224:227], v[120:123], v[52:55], v[224:227]
    ds_read_b64_tr_b16 v[120:121], v11 offset:16960
    v_mfma_f32_16x16x32_bf16 v[228:231], v[124:127], v[28:31], v[228:231]
    s_add_u32 s28, s49, s90
    buffer_load_dwordx4 v26, s[16:19], s28 offen lds
    v_mfma_f32_16x16x32_bf16 v[232:235], v[124:127], v[32:35], v[232:235]
    s_add_u32 m0, m0, s53
    ds_read_b64_tr_b16 v[122:123], v11 offset:17216
    v_mfma_f32_16x16x32_bf16 v[236:239], v[124:127], v[36:39], v[236:239]
    v_mfma_f32_16x16x32_bf16 v[240:243], v[124:127], v[40:43], v[240:243]
    v_mfma_f32_16x16x32_bf16 v[244:247], v[124:127], v[44:47], v[244:247]
    v_mfma_f32_16x16x32_bf16 v[248:251], v[124:127], v[48:51], v[248:251]
    v_mfma_f32_16x16x32_bf16 v[252:255], v[124:127], v[52:55], v[252:255]
    s_add_u32 s28, s49, s91
    buffer_load_dwordx4 v26, s[16:19], s28 offen lds
    v_mfma_f32_16x16x32_bf16 a[112:115], v[128:131], v[28:31], a[112:115]
    s_add_u32 m0, m0, s53
    ds_read_b64_tr_b16 v[124:125], v11 offset:16992
    v_mfma_f32_16x16x32_bf16 a[116:119], v[128:131], v[32:35], a[116:119]
    ds_read_b64_tr_b16 v[126:127], v11 offset:17248
    v_mfma_f32_16x16x32_bf16 a[120:123], v[128:131], v[36:39], a[120:123]
    v_mfma_f32_16x16x32_bf16 a[124:127], v[128:131], v[40:43], a[124:127]
    v_mfma_f32_16x16x32_bf16 a[128:131], v[128:131], v[44:47], a[128:131]
    v_mfma_f32_16x16x32_bf16 a[132:135], v[128:131], v[48:51], a[132:135]
    s_add_u32 s28, s49, s92
    buffer_load_dwordx4 v26, s[16:19], s28 offen lds
    v_mfma_f32_16x16x32_bf16 a[136:139], v[128:131], v[52:55], a[136:139]
    s_add_u32 m0, m0, s53
    ds_read_b64_tr_b16 v[128:129], v11 offset:17024
    v_mfma_f32_16x16x32_bf16 a[140:143], v[132:135], v[28:31], a[140:143]
    ds_read_b64_tr_b16 v[130:131], v11 offset:17280
    v_mfma_f32_16x16x32_bf16 a[144:147], v[132:135], v[32:35], a[144:147]
    v_mfma_f32_16x16x32_bf16 a[148:151], v[132:135], v[36:39], a[148:151]
    v_mfma_f32_16x16x32_bf16 a[152:155], v[132:135], v[40:43], a[152:155]
    v_mfma_f32_16x16x32_bf16 a[156:159], v[132:135], v[44:47], a[156:159]
    s_add_u32 s28, s49, s93
    buffer_load_dwordx4 v26, s[16:19], s28 offen lds
    v_mfma_f32_16x16x32_bf16 a[160:163], v[132:135], v[48:51], a[160:163]
    s_add_u32 m0, m0, s53
    v_mfma_f32_16x16x32_bf16 a[164:167], v[132:135], v[52:55], a[164:167]
    ds_read_b64_tr_b16 v[132:133], v11 offset:17056
    v_mfma_f32_16x16x32_bf16 a[168:171], v[136:139], v[28:31], a[168:171]
    ds_read_b64_tr_b16 v[134:135], v11 offset:17312
    v_mfma_f32_16x16x32_bf16 a[172:175], v[136:139], v[32:35], a[172:175]
    v_mfma_f32_16x16x32_bf16 a[176:179], v[136:139], v[36:39], a[176:179]
    v_mfma_f32_16x16x32_bf16 a[180:183], v[136:139], v[40:43], a[180:183]
    s_add_u32 s28, s49, s94
    buffer_load_dwordx4 v26, s[16:19], s28 offen lds
    v_mfma_f32_16x16x32_bf16 a[184:187], v[136:139], v[44:47], a[184:187]
    s_add_u32 m0, m0, s53
    v_mfma_f32_16x16x32_bf16 a[188:191], v[136:139], v[48:51], a[188:191]
    v_mfma_f32_16x16x32_bf16 a[192:195], v[136:139], v[52:55], a[192:195]
    ds_read_b64_tr_b16 v[136:137], v11 offset:17088
    v_mfma_f32_16x16x32_bf16 a[196:199], v[140:143], v[28:31], a[196:199]
    ds_read_b64_tr_b16 v[138:139], v11 offset:17344
    v_mfma_f32_16x16x32_bf16 a[200:203], v[140:143], v[32:35], a[200:203]
    v_mfma_f32_16x16x32_bf16 a[204:207], v[140:143], v[36:39], a[204:207]
    s_add_u32 s28, s49, s95
    buffer_load_dwordx4 v26, s[16:19], s28 offen lds
    v_mfma_f32_16x16x32_bf16 a[208:211], v[140:143], v[40:43], a[208:211]
    v_mfma_f32_16x16x32_bf16 a[212:215], v[140:143], v[44:47], a[212:215]
    v_mfma_f32_16x16x32_bf16 a[216:219], v[140:143], v[48:51], a[216:219]
    v_mfma_f32_16x16x32_bf16 a[220:223], v[140:143], v[52:55], a[220:223]
    ds_read_b64_tr_b16 v[140:141], v11 offset:17120
    ds_read_b64_tr_b16 v[142:143], v11 offset:17376
    s_waitcnt lgkmcnt(14)
    v_mfma_f32_16x16x32_bf16 v[144:147], v[112:115], v[56:59], v[144:147]
    s_add_u32 m0, s33, 16896
    v_mfma_f32_16x16x32_bf16 v[148:151], v[112:115], v[60:63], v[148:151]
    s_mov_b32 s49, s50
    v_mfma_f32_16x16x32_bf16 v[152:155], v[112:115], v[64:67], v[152:155]
    s_add_u32 s50, s50, s51
    v_mfma_f32_16x16x32_bf16 v[156:159], v[112:115], v[68:71], v[156:159]
    s_add_u32 s82, s82, 1
    v_mfma_f32_16x16x32_bf16 v[160:163], v[112:115], v[72:75], v[160:163]
    s_cmp_eq_u32 s82, 20
    v_mfma_f32_16x16x32_bf16 v[164:167], v[112:115], v[76:79], v[164:167]
    s_cselect_b32 s29, s83, 0
    v_mfma_f32_16x16x32_bf16 v[168:171], v[112:115], v[80:83], v[168:171]
    s_sub_u32 s50, s50, s29
    s_waitcnt vmcnt(16) lgkmcnt(0)
    s_barrier
    ds_read_b64_tr_b16 v[112:113], v11 offset:25344
    v_mfma_f32_16x16x32_bf16 v[172:175], v[116:119], v[56:59], v[172:175]
    ds_read_b64_tr_b16 v[114:115], v11 offset:25600
    v_mfma_f32_16x16x32_bf16 v[176:179], v[116:119], v[60:63], v[176:179]
    ds_read_b128 v[28:31], v27 offset:25344
    v_mfma_f32_16x16x32_bf16 v[180:183], v[116:119], v[64:67], v[180:183]
    s_add_u32 s28, s49, s88
    buffer_load_dwordx4 v26, s[16:19], s28 offen lds
    v_mfma_f32_16x16x32_bf16 v[184:187], v[116:119], v[68:71], v[184:187]
    s_add_u32 m0, m0, s53
    ds_read_b128 v[32:35], v27 offset:26368
    v_mfma_f32_16x16x32_bf16 v[188:191], v[116:119], v[72:75], v[188:191]
    ds_read_b128 v[36:39], v27 offset:27392
    v_mfma_f32_16x16x32_bf16 v[192:195], v[116:119], v[76:79], v[192:195]
    ds_read_b128 v[40:43], v27 offset:28416
    v_mfma_f32_16x16x32_bf16 v[196:199], v[116:119], v[80:83], v[196:199]
    ds_read_b128 v[44:47], v27 offset:29440
    v_mfma_f32_16x16x32_bf16 v[200:203], v[120:123], v[56:59], v[200:203]
    ds_read_b128 v[48:51], v27 offset:30464
    v_mfma_f32_16x16x32_bf16 v[204:207], v[120:123], v[60:63], v[204:207]
    s_add_u32 s28, s49, s89
    buffer_load_dwordx4 v26, s[16:19], s28 offen lds
    v_mfma_f32_16x16x32_bf16 v[208:211], v[120:123], v[64:67], v[208:211]
    s_add_u32 m0, m0, s53
    ds_read_b128 v[52:55], v27 offset:31488
    v_mfma_f32_16x16x32_bf16 v[212:215], v[120:123], v[68:71], v[212:215]
    ds_read_b64_tr_b16 v[116:117], v11 offset:25376
    v_mfma_f32_16x16x32_bf16 v[216:219], v[120:123], v[72:75], v[216:219]
    ds_read_b64_tr_b16 v[118:119], v11 offset:25632
    v_mfma_f32_16x16x32_bf16 v[220:223], v[120:123], v[76:79], v[220:223]
    v_mfma_f32_16x16x32_bf16 v[224:227], v[120:123], v[80:83], v[224:227]
    ds_read_b64_tr_b16 v[120:121], v11 offset:25408
    v_mfma_f32_16x16x32_bf16 v[228:231], v[124:127], v[56:59], v[228:231]
    s_add_u32 s28, s49, s90
    buffer_load_dwordx4 v26, s[16:19], s28 offen lds
    v_mfma_f32_16x16x32_bf16 v[232:235], v[124:127], v[60:63], v[232:235]
    s_add_u32 m0, m0, s53
    ds_read_b64_tr_b16 v[122:123], v11 offset:25664
    v_mfma_f32_16x16x32_bf16 v[236:239], v[124:127], v[64:67], v[236:239]
    v_mfma_f32_16x16x32_bf16 v[240:243], v[124:127], v[68:71], v[240:243]
    v_mfma_f32_16x16x32_bf16 v[244:247], v[124:127], v[72:75], v[244:247]
    v_mfma_f32_16x16x32_bf16 v[248:251], v[124:127], v[76:79], v[248:251]
    v_mfma_f32_16x16x32_bf16 v[252:255], v[124:127], v[80:83], v[252:255]
    s_add_u32 s28, s49, s91
    buffer_load_dwordx4 v26, s[16:19], s28 offen lds
    v_mfma_f32_16x16x32_bf16 a[112:115], v[128:131], v[56:59], a[112:115]
    s_add_u32 m0, m0, s53
    ds_read_b64_tr_b16 v[124:125], v11 offset:25440
    v_mfma_f32_16x16x32_bf16 a[116:119], v[128:131], v[60:63], a[116:119]
    ds_read_b64_tr_b16 v[126:127], v11 offset:25696
    v_mfma_f32_16x16x32_bf16 a[120:123], v[128:131], v[64:67], a[120:123]
    v_mfma_f32_16x16x32_bf16 a[124:127], v[128:131], v[68:71], a[124:127]
    v_mfma_f32_16x16x32_bf16 a[128:131], v[128:131], v[72:75], a[128:131]
    v_mfma_f32_16x16x32_bf16 a[132:135], v[128:131], v[76:79], a[132:135]
    s_add_u32 s28, s49, s92
    buffer_load_dwordx4 v26, s[16:19], s28 offen lds
    v_mfma_f32_16x16x32_bf16 a[136:139], v[128:131], v[80:83], a[136:139]
    s_add_u32 m0, m0, s53
    ds_read_b64_tr_b16 v[128:129], v11 offset:25472
    v_mfma_f32_16x16x32_bf16 a[140:143], v[132:135], v[56:59], a[140:143]
    ds_read_b64_tr_b16 v[130:131], v11 offset:25728
    v_mfma_f32_16x16x32_bf16 a[144:147], v[132:135], v[60:63], a[144:147]
    v_mfma_f32_16x16x32_bf16 a[148:151], v[132:135], v[64:67], a[148:151]
    v_mfma_f32_16x16x32_bf16 a[152:155], v[132:135], v[68:71], a[152:155]
    v_mfma_f32_16x16x32_bf16 a[156:159], v[132:135], v[72:75], a[156:159]
    s_add_u32 s28, s49, s93
    buffer_load_dwordx4 v26, s[16:19], s28 offen lds
    v_mfma_f32_16x16x32_bf16 a[160:163], v[132:135], v[76:79], a[160:163]
    s_add_u32 m0, m0, s53
    v_mfma_f32_16x16x32_bf16 a[164:167], v[132:135], v[80:83], a[164:167]
    ds_read_b64_tr_b16 v[132:133], v11 offset:25504
    v_mfma_f32_16x16x32_bf16 a[168:171], v[136:139], v[56:59], a[168:171]
    ds_read_b64_tr_b16 v[134:135], v11 offset:25760
    v_mfma_f32_16x16x32_bf16 a[172:175], v[136:139], v[60:63], a[172:175]
    v_mfma_f32_16x16x32_bf16 a[176:179], v[136:139], v[64:67], a[176:179]
    v_mfma_f32_16x16x32_bf16 a[180:183], v[136:139], v[68:71], a[180:183]
    s_add_u32 s28, s49, s94
    buffer_load_dwordx4 v26, s[16:19], s28 offen lds
    v_mfma_f32_16x16x32_bf16 a[184:187], v[136:139], v[72:75], a[184:187]
    s_add_u32 m0, m0, s53
    v_mfma_f32_16x16x32_bf16 a[188:191], v[136:139], v[76:79], a[188:191]
    v_mfma_f32_16x16x32_bf16 a[192:195], v[136:139], v[80:83], a[192:195]
    ds_read_b64_tr_b16 v[136:137], v11 offset:25536
    v_mfma_f32_16x16x32_bf16 a[196:199], v[140:143], v[56:59], a[196:199]
    ds_read_b64_tr_b16 v[138:139], v11 offset:25792
    v_mfma_f32_16x16x32_bf16 a[200:203], v[140:143], v[60:63], a[200:203]
    v_mfma_f32_16x16x32_bf16 a[204:207], v[140:143], v[64:67], a[204:207]
    s_add_u32 s28, s49, s95
    buffer_load_dwordx4 v26, s[16:19], s28 offen lds
    v_mfma_f32_16x16x32_bf16 a[208:211], v[140:143], v[68:71], a[208:211]
    v_mfma_f32_16x16x32_bf16 a[212:215], v[140:143], v[72:75], a[212:215]
    v_mfma_f32_16x16x32_bf16 a[216:219], v[140:143], v[76:79], a[216:219]
    v_mfma_f32_16x16x32_bf16 a[220:223], v[140:143], v[80:83], a[220:223]
    ds_read_b64_tr_b16 v[140:141], v11 offset:25568
    ds_read_b64_tr_b16 v[142:143], v11 offset:25824
    s_waitcnt lgkmcnt(14)
    v_mfma_f32_16x16x32_bf16 v[144:147], v[112:115], v[28:31], v[144:147]
    s_add_u32 m0, s33, 25344
    v_mfma_f32_16x16x32_bf16 v[148:151], v[112:115], v[32:35], v[148:151]
    s_mov_b32 s49, s50
    v_mfma_f32_16x16x32_bf16 v[152:155], v[112:115], v[36:39], v[152:155]
    s_add_u32 s50, s50, s51
    v_mfma_f32_16x16x32_bf16 v[156:159], v[112:115], v[40:43], v[156:159]
    s_add_u32 s82, s82, 1
    v_mfma_f32_16x16x32_bf16 v[160:163], v[112:115], v[44:47], v[160:163]
    s_cmp_eq_u32 s82, 20
    v_mfma_f32_16x16x32_bf16 v[164:167], v[112:115], v[48:51], v[164:167]
    s_cselect_b32 s29, s83, 0
    v_mfma_f32_16x16x32_bf16 v[168:171], v[112:115], v[52:55], v[168:171]
    s_sub_u32 s50, s50, s29
    s_waitcnt vmcnt(16) lgkmcnt(0)
    s_barrier
    ds_read_b64_tr_b16 v[112:113], v11 offset:0
    v_mfma_f32_16x16x32_bf16 v[172:175], v[116:119], v[28:31], v[172:175]
    ds_read_b64_tr_b16 v[114:115], v11 offset:256
    v_mfma_f32_16x16x32_bf16 v[176:179], v[116:119], v[32:35], v[176:179]
    ds_read_b128 v[56:59], v27 offset:0
    v_mfma_f32_16x16x32_bf16 v[180:183], v[116:119], v[36:39], v[180:183]
    s_add_u32 s28, s49, s88
    buffer_load_dwordx4 v26, s[16:19], s28 offen lds
    v_mfma_f32_16x16x32_bf16 v[184:187], v[116:119], v[40:43], v[184:187]
    s_add_u32 m0, m0, s53
    ds_read_b128 v[60:63], v27 offset:1024
    v_mfma_f32_16x16x32_bf16 v[188:191], v[116:119], v[44:47], v[188:191]
    ds_read_b128 v[64:67], v27 offset:2048
    v_mfma_f32_16x16x32_bf16 v[192:195], v[116:119], v[48:51], v[192:195]
    ds_read_b128 v[68:71], v27 offset:3072
    v_mfma_f32_16x16x32_bf16 v[196:199], v[116:119], v[52:55], v[196:199]
    ds_read_b128 v[72:75], v27 offset:4096
    v_mfma_f32_16x16x32_bf16 v[200:203], v[120:123], v[28:31], v[200:203]
    ds_read_b128 v[76:79], v27 offset:5120
    v_mfma_f32_16x16x32_bf16 v[204:207], v[120:123], v[32:35], v[204:207]
    s_add_u32 s28, s49, s89
    buffer_load_dwordx4 v26, s[16:19], s28 offen lds
    v_mfma_f32_16x16x32_bf16 v[208:211], v[120:123], v[36:39], v[208:211]
    s_add_u32 m0, m0, s53
    ds_read_b128 v[80:83], v27 offset:6144
    v_mfma_f32_16x16x32_bf16 v[212:215], v[120:123], v[40:43], v[212:215]
    ds_read_b64_tr_b16 v[116:117], v11 offset:32
    v_mfma_f32_16x16x32_bf16 v[216:219], v[120:123], v[44:47], v[216:219]
    ds_read_b64_tr_b16 v[118:119], v11 offset:288
    v_mfma_f32_16x16x32_bf16 v[220:223], v[120:123], v[48:51], v[220:223]
    v_mfma_f32_16x16x32_bf16 v[224:227], v[120:123], v[52:55], v[224:227]
    ds_read_b64_tr_b16 v[120:121], v11 offset:64
    v_mfma_f32_16x16x32_bf16 v[228:231], v[124:127], v[28:31], v[228:231]
    s_add_u32 s28, s49, s90
    buffer_load_dwordx4 v26, s[16:19], s28 offen lds
    v_mfma_f32_16x16x32_bf16 v[232:235], v[124:127], v[32:35], v[232:235]
    s_add_u32 m0, m0, s53
    ds_read_b64_tr_b16 v[122:123], v11 offset:320
    v_mfma_f32_16x16x32_bf16 v[236:239], v[124:127], v[36:39], v[236:239]
    v_mfma_f32_16x16x32_bf16 v[240:243], v[124:127], v[40:43], v[240:243]
    v_mfma_f32_16x16x32_bf16 v[244:247], v[124:127], v[44:47], v[244:247]
    v_mfma_f32_16x16x32_bf16 v[248:251], v[124:127], v[48:51], v[248:251]
    v_mfma_f32_16x16x32_bf16 v[252:255], v[124:127], v[52:55], v[252:255]
    s_add_u32 s28, s49, s91
    buffer_load_dwordx4 v26, s[16:19], s28 offen lds
    v_mfma_f32_16x16x32_bf16 a[112:115], v[128:131], v[28:31], a[112:115]
    s_add_u32 m0, m0, s53
    ds_read_b64_tr_b16 v[124:125], v11 offset:96
    v_mfma_f32_16x16x32_bf16 a[116:119], v[128:131], v[32:35], a[116:119]
    ds_read_b64_tr_b16 v[126:127], v11 offset:352
    v_mfma_f32_16x16x32_bf16 a[120:123], v[128:131], v[36:39], a[120:123]
    v_mfma_f32_16x16x32_bf16 a[124:127], v[128:131], v[40:43], a[124:127]
    v_mfma_f32_16x16x32_bf16 a[128:131], v[128:131], v[44:47], a[128:131]
    v_mfma_f32_16x16x32_bf16 a[132:135], v[128:131], v[48:51], a[132:135]
    s_add_u32 s28, s49, s92
    buffer_load_dwordx4 v26, s[16:19], s28 offen lds
    v_mfma_f32_16x16x32_bf16 a[136:139], v[128:131], v[52:55], a[136:139]
    s_add_u32 m0, m0, s53
    ds_read_b64_tr_b16 v[128:129], v11 offset:128
    v_mfma_f32_16x16x32_bf16 a[140:143], v[132:135], v[28:31], a[140:143]
    ds_read_b64_tr_b16 v[130:131], v11 offset:384
    v_mfma_f32_16x16x32_bf16 a[144:147], v[132:135], v[32:35], a[144:147]
    v_mfma_f32_16x16x32_bf16 a[148:151], v[132:135], v[36:39], a[148:151]
    v_mfma_f32_16x16x32_bf16 a[152:155], v[132:135], v[40:43], a[152:155]
    v_mfma_f32_16x16x32_bf16 a[156:159], v[132:135], v[44:47], a[156:159]
    s_add_u32 s28, s49, s93
    buffer_load_dwordx4 v26, s[16:19], s28 offen lds
    v_mfma_f32_16x16x32_bf16 a[160:163], v[132:135], v[48:51], a[160:163]
    s_add_u32 m0, m0, s53
    v_mfma_f32_16x16x32_bf16 a[164:167], v[132:135], v[52:55], a[164:167]
    ds_read_b64_tr_b16 v[132:133], v11 offset:160
    v_mfma_f32_16x16x32_bf16 a[168:171], v[136:139], v[28:31], a[168:171]
    ds_read_b64_tr_b16 v[134:135], v11 offset:416
    v_mfma_f32_16x16x32_bf16 a[172:175], v[136:139], v[32:35], a[172:175]
    v_mfma_f32_16x16x32_bf16 a[176:179], v[136:139], v[36:39], a[176:179]
    v_mfma_f32_16x16x32_bf16 a[180:183], v[136:139], v[40:43], a[180:183]
    s_add_u32 s28, s49, s94
    buffer_load_dwordx4 v26, s[16:19], s28 offen lds
    v_mfma_f32_16x16x32_bf16 a[184:187], v[136:139], v[44:47], a[184:187]
    s_add_u32 m0, m0, s53
    v_mfma_f32_16x16x32_bf16 a[188:191], v[136:139], v[48:51], a[188:191]
    v_mfma_f32_16x16x32_bf16 a[192:195], v[136:139], v[52:55], a[192:195]
    ds_read_b64_tr_b16 v[136:137], v11 offset:192
    v_mfma_f32_16x16x32_bf16 a[196:199], v[140:143], v[28:31], a[196:199]
    ds_read_b64_tr_b16 v[138:139], v11 offset:448
    v_mfma_f32_16x16x32_bf16 a[200:203], v[140:143], v[32:35], a[200:203]
    v_mfma_f32_16x16x32_bf16 a[204:207], v[140:143], v[36:39], a[204:207]
    s_add_u32 s28, s49, s95
    buffer_load_dwordx4 v26, s[16:19], s28 offen lds
    v_mfma_f32_16x16x32_bf16 a[208:211], v[140:143], v[40:43], a[208:211]
    v_mfma_f32_16x16x32_bf16 a[212:215], v[140:143], v[44:47], a[212:215]
    v_mfma_f32_16x16x32_bf16 a[216:219], v[140:143], v[48:51], a[216:219]
    v_mfma_f32_16x16x32_bf16 a[220:223], v[140:143], v[52:55], a[220:223]
    ds_read_b64_tr_b16 v[140:141], v11 offset:224
    ds_read_b64_tr_b16 v[142:143], v11 offset:480
    s_add_u32 s22, s22, 1
    s_cmp_lt_u32 s22, 3
    s_cbranch_scc1 L_at_qploop
    s_cmp_lg_u32 s70, 0
    s_cbranch_scc1 L_at_qptailB
    s_waitcnt lgkmcnt(14)
    v_mfma_f32_16x16x32_bf16 v[144:147], v[112:115], v[56:59], v[144:147]
    s_add_u32 s29, s34, s100
    v_mfma_f32_16x16x32_bf16 v[148:151], v[112:115], v[60:63], v[148:151]
    s_bfe_u32 s28, s29, 0x20003
    v_mfma_f32_16x16x32_bf16 v[152:155], v[112:115], v[64:67], v[152:155]
    s_lshl_b32 s28, s28, 16
    v_mfma_f32_16x16x32_bf16 v[156:159], v[112:115], v[68:71], v[156:159]
    s_and_b32 s29, s29, 7
    v_mfma_f32_16x16x32_bf16 v[160:163], v[112:115], v[72:75], v[160:163]
    s_lshl_b32 s29, s29, 11
    v_mfma_f32_16x16x32_bf16 v[164:167], v[112:115], v[76:79], v[164:167]
    s_add_u32 s29, s28, s29
    v_mfma_f32_16x16x32_bf16 v[168:171], v[112:115], v[80:83], v[168:171]
    s_lshr_b32 s28, s34, 5
    s_waitcnt vmcnt(16) lgkmcnt(0)
    s_barrier
    ds_read_b64_tr_b16 v[112:113], v11 offset:8448
    v_mfma_f32_16x16x32_bf16 v[172:175], v[116:119], v[56:59], v[172:175]
    s_lshl_b32 s28, s28, 19
    ds_read_b64_tr_b16 v[114:115], v11 offset:8704
    v_mfma_f32_16x16x32_bf16 v[176:179], v[116:119], v[60:63], v[176:179]
    s_add_u32 s49, s28, s29
    ds_read_b128 v[28:31], v27 offset:8448
    v_mfma_f32_16x16x32_bf16 v[180:183], v[116:119], v[64:67], v[180:183]
    s_add_u32 m0, s33, 0
    ds_read_b128 v[32:35], v27 offset:9472
    v_mfma_f32_16x16x32_bf16 v[184:187], v[116:119], v[68:71], v[184:187]
    s_add_u32 s34, s34, 1
    ds_read_b128 v[36:39], v27 offset:10496
    v_mfma_f32_16x16x32_bf16 v[188:191], v[116:119], v[72:75], v[188:191]
    buffer_load_dwordx4 v7, s[4:7], s49 offen offset:0 nt lds
    v_mfma_f32_16x16x32_bf16 v[192:195], v[116:119], v[76:79], v[192:195]
    s_add_u32 m0, m0, s96
    ds_read_b128 v[40:43], v27 offset:11520
    v_mfma_f32_16x16x32_bf16 v[196:199], v[116:119], v[80:83], v[196:199]
    ds_read_b128 v[44:47], v27 offset:12544
    v_mfma_f32_16x16x32_bf16 v[200:203], v[120:123], v[56:59], v[200:203]
    ds_read_b128 v[48:51], v27 offset:13568
    v_mfma_f32_16x16x32_bf16 v[204:207], v[120:123], v[60:63], v[204:207]
    buffer_load_dwordx4 v7, s[4:7], s49 offen offset:256 nt lds
    v_mfma_f32_16x16x32_bf16 v[208:211], v[120:123], v[64:67], v[208:211]
    s_add_u32 m0, m0, s97
    ds_read_b128 v[52:55], v27 offset:14592
    v_mfma_f32_16x16x32_bf16 v[212:215], v[120:123], v[68:71], v[212:215]
    ds_read_b64_tr_b16 v[116:117], v11 offset:8480
    v_mfma_f32_16x16x32_bf16 v[216:219], v[120:123], v[72:75], v[216:219]
    ds_read_b64_tr_b16 v[118:119], v11 offset:8736
    v_mfma_f32_16x16x32_bf16 v[220:223], v[120:123], v[76:79], v[220:223]
    v_mfma_f32_16x16x32_bf16 v[224:227], v[120:123], v[80:83], v[224:227]
    ds_read_b64_tr_b16 v[120:121], v11 offset:8512
    v_mfma_f32_16x16x32_bf16 v[228:231], v[124:127], v[56:59], v[228:231]
    buffer_load_dwordx4 v7, s[4:7], s49 offen offset:512 nt lds
    v_mfma_f32_16x16x32_bf16 v[232:235], v[124:127], v[60:63], v[232:235]
    s_add_u32 m0, m0, s96
    ds_read_b64_tr_b16 v[122:123], v11 offset:8768
    v_mfma_f32_16x16x32_bf16 v[236:239], v[124:127], v[64:67], v[236:239]
    v_mfma_f32_16x16x32_bf16 v[240:243], v[124:127], v[68:71], v[240:243]
    v_mfma_f32_16x16x32_bf16 v[244:247], v[124:127], v[72:75], v[244:247]
    v_mfma_f32_16x16x32_bf16 v[248:251], v[124:127], v[76:79], v[248:251]
    v_mfma_f32_16x16x32_bf16 v[252:255], v[124:127], v[80:83], v[252:255]
    buffer_load_dwordx4 v7, s[4:7], s49 offen offset:768 nt lds
    v_mfma_f32_16x16x32_bf16 a[112:115], v[128:131], v[56:59], a[112:115]
    s_add_u32 m0, m0, s97
    ds_read_b64_tr_b16 v[124:125], v11 offset:8544
    v_mfma_f32_16x16x32_bf16 a[116:119], v[128:131], v[60:63], a[116:119]
    ds_read_b64_tr_b16 v[126:127], v11 offset:8800
    v_mfma_f32_16x16x32_bf16 a[120:123], v[128:131], v[64:67], a[120:123]
    v_mfma_f32_16x16x32_bf16 a[124:127], v[128:131], v[68:71], a[124:127]
    v_mfma_f32_16x16x32_bf16 a[128:131], v[128:131], v[72:75], a[128:131]
    v_mfma_f32_16x16x32_bf16 a[132:135], v[128:131], v[76:79], a[132:135]
    buffer_load_dwordx4 v7, s[4:7], s49 offen offset:1024 nt lds
    v_mfma_f32_16x16x32_bf16 a[136:139], v[128:131], v[80:83], a[136:139]
    s_add_u32 m0, m0, s96
    ds_read_b64_tr_b16 v[128:129], v11 offset:8576
    v_mfma_f32_16x16x32_bf16 a[140:143], v[132:135], v[56:59], a[140:143]
    ds_read_b64_tr_b16 v[130:131], v11 offset:8832
    v_mfma_f32_16x16x32_bf16 a[144:147], v[132:135], v[60:63], a[144:147]
    v_mfma_f32_16x16x32_bf16 a[148:151], v[132:135], v[64:67], a[148:151]
    v_mfma_f32_16x16x32_bf16 a[152:155], v[132:135], v[68:71], a[152:155]
    v_mfma_f32_16x16x32_bf16 a[156:159], v[132:135], v[72:75], a[156:159]
    buffer_load_dwordx4 v7, s[4:7], s49 offen offset:1280 nt lds
    v_mfma_f32_16x16x32_bf16 a[160:163], v[132:135], v[76:79], a[160:163]
    s_add_u32 m0, m0, s97
    v_mfma_f32_16x16x32_bf16 a[164:167], v[132:135], v[80:83], a[164:167]
    ds_read_b64_tr_b16 v[132:133], v11 offset:8608
    v_mfma_f32_16x16x32_bf16 a[168:171], v[136:139], v[56:59], a[168:171]
    ds_read_b64_tr_b16 v[134:135], v11 offset:8864
    v_mfma_f32_16x16x32_bf16 a[172:175], v[136:139], v[60:63], a[172:175]
    v_mfma_f32_16x16x32_bf16 a[176:179], v[136:139], v[64:67], a[176:179]
    v_mfma_f32_16x16x32_bf16 a[180:183], v[136:139], v[68:71], a[180:183]
    buffer_load_dwordx4 v7, s[4:7], s49 offen offset:1536 nt lds
    v_mfma_f32_16x16x32_bf16 a[184:187], v[136:139], v[72:75], a[184:187]
    s_add_u32 m0, m0, s96
    v_mfma_f32_16x16x32_bf16 a[188:191], v[136:139], v[76:79], a[188:191]
    v_mfma_f32_16x16x32_bf16 a[192:195], v[136:139], v[80:83], a[192:195]
    ds_read_b64_tr_b16 v[136:137], v11 offset:8640
    v_mfma_f32_16x16x32_bf16 a[196:199], v[140:143], v[56:59], a[196:199]
    ds_read_b64_tr_b16 v[138:139], v11 offset:8896
    v_mfma_f32_16x16x32_bf16 a[200:203], v[140:143], v[60:63], a[200:203]
    v_mfma_f32_16x16x32_bf16 a[204:207], v[140:143], v[64:67], a[204:207]
    buffer_load_dwordx4 v7, s[4:7], s49 offen offset:1792 nt lds
    v_mfma_f32_16x16x32_bf16 a[208:211], v[140:143], v[68:71], a[208:211]
    v_mfma_f32_16x16x32_bf16 a[212:215], v[140:143], v[72:75], a[212:215]
    v_mfma_f32_16x16x32_bf16 a[216:219], v[140:143], v[76:79], a[216:219]
    v_mfma_f32_16x16x32_bf16 a[220:223], v[140:143], v[80:83], a[220:223]
    ds_read_b64_tr_b16 v[140:141], v11 offset:8672
    ds_read_b64_tr_b16 v[142:143], v11 offset:8928
    s_waitcnt lgkmcnt(14)
    v_mfma_f32_16x16x32_bf16 v[144:147], v[112:115], v[28:31], v[144:147]
    s_add_u32 s29, s34, s100
    v_mfma_f32_16x16x32_bf16 v[148:151], v[112:115], v[32:35], v[148:151]
    s_bfe_u32 s28, s29, 0x20003
    v_mfma_f32_16x16x32_bf16 v[152:155], v[112:115], v[36:39], v[152:155]
    s_lshl_b32 s28, s28, 16
    v_mfma_f32_16x16x32_bf16 v[156:159], v[112:115], v[40:43], v[156:159]
    s_and_b32 s29, s29, 7
    v_mfma_f32_16x16x32_bf16 v[160:163], v[112:115], v[44:47], v[160:163]
    s_lshl_b32 s29, s29, 11
    v_mfma_f32_16x16x32_bf16 v[164:167], v[112:115], v[48:51], v[164:167]
    s_add_u32 s29, s28, s29
    v_mfma_f32_16x16x32_bf16 v[168:171], v[112:115], v[52:55], v[168:171]
    s_lshr_b32 s28, s34, 5
    s_waitcnt vmcnt(16) lgkmcnt(0)
    s_barrier
    ds_read_b64_tr_b16 v[112:113], v11 offset:16896
    v_mfma_f32_16x16x32_bf16 v[172:175], v[116:119], v[28:31], v[172:175]
    s_lshl_b32 s28, s28, 19
    ds_read_b64_tr_b16 v[114:115], v11 offset:17152
    v_mfma_f32_16x16x32_bf16 v[176:179], v[116:119], v[32:35], v[176:179]
    s_add_u32 s49, s28, s29
    ds_read_b128 v[56:59], v27 offset:16896
    v_mfma_f32_16x16x32_bf16 v[180:183], v[116:119], v[36:39], v[180:183]
    s_add_u32 m0, s33, 8448
    ds_read_b128 v[60:63], v27 offset:17920
    v_mfma_f32_16x16x32_bf16 v[184:187], v[116:119], v[40:43], v[184:187]
    s_add_u32 s34, s34, 1
    ds_read_b128 v[64:67], v27 offset:18944
    v_mfma_f32_16x16x32_bf16 v[188:191], v[116:119], v[44:47], v[188:191]
    buffer_load_dwordx4 v7, s[4:7], s49 offen offset:0 nt lds
    v_mfma_f32_16x16x32_bf16 v[192:195], v[116:119], v[48:51], v[192:195]
    s_add_u32 m0, m0, s96
    ds_read_b128 v[68:71], v27 offset:19968
    v_mfma_f32_16x16x32_bf16 v[196:199], v[116:119], v[52:55], v[196:199]
    ds_read_b128 v[72:75], v27 offset:20992
    v_mfma_f32_16x16x32_bf16 v[200:203], v[120:123], v[28:31], v[200:203]
    ds_read_b128 v[76:79], v27 offset:22016
    v_mfma_f32_16x16x32_bf16 v[204:207], v[120:123], v[32:35], v[204:207]
    buffer_load_dwordx4 v7, s[4:7], s49 offen offset:256 nt lds
    v_mfma_f32_16x16x32_bf16 v[208:211], v[120:123], v[36:39], v[208:211]
    s_add_u32 m0, m0, s97
    ds_read_b128 v[80:83], v27 offset:23040
    v_mfma_f32_16x16x32_bf16 v[212:215], v[120:123], v[40:43], v[212:215]
    ds_read_b64_tr_b16 v[116:117], v11 offset:16928
    v_mfma_f32_16x16x32_bf16 v[216:219], v[120:123], v[44:47], v[216:219]
    ds_read_b64_tr_b16 v[118:119], v11 offset:17184
    v_mfma_f32_16x16x32_bf16 v[220:223], v[120:123], v[48:51], v[220:223]
    v_mfma_f32_16x16x32_bf16 v[224:227], v[120:123], v[52:55], v[224:227]
    ds_read_b64_tr_b16 v[120:121], v11 offset:16960
    v_mfma_f32_16x16x32_bf16 v[228:231], v[124:127], v[28:31], v[228:231]
    buffer_load_dwordx4 v7, s[4:7], s49 offen offset:512 nt lds
    v_mfma_f32_16x16x32_bf16 v[232:235], v[124:127], v[32:35], v[232:235]
    s_add_u32 m0, m0, s96
    ds_read_b64_tr_b16 v[122:123], v11 offset:17216
    v_mfma_f32_16x16x32_bf16 v[236:239], v[124:127], v[36:39], v[236:239]
    v_mfma_f32_16x16x32_bf16 v[240:243], v[124:127], v[40:43], v[240:243]
    v_mfma_f32_16x16x32_bf16 v[244:247], v[124:127], v[44:47], v[244:247]
    v_mfma_f32_16x16x32_bf16 v[248:251], v[124:127], v[48:51], v[248:251]
    v_mfma_f32_16x16x32_bf16 v[252:255], v[124:127], v[52:55], v[252:255]
    buffer_load_dwordx4 v7, s[4:7], s49 offen offset:768 nt lds
    v_mfma_f32_16x16x32_bf16 a[112:115], v[128:131], v[28:31], a[112:115]
    s_add_u32 m0, m0, s97
    ds_read_b64_tr_b16 v[124:125], v11 offset:16992
    v_mfma_f32_16x16x32_bf16 a[116:119], v[128:131], v[32:35], a[116:119]
    ds_read_b64_tr_b16 v[126:127], v11 offset:17248
    v_mfma_f32_16x16x32_bf16 a[120:123], v[128:131], v[36:39], a[120:123]
    v_mfma_f32_16x16x32_bf16 a[124:127], v[128:131], v[40:43], a[124:127]
    v_mfma_f32_16x16x32_bf16 a[128:131], v[128:131], v[44:47], a[128:131]
    v_mfma_f32_16x16x32_bf16 a[132:135], v[128:131], v[48:51], a[132:135]
    buffer_load_dwordx4 v7, s[4:7], s49 offen offset:1024 nt lds
    v_mfma_f32_16x16x32_bf16 a[136:139], v[128:131], v[52:55], a[136:139]
    s_add_u32 m0, m0, s96
    ds_read_b64_tr_b16 v[128:129], v11 offset:17024
    v_mfma_f32_16x16x32_bf16 a[140:143], v[132:135], v[28:31], a[140:143]
    ds_read_b64_tr_b16 v[130:131], v11 offset:17280
    v_mfma_f32_16x16x32_bf16 a[144:147], v[132:135], v[32:35], a[144:147]
    v_mfma_f32_16x16x32_bf16 a[148:151], v[132:135], v[36:39], a[148:151]
    v_mfma_f32_16x16x32_bf16 a[152:155], v[132:135], v[40:43], a[152:155]
    v_mfma_f32_16x16x32_bf16 a[156:159], v[132:135], v[44:47], a[156:159]
    buffer_load_dwordx4 v7, s[4:7], s49 offen offset:1280 nt lds
    v_mfma_f32_16x16x32_bf16 a[160:163], v[132:135], v[48:51], a[160:163]
    s_add_u32 m0, m0, s97
    v_mfma_f32_16x16x32_bf16 a[164:167], v[132:135], v[52:55], a[164:167]
    ds_read_b64_tr_b16 v[132:133], v11 offset:17056
    v_mfma_f32_16x16x32_bf16 a[168:171], v[136:139], v[28:31], a[168:171]
    ds_read_b64_tr_b16 v[134:135], v11 offset:17312
    v_mfma_f32_16x16x32_bf16 a[172:175], v[136:139], v[32:35], a[172:175]
    v_mfma_f32_16x16x32_bf16 a[176:179], v[136:139], v[36:39], a[176:179]
    v_mfma_f32_16x16x32_bf16 a[180:183], v[136:139], v[40:43], a[180:183]
    buffer_load_dwordx4 v7, s[4:7], s49 offen offset:1536 nt lds
    v_mfma_f32_16x16x32_bf16 a[184:187], v[136:139], v[44:47], a[184:187]
    s_add_u32 m0, m0, s96
    v_mfma_f32_16x16x32_bf16 a[188:191], v[136:139], v[48:51], a[188:191]
    v_mfma_f32_16x16x32_bf16 a[192:195], v[136:139], v[52:55], a[192:195]
    ds_read_b64_tr_b16 v[136:137], v11 offset:17088
    v_mfma_f32_16x16x32_bf16 a[196:199], v[140:143], v[28:31], a[196:199]
    ds_read_b64_tr_b16 v[138:139], v11 offset:17344
    v_mfma_f32_16x16x32_bf16 a[200:203], v[140:143], v[32:35], a[200:203]
    v_mfma_f32_16x16x32_bf16 a[204:207], v[140:143], v[36:39], a[204:207]
    buffer_load_dwordx4 v7, s[4:7], s49 offen offset:1792 nt lds
    v_mfma_f32_16x16x32_bf16 a[208:211], v[140:143], v[40:43], a[208:211]
    v_mfma_f32_16x16x32_bf16 a[212:215], v[140:143], v[44:47], a[212:215]
    v_mfma_f32_16x16x32_bf16 a[216:219], v[140:143], v[48:51], a[216:219]
    v_mfma_f32_16x16x32_bf16 a[220:223], v[140:143], v[52:55], a[220:223]
    ds_read_b64_tr_b16 v[140:141], v11 offset:17120
    ds_read_b64_tr_b16 v[142:143], v11 offset:17376
    s_waitcnt lgkmcnt(14)
    v_mfma_f32_16x16x32_bf16 v[144:147], v[112:115], v[56:59], v[144:147]
    s_add_u32 s29, s34, s100
    v_mfma_f32_16x16x32_bf16 v[148:151], v[112:115], v[60:63], v[148:151]
    s_bfe_u32 s28, s29, 0x20003
    v_mfma_f32_16x16x32_bf16 v[152:155], v[112:115], v[64:67], v[152:155]
    s_lshl_b32 s28, s28, 16
    v_mfma_f32_16x16x32_bf16 v[156:159], v[112:115], v[68:71], v[156:159]
    s_and_b32 s29, s29, 7
    v_mfma_f32_16x16x32_bf16 v[160:163], v[112:115], v[72:75], v[160:163]
    s_lshl_b32 s29, s29, 11
    v_mfma_f32_16x16x32_bf16 v[164:167], v[112:115], v[76:79], v[164:167]
    s_add_u32 s29, s28, s29
    v_mfma_f32_16x16x32_bf16 v[168:171], v[112:115], v[80:83], v[168:171]
    s_lshr_b32 s28, s34, 5
    s_waitcnt vmcnt(16) lgkmcnt(0)
    s_barrier
    ds_read_b64_tr_b16 v[112:113], v11 offset:25344
    v_mfma_f32_16x16x32_bf16 v[172:175], v[116:119], v[56:59], v[172:175]
    s_lshl_b32 s28, s28, 19
    ds_read_b64_tr_b16 v[114:115], v11 offset:25600
    v_mfma_f32_16x16x32_bf16 v[176:179], v[116:119], v[60:63], v[176:179]
    s_add_u32 s49, s28, s29
    ds_read_b128 v[28:31], v27 offset:25344
    v_mfma_f32_16x16x32_bf16 v[180:183], v[116:119], v[64:67], v[180:183]
    s_add_u32 m0, s33, 16896
    ds_read_b128 v[32:35], v27 offset:26368
    v_mfma_f32_16x16x32_bf16 v[184:187], v[116:119], v[68:71], v[184:187]
    s_add_u32 s34, s34, 1
    ds_read_b128 v[36:39], v27 offset:27392
    v_mfma_f32_16x16x32_bf16 v[188:191], v[116:119], v[72:75], v[188:191]
    buffer_load_dwordx4 v7, s[4:7], s49 offen offset:0 nt lds
    v_mfma_f32_16x16x32_bf16 v[192:195], v[116:119], v[76:79], v[192:195]
    s_add_u32 m0, m0, s96
    ds_read_b128 v[40:43], v27 offset:28416
    v_mfma_f32_16x16x32_bf16 v[196:199], v[116:119], v[80:83], v[196:199]
    ds_read_b128 v[44:47], v27 offset:29440
    v_mfma_f32_16x16x32_bf16 v[200:203], v[120:123], v[56:59], v[200:203]
    ds_read_b128 v[48:51], v27 offset:30464
    v_mfma_f32_16x16x32_bf16 v[204:207], v[120:123], v[60:63], v[204:207]
    buffer_load_dwordx4 v7, s[4:7], s49 offen offset:256 nt lds
    v_mfma_f32_16x16x32_bf16 v[208:211], v[120:123], v[64:67], v[208:211]
    s_add_u32 m0, m0, s97
    ds_read_b128 v[52:55], v27 offset:31488
    v_mfma_f32_16x16x32_bf16 v[212:215], v[120:123], v[68:71], v[212:215]
    ds_read_b64_tr_b16 v[116:117], v11 offset:25376
    v_mfma_f32_16x16x32_bf16 v[216:219], v[120:123], v[72:75], v[216:219]
    ds_read_b64_tr_b16 v[118:119], v11 offset:25632
    v_mfma_f32_16x16x32_bf16 v[220:223], v[120:123], v[76:79], v[220:223]
    v_mfma_f32_16x16x32_bf16 v[224:227], v[120:123], v[80:83], v[224:227]
    ds_read_b64_tr_b16 v[120:121], v11 offset:25408
    v_mfma_f32_16x16x32_bf16 v[228:231], v[124:127], v[56:59], v[228:231]
    buffer_load_dwordx4 v7, s[4:7], s49 offen offset:512 nt lds
    v_mfma_f32_16x16x32_bf16 v[232:235], v[124:127], v[60:63], v[232:235]
    s_add_u32 m0, m0, s96
    ds_read_b64_tr_b16 v[122:123], v11 offset:25664
    v_mfma_f32_16x16x32_bf16 v[236:239], v[124:127], v[64:67], v[236:239]
    v_mfma_f32_16x16x32_bf16 v[240:243], v[124:127], v[68:71], v[240:243]
    v_mfma_f32_16x16x32_bf16 v[244:247], v[124:127], v[72:75], v[244:247]
    v_mfma_f32_16x16x32_bf16 v[248:251], v[124:127], v[76:79], v[248:251]
    v_mfma_f32_16x16x32_bf16 v[252:255], v[124:127], v[80:83], v[252:255]
    buffer_load_dwordx4 v7, s[4:7], s49 offen offset:768 nt lds
    v_mfma_f32_16x16x32_bf16 a[112:115], v[128:131], v[56:59], a[112:115]
    s_add_u32 m0, m0, s97
    ds_read_b64_tr_b16 v[124:125], v11 offset:25440
    v_mfma_f32_16x16x32_bf16 a[116:119], v[128:131], v[60:63], a[116:119]
    ds_read_b64_tr_b16 v[126:127], v11 offset:25696
    v_mfma_f32_16x16x32_bf16 a[120:123], v[128:131], v[64:67], a[120:123]
    v_mfma_f32_16x16x32_bf16 a[124:127], v[128:131], v[68:71], a[124:127]
    v_mfma_f32_16x16x32_bf16 a[128:131], v[128:131], v[72:75], a[128:131]
    v_mfma_f32_16x16x32_bf16 a[132:135], v[128:131], v[76:79], a[132:135]
    buffer_load_dwordx4 v7, s[4:7], s49 offen offset:1024 nt lds
    v_mfma_f32_16x16x32_bf16 a[136:139], v[128:131], v[80:83], a[136:139]
    s_add_u32 m0, m0, s96
    ds_read_b64_tr_b16 v[128:129], v11 offset:25472
    v_mfma_f32_16x16x32_bf16 a[140:143], v[132:135], v[56:59], a[140:143]
    ds_read_b64_tr_b16 v[130:131], v11 offset:25728
    v_mfma_f32_16x16x32_bf16 a[144:147], v[132:135], v[60:63], a[144:147]
    v_mfma_f32_16x16x32_bf16 a[148:151], v[132:135], v[64:67], a[148:151]
    v_mfma_f32_16x16x32_bf16 a[152:155], v[132:135], v[68:71], a[152:155]
    v_mfma_f32_16x16x32_bf16 a[156:159], v[132:135], v[72:75], a[156:159]
    buffer_load_dwordx4 v7, s[4:7], s49 offen offset:1280 nt lds
    v_mfma_f32_16x16x32_bf16 a[160:163], v[132:135], v[76:79], a[160:163]
    s_add_u32 m0, m0, s97
    v_mfma_f32_16x16x32_bf16 a[164:167], v[132:135], v[80:83], a[164:167]
    ds_read_b64_tr_b16 v[132:133], v11 offset:25504
    v_mfma_f32_16x16x32_bf16 a[168:171], v[136:139], v[56:59], a[168:171]
    ds_read_b64_tr_b16 v[134:135], v11 offset:25760
    v_mfma_f32_16x16x32_bf16 a[172:175], v[136:139], v[60:63], a[172:175]
    v_mfma_f32_16x16x32_bf16 a[176:179], v[136:139], v[64:67], a[176:179]
    v_mfma_f32_16x16x32_bf16 a[180:183], v[136:139], v[68:71], a[180:183]
    buffer_load_dwordx4 v7, s[4:7], s49 offen offset:1536 nt lds
    v_mfma_f32_16x16x32_bf16 a[184:187], v[136:139], v[72:75], a[184:187]
    s_add_u32 m0, m0, s96
    v_mfma_f32_16x16x32_bf16 a[188:191], v[136:139], v[76:79], a[188:191]
    v_mfma_f32_16x16x32_bf16 a[192:195], v[136:139], v[80:83], a[192:195]
    ds_read_b64_tr_b16 v[136:137], v11 offset:25536
    v_mfma_f32_16x16x32_bf16 a[196:199], v[140:143], v[56:59], a[196:199]
    ds_read_b64_tr_b16 v[138:139], v11 offset:25792
    v_mfma_f32_16x16x32_bf16 a[200:203], v[140:143], v[60:63], a[200:203]
    v_mfma_f32_16x16x32_bf16 a[204:207], v[140:143], v[64:67], a[204:207]
    buffer_load_dwordx4 v7, s[4:7], s49 offen offset:1792 nt lds
    v_mfma_f32_16x16x32_bf16 a[208:211], v[140:143], v[68:71], a[208:211]
    v_mfma_f32_16x16x32_bf16 a[212:215], v[140:143], v[72:75], a[212:215]
    v_mfma_f32_16x16x32_bf16 a[216:219], v[140:143], v[76:79], a[216:219]
    v_mfma_f32_16x16x32_bf16 a[220:223], v[140:143], v[80:83], a[220:223]
    ds_read_b64_tr_b16 v[140:141], v11 offset:25568
    ds_read_b64_tr_b16 v[142:143], v11 offset:25824
    s_waitcnt lgkmcnt(14)
    v_mfma_f32_16x16x32_bf16 v[144:147], v[112:115], v[28:31], v[144:147]
    s_add_u32 s29, s34, s100
    v_mfma_f32_16x16x32_bf16 v[148:151], v[112:115], v[32:35], v[148:151]
    s_bfe_u32 s28, s29, 0x20003
    v_mfma_f32_16x16x32_bf16 v[152:155], v[112:115], v[36:39], v[152:155]
    s_lshl_b32 s28, s28, 16
    v_mfma_f32_16x16x32_bf16 v[156:159], v[112:115], v[40:43], v[156:159]
    s_and_b32 s29, s29, 7
    v_mfma_f32_16x16x32_bf16 v[160:163], v[112:115], v[44:47], v[160:163]
    s_lshl_b32 s29, s29, 11
    v_mfma_f32_16x16x32_bf16 v[164:167], v[112:115], v[48:51], v[164:167]
    s_add_u32 s29, s28, s29
    v_mfma_f32_16x16x32_bf16 v[168:171], v[112:115], v[52:55], v[168:171]
    s_lshr_b32 s28, s34, 5
    s_waitcnt vmcnt(16) lgkmcnt(0)
    s_barrier
    ds_read_b128 v[56:59], v8 offset:0
    v_mfma_f32_16x16x32_bf16 v[172:175], v[116:119], v[28:31], v[172:175]
    s_lshl_b32 s28, s28, 19
    ds_read_b128 v[60:63], v8 offset:64
    v_mfma_f32_16x16x32_bf16 v[176:179], v[116:119], v[32:35], v[176:179]
    s_add_u32 s49, s28, s29
    ds_read_b128 v[64:67], v8 offset:128
    v_mfma_f32_16x16x32_bf16 v[180:183], v[116:119], v[36:39], v[180:183]
    s_add_u32 m0, s33, 25344
    ds_read_b128 v[68:71], v8 offset:192
    v_mfma_f32_16x16x32_bf16 v[184:187], v[116:119], v[40:43], v[184:187]
    s_add_u32 s34, s34, 1
    ds_read_b128 v[72:75], v8 offset:512
    v_mfma_f32_16x16x32_bf16 v[188:191], v[116:119], v[44:47], v[188:191]
    buffer_load_dwordx4 v7, s[4:7], s49 offen offset:0 nt lds
    v_mfma_f32_16x16x32_bf16 v[192:195], v[116:119], v[48:51], v[192:195]
    s_add_u32 m0, m0, s96
    ds_read_b128 v[76:79], v8 offset:576
    v_mfma_f32_16x16x32_bf16 v[196:199], v[116:119], v[52:55], v[196:199]
    ds_read_b128 v[80:83], v8 offset:640
    v_mfma_f32_16x16x32_bf16 v[200:203], v[120:123], v[28:31], v[200:203]
    ds_read_b128 v[84:87], v8 offset:704
    v_mfma_f32_16x16x32_bf16 v[204:207], v[120:123], v[32:35], v[204:207]
    buffer_load_dwordx4 v7, s[4:7], s49 offen offset:256 nt lds
    v_mfma_f32_16x16x32_bf16 v[208:211], v[120:123], v[36:39], v[208:211]
    s_add_u32 m0, m0, s97
    v_mfma_f32_16x16x32_bf16 v[212:215], v[120:123], v[40:43], v[212:215]
    v_mfma_f32_16x16x32_bf16 v[216:219], v[120:123], v[44:47], v[216:219]
    v_mfma_f32_16x16x32_bf16 v[220:223], v[120:123], v[48:51], v[220:223]
    v_mfma_f32_16x16x32_bf16 v[224:227], v[120:123], v[52:55], v[224:227]
    v_mfma_f32_16x16x32_bf16 v[228:231], v[124:127], v[28:31], v[228:231]
    buffer_load_dwordx4 v7, s[4:7], s49 offen offset:512 nt lds
    v_mfma_f32_16x16x32_bf16 v[232:235], v[124:127], v[32:35], v[232:235]
    s_add_u32 m0, m0, s96
    v_mfma_f32_16x16x32_bf16 v[236:239], v[124:127], v[36:39], v[236:239]
    v_mfma_f32_16x16x32_bf16 v[240:243], v[124:127], v[40:43], v[240:243]
    v_mfma_f32_16x16x32_bf16 v[244:247], v[124:127], v[44:47], v[244:247]
    v_mfma_f32_16x16x32_bf16 v[248:251], v[124:127], v[48:51], v[248:251]
    v_mfma_f32_16x16x32_bf16 v[252:255], v[124:127], v[52:55], v[252:255]
    buffer_load_dwordx4 v7, s[4:7], s49 offen offset:768 nt lds
    v_mfma_f32_16x16x32_bf16 a[112:115], v[128:131], v[28:31], a[112:115]
    s_add_u32 m0, m0, s97
    v_mfma_f32_16x16x32_bf16 a[116:119], v[128:131], v[32:35], a[116:119]
    v_mfma_f32_16x16x32_bf16 a[120:123], v[128:131], v[36:39], a[120:123]
    v_mfma_f32_16x16x32_bf16 a[124:127], v[128:131], v[40:43], a[124:127]
    v_mfma_f32_16x16x32_bf16 a[128:131], v[128:131], v[44:47], a[128:131]
    v_mfma_f32_16x16x32_bf16 a[132:135], v[128:131], v[48:51], a[132:135]
    buffer_load_dwordx4 v7, s[4:7], s49 offen offset:1024 nt lds
    v_mfma_f32_16x16x32_bf16 a[136:139], v[128:131], v[52:55], a[136:139]
    s_add_u32 m0, m0, s96
    v_mfma_f32_16x16x32_bf16 a[140:143], v[132:135], v[28:31], a[140:143]
    v_mfma_f32_16x16x32_bf16 a[144:147], v[132:135], v[32:35], a[144:147]
    v_mfma_f32_16x16x32_bf16 a[148:151], v[132:135], v[36:39], a[148:151]
    v_mfma_f32_16x16x32_bf16 a[152:155], v[132:135], v[40:43], a[152:155]
    v_mfma_f32_16x16x32_bf16 a[156:159], v[132:135], v[44:47], a[156:159]
    buffer_load_dwordx4 v7, s[4:7], s49 offen offset:1280 nt lds
    v_mfma_f32_16x16x32_bf16 a[160:163], v[132:135], v[48:51], a[160:163]
    s_add_u32 m0, m0, s97
    v_mfma_f32_16x16x32_bf16 a[164:167], v[132:135], v[52:55], a[164:167]
    v_mfma_f32_16x16x32_bf16 a[168:171], v[136:139], v[28:31], a[168:171]
    v_mfma_f32_16x16x32_bf16 a[172:175], v[136:139], v[32:35], a[172:175]
    v_mfma_f32_16x16x32_bf16 a[176:179], v[136:139], v[36:39], a[176:179]
    v_mfma_f32_16x16x32_bf16 a[180:183], v[136:139], v[40:43], a[180:183]
    buffer_load_dwordx4 v7, s[4:7], s49 offen offset:1536 nt lds
    v_mfma_f32_16x16x32_bf16 a[184:187], v[136:139], v[44:47], a[184:187]
    s_add_u32 m0, m0, s96
    v_mfma_f32_16x16x32_bf16 a[188:191], v[136:139], v[48:51], a[188:191]
    v_mfma_f32_16x16x32_bf16 a[192:195], v[136:139], v[52:55], a[192:195]
    v_mfma_f32_16x16x32_bf16 a[196:199], v[140:143], v[28:31], a[196:199]
    v_mfma_f32_16x16x32_bf16 a[200:203], v[140:143], v[32:35], a[200:203]
    v_mfma_f32_16x16x32_bf16 a[204:207], v[140:143], v[36:39], a[204:207]
    buffer_load_dwordx4 v7, s[4:7], s49 offen offset:1792 nt lds
    v_mfma_f32_16x16x32_bf16 a[208:211], v[140:143], v[40:43], a[208:211]
    v_mfma_f32_16x16x32_bf16 a[212:215], v[140:143], v[44:47], a[212:215]
    v_mfma_f32_16x16x32_bf16 a[216:219], v[140:143], v[48:51], a[216:219]
    v_mfma_f32_16x16x32_bf16 a[220:223], v[140:143], v[52:55], a[220:223]
    s_branch L_at_qpepi
L_at_qptailB:
    s_mul_i32 s50, s21, s52
    s_mov_b32 s101, s21
    s_add_u32 s50, s50, s55
    s_cmp_ge_u32 s21, 2
    s_cselect_b32 s28, 0x40000000, 0
    s_add_u32 s50, s50, s28
    s_mov_b32 s82, s26
    s_mul_i32 s28, s26, s51
    s_add_u32 s50, s50, s28
    s_waitcnt lgkmcnt(14)
    v_mfma_f32_16x16x32_bf16 v[144:147], v[112:115], v[56:59], v[144:147]
    s_add_u32 m0, s33, 0
    v_mfma_f32_16x16x32_bf16 v[148:151], v[112:115], v[60:63], v[148:151]
    s_mov_b32 s49, s50
    v_mfma_f32_16x16x32_bf16 v[152:155], v[112:115], v[64:67], v[152:155]
    s_add_u32 s50, s50, s51
    v_mfma_f32_16x16x32_bf16 v[156:159], v[112:115], v[68:71], v[156:159]
    s_add_u32 s82, s82, 1
    v_mfma_f32_16x16x32_bf16 v[160:163], v[112:115], v[72:75], v[160:163]
    s_cmp_eq_u32 s82, 20
    v_mfma_f32_16x16x32_bf16 v[164:167], v[112:115], v[76:79], v[164:167]
    s_cselect_b32 s29, s83, 0
    v_mfma_f32_16x16x32_bf16 v[168:171], v[112:115], v[80:83], v[168:171]
    s_sub_u32 s50, s50, s29
    s_waitcnt vmcnt(16) lgkmcnt(0)
    s_barrier
    ds_read_b64_tr_b16 v[112:113], v11 offset:8448
    v_mfma_f32_16x16x32_bf16 v[172:175], v[116:119], v[56:59], v[172:175]
    ds_read_b64_tr_b16 v[114:115], v11 offset:8704
    v_mfma_f32_16x16x32_bf16 v[176:179], v[116:119], v[60:63], v[176:179]
    ds_read_b128 v[28:31], v27 offset:8448
    v_mfma_f32_16x16x32_bf16 v[180:183], v[116:119], v[64:67], v[180:183]
    s_add_u32 s28, s49, s88
    buffer_load_dwordx4 v26, s[16:19], s28 offen lds
    v_mfma_f32_16x16x32_bf16 v[184:187], v[116:119], v[68:71], v[184:187]
    s_add_u32 m0, m0, s53
    ds_read_b128 v[32:35], v27 offset:9472
    v_mfma_f32_16x16x32_bf16 v[188:191], v[116:119], v[72:75], v[188:191]
    ds_read_b128 v[36:39], v27 offset:10496
    v_mfma_f32_16x16x32_bf16 v[192:195], v[116:119], v[76:79], v[192:195]
    ds_read_b128 v[40:43], v27 offset:11520
    v_mfma_f32_16x16x32_bf16 v[196:199], v[116:119], v[80:83], v[196:199]
    ds_read_b128 v[44:47], v27 offset:12544
    v_mfma_f32_16x16x32_bf16 v[200:203], v[120:123], v[56:59], v[200:203]
    ds_read_b128 v[48:51], v27 offset:13568
    v_mfma_f32_16x16x32_bf16 v[204:207], v[120:123], v[60:63], v[204:207]
    s_add_u32 s28, s49, s89
    buffer_load_dwordx4 v26, s[16:19], s28 offen lds
    v_mfma_f32_16x16x32_bf16 v[208:211], v[120:123], v[64:67], v[208:211]
    s_add_u32 m0, m0, s53
    ds_read_b128 v[52:55], v27 offset:14592
    v_mfma_f32_16x16x32_bf16 v[212:215], v[120:123], v[68:71], v[212:215]
    ds_read_b64_tr_b16 v[116:117], v11 offset:8480
    v_mfma_f32_16x16x32_bf16 v[216:219], v[120:123], v[72:75], v[216:219]
    ds_read_b64_tr_b16 v[118:119], v11 offset:8736
    v_mfma_f32_16x16x32_bf16 v[220:223], v[120:123], v[76:79], v[220:223]
    v_mfma_f32_16x16x32_bf16 v[224:227], v[120:123], v[80:83], v[224:227]
    ds_read_b64_tr_b16 v[120:121], v11 offset:8512
    v_mfma_f32_16x16x32_bf16 v[228:231], v[124:127], v[56:59], v[228:231]
    s_add_u32 s28, s49, s90
    buffer_load_dwordx4 v26, s[16:19], s28 offen lds
    v_mfma_f32_16x16x32_bf16 v[232:235], v[124:127], v[60:63], v[232:235]
    s_add_u32 m0, m0, s53
    ds_read_b64_tr_b16 v[122:123], v11 offset:8768
    v_mfma_f32_16x16x32_bf16 v[236:239], v[124:127], v[64:67], v[236:239]
    v_mfma_f32_16x16x32_bf16 v[240:243], v[124:127], v[68:71], v[240:243]
    v_mfma_f32_16x16x32_bf16 v[244:247], v[124:127], v[72:75], v[244:247]
    v_mfma_f32_16x16x32_bf16 v[248:251], v[124:127], v[76:79], v[248:251]
    v_mfma_f32_16x16x32_bf16 v[252:255], v[124:127], v[80:83], v[252:255]
    s_add_u32 s28, s49, s91
    buffer_load_dwordx4 v26, s[16:19], s28 offen lds
    v_mfma_f32_16x16x32_bf16 a[112:115], v[128:131], v[56:59], a[112:115]
    s_add_u32 m0, m0, s53
    ds_read_b64_tr_b16 v[124:125], v11 offset:8544
    v_mfma_f32_16x16x32_bf16 a[116:119], v[128:131], v[60:63], a[116:119]
    ds_read_b64_tr_b16 v[126:127], v11 offset:8800
    v_mfma_f32_16x16x32_bf16 a[120:123], v[128:131], v[64:67], a[120:123]
    v_mfma_f32_16x16x32_bf16 a[124:127], v[128:131], v[68:71], a[124:127]
    v_mfma_f32_16x16x32_bf16 a[128:131], v[128:131], v[72:75], a[128:131]
    v_mfma_f32_16x16x32_bf16 a[132:135], v[128:131], v[76:79], a[132:135]
    s_add_u32 s28, s49, s92
    buffer_load_dwordx4 v26, s[16:19], s28 offen lds
    v_mfma_f32_16x16x32_bf16 a[136:139], v[128:131], v[80:83], a[136:139]
    s_add_u32 m0, m0, s53
    ds_read_b64_tr_b16 v[128:129], v11 offset:8576
    v_mfma_f32_16x16x32_bf16 a[140:143], v[132:135], v[56:59], a[140:143]
    ds_read_b64_tr_b16 v[130:131], v11 offset:8832
    v_mfma_f32_16x16x32_bf16 a[144:147], v[132:135], v[60:63], a[144:147]
    v_mfma_f32_16x16x32_bf16 a[148:151], v[132:135], v[64:67], a[148:151]
    v_mfma_f32_16x16x32_bf16 a[152:155], v[132:135], v[68:71], a[152:155]
    v_mfma_f32_16x16x32_bf16 a[156:159], v[132:135], v[72:75], a[156:159]
    s_add_u32 s28, s49, s93
    buffer_load_dwordx4 v26, s[16:19], s28 offen lds
    v_mfma_f32_16x16x32_bf16 a[160:163], v[132:135], v[76:79], a[160:163]
    s_add_u32 m0, m0, s53
    v_mfma_f32_16x16x32_bf16 a[164:167], v[132:135], v[80:83], a[164:167]
    ds_read_b64_tr_b16 v[132:133], v11 offset:8608
    v_mfma_f32_16x16x32_bf16 a[168:171], v[136:139], v[56:59], a[168:171]
    ds_read_b64_tr_b16 v[134:135], v11 offset:8864
    v_mfma_f32_16x16x32_bf16 a[172:175], v[136:139], v[60:63], a[172:175]
    v_mfma_f32_16x16x32_bf16 a[176:179], v[136:139], v[64:67], a[176:179]
    v_mfma_f32_16x16x32_bf16 a[180:183], v[136:139], v[68:71], a[180:183]
    s_add_u32 s28, s49, s94
    buffer_load_dwordx4 v26, s[16:19], s28 offen lds
    v_mfma_f32_16x16x32_bf16 a[184:187], v[136:139], v[72:75], a[184:187]
    s_add_u32 m0, m0, s53
    v_mfma_f32_16x16x32_bf16 a[188:191], v[136:139], v[76:79], a[188:191]
    v_mfma_f32_16x16x32_bf16 a[192:195], v[136:139], v[80:83], a[192:195]
    ds_read_b64_tr_b16 v[136:137], v11 offset:8640
    v_mfma_f32_16x16x32_bf16 a[196:199], v[140:143], v[56:59], a[196:199]
    ds_read_b64_tr_b16 v[138:139], v11 offset:8896
    v_mfma_f32_16x16x32_bf16 a[200:203], v[140:143], v[60:63], a[200:203]
    v_mfma_f32_16x16x32_bf16 a[204:207], v[140:143], v[64:67], a[204:207]
    s_add_u32 s28, s49, s95
    buffer_load_dwordx4 v26, s[16:19], s28 offen lds
    v_mfma_f32_16x16x32_bf16 a[208:211], v[140:143], v[68:71], a[208:211]
    v_mfma_f32_16x16x32_bf16 a[212:215], v[140:143], v[72:75], a[212:215]
    v_mfma_f32_16x16x32_bf16 a[216:219], v[140:143], v[76:79], a[216:219]
    v_mfma_f32_16x16x32_bf16 a[220:223], v[140:143], v[80:83], a[220:223]
    ds_read_b64_tr_b16 v[140:141], v11 offset:8672
    ds_read_b64_tr_b16 v[142:143], v11 offset:8928
    s_waitcnt lgkmcnt(14)
    v_mfma_f32_16x16x32_bf16 v[144:147], v[112:115], v[28:31], v[144:147]
    s_add_u32 m0, s33, 8448
    v_mfma_f32_16x16x32_bf16 v[148:151], v[112:115], v[32:35], v[148:151]
    s_mov_b32 s49, s50
    v_mfma_f32_16x16x32_bf16 v[152:155], v[112:115], v[36:39], v[152:155]
    s_add_u32 s50, s50, s51
    v_mfma_f32_16x16x32_bf16 v[156:159], v[112:115], v[40:43], v[156:159]
    s_add_u32 s82, s82, 1
    v_mfma_f32_16x16x32_bf16 v[160:163], v[112:115], v[44:47], v[160:163]
    s_cmp_eq_u32 s82, 20
    v_mfma_f32_16x16x32_bf16 v[164:167], v[112:115], v[48:51], v[164:167]
    s_cselect_b32 s29, s83, 0
    v_mfma_f32_16x16x32_bf16 v[168:171], v[112:115], v[52:55], v[168:171]
    s_sub_u32 s50, s50, s29
    s_waitcnt vmcnt(16) lgkmcnt(0)
    s_barrier
    ds_read_b64_tr_b16 v[112:113], v11 offset:16896
    v_mfma_f32_16x16x32_bf16 v[172:175], v[116:119], v[28:31], v[172:175]
    ds_read_b64_tr_b16 v[114:115], v11 offset:17152
    v_mfma_f32_16x16x32_bf16 v[176:179], v[116:119], v[32:35], v[176:179]
    ds_read_b128 v[56:59], v27 offset:16896
    v_mfma_f32_16x16x32_bf16 v[180:183], v[116:119], v[36:39], v[180:183]
    s_add_u32 s28, s49, s88
    buffer_load_dwordx4 v26, s[16:19], s28 offen lds
    v_mfma_f32_16x16x32_bf16 v[184:187], v[116:119], v[40:43], v[184:187]
    s_add_u32 m0, m0, s53
    ds_read_b128 v[60:63], v27 offset:17920
    v_mfma_f32_16x16x32_bf16 v[188:191], v[116:119], v[44:47], v[188:191]
    ds_read_b128 v[64:67], v27 offset:18944
    v_mfma_f32_16x16x32_bf16 v[192:195], v[116:119], v[48:51], v[192:195]
    ds_read_b128 v[68:71], v27 offset:19968
    v_mfma_f32_16x16x32_bf16 v[196:199], v[116:119], v[52:55], v[196:199]
    ds_read_b128 v[72:75], v27 offset:20992
    v_mfma_f32_16x16x32_bf16 v[200:203], v[120:123], v[28:31], v[200:203]
    ds_read_b128 v[76:79], v27 offset:22016
    v_mfma_f32_16x16x32_bf16 v[204:207], v[120:123], v[32:35], v[204:207]
    s_add_u32 s28, s49, s89
    buffer_load_dwordx4 v26, s[16:19], s28 offen lds
    v_mfma_f32_16x16x32_bf16 v[208:211], v[120:123], v[36:39], v[208:211]
    s_add_u32 m0, m0, s53
    ds_read_b128 v[80:83], v27 offset:23040
    v_mfma_f32_16x16x32_bf16 v[212:215], v[120:123], v[40:43], v[212:215]
    ds_read_b64_tr_b16 v[116:117], v11 offset:16928
    v_mfma_f32_16x16x32_bf16 v[216:219], v[120:123], v[44:47], v[216:219]
    ds_read_b64_tr_b16 v[118:119], v11 offset:17184
    v_mfma_f32_16x16x32_bf16 v[220:223], v[120:123], v[48:51], v[220:223]
    v_mfma_f32_16x16x32_bf16 v[224:227], v[120:123], v[52:55], v[224:227]
    ds_read_b64_tr_b16 v[120:121], v11 offset:16960
    v_mfma_f32_16x16x32_bf16 v[228:231], v[124:127], v[28:31], v[228:231]
    s_add_u32 s28, s49, s90
    buffer_load_dwordx4 v26, s[16:19], s28 offen lds
    v_mfma_f32_16x16x32_bf16 v[232:235], v[124:127], v[32:35], v[232:235]
    s_add_u32 m0, m0, s53
    ds_read_b64_tr_b16 v[122:123], v11 offset:17216
    v_mfma_f32_16x16x32_bf16 v[236:239], v[124:127], v[36:39], v[236:239]
    v_mfma_f32_16x16x32_bf16 v[240:243], v[124:127], v[40:43], v[240:243]
    v_mfma_f32_16x16x32_bf16 v[244:247], v[124:127], v[44:47], v[244:247]
    v_mfma_f32_16x16x32_bf16 v[248:251], v[124:127], v[48:51], v[248:251]
    v_mfma_f32_16x16x32_bf16 v[252:255], v[124:127], v[52:55], v[252:255]
    s_add_u32 s28, s49, s91
    buffer_load_dwordx4 v26, s[16:19], s28 offen lds
    v_mfma_f32_16x16x32_bf16 a[112:115], v[128:131], v[28:31], a[112:115]
    s_add_u32 m0, m0, s53
    ds_read_b64_tr_b16 v[124:125], v11 offset:16992
    v_mfma_f32_16x16x32_bf16 a[116:119], v[128:131], v[32:35], a[116:119]
    ds_read_b64_tr_b16 v[126:127], v11 offset:17248
    v_mfma_f32_16x16x32_bf16 a[120:123], v[128:131], v[36:39], a[120:123]
    v_mfma_f32_16x16x32_bf16 a[124:127], v[128:131], v[40:43], a[124:127]
    v_mfma_f32_16x16x32_bf16 a[128:131], v[128:131], v[44:47], a[128:131]
    v_mfma_f32_16x16x32_bf16 a[132:135], v[128:131], v[48:51], a[132:135]
    s_add_u32 s28, s49, s92
    buffer_load_dwordx4 v26, s[16:19], s28 offen lds
    v_mfma_f32_16x16x32_bf16 a[136:139], v[128:131], v[52:55], a[136:139]
    s_add_u32 m0, m0, s53
    ds_read_b64_tr_b16 v[128:129], v11 offset:17024
    v_mfma_f32_16x16x32_bf16 a[140:143], v[132:135], v[28:31], a[140:143]
    ds_read_b64_tr_b16 v[130:131], v11 offset:17280
    v_mfma_f32_16x16x32_bf16 a[144:147], v[132:135], v[32:35], a[144:147]
    v_mfma_f32_16x16x32_bf16 a[148:151], v[132:135], v[36:39], a[148:151]
    v_mfma_f32_16x16x32_bf16 a[152:155], v[132:135], v[40:43], a[152:155]
    v_mfma_f32_16x16x32_bf16 a[156:159], v[132:135], v[44:47], a[156:159]
    s_add_u32 s28, s49, s93
    buffer_load_dwordx4 v26, s[16:19], s28 offen lds
    v_mfma_f32_16x16x32_bf16 a[160:163], v[132:135], v[48:51], a[160:163]
    s_add_u32 m0, m0, s53
    v_mfma_f32_16x16x32_bf16 a[164:167], v[132:135], v[52:55], a[164:167]
    ds_read_b64_tr_b16 v[132:133], v11 offset:17056
    v_mfma_f32_16x16x32_bf16 a[168:171], v[136:139], v[28:31], a[168:171]
    ds_read_b64_tr_b16 v[134:135], v11 offset:17312
    v_mfma_f32_16x16x32_bf16 a[172:175], v[136:139], v[32:35], a[172:175]
    v_mfma_f32_16x16x32_bf16 a[176:179], v[136:139], v[36:39], a[176:179]
    v_mfma_f32_16x16x32_bf16 a[180:183], v[136:139], v[40:43], a[180:183]
    s_add_u32 s28, s49, s94
    buffer_load_dwordx4 v26, s[16:19], s28 offen lds
    v_mfma_f32_16x16x32_bf16 a[184:187], v[136:139], v[44:47], a[184:187]
    s_add_u32 m0, m0, s53
    v_mfma_f32_16x16x32_bf16 a[188:191], v[136:139], v[48:51], a[188:191]
    v_mfma_f32_16x16x32_bf16 a[192:195], v[136:139], v[52:55], a[192:195]
    ds_read_b64_tr_b16 v[136:137], v11 offset:17088
    v_mfma_f32_16x16x32_bf16 a[196:199], v[140:143], v[28:31], a[196:199]
    ds_read_b64_tr_b16 v[138:139], v11 offset:17344
    v_mfma_f32_16x16x32_bf16 a[200:203], v[140:143], v[32:35], a[200:203]
    v_mfma_f32_16x16x32_bf16 a[204:207], v[140:143], v[36:39], a[204:207]
    s_add_u32 s28, s49, s95
    buffer_load_dwordx4 v26, s[16:19], s28 offen lds
    v_mfma_f32_16x16x32_bf16 a[208:211], v[140:143], v[40:43], a[208:211]
    v_mfma_f32_16x16x32_bf16 a[212:215], v[140:143], v[44:47], a[212:215]
    v_mfma_f32_16x16x32_bf16 a[216:219], v[140:143], v[48:51], a[216:219]
    v_mfma_f32_16x16x32_bf16 a[220:223], v[140:143], v[52:55], a[220:223]
    ds_read_b64_tr_b16 v[140:141], v11 offset:17120
    ds_read_b64_tr_b16 v[142:143], v11 offset:17376
    s_waitcnt lgkmcnt(14)
    v_mfma_f32_16x16x32_bf16 v[144:147], v[112:115], v[56:59], v[144:147]
    s_add_u32 m0, s33, 16896
    v_mfma_f32_16x16x32_bf16 v[148:151], v[112:115], v[60:63], v[148:151]
    s_mov_b32 s49, s50
    v_mfma_f32_16x16x32_bf16 v[152:155], v[112:115], v[64:67], v[152:155]
    s_add_u32 s50, s50, s51
    v_mfma_f32_16x16x32_bf16 v[156:159], v[112:115], v[68:71], v[156:159]
    s_add_u32 s82, s82, 1
    v_mfma_f32_16x16x32_bf16 v[160:163], v[112:115], v[72:75], v[160:163]
    s_cmp_eq_u32 s82, 20
    v_mfma_f32_16x16x32_bf16 v[164:167], v[112:115], v[76:79], v[164:167]
    s_cselect_b32 s29, s83, 0
    v_mfma_f32_16x16x32_bf16 v[168:171], v[112:115], v[80:83], v[168:171]
    s_sub_u32 s50, s50, s29
    s_waitcnt vmcnt(16) lgkmcnt(0)
    s_barrier
    ds_read_b64_tr_b16 v[112:113], v11 offset:25344
    v_mfma_f32_16x16x32_bf16 v[172:175], v[116:119], v[56:59], v[172:175]
    ds_read_b64_tr_b16 v[114:115], v11 offset:25600
    v_mfma_f32_16x16x32_bf16 v[176:179], v[116:119], v[60:63], v[176:179]
    ds_read_b128 v[28:31], v27 offset:25344
    v_mfma_f32_16x16x32_bf16 v[180:183], v[116:119], v[64:67], v[180:183]
    s_add_u32 s28, s49, s88
    buffer_load_dwordx4 v26, s[16:19], s28 offen lds
    v_mfma_f32_16x16x32_bf16 v[184:187], v[116:119], v[68:71], v[184:187]
    s_add_u32 m0, m0, s53
    ds_read_b128 v[32:35], v27 offset:26368
    v_mfma_f32_16x16x32_bf16 v[188:191], v[116:119], v[72:75], v[188:191]
    ds_read_b128 v[36:39], v27 offset:27392
    v_mfma_f32_16x16x32_bf16 v[192:195], v[116:119], v[76:79], v[192:195]
    ds_read_b128 v[40:43], v27 offset:28416
    v_mfma_f32_16x16x32_bf16 v[196:199], v[116:119], v[80:83], v[196:199]
    ds_read_b128 v[44:47], v27 offset:29440
    v_mfma_f32_16x16x32_bf16 v[200:203], v[120:123], v[56:59], v[200:203]
    ds_read_b128 v[48:51], v27 offset:30464
    v_mfma_f32_16x16x32_bf16 v[204:207], v[120:123], v[60:63], v[204:207]
    s_add_u32 s28, s49, s89
    buffer_load_dwordx4 v26, s[16:19], s28 offen lds
    v_mfma_f32_16x16x32_bf16 v[208:211], v[120:123], v[64:67], v[208:211]
    s_add_u32 m0, m0, s53
    ds_read_b128 v[52:55], v27 offset:31488
    v_mfma_f32_16x16x32_bf16 v[212:215], v[120:123], v[68:71], v[212:215]
    ds_read_b64_tr_b16 v[116:117], v11 offset:25376
    v_mfma_f32_16x16x32_bf16 v[216:219], v[120:123], v[72:75], v[216:219]
    ds_read_b64_tr_b16 v[118:119], v11 offset:25632
    v_mfma_f32_16x16x32_bf16 v[220:223], v[120:123], v[76:79], v[220:223]
    v_mfma_f32_16x16x32_bf16 v[224:227], v[120:123], v[80:83], v[224:227]
    ds_read_b64_tr_b16 v[120:121], v11 offset:25408
    v_mfma_f32_16x16x32_bf16 v[228:231], v[124:127], v[56:59], v[228:231]
    s_add_u32 s28, s49, s90
    buffer_load_dwordx4 v26, s[16:19], s28 offen lds
    v_mfma_f32_16x16x32_bf16 v[232:235], v[124:127], v[60:63], v[232:235]
    s_add_u32 m0, m0, s53
    ds_read_b64_tr_b16 v[122:123], v11 offset:25664
    v_mfma_f32_16x16x32_bf16 v[236:239], v[124:127], v[64:67], v[236:239]
    v_mfma_f32_16x16x32_bf16 v[240:243], v[124:127], v[68:71], v[240:243]
    v_mfma_f32_16x16x32_bf16 v[244:247], v[124:127], v[72:75], v[244:247]
    v_mfma_f32_16x16x32_bf16 v[248:251], v[124:127], v[76:79], v[248:251]
    v_mfma_f32_16x16x32_bf16 v[252:255], v[124:127], v[80:83], v[252:255]
    s_add_u32 s28, s49, s91
    buffer_load_dwordx4 v26, s[16:19], s28 offen lds
    v_mfma_f32_16x16x32_bf16 a[112:115], v[128:131], v[56:59], a[112:115]
    s_add_u32 m0, m0, s53
    ds_read_b64_tr_b16 v[124:125], v11 offset:25440
    v_mfma_f32_16x16x32_bf16 a[116:119], v[128:131], v[60:63], a[116:119]
    ds_read_b64_tr_b16 v[126:127], v11 offset:25696
    v_mfma_f32_16x16x32_bf16 a[120:123], v[128:131], v[64:67], a[120:123]
    v_mfma_f32_16x16x32_bf16 a[124:127], v[128:131], v[68:71], a[124:127]
    v_mfma_f32_16x16x32_bf16 a[128:131], v[128:131], v[72:75], a[128:131]
    v_mfma_f32_16x16x32_bf16 a[132:135], v[128:131], v[76:79], a[132:135]
    s_add_u32 s28, s49, s92
    buffer_load_dwordx4 v26, s[16:19], s28 offen lds
    v_mfma_f32_16x16x32_bf16 a[136:139], v[128:131], v[80:83], a[136:139]
    s_add_u32 m0, m0, s53
    ds_read_b64_tr_b16 v[128:129], v11 offset:25472
    v_mfma_f32_16x16x32_bf16 a[140:143], v[132:135], v[56:59], a[140:143]
    ds_read_b64_tr_b16 v[130:131], v11 offset:25728
    v_mfma_f32_16x16x32_bf16 a[144:147], v[132:135], v[60:63], a[144:147]
    v_mfma_f32_16x16x32_bf16 a[148:151], v[132:135], v[64:67], a[148:151]
    v_mfma_f32_16x16x32_bf16 a[152:155], v[132:135], v[68:71], a[152:155]
    v_mfma_f32_16x16x32_bf16 a[156:159], v[132:135], v[72:75], a[156:159]
    s_add_u32 s28, s49, s93
    buffer_load_dwordx4 v26, s[16:19], s28 offen lds
    v_mfma_f32_16x16x32_bf16 a[160:163], v[132:135], v[76:79], a[160:163]
    s_add_u32 m0, m0, s53
    v_mfma_f32_16x16x32_bf16 a[164:167], v[132:135], v[80:83], a[164:167]
    ds_read_b64_tr_b16 v[132:133], v11 offset:25504
    v_mfma_f32_16x16x32_bf16 a[168:171], v[136:139], v[56:59], a[168:171]
    ds_read_b64_tr_b16 v[134:135], v11 offset:25760
    v_mfma_f32_16x16x32_bf16 a[172:175], v[136:139], v[60:63], a[172:175]
    v_mfma_f32_16x16x32_bf16 a[176:179], v[136:139], v[64:67], a[176:179]
    v_mfma_f32_16x16x32_bf16 a[180:183], v[136:139], v[68:71], a[180:183]
    s_add_u32 s28, s49, s94
    buffer_load_dwordx4 v26, s[16:19], s28 offen lds
    v_mfma_f32_16x16x32_bf16 a[184:187], v[136:139], v[72:75], a[184:187]
    s_add_u32 m0, m0, s53
    v_mfma_f32_16x16x32_bf16 a[188:191], v[136:139], v[76:79], a[188:191]
    v_mfma_f32_16x16x32_bf16 a[192:195], v[136:139], v[80:83], a[192:195]
    ds_read_b64_tr_b16 v[136:137], v11 offset:25536
    v_mfma_f32_16x16x32_bf16 a[196:199], v[140:143], v[56:59], a[196:199]
    ds_read_b64_tr_b16 v[138:139], v11 offset:25792
    v_mfma_f32_16x16x32_bf16 a[200:203], v[140:143], v[60:63], a[200:203]
    v_mfma_f32_16x16x32_bf16 a[204:207], v[140:143], v[64:67], a[204:207]
    s_add_u32 s28, s49, s95
    buffer_load_dwordx4 v26, s[16:19], s28 offen lds
    v_mfma_f32_16x16x32_bf16 a[208:211], v[140:143], v[68:71], a[208:211]
    v_mfma_f32_16x16x32_bf16 a[212:215], v[140:143], v[72:75], a[212:215]
    v_mfma_f32_16x16x32_bf16 a[216:219], v[140:143], v[76:79], a[216:219]
    v_mfma_f32_16x16x32_bf16 a[220:223], v[140:143], v[80:83], a[220:223]
    ds_read_b64_tr_b16 v[140:141], v11 offset:25568
    ds_read_b64_tr_b16 v[142:143], v11 offset:25824
    s_waitcnt lgkmcnt(14)
    v_mfma_f32_16x16x32_bf16 v[144:147], v[112:115], v[28:31], v[144:147]
    s_add_u32 m0, s33, 25344
    v_mfma_f32_16x16x32_bf16 v[148:151], v[112:115], v[32:35], v[148:151]
    s_mov_b32 s49, s50
    v_mfma_f32_16x16x32_bf16 v[152:155], v[112:115], v[36:39], v[152:155]
    s_add_u32 s50, s50, s51
    v_mfma_f32_16x16x32_bf16 v[156:159], v[112:115], v[40:43], v[156:159]
    s_add_u32 s82, s82, 1
    v_mfma_f32_16x16x32_bf16 v[160:163], v[112:115], v[44:47], v[160:163]
    s_cmp_eq_u32 s82, 20
    v_mfma_f32_16x16x32_bf16 v[164:167], v[112:115], v[48:51], v[164:167]
    s_cselect_b32 s29, s83, 0
    v_mfma_f32_16x16x32_bf16 v[168:171], v[112:115], v[52:55], v[168:171]
    s_sub_u32 s50, s50, s29
    s_waitcnt vmcnt(16) lgkmcnt(0)
    s_barrier
    v_mfma_f32_16x16x32_bf16 v[172:175], v[116:119], v[28:31], v[172:175]
    v_mfma_f32_16x16x32_bf16 v[176:179], v[116:119], v[32:35], v[176:179]
    v_mfma_f32_16x16x32_bf16 v[180:183], v[116:119], v[36:39], v[180:183]
    s_add_u32 s28, s49, s88
    buffer_load_dwordx4 v26, s[16:19], s28 offen lds
    v_mfma_f32_16x16x32_bf16 v[184:187], v[116:119], v[40:43], v[184:187]
    s_add_u32 m0, m0, s53
    v_mfma_f32_16x16x32_bf16 v[188:191], v[116:119], v[44:47], v[188:191]
    v_mfma_f32_16x16x32_bf16 v[192:195], v[116:119], v[48:51], v[192:195]
    v_mfma_f32_16x16x32_bf16 v[196:199], v[116:119], v[52:55], v[196:199]
    v_mfma_f32_16x16x32_bf16 v[200:203], v[120:123], v[28:31], v[200:203]
    v_mfma_f32_16x16x32_bf16 v[204:207], v[120:123], v[32:35], v[204:207]
    s_add_u32 s28, s49, s89
    buffer_load_dwordx4 v26, s[16:19], s28 offen lds
    v_mfma_f32_16x16x32_bf16 v[208:211], v[120:123], v[36:39], v[208:211]
    s_add_u32 m0, m0, s53
    v_mfma_f32_16x16x32_bf16 v[212:215], v[120:123], v[40:43], v[212:215]
    v_mfma_f32_16x16x32_bf16 v[216:219], v[120:123], v[44:47], v[216:219]
    v_mfma_f32_16x16x32_bf16 v[220:223], v[120:123], v[48:51], v[220:223]
    v_mfma_f32_16x16x32_bf16 v[224:227], v[120:123], v[52:55], v[224:227]
    v_mfma_f32_16x16x32_bf16 v[228:231], v[124:127], v[28:31], v[228:231]
    s_add_u32 s28, s49, s90
    buffer_load_dwordx4 v26, s[16:19], s28 offen lds
    v_mfma_f32_16x16x32_bf16 v[232:235], v[124:127], v[32:35], v[232:235]
    s_add_u32 m0, m0, s53
    v_mfma_f32_16x16x32_bf16 v[236:239], v[124:127], v[36:39], v[236:239]
    v_mfma_f32_16x16x32_bf16 v[240:243], v[124:127], v[40:43], v[240:243]
    v_mfma_f32_16x16x32_bf16 v[244:247], v[124:127], v[44:47], v[244:247]
    v_mfma_f32_16x16x32_bf16 v[248:251], v[124:127], v[48:51], v[248:251]
    v_mfma_f32_16x16x32_bf16 v[252:255], v[124:127], v[52:55], v[252:255]
    s_add_u32 s28, s49, s91
    buffer_load_dwordx4 v26, s[16:19], s28 offen lds
    v_mfma_f32_16x16x32_bf16 a[112:115], v[128:131], v[28:31], a[112:115]
    s_add_u32 m0, m0, s53
    v_mfma_f32_16x16x32_bf16 a[116:119], v[128:131], v[32:35], a[116:119]
    v_mfma_f32_16x16x32_bf16 a[120:123], v[128:131], v[36:39], a[120:123]
    v_mfma_f32_16x16x32_bf16 a[124:127], v[128:131], v[40:43], a[124:127]
    v_mfma_f32_16x16x32_bf16 a[128:131], v[128:131], v[44:47], a[128:131]
    v_mfma_f32_16x16x32_bf16 a[132:135], v[128:131], v[48:51], a[132:135]
    s_add_u32 s28, s49, s92
    buffer_load_dwordx4 v26, s[16:19], s28 offen lds
    v_mfma_f32_16x16x32_bf16 a[136:139], v[128:131], v[52:55], a[136:139]
    s_add_u32 m0, m0, s53
    v_mfma_f32_16x16x32_bf16 a[140:143], v[132:135], v[28:31], a[140:143]
    v_mfma_f32_16x16x32_bf16 a[144:147], v[132:135], v[32:35], a[144:147]
    v_mfma_f32_16x16x32_bf16 a[148:151], v[132:135], v[36:39], a[148:151]
    v_mfma_f32_16x16x32_bf16 a[152:155], v[132:135], v[40:43], a[152:155]
    v_mfma_f32_16x16x32_bf16 a[156:159], v[132:135], v[44:47], a[156:159]
    s_add_u32 s28, s49, s93
    buffer_load_dwordx4 v26, s[16:19], s28 offen lds
    v_mfma_f32_16x16x32_bf16 a[160:163], v[132:135], v[48:51], a[160:163]
    s_add_u32 m0, m0, s53
    v_mfma_f32_16x16x32_bf16 a[164:167], v[132:135], v[52:55], a[164:167]
    v_mfma_f32_16x16x32_bf16 a[168:171], v[136:139], v[28:31], a[168:171]
    v_mfma_f32_16x16x32_bf16 a[172:175], v[136:139], v[32:35], a[172:175]
    v_mfma_f32_16x16x32_bf16 a[176:179], v[136:139], v[36:39], a[176:179]
    v_mfma_f32_16x16x32_bf16 a[180:183], v[136:139], v[40:43], a[180:183]
    s_add_u32 s28, s49, s94
    buffer_load_dwordx4 v26, s[16:19], s28 offen lds
    v_mfma_f32_16x16x32_bf16 a[184:187], v[136:139], v[44:47], a[184:187]
    s_add_u32 m0, m0, s53
    v_mfma_f32_16x16x32_bf16 a[188:191], v[136:139], v[48:51], a[188:191]
    v_mfma_f32_16x16x32_bf16 a[192:195], v[136:139], v[52:55], a[192:195]
    v_mfma_f32_16x16x32_bf16 a[196:199], v[140:143], v[28:31], a[196:199]
    v_mfma_f32_16x16x32_bf16 a[200:203], v[140:143], v[32:35], a[200:203]
    v_mfma_f32_16x16x32_bf16 a[204:207], v[140:143], v[36:39], a[204:207]
    s_add_u32 s28, s49, s95
    buffer_load_dwordx4 v26, s[16:19], s28 offen lds
    v_mfma_f32_16x16x32_bf16 a[208:211], v[140:143], v[40:43], a[208:211]
    v_mfma_f32_16x16x32_bf16 a[212:215], v[140:143], v[44:47], a[212:215]
    v_mfma_f32_16x16x32_bf16 a[216:219], v[140:143], v[48:51], a[216:219]
    v_mfma_f32_16x16x32_bf16 a[220:223], v[140:143], v[52:55], a[220:223]
L_at_qpepi:
    v_mov_b32 v4, s54
    v_mov_b32 v5, s54
    s_nop 6
    v_pk_mul_f32 v[144:145], v[144:145], v[4:5]
    v_pk_mul_f32 v[146:147], v[146:147], v[4:5]
    v_pk_mul_f32 v[148:149], v[148:149], v[4:5]
    v_pk_mul_f32 v[150:151], v[150:151], v[4:5]
    v_pk_mul_f32 v[152:153], v[152:153], v[4:5]
    v_pk_mul_f32 v[154:155], v[154:155], v[4:5]
    v_pk_mul_f32 v[156:157], v[156:157], v[4:5]
    v_pk_mul_f32 v[158:159], v[158:159], v[4:5]
    v_pk_mul_f32 v[160:161], v[160:161], v[4:5]
    v_pk_mul_f32 v[162:163], v[162:163], v[4:5]
    v_pk_mul_f32 v[164:165], v[164:165], v[4:5]
    v_pk_mul_f32 v[166:167], v[166:167], v[4:5]
    v_pk_mul_f32 v[168:169], v[168:169], v[4:5]
    v_pk_mul_f32 v[170:171], v[170:171], v[4:5]
    v_pk_mul_f32 v[172:173], v[172:173], v[4:5]
    v_pk_mul_f32 v[174:175], v[174:175], v[4:5]
    v_pk_mul_f32 v[176:177], v[176:177], v[4:5]
    v_pk_mul_f32 v[178:179], v[178:179], v[4:5]
    v_pk_mul_f32 v[180:181], v[180:181], v[4:5]
    v_pk_mul_f32 v[182:183], v[182:183], v[4:5]
    v_pk_mul_f32 v[184:185], v[184:185], v[4:5]
    v_pk_mul_f32 v[186:187], v[186:187], v[4:5]
    v_pk_mul_f32 v[188:189], v[188:189], v[4:5]
    v_pk_mul_f32 v[190:191], v[190:191], v[4:5]
    v_pk_mul_f32 v[192:193], v[192:193], v[4:5]
    v_pk_mul_f32 v[194:195], v[194:195], v[4:5]
    v_pk_mul_f32 v[196:197], v[196:197], v[4:5]
    v_pk_mul_f32 v[198:199], v[198:199], v[4:5]
    v_cvt_pk_bf16_f32 v88, v144, v145
    v_cvt_pk_bf16_f32 v89, v146, v147
    v_cvt_pk_bf16_f32 v90, v172, v173
    v_cvt_pk_bf16_f32 v91, v174, v175
    v_cvt_pk_bf16_f32 v92, v148, v149
    v_cvt_pk_bf16_f32 v93, v150, v151
    v_cvt_pk_bf16_f32 v94, v176, v177
    v_cvt_pk_bf16_f32 v95, v178, v179
    v_cvt_pk_bf16_f32 v96, v152, v153
    v_cvt_pk_bf16_f32 v97, v154, v155
    v_cvt_pk_bf16_f32 v98, v180, v181
    v_cvt_pk_bf16_f32 v99, v182, v183
    v_cvt_pk_bf16_f32 v100, v156, v157
    v_cvt_pk_bf16_f32 v101, v158, v159
    v_cvt_pk_bf16_f32 v102, v184, v185
    v_cvt_pk_bf16_f32 v103, v186, v187
    v_cvt_pk_bf16_f32 v104, v160, v161
    v_cvt_pk_bf16_f32 v105, v162, v163
    v_cvt_pk_bf16_f32 v106, v188, v189
    v_cvt_pk_bf16_f32 v107, v190, v191
    v_cvt_pk_bf16_f32 v108, v164, v165
    v_cvt_pk_bf16_f32 v109, v166, v167
    v_cvt_pk_bf16_f32 v110, v192, v193
    v_cvt_pk_bf16_f32 v111, v194, v195
    v_cvt_pk_bf16_f32 v112, v168, v169
    v_cvt_pk_bf16_f32 v113, v170, v171
    v_cvt_pk_bf16_f32 v114, v196, v197
    v_cvt_pk_bf16_f32 v115, v198, v199
    s_nop 1
    v_permlane16_swap_b32 v88, v90
    v_permlane16_swap_b32 v89, v91
    v_permlane16_swap_b32 v92, v94
    v_permlane16_swap_b32 v93, v95
    v_permlane16_swap_b32 v96, v98
    v_permlane16_swap_b32 v97, v99
    v_permlane16_swap_b32 v100, v102
    v_permlane16_swap_b32 v101, v103
    v_permlane16_swap_b32 v104, v106
    v_permlane16_swap_b32 v105, v107
    v_permlane16_swap_b32 v108, v110
    v_permlane16_swap_b32 v109, v111
    v_permlane16_swap_b32 v112, v114
    v_permlane16_swap_b32 v113, v115
    v_accvgpr_write_b32 a0, v88
    v_accvgpr_write_b32 a1, v89
    v_accvgpr_write_b32 a2, v90
    v_accvgpr_write_b32 a3, v91
    v_accvgpr_write_b32 a16, v92
    v_accvgpr_write_b32 a17, v93
    v_accvgpr_write_b32 a18, v94
    v_accvgpr_write_b32 a19, v95
    v_accvgpr_write_b32 a32, v96
    v_accvgpr_write_b32 a33, v97
    v_accvgpr_write_b32 a34, v98
    v_accvgpr_write_b32 a35, v99
    v_accvgpr_write_b32 a48, v100
    v_accvgpr_write_b32 a49, v101
    v_accvgpr_write_b32 a50, v102
    v_accvgpr_write_b32 a51, v103
    v_accvgpr_write_b32 a64, v104
    v_accvgpr_write_b32 a65, v105
    v_accvgpr_write_b32 a66, v106
    v_accvgpr_write_b32 a67, v107
    v_accvgpr_write_b32 a80, v108
    v_accvgpr_write_b32 a81, v109
    v_accvgpr_write_b32 a82, v110
    v_accvgpr_write_b32 a83, v111
    v_accvgpr_write_b32 a96, v112
    v_accvgpr_write_b32 a97, v113
    v_accvgpr_write_b32 a98, v114
    v_accvgpr_write_b32 a99, v115
    v_pk_mul_f32 v[200:201], v[200:201], v[4:5]
    v_pk_mul_f32 v[202:203], v[202:203], v[4:5]
    v_pk_mul_f32 v[204:205], v[204:205], v[4:5]
    v_pk_mul_f32 v[206:207], v[206:207], v[4:5]
    v_pk_mul_f32 v[208:209], v[208:209], v[4:5]
    v_pk_mul_f32 v[210:211], v[210:211], v[4:5]
    v_pk_mul_f32 v[212:213], v[212:213], v[4:5]
    v_pk_mul_f32 v[214:215], v[214:215], v[4:5]
    v_pk_mul_f32 v[216:217], v[216:217], v[4:5]
    v_pk_mul_f32 v[218:219], v[218:219], v[4:5]
    v_pk_mul_f32 v[220:221], v[220:221], v[4:5]
    v_pk_mul_f32 v[222:223], v[222:223], v[4:5]
    v_pk_mul_f32 v[224:225], v[224:225], v[4:5]
    v_pk_mul_f32 v[226:227], v[226:227], v[4:5]
    v_pk_mul_f32 v[228:229], v[228:229], v[4:5]
    v_pk_mul_f32 v[230:231], v[230:231], v[4:5]
    v_pk_mul_f32 v[232:233], v[232:233], v[4:5]
    v_pk_mul_f32 v[234:235], v[234:235], v[4:5]
    v_pk_mul_f32 v[236:237], v[236:237], v[4:5]
    v_pk_mul_f32 v[238:239], v[238:239], v[4:5]
    v_pk_mul_f32 v[240:241], v[240:241], v[4:5]
    v_pk_mul_f32 v[242:243], v[242:243], v[4:5]
    v_pk_mul_f32 v[244:245], v[244:245], v[4:5]
    v_pk_mul_f32 v[246:247], v[246:247], v[4:5]
    v_pk_mul_f32 v[248:249], v[248:249], v[4:5]
    v_pk_mul_f32 v[250:251], v[250:251], v[4:5]
    v_pk_mul_f32 v[252:253], v[252:253], v[4:5]
    v_pk_mul_f32 v[254:255], v[254:255], v[4:5]
    v_cvt_pk_bf16_f32 v116, v200, v201
    v_cvt_pk_bf16_f32 v117, v202, v203
    v_cvt_pk_bf16_f32 v118, v228, v229
    v_cvt_pk_bf16_f32 v119, v230, v231
    v_cvt_pk_bf16_f32 v120, v204, v205
    v_cvt_pk_bf16_f32 v121, v206, v207
    v_cvt_pk_bf16_f32 v122, v232, v233
    v_cvt_pk_bf16_f32 v123, v234, v235
    v_cvt_pk_bf16_f32 v124, v208, v209
    v_cvt_pk_bf16_f32 v125, v210, v211
    v_cvt_pk_bf16_f32 v126, v236, v237
    v_cvt_pk_bf16_f32 v127, v238, v239
    v_cvt_pk_bf16_f32 v128, v212, v213
    v_cvt_pk_bf16_f32 v129, v214, v215
    v_cvt_pk_bf16_f32 v130, v240, v241
    v_cvt_pk_bf16_f32 v131, v242, v243
    v_cvt_pk_bf16_f32 v132, v216, v217
    v_cvt_pk_bf16_f32 v133, v218, v219
    v_cvt_pk_bf16_f32 v134, v244, v245
    v_cvt_pk_bf16_f32 v135, v246, v247
    v_cvt_pk_bf16_f32 v136, v220, v221
    v_cvt_pk_bf16_f32 v137, v222, v223
    v_cvt_pk_bf16_f32 v138, v248, v249
    v_cvt_pk_bf16_f32 v139, v250, v251
    v_cvt_pk_bf16_f32 v140, v224, v225
    v_cvt_pk_bf16_f32 v141, v226, v227
    v_cvt_pk_bf16_f32 v142, v252, v253
    v_cvt_pk_bf16_f32 v143, v254, v255
    s_nop 1
    v_permlane16_swap_b32 v116, v118
    v_permlane16_swap_b32 v117, v119
    v_permlane16_swap_b32 v120, v122
    v_permlane16_swap_b32 v121, v123
    v_permlane16_swap_b32 v124, v126
    v_permlane16_swap_b32 v125, v127
    v_permlane16_swap_b32 v128, v130
    v_permlane16_swap_b32 v129, v131
    v_permlane16_swap_b32 v132, v134
    v_permlane16_swap_b32 v133, v135
    v_permlane16_swap_b32 v136, v138
    v_permlane16_swap_b32 v137, v139
    v_permlane16_swap_b32 v140, v142
    v_permlane16_swap_b32 v141, v143
    v_accvgpr_write_b32 a4, v116
    v_accvgpr_write_b32 a5, v117
    v_accvgpr_write_b32 a6, v118
    v_accvgpr_write_b32 a7, v119
    v_accvgpr_write_b32 a20, v120
    v_accvgpr_write_b32 a21, v121
    v_accvgpr_write_b32 a22, v122
    v_accvgpr_write_b32 a23, v123
    v_accvgpr_write_b32 a36, v124
    v_accvgpr_write_b32 a37, v125
    v_accvgpr_write_b32 a38, v126
    v_accvgpr_write_b32 a39, v127
    v_accvgpr_write_b32 a52, v128
    v_accvgpr_write_b32 a53, v129
    v_accvgpr_write_b32 a54, v130
    v_accvgpr_write_b32 a55, v131
    v_accvgpr_write_b32 a68, v132
    v_accvgpr_write_b32 a69, v133
    v_accvgpr_write_b32 a70, v134
    v_accvgpr_write_b32 a71, v135
    v_accvgpr_write_b32 a84, v136
    v_accvgpr_write_b32 a85, v137
    v_accvgpr_write_b32 a86, v138
    v_accvgpr_write_b32 a87, v139
    v_accvgpr_write_b32 a100, v140
    v_accvgpr_write_b32 a101, v141
    v_accvgpr_write_b32 a102, v142
    v_accvgpr_write_b32 a103, v143
    v_accvgpr_read_b32 v144, a112
    v_accvgpr_read_b32 v145, a113
    v_accvgpr_read_b32 v146, a114
    v_accvgpr_read_b32 v147, a115
    v_accvgpr_read_b32 v148, a116
    v_accvgpr_read_b32 v149, a117
    v_accvgpr_read_b32 v150, a118
    v_accvgpr_read_b32 v151, a119
    v_accvgpr_read_b32 v152, a120
    v_accvgpr_read_b32 v153, a121
    v_accvgpr_read_b32 v154, a122
    v_accvgpr_read_b32 v155, a123
    v_accvgpr_read_b32 v156, a124
    v_accvgpr_read_b32 v157, a125
    v_accvgpr_read_b32 v158, a126
    v_accvgpr_read_b32 v159, a127
    v_accvgpr_read_b32 v160, a128
    v_accvgpr_read_b32 v161, a129
    v_accvgpr_read_b32 v162, a130
    v_accvgpr_read_b32 v163, a131
    v_accvgpr_read_b32 v164, a132
    v_accvgpr_read_b32 v165, a133
    v_accvgpr_read_b32 v166, a134
    v_accvgpr_read_b32 v167, a135
    v_accvgpr_read_b32 v168, a136
    v_accvgpr_read_b32 v169, a137
    v_accvgpr_read_b32 v170, a138
    v_accvgpr_read_b32 v171, a139
    v_accvgpr_read_b32 v172, a140
    v_accvgpr_read_b32 v173, a141
    v_accvgpr_read_b32 v174, a142
    v_accvgpr_read_b32 v175, a143
    v_accvgpr_read_b32 v176, a144
    v_accvgpr_read_b32 v177, a145
    v_accvgpr_read_b32 v178, a146
    v_accvgpr_read_b32 v179, a147
    v_accvgpr_read_b32 v180, a148
    v_accvgpr_read_b32 v181, a149
    v_accvgpr_read_b32 v182, a150
    v_accvgpr_read_b32 v183, a151
    v_accvgpr_read_b32 v184, a152
    v_accvgpr_read_b32 v185, a153
    v_accvgpr_read_b32 v186, a154
    v_accvgpr_read_b32 v187, a155
    v_accvgpr_read_b32 v188, a156
    v_accvgpr_read_b32 v189, a157
    v_accvgpr_read_b32 v190, a158
    v_accvgpr_read_b32 v191, a159
    v_accvgpr_read_b32 v192, a160
    v_accvgpr_read_b32 v193, a161
    v_accvgpr_read_b32 v194, a162
    v_accvgpr_read_b32 v195, a163
    v_accvgpr_read_b32 v196, a164
    v_accvgpr_read_b32 v197, a165
    v_accvgpr_read_b32 v198, a166
    v_accvgpr_read_b32 v199, a167
    v_pk_mul_f32 v[144:145], v[144:145], v[4:5]
    v_pk_mul_f32 v[146:147], v[146:147], v[4:5]
    v_pk_mul_f32 v[148:149], v[148:149], v[4:5]
    v_pk_mul_f32 v[150:151], v[150:151], v[4:5]
    v_pk_mul_f32 v[152:153], v[152:153], v[4:5]
    v_pk_mul_f32 v[154:155], v[154:155], v[4:5]
    v_pk_mul_f32 v[156:157], v[156:157], v[4:5]
    v_pk_mul_f32 v[158:159], v[158:159], v[4:5]
    v_pk_mul_f32 v[160:161], v[160:161], v[4:5]
    v_pk_mul_f32 v[162:163], v[162:163], v[4:5]
    v_pk_mul_f32 v[164:165], v[164:165], v[4:5]
    v_pk_mul_f32 v[166:167], v[166:167], v[4:5]
    v_pk_mul_f32 v[168:169], v[168:169], v[4:5]
    v_pk_mul_f32 v[170:171], v[170:171], v[4:5]
    v_pk_mul_f32 v[172:173], v[172:173], v[4:5]
    v_pk_mul_f32 v[174:175], v[174:175], v[4:5]
    v_pk_mul_f32 v[176:177], v[176:177], v[4:5]
    v_pk_mul_f32 v[178:179], v[178:179], v[4:5]
    v_pk_mul_f32 v[180:181], v[180:181], v[4:5]
    v_pk_mul_f32 v[182:183], v[182:183], v[4:5]
    v_pk_mul_f32 v[184:185], v[184:185], v[4:5]
    v_pk_mul_f32 v[186:187], v[186:187], v[4:5]
    v_pk_mul_f32 v[188:189], v[188:189], v[4:5]
    v_pk_mul_f32 v[190:191], v[190:191], v[4:5]
    v_pk_mul_f32 v[192:193], v[192:193], v[4:5]
    v_pk_mul_f32 v[194:195], v[194:195], v[4:5]
    v_pk_mul_f32 v[196:197], v[196:197], v[4:5]
    v_pk_mul_f32 v[198:199], v[198:199], v[4:5]
    v_cvt_pk_bf16_f32 v88, v144, v145
    v_cvt_pk_bf16_f32 v89, v146, v147
    v_cvt_pk_bf16_f32 v90, v172, v173
    v_cvt_pk_bf16_f32 v91, v174, v175
    v_cvt_pk_bf16_f32 v92, v148, v149
    v_cvt_pk_bf16_f32 v93, v150, v151
    v_cvt_pk_bf16_f32 v94, v176, v177
    v_cvt_pk_bf16_f32 v95, v178, v179
    v_cvt_pk_bf16_f32 v96, v152, v153
    v_cvt_pk_bf16_f32 v97, v154, v155
    v_cvt_pk_bf16_f32 v98, v180, v181
    v_cvt_pk_bf16_f32 v99, v182, v183
    v_cvt_pk_bf16_f32 v100, v156, v157
    v_cvt_pk_bf16_f32 v101, v158, v159
    v_cvt_pk_bf16_f32 v102, v184, v185
    v_cvt_pk_bf16_f32 v103, v186, v187
    v_cvt_pk_bf16_f32 v104, v160, v161
    v_cvt_pk_bf16_f32 v105, v162, v163
    v_cvt_pk_bf16_f32 v106, v188, v189
    v_cvt_pk_bf16_f32 v107, v190, v191
    v_cvt_pk_bf16_f32 v108, v164, v165
    v_cvt_pk_bf16_f32 v109, v166, v167
    v_cvt_pk_bf16_f32 v110, v192, v193
    v_cvt_pk_bf16_f32 v111, v194, v195
    v_cvt_pk_bf16_f32 v112, v168, v169
    v_cvt_pk_bf16_f32 v113, v170, v171
    v_cvt_pk_bf16_f32 v114, v196, v197
    v_cvt_pk_bf16_f32 v115, v198, v199
    s_nop 1
    v_permlane16_swap_b32 v88, v90
    v_permlane16_swap_b32 v89, v91
    v_permlane16_swap_b32 v92, v94
    v_permlane16_swap_b32 v93, v95
    v_permlane16_swap_b32 v96, v98
    v_permlane16_swap_b32 v97, v99
    v_permlane16_swap_b32 v100, v102
    v_permlane16_swap_b32 v101, v103
    v_permlane16_swap_b32 v104, v106
    v_permlane16_swap_b32 v105, v107
    v_permlane16_swap_b32 v108, v110
    v_permlane16_swap_b32 v109, v111
    v_permlane16_swap_b32 v112, v114
    v_permlane16_swap_b32 v113, v115
    v_accvgpr_write_b32 a8, v88
    v_accvgpr_write_b32 a9, v89
    v_accvgpr_write_b32 a10, v90
    v_accvgpr_write_b32 a11, v91
    v_accvgpr_write_b32 a24, v92
    v_accvgpr_write_b32 a25, v93
    v_accvgpr_write_b32 a26, v94
    v_accvgpr_write_b32 a27, v95
    v_accvgpr_write_b32 a40, v96
    v_accvgpr_write_b32 a41, v97
    v_accvgpr_write_b32 a42, v98
    v_accvgpr_write_b32 a43, v99
    v_accvgpr_write_b32 a56, v100
    v_accvgpr_write_b32 a57, v101
    v_accvgpr_write_b32 a58, v102
    v_accvgpr_write_b32 a59, v103
    v_accvgpr_write_b32 a72, v104
    v_accvgpr_write_b32 a73, v105
    v_accvgpr_write_b32 a74, v106
    v_accvgpr_write_b32 a75, v107
    v_accvgpr_write_b32 a88, v108
    v_accvgpr_write_b32 a89, v109
    v_accvgpr_write_b32 a90, v110
    v_accvgpr_write_b32 a91, v111
    v_accvgpr_write_b32 a104, v112
    v_accvgpr_write_b32 a105, v113
    v_accvgpr_write_b32 a106, v114
    v_accvgpr_write_b32 a107, v115
    v_accvgpr_read_b32 v200, a168
    v_accvgpr_read_b32 v201, a169
    v_accvgpr_read_b32 v202, a170
    v_accvgpr_read_b32 v203, a171
    v_accvgpr_read_b32 v204, a172
    v_accvgpr_read_b32 v205, a173
    v_accvgpr_read_b32 v206, a174
    v_accvgpr_read_b32 v207, a175
    v_accvgpr_read_b32 v208, a176
    v_accvgpr_read_b32 v209, a177
    v_accvgpr_read_b32 v210, a178
    v_accvgpr_read_b32 v211, a179
    v_accvgpr_read_b32 v212, a180
    v_accvgpr_read_b32 v213, a181
    v_accvgpr_read_b32 v214, a182
    v_accvgpr_read_b32 v215, a183
    v_accvgpr_read_b32 v216, a184
    v_accvgpr_read_b32 v217, a185
    v_accvgpr_read_b32 v218, a186
    v_accvgpr_read_b32 v219, a187
    v_accvgpr_read_b32 v220, a188
    v_accvgpr_read_b32 v221, a189
    v_accvgpr_read_b32 v222, a190
    v_accvgpr_read_b32 v223, a191
    v_accvgpr_read_b32 v224, a192
    v_accvgpr_read_b32 v225, a193
    v_accvgpr_read_b32 v226, a194
    v_accvgpr_read_b32 v227, a195
    v_accvgpr_read_b32 v228, a196
    v_accvgpr_read_b32 v229, a197
    v_accvgpr_read_b32 v230, a198
    v_accvgpr_read_b32 v231, a199
    v_accvgpr_read_b32 v232, a200
    v_accvgpr_read_b32 v233, a201
    v_accvgpr_read_b32 v234, a202
    v_accvgpr_read_b32 v235, a203
    v_accvgpr_read_b32 v236, a204
    v_accvgpr_read_b32 v237, a205
    v_accvgpr_read_b32 v238, a206
    v_accvgpr_read_b32 v239, a207
    v_accvgpr_read_b32 v240, a208
    v_accvgpr_read_b32 v241, a209
    v_accvgpr_read_b32 v242, a210
    v_accvgpr_read_b32 v243, a211
    v_accvgpr_read_b32 v244, a212
    v_accvgpr_read_b32 v245, a213
    v_accvgpr_read_b32 v246, a214
    v_accvgpr_read_b32 v247, a215
    v_accvgpr_read_b32 v248, a216
    v_accvgpr_read_b32 v249, a217
    v_accvgpr_read_b32 v250, a218
    v_accvgpr_read_b32 v251, a219
    v_accvgpr_read_b32 v252, a220
    v_accvgpr_read_b32 v253, a221
    v_accvgpr_read_b32 v254, a222
    v_accvgpr_read_b32 v255, a223
    v_pk_mul_f32 v[200:201], v[200:201], v[4:5]
    v_pk_mul_f32 v[202:203], v[202:203], v[4:5]
    v_pk_mul_f32 v[204:205], v[204:205], v[4:5]
    v_pk_mul_f32 v[206:207], v[206:207], v[4:5]
    v_pk_mul_f32 v[208:209], v[208:209], v[4:5]
    v_pk_mul_f32 v[210:211], v[210:211], v[4:5]
    v_pk_mul_f32 v[212:213], v[212:213], v[4:5]
    v_pk_mul_f32 v[214:215], v[214:215], v[4:5]
    v_pk_mul_f32 v[216:217], v[216:217], v[4:5]
    v_pk_mul_f32 v[218:219], v[218:219], v[4:5]
    v_pk_mul_f32 v[220:221], v[220:221], v[4:5]
    v_pk_mul_f32 v[222:223], v[222:223], v[4:5]
    v_pk_mul_f32 v[224:225], v[224:225], v[4:5]
    v_pk_mul_f32 v[226:227], v[226:227], v[4:5]
    v_pk_mul_f32 v[228:229], v[228:229], v[4:5]
    v_pk_mul_f32 v[230:231], v[230:231], v[4:5]
    v_pk_mul_f32 v[232:233], v[232:233], v[4:5]
    v_pk_mul_f32 v[234:235], v[234:235], v[4:5]
    v_pk_mul_f32 v[236:237], v[236:237], v[4:5]
    v_pk_mul_f32 v[238:239], v[238:239], v[4:5]
    v_pk_mul_f32 v[240:241], v[240:241], v[4:5]
    v_pk_mul_f32 v[242:243], v[242:243], v[4:5]
    v_pk_mul_f32 v[244:245], v[244:245], v[4:5]
    v_pk_mul_f32 v[246:247], v[246:247], v[4:5]
    v_pk_mul_f32 v[248:249], v[248:249], v[4:5]
    v_pk_mul_f32 v[250:251], v[250:251], v[4:5]
    v_pk_mul_f32 v[252:253], v[252:253], v[4:5]
    v_pk_mul_f32 v[254:255], v[254:255], v[4:5]
    v_cvt_pk_bf16_f32 v116, v200, v201
    v_cvt_pk_bf16_f32 v117, v202, v203
    v_cvt_pk_bf16_f32 v118, v228, v229
    v_cvt_pk_bf16_f32 v119, v230, v231
    v_cvt_pk_bf16_f32 v120, v204, v205
    v_cvt_pk_bf16_f32 v121, v206, v207
    v_cvt_pk_bf16_f32 v122, v232, v233
    v_cvt_pk_bf16_f32 v123, v234, v235
    v_cvt_pk_bf16_f32 v124, v208, v209
    v_cvt_pk_bf16_f32 v125, v210, v211
    v_cvt_pk_bf16_f32 v126, v236, v237
    v_cvt_pk_bf16_f32 v127, v238, v239
    v_cvt_pk_bf16_f32 v128, v212, v213
    v_cvt_pk_bf16_f32 v129, v214, v215
    v_cvt_pk_bf16_f32 v130, v240, v241
    v_cvt_pk_bf16_f32 v131, v242, v243
    v_cvt_pk_bf16_f32 v132, v216, v217
    v_cvt_pk_bf16_f32 v133, v218, v219
    v_cvt_pk_bf16_f32 v134, v244, v245
    v_cvt_pk_bf16_f32 v135, v246, v247
    v_cvt_pk_bf16_f32 v136, v220, v221
    v_cvt_pk_bf16_f32 v137, v222, v223
    v_cvt_pk_bf16_f32 v138, v248, v249
    v_cvt_pk_bf16_f32 v139, v250, v251
    v_cvt_pk_bf16_f32 v140, v224, v225
    v_cvt_pk_bf16_f32 v141, v226, v227
    v_cvt_pk_bf16_f32 v142, v252, v253
    v_cvt_pk_bf16_f32 v143, v254, v255
    s_nop 1
    v_permlane16_swap_b32 v116, v118
    v_permlane16_swap_b32 v117, v119
    v_permlane16_swap_b32 v120, v122
    v_permlane16_swap_b32 v121, v123
    v_permlane16_swap_b32 v124, v126
    v_permlane16_swap_b32 v125, v127
    v_permlane16_swap_b32 v128, v130
    v_permlane16_swap_b32 v129, v131
    v_permlane16_swap_b32 v132, v134
    v_permlane16_swap_b32 v133, v135
    v_permlane16_swap_b32 v136, v138
    v_permlane16_swap_b32 v137, v139
    v_permlane16_swap_b32 v140, v142
    v_permlane16_swap_b32 v141, v143
    v_accvgpr_write_b32 a12, v116
    v_accvgpr_write_b32 a13, v117
    v_accvgpr_write_b32 a14, v118
    v_accvgpr_write_b32 a15, v119
    v_accvgpr_write_b32 a28, v120
    v_accvgpr_write_b32 a29, v121
    v_accvgpr_write_b32 a30, v122
    v_accvgpr_write_b32 a31, v123
    v_accvgpr_write_b32 a44, v124
    v_accvgpr_write_b32 a45, v125
    v_accvgpr_write_b32 a46, v126
    v_accvgpr_write_b32 a47, v127
    v_accvgpr_write_b32 a60, v128
    v_accvgpr_write_b32 a61, v129
    v_accvgpr_write_b32 a62, v130
    v_accvgpr_write_b32 a63, v131
    v_accvgpr_write_b32 a76, v132
    v_accvgpr_write_b32 a77, v133
    v_accvgpr_write_b32 a78, v134
    v_accvgpr_write_b32 a79, v135
    v_accvgpr_write_b32 a92, v136
    v_accvgpr_write_b32 a93, v137
    v_accvgpr_write_b32 a94, v138
    v_accvgpr_write_b32 a95, v139
    v_accvgpr_write_b32 a108, v140
    v_accvgpr_write_b32 a109, v141
    v_accvgpr_write_b32 a110, v142
    v_accvgpr_write_b32 a111, v143
    s_cmp_eq_u32 s70, 0
    s_cbranch_scc1 L_at_nostash
    s_mov_b32 s70, 0
    s_lshl_b32 s30, s2, 2
    s_add_u32 s30, s30, s20
    s_mul_i32 s30, s30, 28672
    v_lshlrev_b32 v4, 4, v1
    buffer_store_dwordx4 a[0:3], v4, s[12:15], s30 offen offset:0
    buffer_store_dwordx4 a[4:7], v4, s[12:15], s30 offen offset:1024
    buffer_store_dwordx4 a[8:11], v4, s[12:15], s30 offen offset:2048
    buffer_store_dwordx4 a[12:15], v4, s[12:15], s30 offen offset:3072
    s_add_u32 s30, s30, 4096
    buffer_store_dwordx4 a[16:19], v4, s[12:15], s30 offen offset:0
    buffer_store_dwordx4 a[20:23], v4, s[12:15], s30 offen offset:1024
    buffer_store_dwordx4 a[24:27], v4, s[12:15], s30 offen offset:2048
    buffer_store_dwordx4 a[28:31], v4, s[12:15], s30 offen offset:3072
    s_add_u32 s30, s30, 4096
    buffer_store_dwordx4 a[32:35], v4, s[12:15], s30 offen offset:0
    buffer_store_dwordx4 a[36:39], v4, s[12:15], s30 offen offset:1024
    buffer_store_dwordx4 a[40:43], v4, s[12:15], s30 offen offset:2048
    buffer_store_dwordx4 a[44:47], v4, s[12:15], s30 offen offset:3072
    s_add_u32 s30, s30, 4096
    buffer_store_dwordx4 a[48:51], v4, s[12:15], s30 offen offset:0
    buffer_store_dwordx4 a[52:55], v4, s[12:15], s30 offen offset:1024
    buffer_store_dwordx4 a[56:59], v4, s[12:15], s30 offen offset:2048
    buffer_store_dwordx4 a[60:63], v4, s[12:15], s30 offen offset:3072
    s_add_u32 s30, s30, 4096
    buffer_store_dwordx4 a[64:67], v4, s[12:15], s30 offen offset:0
    buffer_store_dwordx4 a[68:71], v4, s[12:15], s30 offen offset:1024
    buffer_store_dwordx4 a[72:75], v4, s[12:15], s30 offen offset:2048
    buffer_store_dwordx4 a[76:79], v4, s[12:15], s30 offen offset:3072
    s_add_u32 s30, s30, 4096
    buffer_store_dwordx4 a[80:83], v4, s[12:15], s30 offen offset:0
    buffer_store_dwordx4 a[84:87], v4, s[12:15], s30 offen offset:1024
    buffer_store_dwordx4 a[88:91], v4, s[12:15], s30 offen offset:2048
    buffer_store_dwordx4 a[92:95], v4, s[12:15], s30 offen offset:3072
    s_add_u32 s30, s30, 4096
    buffer_store_dwordx4 a[96:99], v4, s[12:15], s30 offen offset:0
    buffer_store_dwordx4 a[100:103], v4, s[12:15], s30 offen offset:1024
    buffer_store_dwordx4 a[104:107], v4, s[12:15], s30 offen offset:2048
    buffer_store_dwordx4 a[108:111], v4, s[12:15], s30 offen offset:3072
    s_mov_b32 s68, 3
    s_branch L_at_round
L_at_nostash:
    s_cmp_lg_u32 s25, 0
    s_cbranch_scc1 L_at_maxpass
L_at_pre:
    s_cmp_lg_u32 s71, 1
    s_cbranch_scc1 L_at_nowo1
    s_mov_b32 s71, 2
    v_lshrrev_b32 v2, 4, v1
    v_bfe_u32 v3, v1, 2, 2
    v_lshl_add_u32 v3, v2, 3, v3
    v_mul_u32_u24 v3, 160, v3
    v_and_b32 v4, 3, v1
    v_lshl_add_u32 v3, v4, 3, v3
    s_mul_i32 s31, s20, 7168
    s_add_u32 s31, s31, 135168
    v_add_u32 v3, s31, v3
    v_lshlrev_b32 v4, 4, v1
    s_mul_i32 s28, s2, 40960
    s_mul_i32 s29, s20, 10240
    s_add_u32 s28, s28, s29
    s_add_u32 s28, s28, 117440512
    ds_read_b64_tr_b16 v[112:113], v3 offset:0
    ds_read_b64_tr_b16 v[114:115], v3 offset:640
    ds_read_b64_tr_b16 v[116:117], v3 offset:32
    ds_read_b64_tr_b16 v[118:119], v3 offset:672
    ds_read_b64_tr_b16 v[120:121], v3 offset:64
    ds_read_b64_tr_b16 v[122:123], v3 offset:704
    ds_read_b64_tr_b16 v[124:125], v3 offset:96
    ds_read_b64_tr_b16 v[126:127], v3 offset:736
    ds_read_b64_tr_b16 v[128:129], v3 offset:128
    ds_read_b64_tr_b16 v[130:131], v3 offset:768
    s_waitcnt lgkmcnt(0)
    buffer_store_dwordx4 v[112:115], v4, s[12:15], s28 offen offset:0
    buffer_store_dwordx4 v[116:119], v4, s[12:15], s28 offen offset:1024
    buffer_store_dwordx4 v[120:123], v4, s[12:15], s28 offen offset:2048
    buffer_store_dwordx4 v[124:127], v4, s[12:15], s28 offen offset:3072
    s_add_u32 s28, s28, 4096
    buffer_store_dwordx4 v[128:131], v4, s[12:15], s28 offen offset:0
    s_nop 1
    s_mov_b32 s28, 6554
    v_add_u32 v2, 0, v1
    v_mul_u32_u24 v3, s28, v2
    v_lshrrev_b32 v3, 16, v3
    v_mul_u32_u24 v4, 10, v3
    v_sub_u32 v4, v2, v4
    v_mul_u32_u24 v3, 1280, v3
    v_lshl_add_u32 v88, v4, 4, v3
    v_add_u32 v2, 64, v1
    v_mul_u32_u24 v3, s28, v2
    v_lshrrev_b32 v3, 16, v3
    v_mul_u32_u24 v4, 10, v3
    v_sub_u32 v4, v2, v4
    v_mul_u32_u24 v3, 1280, v3
    v_lshl_add_u32 v89, v4, 4, v3
    v_add_u32 v2, 128, v1
    v_mul_u32_u24 v3, s28, v2
    v_lshrrev_b32 v3, 16, v3
    v_mul_u32_u24 v4, 10, v3
    v_sub_u32 v4, v2, v4
    v_mul_u32_u24 v3, 1280, v3
    v_lshl_add_u32 v90, v4, 4, v3
    v_add_u32 v2, 192, v1
    v_mul_u32_u24 v3, s28, v2
    v_lshrrev_b32 v3, 16, v3
    v_mul_u32_u24 v4, 10, v3
    v_sub_u32 v4, v2, v4
    v_mul_u32_u24 v3, 1280, v3
    v_lshl_add_u32 v91, v4, 4, v3
    v_add_u32 v2, 256, v1
    v_mul_u32_u24 v3, s28, v2
    v_lshrrev_b32 v3, 16, v3
    v_mul_u32_u24 v4, 10, v3
    v_sub_u32 v4, v2, v4
    v_mul_u32_u24 v3, 1280, v3
    v_lshl_add_u32 v92, v4, 4, v3
    s_and_b32 s28, s2, 127
    s_mul_i32 s28, s28, 40960
    s_mul_i32 s29, s20, 320
    s_add_u32 s28, s28, s29
    s_add_u32 s28, s28, 160
    s_mul_i32 s31, s20, 7168
    s_add_u32 s31, s31, 135168
    s_add_u32 m0, s31, 0
    s_nop 0
    buffer_load_dwordx4 v88, s[84:87], s28 offen lds
    s_add_u32 m0, s31, 1024
    s_nop 0
    buffer_load_dwordx4 v89, s[84:87], s28 offen lds
    s_add_u32 m0, s31, 2048
    s_nop 0
    buffer_load_dwordx4 v90, s[84:87], s28 offen lds
    s_add_u32 m0, s31, 3072
    s_nop 0
    buffer_load_dwordx4 v91, s[84:87], s28 offen lds
    s_add_u32 m0, s31, 4096
    s_nop 0
    buffer_load_dwordx4 v92, s[84:87], s28 offen lds
L_at_nowo1:
    s_waitcnt lgkmcnt(0)
    v_mfma_f32_16x16x32_bf16 v[88:91], v[56:59], a[0:3], 0
    v_mov_b32 v168, 0
    v_mov_b32 v169, 0
    v_mfma_f32_16x16x32_bf16 v[88:91], v[60:63], a[4:7], v[88:91]
    v_mov_b32 v170, 0
    v_mov_b32 v171, 0
    v_mfma_f32_16x16x32_bf16 v[88:91], v[64:67], a[8:11], v[88:91]
    v_mov_b32 v196, 0
    v_mov_b32 v197, 0
    v_mfma_f32_16x16x32_bf16 v[88:91], v[68:71], a[12:15], v[88:91]
    v_mov_b32 v198, 0
    v_mov_b32 v199, 0
    v_mfma_f32_16x16x32_bf16 v[92:95], v[72:75], a[0:3], 0
    v_mov_b32 v224, 0
    v_mov_b32 v225, 0
    v_mfma_f32_16x16x32_bf16 v[92:95], v[76:79], a[4:7], v[92:95]
    v_mov_b32 v226, 0
    v_mov_b32 v227, 0
    v_mfma_f32_16x16x32_bf16 v[92:95], v[80:83], a[8:11], v[92:95]
    v_mov_b32 v252, 0
    v_mov_b32 v253, 0
    v_mfma_f32_16x16x32_bf16 v[92:95], v[84:87], a[12:15], v[92:95]
    v_mov_b32 v254, 0
    v_mov_b32 v255, 0
    v_accvgpr_write_b32 a136, 0
    v_accvgpr_write_b32 a137, 0
    v_accvgpr_write_b32 a138, 0
    v_accvgpr_write_b32 a139, 0
    v_accvgpr_write_b32 a164, 0
    v_accvgpr_write_b32 a165, 0
    v_accvgpr_write_b32 a166, 0
    v_accvgpr_write_b32 a167, 0
    v_accvgpr_write_b32 a192, 0
    v_accvgpr_write_b32 a193, 0
    v_accvgpr_write_b32 a194, 0
    v_accvgpr_write_b32 a195, 0
    v_accvgpr_write_b32 a220, 0
    v_accvgpr_write_b32 a221, 0
    v_accvgpr_write_b32 a222, 0
    v_accvgpr_write_b32 a223, 0
    v_mfma_f32_16x16x32_bf16 v[96:99], v[56:59], a[16:19], 0
    v_max3_f32 v2, v88, v89, v12
    v_max3_f32 v3, v90, v91, v92
    v_max3_f32 v2, v93, v94, v2
    v_mfma_f32_16x16x32_bf16 v[96:99], v[60:63], a[20:23], v[96:99]
    v_max3_f32 v2, v95, v2, v3
    v_mov_b32 v3, v2
    s_nop 1
    v_permlane16_swap_b32 v2, v3
    v_mfma_f32_16x16x32_bf16 v[96:99], v[64:67], a[24:27], v[96:99]
    s_nop 1
    v_max_f32 v2, v2, v3
    v_mov_b32 v3, v2
    v_mfma_f32_16x16x32_bf16 v[96:99], v[68:71], a[28:31], v[96:99]
    s_nop 1
    v_permlane32_swap_b32 v2, v3
    s_nop 1
    v_max_f32 v2, v2, v3
    v_mfma_f32_16x16x32_bf16 v[100:103], v[72:75], a[16:19], 0
    v_mov_b32 v12, 0
    v_mov_b32 v13, 0
    v_sub_f32 v88, v88, v2
    v_mfma_f32_16x16x32_bf16 v[100:103], v[76:79], a[20:23], v[100:103]
    v_sub_f32 v89, v89, v2
    v_sub_f32 v90, v90, v2
    v_sub_f32 v91, v91, v2
    v_sub_f32 v92, v92, v2
    v_mfma_f32_16x16x32_bf16 v[100:103], v[80:83], a[24:27], v[100:103]
    v_sub_f32 v93, v93, v2
    v_sub_f32 v94, v94, v2
    v_sub_f32 v95, v95, v2
    v_mfma_f32_16x16x32_bf16 v[100:103], v[84:87], a[28:31], v[100:103]
    v_sub_f32 v28, 0, v2
    v_sub_f32 v29, 0, v2
    v_sub_f32 v30, 0, v2
    v_sub_f32 v31, 0, v2
    ds_read_b64_tr_b16 v[112:113], v9 offset:0
    ds_read_b64_tr_b16 v[114:115], v9 offset:512
    v_exp_f32 v88, v88
    ds_read_b64_tr_b16 v[116:117], v9 offset:32
    ds_read_b64_tr_b16 v[118:119], v9 offset:544
    v_exp_f32 v89, v89
    v_exp_f32 v90, v90
    ds_read_b64_tr_b16 v[120:121], v9 offset:64
    ds_read_b64_tr_b16 v[122:123], v9 offset:576
    v_exp_f32 v91, v91
    v_add_f32 v12, v12, v88
    v_add_f32 v13, v13, v89
    ds_read_b64_tr_b16 v[124:125], v9 offset:96
    ds_read_b64_tr_b16 v[126:127], v9 offset:608
    v_cvt_pk_bf16_f32 v104, v88, v89
    v_exp_f32 v92, v92
    ds_read_b64_tr_b16 v[128:129], v9 offset:128
    ds_read_b64_tr_b16 v[130:131], v9 offset:640
    v_exp_f32 v93, v93
    v_add_f32 v12, v12, v90
    v_add_f32 v13, v13, v91
    ds_read_b64_tr_b16 v[132:133], v9 offset:160
    ds_read_b64_tr_b16 v[134:135], v9 offset:672
    v_cvt_pk_bf16_f32 v105, v90, v91
    v_exp_f32 v94, v94
    ds_read_b64_tr_b16 v[136:137], v9 offset:192
    ds_read_b64_tr_b16 v[138:139], v9 offset:704
    v_exp_f32 v95, v95
    v_add_f32 v12, v12, v92
    v_add_f32 v13, v13, v93
    ds_read_b64_tr_b16 v[140:141], v9 offset:224
    ds_read_b64_tr_b16 v[142:143], v9 offset:736
    v_cvt_pk_bf16_f32 v106, v92, v93
    v_add_f32 v12, v12, v94
    v_add_f32 v13, v13, v95
    v_cvt_pk_bf16_f32 v107, v94, v95
    v_mfma_f32_16x16x32_bf16 v[88:91], v[56:59], a[32:35], 0
    v_max3_f32 v2, v96, v97, v14
    v_max3_f32 v3, v98, v99, v100
    v_max3_f32 v2, v101, v102, v2
    v_mfma_f32_16x16x32_bf16 v[88:91], v[60:63], a[36:39], v[88:91]
    v_max3_f32 v2, v103, v2, v3
    v_mov_b32 v3, v2
    s_nop 1
    v_permlane16_swap_b32 v2, v3
    v_mfma_f32_16x16x32_bf16 v[88:91], v[64:67], a[40:43], v[88:91]
    s_nop 1
    v_max_f32 v2, v2, v3
    v_mov_b32 v3, v2
    v_mfma_f32_16x16x32_bf16 v[88:91], v[68:71], a[44:47], v[88:91]
    s_nop 1
    v_permlane32_swap_b32 v2, v3
    s_nop 1
    v_max_f32 v2, v2, v3
    v_mfma_f32_16x16x32_bf16 v[92:95], v[72:75], a[32:35], 0
    v_mov_b32 v14, 0
    v_mov_b32 v15, 0
    v_sub_f32 v96, v96, v2
    v_mfma_f32_16x16x32_bf16 v[92:95], v[76:79], a[36:39], v[92:95]
    v_sub_f32 v97, v97, v2
    v_sub_f32 v98, v98, v2
    v_sub_f32 v99, v99, v2
    v_sub_f32 v100, v100, v2
    v_mfma_f32_16x16x32_bf16 v[92:95], v[80:83], a[40:43], v[92:95]
    v_sub_f32 v101, v101, v2
    v_sub_f32 v102, v102, v2
    v_sub_f32 v103, v103, v2
    v_mfma_f32_16x16x32_bf16 v[92:95], v[84:87], a[44:47], v[92:95]
    v_sub_f32 v32, 0, v2
    v_sub_f32 v33, 0, v2
    v_sub_f32 v34, 0, v2
    v_sub_f32 v35, 0, v2
    s_waitcnt lgkmcnt(0)
    v_mfma_f32_16x16x32_bf16 v[144:147], v[112:115], v[104:107], 0
    v_exp_f32 v96, v96
    v_mfma_f32_16x16x32_bf16 v[172:175], v[116:119], v[104:107], 0
    v_exp_f32 v97, v97
    v_exp_f32 v98, v98
    v_mfma_f32_16x16x32_bf16 v[200:203], v[120:123], v[104:107], 0
    v_exp_f32 v99, v99
    v_add_f32 v14, v14, v96
    v_add_f32 v15, v15, v97
    v_mfma_f32_16x16x32_bf16 v[228:231], v[124:127], v[104:107], 0
    v_cvt_pk_bf16_f32 v108, v96, v97
    v_exp_f32 v100, v100
    v_mfma_f32_16x16x32_bf16 a[112:115], v[128:131], v[104:107], 0
    v_exp_f32 v101, v101
    v_add_f32 v14, v14, v98
    v_add_f32 v15, v15, v99
    v_mfma_f32_16x16x32_bf16 a[140:143], v[132:135], v[104:107], 0
    v_cvt_pk_bf16_f32 v109, v98, v99
    v_exp_f32 v102, v102
    v_mfma_f32_16x16x32_bf16 a[168:171], v[136:139], v[104:107], 0
    v_exp_f32 v103, v103
    v_add_f32 v14, v14, v100
    v_add_f32 v15, v15, v101
    v_mfma_f32_16x16x32_bf16 a[196:199], v[140:143], v[104:107], 0
    v_cvt_pk_bf16_f32 v110, v100, v101
    v_add_f32 v14, v14, v102
    v_add_f32 v15, v15, v103
    v_cvt_pk_bf16_f32 v111, v102, v103
    v_mfma_f32_16x16x32_bf16 v[96:99], v[56:59], a[48:51], 0
    v_max3_f32 v2, v88, v89, v16
    v_max3_f32 v3, v90, v91, v92
    v_max3_f32 v2, v93, v94, v2
    v_mfma_f32_16x16x32_bf16 v[96:99], v[60:63], a[52:55], v[96:99]
    v_max3_f32 v2, v95, v2, v3
    v_mov_b32 v3, v2
    s_nop 1
    v_permlane16_swap_b32 v2, v3
    v_mfma_f32_16x16x32_bf16 v[96:99], v[64:67], a[56:59], v[96:99]
    s_nop 1
    v_max_f32 v2, v2, v3
    v_mov_b32 v3, v2
    v_mfma_f32_16x16x32_bf16 v[96:99], v[68:71], a[60:63], v[96:99]
    s_nop 1
    v_permlane32_swap_b32 v2, v3
    s_nop 1
    v_max_f32 v2, v2, v3
    v_mfma_f32_16x16x32_bf16 v[100:103], v[72:75], a[48:51], 0
    v_mov_b32 v16, 0
    v_mov_b32 v17, 0
    v_sub_f32 v88, v88, v2
    v_mfma_f32_16x16x32_bf16 v[100:103], v[76:79], a[52:55], v[100:103]
    v_sub_f32 v89, v89, v2
    v_sub_f32 v90, v90, v2
    v_sub_f32 v91, v91, v2
    v_sub_f32 v92, v92, v2
    v_mfma_f32_16x16x32_bf16 v[100:103], v[80:83], a[56:59], v[100:103]
    v_sub_f32 v93, v93, v2
    v_sub_f32 v94, v94, v2
    v_sub_f32 v95, v95, v2
    v_mfma_f32_16x16x32_bf16 v[100:103], v[84:87], a[60:63], v[100:103]
    v_sub_f32 v36, 0, v2
    v_sub_f32 v37, 0, v2
    v_sub_f32 v38, 0, v2
    v_sub_f32 v39, 0, v2
    v_mfma_f32_16x16x32_bf16 v[148:151], v[112:115], v[108:111], 0
    v_exp_f32 v88, v88
    v_mfma_f32_16x16x32_bf16 v[176:179], v[116:119], v[108:111], 0
    v_exp_f32 v89, v89
    v_exp_f32 v90, v90
    v_mfma_f32_16x16x32_bf16 v[204:207], v[120:123], v[108:111], 0
    v_exp_f32 v91, v91
    v_add_f32 v16, v16, v88
    v_add_f32 v17, v17, v89
    v_mfma_f32_16x16x32_bf16 v[232:235], v[124:127], v[108:111], 0
    v_cvt_pk_bf16_f32 v104, v88, v89
    v_exp_f32 v92, v92
    v_mfma_f32_16x16x32_bf16 a[116:119], v[128:131], v[108:111], 0
    v_exp_f32 v93, v93
    v_add_f32 v16, v16, v90
    v_add_f32 v17, v17, v91
    v_mfma_f32_16x16x32_bf16 a[144:147], v[132:135], v[108:111], 0
    v_cvt_pk_bf16_f32 v105, v90, v91
    v_exp_f32 v94, v94
    v_mfma_f32_16x16x32_bf16 a[172:175], v[136:139], v[108:111], 0
    v_exp_f32 v95, v95
    v_add_f32 v16, v16, v92
    v_add_f32 v17, v17, v93
    v_mfma_f32_16x16x32_bf16 a[200:203], v[140:143], v[108:111], 0
    v_cvt_pk_bf16_f32 v106, v92, v93
    v_add_f32 v16, v16, v94
    v_add_f32 v17, v17, v95
    v_cvt_pk_bf16_f32 v107, v94, v95
    v_mfma_f32_16x16x32_bf16 v[88:91], v[56:59], a[64:67], 0
    v_max3_f32 v2, v96, v97, v18
    v_max3_f32 v3, v98, v99, v100
    v_max3_f32 v2, v101, v102, v2
    v_mfma_f32_16x16x32_bf16 v[88:91], v[60:63], a[68:71], v[88:91]
    v_max3_f32 v2, v103, v2, v3
    v_mov_b32 v3, v2
    s_nop 1
    v_permlane16_swap_b32 v2, v3
    v_mfma_f32_16x16x32_bf16 v[88:91], v[64:67], a[72:75], v[88:91]
    s_nop 1
    v_max_f32 v2, v2, v3
    v_mov_b32 v3, v2
    v_mfma_f32_16x16x32_bf16 v[88:91], v[68:71], a[76:79], v[88:91]
    s_nop 1
    v_permlane32_swap_b32 v2, v3
    s_nop 1
    v_max_f32 v2, v2, v3
    v_mfma_f32_16x16x32_bf16 v[92:95], v[72:75], a[64:67], 0
    v_mov_b32 v18, 0
    v_mov_b32 v19, 0
    v_sub_f32 v96, v96, v2
    v_mfma_f32_16x16x32_bf16 v[92:95], v[76:79], a[68:71], v[92:95]
    v_sub_f32 v97, v97, v2
    v_sub_f32 v98, v98, v2
    v_sub_f32 v99, v99, v2
    v_sub_f32 v100, v100, v2
    v_mfma_f32_16x16x32_bf16 v[92:95], v[80:83], a[72:75], v[92:95]
    v_sub_f32 v101, v101, v2
    v_sub_f32 v102, v102, v2
    v_sub_f32 v103, v103, v2
    v_mfma_f32_16x16x32_bf16 v[92:95], v[84:87], a[76:79], v[92:95]
    v_sub_f32 v40, 0, v2
    v_sub_f32 v41, 0, v2
    v_sub_f32 v42, 0, v2
    v_sub_f32 v43, 0, v2
    v_mfma_f32_16x16x32_bf16 v[152:155], v[112:115], v[104:107], 0
    v_exp_f32 v96, v96
    v_mfma_f32_16x16x32_bf16 v[180:183], v[116:119], v[104:107], 0
    v_exp_f32 v97, v97
    v_exp_f32 v98, v98
    v_mfma_f32_16x16x32_bf16 v[208:211], v[120:123], v[104:107], 0
    v_exp_f32 v99, v99
    v_add_f32 v18, v18, v96
    v_add_f32 v19, v19, v97
    v_mfma_f32_16x16x32_bf16 v[236:239], v[124:127], v[104:107], 0
    v_cvt_pk_bf16_f32 v108, v96, v97
    v_exp_f32 v100, v100
    v_mfma_f32_16x16x32_bf16 a[120:123], v[128:131], v[104:107], 0
    v_exp_f32 v101, v101
    v_add_f32 v18, v18, v98
    v_add_f32 v19, v19, v99
    v_mfma_f32_16x16x32_bf16 a[148:151], v[132:135], v[104:107], 0
    v_cvt_pk_bf16_f32 v109, v98, v99
    v_exp_f32 v102, v102
    v_mfma_f32_16x16x32_bf16 a[176:179], v[136:139], v[104:107], 0
    v_exp_f32 v103, v103
    v_add_f32 v18, v18, v100
    v_add_f32 v19, v19, v101
    v_mfma_f32_16x16x32_bf16 a[204:207], v[140:143], v[104:107], 0
    v_cvt_pk_bf16_f32 v110, v100, v101
    v_add_f32 v18, v18, v102
    v_add_f32 v19, v19, v103
    v_cvt_pk_bf16_f32 v111, v102, v103
    v_mfma_f32_16x16x32_bf16 v[96:99], v[56:59], a[80:83], 0
    v_max3_f32 v2, v88, v89, v20
    v_max3_f32 v3, v90, v91, v92
    v_max3_f32 v2, v93, v94, v2
    v_mfma_f32_16x16x32_bf16 v[96:99], v[60:63], a[84:87], v[96:99]
    v_max3_f32 v2, v95, v2, v3
    v_mov_b32 v3, v2
    s_nop 1
    v_permlane16_swap_b32 v2, v3
    v_mfma_f32_16x16x32_bf16 v[96:99], v[64:67], a[88:91], v[96:99]
    s_nop 1
    v_max_f32 v2, v2, v3
    v_mov_b32 v3, v2
    v_mfma_f32_16x16x32_bf16 v[96:99], v[68:71], a[92:95], v[96:99]
    s_nop 1
    v_permlane32_swap_b32 v2, v3
    s_nop 1
    v_max_f32 v2, v2, v3
    v_mfma_f32_16x16x32_bf16 v[100:103], v[72:75], a[80:83], 0
    v_mov_b32 v20, 0
    v_mov_b32 v21, 0
    v_sub_f32 v88, v88, v2
    v_mfma_f32_16x16x32_bf16 v[100:103], v[76:79], a[84:87], v[100:103]
    v_sub_f32 v89, v89, v2
    v_sub_f32 v90, v90, v2
    v_sub_f32 v91, v91, v2
    v_sub_f32 v92, v92, v2
    v_mfma_f32_16x16x32_bf16 v[100:103], v[80:83], a[88:91], v[100:103]
    v_sub_f32 v93, v93, v2
    v_sub_f32 v94, v94, v2
    v_sub_f32 v95, v95, v2
    v_mfma_f32_16x16x32_bf16 v[100:103], v[84:87], a[92:95], v[100:103]
    v_sub_f32 v44, 0, v2
    v_sub_f32 v45, 0, v2
    v_sub_f32 v46, 0, v2
    v_sub_f32 v47, 0, v2
    v_mfma_f32_16x16x32_bf16 v[156:159], v[112:115], v[108:111], 0
    v_exp_f32 v88, v88
    v_mfma_f32_16x16x32_bf16 v[184:187], v[116:119], v[108:111], 0
    v_exp_f32 v89, v89
    v_exp_f32 v90, v90
    v_mfma_f32_16x16x32_bf16 v[212:215], v[120:123], v[108:111], 0
    v_exp_f32 v91, v91
    v_add_f32 v20, v20, v88
    v_add_f32 v21, v21, v89
    v_mfma_f32_16x16x32_bf16 v[240:243], v[124:127], v[108:111], 0
    v_cvt_pk_bf16_f32 v104, v88, v89
    v_exp_f32 v92, v92
    v_mfma_f32_16x16x32_bf16 a[124:127], v[128:131], v[108:111], 0
    v_exp_f32 v93, v93
    v_add_f32 v20, v20, v90
    v_add_f32 v21, v21, v91
    v_mfma_f32_16x16x32_bf16 a[152:155], v[132:135], v[108:111], 0
    v_cvt_pk_bf16_f32 v105, v90, v91
    v_exp_f32 v94, v94
    v_mfma_f32_16x16x32_bf16 a[180:183], v[136:139], v[108:111], 0
    v_exp_f32 v95, v95
    v_add_f32 v20, v20, v92
    v_add_f32 v21, v21, v93
    v_mfma_f32_16x16x32_bf16 a[208:211], v[140:143], v[108:111], 0
    v_cvt_pk_bf16_f32 v106, v92, v93
    v_add_f32 v20, v20, v94
    v_add_f32 v21, v21, v95
    v_cvt_pk_bf16_f32 v107, v94, v95
    s_cmp_eq_u32 s68, 0
    s_cbranch_scc1 L_bw1_3296
    s_sub_u32 s68, s68, 1
    s_waitcnt vmcnt(44) lgkmcnt(0)
    s_branch L_bw2_3296
L_bw1_3296:
    s_waitcnt vmcnt(16) lgkmcnt(0)
L_bw2_3296:
    s_barrier
    s_cmp_le_u32 s21, s27
    s_cbranch_scc1 L_at_nofb_3305
    s_sub_u32 s28, s21, 1
    s_cmp_eq_u32 s28, s23
    s_cbranch_scc1 L_at_nofb_3305
    s_lshl_b32 s29, s28, 2
    s_add_u32 s29, s29, 76000
    v_mov_b32 v4, s29
    ds_read_b32 v4, v4
    s_waitcnt lgkmcnt(0)
    v_readfirstlane_b32 s29, v4
    s_nop 3
    s_cmp_lg_u32 s29, 0
    s_cbranch_scc1 L_at_fallback
L_at_nofb_3305:
    v_mfma_f32_16x16x32_bf16 v[88:91], v[56:59], a[96:99], 0
    ds_read_b128 v[56:59], v8 offset:8448
    v_max3_f32 v2, v96, v97, v22
    v_max3_f32 v3, v98, v99, v100
    v_max3_f32 v2, v101, v102, v2
    v_mfma_f32_16x16x32_bf16 v[88:91], v[60:63], a[100:103], v[88:91]
    ds_read_b128 v[60:63], v8 offset:8512
    v_max3_f32 v2, v103, v2, v3
    v_mov_b32 v3, v2
    s_nop 1
    v_permlane16_swap_b32 v2, v3
    v_mfma_f32_16x16x32_bf16 v[88:91], v[64:67], a[104:107], v[88:91]
    ds_read_b128 v[64:67], v8 offset:8576
    s_nop 1
    v_max_f32 v2, v2, v3
    v_mov_b32 v3, v2
    v_mfma_f32_16x16x32_bf16 v[88:91], v[68:71], a[108:111], v[88:91]
    ds_read_b128 v[68:71], v8 offset:8640
    s_nop 1
    v_permlane32_swap_b32 v2, v3
    s_nop 1
    v_max_f32 v2, v2, v3
    v_mfma_f32_16x16x32_bf16 v[92:95], v[72:75], a[96:99], 0
    ds_read_b128 v[72:75], v8 offset:8960
    v_mov_b32 v22, 0
    v_mov_b32 v23, 0
    v_sub_f32 v96, v96, v2
    v_mfma_f32_16x16x32_bf16 v[92:95], v[76:79], a[100:103], v[92:95]
    ds_read_b128 v[76:79], v8 offset:9024
    v_sub_f32 v97, v97, v2
    v_sub_f32 v98, v98, v2
    v_sub_f32 v99, v99, v2
    v_sub_f32 v100, v100, v2
    v_mfma_f32_16x16x32_bf16 v[92:95], v[80:83], a[104:107], v[92:95]
    ds_read_b128 v[80:83], v8 offset:9088
    v_sub_f32 v101, v101, v2
    v_sub_f32 v102, v102, v2
    v_sub_f32 v103, v103, v2
    v_mfma_f32_16x16x32_bf16 v[92:95], v[84:87], a[108:111], v[92:95]
    ds_read_b128 v[84:87], v8 offset:9152
    v_sub_f32 v48, 0, v2
    v_sub_f32 v49, 0, v2
    v_sub_f32 v50, 0, v2
    v_sub_f32 v51, 0, v2
    v_mfma_f32_16x16x32_bf16 v[160:163], v[112:115], v[104:107], 0
    v_exp_f32 v96, v96
    v_mfma_f32_16x16x32_bf16 v[188:191], v[116:119], v[104:107], 0
    v_exp_f32 v97, v97
    v_exp_f32 v98, v98
    v_mfma_f32_16x16x32_bf16 v[216:219], v[120:123], v[104:107], 0
    v_exp_f32 v99, v99
    v_add_f32 v22, v22, v96
    v_add_f32 v23, v23, v97
    v_mfma_f32_16x16x32_bf16 v[244:247], v[124:127], v[104:107], 0
    v_cvt_pk_bf16_f32 v108, v96, v97
    v_exp_f32 v100, v100
    v_mfma_f32_16x16x32_bf16 a[128:131], v[128:131], v[104:107], 0
    v_exp_f32 v101, v101
    v_add_f32 v22, v22, v98
    v_add_f32 v23, v23, v99
    v_mfma_f32_16x16x32_bf16 a[156:159], v[132:135], v[104:107], 0
    v_cvt_pk_bf16_f32 v109, v98, v99
    v_exp_f32 v102, v102
    v_mfma_f32_16x16x32_bf16 a[184:187], v[136:139], v[104:107], 0
    v_exp_f32 v103, v103
    v_add_f32 v22, v22, v100
    v_add_f32 v23, v23, v101
    v_mfma_f32_16x16x32_bf16 a[212:215], v[140:143], v[104:107], 0
    v_cvt_pk_bf16_f32 v110, v100, v101
    v_add_f32 v22, v22, v102
    v_add_f32 v23, v23, v103
    v_cvt_pk_bf16_f32 v111, v102, v103
    s_waitcnt lgkmcnt(0)
    v_mfma_f32_16x16x32_bf16 v[96:99], v[56:59], a[0:3], v[28:31]
    v_max3_f32 v2, v88, v89, v24
    v_max3_f32 v3, v90, v91, v92
    v_max3_f32 v2, v93, v94, v2
    v_mfma_f32_16x16x32_bf16 v[96:99], v[60:63], a[4:7], v[96:99]
    v_max3_f32 v2, v95, v2, v3
    v_mov_b32 v3, v2
    s_nop 1
    v_permlane16_swap_b32 v2, v3
    v_mfma_f32_16x16x32_bf16 v[96:99], v[64:67], a[8:11], v[96:99]
    s_nop 1
    v_max_f32 v2, v2, v3
    v_mov_b32 v3, v2
    v_mfma_f32_16x16x32_bf16 v[96:99], v[68:71], a[12:15], v[96:99]
    s_nop 1
    v_permlane32_swap_b32 v2, v3
    s_nop 1
    v_max_f32 v2, v2, v3
    v_mfma_f32_16x16x32_bf16 v[100:103], v[72:75], a[0:3], v[28:31]
    v_mov_b32 v24, 0
    v_mov_b32 v25, 0
    v_sub_f32 v88, v88, v2
    v_mfma_f32_16x16x32_bf16 v[100:103], v[76:79], a[4:7], v[100:103]
    v_sub_f32 v89, v89, v2
    v_sub_f32 v90, v90, v2
    v_sub_f32 v91, v91, v2
    v_sub_f32 v92, v92, v2
    v_mfma_f32_16x16x32_bf16 v[100:103], v[80:83], a[8:11], v[100:103]
    v_sub_f32 v93, v93, v2
    v_sub_f32 v94, v94, v2
    v_sub_f32 v95, v95, v2
    v_mfma_f32_16x16x32_bf16 v[100:103], v[84:87], a[12:15], v[100:103]
    v_sub_f32 v52, 0, v2
    v_sub_f32 v53, 0, v2
    v_sub_f32 v54, 0, v2
    v_sub_f32 v55, 0, v2
    v_mfma_f32_16x16x32_bf16 v[164:167], v[112:115], v[108:111], 0
    v_exp_f32 v88, v88
    v_mfma_f32_16x16x32_bf16 v[192:195], v[116:119], v[108:111], 0
    v_exp_f32 v89, v89
    v_exp_f32 v90, v90
    v_mfma_f32_16x16x32_bf16 v[220:223], v[120:123], v[108:111], 0
    v_exp_f32 v91, v91
    v_add_f32 v24, v24, v88
    v_add_f32 v25, v25, v89
    v_mfma_f32_16x16x32_bf16 v[248:251], v[124:127], v[108:111], 0
    v_cvt_pk_bf16_f32 v104, v88, v89
    v_exp_f32 v92, v92
    v_mfma_f32_16x16x32_bf16 a[132:135], v[128:131], v[108:111], 0
    v_exp_f32 v93, v93
    v_add_f32 v24, v24, v90
    v_add_f32 v25, v25, v91
    v_mfma_f32_16x16x32_bf16 a[160:163], v[132:135], v[108:111], 0
    v_cvt_pk_bf16_f32 v105, v90, v91
    v_exp_f32 v94, v94
    v_mfma_f32_16x16x32_bf16 a[188:191], v[136:139], v[108:111], 0
    v_exp_f32 v95, v95
    v_add_f32 v24, v24, v92
    v_add_f32 v25, v25, v93
    v_mfma_f32_16x16x32_bf16 a[216:219], v[140:143], v[108:111], 0
    v_cvt_pk_bf16_f32 v106, v92, v93
    v_add_f32 v24, v24, v94
    v_add_f32 v25, v25, v95
    v_cvt_pk_bf16_f32 v107, v94, v95
    s_mov_b32 s22, 0
L_at_loop:
    v_mfma_f32_16x16x32_bf16 v[88:91], v[56:59], a[16:19], v[32:35]
    v_mfma_f32_16x16x32_bf16 v[88:91], v[60:63], a[20:23], v[88:91]
    v_exp_f32 v96, v96
    v_mfma_f32_16x16x32_bf16 v[88:91], v[64:67], a[24:27], v[88:91]
    v_exp_f32 v97, v97
    v_mfma_f32_16x16x32_bf16 v[88:91], v[68:71], a[28:31], v[88:91]
    v_exp_f32 v98, v98
    v_mfma_f32_16x16x32_bf16 v[92:95], v[72:75], a[16:19], v[32:35]
    v_exp_f32 v99, v99
    v_mfma_f32_16x16x32_bf16 v[92:95], v[76:79], a[20:23], v[92:95]
    v_add_f32 v12, v12, v96
    v_add_f32 v13, v13, v97
    v_mfma_f32_16x16x32_bf16 v[92:95], v[80:83], a[24:27], v[92:95]
    v_cvt_pk_bf16_f32 v108, v96, v97
    v_mfma_f32_16x16x32_bf16 v[92:95], v[84:87], a[28:31], v[92:95]
    v_exp_f32 v100, v100
    v_mfma_f32_16x16x32_bf16 v[168:171], v[112:115], v[104:107], v[168:171]
    ds_read_b64_tr_b16 v[112:113], v9 offset:8448
    ds_read_b64_tr_b16 v[114:115], v9 offset:8960
    v_exp_f32 v101, v101
    v_mfma_f32_16x16x32_bf16 v[196:199], v[116:119], v[104:107], v[196:199]
    ds_read_b64_tr_b16 v[116:117], v9 offset:8480
    ds_read_b64_tr_b16 v[118:119], v9 offset:8992
    v_add_f32 v12, v12, v98
    v_add_f32 v13, v13, v99
    v_mfma_f32_16x16x32_bf16 v[224:227], v[120:123], v[104:107], v[224:227]
    ds_read_b64_tr_b16 v[120:121], v9 offset:8512
    ds_read_b64_tr_b16 v[122:123], v9 offset:9024
    v_cvt_pk_bf16_f32 v109, v98, v99
    v_mfma_f32_16x16x32_bf16 v[252:255], v[124:127], v[104:107], v[252:255]
    ds_read_b64_tr_b16 v[124:125], v9 offset:8544
    ds_read_b64_tr_b16 v[126:127], v9 offset:9056
    v_exp_f32 v102, v102
    v_mfma_f32_16x16x32_bf16 a[136:139], v[128:131], v[104:107], a[136:139]
    ds_read_b64_tr_b16 v[128:129], v9 offset:8576
    ds_read_b64_tr_b16 v[130:131], v9 offset:9088
    v_exp_f32 v103, v103
    v_mfma_f32_16x16x32_bf16 a[164:167], v[132:135], v[104:107], a[164:167]
    ds_read_b64_tr_b16 v[132:133], v9 offset:8608
    ds_read_b64_tr_b16 v[134:135], v9 offset:9120
    v_add_f32 v12, v12, v100
    v_add_f32 v13, v13, v101
    v_mfma_f32_16x16x32_bf16 a[192:195], v[136:139], v[104:107], a[192:195]
    ds_read_b64_tr_b16 v[136:137], v9 offset:8640
    ds_read_b64_tr_b16 v[138:139], v9 offset:9152
    v_cvt_pk_bf16_f32 v110, v100, v101
    v_add_f32 v12, v12, v102
    v_mfma_f32_16x16x32_bf16 a[220:223], v[140:143], v[104:107], a[220:223]
    ds_read_b64_tr_b16 v[140:141], v9 offset:8672
    ds_read_b64_tr_b16 v[142:143], v9 offset:9184
    v_add_f32 v13, v13, v103
    v_cvt_pk_bf16_f32 v111, v102, v103
    v_mfma_f32_16x16x32_bf16 v[96:99], v[56:59], a[32:35], v[36:39]
    v_mfma_f32_16x16x32_bf16 v[96:99], v[60:63], a[36:39], v[96:99]
    s_add_u32 s29, s34, s100
    v_exp_f32 v88, v88
    v_mfma_f32_16x16x32_bf16 v[96:99], v[64:67], a[40:43], v[96:99]
    v_exp_f32 v89, v89
    v_mfma_f32_16x16x32_bf16 v[96:99], v[68:71], a[44:47], v[96:99]
    s_bfe_u32 s28, s29, 0x20003
    v_exp_f32 v90, v90
    v_mfma_f32_16x16x32_bf16 v[100:103], v[72:75], a[32:35], v[36:39]
    v_exp_f32 v91, v91
    v_mfma_f32_16x16x32_bf16 v[100:103], v[76:79], a[36:39], v[100:103]
    s_lshl_b32 s28, s28, 16
    v_add_f32 v14, v14, v88
    v_add_f32 v15, v15, v89
    v_mfma_f32_16x16x32_bf16 v[100:103], v[80:83], a[40:43], v[100:103]
    v_cvt_pk_bf16_f32 v104, v88, v89
    v_mfma_f32_16x16x32_bf16 v[100:103], v[84:87], a[44:47], v[100:103]
    v_exp_f32 v92, v92
    s_waitcnt lgkmcnt(0)
    v_mfma_f32_16x16x32_bf16 v[144:147], v[112:115], v[108:111], v[144:147]
    s_and_b32 s29, s29, 7
    v_exp_f32 v93, v93
    v_mfma_f32_16x16x32_bf16 v[172:175], v[116:119], v[108:111], v[172:175]
    v_add_f32 v14, v14, v90
    v_add_f32 v15, v15, v91
    v_mfma_f32_16x16x32_bf16 v[200:203], v[120:123], v[108:111], v[200:203]
    s_lshl_b32 s29, s29, 11
    v_cvt_pk_bf16_f32 v105, v90, v91
    v_mfma_f32_16x16x32_bf16 v[228:231], v[124:127], v[108:111], v[228:231]
    v_exp_f32 v94, v94
    v_mfma_f32_16x16x32_bf16 a[112:115], v[128:131], v[108:111], a[112:115]
    s_add_u32 s29, s28, s29
    v_exp_f32 v95, v95
    v_mfma_f32_16x16x32_bf16 a[140:143], v[132:135], v[108:111], a[140:143]
    v_add_f32 v14, v14, v92
    v_add_f32 v15, v15, v93
    v_mfma_f32_16x16x32_bf16 a[168:171], v[136:139], v[108:111], a[168:171]
    s_lshr_b32 s28, s34, 5
    v_cvt_pk_bf16_f32 v106, v92, v93
    v_add_f32 v14, v14, v94
    v_mfma_f32_16x16x32_bf16 a[196:199], v[140:143], v[108:111], a[196:199]
    v_add_f32 v15, v15, v95
    v_cvt_pk_bf16_f32 v107, v94, v95
    v_mfma_f32_16x16x32_bf16 v[88:91], v[56:59], a[48:51], v[40:43]
    v_mfma_f32_16x16x32_bf16 v[88:91], v[60:63], a[52:55], v[88:91]
    s_lshl_b32 s28, s28, 19
    v_exp_f32 v96, v96
    v_mfma_f32_16x16x32_bf16 v[88:91], v[64:67], a[56:59], v[88:91]
    v_exp_f32 v97, v97
    v_mfma_f32_16x16x32_bf16 v[88:91], v[68:71], a[60:63], v[88:91]
    s_add_u32 s49, s28, s29
    v_exp_f32 v98, v98
    v_mfma_f32_16x16x32_bf16 v[92:95], v[72:75], a[48:51], v[40:43]
    v_exp_f32 v99, v99
    v_mfma_f32_16x16x32_bf16 v[92:95], v[76:79], a[52:55], v[92:95]
    s_add_u32 m0, s33, 0
    v_add_f32 v16, v16, v96
    v_add_f32 v17, v17, v97
    v_mfma_f32_16x16x32_bf16 v[92:95], v[80:83], a[56:59], v[92:95]
    v_cvt_pk_bf16_f32 v108, v96, v97
    v_mfma_f32_16x16x32_bf16 v[92:95], v[84:87], a[60:63], v[92:95]
    v_exp_f32 v100, v100
    v_mfma_f32_16x16x32_bf16 v[148:151], v[112:115], v[104:107], v[148:151]
    s_add_u32 s34, s34, 1
    v_exp_f32 v101, v101
    v_mfma_f32_16x16x32_bf16 v[176:179], v[116:119], v[104:107], v[176:179]
    v_add_f32 v16, v16, v98
    v_add_f32 v17, v17, v99
    v_mfma_f32_16x16x32_bf16 v[204:207], v[120:123], v[104:107], v[204:207]
    buffer_load_dwordx4 v7, s[4:7], s49 offen offset:0 nt lds
    v_cvt_pk_bf16_f32 v109, v98, v99
    v_mfma_f32_16x16x32_bf16 v[232:235], v[124:127], v[104:107], v[232:235]
    v_exp_f32 v102, v102
    v_mfma_f32_16x16x32_bf16 a[116:119], v[128:131], v[104:107], a[116:119]
    s_add_u32 m0, m0, s96
    v_exp_f32 v103, v103
    v_mfma_f32_16x16x32_bf16 a[144:147], v[132:135], v[104:107], a[144:147]
    v_add_f32 v16, v16, v100
    v_add_f32 v17, v17, v101
    v_mfma_f32_16x16x32_bf16 a[172:175], v[136:139], v[104:107], a[172:175]
    buffer_load_dwordx4 v7, s[4:7], s49 offen offset:256 nt lds
    v_cvt_pk_bf16_f32 v110, v100, v101
    v_add_f32 v16, v16, v102
    v_mfma_f32_16x16x32_bf16 a[200:203], v[140:143], v[104:107], a[200:203]
    v_add_f32 v17, v17, v103
    v_cvt_pk_bf16_f32 v111, v102, v103
    v_mfma_f32_16x16x32_bf16 v[96:99], v[56:59], a[64:67], v[44:47]
    v_mfma_f32_16x16x32_bf16 v[96:99], v[60:63], a[68:71], v[96:99]
    s_add_u32 m0, m0, s97
    v_exp_f32 v88, v88
    v_mfma_f32_16x16x32_bf16 v[96:99], v[64:67], a[72:75], v[96:99]
    v_exp_f32 v89, v89
    v_mfma_f32_16x16x32_bf16 v[96:99], v[68:71], a[76:79], v[96:99]
    buffer_load_dwordx4 v7, s[4:7], s49 offen offset:512 nt lds
    v_exp_f32 v90, v90
    v_mfma_f32_16x16x32_bf16 v[100:103], v[72:75], a[64:67], v[44:47]
    v_exp_f32 v91, v91
    v_mfma_f32_16x16x32_bf16 v[100:103], v[76:79], a[68:71], v[100:103]
    s_add_u32 m0, m0, s96
    v_add_f32 v18, v18, v88
    v_add_f32 v19, v19, v89
    v_mfma_f32_16x16x32_bf16 v[100:103], v[80:83], a[72:75], v[100:103]
    v_cvt_pk_bf16_f32 v104, v88, v89
    v_mfma_f32_16x16x32_bf16 v[100:103], v[84:87], a[76:79], v[100:103]
    v_exp_f32 v92, v92
    v_mfma_f32_16x16x32_bf16 v[152:155], v[112:115], v[108:111], v[152:155]
    buffer_load_dwordx4 v7, s[4:7], s49 offen offset:768 nt lds
    v_exp_f32 v93, v93
    v_mfma_f32_16x16x32_bf16 v[180:183], v[116:119], v[108:111], v[180:183]
    v_add_f32 v18, v18, v90
    v_add_f32 v19, v19, v91
    v_mfma_f32_16x16x32_bf16 v[208:211], v[120:123], v[108:111], v[208:211]
    s_add_u32 m0, m0, s97
    v_cvt_pk_bf16_f32 v105, v90, v91
    v_mfma_f32_16x16x32_bf16 v[236:239], v[124:127], v[108:111], v[236:239]
    v_exp_f32 v94, v94
    v_mfma_f32_16x16x32_bf16 a[120:123], v[128:131], v[108:111], a[120:123]
    buffer_load_dwordx4 v7, s[4:7], s49 offen offset:1024 nt lds
    v_exp_f32 v95, v95
    v_mfma_f32_16x16x32_bf16 a[148:151], v[132:135], v[108:111], a[148:151]
    v_add_f32 v18, v18, v92
    v_add_f32 v19, v19, v93
    v_mfma_f32_16x16x32_bf16 a[176:179], v[136:139], v[108:111], a[176:179]
    s_add_u32 m0, m0, s96
    v_cvt_pk_bf16_f32 v106, v92, v93
    v_add_f32 v18, v18, v94
    v_mfma_f32_16x16x32_bf16 a[204:207], v[140:143], v[108:111], a[204:207]
    v_add_f32 v19, v19, v95
    v_cvt_pk_bf16_f32 v107, v94, v95
    v_mfma_f32_16x16x32_bf16 v[88:91], v[56:59], a[80:83], v[48:51]
    v_mfma_f32_16x16x32_bf16 v[88:91], v[60:63], a[84:87], v[88:91]
    buffer_load_dwordx4 v7, s[4:7], s49 offen offset:1280 nt lds
    v_exp_f32 v96, v96
    v_mfma_f32_16x16x32_bf16 v[88:91], v[64:67], a[88:91], v[88:91]
    v_exp_f32 v97, v97
    v_mfma_f32_16x16x32_bf16 v[88:91], v[68:71], a[92:95], v[88:91]
    s_add_u32 m0, m0, s97
    v_exp_f32 v98, v98
    v_mfma_f32_16x16x32_bf16 v[92:95], v[72:75], a[80:83], v[48:51]
    v_exp_f32 v99, v99
    v_mfma_f32_16x16x32_bf16 v[92:95], v[76:79], a[84:87], v[92:95]
    buffer_load_dwordx4 v7, s[4:7], s49 offen offset:1536 nt lds
    v_add_f32 v20, v20, v96
    v_add_f32 v21, v21, v97
    v_mfma_f32_16x16x32_bf16 v[92:95], v[80:83], a[88:91], v[92:95]
    v_cvt_pk_bf16_f32 v108, v96, v97
    v_mfma_f32_16x16x32_bf16 v[92:95], v[84:87], a[92:95], v[92:95]
    v_exp_f32 v100, v100
    v_mfma_f32_16x16x32_bf16 v[156:159], v[112:115], v[104:107], v[156:159]
    s_add_u32 m0, m0, s96
    v_exp_f32 v101, v101
    v_mfma_f32_16x16x32_bf16 v[184:187], v[116:119], v[104:107], v[184:187]
    v_add_f32 v20, v20, v98
    v_add_f32 v21, v21, v99
    v_mfma_f32_16x16x32_bf16 v[212:215], v[120:123], v[104:107], v[212:215]
    buffer_load_dwordx4 v7, s[4:7], s49 offen offset:1792 nt lds
    v_cvt_pk_bf16_f32 v109, v98, v99
    v_mfma_f32_16x16x32_bf16 v[240:243], v[124:127], v[104:107], v[240:243]
    v_exp_f32 v102, v102
    v_mfma_f32_16x16x32_bf16 a[124:127], v[128:131], v[104:107], a[124:127]
    v_exp_f32 v103, v103
    v_mfma_f32_16x16x32_bf16 a[152:155], v[132:135], v[104:107], a[152:155]
    v_add_f32 v20, v20, v100
    v_add_f32 v21, v21, v101
    v_mfma_f32_16x16x32_bf16 a[180:183], v[136:139], v[104:107], a[180:183]
    v_cvt_pk_bf16_f32 v110, v100, v101
    v_add_f32 v20, v20, v102
    v_mfma_f32_16x16x32_bf16 a[208:211], v[140:143], v[104:107], a[208:211]
    v_add_f32 v21, v21, v103
    v_cvt_pk_bf16_f32 v111, v102, v103
    s_cmp_eq_u32 s68, 0
    s_cbranch_scc1 L_bw1_3682
    s_sub_u32 s68, s68, 1
    s_waitcnt vmcnt(44) lgkmcnt(0)
    s_branch L_bw2_3682
L_bw1_3682:
    s_waitcnt vmcnt(16) lgkmcnt(0)
L_bw2_3682:
    s_barrier
    v_mfma_f32_16x16x32_bf16 v[96:99], v[56:59], a[96:99], v[52:55]
    ds_read_b128 v[56:59], v8 offset:16896
    v_mfma_f32_16x16x32_bf16 v[96:99], v[60:63], a[100:103], v[96:99]
    ds_read_b128 v[60:63], v8 offset:16960
    v_exp_f32 v88, v88
    v_mfma_f32_16x16x32_bf16 v[96:99], v[64:67], a[104:107], v[96:99]
    ds_read_b128 v[64:67], v8 offset:17024
    v_exp_f32 v89, v89
    v_mfma_f32_16x16x32_bf16 v[96:99], v[68:71], a[108:111], v[96:99]
    ds_read_b128 v[68:71], v8 offset:17088
    v_exp_f32 v90, v90
    v_mfma_f32_16x16x32_bf16 v[100:103], v[72:75], a[96:99], v[52:55]
    ds_read_b128 v[72:75], v8 offset:17408
    v_exp_f32 v91, v91
    v_mfma_f32_16x16x32_bf16 v[100:103], v[76:79], a[100:103], v[100:103]
    ds_read_b128 v[76:79], v8 offset:17472
    v_add_f32 v22, v22, v88
    v_add_f32 v23, v23, v89
    v_mfma_f32_16x16x32_bf16 v[100:103], v[80:83], a[104:107], v[100:103]
    ds_read_b128 v[80:83], v8 offset:17536
    v_cvt_pk_bf16_f32 v104, v88, v89
    v_mfma_f32_16x16x32_bf16 v[100:103], v[84:87], a[108:111], v[100:103]
    ds_read_b128 v[84:87], v8 offset:17600
    v_exp_f32 v92, v92
    v_mfma_f32_16x16x32_bf16 v[160:163], v[112:115], v[108:111], v[160:163]
    v_exp_f32 v93, v93
    v_mfma_f32_16x16x32_bf16 v[188:191], v[116:119], v[108:111], v[188:191]
    v_add_f32 v22, v22, v90
    v_add_f32 v23, v23, v91
    v_mfma_f32_16x16x32_bf16 v[216:219], v[120:123], v[108:111], v[216:219]
    v_cvt_pk_bf16_f32 v105, v90, v91
    v_mfma_f32_16x16x32_bf16 v[244:247], v[124:127], v[108:111], v[244:247]
    v_exp_f32 v94, v94
    v_mfma_f32_16x16x32_bf16 a[128:131], v[128:131], v[108:111], a[128:131]
    v_exp_f32 v95, v95
    v_mfma_f32_16x16x32_bf16 a[156:159], v[132:135], v[108:111], a[156:159]
    v_add_f32 v22, v22, v92
    v_add_f32 v23, v23, v93
    v_mfma_f32_16x16x32_bf16 a[184:187], v[136:139], v[108:111], a[184:187]
    v_cvt_pk_bf16_f32 v106, v92, v93
    v_add_f32 v22, v22, v94
    v_mfma_f32_16x16x32_bf16 a[212:215], v[140:143], v[108:111], a[212:215]
    v_add_f32 v23, v23, v95
    v_cvt_pk_bf16_f32 v107, v94, v95
    s_waitcnt lgkmcnt(0)
    v_mfma_f32_16x16x32_bf16 v[88:91], v[56:59], a[0:3], v[28:31]
    v_mfma_f32_16x16x32_bf16 v[88:91], v[60:63], a[4:7], v[88:91]
    v_exp_f32 v96, v96
    v_mfma_f32_16x16x32_bf16 v[88:91], v[64:67], a[8:11], v[88:91]
    v_exp_f32 v97, v97
    v_mfma_f32_16x16x32_bf16 v[88:91], v[68:71], a[12:15], v[88:91]
    v_exp_f32 v98, v98
    v_mfma_f32_16x16x32_bf16 v[92:95], v[72:75], a[0:3], v[28:31]
    v_exp_f32 v99, v99
    v_mfma_f32_16x16x32_bf16 v[92:95], v[76:79], a[4:7], v[92:95]
    v_add_f32 v24, v24, v96
    v_add_f32 v25, v25, v97
    v_mfma_f32_16x16x32_bf16 v[92:95], v[80:83], a[8:11], v[92:95]
    v_cvt_pk_bf16_f32 v108, v96, v97
    v_mfma_f32_16x16x32_bf16 v[92:95], v[84:87], a[12:15], v[92:95]
    v_exp_f32 v100, v100
    v_mfma_f32_16x16x32_bf16 v[164:167], v[112:115], v[104:107], v[164:167]
    v_exp_f32 v101, v101
    v_mfma_f32_16x16x32_bf16 v[192:195], v[116:119], v[104:107], v[192:195]
    v_add_f32 v24, v24, v98
    v_add_f32 v25, v25, v99
    v_mfma_f32_16x16x32_bf16 v[220:223], v[120:123], v[104:107], v[220:223]
    v_cvt_pk_bf16_f32 v109, v98, v99
    v_mfma_f32_16x16x32_bf16 v[248:251], v[124:127], v[104:107], v[248:251]
    v_exp_f32 v102, v102
    v_mfma_f32_16x16x32_bf16 a[132:135], v[128:131], v[104:107], a[132:135]
    v_exp_f32 v103, v103
    v_mfma_f32_16x16x32_bf16 a[160:163], v[132:135], v[104:107], a[160:163]
    v_add_f32 v24, v24, v100
    v_add_f32 v25, v25, v101
    v_mfma_f32_16x16x32_bf16 a[188:191], v[136:139], v[104:107], a[188:191]
    v_cvt_pk_bf16_f32 v110, v100, v101
    v_add_f32 v24, v24, v102
    v_mfma_f32_16x16x32_bf16 a[216:219], v[140:143], v[104:107], a[216:219]
    v_add_f32 v25, v25, v103
    v_cvt_pk_bf16_f32 v111, v102, v103
    v_mfma_f32_16x16x32_bf16 v[96:99], v[56:59], a[16:19], v[32:35]
    v_mfma_f32_16x16x32_bf16 v[96:99], v[60:63], a[20:23], v[96:99]
    v_exp_f32 v88, v88
    v_mfma_f32_16x16x32_bf16 v[96:99], v[64:67], a[24:27], v[96:99]
    v_exp_f32 v89, v89
    v_mfma_f32_16x16x32_bf16 v[96:99], v[68:71], a[28:31], v[96:99]
    v_exp_f32 v90, v90
    v_mfma_f32_16x16x32_bf16 v[100:103], v[72:75], a[16:19], v[32:35]
    v_exp_f32 v91, v91
    v_mfma_f32_16x16x32_bf16 v[100:103], v[76:79], a[20:23], v[100:103]
    v_add_f32 v12, v12, v88
    v_add_f32 v13, v13, v89
    v_mfma_f32_16x16x32_bf16 v[100:103], v[80:83], a[24:27], v[100:103]
    v_cvt_pk_bf16_f32 v104, v88, v89
    v_mfma_f32_16x16x32_bf16 v[100:103], v[84:87], a[28:31], v[100:103]
    v_exp_f32 v92, v92
    v_mfma_f32_16x16x32_bf16 v[168:171], v[112:115], v[108:111], v[168:171]
    ds_read_b64_tr_b16 v[112:113], v9 offset:16896
    ds_read_b64_tr_b16 v[114:115], v9 offset:17408
    v_exp_f32 v93, v93
    v_mfma_f32_16x16x32_bf16 v[196:199], v[116:119], v[108:111], v[196:199]
    ds_read_b64_tr_b16 v[116:117], v9 offset:16928
    ds_read_b64_tr_b16 v[118:119], v9 offset:17440
    v_add_f32 v12, v12, v90
    v_add_f32 v13, v13, v91
    v_mfma_f32_16x16x32_bf16 v[224:227], v[120:123], v[108:111], v[224:227]
    ds_read_b64_tr_b16 v[120:121], v9 offset:16960
    ds_read_b64_tr_b16 v[122:123], v9 offset:17472
    v_cvt_pk_bf16_f32 v105, v90, v91
    v_mfma_f32_16x16x32_bf16 v[252:255], v[124:127], v[108:111], v[252:255]
    ds_read_b64_tr_b16 v[124:125], v9 offset:16992
    ds_read_b64_tr_b16 v[126:127], v9 offset:17504
    v_exp_f32 v94, v94
    v_mfma_f32_16x16x32_bf16 a[136:139], v[128:131], v[108:111], a[136:139]
    ds_read_b64_tr_b16 v[128:129], v9 offset:17024
    ds_read_b64_tr_b16 v[130:131], v9 offset:17536
    v_exp_f32 v95, v95
    v_mfma_f32_16x16x32_bf16 a[164:167], v[132:135], v[108:111], a[164:167]
    ds_read_b64_tr_b16 v[132:133], v9 offset:17056
    ds_read_b64_tr_b16 v[134:135], v9 offset:17568
    v_add_f32 v12, v12, v92
    v_add_f32 v13, v13, v93
    v_mfma_f32_16x16x32_bf16 a[192:195], v[136:139], v[108:111], a[192:195]
    ds_read_b64_tr_b16 v[136:137], v9 offset:17088
    ds_read_b64_tr_b16 v[138:139], v9 offset:17600
    v_cvt_pk_bf16_f32 v106, v92, v93
    v_add_f32 v12, v12, v94
    v_mfma_f32_16x16x32_bf16 a[220:223], v[140:143], v[108:111], a[220:223]
    ds_read_b64_tr_b16 v[140:141], v9 offset:17120
    ds_read_b64_tr_b16 v[142:143], v9 offset:17632
    v_add_f32 v13, v13, v95
    v_cvt_pk_bf16_f32 v107, v94, v95
    v_mfma_f32_16x16x32_bf16 v[88:91], v[56:59], a[32:35], v[36:39]
    v_mfma_f32_16x16x32_bf16 v[88:91], v[60:63], a[36:39], v[88:91]
    s_add_u32 s29, s34, s100
    v_exp_f32 v96, v96
    v_mfma_f32_16x16x32_bf16 v[88:91], v[64:67], a[40:43], v[88:91]
    v_exp_f32 v97, v97
    v_mfma_f32_16x16x32_bf16 v[88:91], v[68:71], a[44:47], v[88:91]
    s_bfe_u32 s28, s29, 0x20003
    v_exp_f32 v98, v98
    v_mfma_f32_16x16x32_bf16 v[92:95], v[72:75], a[32:35], v[36:39]
    v_exp_f32 v99, v99
    v_mfma_f32_16x16x32_bf16 v[92:95], v[76:79], a[36:39], v[92:95]
    s_lshl_b32 s28, s28, 16
    v_add_f32 v14, v14, v96
    v_add_f32 v15, v15, v97
    v_mfma_f32_16x16x32_bf16 v[92:95], v[80:83], a[40:43], v[92:95]
    v_cvt_pk_bf16_f32 v108, v96, v97
    v_mfma_f32_16x16x32_bf16 v[92:95], v[84:87], a[44:47], v[92:95]
    v_exp_f32 v100, v100
    s_waitcnt lgkmcnt(0)
    v_mfma_f32_16x16x32_bf16 v[144:147], v[112:115], v[104:107], v[144:147]
    s_and_b32 s29, s29, 7
    v_exp_f32 v101, v101
    v_mfma_f32_16x16x32_bf16 v[172:175], v[116:119], v[104:107], v[172:175]
    v_add_f32 v14, v14, v98
    v_add_f32 v15, v15, v99
    v_mfma_f32_16x16x32_bf16 v[200:203], v[120:123], v[104:107], v[200:203]
    s_lshl_b32 s29, s29, 11
    v_cvt_pk_bf16_f32 v109, v98, v99
    v_mfma_f32_16x16x32_bf16 v[228:231], v[124:127], v[104:107], v[228:231]
    v_exp_f32 v102, v102
    v_mfma_f32_16x16x32_bf16 a[112:115], v[128:131], v[104:107], a[112:115]
    s_add_u32 s29, s28, s29
    v_exp_f32 v103, v103
    v_mfma_f32_16x16x32_bf16 a[140:143], v[132:135], v[104:107], a[140:143]
    v_add_f32 v14, v14, v100
    v_add_f32 v15, v15, v101
    v_mfma_f32_16x16x32_bf16 a[168:171], v[136:139], v[104:107], a[168:171]
    s_lshr_b32 s28, s34, 5
    v_cvt_pk_bf16_f32 v110, v100, v101
    v_add_f32 v14, v14, v102
    v_mfma_f32_16x16x32_bf16 a[196:199], v[140:143], v[104:107], a[196:199]
    v_add_f32 v15, v15, v103
    v_cvt_pk_bf16_f32 v111, v102, v103
    v_mfma_f32_16x16x32_bf16 v[96:99], v[56:59], a[48:51], v[40:43]
    v_mfma_f32_16x16x32_bf16 v[96:99], v[60:63], a[52:55], v[96:99]
    s_lshl_b32 s28, s28, 19
    v_exp_f32 v88, v88
    v_mfma_f32_16x16x32_bf16 v[96:99], v[64:67], a[56:59], v[96:99]
    v_exp_f32 v89, v89
    v_mfma_f32_16x16x32_bf16 v[96:99], v[68:71], a[60:63], v[96:99]
    s_add_u32 s49, s28, s29
    v_exp_f32 v90, v90
    v_mfma_f32_16x16x32_bf16 v[100:103], v[72:75], a[48:51], v[40:43]
    v_exp_f32 v91, v91
    v_mfma_f32_16x16x32_bf16 v[100:103], v[76:79], a[52:55], v[100:103]
    s_add_u32 m0, s33, 8448
    v_add_f32 v16, v16, v88
    v_add_f32 v17, v17, v89
    v_mfma_f32_16x16x32_bf16 v[100:103], v[80:83], a[56:59], v[100:103]
    v_cvt_pk_bf16_f32 v104, v88, v89
    v_mfma_f32_16x16x32_bf16 v[100:103], v[84:87], a[60:63], v[100:103]
    v_exp_f32 v92, v92
    v_mfma_f32_16x16x32_bf16 v[148:151], v[112:115], v[108:111], v[148:151]
    s_add_u32 s34, s34, 1
    v_exp_f32 v93, v93
    v_mfma_f32_16x16x32_bf16 v[176:179], v[116:119], v[108:111], v[176:179]
    v_add_f32 v16, v16, v90
    v_add_f32 v17, v17, v91
    v_mfma_f32_16x16x32_bf16 v[204:207], v[120:123], v[108:111], v[204:207]
    buffer_load_dwordx4 v7, s[4:7], s49 offen offset:0 nt lds
    v_cvt_pk_bf16_f32 v105, v90, v91
    v_mfma_f32_16x16x32_bf16 v[232:235], v[124:127], v[108:111], v[232:235]
    v_exp_f32 v94, v94
    v_mfma_f32_16x16x32_bf16 a[116:119], v[128:131], v[108:111], a[116:119]
    s_add_u32 m0, m0, s96
    v_exp_f32 v95, v95
    v_mfma_f32_16x16x32_bf16 a[144:147], v[132:135], v[108:111], a[144:147]
    v_add_f32 v16, v16, v92
    v_add_f32 v17, v17, v93
    v_mfma_f32_16x16x32_bf16 a[172:175], v[136:139], v[108:111], a[172:175]
    buffer_load_dwordx4 v7, s[4:7], s49 offen offset:256 nt lds
    v_cvt_pk_bf16_f32 v106, v92, v93
    v_add_f32 v16, v16, v94
    v_mfma_f32_16x16x32_bf16 a[200:203], v[140:143], v[108:111], a[200:203]
    v_add_f32 v17, v17, v95
    v_cvt_pk_bf16_f32 v107, v94, v95
    v_mfma_f32_16x16x32_bf16 v[88:91], v[56:59], a[64:67], v[44:47]
    v_mfma_f32_16x16x32_bf16 v[88:91], v[60:63], a[68:71], v[88:91]
    s_add_u32 m0, m0, s97
    v_exp_f32 v96, v96
    v_mfma_f32_16x16x32_bf16 v[88:91], v[64:67], a[72:75], v[88:91]
    v_exp_f32 v97, v97
    v_mfma_f32_16x16x32_bf16 v[88:91], v[68:71], a[76:79], v[88:91]
    buffer_load_dwordx4 v7, s[4:7], s49 offen offset:512 nt lds
    v_exp_f32 v98, v98
    v_mfma_f32_16x16x32_bf16 v[92:95], v[72:75], a[64:67], v[44:47]
    v_exp_f32 v99, v99
    v_mfma_f32_16x16x32_bf16 v[92:95], v[76:79], a[68:71], v[92:95]
    s_add_u32 m0, m0, s96
    v_add_f32 v18, v18, v96
    v_add_f32 v19, v19, v97
    v_mfma_f32_16x16x32_bf16 v[92:95], v[80:83], a[72:75], v[92:95]
    v_cvt_pk_bf16_f32 v108, v96, v97
    v_mfma_f32_16x16x32_bf16 v[92:95], v[84:87], a[76:79], v[92:95]
    v_exp_f32 v100, v100
    v_mfma_f32_16x16x32_bf16 v[152:155], v[112:115], v[104:107], v[152:155]
    buffer_load_dwordx4 v7, s[4:7], s49 offen offset:768 nt lds
    v_exp_f32 v101, v101
    v_mfma_f32_16x16x32_bf16 v[180:183], v[116:119], v[104:107], v[180:183]
    v_add_f32 v18, v18, v98
    v_add_f32 v19, v19, v99
    v_mfma_f32_16x16x32_bf16 v[208:211], v[120:123], v[104:107], v[208:211]
    s_add_u32 m0, m0, s97
    v_cvt_pk_bf16_f32 v109, v98, v99
    v_mfma_f32_16x16x32_bf16 v[236:239], v[124:127], v[104:107], v[236:239]
    v_exp_f32 v102, v102
    v_mfma_f32_16x16x32_bf16 a[120:123], v[128:131], v[104:107], a[120:123]
    buffer_load_dwordx4 v7, s[4:7], s49 offen offset:1024 nt lds
    v_exp_f32 v103, v103
    v_mfma_f32_16x16x32_bf16 a[148:151], v[132:135], v[104:107], a[148:151]
    v_add_f32 v18, v18, v100
    v_add_f32 v19, v19, v101
    v_mfma_f32_16x16x32_bf16 a[176:179], v[136:139], v[104:107], a[176:179]
    s_add_u32 m0, m0, s96
    v_cvt_pk_bf16_f32 v110, v100, v101
    v_add_f32 v18, v18, v102
    v_mfma_f32_16x16x32_bf16 a[204:207], v[140:143], v[104:107], a[204:207]
    v_add_f32 v19, v19, v103
    v_cvt_pk_bf16_f32 v111, v102, v103
    v_mfma_f32_16x16x32_bf16 v[96:99], v[56:59], a[80:83], v[48:51]
    v_mfma_f32_16x16x32_bf16 v[96:99], v[60:63], a[84:87], v[96:99]
    buffer_load_dwordx4 v7, s[4:7], s49 offen offset:1280 nt lds
    v_exp_f32 v88, v88
    v_mfma_f32_16x16x32_bf16 v[96:99], v[64:67], a[88:91], v[96:99]
    v_exp_f32 v89, v89
    v_mfma_f32_16x16x32_bf16 v[96:99], v[68:71], a[92:95], v[96:99]
    s_add_u32 m0, m0, s97
    v_exp_f32 v90, v90
    v_mfma_f32_16x16x32_bf16 v[100:103], v[72:75], a[80:83], v[48:51]
    v_exp_f32 v91, v91
    v_mfma_f32_16x16x32_bf16 v[100:103], v[76:79], a[84:87], v[100:103]
    buffer_load_dwordx4 v7, s[4:7], s49 offen offset:1536 nt lds
    v_add_f32 v20, v20, v88
    v_add_f32 v21, v21, v89
    v_mfma_f32_16x16x32_bf16 v[100:103], v[80:83], a[88:91], v[100:103]
    v_cvt_pk_bf16_f32 v104, v88, v89
    v_mfma_f32_16x16x32_bf16 v[100:103], v[84:87], a[92:95], v[100:103]
    v_exp_f32 v92, v92
    v_mfma_f32_16x16x32_bf16 v[156:159], v[112:115], v[108:111], v[156:159]
    s_add_u32 m0, m0, s96
    v_exp_f32 v93, v93
    v_mfma_f32_16x16x32_bf16 v[184:187], v[116:119], v[108:111], v[184:187]
    v_add_f32 v20, v20, v90
    v_add_f32 v21, v21, v91
    v_mfma_f32_16x16x32_bf16 v[212:215], v[120:123], v[108:111], v[212:215]
    buffer_load_dwordx4 v7, s[4:7], s49 offen offset:1792 nt lds
    v_cvt_pk_bf16_f32 v105, v90, v91
    v_mfma_f32_16x16x32_bf16 v[240:243], v[124:127], v[108:111], v[240:243]
    v_exp_f32 v94, v94
    v_mfma_f32_16x16x32_bf16 a[124:127], v[128:131], v[108:111], a[124:127]
    v_exp_f32 v95, v95
    v_mfma_f32_16x16x32_bf16 a[152:155], v[132:135], v[108:111], a[152:155]
    v_add_f32 v20, v20, v92
    v_add_f32 v21, v21, v93
    v_mfma_f32_16x16x32_bf16 a[180:183], v[136:139], v[108:111], a[180:183]
    v_cvt_pk_bf16_f32 v106, v92, v93
    v_add_f32 v20, v20, v94
    v_mfma_f32_16x16x32_bf16 a[208:211], v[140:143], v[108:111], a[208:211]
    v_add_f32 v21, v21, v95
    v_cvt_pk_bf16_f32 v107, v94, v95
    s_cmp_eq_u32 s68, 0
    s_cbranch_scc1 L_bw1_3995
    s_sub_u32 s68, s68, 1
    s_waitcnt vmcnt(44) lgkmcnt(0)
    s_branch L_bw2_3995
L_bw1_3995:
    s_waitcnt vmcnt(16) lgkmcnt(0)
L_bw2_3995:
    s_barrier
    v_mfma_f32_16x16x32_bf16 v[88:91], v[56:59], a[96:99], v[52:55]
    ds_read_b128 v[56:59], v8 offset:25344
    v_mfma_f32_16x16x32_bf16 v[88:91], v[60:63], a[100:103], v[88:91]
    ds_read_b128 v[60:63], v8 offset:25408
    v_exp_f32 v96, v96
    v_mfma_f32_16x16x32_bf16 v[88:91], v[64:67], a[104:107], v[88:91]
    ds_read_b128 v[64:67], v8 offset:25472
    v_exp_f32 v97, v97
    v_mfma_f32_16x16x32_bf16 v[88:91], v[68:71], a[108:111], v[88:91]
    ds_read_b128 v[68:71], v8 offset:25536
    v_exp_f32 v98, v98
    v_mfma_f32_16x16x32_bf16 v[92:95], v[72:75], a[96:99], v[52:55]
    ds_read_b128 v[72:75], v8 offset:25856
    v_exp_f32 v99, v99
    v_mfma_f32_16x16x32_bf16 v[92:95], v[76:79], a[100:103], v[92:95]
    ds_read_b128 v[76:79], v8 offset:25920
    v_add_f32 v22, v22, v96
    v_add_f32 v23, v23, v97
    v_mfma_f32_16x16x32_bf16 v[92:95], v[80:83], a[104:107], v[92:95]
    ds_read_b128 v[80:83], v8 offset:25984
    v_cvt_pk_bf16_f32 v108, v96, v97
    v_mfma_f32_16x16x32_bf16 v[92:95], v[84:87], a[108:111], v[92:95]
    ds_read_b128 v[84:87], v8 offset:26048
    v_exp_f32 v100, v100
    v_mfma_f32_16x16x32_bf16 v[160:163], v[112:115], v[104:107], v[160:163]
    v_exp_f32 v101, v101
    v_mfma_f32_16x16x32_bf16 v[188:191], v[116:119], v[104:107], v[188:191]
    v_add_f32 v22, v22, v98
    v_add_f32 v23, v23, v99
    v_mfma_f32_16x16x32_bf16 v[216:219], v[120:123], v[104:107], v[216:219]
    v_cvt_pk_bf16_f32 v109, v98, v99
    v_mfma_f32_16x16x32_bf16 v[244:247], v[124:127], v[104:107], v[244:247]
    v_exp_f32 v102, v102
    v_mfma_f32_16x16x32_bf16 a[128:131], v[128:131], v[104:107], a[128:131]
    v_exp_f32 v103, v103
    v_mfma_f32_16x16x32_bf16 a[156:159], v[132:135], v[104:107], a[156:159]
    v_add_f32 v22, v22, v100
    v_add_f32 v23, v23, v101
    v_mfma_f32_16x16x32_bf16 a[184:187], v[136:139], v[104:107], a[184:187]
    v_cvt_pk_bf16_f32 v110, v100, v101
    v_add_f32 v22, v22, v102
    v_mfma_f32_16x16x32_bf16 a[212:215], v[140:143], v[104:107], a[212:215]
    v_add_f32 v23, v23, v103
    v_cvt_pk_bf16_f32 v111, v102, v103
    s_waitcnt lgkmcnt(0)
    v_mfma_f32_16x16x32_bf16 v[96:99], v[56:59], a[0:3], v[28:31]
    v_mfma_f32_16x16x32_bf16 v[96:99], v[60:63], a[4:7], v[96:99]
    v_exp_f32 v88, v88
    v_mfma_f32_16x16x32_bf16 v[96:99], v[64:67], a[8:11], v[96:99]
    v_exp_f32 v89, v89
    v_mfma_f32_16x16x32_bf16 v[96:99], v[68:71], a[12:15], v[96:99]
    v_exp_f32 v90, v90
    v_mfma_f32_16x16x32_bf16 v[100:103], v[72:75], a[0:3], v[28:31]
    v_exp_f32 v91, v91
    v_mfma_f32_16x16x32_bf16 v[100:103], v[76:79], a[4:7], v[100:103]
    v_add_f32 v24, v24, v88
    v_add_f32 v25, v25, v89
    v_mfma_f32_16x16x32_bf16 v[100:103], v[80:83], a[8:11], v[100:103]
    v_cvt_pk_bf16_f32 v104, v88, v89
    v_mfma_f32_16x16x32_bf16 v[100:103], v[84:87], a[12:15], v[100:103]
    v_exp_f32 v92, v92
    v_mfma_f32_16x16x32_bf16 v[164:167], v[112:115], v[108:111], v[164:167]
    v_exp_f32 v93, v93
    v_mfma_f32_16x16x32_bf16 v[192:195], v[116:119], v[108:111], v[192:195]
    v_add_f32 v24, v24, v90
    v_add_f32 v25, v25, v91
    v_mfma_f32_16x16x32_bf16 v[220:223], v[120:123], v[108:111], v[220:223]
    v_cvt_pk_bf16_f32 v105, v90, v91
    v_mfma_f32_16x16x32_bf16 v[248:251], v[124:127], v[108:111], v[248:251]
    v_exp_f32 v94, v94
    v_mfma_f32_16x16x32_bf16 a[132:135], v[128:131], v[108:111], a[132:135]
    v_exp_f32 v95, v95
    v_mfma_f32_16x16x32_bf16 a[160:163], v[132:135], v[108:111], a[160:163]
    v_add_f32 v24, v24, v92
    v_add_f32 v25, v25, v93
    v_mfma_f32_16x16x32_bf16 a[188:191], v[136:139], v[108:111], a[188:191]
    v_cvt_pk_bf16_f32 v106, v92, v93
    v_add_f32 v24, v24, v94
    v_mfma_f32_16x16x32_bf16 a[216:219], v[140:143], v[108:111], a[216:219]
    v_add_f32 v25, v25, v95
    v_cvt_pk_bf16_f32 v107, v94, v95
    v_mfma_f32_16x16x32_bf16 v[88:91], v[56:59], a[16:19], v[32:35]
    v_mfma_f32_16x16x32_bf16 v[88:91], v[60:63], a[20:23], v[88:91]
    v_exp_f32 v96, v96
    v_mfma_f32_16x16x32_bf16 v[88:91], v[64:67], a[24:27], v[88:91]
    v_exp_f32 v97, v97
    v_mfma_f32_16x16x32_bf16 v[88:91], v[68:71], a[28:31], v[88:91]
    v_exp_f32 v98, v98
    v_mfma_f32_16x16x32_bf16 v[92:95], v[72:75], a[16:19], v[32:35]
    v_exp_f32 v99, v99
    v_mfma_f32_16x16x32_bf16 v[92:95], v[76:79], a[20:23], v[92:95]
    v_add_f32 v12, v12, v96
    v_add_f32 v13, v13, v97
    v_mfma_f32_16x16x32_bf16 v[92:95], v[80:83], a[24:27], v[92:95]
    v_cvt_pk_bf16_f32 v108, v96, v97
    v_mfma_f32_16x16x32_bf16 v[92:95], v[84:87], a[28:31], v[92:95]
    v_exp_f32 v100, v100
    v_mfma_f32_16x16x32_bf16 v[168:171], v[112:115], v[104:107], v[168:171]
    ds_read_b64_tr_b16 v[112:113], v9 offset:25344
    ds_read_b64_tr_b16 v[114:115], v9 offset:25856
    v_exp_f32 v101, v101
    v_mfma_f32_16x16x32_bf16 v[196:199], v[116:119], v[104:107], v[196:199]
    ds_read_b64_tr_b16 v[116:117], v9 offset:25376
    ds_read_b64_tr_b16 v[118:119], v9 offset:25888
    v_add_f32 v12, v12, v98
    v_add_f32 v13, v13, v99
    v_mfma_f32_16x16x32_bf16 v[224:227], v[120:123], v[104:107], v[224:227]
    ds_read_b64_tr_b16 v[120:121], v9 offset:25408
    ds_read_b64_tr_b16 v[122:123], v9 offset:25920
    v_cvt_pk_bf16_f32 v109, v98, v99
    v_mfma_f32_16x16x32_bf16 v[252:255], v[124:127], v[104:107], v[252:255]
    ds_read_b64_tr_b16 v[124:125], v9 offset:25440
    ds_read_b64_tr_b16 v[126:127], v9 offset:25952
    v_exp_f32 v102, v102
    v_mfma_f32_16x16x32_bf16 a[136:139], v[128:131], v[104:107], a[136:139]
    ds_read_b64_tr_b16 v[128:129], v9 offset:25472
    ds_read_b64_tr_b16 v[130:131], v9 offset:25984
    v_exp_f32 v103, v103
    v_mfma_f32_16x16x32_bf16 a[164:167], v[132:135], v[104:107], a[164:167]
    ds_read_b64_tr_b16 v[132:133], v9 offset:25504
    ds_read_b64_tr_b16 v[134:135], v9 offset:26016
    v_add_f32 v12, v12, v100
    v_add_f32 v13, v13, v101
    v_mfma_f32_16x16x32_bf16 a[192:195], v[136:139], v[104:107], a[192:195]
    ds_read_b64_tr_b16 v[136:137], v9 offset:25536
    ds_read_b64_tr_b16 v[138:139], v9 offset:26048
    v_cvt_pk_bf16_f32 v110, v100, v101
    v_add_f32 v12, v12, v102
    v_mfma_f32_16x16x32_bf16 a[220:223], v[140:143], v[104:107], a[220:223]
    ds_read_b64_tr_b16 v[140:141], v9 offset:25568
    ds_read_b64_tr_b16 v[142:143], v9 offset:26080
    v_add_f32 v13, v13, v103
    v_cvt_pk_bf16_f32 v111, v102, v103
    v_mfma_f32_16x16x32_bf16 v[96:99], v[56:59], a[32:35], v[36:39]
    v_mfma_f32_16x16x32_bf16 v[96:99], v[60:63], a[36:39], v[96:99]
    s_add_u32 s29, s34, s100
    v_exp_f32 v88, v88
    v_mfma_f32_16x16x32_bf16 v[96:99], v[64:67], a[40:43], v[96:99]
    v_exp_f32 v89, v89
    v_mfma_f32_16x16x32_bf16 v[96:99], v[68:71], a[44:47], v[96:99]
    s_bfe_u32 s28, s29, 0x20003
    v_exp_f32 v90, v90
    v_mfma_f32_16x16x32_bf16 v[100:103], v[72:75], a[32:35], v[36:39]
    v_exp_f32 v91, v91
    v_mfma_f32_16x16x32_bf16 v[100:103], v[76:79], a[36:39], v[100:103]
    s_lshl_b32 s28, s28, 16
    v_add_f32 v14, v14, v88
    v_add_f32 v15, v15, v89
    v_mfma_f32_16x16x32_bf16 v[100:103], v[80:83], a[40:43], v[100:103]
    v_cvt_pk_bf16_f32 v104, v88, v89
    v_mfma_f32_16x16x32_bf16 v[100:103], v[84:87], a[44:47], v[100:103]
    v_exp_f32 v92, v92
    s_waitcnt lgkmcnt(0)
    v_mfma_f32_16x16x32_bf16 v[144:147], v[112:115], v[108:111], v[144:147]
    s_and_b32 s29, s29, 7
    v_exp_f32 v93, v93
    v_mfma_f32_16x16x32_bf16 v[172:175], v[116:119], v[108:111], v[172:175]
    v_add_f32 v14, v14, v90
    v_add_f32 v15, v15, v91
    v_mfma_f32_16x16x32_bf16 v[200:203], v[120:123], v[108:111], v[200:203]
    s_lshl_b32 s29, s29, 11
    v_cvt_pk_bf16_f32 v105, v90, v91
    v_mfma_f32_16x16x32_bf16 v[228:231], v[124:127], v[108:111], v[228:231]
    v_exp_f32 v94, v94
    v_mfma_f32_16x16x32_bf16 a[112:115], v[128:131], v[108:111], a[112:115]
    s_add_u32 s29, s28, s29
    v_exp_f32 v95, v95
    v_mfma_f32_16x16x32_bf16 a[140:143], v[132:135], v[108:111], a[140:143]
    v_add_f32 v14, v14, v92
    v_add_f32 v15, v15, v93
    v_mfma_f32_16x16x32_bf16 a[168:171], v[136:139], v[108:111], a[168:171]
    s_lshr_b32 s28, s34, 5
    v_cvt_pk_bf16_f32 v106, v92, v93
    v_add_f32 v14, v14, v94
    v_mfma_f32_16x16x32_bf16 a[196:199], v[140:143], v[108:111], a[196:199]
    v_add_f32 v15, v15, v95
    v_cvt_pk_bf16_f32 v107, v94, v95
    v_mfma_f32_16x16x32_bf16 v[88:91], v[56:59], a[48:51], v[40:43]
    v_mfma_f32_16x16x32_bf16 v[88:91], v[60:63], a[52:55], v[88:91]
    s_lshl_b32 s28, s28, 19
    v_exp_f32 v96, v96
    v_mfma_f32_16x16x32_bf16 v[88:91], v[64:67], a[56:59], v[88:91]
    v_exp_f32 v97, v97
    v_mfma_f32_16x16x32_bf16 v[88:91], v[68:71], a[60:63], v[88:91]
    s_add_u32 s49, s28, s29
    v_exp_f32 v98, v98
    v_mfma_f32_16x16x32_bf16 v[92:95], v[72:75], a[48:51], v[40:43]
    v_exp_f32 v99, v99
    v_mfma_f32_16x16x32_bf16 v[92:95], v[76:79], a[52:55], v[92:95]
    s_add_u32 m0, s33, 16896
    v_add_f32 v16, v16, v96
    v_add_f32 v17, v17, v97
    v_mfma_f32_16x16x32_bf16 v[92:95], v[80:83], a[56:59], v[92:95]
    v_cvt_pk_bf16_f32 v108, v96, v97
    v_mfma_f32_16x16x32_bf16 v[92:95], v[84:87], a[60:63], v[92:95]
    v_exp_f32 v100, v100
    v_mfma_f32_16x16x32_bf16 v[148:151], v[112:115], v[104:107], v[148:151]
    s_add_u32 s34, s34, 1
    v_exp_f32 v101, v101
    v_mfma_f32_16x16x32_bf16 v[176:179], v[116:119], v[104:107], v[176:179]
    v_add_f32 v16, v16, v98
    v_add_f32 v17, v17, v99
    v_mfma_f32_16x16x32_bf16 v[204:207], v[120:123], v[104:107], v[204:207]
    buffer_load_dwordx4 v7, s[4:7], s49 offen offset:0 nt lds
    v_cvt_pk_bf16_f32 v109, v98, v99
    v_mfma_f32_16x16x32_bf16 v[232:235], v[124:127], v[104:107], v[232:235]
    v_exp_f32 v102, v102
    v_mfma_f32_16x16x32_bf16 a[116:119], v[128:131], v[104:107], a[116:119]
    s_add_u32 m0, m0, s96
    v_exp_f32 v103, v103
    v_mfma_f32_16x16x32_bf16 a[144:147], v[132:135], v[104:107], a[144:147]
    v_add_f32 v16, v16, v100
    v_add_f32 v17, v17, v101
    v_mfma_f32_16x16x32_bf16 a[172:175], v[136:139], v[104:107], a[172:175]
    buffer_load_dwordx4 v7, s[4:7], s49 offen offset:256 nt lds
    v_cvt_pk_bf16_f32 v110, v100, v101
    v_add_f32 v16, v16, v102
    v_mfma_f32_16x16x32_bf16 a[200:203], v[140:143], v[104:107], a[200:203]
    v_add_f32 v17, v17, v103
    v_cvt_pk_bf16_f32 v111, v102, v103
    v_mfma_f32_16x16x32_bf16 v[96:99], v[56:59], a[64:67], v[44:47]
    v_mfma_f32_16x16x32_bf16 v[96:99], v[60:63], a[68:71], v[96:99]
    s_add_u32 m0, m0, s97
    v_exp_f32 v88, v88
    v_mfma_f32_16x16x32_bf16 v[96:99], v[64:67], a[72:75], v[96:99]
    v_exp_f32 v89, v89
    v_mfma_f32_16x16x32_bf16 v[96:99], v[68:71], a[76:79], v[96:99]
    buffer_load_dwordx4 v7, s[4:7], s49 offen offset:512 nt lds
    v_exp_f32 v90, v90
    v_mfma_f32_16x16x32_bf16 v[100:103], v[72:75], a[64:67], v[44:47]
    v_exp_f32 v91, v91
    v_mfma_f32_16x16x32_bf16 v[100:103], v[76:79], a[68:71], v[100:103]
    s_add_u32 m0, m0, s96
    v_add_f32 v18, v18, v88
    v_add_f32 v19, v19, v89
    v_mfma_f32_16x16x32_bf16 v[100:103], v[80:83], a[72:75], v[100:103]
    v_cvt_pk_bf16_f32 v104, v88, v89
    v_mfma_f32_16x16x32_bf16 v[100:103], v[84:87], a[76:79], v[100:103]
    v_exp_f32 v92, v92
    v_mfma_f32_16x16x32_bf16 v[152:155], v[112:115], v[108:111], v[152:155]
    buffer_load_dwordx4 v7, s[4:7], s49 offen offset:768 nt lds
    v_exp_f32 v93, v93
    v_mfma_f32_16x16x32_bf16 v[180:183], v[116:119], v[108:111], v[180:183]
    v_add_f32 v18, v18, v90
    v_add_f32 v19, v19, v91
    v_mfma_f32_16x16x32_bf16 v[208:211], v[120:123], v[108:111], v[208:211]
    s_add_u32 m0, m0, s97
    v_cvt_pk_bf16_f32 v105, v90, v91
    v_mfma_f32_16x16x32_bf16 v[236:239], v[124:127], v[108:111], v[236:239]
    v_exp_f32 v94, v94
    v_mfma_f32_16x16x32_bf16 a[120:123], v[128:131], v[108:111], a[120:123]
    buffer_load_dwordx4 v7, s[4:7], s49 offen offset:1024 nt lds
    v_exp_f32 v95, v95
    v_mfma_f32_16x16x32_bf16 a[148:151], v[132:135], v[108:111], a[148:151]
    v_add_f32 v18, v18, v92
    v_add_f32 v19, v19, v93
    v_mfma_f32_16x16x32_bf16 a[176:179], v[136:139], v[108:111], a[176:179]
    s_add_u32 m0, m0, s96
    v_cvt_pk_bf16_f32 v106, v92, v93
    v_add_f32 v18, v18, v94
    v_mfma_f32_16x16x32_bf16 a[204:207], v[140:143], v[108:111], a[204:207]
    v_add_f32 v19, v19, v95
    v_cvt_pk_bf16_f32 v107, v94, v95
    v_mfma_f32_16x16x32_bf16 v[88:91], v[56:59], a[80:83], v[48:51]
    v_mfma_f32_16x16x32_bf16 v[88:91], v[60:63], a[84:87], v[88:91]
    buffer_load_dwordx4 v7, s[4:7], s49 offen offset:1280 nt lds
    v_exp_f32 v96, v96
    v_mfma_f32_16x16x32_bf16 v[88:91], v[64:67], a[88:91], v[88:91]
    v_exp_f32 v97, v97
    v_mfma_f32_16x16x32_bf16 v[88:91], v[68:71], a[92:95], v[88:91]
    s_add_u32 m0, m0, s97
    v_exp_f32 v98, v98
    v_mfma_f32_16x16x32_bf16 v[92:95], v[72:75], a[80:83], v[48:51]
    v_exp_f32 v99, v99
    v_mfma_f32_16x16x32_bf16 v[92:95], v[76:79], a[84:87], v[92:95]
    buffer_load_dwordx4 v7, s[4:7], s49 offen offset:1536 nt lds
    v_add_f32 v20, v20, v96
    v_add_f32 v21, v21, v97
    v_mfma_f32_16x16x32_bf16 v[92:95], v[80:83], a[88:91], v[92:95]
    v_cvt_pk_bf16_f32 v108, v96, v97
    v_mfma_f32_16x16x32_bf16 v[92:95], v[84:87], a[92:95], v[92:95]
    v_exp_f32 v100, v100
    v_mfma_f32_16x16x32_bf16 v[156:159], v[112:115], v[104:107], v[156:159]
    s_add_u32 m0, m0, s96
    v_exp_f32 v101, v101
    v_mfma_f32_16x16x32_bf16 v[184:187], v[116:119], v[104:107], v[184:187]
    v_add_f32 v20, v20, v98
    v_add_f32 v21, v21, v99
    v_mfma_f32_16x16x32_bf16 v[212:215], v[120:123], v[104:107], v[212:215]
    buffer_load_dwordx4 v7, s[4:7], s49 offen offset:1792 nt lds
    v_cvt_pk_bf16_f32 v109, v98, v99
    v_mfma_f32_16x16x32_bf16 v[240:243], v[124:127], v[104:107], v[240:243]
    v_exp_f32 v102, v102
    v_mfma_f32_16x16x32_bf16 a[124:127], v[128:131], v[104:107], a[124:127]
    v_exp_f32 v103, v103
    v_mfma_f32_16x16x32_bf16 a[152:155], v[132:135], v[104:107], a[152:155]
    v_add_f32 v20, v20, v100
    v_add_f32 v21, v21, v101
    v_mfma_f32_16x16x32_bf16 a[180:183], v[136:139], v[104:107], a[180:183]
    v_cvt_pk_bf16_f32 v110, v100, v101
    v_add_f32 v20, v20, v102
    v_mfma_f32_16x16x32_bf16 a[208:211], v[140:143], v[104:107], a[208:211]
    v_add_f32 v21, v21, v103
    v_cvt_pk_bf16_f32 v111, v102, v103
    s_waitcnt vmcnt(16) lgkmcnt(0)
    s_barrier
    v_mfma_f32_16x16x32_bf16 v[96:99], v[56:59], a[96:99], v[52:55]
    ds_read_b128 v[56:59], v8 offset:0
    v_mfma_f32_16x16x32_bf16 v[96:99], v[60:63], a[100:103], v[96:99]
    ds_read_b128 v[60:63], v8 offset:64
    v_exp_f32 v88, v88
    v_mfma_f32_16x16x32_bf16 v[96:99], v[64:67], a[104:107], v[96:99]
    ds_read_b128 v[64:67], v8 offset:128
    v_exp_f32 v89, v89
    v_mfma_f32_16x16x32_bf16 v[96:99], v[68:71], a[108:111], v[96:99]
    ds_read_b128 v[68:71], v8 offset:192
    v_exp_f32 v90, v90
    v_mfma_f32_16x16x32_bf16 v[100:103], v[72:75], a[96:99], v[52:55]
    ds_read_b128 v[72:75], v8 offset:512
    v_exp_f32 v91, v91
    v_mfma_f32_16x16x32_bf16 v[100:103], v[76:79], a[100:103], v[100:103]
    ds_read_b128 v[76:79], v8 offset:576
    v_add_f32 v22, v22, v88
    v_add_f32 v23, v23, v89
    v_mfma_f32_16x16x32_bf16 v[100:103], v[80:83], a[104:107], v[100:103]
    ds_read_b128 v[80:83], v8 offset:640
    v_cvt_pk_bf16_f32 v104, v88, v89
    v_mfma_f32_16x16x32_bf16 v[100:103], v[84:87], a[108:111], v[100:103]
    ds_read_b128 v[84:87], v8 offset:704
    v_exp_f32 v92, v92
    v_mfma_f32_16x16x32_bf16 v[160:163], v[112:115], v[108:111], v[160:163]
    v_exp_f32 v93, v93
    v_mfma_f32_16x16x32_bf16 v[188:191], v[116:119], v[108:111], v[188:191]
    v_add_f32 v22, v22, v90
    v_add_f32 v23, v23, v91
    v_mfma_f32_16x16x32_bf16 v[216:219], v[120:123], v[108:111], v[216:219]
    v_cvt_pk_bf16_f32 v105, v90, v91
    v_mfma_f32_16x16x32_bf16 v[244:247], v[124:127], v[108:111], v[244:247]
    v_exp_f32 v94, v94
    v_mfma_f32_16x16x32_bf16 a[128:131], v[128:131], v[108:111], a[128:131]
    v_exp_f32 v95, v95
    v_mfma_f32_16x16x32_bf16 a[156:159], v[132:135], v[108:111], a[156:159]
    v_add_f32 v22, v22, v92
    v_add_f32 v23, v23, v93
    v_mfma_f32_16x16x32_bf16 a[184:187], v[136:139], v[108:111], a[184:187]
    v_cvt_pk_bf16_f32 v106, v92, v93
    v_add_f32 v22, v22, v94
    v_mfma_f32_16x16x32_bf16 a[212:215], v[140:143], v[108:111], a[212:215]
    v_add_f32 v23, v23, v95
    v_cvt_pk_bf16_f32 v107, v94, v95
    s_waitcnt lgkmcnt(0)
    v_mfma_f32_16x16x32_bf16 v[88:91], v[56:59], a[0:3], v[28:31]
    v_mfma_f32_16x16x32_bf16 v[88:91], v[60:63], a[4:7], v[88:91]
    v_exp_f32 v96, v96
    v_mfma_f32_16x16x32_bf16 v[88:91], v[64:67], a[8:11], v[88:91]
    v_exp_f32 v97, v97
    v_mfma_f32_16x16x32_bf16 v[88:91], v[68:71], a[12:15], v[88:91]
    v_exp_f32 v98, v98
    v_mfma_f32_16x16x32_bf16 v[92:95], v[72:75], a[0:3], v[28:31]
    v_exp_f32 v99, v99
    v_mfma_f32_16x16x32_bf16 v[92:95], v[76:79], a[4:7], v[92:95]
    v_add_f32 v24, v24, v96
    v_add_f32 v25, v25, v97
    v_mfma_f32_16x16x32_bf16 v[92:95], v[80:83], a[8:11], v[92:95]
    v_cvt_pk_bf16_f32 v108, v96, v97
    v_mfma_f32_16x16x32_bf16 v[92:95], v[84:87], a[12:15], v[92:95]
    v_exp_f32 v100, v100
    v_mfma_f32_16x16x32_bf16 v[164:167], v[112:115], v[104:107], v[164:167]
    v_exp_f32 v101, v101
    v_mfma_f32_16x16x32_bf16 v[192:195], v[116:119], v[104:107], v[192:195]
    v_add_f32 v24, v24, v98
    v_add_f32 v25, v25, v99
    v_mfma_f32_16x16x32_bf16 v[220:223], v[120:123], v[104:107], v[220:223]
    v_cvt_pk_bf16_f32 v109, v98, v99
    v_mfma_f32_16x16x32_bf16 v[248:251], v[124:127], v[104:107], v[248:251]
    v_exp_f32 v102, v102
    v_mfma_f32_16x16x32_bf16 a[132:135], v[128:131], v[104:107], a[132:135]
    v_exp_f32 v103, v103
    v_mfma_f32_16x16x32_bf16 a[160:163], v[132:135], v[104:107], a[160:163]
    v_add_f32 v24, v24, v100
    v_add_f32 v25, v25, v101
    v_mfma_f32_16x16x32_bf16 a[188:191], v[136:139], v[104:107], a[188:191]
    v_cvt_pk_bf16_f32 v110, v100, v101
    v_add_f32 v24, v24, v102
    v_mfma_f32_16x16x32_bf16 a[216:219], v[140:143], v[104:107], a[216:219]
    v_add_f32 v25, v25, v103
    v_cvt_pk_bf16_f32 v111, v102, v103
    v_mfma_f32_16x16x32_bf16 v[96:99], v[56:59], a[16:19], v[32:35]
    v_mfma_f32_16x16x32_bf16 v[96:99], v[60:63], a[20:23], v[96:99]
    v_exp_f32 v88, v88
    v_mfma_f32_16x16x32_bf16 v[96:99], v[64:67], a[24:27], v[96:99]
    v_exp_f32 v89, v89
    v_mfma_f32_16x16x32_bf16 v[96:99], v[68:71], a[28:31], v[96:99]
    v_exp_f32 v90, v90
    v_mfma_f32_16x16x32_bf16 v[100:103], v[72:75], a[16:19], v[32:35]
    v_exp_f32 v91, v91
    v_mfma_f32_16x16x32_bf16 v[100:103], v[76:79], a[20:23], v[100:103]
    v_add_f32 v12, v12, v88
    v_add_f32 v13, v13, v89
    v_mfma_f32_16x16x32_bf16 v[100:103], v[80:83], a[24:27], v[100:103]
    v_cvt_pk_bf16_f32 v104, v88, v89
    v_mfma_f32_16x16x32_bf16 v[100:103], v[84:87], a[28:31], v[100:103]
    v_exp_f32 v92, v92
    v_mfma_f32_16x16x32_bf16 v[168:171], v[112:115], v[108:111], v[168:171]
    ds_read_b64_tr_b16 v[112:113], v9 offset:0
    ds_read_b64_tr_b16 v[114:115], v9 offset:512
    v_exp_f32 v93, v93
    v_mfma_f32_16x16x32_bf16 v[196:199], v[116:119], v[108:111], v[196:199]
    ds_read_b64_tr_b16 v[116:117], v9 offset:32
    ds_read_b64_tr_b16 v[118:119], v9 offset:544
    v_add_f32 v12, v12, v90
    v_add_f32 v13, v13, v91
    v_mfma_f32_16x16x32_bf16 v[224:227], v[120:123], v[108:111], v[224:227]
    ds_read_b64_tr_b16 v[120:121], v9 offset:64
    ds_read_b64_tr_b16 v[122:123], v9 offset:576
    v_cvt_pk_bf16_f32 v105, v90, v91
    v_mfma_f32_16x16x32_bf16 v[252:255], v[124:127], v[108:111], v[252:255]
    ds_read_b64_tr_b16 v[124:125], v9 offset:96
    ds_read_b64_tr_b16 v[126:127], v9 offset:608
    v_exp_f32 v94, v94
    v_mfma_f32_16x16x32_bf16 a[136:139], v[128:131], v[108:111], a[136:139]
    ds_read_b64_tr_b16 v[128:129], v9 offset:128
    ds_read_b64_tr_b16 v[130:131], v9 offset:640
    v_exp_f32 v95, v95
    v_mfma_f32_16x16x32_bf16 a[164:167], v[132:135], v[108:111], a[164:167]
    ds_read_b64_tr_b16 v[132:133], v9 offset:160
    ds_read_b64_tr_b16 v[134:135], v9 offset:672
    v_add_f32 v12, v12, v92
    v_add_f32 v13, v13, v93
    v_mfma_f32_16x16x32_bf16 a[192:195], v[136:139], v[108:111], a[192:195]
    ds_read_b64_tr_b16 v[136:137], v9 offset:192
    ds_read_b64_tr_b16 v[138:139], v9 offset:704
    v_cvt_pk_bf16_f32 v106, v92, v93
    v_add_f32 v12, v12, v94
    v_mfma_f32_16x16x32_bf16 a[220:223], v[140:143], v[108:111], a[220:223]
    ds_read_b64_tr_b16 v[140:141], v9 offset:224
    ds_read_b64_tr_b16 v[142:143], v9 offset:736
    v_add_f32 v13, v13, v95
    v_cvt_pk_bf16_f32 v107, v94, v95
    v_mfma_f32_16x16x32_bf16 v[88:91], v[56:59], a[32:35], v[36:39]
    v_mfma_f32_16x16x32_bf16 v[88:91], v[60:63], a[36:39], v[88:91]
    s_add_u32 s29, s34, s100
    v_exp_f32 v96, v96
    v_mfma_f32_16x16x32_bf16 v[88:91], v[64:67], a[40:43], v[88:91]
    v_exp_f32 v97, v97
    v_mfma_f32_16x16x32_bf16 v[88:91], v[68:71], a[44:47], v[88:91]
    s_bfe_u32 s28, s29, 0x20003
    v_exp_f32 v98, v98
    v_mfma_f32_16x16x32_bf16 v[92:95], v[72:75], a[32:35], v[36:39]
    v_exp_f32 v99, v99
    v_mfma_f32_16x16x32_bf16 v[92:95], v[76:79], a[36:39], v[92:95]
    s_lshl_b32 s28, s28, 16
    v_add_f32 v14, v14, v96
    v_add_f32 v15, v15, v97
    v_mfma_f32_16x16x32_bf16 v[92:95], v[80:83], a[40:43], v[92:95]
    v_cvt_pk_bf16_f32 v108, v96, v97
    v_mfma_f32_16x16x32_bf16 v[92:95], v[84:87], a[44:47], v[92:95]
    v_exp_f32 v100, v100
    s_waitcnt lgkmcnt(0)
    v_mfma_f32_16x16x32_bf16 v[144:147], v[112:115], v[104:107], v[144:147]
    s_and_b32 s29, s29, 7
    v_exp_f32 v101, v101
    v_mfma_f32_16x16x32_bf16 v[172:175], v[116:119], v[104:107], v[172:175]
    v_add_f32 v14, v14, v98
    v_add_f32 v15, v15, v99
    v_mfma_f32_16x16x32_bf16 v[200:203], v[120:123], v[104:107], v[200:203]
    s_lshl_b32 s29, s29, 11
    v_cvt_pk_bf16_f32 v109, v98, v99
    v_mfma_f32_16x16x32_bf16 v[228:231], v[124:127], v[104:107], v[228:231]
    v_exp_f32 v102, v102
    v_mfma_f32_16x16x32_bf16 a[112:115], v[128:131], v[104:107], a[112:115]
    s_add_u32 s29, s28, s29
    v_exp_f32 v103, v103
    v_mfma_f32_16x16x32_bf16 a[140:143], v[132:135], v[104:107], a[140:143]
    v_add_f32 v14, v14, v100
    v_add_f32 v15, v15, v101
    v_mfma_f32_16x16x32_bf16 a[168:171], v[136:139], v[104:107], a[168:171]
    s_lshr_b32 s28, s34, 5
    v_cvt_pk_bf16_f32 v110, v100, v101
    v_add_f32 v14, v14, v102
    v_mfma_f32_16x16x32_bf16 a[196:199], v[140:143], v[104:107], a[196:199]
    v_add_f32 v15, v15, v103
    v_cvt_pk_bf16_f32 v111, v102, v103
    v_mfma_f32_16x16x32_bf16 v[96:99], v[56:59], a[48:51], v[40:43]
    v_mfma_f32_16x16x32_bf16 v[96:99], v[60:63], a[52:55], v[96:99]
    s_lshl_b32 s28, s28, 19
    v_exp_f32 v88, v88
    v_mfma_f32_16x16x32_bf16 v[96:99], v[64:67], a[56:59], v[96:99]
    v_exp_f32 v89, v89
    v_mfma_f32_16x16x32_bf16 v[96:99], v[68:71], a[60:63], v[96:99]
    s_add_u32 s49, s28, s29
    v_exp_f32 v90, v90
    v_mfma_f32_16x16x32_bf16 v[100:103], v[72:75], a[48:51], v[40:43]
    v_exp_f32 v91, v91
    v_mfma_f32_16x16x32_bf16 v[100:103], v[76:79], a[52:55], v[100:103]
    s_add_u32 m0, s33, 25344
    v_add_f32 v16, v16, v88
    v_add_f32 v17, v17, v89
    v_mfma_f32_16x16x32_bf16 v[100:103], v[80:83], a[56:59], v[100:103]
    v_cvt_pk_bf16_f32 v104, v88, v89
    v_mfma_f32_16x16x32_bf16 v[100:103], v[84:87], a[60:63], v[100:103]
    v_exp_f32 v92, v92
    v_mfma_f32_16x16x32_bf16 v[148:151], v[112:115], v[108:111], v[148:151]
    s_add_u32 s34, s34, 1
    v_exp_f32 v93, v93
    v_mfma_f32_16x16x32_bf16 v[176:179], v[116:119], v[108:111], v[176:179]
    v_add_f32 v16, v16, v90
    v_add_f32 v17, v17, v91
    v_mfma_f32_16x16x32_bf16 v[204:207], v[120:123], v[108:111], v[204:207]
    buffer_load_dwordx4 v7, s[4:7], s49 offen offset:0 nt lds
    v_cvt_pk_bf16_f32 v105, v90, v91
    v_mfma_f32_16x16x32_bf16 v[232:235], v[124:127], v[108:111], v[232:235]
    v_exp_f32 v94, v94
    v_mfma_f32_16x16x32_bf16 a[116:119], v[128:131], v[108:111], a[116:119]
    s_add_u32 m0, m0, s96
    v_exp_f32 v95, v95
    v_mfma_f32_16x16x32_bf16 a[144:147], v[132:135], v[108:111], a[144:147]
    v_add_f32 v16, v16, v92
    v_add_f32 v17, v17, v93
    v_mfma_f32_16x16x32_bf16 a[172:175], v[136:139], v[108:111], a[172:175]
    buffer_load_dwordx4 v7, s[4:7], s49 offen offset:256 nt lds
    v_cvt_pk_bf16_f32 v106, v92, v93
    v_add_f32 v16, v16, v94
    v_mfma_f32_16x16x32_bf16 a[200:203], v[140:143], v[108:111], a[200:203]
    v_add_f32 v17, v17, v95
    v_cvt_pk_bf16_f32 v107, v94, v95
    v_mfma_f32_16x16x32_bf16 v[88:91], v[56:59], a[64:67], v[44:47]
    v_mfma_f32_16x16x32_bf16 v[88:91], v[60:63], a[68:71], v[88:91]
    s_add_u32 m0, m0, s97
    v_exp_f32 v96, v96
    v_mfma_f32_16x16x32_bf16 v[88:91], v[64:67], a[72:75], v[88:91]
    v_exp_f32 v97, v97
    v_mfma_f32_16x16x32_bf16 v[88:91], v[68:71], a[76:79], v[88:91]
    buffer_load_dwordx4 v7, s[4:7], s49 offen offset:512 nt lds
    v_exp_f32 v98, v98
    v_mfma_f32_16x16x32_bf16 v[92:95], v[72:75], a[64:67], v[44:47]
    v_exp_f32 v99, v99
    v_mfma_f32_16x16x32_bf16 v[92:95], v[76:79], a[68:71], v[92:95]
    s_add_u32 m0, m0, s96
    v_add_f32 v18, v18, v96
    v_add_f32 v19, v19, v97
    v_mfma_f32_16x16x32_bf16 v[92:95], v[80:83], a[72:75], v[92:95]
    v_cvt_pk_bf16_f32 v108, v96, v97
    v_mfma_f32_16x16x32_bf16 v[92:95], v[84:87], a[76:79], v[92:95]
    v_exp_f32 v100, v100
    v_mfma_f32_16x16x32_bf16 v[152:155], v[112:115], v[104:107], v[152:155]
    buffer_load_dwordx4 v7, s[4:7], s49 offen offset:768 nt lds
    v_exp_f32 v101, v101
    v_mfma_f32_16x16x32_bf16 v[180:183], v[116:119], v[104:107], v[180:183]
    v_add_f32 v18, v18, v98
    v_add_f32 v19, v19, v99
    v_mfma_f32_16x16x32_bf16 v[208:211], v[120:123], v[104:107], v[208:211]
    s_add_u32 m0, m0, s97
    v_cvt_pk_bf16_f32 v109, v98, v99
    v_mfma_f32_16x16x32_bf16 v[236:239], v[124:127], v[104:107], v[236:239]
    v_exp_f32 v102, v102
    v_mfma_f32_16x16x32_bf16 a[120:123], v[128:131], v[104:107], a[120:123]
    buffer_load_dwordx4 v7, s[4:7], s49 offen offset:1024 nt lds
    v_exp_f32 v103, v103
    v_mfma_f32_16x16x32_bf16 a[148:151], v[132:135], v[104:107], a[148:151]
    v_add_f32 v18, v18, v100
    v_add_f32 v19, v19, v101
    v_mfma_f32_16x16x32_bf16 a[176:179], v[136:139], v[104:107], a[176:179]
    s_add_u32 m0, m0, s96
    v_cvt_pk_bf16_f32 v110, v100, v101
    v_add_f32 v18, v18, v102
    v_mfma_f32_16x16x32_bf16 a[204:207], v[140:143], v[104:107], a[204:207]
    v_add_f32 v19, v19, v103
    v_cvt_pk_bf16_f32 v111, v102, v103
    v_mfma_f32_16x16x32_bf16 v[96:99], v[56:59], a[80:83], v[48:51]
    v_mfma_f32_16x16x32_bf16 v[96:99], v[60:63], a[84:87], v[96:99]
    buffer_load_dwordx4 v7, s[4:7], s49 offen offset:1280 nt lds
    v_exp_f32 v88, v88
    v_mfma_f32_16x16x32_bf16 v[96:99], v[64:67], a[88:91], v[96:99]
    v_exp_f32 v89, v89
    v_mfma_f32_16x16x32_bf16 v[96:99], v[68:71], a[92:95], v[96:99]
    s_add_u32 m0, m0, s97
    v_exp_f32 v90, v90
    v_mfma_f32_16x16x32_bf16 v[100:103], v[72:75], a[80:83], v[48:51]
    v_exp_f32 v91, v91
    v_mfma_f32_16x16x32_bf16 v[100:103], v[76:79], a[84:87], v[100:103]
    buffer_load_dwordx4 v7, s[4:7], s49 offen offset:1536 nt lds
    v_add_f32 v20, v20, v88
    v_add_f32 v21, v21, v89
    v_mfma_f32_16x16x32_bf16 v[100:103], v[80:83], a[88:91], v[100:103]
    v_cvt_pk_bf16_f32 v104, v88, v89
    v_mfma_f32_16x16x32_bf16 v[100:103], v[84:87], a[92:95], v[100:103]
    v_exp_f32 v92, v92
    v_mfma_f32_16x16x32_bf16 v[156:159], v[112:115], v[108:111], v[156:159]
    s_add_u32 m0, m0, s96
    v_exp_f32 v93, v93
    v_mfma_f32_16x16x32_bf16 v[184:187], v[116:119], v[108:111], v[184:187]
    v_add_f32 v20, v20, v90
    v_add_f32 v21, v21, v91
    v_mfma_f32_16x16x32_bf16 v[212:215], v[120:123], v[108:111], v[212:215]
    buffer_load_dwordx4 v7, s[4:7], s49 offen offset:1792 nt lds
    v_cvt_pk_bf16_f32 v105, v90, v91
    v_mfma_f32_16x16x32_bf16 v[240:243], v[124:127], v[108:111], v[240:243]
    v_exp_f32 v94, v94
    v_mfma_f32_16x16x32_bf16 a[124:127], v[128:131], v[108:111], a[124:127]
    v_exp_f32 v95, v95
    v_mfma_f32_16x16x32_bf16 a[152:155], v[132:135], v[108:111], a[152:155]
    v_add_f32 v20, v20, v92
    v_add_f32 v21, v21, v93
    v_mfma_f32_16x16x32_bf16 a[180:183], v[136:139], v[108:111], a[180:183]
    v_cvt_pk_bf16_f32 v106, v92, v93
    v_add_f32 v20, v20, v94
    v_mfma_f32_16x16x32_bf16 a[208:211], v[140:143], v[108:111], a[208:211]
    v_add_f32 v21, v21, v95
    v_cvt_pk_bf16_f32 v107, v94, v95
    s_waitcnt vmcnt(16) lgkmcnt(0)
    s_barrier
    v_mfma_f32_16x16x32_bf16 v[88:91], v[56:59], a[96:99], v[52:55]
    ds_read_b128 v[56:59], v8 offset:8448
    v_mfma_f32_16x16x32_bf16 v[88:91], v[60:63], a[100:103], v[88:91]
    ds_read_b128 v[60:63], v8 offset:8512
    v_exp_f32 v96, v96
    v_mfma_f32_16x16x32_bf16 v[88:91], v[64:67], a[104:107], v[88:91]
    ds_read_b128 v[64:67], v8 offset:8576
    v_exp_f32 v97, v97
    v_mfma_f32_16x16x32_bf16 v[88:91], v[68:71], a[108:111], v[88:91]
    ds_read_b128 v[68:71], v8 offset:8640
    v_exp_f32 v98, v98
    v_mfma_f32_16x16x32_bf16 v[92:95], v[72:75], a[96:99], v[52:55]
    ds_read_b128 v[72:75], v8 offset:8960
    v_exp_f32 v99, v99
    v_mfma_f32_16x16x32_bf16 v[92:95], v[76:79], a[100:103], v[92:95]
    ds_read_b128 v[76:79], v8 offset:9024
    v_add_f32 v22, v22, v96
    v_add_f32 v23, v23, v97
    v_mfma_f32_16x16x32_bf16 v[92:95], v[80:83], a[104:107], v[92:95]
    ds_read_b128 v[80:83], v8 offset:9088
    v_cvt_pk_bf16_f32 v108, v96, v97
    v_mfma_f32_16x16x32_bf16 v[92:95], v[84:87], a[108:111], v[92:95]
    ds_read_b128 v[84:87], v8 offset:9152
    v_exp_f32 v100, v100
    v_mfma_f32_16x16x32_bf16 v[160:163], v[112:115], v[104:107], v[160:163]
    v_exp_f32 v101, v101
    v_mfma_f32_16x16x32_bf16 v[188:191], v[116:119], v[104:107], v[188:191]
    v_add_f32 v22, v22, v98
    v_add_f32 v23, v23, v99
    v_mfma_f32_16x16x32_bf16 v[216:219], v[120:123], v[104:107], v[216:219]
    v_cvt_pk_bf16_f32 v109, v98, v99
    v_mfma_f32_16x16x32_bf16 v[244:247], v[124:127], v[104:107], v[244:247]
    v_exp_f32 v102, v102
    v_mfma_f32_16x16x32_bf16 a[128:131], v[128:131], v[104:107], a[128:131]
    v_exp_f32 v103, v103
    v_mfma_f32_16x16x32_bf16 a[156:159], v[132:135], v[104:107], a[156:159]
    v_add_f32 v22, v22, v100
    v_add_f32 v23, v23, v101
    v_mfma_f32_16x16x32_bf16 a[184:187], v[136:139], v[104:107], a[184:187]
    v_cvt_pk_bf16_f32 v110, v100, v101
    v_add_f32 v22, v22, v102
    v_mfma_f32_16x16x32_bf16 a[212:215], v[140:143], v[104:107], a[212:215]
    v_add_f32 v23, v23, v103
    v_cvt_pk_bf16_f32 v111, v102, v103
    s_waitcnt lgkmcnt(0)
    v_mfma_f32_16x16x32_bf16 v[96:99], v[56:59], a[0:3], v[28:31]
    v_mfma_f32_16x16x32_bf16 v[96:99], v[60:63], a[4:7], v[96:99]
    v_exp_f32 v88, v88
    v_mfma_f32_16x16x32_bf16 v[96:99], v[64:67], a[8:11], v[96:99]
    v_exp_f32 v89, v89
    v_mfma_f32_16x16x32_bf16 v[96:99], v[68:71], a[12:15], v[96:99]
    v_exp_f32 v90, v90
    v_mfma_f32_16x16x32_bf16 v[100:103], v[72:75], a[0:3], v[28:31]
    v_exp_f32 v91, v91
    v_mfma_f32_16x16x32_bf16 v[100:103], v[76:79], a[4:7], v[100:103]
    v_add_f32 v24, v24, v88
    v_add_f32 v25, v25, v89
    v_mfma_f32_16x16x32_bf16 v[100:103], v[80:83], a[8:11], v[100:103]
    v_cvt_pk_bf16_f32 v104, v88, v89
    v_mfma_f32_16x16x32_bf16 v[100:103], v[84:87], a[12:15], v[100:103]
    v_exp_f32 v92, v92
    v_mfma_f32_16x16x32_bf16 v[164:167], v[112:115], v[108:111], v[164:167]
    v_exp_f32 v93, v93
    v_mfma_f32_16x16x32_bf16 v[192:195], v[116:119], v[108:111], v[192:195]
    v_add_f32 v24, v24, v90
    v_add_f32 v25, v25, v91
    v_mfma_f32_16x16x32_bf16 v[220:223], v[120:123], v[108:111], v[220:223]
    v_cvt_pk_bf16_f32 v105, v90, v91
    v_mfma_f32_16x16x32_bf16 v[248:251], v[124:127], v[108:111], v[248:251]
    v_exp_f32 v94, v94
    v_mfma_f32_16x16x32_bf16 a[132:135], v[128:131], v[108:111], a[132:135]
    v_exp_f32 v95, v95
    v_mfma_f32_16x16x32_bf16 a[160:163], v[132:135], v[108:111], a[160:163]
    v_add_f32 v24, v24, v92
    v_add_f32 v25, v25, v93
    v_mfma_f32_16x16x32_bf16 a[188:191], v[136:139], v[108:111], a[188:191]
    v_cvt_pk_bf16_f32 v106, v92, v93
    v_add_f32 v24, v24, v94
    v_mfma_f32_16x16x32_bf16 a[216:219], v[140:143], v[108:111], a[216:219]
    v_add_f32 v25, v25, v95
    v_cvt_pk_bf16_f32 v107, v94, v95
    s_add_u32 s22, s22, 1
    s_cmp_lt_u32 s22, 6
    s_cbranch_scc1 L_at_loop
    s_add_u32 s21, s21, 1
    v_mfma_f32_16x16x32_bf16 v[88:91], v[56:59], a[16:19], v[32:35]
    v_mfma_f32_16x16x32_bf16 v[88:91], v[60:63], a[20:23], v[88:91]
    v_exp_f32 v96, v96
    v_mfma_f32_16x16x32_bf16 v[88:91], v[64:67], a[24:27], v[88:91]
    v_exp_f32 v97, v97
    v_mfma_f32_16x16x32_bf16 v[88:91], v[68:71], a[28:31], v[88:91]
    v_exp_f32 v98, v98
    v_mfma_f32_16x16x32_bf16 v[92:95], v[72:75], a[16:19], v[32:35]
    v_exp_f32 v99, v99
    v_mfma_f32_16x16x32_bf16 v[92:95], v[76:79], a[20:23], v[92:95]
    v_add_f32 v12, v12, v96
    v_add_f32 v13, v13, v97
    v_mfma_f32_16x16x32_bf16 v[92:95], v[80:83], a[24:27], v[92:95]
    v_cvt_pk_bf16_f32 v108, v96, v97
    v_mfma_f32_16x16x32_bf16 v[92:95], v[84:87], a[28:31], v[92:95]
    v_exp_f32 v100, v100
    v_mfma_f32_16x16x32_bf16 v[168:171], v[112:115], v[104:107], v[168:171]
    ds_read_b64_tr_b16 v[112:113], v9 offset:8448
    ds_read_b64_tr_b16 v[114:115], v9 offset:8960
    v_exp_f32 v101, v101
    v_mfma_f32_16x16x32_bf16 v[196:199], v[116:119], v[104:107], v[196:199]
    ds_read_b64_tr_b16 v[116:117], v9 offset:8480
    ds_read_b64_tr_b16 v[118:119], v9 offset:8992
    v_add_f32 v12, v12, v98
    v_add_f32 v13, v13, v99
    v_mfma_f32_16x16x32_bf16 v[224:227], v[120:123], v[104:107], v[224:227]
    ds_read_b64_tr_b16 v[120:121], v9 offset:8512
    ds_read_b64_tr_b16 v[122:123], v9 offset:9024
    v_cvt_pk_bf16_f32 v109, v98, v99
    v_mfma_f32_16x16x32_bf16 v[252:255], v[124:127], v[104:107], v[252:255]
    ds_read_b64_tr_b16 v[124:125], v9 offset:8544
    ds_read_b64_tr_b16 v[126:127], v9 offset:9056
    v_exp_f32 v102, v102
    v_mfma_f32_16x16x32_bf16 a[136:139], v[128:131], v[104:107], a[136:139]
    ds_read_b64_tr_b16 v[128:129], v9 offset:8576
    ds_read_b64_tr_b16 v[130:131], v9 offset:9088
    v_exp_f32 v103, v103
    v_mfma_f32_16x16x32_bf16 a[164:167], v[132:135], v[104:107], a[164:167]
    ds_read_b64_tr_b16 v[132:133], v9 offset:8608
    ds_read_b64_tr_b16 v[134:135], v9 offset:9120
    v_add_f32 v12, v12, v100
    v_add_f32 v13, v13, v101
    v_mfma_f32_16x16x32_bf16 a[192:195], v[136:139], v[104:107], a[192:195]
    ds_read_b64_tr_b16 v[136:137], v9 offset:8640
    ds_read_b64_tr_b16 v[138:139], v9 offset:9152
    v_cvt_pk_bf16_f32 v110, v100, v101
    v_add_f32 v12, v12, v102
    v_mfma_f32_16x16x32_bf16 a[220:223], v[140:143], v[104:107], a[220:223]
    ds_read_b64_tr_b16 v[140:141], v9 offset:8672
    ds_read_b64_tr_b16 v[142:143], v9 offset:9184
    v_add_f32 v13, v13, v103
    v_cvt_pk_bf16_f32 v111, v102, v103
    v_mfma_f32_16x16x32_bf16 v[96:99], v[56:59], a[32:35], v[36:39]
    v_mfma_f32_16x16x32_bf16 v[96:99], v[60:63], a[36:39], v[96:99]
    s_add_u32 s29, s34, s100
    v_exp_f32 v88, v88
    v_mfma_f32_16x16x32_bf16 v[96:99], v[64:67], a[40:43], v[96:99]
    v_exp_f32 v89, v89
    v_mfma_f32_16x16x32_bf16 v[96:99], v[68:71], a[44:47], v[96:99]
    s_bfe_u32 s28, s29, 0x20003
    v_exp_f32 v90, v90
    v_mfma_f32_16x16x32_bf16 v[100:103], v[72:75], a[32:35], v[36:39]
    v_exp_f32 v91, v91
    v_mfma_f32_16x16x32_bf16 v[100:103], v[76:79], a[36:39], v[100:103]
    s_lshl_b32 s28, s28, 16
    v_add_f32 v14, v14, v88
    v_add_f32 v15, v15, v89
    v_mfma_f32_16x16x32_bf16 v[100:103], v[80:83], a[40:43], v[100:103]
    v_cvt_pk_bf16_f32 v104, v88, v89
    v_mfma_f32_16x16x32_bf16 v[100:103], v[84:87], a[44:47], v[100:103]
    v_exp_f32 v92, v92
    s_waitcnt lgkmcnt(0)
    v_mfma_f32_16x16x32_bf16 v[144:147], v[112:115], v[108:111], v[144:147]
    s_and_b32 s29, s29, 7
    v_exp_f32 v93, v93
    v_mfma_f32_16x16x32_bf16 v[172:175], v[116:119], v[108:111], v[172:175]
    v_add_f32 v14, v14, v90
    v_add_f32 v15, v15, v91
    v_mfma_f32_16x16x32_bf16 v[200:203], v[120:123], v[108:111], v[200:203]
    s_lshl_b32 s29, s29, 11
    v_cvt_pk_bf16_f32 v105, v90, v91
    v_mfma_f32_16x16x32_bf16 v[228:231], v[124:127], v[108:111], v[228:231]
    v_exp_f32 v94, v94
    v_mfma_f32_16x16x32_bf16 a[112:115], v[128:131], v[108:111], a[112:115]
    s_add_u32 s29, s28, s29
    v_exp_f32 v95, v95
    v_mfma_f32_16x16x32_bf16 a[140:143], v[132:135], v[108:111], a[140:143]
    v_add_f32 v14, v14, v92
    v_add_f32 v15, v15, v93
    v_mfma_f32_16x16x32_bf16 a[168:171], v[136:139], v[108:111], a[168:171]
    s_lshr_b32 s28, s34, 5
    v_cvt_pk_bf16_f32 v106, v92, v93
    v_add_f32 v14, v14, v94
    v_mfma_f32_16x16x32_bf16 a[196:199], v[140:143], v[108:111], a[196:199]
    v_add_f32 v15, v15, v95
    v_cvt_pk_bf16_f32 v107, v94, v95
    v_mfma_f32_16x16x32_bf16 v[88:91], v[56:59], a[48:51], v[40:43]
    v_mfma_f32_16x16x32_bf16 v[88:91], v[60:63], a[52:55], v[88:91]
    s_lshl_b32 s28, s28, 19
    v_exp_f32 v96, v96
    v_mfma_f32_16x16x32_bf16 v[88:91], v[64:67], a[56:59], v[88:91]
    v_exp_f32 v97, v97
    v_mfma_f32_16x16x32_bf16 v[88:91], v[68:71], a[60:63], v[88:91]
    s_add_u32 s49, s28, s29
    v_exp_f32 v98, v98
    v_mfma_f32_16x16x32_bf16 v[92:95], v[72:75], a[48:51], v[40:43]
    v_exp_f32 v99, v99
    v_mfma_f32_16x16x32_bf16 v[92:95], v[76:79], a[52:55], v[92:95]
    s_add_u32 m0, s33, 0
    v_add_f32 v16, v16, v96
    v_add_f32 v17, v17, v97
    v_mfma_f32_16x16x32_bf16 v[92:95], v[80:83], a[56:59], v[92:95]
    v_cvt_pk_bf16_f32 v108, v96, v97
    v_mfma_f32_16x16x32_bf16 v[92:95], v[84:87], a[60:63], v[92:95]
    v_exp_f32 v100, v100
    v_mfma_f32_16x16x32_bf16 v[148:151], v[112:115], v[104:107], v[148:151]
    s_add_u32 s34, s34, 1
    v_exp_f32 v101, v101
    v_mfma_f32_16x16x32_bf16 v[176:179], v[116:119], v[104:107], v[176:179]
    v_add_f32 v16, v16, v98
    v_add_f32 v17, v17, v99
    v_mfma_f32_16x16x32_bf16 v[204:207], v[120:123], v[104:107], v[204:207]
    buffer_load_dwordx4 v7, s[4:7], s49 offen offset:0 nt lds
    v_cvt_pk_bf16_f32 v109, v98, v99
    v_mfma_f32_16x16x32_bf16 v[232:235], v[124:127], v[104:107], v[232:235]
    v_exp_f32 v102, v102
    v_mfma_f32_16x16x32_bf16 a[116:119], v[128:131], v[104:107], a[116:119]
    s_add_u32 m0, m0, s96
    v_exp_f32 v103, v103
    v_mfma_f32_16x16x32_bf16 a[144:147], v[132:135], v[104:107], a[144:147]
    v_add_f32 v16, v16, v100
    v_add_f32 v17, v17, v101
    v_mfma_f32_16x16x32_bf16 a[172:175], v[136:139], v[104:107], a[172:175]
    buffer_load_dwordx4 v7, s[4:7], s49 offen offset:256 nt lds
    v_cvt_pk_bf16_f32 v110, v100, v101
    v_add_f32 v16, v16, v102
    v_mfma_f32_16x16x32_bf16 a[200:203], v[140:143], v[104:107], a[200:203]
    v_add_f32 v17, v17, v103
    v_cvt_pk_bf16_f32 v111, v102, v103
    v_mfma_f32_16x16x32_bf16 v[96:99], v[56:59], a[64:67], v[44:47]
    v_mfma_f32_16x16x32_bf16 v[96:99], v[60:63], a[68:71], v[96:99]
    s_add_u32 m0, m0, s97
    v_exp_f32 v88, v88
    v_mfma_f32_16x16x32_bf16 v[96:99], v[64:67], a[72:75], v[96:99]
    v_exp_f32 v89, v89
    v_mfma_f32_16x16x32_bf16 v[96:99], v[68:71], a[76:79], v[96:99]
    buffer_load_dwordx4 v7, s[4:7], s49 offen offset:512 nt lds
    v_exp_f32 v90, v90
    v_mfma_f32_16x16x32_bf16 v[100:103], v[72:75], a[64:67], v[44:47]
    v_exp_f32 v91, v91
    v_mfma_f32_16x16x32_bf16 v[100:103], v[76:79], a[68:71], v[100:103]
    s_add_u32 m0, m0, s96
    v_add_f32 v18, v18, v88
    v_add_f32 v19, v19, v89
    v_mfma_f32_16x16x32_bf16 v[100:103], v[80:83], a[72:75], v[100:103]
    v_cvt_pk_bf16_f32 v104, v88, v89
    v_mfma_f32_16x16x32_bf16 v[100:103], v[84:87], a[76:79], v[100:103]
    v_exp_f32 v92, v92
    v_mfma_f32_16x16x32_bf16 v[152:155], v[112:115], v[108:111], v[152:155]
    buffer_load_dwordx4 v7, s[4:7], s49 offen offset:768 nt lds
    v_exp_f32 v93, v93
    v_mfma_f32_16x16x32_bf16 v[180:183], v[116:119], v[108:111], v[180:183]
    v_add_f32 v18, v18, v90
    v_add_f32 v19, v19, v91
    v_mfma_f32_16x16x32_bf16 v[208:211], v[120:123], v[108:111], v[208:211]
    s_add_u32 m0, m0, s97
    v_cvt_pk_bf16_f32 v105, v90, v91
    v_mfma_f32_16x16x32_bf16 v[236:239], v[124:127], v[108:111], v[236:239]
    v_exp_f32 v94, v94
    v_mfma_f32_16x16x32_bf16 a[120:123], v[128:131], v[108:111], a[120:123]
    buffer_load_dwordx4 v7, s[4:7], s49 offen offset:1024 nt lds
    v_exp_f32 v95, v95
    v_mfma_f32_16x16x32_bf16 a[148:151], v[132:135], v[108:111], a[148:151]
    v_add_f32 v18, v18, v92
    v_add_f32 v19, v19, v93
    v_mfma_f32_16x16x32_bf16 a[176:179], v[136:139], v[108:111], a[176:179]
    s_add_u32 m0, m0, s96
    v_cvt_pk_bf16_f32 v106, v92, v93
    v_add_f32 v18, v18, v94
    v_mfma_f32_16x16x32_bf16 a[204:207], v[140:143], v[108:111], a[204:207]
    v_add_f32 v19, v19, v95
    v_cvt_pk_bf16_f32 v107, v94, v95
    v_mfma_f32_16x16x32_bf16 v[88:91], v[56:59], a[80:83], v[48:51]
    v_mfma_f32_16x16x32_bf16 v[88:91], v[60:63], a[84:87], v[88:91]
    buffer_load_dwordx4 v7, s[4:7], s49 offen offset:1280 nt lds
    v_exp_f32 v96, v96
    v_mfma_f32_16x16x32_bf16 v[88:91], v[64:67], a[88:91], v[88:91]
    v_exp_f32 v97, v97
    v_mfma_f32_16x16x32_bf16 v[88:91], v[68:71], a[92:95], v[88:91]
    s_add_u32 m0, m0, s97
    v_exp_f32 v98, v98
    v_mfma_f32_16x16x32_bf16 v[92:95], v[72:75], a[80:83], v[48:51]
    v_exp_f32 v99, v99
    v_mfma_f32_16x16x32_bf16 v[92:95], v[76:79], a[84:87], v[92:95]
    buffer_load_dwordx4 v7, s[4:7], s49 offen offset:1536 nt lds
    v_add_f32 v20, v20, v96
    v_add_f32 v21, v21, v97
    v_mfma_f32_16x16x32_bf16 v[92:95], v[80:83], a[88:91], v[92:95]
    v_cvt_pk_bf16_f32 v108, v96, v97
    v_mfma_f32_16x16x32_bf16 v[92:95], v[84:87], a[92:95], v[92:95]
    v_exp_f32 v100, v100
    v_mfma_f32_16x16x32_bf16 v[156:159], v[112:115], v[104:107], v[156:159]
    s_add_u32 m0, m0, s96
    v_exp_f32 v101, v101
    v_mfma_f32_16x16x32_bf16 v[184:187], v[116:119], v[104:107], v[184:187]
    v_add_f32 v20, v20, v98
    v_add_f32 v21, v21, v99
    v_mfma_f32_16x16x32_bf16 v[212:215], v[120:123], v[104:107], v[212:215]
    buffer_load_dwordx4 v7, s[4:7], s49 offen offset:1792 nt lds
    v_cvt_pk_bf16_f32 v109, v98, v99
    v_mfma_f32_16x16x32_bf16 v[240:243], v[124:127], v[104:107], v[240:243]
    v_exp_f32 v102, v102
    v_mfma_f32_16x16x32_bf16 a[124:127], v[128:131], v[104:107], a[124:127]
    v_exp_f32 v103, v103
    v_mfma_f32_16x16x32_bf16 a[152:155], v[132:135], v[104:107], a[152:155]
    v_add_f32 v20, v20, v100
    v_add_f32 v21, v21, v101
    v_mfma_f32_16x16x32_bf16 a[180:183], v[136:139], v[104:107], a[180:183]
    v_cvt_pk_bf16_f32 v110, v100, v101
    v_add_f32 v20, v20, v102
    v_mfma_f32_16x16x32_bf16 a[208:211], v[140:143], v[104:107], a[208:211]
    v_add_f32 v21, v21, v103
    v_cvt_pk_bf16_f32 v111, v102, v103
    s_waitcnt vmcnt(16) lgkmcnt(0)
    s_barrier
    v_mfma_f32_16x16x32_bf16 v[96:99], v[56:59], a[96:99], v[52:55]
    ds_read_b128 v[56:59], v8 offset:16896
    v_mfma_f32_16x16x32_bf16 v[96:99], v[60:63], a[100:103], v[96:99]
    ds_read_b128 v[60:63], v8 offset:16960
    v_exp_f32 v88, v88
    v_mfma_f32_16x16x32_bf16 v[96:99], v[64:67], a[104:107], v[96:99]
    ds_read_b128 v[64:67], v8 offset:17024
    v_exp_f32 v89, v89
    v_mfma_f32_16x16x32_bf16 v[96:99], v[68:71], a[108:111], v[96:99]
    ds_read_b128 v[68:71], v8 offset:17088
    v_exp_f32 v90, v90
    v_mfma_f32_16x16x32_bf16 v[100:103], v[72:75], a[96:99], v[52:55]
    ds_read_b128 v[72:75], v8 offset:17408
    v_exp_f32 v91, v91
    v_mfma_f32_16x16x32_bf16 v[100:103], v[76:79], a[100:103], v[100:103]
    ds_read_b128 v[76:79], v8 offset:17472
    v_add_f32 v22, v22, v88
    v_add_f32 v23, v23, v89
    v_mfma_f32_16x16x32_bf16 v[100:103], v[80:83], a[104:107], v[100:103]
    ds_read_b128 v[80:83], v8 offset:17536
    v_cvt_pk_bf16_f32 v104, v88, v89
    v_mfma_f32_16x16x32_bf16 v[100:103], v[84:87], a[108:111], v[100:103]
    ds_read_b128 v[84:87], v8 offset:17600
    v_exp_f32 v92, v92
    v_mfma_f32_16x16x32_bf16 v[160:163], v[112:115], v[108:111], v[160:163]
    v_exp_f32 v93, v93
    v_mfma_f32_16x16x32_bf16 v[188:191], v[116:119], v[108:111], v[188:191]
    v_add_f32 v22, v22, v90
    v_add_f32 v23, v23, v91
    v_mfma_f32_16x16x32_bf16 v[216:219], v[120:123], v[108:111], v[216:219]
    v_cvt_pk_bf16_f32 v105, v90, v91
    v_mfma_f32_16x16x32_bf16 v[244:247], v[124:127], v[108:111], v[244:247]
    v_exp_f32 v94, v94
    v_mfma_f32_16x16x32_bf16 a[128:131], v[128:131], v[108:111], a[128:131]
    v_exp_f32 v95, v95
    v_mfma_f32_16x16x32_bf16 a[156:159], v[132:135], v[108:111], a[156:159]
    v_add_f32 v22, v22, v92
    v_add_f32 v23, v23, v93
    v_mfma_f32_16x16x32_bf16 a[184:187], v[136:139], v[108:111], a[184:187]
    v_cvt_pk_bf16_f32 v106, v92, v93
    v_add_f32 v22, v22, v94
    v_mfma_f32_16x16x32_bf16 a[212:215], v[140:143], v[108:111], a[212:215]
    v_add_f32 v23, v23, v95
    v_cvt_pk_bf16_f32 v107, v94, v95
    s_waitcnt lgkmcnt(0)
    v_mfma_f32_16x16x32_bf16 v[88:91], v[56:59], a[0:3], v[28:31]
    v_mfma_f32_16x16x32_bf16 v[88:91], v[60:63], a[4:7], v[88:91]
    v_exp_f32 v96, v96
    v_mfma_f32_16x16x32_bf16 v[88:91], v[64:67], a[8:11], v[88:91]
    v_exp_f32 v97, v97
    v_mfma_f32_16x16x32_bf16 v[88:91], v[68:71], a[12:15], v[88:91]
    v_exp_f32 v98, v98
    v_mfma_f32_16x16x32_bf16 v[92:95], v[72:75], a[0:3], v[28:31]
    v_exp_f32 v99, v99
    v_mfma_f32_16x16x32_bf16 v[92:95], v[76:79], a[4:7], v[92:95]
    v_add_f32 v24, v24, v96
    v_add_f32 v25, v25, v97
    v_mfma_f32_16x16x32_bf16 v[92:95], v[80:83], a[8:11], v[92:95]
    v_cvt_pk_bf16_f32 v108, v96, v97
    v_mfma_f32_16x16x32_bf16 v[92:95], v[84:87], a[12:15], v[92:95]
    v_exp_f32 v100, v100
    v_mfma_f32_16x16x32_bf16 v[164:167], v[112:115], v[104:107], v[164:167]
    v_exp_f32 v101, v101
    v_mfma_f32_16x16x32_bf16 v[192:195], v[116:119], v[104:107], v[192:195]
    v_add_f32 v24, v24, v98
    v_add_f32 v25, v25, v99
    v_mfma_f32_16x16x32_bf16 v[220:223], v[120:123], v[104:107], v[220:223]
    v_cvt_pk_bf16_f32 v109, v98, v99
    v_mfma_f32_16x16x32_bf16 v[248:251], v[124:127], v[104:107], v[248:251]
    v_exp_f32 v102, v102
    v_mfma_f32_16x16x32_bf16 a[132:135], v[128:131], v[104:107], a[132:135]
    v_exp_f32 v103, v103
    v_mfma_f32_16x16x32_bf16 a[160:163], v[132:135], v[104:107], a[160:163]
    v_add_f32 v24, v24, v100
    v_add_f32 v25, v25, v101
    v_mfma_f32_16x16x32_bf16 a[188:191], v[136:139], v[104:107], a[188:191]
    v_cvt_pk_bf16_f32 v110, v100, v101
    v_add_f32 v24, v24, v102
    v_mfma_f32_16x16x32_bf16 a[216:219], v[140:143], v[104:107], a[216:219]
    v_add_f32 v25, v25, v103
    v_cvt_pk_bf16_f32 v111, v102, v103
    v_mfma_f32_16x16x32_bf16 v[96:99], v[56:59], a[16:19], v[32:35]
    v_mfma_f32_16x16x32_bf16 v[96:99], v[60:63], a[20:23], v[96:99]
    v_exp_f32 v88, v88
    v_mfma_f32_16x16x32_bf16 v[96:99], v[64:67], a[24:27], v[96:99]
    v_exp_f32 v89, v89
    v_mfma_f32_16x16x32_bf16 v[96:99], v[68:71], a[28:31], v[96:99]
    v_exp_f32 v90, v90
    v_mfma_f32_16x16x32_bf16 v[100:103], v[72:75], a[16:19], v[32:35]
    v_exp_f32 v91, v91
    v_mfma_f32_16x16x32_bf16 v[100:103], v[76:79], a[20:23], v[100:103]
    v_add_f32 v12, v12, v88
    v_add_f32 v13, v13, v89
    v_mfma_f32_16x16x32_bf16 v[100:103], v[80:83], a[24:27], v[100:103]
    v_cvt_pk_bf16_f32 v104, v88, v89
    v_mfma_f32_16x16x32_bf16 v[100:103], v[84:87], a[28:31], v[100:103]
    v_exp_f32 v92, v92
    v_mfma_f32_16x16x32_bf16 v[168:171], v[112:115], v[108:111], v[168:171]
    ds_read_b64_tr_b16 v[112:113], v9 offset:16896
    ds_read_b64_tr_b16 v[114:115], v9 offset:17408
    v_exp_f32 v93, v93
    v_mfma_f32_16x16x32_bf16 v[196:199], v[116:119], v[108:111], v[196:199]
    ds_read_b64_tr_b16 v[116:117], v9 offset:16928
    ds_read_b64_tr_b16 v[118:119], v9 offset:17440
    v_add_f32 v12, v12, v90
    v_add_f32 v13, v13, v91
    v_mfma_f32_16x16x32_bf16 v[224:227], v[120:123], v[108:111], v[224:227]
    ds_read_b64_tr_b16 v[120:121], v9 offset:16960
    ds_read_b64_tr_b16 v[122:123], v9 offset:17472
    v_cvt_pk_bf16_f32 v105, v90, v91
    v_mfma_f32_16x16x32_bf16 v[252:255], v[124:127], v[108:111], v[252:255]
    ds_read_b64_tr_b16 v[124:125], v9 offset:16992
    ds_read_b64_tr_b16 v[126:127], v9 offset:17504
    v_exp_f32 v94, v94
    v_mfma_f32_16x16x32_bf16 a[136:139], v[128:131], v[108:111], a[136:139]
    ds_read_b64_tr_b16 v[128:129], v9 offset:17024
    ds_read_b64_tr_b16 v[130:131], v9 offset:17536
    v_exp_f32 v95, v95
    v_mfma_f32_16x16x32_bf16 a[164:167], v[132:135], v[108:111], a[164:167]
    ds_read_b64_tr_b16 v[132:133], v9 offset:17056
    ds_read_b64_tr_b16 v[134:135], v9 offset:17568
    v_add_f32 v12, v12, v92
    v_add_f32 v13, v13, v93
    v_mfma_f32_16x16x32_bf16 a[192:195], v[136:139], v[108:111], a[192:195]
    ds_read_b64_tr_b16 v[136:137], v9 offset:17088
    ds_read_b64_tr_b16 v[138:139], v9 offset:17600
    v_cvt_pk_bf16_f32 v106, v92, v93
    v_add_f32 v12, v12, v94
    v_mfma_f32_16x16x32_bf16 a[220:223], v[140:143], v[108:111], a[220:223]
    ds_read_b64_tr_b16 v[140:141], v9 offset:17120
    ds_read_b64_tr_b16 v[142:143], v9 offset:17632
    v_add_f32 v13, v13, v95
    v_cvt_pk_bf16_f32 v107, v94, v95
    v_mfma_f32_16x16x32_bf16 v[88:91], v[56:59], a[32:35], v[36:39]
    v_mfma_f32_16x16x32_bf16 v[88:91], v[60:63], a[36:39], v[88:91]
    s_add_u32 s29, s34, s100
    v_exp_f32 v96, v96
    v_mfma_f32_16x16x32_bf16 v[88:91], v[64:67], a[40:43], v[88:91]
    v_exp_f32 v97, v97
    v_mfma_f32_16x16x32_bf16 v[88:91], v[68:71], a[44:47], v[88:91]
    s_bfe_u32 s28, s29, 0x20003
    v_exp_f32 v98, v98
    v_mfma_f32_16x16x32_bf16 v[92:95], v[72:75], a[32:35], v[36:39]
    v_exp_f32 v99, v99
    v_mfma_f32_16x16x32_bf16 v[92:95], v[76:79], a[36:39], v[92:95]
    s_lshl_b32 s28, s28, 16
    v_add_f32 v14, v14, v96
    v_add_f32 v15, v15, v97
    v_mfma_f32_16x16x32_bf16 v[92:95], v[80:83], a[40:43], v[92:95]
    v_cvt_pk_bf16_f32 v108, v96, v97
    v_mfma_f32_16x16x32_bf16 v[92:95], v[84:87], a[44:47], v[92:95]
    v_exp_f32 v100, v100
    s_waitcnt lgkmcnt(0)
    v_mfma_f32_16x16x32_bf16 v[144:147], v[112:115], v[104:107], v[144:147]
    s_and_b32 s29, s29, 7
    v_exp_f32 v101, v101
    v_mfma_f32_16x16x32_bf16 v[172:175], v[116:119], v[104:107], v[172:175]
    v_add_f32 v14, v14, v98
    v_add_f32 v15, v15, v99
    v_mfma_f32_16x16x32_bf16 v[200:203], v[120:123], v[104:107], v[200:203]
    s_lshl_b32 s29, s29, 11
    v_cvt_pk_bf16_f32 v109, v98, v99
    v_mfma_f32_16x16x32_bf16 v[228:231], v[124:127], v[104:107], v[228:231]
    v_exp_f32 v102, v102
    v_mfma_f32_16x16x32_bf16 a[112:115], v[128:131], v[104:107], a[112:115]
    s_add_u32 s29, s28, s29
    v_exp_f32 v103, v103
    v_mfma_f32_16x16x32_bf16 a[140:143], v[132:135], v[104:107], a[140:143]
    v_add_f32 v14, v14, v100
    v_add_f32 v15, v15, v101
    v_mfma_f32_16x16x32_bf16 a[168:171], v[136:139], v[104:107], a[168:171]
    s_lshr_b32 s28, s34, 5
    v_cvt_pk_bf16_f32 v110, v100, v101
    v_add_f32 v14, v14, v102
    v_mfma_f32_16x16x32_bf16 a[196:199], v[140:143], v[104:107], a[196:199]
    v_add_f32 v15, v15, v103
    v_cvt_pk_bf16_f32 v111, v102, v103
    v_mfma_f32_16x16x32_bf16 v[96:99], v[56:59], a[48:51], v[40:43]
    v_mfma_f32_16x16x32_bf16 v[96:99], v[60:63], a[52:55], v[96:99]
    s_lshl_b32 s28, s28, 19
    v_exp_f32 v88, v88
    v_mfma_f32_16x16x32_bf16 v[96:99], v[64:67], a[56:59], v[96:99]
    v_exp_f32 v89, v89
    v_mfma_f32_16x16x32_bf16 v[96:99], v[68:71], a[60:63], v[96:99]
    s_add_u32 s49, s28, s29
    v_exp_f32 v90, v90
    v_mfma_f32_16x16x32_bf16 v[100:103], v[72:75], a[48:51], v[40:43]
    v_exp_f32 v91, v91
    v_mfma_f32_16x16x32_bf16 v[100:103], v[76:79], a[52:55], v[100:103]
    s_add_u32 m0, s33, 8448
    v_add_f32 v16, v16, v88
    v_add_f32 v17, v17, v89
    v_mfma_f32_16x16x32_bf16 v[100:103], v[80:83], a[56:59], v[100:103]
    v_cvt_pk_bf16_f32 v104, v88, v89
    v_mfma_f32_16x16x32_bf16 v[100:103], v[84:87], a[60:63], v[100:103]
    v_exp_f32 v92, v92
    v_mfma_f32_16x16x32_bf16 v[148:151], v[112:115], v[108:111], v[148:151]
    s_add_u32 s34, s34, 1
    v_exp_f32 v93, v93
    v_mfma_f32_16x16x32_bf16 v[176:179], v[116:119], v[108:111], v[176:179]
    v_add_f32 v16, v16, v90
    v_add_f32 v17, v17, v91
    v_mfma_f32_16x16x32_bf16 v[204:207], v[120:123], v[108:111], v[204:207]
    buffer_load_dwordx4 v7, s[4:7], s49 offen offset:0 nt lds
    v_cvt_pk_bf16_f32 v105, v90, v91
    v_mfma_f32_16x16x32_bf16 v[232:235], v[124:127], v[108:111], v[232:235]
    v_exp_f32 v94, v94
    v_mfma_f32_16x16x32_bf16 a[116:119], v[128:131], v[108:111], a[116:119]
    s_add_u32 m0, m0, s96
    v_exp_f32 v95, v95
    v_mfma_f32_16x16x32_bf16 a[144:147], v[132:135], v[108:111], a[144:147]
    v_add_f32 v16, v16, v92
    v_add_f32 v17, v17, v93
    v_mfma_f32_16x16x32_bf16 a[172:175], v[136:139], v[108:111], a[172:175]
    buffer_load_dwordx4 v7, s[4:7], s49 offen offset:256 nt lds
    v_cvt_pk_bf16_f32 v106, v92, v93
    v_add_f32 v16, v16, v94
    v_mfma_f32_16x16x32_bf16 a[200:203], v[140:143], v[108:111], a[200:203]
    v_add_f32 v17, v17, v95
    v_cvt_pk_bf16_f32 v107, v94, v95
    v_mfma_f32_16x16x32_bf16 v[88:91], v[56:59], a[64:67], v[44:47]
    v_mfma_f32_16x16x32_bf16 v[88:91], v[60:63], a[68:71], v[88:91]
    s_add_u32 m0, m0, s97
    v_exp_f32 v96, v96
    v_mfma_f32_16x16x32_bf16 v[88:91], v[64:67], a[72:75], v[88:91]
    v_exp_f32 v97, v97
    v_mfma_f32_16x16x32_bf16 v[88:91], v[68:71], a[76:79], v[88:91]
    buffer_load_dwordx4 v7, s[4:7], s49 offen offset:512 nt lds
    v_exp_f32 v98, v98
    v_mfma_f32_16x16x32_bf16 v[92:95], v[72:75], a[64:67], v[44:47]
    v_exp_f32 v99, v99
    v_mfma_f32_16x16x32_bf16 v[92:95], v[76:79], a[68:71], v[92:95]
    s_add_u32 m0, m0, s96
    v_add_f32 v18, v18, v96
    v_add_f32 v19, v19, v97
    v_mfma_f32_16x16x32_bf16 v[92:95], v[80:83], a[72:75], v[92:95]
    v_cvt_pk_bf16_f32 v108, v96, v97
    v_mfma_f32_16x16x32_bf16 v[92:95], v[84:87], a[76:79], v[92:95]
    v_exp_f32 v100, v100
    v_mfma_f32_16x16x32_bf16 v[152:155], v[112:115], v[104:107], v[152:155]
    buffer_load_dwordx4 v7, s[4:7], s49 offen offset:768 nt lds
    v_exp_f32 v101, v101
    v_mfma_f32_16x16x32_bf16 v[180:183], v[116:119], v[104:107], v[180:183]
    v_add_f32 v18, v18, v98
    v_add_f32 v19, v19, v99
    v_mfma_f32_16x16x32_bf16 v[208:211], v[120:123], v[104:107], v[208:211]
    s_add_u32 m0, m0, s97
    v_cvt_pk_bf16_f32 v109, v98, v99
    v_mfma_f32_16x16x32_bf16 v[236:239], v[124:127], v[104:107], v[236:239]
    v_exp_f32 v102, v102
    v_mfma_f32_16x16x32_bf16 a[120:123], v[128:131], v[104:107], a[120:123]
    buffer_load_dwordx4 v7, s[4:7], s49 offen offset:1024 nt lds
    v_exp_f32 v103, v103
    v_mfma_f32_16x16x32_bf16 a[148:151], v[132:135], v[104:107], a[148:151]
    v_add_f32 v18, v18, v100
    v_add_f32 v19, v19, v101
    v_mfma_f32_16x16x32_bf16 a[176:179], v[136:139], v[104:107], a[176:179]
    s_add_u32 m0, m0, s96
    v_cvt_pk_bf16_f32 v110, v100, v101
    v_add_f32 v18, v18, v102
    v_mfma_f32_16x16x32_bf16 a[204:207], v[140:143], v[104:107], a[204:207]
    v_add_f32 v19, v19, v103
    v_cvt_pk_bf16_f32 v111, v102, v103
    v_mfma_f32_16x16x32_bf16 v[96:99], v[56:59], a[80:83], v[48:51]
    v_mfma_f32_16x16x32_bf16 v[96:99], v[60:63], a[84:87], v[96:99]
    buffer_load_dwordx4 v7, s[4:7], s49 offen offset:1280 nt lds
    v_exp_f32 v88, v88
    v_mfma_f32_16x16x32_bf16 v[96:99], v[64:67], a[88:91], v[96:99]
    v_exp_f32 v89, v89
    v_mfma_f32_16x16x32_bf16 v[96:99], v[68:71], a[92:95], v[96:99]
    s_add_u32 m0, m0, s97
    v_exp_f32 v90, v90
    v_mfma_f32_16x16x32_bf16 v[100:103], v[72:75], a[80:83], v[48:51]
    v_exp_f32 v91, v91
    v_mfma_f32_16x16x32_bf16 v[100:103], v[76:79], a[84:87], v[100:103]
    buffer_load_dwordx4 v7, s[4:7], s49 offen offset:1536 nt lds
    v_add_f32 v20, v20, v88
    v_add_f32 v21, v21, v89
    v_mfma_f32_16x16x32_bf16 v[100:103], v[80:83], a[88:91], v[100:103]
    v_cvt_pk_bf16_f32 v104, v88, v89
    v_mfma_f32_16x16x32_bf16 v[100:103], v[84:87], a[92:95], v[100:103]
    v_exp_f32 v92, v92
    v_mfma_f32_16x16x32_bf16 v[156:159], v[112:115], v[108:111], v[156:159]
    s_add_u32 m0, m0, s96
    v_exp_f32 v93, v93
    v_mfma_f32_16x16x32_bf16 v[184:187], v[116:119], v[108:111], v[184:187]
    v_add_f32 v20, v20, v90
    v_add_f32 v21, v21, v91
    v_mfma_f32_16x16x32_bf16 v[212:215], v[120:123], v[108:111], v[212:215]
    buffer_load_dwordx4 v7, s[4:7], s49 offen offset:1792 nt lds
    v_cvt_pk_bf16_f32 v105, v90, v91
    v_mfma_f32_16x16x32_bf16 v[240:243], v[124:127], v[108:111], v[240:243]
    v_exp_f32 v94, v94
    v_mfma_f32_16x16x32_bf16 a[124:127], v[128:131], v[108:111], a[124:127]
    v_exp_f32 v95, v95
    v_mfma_f32_16x16x32_bf16 a[152:155], v[132:135], v[108:111], a[152:155]
    v_add_f32 v20, v20, v92
    v_add_f32 v21, v21, v93
    v_mfma_f32_16x16x32_bf16 a[180:183], v[136:139], v[108:111], a[180:183]
    v_cvt_pk_bf16_f32 v106, v92, v93
    v_add_f32 v20, v20, v94
    v_mfma_f32_16x16x32_bf16 a[208:211], v[140:143], v[108:111], a[208:211]
    v_add_f32 v21, v21, v95
    v_cvt_pk_bf16_f32 v107, v94, v95
    s_waitcnt vmcnt(16) lgkmcnt(0)
    s_barrier
    v_mfma_f32_16x16x32_bf16 v[88:91], v[56:59], a[96:99], v[52:55]
    ds_read_b128 v[56:59], v8 offset:25344
    v_mfma_f32_16x16x32_bf16 v[88:91], v[60:63], a[100:103], v[88:91]
    ds_read_b128 v[60:63], v8 offset:25408
    v_exp_f32 v96, v96
    v_mfma_f32_16x16x32_bf16 v[88:91], v[64:67], a[104:107], v[88:91]
    ds_read_b128 v[64:67], v8 offset:25472
    v_exp_f32 v97, v97
    v_mfma_f32_16x16x32_bf16 v[88:91], v[68:71], a[108:111], v[88:91]
    ds_read_b128 v[68:71], v8 offset:25536
    v_exp_f32 v98, v98
    v_mfma_f32_16x16x32_bf16 v[92:95], v[72:75], a[96:99], v[52:55]
    ds_read_b128 v[72:75], v8 offset:25856
    v_exp_f32 v99, v99
    v_mfma_f32_16x16x32_bf16 v[92:95], v[76:79], a[100:103], v[92:95]
    ds_read_b128 v[76:79], v8 offset:25920
    v_add_f32 v22, v22, v96
    v_add_f32 v23, v23, v97
    v_mfma_f32_16x16x32_bf16 v[92:95], v[80:83], a[104:107], v[92:95]
    ds_read_b128 v[80:83], v8 offset:25984
    v_cvt_pk_bf16_f32 v108, v96, v97
    v_mfma_f32_16x16x32_bf16 v[92:95], v[84:87], a[108:111], v[92:95]
    ds_read_b128 v[84:87], v8 offset:26048
    v_exp_f32 v100, v100
    v_mfma_f32_16x16x32_bf16 v[160:163], v[112:115], v[104:107], v[160:163]
    v_exp_f32 v101, v101
    v_mfma_f32_16x16x32_bf16 v[188:191], v[116:119], v[104:107], v[188:191]
    v_add_f32 v22, v22, v98
    v_add_f32 v23, v23, v99
    v_mfma_f32_16x16x32_bf16 v[216:219], v[120:123], v[104:107], v[216:219]
    v_cvt_pk_bf16_f32 v109, v98, v99
    v_mfma_f32_16x16x32_bf16 v[244:247], v[124:127], v[104:107], v[244:247]
    v_exp_f32 v102, v102
    v_mfma_f32_16x16x32_bf16 a[128:131], v[128:131], v[104:107], a[128:131]
    v_exp_f32 v103, v103
    v_mfma_f32_16x16x32_bf16 a[156:159], v[132:135], v[104:107], a[156:159]
    v_add_f32 v22, v22, v100
    v_add_f32 v23, v23, v101
    v_mfma_f32_16x16x32_bf16 a[184:187], v[136:139], v[104:107], a[184:187]
    v_cvt_pk_bf16_f32 v110, v100, v101
    v_add_f32 v22, v22, v102
    v_mfma_f32_16x16x32_bf16 a[212:215], v[140:143], v[104:107], a[212:215]
    v_add_f32 v23, v23, v103
    v_cvt_pk_bf16_f32 v111, v102, v103
    s_waitcnt lgkmcnt(0)
    v_mfma_f32_16x16x32_bf16 v[96:99], v[56:59], a[0:3], v[28:31]
    v_mfma_f32_16x16x32_bf16 v[96:99], v[60:63], a[4:7], v[96:99]
    v_exp_f32 v88, v88
    v_mfma_f32_16x16x32_bf16 v[96:99], v[64:67], a[8:11], v[96:99]
    v_exp_f32 v89, v89
    v_mfma_f32_16x16x32_bf16 v[96:99], v[68:71], a[12:15], v[96:99]
    v_exp_f32 v90, v90
    v_mfma_f32_16x16x32_bf16 v[100:103], v[72:75], a[0:3], v[28:31]
    v_exp_f32 v91, v91
    v_mfma_f32_16x16x32_bf16 v[100:103], v[76:79], a[4:7], v[100:103]
    v_add_f32 v24, v24, v88
    v_add_f32 v25, v25, v89
    v_mfma_f32_16x16x32_bf16 v[100:103], v[80:83], a[8:11], v[100:103]
    v_cvt_pk_bf16_f32 v104, v88, v89
    v_mfma_f32_16x16x32_bf16 v[100:103], v[84:87], a[12:15], v[100:103]
    v_exp_f32 v92, v92
    v_mfma_f32_16x16x32_bf16 v[164:167], v[112:115], v[108:111], v[164:167]
    v_exp_f32 v93, v93
    v_mfma_f32_16x16x32_bf16 v[192:195], v[116:119], v[108:111], v[192:195]
    v_add_f32 v24, v24, v90
    v_add_f32 v25, v25, v91
    v_mfma_f32_16x16x32_bf16 v[220:223], v[120:123], v[108:111], v[220:223]
    v_cvt_pk_bf16_f32 v105, v90, v91
    v_mfma_f32_16x16x32_bf16 v[248:251], v[124:127], v[108:111], v[248:251]
    v_exp_f32 v94, v94
    v_mfma_f32_16x16x32_bf16 a[132:135], v[128:131], v[108:111], a[132:135]
    v_exp_f32 v95, v95
    v_mfma_f32_16x16x32_bf16 a[160:163], v[132:135], v[108:111], a[160:163]
    v_add_f32 v24, v24, v92
    v_add_f32 v25, v25, v93
    v_mfma_f32_16x16x32_bf16 a[188:191], v[136:139], v[108:111], a[188:191]
    v_cvt_pk_bf16_f32 v106, v92, v93
    v_add_f32 v24, v24, v94
    v_mfma_f32_16x16x32_bf16 a[216:219], v[140:143], v[108:111], a[216:219]
    v_add_f32 v25, v25, v95
    v_cvt_pk_bf16_f32 v107, v94, v95
    v_mfma_f32_16x16x32_bf16 v[88:91], v[56:59], a[16:19], v[32:35]
    v_mfma_f32_16x16x32_bf16 v[88:91], v[60:63], a[20:23], v[88:91]
    v_exp_f32 v96, v96
    v_mfma_f32_16x16x32_bf16 v[88:91], v[64:67], a[24:27], v[88:91]
    v_exp_f32 v97, v97
    v_mfma_f32_16x16x32_bf16 v[88:91], v[68:71], a[28:31], v[88:91]
    v_exp_f32 v98, v98
    v_mfma_f32_16x16x32_bf16 v[92:95], v[72:75], a[16:19], v[32:35]
    v_exp_f32 v99, v99
    v_mfma_f32_16x16x32_bf16 v[92:95], v[76:79], a[20:23], v[92:95]
    v_add_f32 v12, v12, v96
    v_add_f32 v13, v13, v97
    v_mfma_f32_16x16x32_bf16 v[92:95], v[80:83], a[24:27], v[92:95]
    v_cvt_pk_bf16_f32 v108, v96, v97
    v_mfma_f32_16x16x32_bf16 v[92:95], v[84:87], a[28:31], v[92:95]
    v_exp_f32 v100, v100
    v_mfma_f32_16x16x32_bf16 v[168:171], v[112:115], v[104:107], v[168:171]
    ds_read_b64_tr_b16 v[112:113], v9 offset:25344
    ds_read_b64_tr_b16 v[114:115], v9 offset:25856
    v_exp_f32 v101, v101
    v_mfma_f32_16x16x32_bf16 v[196:199], v[116:119], v[104:107], v[196:199]
    ds_read_b64_tr_b16 v[116:117], v9 offset:25376
    ds_read_b64_tr_b16 v[118:119], v9 offset:25888
    v_add_f32 v12, v12, v98
    v_add_f32 v13, v13, v99
    v_mfma_f32_16x16x32_bf16 v[224:227], v[120:123], v[104:107], v[224:227]
    ds_read_b64_tr_b16 v[120:121], v9 offset:25408
    ds_read_b64_tr_b16 v[122:123], v9 offset:25920
    v_cvt_pk_bf16_f32 v109, v98, v99
    v_mfma_f32_16x16x32_bf16 v[252:255], v[124:127], v[104:107], v[252:255]
    ds_read_b64_tr_b16 v[124:125], v9 offset:25440
    ds_read_b64_tr_b16 v[126:127], v9 offset:25952
    v_exp_f32 v102, v102
    v_mfma_f32_16x16x32_bf16 a[136:139], v[128:131], v[104:107], a[136:139]
    ds_read_b64_tr_b16 v[128:129], v9 offset:25472
    ds_read_b64_tr_b16 v[130:131], v9 offset:25984
    v_exp_f32 v103, v103
    v_mfma_f32_16x16x32_bf16 a[164:167], v[132:135], v[104:107], a[164:167]
    ds_read_b64_tr_b16 v[132:133], v9 offset:25504
    ds_read_b64_tr_b16 v[134:135], v9 offset:26016
    v_add_f32 v12, v12, v100
    v_add_f32 v13, v13, v101
    v_mfma_f32_16x16x32_bf16 a[192:195], v[136:139], v[104:107], a[192:195]
    ds_read_b64_tr_b16 v[136:137], v9 offset:25536
    ds_read_b64_tr_b16 v[138:139], v9 offset:26048
    v_cvt_pk_bf16_f32 v110, v100, v101
    v_add_f32 v12, v12, v102
    v_mfma_f32_16x16x32_bf16 a[220:223], v[140:143], v[104:107], a[220:223]
    ds_read_b64_tr_b16 v[140:141], v9 offset:25568
    ds_read_b64_tr_b16 v[142:143], v9 offset:26080
    v_add_f32 v13, v13, v103
    v_cvt_pk_bf16_f32 v111, v102, v103
    v_mfma_f32_16x16x32_bf16 v[96:99], v[56:59], a[32:35], v[36:39]
    v_mfma_f32_16x16x32_bf16 v[96:99], v[60:63], a[36:39], v[96:99]
    s_add_u32 s29, s34, s100
    v_exp_f32 v88, v88
    v_mfma_f32_16x16x32_bf16 v[96:99], v[64:67], a[40:43], v[96:99]
    v_exp_f32 v89, v89
    v_mfma_f32_16x16x32_bf16 v[96:99], v[68:71], a[44:47], v[96:99]
    s_bfe_u32 s28, s29, 0x20003
    v_exp_f32 v90, v90
    v_mfma_f32_16x16x32_bf16 v[100:103], v[72:75], a[32:35], v[36:39]
    v_exp_f32 v91, v91
    v_mfma_f32_16x16x32_bf16 v[100:103], v[76:79], a[36:39], v[100:103]
    s_lshl_b32 s28, s28, 16
    v_add_f32 v14, v14, v88
    v_add_f32 v15, v15, v89
    v_mfma_f32_16x16x32_bf16 v[100:103], v[80:83], a[40:43], v[100:103]
    v_cvt_pk_bf16_f32 v104, v88, v89
    v_mfma_f32_16x16x32_bf16 v[100:103], v[84:87], a[44:47], v[100:103]
    v_exp_f32 v92, v92
    s_waitcnt lgkmcnt(0)
    v_mfma_f32_16x16x32_bf16 v[144:147], v[112:115], v[108:111], v[144:147]
    s_and_b32 s29, s29, 7
    v_exp_f32 v93, v93
    v_mfma_f32_16x16x32_bf16 v[172:175], v[116:119], v[108:111], v[172:175]
    v_add_f32 v14, v14, v90
    v_add_f32 v15, v15, v91
    v_mfma_f32_16x16x32_bf16 v[200:203], v[120:123], v[108:111], v[200:203]
    s_lshl_b32 s29, s29, 11
    v_cvt_pk_bf16_f32 v105, v90, v91
    v_mfma_f32_16x16x32_bf16 v[228:231], v[124:127], v[108:111], v[228:231]
    v_exp_f32 v94, v94
    v_mfma_f32_16x16x32_bf16 a[112:115], v[128:131], v[108:111], a[112:115]
    s_add_u32 s29, s28, s29
    v_exp_f32 v95, v95
    v_mfma_f32_16x16x32_bf16 a[140:143], v[132:135], v[108:111], a[140:143]
    v_add_f32 v14, v14, v92
    v_add_f32 v15, v15, v93
    v_mfma_f32_16x16x32_bf16 a[168:171], v[136:139], v[108:111], a[168:171]
    s_lshr_b32 s28, s34, 5
    v_cvt_pk_bf16_f32 v106, v92, v93
    v_add_f32 v14, v14, v94
    v_mfma_f32_16x16x32_bf16 a[196:199], v[140:143], v[108:111], a[196:199]
    v_add_f32 v15, v15, v95
    v_cvt_pk_bf16_f32 v107, v94, v95
    v_mfma_f32_16x16x32_bf16 v[88:91], v[56:59], a[48:51], v[40:43]
    v_mfma_f32_16x16x32_bf16 v[88:91], v[60:63], a[52:55], v[88:91]
    s_lshl_b32 s28, s28, 19
    v_exp_f32 v96, v96
    v_mfma_f32_16x16x32_bf16 v[88:91], v[64:67], a[56:59], v[88:91]
    v_exp_f32 v97, v97
    v_mfma_f32_16x16x32_bf16 v[88:91], v[68:71], a[60:63], v[88:91]
    s_add_u32 s49, s28, s29
    v_exp_f32 v98, v98
    v_mfma_f32_16x16x32_bf16 v[92:95], v[72:75], a[48:51], v[40:43]
    v_exp_f32 v99, v99
    v_mfma_f32_16x16x32_bf16 v[92:95], v[76:79], a[52:55], v[92:95]
    s_add_u32 m0, s33, 16896
    v_add_f32 v16, v16, v96
    v_add_f32 v17, v17, v97
    v_mfma_f32_16x16x32_bf16 v[92:95], v[80:83], a[56:59], v[92:95]
    v_cvt_pk_bf16_f32 v108, v96, v97
    v_mfma_f32_16x16x32_bf16 v[92:95], v[84:87], a[60:63], v[92:95]
    v_exp_f32 v100, v100
    v_mfma_f32_16x16x32_bf16 v[148:151], v[112:115], v[104:107], v[148:151]
    s_add_u32 s34, s34, 1
    v_exp_f32 v101, v101
    v_mfma_f32_16x16x32_bf16 v[176:179], v[116:119], v[104:107], v[176:179]
    v_add_f32 v16, v16, v98
    v_add_f32 v17, v17, v99
    v_mfma_f32_16x16x32_bf16 v[204:207], v[120:123], v[104:107], v[204:207]
    buffer_load_dwordx4 v7, s[4:7], s49 offen offset:0 nt lds
    v_cvt_pk_bf16_f32 v109, v98, v99
    v_mfma_f32_16x16x32_bf16 v[232:235], v[124:127], v[104:107], v[232:235]
    v_exp_f32 v102, v102
    v_mfma_f32_16x16x32_bf16 a[116:119], v[128:131], v[104:107], a[116:119]
    s_add_u32 m0, m0, s96
    v_exp_f32 v103, v103
    v_mfma_f32_16x16x32_bf16 a[144:147], v[132:135], v[104:107], a[144:147]
    v_add_f32 v16, v16, v100
    v_add_f32 v17, v17, v101
    v_mfma_f32_16x16x32_bf16 a[172:175], v[136:139], v[104:107], a[172:175]
    buffer_load_dwordx4 v7, s[4:7], s49 offen offset:256 nt lds
    v_cvt_pk_bf16_f32 v110, v100, v101
    v_add_f32 v16, v16, v102
    v_mfma_f32_16x16x32_bf16 a[200:203], v[140:143], v[104:107], a[200:203]
    v_add_f32 v17, v17, v103
    v_cvt_pk_bf16_f32 v111, v102, v103
    v_mfma_f32_16x16x32_bf16 v[96:99], v[56:59], a[64:67], v[44:47]
    v_mfma_f32_16x16x32_bf16 v[96:99], v[60:63], a[68:71], v[96:99]
    s_add_u32 m0, m0, s97
    v_exp_f32 v88, v88
    v_mfma_f32_16x16x32_bf16 v[96:99], v[64:67], a[72:75], v[96:99]
    v_exp_f32 v89, v89
    v_mfma_f32_16x16x32_bf16 v[96:99], v[68:71], a[76:79], v[96:99]
    buffer_load_dwordx4 v7, s[4:7], s49 offen offset:512 nt lds
    v_exp_f32 v90, v90
    v_mfma_f32_16x16x32_bf16 v[100:103], v[72:75], a[64:67], v[44:47]
    v_exp_f32 v91, v91
    v_mfma_f32_16x16x32_bf16 v[100:103], v[76:79], a[68:71], v[100:103]
    s_add_u32 m0, m0, s96
    v_add_f32 v18, v18, v88
    v_add_f32 v19, v19, v89
    v_mfma_f32_16x16x32_bf16 v[100:103], v[80:83], a[72:75], v[100:103]
    v_cvt_pk_bf16_f32 v104, v88, v89
    v_mfma_f32_16x16x32_bf16 v[100:103], v[84:87], a[76:79], v[100:103]
    v_exp_f32 v92, v92
    v_mfma_f32_16x16x32_bf16 v[152:155], v[112:115], v[108:111], v[152:155]
    buffer_load_dwordx4 v7, s[4:7], s49 offen offset:768 nt lds
    v_exp_f32 v93, v93
    v_mfma_f32_16x16x32_bf16 v[180:183], v[116:119], v[108:111], v[180:183]
    v_add_f32 v18, v18, v90
    v_add_f32 v19, v19, v91
    v_mfma_f32_16x16x32_bf16 v[208:211], v[120:123], v[108:111], v[208:211]
    s_add_u32 m0, m0, s97
    v_cvt_pk_bf16_f32 v105, v90, v91
    v_mfma_f32_16x16x32_bf16 v[236:239], v[124:127], v[108:111], v[236:239]
    v_exp_f32 v94, v94
    v_mfma_f32_16x16x32_bf16 a[120:123], v[128:131], v[108:111], a[120:123]
    buffer_load_dwordx4 v7, s[4:7], s49 offen offset:1024 nt lds
    v_exp_f32 v95, v95
    v_mfma_f32_16x16x32_bf16 a[148:151], v[132:135], v[108:111], a[148:151]
    v_add_f32 v18, v18, v92
    v_add_f32 v19, v19, v93
    v_mfma_f32_16x16x32_bf16 a[176:179], v[136:139], v[108:111], a[176:179]
    s_add_u32 m0, m0, s96
    v_cvt_pk_bf16_f32 v106, v92, v93
    v_add_f32 v18, v18, v94
    v_mfma_f32_16x16x32_bf16 a[204:207], v[140:143], v[108:111], a[204:207]
    v_add_f32 v19, v19, v95
    v_cvt_pk_bf16_f32 v107, v94, v95
    v_mfma_f32_16x16x32_bf16 v[88:91], v[56:59], a[80:83], v[48:51]
    v_mfma_f32_16x16x32_bf16 v[88:91], v[60:63], a[84:87], v[88:91]
    buffer_load_dwordx4 v7, s[4:7], s49 offen offset:1280 nt lds
    v_exp_f32 v96, v96
    v_mfma_f32_16x16x32_bf16 v[88:91], v[64:67], a[88:91], v[88:91]
    v_exp_f32 v97, v97
    v_mfma_f32_16x16x32_bf16 v[88:91], v[68:71], a[92:95], v[88:91]
    s_add_u32 m0, m0, s97
    v_exp_f32 v98, v98
    v_mfma_f32_16x16x32_bf16 v[92:95], v[72:75], a[80:83], v[48:51]
    v_exp_f32 v99, v99
    v_mfma_f32_16x16x32_bf16 v[92:95], v[76:79], a[84:87], v[92:95]
    buffer_load_dwordx4 v7, s[4:7], s49 offen offset:1536 nt lds
    v_add_f32 v20, v20, v96
    v_add_f32 v21, v21, v97
    v_mfma_f32_16x16x32_bf16 v[92:95], v[80:83], a[88:91], v[92:95]
    v_cvt_pk_bf16_f32 v108, v96, v97
    v_mfma_f32_16x16x32_bf16 v[92:95], v[84:87], a[92:95], v[92:95]
    v_exp_f32 v100, v100
    v_mfma_f32_16x16x32_bf16 v[156:159], v[112:115], v[104:107], v[156:159]
    s_add_u32 m0, m0, s96
    v_exp_f32 v101, v101
    v_mfma_f32_16x16x32_bf16 v[184:187], v[116:119], v[104:107], v[184:187]
    v_add_f32 v20, v20, v98
    v_add_f32 v21, v21, v99
    v_mfma_f32_16x16x32_bf16 v[212:215], v[120:123], v[104:107], v[212:215]
    buffer_load_dwordx4 v7, s[4:7], s49 offen offset:1792 nt lds
    v_cvt_pk_bf16_f32 v109, v98, v99
    v_mfma_f32_16x16x32_bf16 v[240:243], v[124:127], v[104:107], v[240:243]
    v_exp_f32 v102, v102
    v_mfma_f32_16x16x32_bf16 a[124:127], v[128:131], v[104:107], a[124:127]
    v_exp_f32 v103, v103
    v_mfma_f32_16x16x32_bf16 a[152:155], v[132:135], v[104:107], a[152:155]
    v_add_f32 v20, v20, v100
    v_add_f32 v21, v21, v101
    v_mfma_f32_16x16x32_bf16 a[180:183], v[136:139], v[104:107], a[180:183]
    v_cvt_pk_bf16_f32 v110, v100, v101
    v_add_f32 v20, v20, v102
    v_mfma_f32_16x16x32_bf16 a[208:211], v[140:143], v[104:107], a[208:211]
    v_add_f32 v21, v21, v103
    v_cvt_pk_bf16_f32 v111, v102, v103
    s_waitcnt vmcnt(16) lgkmcnt(0)
    s_barrier
    v_mfma_f32_16x16x32_bf16 v[96:99], v[56:59], a[96:99], v[52:55]
    ds_read_b128 v[56:59], v8 offset:0
    v_mfma_f32_16x16x32_bf16 v[96:99], v[60:63], a[100:103], v[96:99]
    ds_read_b128 v[60:63], v8 offset:64
    v_exp_f32 v88, v88
    v_mfma_f32_16x16x32_bf16 v[96:99], v[64:67], a[104:107], v[96:99]
    ds_read_b128 v[64:67], v8 offset:128
    v_exp_f32 v89, v89
    v_mfma_f32_16x16x32_bf16 v[96:99], v[68:71], a[108:111], v[96:99]
    ds_read_b128 v[68:71], v8 offset:192
    v_exp_f32 v90, v90
    v_mfma_f32_16x16x32_bf16 v[100:103], v[72:75], a[96:99], v[52:55]
    ds_read_b128 v[72:75], v8 offset:512
    v_exp_f32 v91, v91
    v_mfma_f32_16x16x32_bf16 v[100:103], v[76:79], a[100:103], v[100:103]
    ds_read_b128 v[76:79], v8 offset:576
    v_add_f32 v22, v22, v88
    v_add_f32 v23, v23, v89
    v_mfma_f32_16x16x32_bf16 v[100:103], v[80:83], a[104:107], v[100:103]
    ds_read_b128 v[80:83], v8 offset:640
    v_cvt_pk_bf16_f32 v104, v88, v89
    v_mfma_f32_16x16x32_bf16 v[100:103], v[84:87], a[108:111], v[100:103]
    ds_read_b128 v[84:87], v8 offset:704
    v_exp_f32 v92, v92
    v_mfma_f32_16x16x32_bf16 v[160:163], v[112:115], v[108:111], v[160:163]
    v_exp_f32 v93, v93
    v_mfma_f32_16x16x32_bf16 v[188:191], v[116:119], v[108:111], v[188:191]
    v_add_f32 v22, v22, v90
    v_add_f32 v23, v23, v91
    v_mfma_f32_16x16x32_bf16 v[216:219], v[120:123], v[108:111], v[216:219]
    v_cvt_pk_bf16_f32 v105, v90, v91
    v_mfma_f32_16x16x32_bf16 v[244:247], v[124:127], v[108:111], v[244:247]
    v_exp_f32 v94, v94
    v_mfma_f32_16x16x32_bf16 a[128:131], v[128:131], v[108:111], a[128:131]
    v_exp_f32 v95, v95
    v_mfma_f32_16x16x32_bf16 a[156:159], v[132:135], v[108:111], a[156:159]
    v_add_f32 v22, v22, v92
    v_add_f32 v23, v23, v93
    v_mfma_f32_16x16x32_bf16 a[184:187], v[136:139], v[108:111], a[184:187]
    v_cvt_pk_bf16_f32 v106, v92, v93
    v_add_f32 v22, v22, v94
    v_mfma_f32_16x16x32_bf16 a[212:215], v[140:143], v[108:111], a[212:215]
    v_add_f32 v23, v23, v95
    v_cvt_pk_bf16_f32 v107, v94, v95
    s_waitcnt lgkmcnt(0)
    v_mfma_f32_16x16x32_bf16 v[88:91], v[56:59], a[0:3], v[28:31]
    v_mfma_f32_16x16x32_bf16 v[88:91], v[60:63], a[4:7], v[88:91]
    v_exp_f32 v96, v96
    v_mfma_f32_16x16x32_bf16 v[88:91], v[64:67], a[8:11], v[88:91]
    v_exp_f32 v97, v97
    v_mfma_f32_16x16x32_bf16 v[88:91], v[68:71], a[12:15], v[88:91]
    v_exp_f32 v98, v98
    v_mfma_f32_16x16x32_bf16 v[92:95], v[72:75], a[0:3], v[28:31]
    v_exp_f32 v99, v99
    v_mfma_f32_16x16x32_bf16 v[92:95], v[76:79], a[4:7], v[92:95]
    v_add_f32 v24, v24, v96
    v_add_f32 v25, v25, v97
    v_mfma_f32_16x16x32_bf16 v[92:95], v[80:83], a[8:11], v[92:95]
    v_cvt_pk_bf16_f32 v108, v96, v97
    v_mfma_f32_16x16x32_bf16 v[92:95], v[84:87], a[12:15], v[92:95]
    v_exp_f32 v100, v100
    v_mfma_f32_16x16x32_bf16 v[164:167], v[112:115], v[104:107], v[164:167]
    v_exp_f32 v101, v101
    v_mfma_f32_16x16x32_bf16 v[192:195], v[116:119], v[104:107], v[192:195]
    v_add_f32 v24, v24, v98
    v_add_f32 v25, v25, v99
    v_mfma_f32_16x16x32_bf16 v[220:223], v[120:123], v[104:107], v[220:223]
    v_cvt_pk_bf16_f32 v109, v98, v99
    v_mfma_f32_16x16x32_bf16 v[248:251], v[124:127], v[104:107], v[248:251]
    v_exp_f32 v102, v102
    v_mfma_f32_16x16x32_bf16 a[132:135], v[128:131], v[104:107], a[132:135]
    v_exp_f32 v103, v103
    v_mfma_f32_16x16x32_bf16 a[160:163], v[132:135], v[104:107], a[160:163]
    v_add_f32 v24, v24, v100
    v_add_f32 v25, v25, v101
    v_mfma_f32_16x16x32_bf16 a[188:191], v[136:139], v[104:107], a[188:191]
    v_cvt_pk_bf16_f32 v110, v100, v101
    v_add_f32 v24, v24, v102
    v_mfma_f32_16x16x32_bf16 a[216:219], v[140:143], v[104:107], a[216:219]
    v_add_f32 v25, v25, v103
    v_cvt_pk_bf16_f32 v111, v102, v103
    s_mul_i32 s50, s21, s52
    s_mov_b32 s101, s21
    s_add_u32 s50, s50, s55
    s_cmp_ge_u32 s21, 2
    s_cselect_b32 s28, 0x40000000, 0
    s_add_u32 s50, s50, s28
    s_mov_b32 s82, s26
    s_mul_i32 s28, s26, s51
    s_add_u32 s50, s50, s28
    v_mfma_f32_16x16x32_bf16 v[96:99], v[56:59], a[16:19], v[32:35]
    v_mfma_f32_16x16x32_bf16 v[96:99], v[60:63], a[20:23], v[96:99]
    v_exp_f32 v88, v88
    v_mfma_f32_16x16x32_bf16 v[96:99], v[64:67], a[24:27], v[96:99]
    v_exp_f32 v89, v89
    v_mfma_f32_16x16x32_bf16 v[96:99], v[68:71], a[28:31], v[96:99]
    v_exp_f32 v90, v90
    v_mfma_f32_16x16x32_bf16 v[100:103], v[72:75], a[16:19], v[32:35]
    v_exp_f32 v91, v91
    v_mfma_f32_16x16x32_bf16 v[100:103], v[76:79], a[20:23], v[100:103]
    v_add_f32 v12, v12, v88
    v_add_f32 v13, v13, v89
    v_mfma_f32_16x16x32_bf16 v[100:103], v[80:83], a[24:27], v[100:103]
    v_cvt_pk_bf16_f32 v104, v88, v89
    v_mfma_f32_16x16x32_bf16 v[100:103], v[84:87], a[28:31], v[100:103]
    v_exp_f32 v92, v92
    v_mfma_f32_16x16x32_bf16 v[168:171], v[112:115], v[108:111], v[168:171]
    ds_read_b64_tr_b16 v[112:113], v9 offset:0
    ds_read_b64_tr_b16 v[114:115], v9 offset:512
    v_exp_f32 v93, v93
    v_mfma_f32_16x16x32_bf16 v[196:199], v[116:119], v[108:111], v[196:199]
    ds_read_b64_tr_b16 v[116:117], v9 offset:32
    ds_read_b64_tr_b16 v[118:119], v9 offset:544
    v_add_f32 v12, v12, v90
    v_add_f32 v13, v13, v91
    v_mfma_f32_16x16x32_bf16 v[224:227], v[120:123], v[108:111], v[224:227]
    ds_read_b64_tr_b16 v[120:121], v9 offset:64
    ds_read_b64_tr_b16 v[122:123], v9 offset:576
    v_cvt_pk_bf16_f32 v105, v90, v91
    v_mfma_f32_16x16x32_bf16 v[252:255], v[124:127], v[108:111], v[252:255]
    ds_read_b64_tr_b16 v[124:125], v9 offset:96
    ds_read_b64_tr_b16 v[126:127], v9 offset:608
    v_exp_f32 v94, v94
    v_mfma_f32_16x16x32_bf16 a[136:139], v[128:131], v[108:111], a[136:139]
    ds_read_b64_tr_b16 v[128:129], v9 offset:128
    ds_read_b64_tr_b16 v[130:131], v9 offset:640
    v_exp_f32 v95, v95
    v_mfma_f32_16x16x32_bf16 a[164:167], v[132:135], v[108:111], a[164:167]
    ds_read_b64_tr_b16 v[132:133], v9 offset:160
    ds_read_b64_tr_b16 v[134:135], v9 offset:672
    v_add_f32 v12, v12, v92
    v_add_f32 v13, v13, v93
    v_mfma_f32_16x16x32_bf16 a[192:195], v[136:139], v[108:111], a[192:195]
    ds_read_b64_tr_b16 v[136:137], v9 offset:192
    ds_read_b64_tr_b16 v[138:139], v9 offset:704
    v_cvt_pk_bf16_f32 v106, v92, v93
    v_add_f32 v12, v12, v94
    v_mfma_f32_16x16x32_bf16 a[220:223], v[140:143], v[108:111], a[220:223]
    ds_read_b64_tr_b16 v[140:141], v9 offset:224
    ds_read_b64_tr_b16 v[142:143], v9 offset:736
    v_add_f32 v13, v13, v95
    v_cvt_pk_bf16_f32 v107, v94, v95
    v_mfma_f32_16x16x32_bf16 v[88:91], v[56:59], a[32:35], v[36:39]
    v_mfma_f32_16x16x32_bf16 v[88:91], v[60:63], a[36:39], v[88:91]
    s_add_u32 s29, s34, s100
    v_exp_f32 v96, v96
    v_mfma_f32_16x16x32_bf16 v[88:91], v[64:67], a[40:43], v[88:91]
    v_exp_f32 v97, v97
    v_mfma_f32_16x16x32_bf16 v[88:91], v[68:71], a[44:47], v[88:91]
    s_bfe_u32 s28, s29, 0x20003
    v_exp_f32 v98, v98
    v_mfma_f32_16x16x32_bf16 v[92:95], v[72:75], a[32:35], v[36:39]
    v_exp_f32 v99, v99
    v_mfma_f32_16x16x32_bf16 v[92:95], v[76:79], a[36:39], v[92:95]
    s_lshl_b32 s28, s28, 16
    v_add_f32 v14, v14, v96
    v_add_f32 v15, v15, v97
    v_mfma_f32_16x16x32_bf16 v[92:95], v[80:83], a[40:43], v[92:95]
    v_cvt_pk_bf16_f32 v108, v96, v97
    v_mfma_f32_16x16x32_bf16 v[92:95], v[84:87], a[44:47], v[92:95]
    v_exp_f32 v100, v100
    s_waitcnt lgkmcnt(0)
    v_mfma_f32_16x16x32_bf16 v[144:147], v[112:115], v[104:107], v[144:147]
    s_and_b32 s29, s29, 7
    v_exp_f32 v101, v101
    v_mfma_f32_16x16x32_bf16 v[172:175], v[116:119], v[104:107], v[172:175]
    v_add_f32 v14, v14, v98
    v_add_f32 v15, v15, v99
    v_mfma_f32_16x16x32_bf16 v[200:203], v[120:123], v[104:107], v[200:203]
    s_lshl_b32 s29, s29, 11
    v_cvt_pk_bf16_f32 v109, v98, v99
    v_mfma_f32_16x16x32_bf16 v[228:231], v[124:127], v[104:107], v[228:231]
    v_exp_f32 v102, v102
    v_mfma_f32_16x16x32_bf16 a[112:115], v[128:131], v[104:107], a[112:115]
    s_add_u32 s29, s28, s29
    v_exp_f32 v103, v103
    v_mfma_f32_16x16x32_bf16 a[140:143], v[132:135], v[104:107], a[140:143]
    v_add_f32 v14, v14, v100
    v_add_f32 v15, v15, v101
    v_mfma_f32_16x16x32_bf16 a[168:171], v[136:139], v[104:107], a[168:171]
    s_lshr_b32 s28, s34, 5
    v_cvt_pk_bf16_f32 v110, v100, v101
    v_add_f32 v14, v14, v102
    v_mfma_f32_16x16x32_bf16 a[196:199], v[140:143], v[104:107], a[196:199]
    v_add_f32 v15, v15, v103
    v_cvt_pk_bf16_f32 v111, v102, v103
    v_mfma_f32_16x16x32_bf16 v[96:99], v[56:59], a[48:51], v[40:43]
    v_mfma_f32_16x16x32_bf16 v[96:99], v[60:63], a[52:55], v[96:99]
    s_lshl_b32 s28, s28, 19
    v_exp_f32 v88, v88
    v_mfma_f32_16x16x32_bf16 v[96:99], v[64:67], a[56:59], v[96:99]
    v_exp_f32 v89, v89
    v_mfma_f32_16x16x32_bf16 v[96:99], v[68:71], a[60:63], v[96:99]
    s_add_u32 s49, s28, s29
    v_exp_f32 v90, v90
    v_mfma_f32_16x16x32_bf16 v[100:103], v[72:75], a[48:51], v[40:43]
    v_exp_f32 v91, v91
    v_mfma_f32_16x16x32_bf16 v[100:103], v[76:79], a[52:55], v[100:103]
    s_add_u32 m0, s33, 25344
    v_add_f32 v16, v16, v88
    v_add_f32 v17, v17, v89
    v_mfma_f32_16x16x32_bf16 v[100:103], v[80:83], a[56:59], v[100:103]
    v_cvt_pk_bf16_f32 v104, v88, v89
    v_mfma_f32_16x16x32_bf16 v[100:103], v[84:87], a[60:63], v[100:103]
    v_exp_f32 v92, v92
    v_mfma_f32_16x16x32_bf16 v[148:151], v[112:115], v[108:111], v[148:151]
    s_add_u32 s34, s34, 1
    v_exp_f32 v93, v93
    v_mfma_f32_16x16x32_bf16 v[176:179], v[116:119], v[108:111], v[176:179]
    v_add_f32 v16, v16, v90
    v_add_f32 v17, v17, v91
    v_mfma_f32_16x16x32_bf16 v[204:207], v[120:123], v[108:111], v[204:207]
    buffer_load_dwordx4 v7, s[4:7], s49 offen offset:0 nt lds
    v_cvt_pk_bf16_f32 v105, v90, v91
    v_mfma_f32_16x16x32_bf16 v[232:235], v[124:127], v[108:111], v[232:235]
    v_exp_f32 v94, v94
    v_mfma_f32_16x16x32_bf16 a[116:119], v[128:131], v[108:111], a[116:119]
    s_add_u32 m0, m0, s96
    v_exp_f32 v95, v95
    v_mfma_f32_16x16x32_bf16 a[144:147], v[132:135], v[108:111], a[144:147]
    v_add_f32 v16, v16, v92
    v_add_f32 v17, v17, v93
    v_mfma_f32_16x16x32_bf16 a[172:175], v[136:139], v[108:111], a[172:175]
    buffer_load_dwordx4 v7, s[4:7], s49 offen offset:256 nt lds
    v_cvt_pk_bf16_f32 v106, v92, v93
    v_add_f32 v16, v16, v94
    v_mfma_f32_16x16x32_bf16 a[200:203], v[140:143], v[108:111], a[200:203]
    v_add_f32 v17, v17, v95
    v_cvt_pk_bf16_f32 v107, v94, v95
    v_mfma_f32_16x16x32_bf16 v[88:91], v[56:59], a[64:67], v[44:47]
    v_mfma_f32_16x16x32_bf16 v[88:91], v[60:63], a[68:71], v[88:91]
    s_add_u32 m0, m0, s97
    v_exp_f32 v96, v96
    v_mfma_f32_16x16x32_bf16 v[88:91], v[64:67], a[72:75], v[88:91]
    v_exp_f32 v97, v97
    v_mfma_f32_16x16x32_bf16 v[88:91], v[68:71], a[76:79], v[88:91]
    buffer_load_dwordx4 v7, s[4:7], s49 offen offset:512 nt lds
    v_exp_f32 v98, v98
    v_mfma_f32_16x16x32_bf16 v[92:95], v[72:75], a[64:67], v[44:47]
    v_exp_f32 v99, v99
    v_mfma_f32_16x16x32_bf16 v[92:95], v[76:79], a[68:71], v[92:95]
    s_add_u32 m0, m0, s96
    v_add_f32 v18, v18, v96
    v_add_f32 v19, v19, v97
    v_mfma_f32_16x16x32_bf16 v[92:95], v[80:83], a[72:75], v[92:95]
    v_cvt_pk_bf16_f32 v108, v96, v97
    v_mfma_f32_16x16x32_bf16 v[92:95], v[84:87], a[76:79], v[92:95]
    v_exp_f32 v100, v100
    v_mfma_f32_16x16x32_bf16 v[152:155], v[112:115], v[104:107], v[152:155]
    buffer_load_dwordx4 v7, s[4:7], s49 offen offset:768 nt lds
    v_exp_f32 v101, v101
    v_mfma_f32_16x16x32_bf16 v[180:183], v[116:119], v[104:107], v[180:183]
    v_add_f32 v18, v18, v98
    v_add_f32 v19, v19, v99
    v_mfma_f32_16x16x32_bf16 v[208:211], v[120:123], v[104:107], v[208:211]
    s_add_u32 m0, m0, s97
    v_cvt_pk_bf16_f32 v109, v98, v99
    v_mfma_f32_16x16x32_bf16 v[236:239], v[124:127], v[104:107], v[236:239]
    v_exp_f32 v102, v102
    v_mfma_f32_16x16x32_bf16 a[120:123], v[128:131], v[104:107], a[120:123]
    buffer_load_dwordx4 v7, s[4:7], s49 offen offset:1024 nt lds
    v_exp_f32 v103, v103
    v_mfma_f32_16x16x32_bf16 a[148:151], v[132:135], v[104:107], a[148:151]
    v_add_f32 v18, v18, v100
    v_add_f32 v19, v19, v101
    v_mfma_f32_16x16x32_bf16 a[176:179], v[136:139], v[104:107], a[176:179]
    s_add_u32 m0, m0, s96
    v_cvt_pk_bf16_f32 v110, v100, v101
    v_add_f32 v18, v18, v102
    v_mfma_f32_16x16x32_bf16 a[204:207], v[140:143], v[104:107], a[204:207]
    v_add_f32 v19, v19, v103
    v_cvt_pk_bf16_f32 v111, v102, v103
    v_mfma_f32_16x16x32_bf16 v[96:99], v[56:59], a[80:83], v[48:51]
    v_mfma_f32_16x16x32_bf16 v[96:99], v[60:63], a[84:87], v[96:99]
    buffer_load_dwordx4 v7, s[4:7], s49 offen offset:1280 nt lds
    v_exp_f32 v88, v88
    v_mfma_f32_16x16x32_bf16 v[96:99], v[64:67], a[88:91], v[96:99]
    v_exp_f32 v89, v89
    v_mfma_f32_16x16x32_bf16 v[96:99], v[68:71], a[92:95], v[96:99]
    s_add_u32 m0, m0, s97
    v_exp_f32 v90, v90
    v_mfma_f32_16x16x32_bf16 v[100:103], v[72:75], a[80:83], v[48:51]
    v_exp_f32 v91, v91
    v_mfma_f32_16x16x32_bf16 v[100:103], v[76:79], a[84:87], v[100:103]
    buffer_load_dwordx4 v7, s[4:7], s49 offen offset:1536 nt lds
    v_add_f32 v20, v20, v88
    v_add_f32 v21, v21, v89
    v_mfma_f32_16x16x32_bf16 v[100:103], v[80:83], a[88:91], v[100:103]
    v_cvt_pk_bf16_f32 v104, v88, v89
    v_mfma_f32_16x16x32_bf16 v[100:103], v[84:87], a[92:95], v[100:103]
    v_exp_f32 v92, v92
    v_mfma_f32_16x16x32_bf16 v[156:159], v[112:115], v[108:111], v[156:159]
    s_add_u32 m0, m0, s96
    v_exp_f32 v93, v93
    v_mfma_f32_16x16x32_bf16 v[184:187], v[116:119], v[108:111], v[184:187]
    v_add_f32 v20, v20, v90
    v_add_f32 v21, v21, v91
    v_mfma_f32_16x16x32_bf16 v[212:215], v[120:123], v[108:111], v[212:215]
    buffer_load_dwordx4 v7, s[4:7], s49 offen offset:1792 nt lds
    v_cvt_pk_bf16_f32 v105, v90, v91
    v_mfma_f32_16x16x32_bf16 v[240:243], v[124:127], v[108:111], v[240:243]
    v_exp_f32 v94, v94
    v_mfma_f32_16x16x32_bf16 a[124:127], v[128:131], v[108:111], a[124:127]
    v_exp_f32 v95, v95
    v_mfma_f32_16x16x32_bf16 a[152:155], v[132:135], v[108:111], a[152:155]
    v_add_f32 v20, v20, v92
    v_add_f32 v21, v21, v93
    v_mfma_f32_16x16x32_bf16 a[180:183], v[136:139], v[108:111], a[180:183]
    v_cvt_pk_bf16_f32 v106, v92, v93
    v_add_f32 v20, v20, v94
    v_mfma_f32_16x16x32_bf16 a[208:211], v[140:143], v[108:111], a[208:211]
    v_add_f32 v21, v21, v95
    v_cvt_pk_bf16_f32 v107, v94, v95
    s_waitcnt vmcnt(16) lgkmcnt(0)
    s_barrier
    v_mfma_f32_16x16x32_bf16 v[88:91], v[56:59], a[96:99], v[52:55]
    ds_read_b128 v[56:59], v8 offset:8448
    v_mfma_f32_16x16x32_bf16 v[88:91], v[60:63], a[100:103], v[88:91]
    ds_read_b128 v[60:63], v8 offset:8512
    v_exp_f32 v96, v96
    v_mfma_f32_16x16x32_bf16 v[88:91], v[64:67], a[104:107], v[88:91]
    ds_read_b128 v[64:67], v8 offset:8576
    v_exp_f32 v97, v97
    v_mfma_f32_16x16x32_bf16 v[88:91], v[68:71], a[108:111], v[88:91]
    ds_read_b128 v[68:71], v8 offset:8640
    v_exp_f32 v98, v98
    v_mfma_f32_16x16x32_bf16 v[92:95], v[72:75], a[96:99], v[52:55]
    ds_read_b128 v[72:75], v8 offset:8960
    v_exp_f32 v99, v99
    v_mfma_f32_16x16x32_bf16 v[92:95], v[76:79], a[100:103], v[92:95]
    ds_read_b128 v[76:79], v8 offset:9024
    v_add_f32 v22, v22, v96
    v_add_f32 v23, v23, v97
    v_mfma_f32_16x16x32_bf16 v[92:95], v[80:83], a[104:107], v[92:95]
    ds_read_b128 v[80:83], v8 offset:9088
    v_cvt_pk_bf16_f32 v108, v96, v97
    v_mfma_f32_16x16x32_bf16 v[92:95], v[84:87], a[108:111], v[92:95]
    ds_read_b128 v[84:87], v8 offset:9152
    v_exp_f32 v100, v100
    v_mfma_f32_16x16x32_bf16 v[160:163], v[112:115], v[104:107], v[160:163]
    v_exp_f32 v101, v101
    v_mfma_f32_16x16x32_bf16 v[188:191], v[116:119], v[104:107], v[188:191]
    v_add_f32 v22, v22, v98
    v_add_f32 v23, v23, v99
    v_mfma_f32_16x16x32_bf16 v[216:219], v[120:123], v[104:107], v[216:219]
    v_cvt_pk_bf16_f32 v109, v98, v99
    v_mfma_f32_16x16x32_bf16 v[244:247], v[124:127], v[104:107], v[244:247]
    v_exp_f32 v102, v102
    v_mfma_f32_16x16x32_bf16 a[128:131], v[128:131], v[104:107], a[128:131]
    v_exp_f32 v103, v103
    v_mfma_f32_16x16x32_bf16 a[156:159], v[132:135], v[104:107], a[156:159]
    v_add_f32 v22, v22, v100
    v_add_f32 v23, v23, v101
    v_mfma_f32_16x16x32_bf16 a[184:187], v[136:139], v[104:107], a[184:187]
    v_cvt_pk_bf16_f32 v110, v100, v101
    v_add_f32 v22, v22, v102
    v_mfma_f32_16x16x32_bf16 a[212:215], v[140:143], v[104:107], a[212:215]
    v_add_f32 v23, v23, v103
    v_cvt_pk_bf16_f32 v111, v102, v103
    s_waitcnt lgkmcnt(0)
    v_mfma_f32_16x16x32_bf16 v[96:99], v[56:59], a[0:3], v[28:31]
    v_mfma_f32_16x16x32_bf16 v[96:99], v[60:63], a[4:7], v[96:99]
    v_exp_f32 v88, v88
    v_mfma_f32_16x16x32_bf16 v[96:99], v[64:67], a[8:11], v[96:99]
    v_exp_f32 v89, v89
    v_mfma_f32_16x16x32_bf16 v[96:99], v[68:71], a[12:15], v[96:99]
    v_exp_f32 v90, v90
    v_mfma_f32_16x16x32_bf16 v[100:103], v[72:75], a[0:3], v[28:31]
    v_exp_f32 v91, v91
    v_mfma_f32_16x16x32_bf16 v[100:103], v[76:79], a[4:7], v[100:103]
    v_add_f32 v24, v24, v88
    v_add_f32 v25, v25, v89
    v_mfma_f32_16x16x32_bf16 v[100:103], v[80:83], a[8:11], v[100:103]
    v_cvt_pk_bf16_f32 v104, v88, v89
    v_mfma_f32_16x16x32_bf16 v[100:103], v[84:87], a[12:15], v[100:103]
    v_exp_f32 v92, v92
    v_mfma_f32_16x16x32_bf16 v[164:167], v[112:115], v[108:111], v[164:167]
    v_exp_f32 v93, v93
    v_mfma_f32_16x16x32_bf16 v[192:195], v[116:119], v[108:111], v[192:195]
    v_add_f32 v24, v24, v90
    v_add_f32 v25, v25, v91
    v_mfma_f32_16x16x32_bf16 v[220:223], v[120:123], v[108:111], v[220:223]
    v_cvt_pk_bf16_f32 v105, v90, v91
    v_mfma_f32_16x16x32_bf16 v[248:251], v[124:127], v[108:111], v[248:251]
    v_exp_f32 v94, v94
    v_mfma_f32_16x16x32_bf16 a[132:135], v[128:131], v[108:111], a[132:135]
    v_exp_f32 v95, v95
    v_mfma_f32_16x16x32_bf16 a[160:163], v[132:135], v[108:111], a[160:163]
    v_add_f32 v24, v24, v92
    v_add_f32 v25, v25, v93
    v_mfma_f32_16x16x32_bf16 a[188:191], v[136:139], v[108:111], a[188:191]
    v_cvt_pk_bf16_f32 v106, v92, v93
    v_add_f32 v24, v24, v94
    v_mfma_f32_16x16x32_bf16 a[216:219], v[140:143], v[108:111], a[216:219]
    v_add_f32 v25, v25, v95
    v_cvt_pk_bf16_f32 v107, v94, v95
    s_cmp_lg_u32 s69, 0
    s_cbranch_scc1 L_at_atailB
    v_mfma_f32_16x16x32_bf16 v[88:91], v[56:59], a[16:19], v[32:35]
    v_mfma_f32_16x16x32_bf16 v[88:91], v[60:63], a[20:23], v[88:91]
    v_exp_f32 v96, v96
    v_mfma_f32_16x16x32_bf16 v[88:91], v[64:67], a[24:27], v[88:91]
    v_exp_f32 v97, v97
    v_mfma_f32_16x16x32_bf16 v[88:91], v[68:71], a[28:31], v[88:91]
    v_exp_f32 v98, v98
    v_mfma_f32_16x16x32_bf16 v[92:95], v[72:75], a[16:19], v[32:35]
    v_exp_f32 v99, v99
    v_mfma_f32_16x16x32_bf16 v[92:95], v[76:79], a[20:23], v[92:95]
    v_add_f32 v12, v12, v96
    v_add_f32 v13, v13, v97
    v_mfma_f32_16x16x32_bf16 v[92:95], v[80:83], a[24:27], v[92:95]
    v_cvt_pk_bf16_f32 v108, v96, v97
    v_mfma_f32_16x16x32_bf16 v[92:95], v[84:87], a[28:31], v[92:95]
    v_exp_f32 v100, v100
    v_mfma_f32_16x16x32_bf16 v[168:171], v[112:115], v[104:107], v[168:171]
    ds_read_b64_tr_b16 v[112:113], v9 offset:8448
    ds_read_b64_tr_b16 v[114:115], v9 offset:8960
    v_exp_f32 v101, v101
    v_mfma_f32_16x16x32_bf16 v[196:199], v[116:119], v[104:107], v[196:199]
    ds_read_b64_tr_b16 v[116:117], v9 offset:8480
    ds_read_b64_tr_b16 v[118:119], v9 offset:8992
    v_add_f32 v12, v12, v98
    v_add_f32 v13, v13, v99
    v_mfma_f32_16x16x32_bf16 v[224:227], v[120:123], v[104:107], v[224:227]
    ds_read_b64_tr_b16 v[120:121], v9 offset:8512
    ds_read_b64_tr_b16 v[122:123], v9 offset:9024
    v_cvt_pk_bf16_f32 v109, v98, v99
    v_mfma_f32_16x16x32_bf16 v[252:255], v[124:127], v[104:107], v[252:255]
    ds_read_b64_tr_b16 v[124:125], v9 offset:8544
    ds_read_b64_tr_b16 v[126:127], v9 offset:9056
    v_exp_f32 v102, v102
    v_mfma_f32_16x16x32_bf16 a[136:139], v[128:131], v[104:107], a[136:139]
    ds_read_b64_tr_b16 v[128:129], v9 offset:8576
    ds_read_b64_tr_b16 v[130:131], v9 offset:9088
    v_exp_f32 v103, v103
    v_mfma_f32_16x16x32_bf16 a[164:167], v[132:135], v[104:107], a[164:167]
    ds_read_b64_tr_b16 v[132:133], v9 offset:8608
    ds_read_b64_tr_b16 v[134:135], v9 offset:9120
    v_add_f32 v12, v12, v100
    v_add_f32 v13, v13, v101
    v_mfma_f32_16x16x32_bf16 a[192:195], v[136:139], v[104:107], a[192:195]
    ds_read_b64_tr_b16 v[136:137], v9 offset:8640
    ds_read_b64_tr_b16 v[138:139], v9 offset:9152
    v_cvt_pk_bf16_f32 v110, v100, v101
    v_add_f32 v12, v12, v102
    v_mfma_f32_16x16x32_bf16 a[220:223], v[140:143], v[104:107], a[220:223]
    ds_read_b64_tr_b16 v[140:141], v9 offset:8672
    ds_read_b64_tr_b16 v[142:143], v9 offset:9184
    v_add_f32 v13, v13, v103
    v_cvt_pk_bf16_f32 v111, v102, v103
    v_mfma_f32_16x16x32_bf16 v[96:99], v[56:59], a[32:35], v[36:39]
    v_mfma_f32_16x16x32_bf16 v[96:99], v[60:63], a[36:39], v[96:99]
    s_add_u32 m0, s33, 0
    v_exp_f32 v88, v88
    v_mfma_f32_16x16x32_bf16 v[96:99], v[64:67], a[40:43], v[96:99]
    v_exp_f32 v89, v89
    v_mfma_f32_16x16x32_bf16 v[96:99], v[68:71], a[44:47], v[96:99]
    s_mov_b32 s49, s50
    v_exp_f32 v90, v90
    v_mfma_f32_16x16x32_bf16 v[100:103], v[72:75], a[32:35], v[36:39]
    v_exp_f32 v91, v91
    v_mfma_f32_16x16x32_bf16 v[100:103], v[76:79], a[36:39], v[100:103]
    s_add_u32 s50, s50, s51
    v_add_f32 v14, v14, v88
    v_add_f32 v15, v15, v89
    v_mfma_f32_16x16x32_bf16 v[100:103], v[80:83], a[40:43], v[100:103]
    v_cvt_pk_bf16_f32 v104, v88, v89
    v_mfma_f32_16x16x32_bf16 v[100:103], v[84:87], a[44:47], v[100:103]
    s_add_u32 s82, s82, 1
    v_exp_f32 v92, v92
    s_waitcnt lgkmcnt(0)
    v_mfma_f32_16x16x32_bf16 v[144:147], v[112:115], v[108:111], v[144:147]
    v_exp_f32 v93, v93
    v_mfma_f32_16x16x32_bf16 v[172:175], v[116:119], v[108:111], v[172:175]
    s_cmp_eq_u32 s82, 20
    v_add_f32 v14, v14, v90
    v_add_f32 v15, v15, v91
    v_mfma_f32_16x16x32_bf16 v[200:203], v[120:123], v[108:111], v[200:203]
    v_cvt_pk_bf16_f32 v105, v90, v91
    v_mfma_f32_16x16x32_bf16 v[228:231], v[124:127], v[108:111], v[228:231]
    s_cselect_b32 s29, s83, 0
    v_exp_f32 v94, v94
    v_mfma_f32_16x16x32_bf16 a[112:115], v[128:131], v[108:111], a[112:115]
    v_exp_f32 v95, v95
    v_mfma_f32_16x16x32_bf16 a[140:143], v[132:135], v[108:111], a[140:143]
    s_sub_u32 s50, s50, s29
    v_add_f32 v14, v14, v92
    v_add_f32 v15, v15, v93
    v_mfma_f32_16x16x32_bf16 a[168:171], v[136:139], v[108:111], a[168:171]
    v_cvt_pk_bf16_f32 v106, v92, v93
    v_add_f32 v14, v14, v94
    v_mfma_f32_16x16x32_bf16 a[196:199], v[140:143], v[108:111], a[196:199]
    s_add_u32 s28, s49, s88
    v_add_f32 v15, v15, v95
    v_cvt_pk_bf16_f32 v107, v94, v95
    v_mfma_f32_16x16x32_bf16 v[88:91], v[56:59], a[48:51], v[40:43]
    v_mfma_f32_16x16x32_bf16 v[88:91], v[60:63], a[52:55], v[88:91]
    buffer_load_dwordx4 v26, s[16:19], s28 offen lds
    v_exp_f32 v96, v96
    v_mfma_f32_16x16x32_bf16 v[88:91], v[64:67], a[56:59], v[88:91]
    v_exp_f32 v97, v97
    v_mfma_f32_16x16x32_bf16 v[88:91], v[68:71], a[60:63], v[88:91]
    s_add_u32 m0, m0, s53
    v_exp_f32 v98, v98
    v_mfma_f32_16x16x32_bf16 v[92:95], v[72:75], a[48:51], v[40:43]
    v_exp_f32 v99, v99
    v_mfma_f32_16x16x32_bf16 v[92:95], v[76:79], a[52:55], v[92:95]
    s_add_u32 s28, s49, s89
    v_add_f32 v16, v16, v96
    v_add_f32 v17, v17, v97
    v_mfma_f32_16x16x32_bf16 v[92:95], v[80:83], a[56:59], v[92:95]
    v_cvt_pk_bf16_f32 v108, v96, v97
    v_mfma_f32_16x16x32_bf16 v[92:95], v[84:87], a[60:63], v[92:95]
    buffer_load_dwordx4 v26, s[16:19], s28 offen lds
    v_exp_f32 v100, v100
    v_mfma_f32_16x16x32_bf16 v[148:151], v[112:115], v[104:107], v[148:151]
    v_exp_f32 v101, v101
    v_mfma_f32_16x16x32_bf16 v[176:179], v[116:119], v[104:107], v[176:179]
    s_add_u32 m0, m0, s53
    v_add_f32 v16, v16, v98
    v_add_f32 v17, v17, v99
    v_mfma_f32_16x16x32_bf16 v[204:207], v[120:123], v[104:107], v[204:207]
    v_cvt_pk_bf16_f32 v109, v98, v99
    v_mfma_f32_16x16x32_bf16 v[232:235], v[124:127], v[104:107], v[232:235]
    s_add_u32 s28, s49, s90
    v_exp_f32 v102, v102
    v_mfma_f32_16x16x32_bf16 a[116:119], v[128:131], v[104:107], a[116:119]
    v_exp_f32 v103, v103
    v_mfma_f32_16x16x32_bf16 a[144:147], v[132:135], v[104:107], a[144:147]
    buffer_load_dwordx4 v26, s[16:19], s28 offen lds
    v_add_f32 v16, v16, v100
    v_add_f32 v17, v17, v101
    v_mfma_f32_16x16x32_bf16 a[172:175], v[136:139], v[104:107], a[172:175]
    v_cvt_pk_bf16_f32 v110, v100, v101
    v_add_f32 v16, v16, v102
    v_mfma_f32_16x16x32_bf16 a[200:203], v[140:143], v[104:107], a[200:203]
    s_add_u32 m0, m0, s53
    v_add_f32 v17, v17, v103
    v_cvt_pk_bf16_f32 v111, v102, v103
    v_mfma_f32_16x16x32_bf16 v[96:99], v[56:59], a[64:67], v[44:47]
    v_mfma_f32_16x16x32_bf16 v[96:99], v[60:63], a[68:71], v[96:99]
    s_add_u32 s28, s49, s91
    v_exp_f32 v88, v88
    v_mfma_f32_16x16x32_bf16 v[96:99], v[64:67], a[72:75], v[96:99]
    v_exp_f32 v89, v89
    v_mfma_f32_16x16x32_bf16 v[96:99], v[68:71], a[76:79], v[96:99]
    buffer_load_dwordx4 v26, s[16:19], s28 offen lds
    v_exp_f32 v90, v90
    v_mfma_f32_16x16x32_bf16 v[100:103], v[72:75], a[64:67], v[44:47]
    v_exp_f32 v91, v91
    v_mfma_f32_16x16x32_bf16 v[100:103], v[76:79], a[68:71], v[100:103]
    s_add_u32 m0, m0, s53
    v_add_f32 v18, v18, v88
    v_add_f32 v19, v19, v89
    v_mfma_f32_16x16x32_bf16 v[100:103], v[80:83], a[72:75], v[100:103]
    v_cvt_pk_bf16_f32 v104, v88, v89
    v_mfma_f32_16x16x32_bf16 v[100:103], v[84:87], a[76:79], v[100:103]
    s_add_u32 s28, s49, s92
    v_exp_f32 v92, v92
    v_mfma_f32_16x16x32_bf16 v[152:155], v[112:115], v[108:111], v[152:155]
    v_exp_f32 v93, v93
    v_mfma_f32_16x16x32_bf16 v[180:183], v[116:119], v[108:111], v[180:183]
    buffer_load_dwordx4 v26, s[16:19], s28 offen lds
    v_add_f32 v18, v18, v90
    v_add_f32 v19, v19, v91
    v_mfma_f32_16x16x32_bf16 v[208:211], v[120:123], v[108:111], v[208:211]
    v_cvt_pk_bf16_f32 v105, v90, v91
    v_mfma_f32_16x16x32_bf16 v[236:239], v[124:127], v[108:111], v[236:239]
    s_add_u32 m0, m0, s53
    v_exp_f32 v94, v94
    v_mfma_f32_16x16x32_bf16 a[120:123], v[128:131], v[108:111], a[120:123]
    v_exp_f32 v95, v95
    v_mfma_f32_16x16x32_bf16 a[148:151], v[132:135], v[108:111], a[148:151]
    s_add_u32 s28, s49, s93
    v_add_f32 v18, v18, v92
    v_add_f32 v19, v19, v93
    v_mfma_f32_16x16x32_bf16 a[176:179], v[136:139], v[108:111], a[176:179]
    v_cvt_pk_bf16_f32 v106, v92, v93
    v_add_f32 v18, v18, v94
    v_mfma_f32_16x16x32_bf16 a[204:207], v[140:143], v[108:111], a[204:207]
    buffer_load_dwordx4 v26, s[16:19], s28 offen lds
    v_add_f32 v19, v19, v95
    v_cvt_pk_bf16_f32 v107, v94, v95
    v_mfma_f32_16x16x32_bf16 v[88:91], v[56:59], a[80:83], v[48:51]
    v_mfma_f32_16x16x32_bf16 v[88:91], v[60:63], a[84:87], v[88:91]
    s_add_u32 m0, m0, s53
    v_exp_f32 v96, v96
    v_mfma_f32_16x16x32_bf16 v[88:91], v[64:67], a[88:91], v[88:91]
    v_exp_f32 v97, v97
    v_mfma_f32_16x16x32_bf16 v[88:91], v[68:71], a[92:95], v[88:91]
    s_add_u32 s28, s49, s94
    v_exp_f32 v98, v98
    v_mfma_f32_16x16x32_bf16 v[92:95], v[72:75], a[80:83], v[48:51]
    v_exp_f32 v99, v99
    v_mfma_f32_16x16x32_bf16 v[92:95], v[76:79], a[84:87], v[92:95]
    buffer_load_dwordx4 v26, s[16:19], s28 offen lds
    v_add_f32 v20, v20, v96
    v_add_f32 v21, v21, v97
    v_mfma_f32_16x16x32_bf16 v[92:95], v[80:83], a[88:91], v[92:95]
    v_cvt_pk_bf16_f32 v108, v96, v97
    v_mfma_f32_16x16x32_bf16 v[92:95], v[84:87], a[92:95], v[92:95]
    s_add_u32 m0, m0, s53
    v_exp_f32 v100, v100
    v_mfma_f32_16x16x32_bf16 v[156:159], v[112:115], v[104:107], v[156:159]
    v_exp_f32 v101, v101
    v_mfma_f32_16x16x32_bf16 v[184:187], v[116:119], v[104:107], v[184:187]
    s_add_u32 s28, s49, s95
    v_add_f32 v20, v20, v98
    v_add_f32 v21, v21, v99
    v_mfma_f32_16x16x32_bf16 v[212:215], v[120:123], v[104:107], v[212:215]
    v_cvt_pk_bf16_f32 v109, v98, v99
    v_mfma_f32_16x16x32_bf16 v[240:243], v[124:127], v[104:107], v[240:243]
    buffer_load_dwordx4 v26, s[16:19], s28 offen lds
    v_exp_f32 v102, v102
    v_mfma_f32_16x16x32_bf16 a[124:127], v[128:131], v[104:107], a[124:127]
    v_exp_f32 v103, v103
    v_mfma_f32_16x16x32_bf16 a[152:155], v[132:135], v[104:107], a[152:155]
    v_add_f32 v20, v20, v100
    v_add_f32 v21, v21, v101
    v_mfma_f32_16x16x32_bf16 a[180:183], v[136:139], v[104:107], a[180:183]
    v_cvt_pk_bf16_f32 v110, v100, v101
    v_add_f32 v20, v20, v102
    v_mfma_f32_16x16x32_bf16 a[208:211], v[140:143], v[104:107], a[208:211]
    v_add_f32 v21, v21, v103
    v_cvt_pk_bf16_f32 v111, v102, v103
    s_waitcnt vmcnt(16) lgkmcnt(0)
    s_barrier
    v_mfma_f32_16x16x32_bf16 v[96:99], v[56:59], a[96:99], v[52:55]
    ds_read_b128 v[56:59], v8 offset:16896
    v_mfma_f32_16x16x32_bf16 v[96:99], v[60:63], a[100:103], v[96:99]
    ds_read_b128 v[60:63], v8 offset:16960
    v_exp_f32 v88, v88
    v_mfma_f32_16x16x32_bf16 v[96:99], v[64:67], a[104:107], v[96:99]
    ds_read_b128 v[64:67], v8 offset:17024
    v_exp_f32 v89, v89
    v_mfma_f32_16x16x32_bf16 v[96:99], v[68:71], a[108:111], v[96:99]
    ds_read_b128 v[68:71], v8 offset:17088
    v_exp_f32 v90, v90
    v_mfma_f32_16x16x32_bf16 v[100:103], v[72:75], a[96:99], v[52:55]
    ds_read_b128 v[72:75], v8 offset:17408
    v_exp_f32 v91, v91
    v_mfma_f32_16x16x32_bf16 v[100:103], v[76:79], a[100:103], v[100:103]
    ds_read_b128 v[76:79], v8 offset:17472
    v_add_f32 v22, v22, v88
    v_add_f32 v23, v23, v89
    v_mfma_f32_16x16x32_bf16 v[100:103], v[80:83], a[104:107], v[100:103]
    ds_read_b128 v[80:83], v8 offset:17536
    v_cvt_pk_bf16_f32 v104, v88, v89
    v_mfma_f32_16x16x32_bf16 v[100:103], v[84:87], a[108:111], v[100:103]
    ds_read_b128 v[84:87], v8 offset:17600
    v_exp_f32 v92, v92
    v_mfma_f32_16x16x32_bf16 v[160:163], v[112:115], v[108:111], v[160:163]
    v_exp_f32 v93, v93
    v_mfma_f32_16x16x32_bf16 v[188:191], v[116:119], v[108:111], v[188:191]
    v_add_f32 v22, v22, v90
    v_add_f32 v23, v23, v91
    v_mfma_f32_16x16x32_bf16 v[216:219], v[120:123], v[108:111], v[216:219]
    v_cvt_pk_bf16_f32 v105, v90, v91
    v_mfma_f32_16x16x32_bf16 v[244:247], v[124:127], v[108:111], v[244:247]
    v_exp_f32 v94, v94
    v_mfma_f32_16x16x32_bf16 a[128:131], v[128:131], v[108:111], a[128:131]
    v_exp_f32 v95, v95
    v_mfma_f32_16x16x32_bf16 a[156:159], v[132:135], v[108:111], a[156:159]
    v_add_f32 v22, v22, v92
    v_add_f32 v23, v23, v93
    v_mfma_f32_16x16x32_bf16 a[184:187], v[136:139], v[108:111], a[184:187]
    v_cvt_pk_bf16_f32 v106, v92, v93
    v_add_f32 v22, v22, v94
    v_mfma_f32_16x16x32_bf16 a[212:215], v[140:143], v[108:111], a[212:215]
    v_add_f32 v23, v23, v95
    v_cvt_pk_bf16_f32 v107, v94, v95
    s_waitcnt lgkmcnt(0)
    v_mfma_f32_16x16x32_bf16 v[88:91], v[56:59], a[0:3], v[28:31]
    v_mfma_f32_16x16x32_bf16 v[88:91], v[60:63], a[4:7], v[88:91]
    v_exp_f32 v96, v96
    v_mfma_f32_16x16x32_bf16 v[88:91], v[64:67], a[8:11], v[88:91]
    v_exp_f32 v97, v97
    v_mfma_f32_16x16x32_bf16 v[88:91], v[68:71], a[12:15], v[88:91]
    v_exp_f32 v98, v98
    v_mfma_f32_16x16x32_bf16 v[92:95], v[72:75], a[0:3], v[28:31]
    v_exp_f32 v99, v99
    v_mfma_f32_16x16x32_bf16 v[92:95], v[76:79], a[4:7], v[92:95]
    v_add_f32 v24, v24, v96
    v_add_f32 v25, v25, v97
    v_mfma_f32_16x16x32_bf16 v[92:95], v[80:83], a[8:11], v[92:95]
    v_cvt_pk_bf16_f32 v108, v96, v97
    v_mfma_f32_16x16x32_bf16 v[92:95], v[84:87], a[12:15], v[92:95]
    v_exp_f32 v100, v100
    v_mfma_f32_16x16x32_bf16 v[164:167], v[112:115], v[104:107], v[164:167]
    v_exp_f32 v101, v101
    v_mfma_f32_16x16x32_bf16 v[192:195], v[116:119], v[104:107], v[192:195]
    v_add_f32 v24, v24, v98
    v_add_f32 v25, v25, v99
    v_mfma_f32_16x16x32_bf16 v[220:223], v[120:123], v[104:107], v[220:223]
    v_cvt_pk_bf16_f32 v109, v98, v99
    v_mfma_f32_16x16x32_bf16 v[248:251], v[124:127], v[104:107], v[248:251]
    v_exp_f32 v102, v102
    v_mfma_f32_16x16x32_bf16 a[132:135], v[128:131], v[104:107], a[132:135]
    v_exp_f32 v103, v103
    v_mfma_f32_16x16x32_bf16 a[160:163], v[132:135], v[104:107], a[160:163]
    v_add_f32 v24, v24, v100
    v_add_f32 v25, v25, v101
    v_mfma_f32_16x16x32_bf16 a[188:191], v[136:139], v[104:107], a[188:191]
    v_cvt_pk_bf16_f32 v110, v100, v101
    v_add_f32 v24, v24, v102
    v_mfma_f32_16x16x32_bf16 a[216:219], v[140:143], v[104:107], a[216:219]
    v_add_f32 v25, v25, v103
    v_cvt_pk_bf16_f32 v111, v102, v103
    v_mfma_f32_16x16x32_bf16 v[96:99], v[56:59], a[16:19], v[32:35]
    v_mfma_f32_16x16x32_bf16 v[96:99], v[60:63], a[20:23], v[96:99]
    v_exp_f32 v88, v88
    v_mfma_f32_16x16x32_bf16 v[96:99], v[64:67], a[24:27], v[96:99]
    v_exp_f32 v89, v89
    v_mfma_f32_16x16x32_bf16 v[96:99], v[68:71], a[28:31], v[96:99]
    v_exp_f32 v90, v90
    v_mfma_f32_16x16x32_bf16 v[100:103], v[72:75], a[16:19], v[32:35]
    v_exp_f32 v91, v91
    v_mfma_f32_16x16x32_bf16 v[100:103], v[76:79], a[20:23], v[100:103]
    v_add_f32 v12, v12, v88
    v_add_f32 v13, v13, v89
    v_mfma_f32_16x16x32_bf16 v[100:103], v[80:83], a[24:27], v[100:103]
    v_cvt_pk_bf16_f32 v104, v88, v89
    v_mfma_f32_16x16x32_bf16 v[100:103], v[84:87], a[28:31], v[100:103]
    v_exp_f32 v92, v92
    v_mfma_f32_16x16x32_bf16 v[168:171], v[112:115], v[108:111], v[168:171]
    ds_read_b64_tr_b16 v[112:113], v9 offset:16896
    ds_read_b64_tr_b16 v[114:115], v9 offset:17408
    v_exp_f32 v93, v93
    v_mfma_f32_16x16x32_bf16 v[196:199], v[116:119], v[108:111], v[196:199]
    ds_read_b64_tr_b16 v[116:117], v9 offset:16928
    ds_read_b64_tr_b16 v[118:119], v9 offset:17440
    v_add_f32 v12, v12, v90
    v_add_f32 v13, v13, v91
    v_mfma_f32_16x16x32_bf16 v[224:227], v[120:123], v[108:111], v[224:227]
    ds_read_b64_tr_b16 v[120:121], v9 offset:16960
    ds_read_b64_tr_b16 v[122:123], v9 offset:17472
    v_cvt_pk_bf16_f32 v105, v90, v91
    v_mfma_f32_16x16x32_bf16 v[252:255], v[124:127], v[108:111], v[252:255]
    ds_read_b64_tr_b16 v[124:125], v9 offset:16992
    ds_read_b64_tr_b16 v[126:127], v9 offset:17504
    v_exp_f32 v94, v94
    v_mfma_f32_16x16x32_bf16 a[136:139], v[128:131], v[108:111], a[136:139]
    ds_read_b64_tr_b16 v[128:129], v9 offset:17024
    ds_read_b64_tr_b16 v[130:131], v9 offset:17536
    v_exp_f32 v95, v95
    v_mfma_f32_16x16x32_bf16 a[164:167], v[132:135], v[108:111], a[164:167]
    ds_read_b64_tr_b16 v[132:133], v9 offset:17056
    ds_read_b64_tr_b16 v[134:135], v9 offset:17568
    v_add_f32 v12, v12, v92
    v_add_f32 v13, v13, v93
    v_mfma_f32_16x16x32_bf16 a[192:195], v[136:139], v[108:111], a[192:195]
    ds_read_b64_tr_b16 v[136:137], v9 offset:17088
    ds_read_b64_tr_b16 v[138:139], v9 offset:17600
    v_cvt_pk_bf16_f32 v106, v92, v93
    v_add_f32 v12, v12, v94
    v_mfma_f32_16x16x32_bf16 a[220:223], v[140:143], v[108:111], a[220:223]
    ds_read_b64_tr_b16 v[140:141], v9 offset:17120
    ds_read_b64_tr_b16 v[142:143], v9 offset:17632
    v_add_f32 v13, v13, v95
    v_cvt_pk_bf16_f32 v107, v94, v95
    v_mfma_f32_16x16x32_bf16 v[88:91], v[56:59], a[32:35], v[36:39]
    v_mfma_f32_16x16x32_bf16 v[88:91], v[60:63], a[36:39], v[88:91]
    s_add_u32 m0, s33, 8448
    v_exp_f32 v96, v96
    v_mfma_f32_16x16x32_bf16 v[88:91], v[64:67], a[40:43], v[88:91]
    v_exp_f32 v97, v97
    v_mfma_f32_16x16x32_bf16 v[88:91], v[68:71], a[44:47], v[88:91]
    s_mov_b32 s49, s50
    v_exp_f32 v98, v98
    v_mfma_f32_16x16x32_bf16 v[92:95], v[72:75], a[32:35], v[36:39]
    v_exp_f32 v99, v99
    v_mfma_f32_16x16x32_bf16 v[92:95], v[76:79], a[36:39], v[92:95]
    s_add_u32 s50, s50, s51
    v_add_f32 v14, v14, v96
    v_add_f32 v15, v15, v97
    v_mfma_f32_16x16x32_bf16 v[92:95], v[80:83], a[40:43], v[92:95]
    v_cvt_pk_bf16_f32 v108, v96, v97
    v_mfma_f32_16x16x32_bf16 v[92:95], v[84:87], a[44:47], v[92:95]
    s_add_u32 s82, s82, 1
    v_exp_f32 v100, v100
    s_waitcnt lgkmcnt(0)
    v_mfma_f32_16x16x32_bf16 v[144:147], v[112:115], v[104:107], v[144:147]
    v_exp_f32 v101, v101
    v_mfma_f32_16x16x32_bf16 v[172:175], v[116:119], v[104:107], v[172:175]
    s_cmp_eq_u32 s82, 20
    v_add_f32 v14, v14, v98
    v_add_f32 v15, v15, v99
    v_mfma_f32_16x16x32_bf16 v[200:203], v[120:123], v[104:107], v[200:203]
    v_cvt_pk_bf16_f32 v109, v98, v99
    v_mfma_f32_16x16x32_bf16 v[228:231], v[124:127], v[104:107], v[228:231]
    s_cselect_b32 s29, s83, 0
    v_exp_f32 v102, v102
    v_mfma_f32_16x16x32_bf16 a[112:115], v[128:131], v[104:107], a[112:115]
    v_exp_f32 v103, v103
    v_mfma_f32_16x16x32_bf16 a[140:143], v[132:135], v[104:107], a[140:143]
    s_sub_u32 s50, s50, s29
    v_add_f32 v14, v14, v100
    v_add_f32 v15, v15, v101
    v_mfma_f32_16x16x32_bf16 a[168:171], v[136:139], v[104:107], a[168:171]
    v_cvt_pk_bf16_f32 v110, v100, v101
    v_add_f32 v14, v14, v102
    v_mfma_f32_16x16x32_bf16 a[196:199], v[140:143], v[104:107], a[196:199]
    s_add_u32 s28, s49, s88
    v_add_f32 v15, v15, v103
    v_cvt_pk_bf16_f32 v111, v102, v103
    v_mfma_f32_16x16x32_bf16 v[96:99], v[56:59], a[48:51], v[40:43]
    v_mfma_f32_16x16x32_bf16 v[96:99], v[60:63], a[52:55], v[96:99]
    buffer_load_dwordx4 v26, s[16:19], s28 offen lds
    v_exp_f32 v88, v88
    v_mfma_f32_16x16x32_bf16 v[96:99], v[64:67], a[56:59], v[96:99]
    v_exp_f32 v89, v89
    v_mfma_f32_16x16x32_bf16 v[96:99], v[68:71], a[60:63], v[96:99]
    s_add_u32 m0, m0, s53
    v_exp_f32 v90, v90
    v_mfma_f32_16x16x32_bf16 v[100:103], v[72:75], a[48:51], v[40:43]
    v_exp_f32 v91, v91
    v_mfma_f32_16x16x32_bf16 v[100:103], v[76:79], a[52:55], v[100:103]
    s_add_u32 s28, s49, s89
    v_add_f32 v16, v16, v88
    v_add_f32 v17, v17, v89
    v_mfma_f32_16x16x32_bf16 v[100:103], v[80:83], a[56:59], v[100:103]
    v_cvt_pk_bf16_f32 v104, v88, v89
    v_mfma_f32_16x16x32_bf16 v[100:103], v[84:87], a[60:63], v[100:103]
    buffer_load_dwordx4 v26, s[16:19], s28 offen lds
    v_exp_f32 v92, v92
    v_mfma_f32_16x16x32_bf16 v[148:151], v[112:115], v[108:111], v[148:151]
    v_exp_f32 v93, v93
    v_mfma_f32_16x16x32_bf16 v[176:179], v[116:119], v[108:111], v[176:179]
    s_add_u32 m0, m0, s53
    v_add_f32 v16, v16, v90
    v_add_f32 v17, v17, v91
    v_mfma_f32_16x16x32_bf16 v[204:207], v[120:123], v[108:111], v[204:207]
    v_cvt_pk_bf16_f32 v105, v90, v91
    v_mfma_f32_16x16x32_bf16 v[232:235], v[124:127], v[108:111], v[232:235]
    s_add_u32 s28, s49, s90
    v_exp_f32 v94, v94
    v_mfma_f32_16x16x32_bf16 a[116:119], v[128:131], v[108:111], a[116:119]
    v_exp_f32 v95, v95
    v_mfma_f32_16x16x32_bf16 a[144:147], v[132:135], v[108:111], a[144:147]
    buffer_load_dwordx4 v26, s[16:19], s28 offen lds
    v_add_f32 v16, v16, v92
    v_add_f32 v17, v17, v93
    v_mfma_f32_16x16x32_bf16 a[172:175], v[136:139], v[108:111], a[172:175]
    v_cvt_pk_bf16_f32 v106, v92, v93
    v_add_f32 v16, v16, v94
    v_mfma_f32_16x16x32_bf16 a[200:203], v[140:143], v[108:111], a[200:203]
    s_add_u32 m0, m0, s53
    v_add_f32 v17, v17, v95
    v_cvt_pk_bf16_f32 v107, v94, v95
    v_mfma_f32_16x16x32_bf16 v[88:91], v[56:59], a[64:67], v[44:47]
    v_mfma_f32_16x16x32_bf16 v[88:91], v[60:63], a[68:71], v[88:91]
    s_add_u32 s28, s49, s91
    v_exp_f32 v96, v96
    v_mfma_f32_16x16x32_bf16 v[88:91], v[64:67], a[72:75], v[88:91]
    v_exp_f32 v97, v97
    v_mfma_f32_16x16x32_bf16 v[88:91], v[68:71], a[76:79], v[88:91]
    buffer_load_dwordx4 v26, s[16:19], s28 offen lds
    v_exp_f32 v98, v98
    v_mfma_f32_16x16x32_bf16 v[92:95], v[72:75], a[64:67], v[44:47]
    v_exp_f32 v99, v99
    v_mfma_f32_16x16x32_bf16 v[92:95], v[76:79], a[68:71], v[92:95]
    s_add_u32 m0, m0, s53
    v_add_f32 v18, v18, v96
    v_add_f32 v19, v19, v97
    v_mfma_f32_16x16x32_bf16 v[92:95], v[80:83], a[72:75], v[92:95]
    v_cvt_pk_bf16_f32 v108, v96, v97
    v_mfma_f32_16x16x32_bf16 v[92:95], v[84:87], a[76:79], v[92:95]
    s_add_u32 s28, s49, s92
    v_exp_f32 v100, v100
    v_mfma_f32_16x16x32_bf16 v[152:155], v[112:115], v[104:107], v[152:155]
    v_exp_f32 v101, v101
    v_mfma_f32_16x16x32_bf16 v[180:183], v[116:119], v[104:107], v[180:183]
    buffer_load_dwordx4 v26, s[16:19], s28 offen lds
    v_add_f32 v18, v18, v98
    v_add_f32 v19, v19, v99
    v_mfma_f32_16x16x32_bf16 v[208:211], v[120:123], v[104:107], v[208:211]
    v_cvt_pk_bf16_f32 v109, v98, v99
    v_mfma_f32_16x16x32_bf16 v[236:239], v[124:127], v[104:107], v[236:239]
    s_add_u32 m0, m0, s53
    v_exp_f32 v102, v102
    v_mfma_f32_16x16x32_bf16 a[120:123], v[128:131], v[104:107], a[120:123]
    v_exp_f32 v103, v103
    v_mfma_f32_16x16x32_bf16 a[148:151], v[132:135], v[104:107], a[148:151]
    s_add_u32 s28, s49, s93
    v_add_f32 v18, v18, v100
    v_add_f32 v19, v19, v101
    v_mfma_f32_16x16x32_bf16 a[176:179], v[136:139], v[104:107], a[176:179]
    v_cvt_pk_bf16_f32 v110, v100, v101
    v_add_f32 v18, v18, v102
    v_mfma_f32_16x16x32_bf16 a[204:207], v[140:143], v[104:107], a[204:207]
    buffer_load_dwordx4 v26, s[16:19], s28 offen lds
    v_add_f32 v19, v19, v103
    v_cvt_pk_bf16_f32 v111, v102, v103
    v_mfma_f32_16x16x32_bf16 v[96:99], v[56:59], a[80:83], v[48:51]
    v_mfma_f32_16x16x32_bf16 v[96:99], v[60:63], a[84:87], v[96:99]
    s_add_u32 m0, m0, s53
    v_exp_f32 v88, v88
    v_mfma_f32_16x16x32_bf16 v[96:99], v[64:67], a[88:91], v[96:99]
    v_exp_f32 v89, v89
    v_mfma_f32_16x16x32_bf16 v[96:99], v[68:71], a[92:95], v[96:99]
    s_add_u32 s28, s49, s94
    v_exp_f32 v90, v90
    v_mfma_f32_16x16x32_bf16 v[100:103], v[72:75], a[80:83], v[48:51]
    v_exp_f32 v91, v91
    v_mfma_f32_16x16x32_bf16 v[100:103], v[76:79], a[84:87], v[100:103]
    buffer_load_dwordx4 v26, s[16:19], s28 offen lds
    v_add_f32 v20, v20, v88
    v_add_f32 v21, v21, v89
    v_mfma_f32_16x16x32_bf16 v[100:103], v[80:83], a[88:91], v[100:103]
    v_cvt_pk_bf16_f32 v104, v88, v89
    v_mfma_f32_16x16x32_bf16 v[100:103], v[84:87], a[92:95], v[100:103]
    s_add_u32 m0, m0, s53
    v_exp_f32 v92, v92
    v_mfma_f32_16x16x32_bf16 v[156:159], v[112:115], v[108:111], v[156:159]
    v_exp_f32 v93, v93
    v_mfma_f32_16x16x32_bf16 v[184:187], v[116:119], v[108:111], v[184:187]
    s_add_u32 s28, s49, s95
    v_add_f32 v20, v20, v90
    v_add_f32 v21, v21, v91
    v_mfma_f32_16x16x32_bf16 v[212:215], v[120:123], v[108:111], v[212:215]
    v_cvt_pk_bf16_f32 v105, v90, v91
    v_mfma_f32_16x16x32_bf16 v[240:243], v[124:127], v[108:111], v[240:243]
    buffer_load_dwordx4 v26, s[16:19], s28 offen lds
    v_exp_f32 v94, v94
    v_mfma_f32_16x16x32_bf16 a[124:127], v[128:131], v[108:111], a[124:127]
    v_exp_f32 v95, v95
    v_mfma_f32_16x16x32_bf16 a[152:155], v[132:135], v[108:111], a[152:155]
    v_add_f32 v20, v20, v92
    v_add_f32 v21, v21, v93
    v_mfma_f32_16x16x32_bf16 a[180:183], v[136:139], v[108:111], a[180:183]
    v_cvt_pk_bf16_f32 v106, v92, v93
    v_add_f32 v20, v20, v94
    v_mfma_f32_16x16x32_bf16 a[208:211], v[140:143], v[108:111], a[208:211]
    v_add_f32 v21, v21, v95
    v_cvt_pk_bf16_f32 v107, v94, v95
    s_waitcnt vmcnt(16) lgkmcnt(0)
    s_barrier
    v_mfma_f32_16x16x32_bf16 v[88:91], v[56:59], a[96:99], v[52:55]
    ds_read_b128 v[56:59], v8 offset:25344
    v_mfma_f32_16x16x32_bf16 v[88:91], v[60:63], a[100:103], v[88:91]
    ds_read_b128 v[60:63], v8 offset:25408
    v_exp_f32 v96, v96
    v_mfma_f32_16x16x32_bf16 v[88:91], v[64:67], a[104:107], v[88:91]
    ds_read_b128 v[64:67], v8 offset:25472
    v_exp_f32 v97, v97
    v_mfma_f32_16x16x32_bf16 v[88:91], v[68:71], a[108:111], v[88:91]
    ds_read_b128 v[68:71], v8 offset:25536
    v_exp_f32 v98, v98
    v_mfma_f32_16x16x32_bf16 v[92:95], v[72:75], a[96:99], v[52:55]
    ds_read_b128 v[72:75], v8 offset:25856
    v_exp_f32 v99, v99
    v_mfma_f32_16x16x32_bf16 v[92:95], v[76:79], a[100:103], v[92:95]
    ds_read_b128 v[76:79], v8 offset:25920
    v_add_f32 v22, v22, v96
    v_add_f32 v23, v23, v97
    v_mfma_f32_16x16x32_bf16 v[92:95], v[80:83], a[104:107], v[92:95]
    ds_read_b128 v[80:83], v8 offset:25984
    v_cvt_pk_bf16_f32 v108, v96, v97
    v_mfma_f32_16x16x32_bf16 v[92:95], v[84:87], a[108:111], v[92:95]
    ds_read_b128 v[84:87], v8 offset:26048
    v_exp_f32 v100, v100
    v_mfma_f32_16x16x32_bf16 v[160:163], v[112:115], v[104:107], v[160:163]
    v_exp_f32 v101, v101
    v_mfma_f32_16x16x32_bf16 v[188:191], v[116:119], v[104:107], v[188:191]
    v_add_f32 v22, v22, v98
    v_add_f32 v23, v23, v99
    v_mfma_f32_16x16x32_bf16 v[216:219], v[120:123], v[104:107], v[216:219]
    v_cvt_pk_bf16_f32 v109, v98, v99
    v_mfma_f32_16x16x32_bf16 v[244:247], v[124:127], v[104:107], v[244:247]
    v_exp_f32 v102, v102
    v_mfma_f32_16x16x32_bf16 a[128:131], v[128:131], v[104:107], a[128:131]
    v_exp_f32 v103, v103
    v_mfma_f32_16x16x32_bf16 a[156:159], v[132:135], v[104:107], a[156:159]
    v_add_f32 v22, v22, v100
    v_add_f32 v23, v23, v101
    v_mfma_f32_16x16x32_bf16 a[184:187], v[136:139], v[104:107], a[184:187]
    v_cvt_pk_bf16_f32 v110, v100, v101
    v_add_f32 v22, v22, v102
    v_mfma_f32_16x16x32_bf16 a[212:215], v[140:143], v[104:107], a[212:215]
    v_add_f32 v23, v23, v103
    v_cvt_pk_bf16_f32 v111, v102, v103
    s_waitcnt lgkmcnt(0)
    v_mfma_f32_16x16x32_bf16 v[96:99], v[56:59], a[0:3], v[28:31]
    v_mfma_f32_16x16x32_bf16 v[96:99], v[60:63], a[4:7], v[96:99]
    v_exp_f32 v88, v88
    v_mfma_f32_16x16x32_bf16 v[96:99], v[64:67], a[8:11], v[96:99]
    v_exp_f32 v89, v89
    v_mfma_f32_16x16x32_bf16 v[96:99], v[68:71], a[12:15], v[96:99]
    v_exp_f32 v90, v90
    v_mfma_f32_16x16x32_bf16 v[100:103], v[72:75], a[0:3], v[28:31]
    v_exp_f32 v91, v91
    v_mfma_f32_16x16x32_bf16 v[100:103], v[76:79], a[4:7], v[100:103]
    v_add_f32 v24, v24, v88
    v_add_f32 v25, v25, v89
    v_mfma_f32_16x16x32_bf16 v[100:103], v[80:83], a[8:11], v[100:103]
    v_cvt_pk_bf16_f32 v104, v88, v89
    v_mfma_f32_16x16x32_bf16 v[100:103], v[84:87], a[12:15], v[100:103]
    v_exp_f32 v92, v92
    v_mfma_f32_16x16x32_bf16 v[164:167], v[112:115], v[108:111], v[164:167]
    v_exp_f32 v93, v93
    v_mfma_f32_16x16x32_bf16 v[192:195], v[116:119], v[108:111], v[192:195]
    v_add_f32 v24, v24, v90
    v_add_f32 v25, v25, v91
    v_mfma_f32_16x16x32_bf16 v[220:223], v[120:123], v[108:111], v[220:223]
    v_cvt_pk_bf16_f32 v105, v90, v91
    v_mfma_f32_16x16x32_bf16 v[248:251], v[124:127], v[108:111], v[248:251]
    v_exp_f32 v94, v94
    v_mfma_f32_16x16x32_bf16 a[132:135], v[128:131], v[108:111], a[132:135]
    v_exp_f32 v95, v95
    v_mfma_f32_16x16x32_bf16 a[160:163], v[132:135], v[108:111], a[160:163]
    v_add_f32 v24, v24, v92
    v_add_f32 v25, v25, v93
    v_mfma_f32_16x16x32_bf16 a[188:191], v[136:139], v[108:111], a[188:191]
    v_cvt_pk_bf16_f32 v106, v92, v93
    v_add_f32 v24, v24, v94
    v_mfma_f32_16x16x32_bf16 a[216:219], v[140:143], v[108:111], a[216:219]
    v_add_f32 v25, v25, v95
    v_cvt_pk_bf16_f32 v107, v94, v95
    v_mfma_f32_16x16x32_bf16 v[88:91], v[56:59], a[16:19], v[32:35]
    v_mfma_f32_16x16x32_bf16 v[88:91], v[60:63], a[20:23], v[88:91]
    v_exp_f32 v96, v96
    v_mfma_f32_16x16x32_bf16 v[88:91], v[64:67], a[24:27], v[88:91]
    v_exp_f32 v97, v97
    v_mfma_f32_16x16x32_bf16 v[88:91], v[68:71], a[28:31], v[88:91]
    v_exp_f32 v98, v98
    v_mfma_f32_16x16x32_bf16 v[92:95], v[72:75], a[16:19], v[32:35]
    v_exp_f32 v99, v99
    v_mfma_f32_16x16x32_bf16 v[92:95], v[76:79], a[20:23], v[92:95]
    v_add_f32 v12, v12, v96
    v_add_f32 v13, v13, v97
    v_mfma_f32_16x16x32_bf16 v[92:95], v[80:83], a[24:27], v[92:95]
    v_cvt_pk_bf16_f32 v108, v96, v97
    v_mfma_f32_16x16x32_bf16 v[92:95], v[84:87], a[28:31], v[92:95]
    v_exp_f32 v100, v100
    v_mfma_f32_16x16x32_bf16 v[168:171], v[112:115], v[104:107], v[168:171]
    ds_read_b64_tr_b16 v[112:113], v9 offset:25344
    ds_read_b64_tr_b16 v[114:115], v9 offset:25856
    v_exp_f32 v101, v101
    v_mfma_f32_16x16x32_bf16 v[196:199], v[116:119], v[104:107], v[196:199]
    ds_read_b64_tr_b16 v[116:117], v9 offset:25376
    ds_read_b64_tr_b16 v[118:119], v9 offset:25888
    v_add_f32 v12, v12, v98
    v_add_f32 v13, v13, v99
    v_mfma_f32_16x16x32_bf16 v[224:227], v[120:123], v[104:107], v[224:227]
    ds_read_b64_tr_b16 v[120:121], v9 offset:25408
    ds_read_b64_tr_b16 v[122:123], v9 offset:25920
    v_cvt_pk_bf16_f32 v109, v98, v99
    v_mfma_f32_16x16x32_bf16 v[252:255], v[124:127], v[104:107], v[252:255]
    ds_read_b64_tr_b16 v[124:125], v9 offset:25440
    ds_read_b64_tr_b16 v[126:127], v9 offset:25952
    v_exp_f32 v102, v102
    v_mfma_f32_16x16x32_bf16 a[136:139], v[128:131], v[104:107], a[136:139]
    ds_read_b64_tr_b16 v[128:129], v9 offset:25472
    ds_read_b64_tr_b16 v[130:131], v9 offset:25984
    v_exp_f32 v103, v103
    v_mfma_f32_16x16x32_bf16 a[164:167], v[132:135], v[104:107], a[164:167]
    ds_read_b64_tr_b16 v[132:133], v9 offset:25504
    ds_read_b64_tr_b16 v[134:135], v9 offset:26016
    v_add_f32 v12, v12, v100
    v_add_f32 v13, v13, v101
    v_mfma_f32_16x16x32_bf16 a[192:195], v[136:139], v[104:107], a[192:195]
    ds_read_b64_tr_b16 v[136:137], v9 offset:25536
    ds_read_b64_tr_b16 v[138:139], v9 offset:26048
    v_cvt_pk_bf16_f32 v110, v100, v101
    v_add_f32 v12, v12, v102
    v_mfma_f32_16x16x32_bf16 a[220:223], v[140:143], v[104:107], a[220:223]
    ds_read_b64_tr_b16 v[140:141], v9 offset:25568
    ds_read_b64_tr_b16 v[142:143], v9 offset:26080
    v_add_f32 v13, v13, v103
    v_cvt_pk_bf16_f32 v111, v102, v103
    v_mfma_f32_16x16x32_bf16 v[96:99], v[56:59], a[32:35], v[36:39]
    v_mfma_f32_16x16x32_bf16 v[96:99], v[60:63], a[36:39], v[96:99]
    s_add_u32 m0, s33, 16896
    v_exp_f32 v88, v88
    v_mfma_f32_16x16x32_bf16 v[96:99], v[64:67], a[40:43], v[96:99]
    v_exp_f32 v89, v89
    v_mfma_f32_16x16x32_bf16 v[96:99], v[68:71], a[44:47], v[96:99]
    s_mov_b32 s49, s50
    v_exp_f32 v90, v90
    v_mfma_f32_16x16x32_bf16 v[100:103], v[72:75], a[32:35], v[36:39]
    v_exp_f32 v91, v91
    v_mfma_f32_16x16x32_bf16 v[100:103], v[76:79], a[36:39], v[100:103]
    s_add_u32 s50, s50, s51
    v_add_f32 v14, v14, v88
    v_add_f32 v15, v15, v89
    v_mfma_f32_16x16x32_bf16 v[100:103], v[80:83], a[40:43], v[100:103]
    v_cvt_pk_bf16_f32 v104, v88, v89
    v_mfma_f32_16x16x32_bf16 v[100:103], v[84:87], a[44:47], v[100:103]
    s_add_u32 s82, s82, 1
    v_exp_f32 v92, v92
    s_waitcnt lgkmcnt(0)
    v_mfma_f32_16x16x32_bf16 v[144:147], v[112:115], v[108:111], v[144:147]
    v_exp_f32 v93, v93
    v_mfma_f32_16x16x32_bf16 v[172:175], v[116:119], v[108:111], v[172:175]
    s_cmp_eq_u32 s82, 20
    v_add_f32 v14, v14, v90
    v_add_f32 v15, v15, v91
    v_mfma_f32_16x16x32_bf16 v[200:203], v[120:123], v[108:111], v[200:203]
    v_cvt_pk_bf16_f32 v105, v90, v91
    v_mfma_f32_16x16x32_bf16 v[228:231], v[124:127], v[108:111], v[228:231]
    s_cselect_b32 s29, s83, 0
    v_exp_f32 v94, v94
    v_mfma_f32_16x16x32_bf16 a[112:115], v[128:131], v[108:111], a[112:115]
    v_exp_f32 v95, v95
    v_mfma_f32_16x16x32_bf16 a[140:143], v[132:135], v[108:111], a[140:143]
    s_sub_u32 s50, s50, s29
    v_add_f32 v14, v14, v92
    v_add_f32 v15, v15, v93
    v_mfma_f32_16x16x32_bf16 a[168:171], v[136:139], v[108:111], a[168:171]
    v_cvt_pk_bf16_f32 v106, v92, v93
    v_add_f32 v14, v14, v94
    v_mfma_f32_16x16x32_bf16 a[196:199], v[140:143], v[108:111], a[196:199]
    s_add_u32 s28, s49, s88
    v_add_f32 v15, v15, v95
    v_cvt_pk_bf16_f32 v107, v94, v95
    v_mfma_f32_16x16x32_bf16 v[88:91], v[56:59], a[48:51], v[40:43]
    v_mfma_f32_16x16x32_bf16 v[88:91], v[60:63], a[52:55], v[88:91]
    buffer_load_dwordx4 v26, s[16:19], s28 offen lds
    v_exp_f32 v96, v96
    v_mfma_f32_16x16x32_bf16 v[88:91], v[64:67], a[56:59], v[88:91]
    v_exp_f32 v97, v97
    v_mfma_f32_16x16x32_bf16 v[88:91], v[68:71], a[60:63], v[88:91]
    s_add_u32 m0, m0, s53
    v_exp_f32 v98, v98
    v_mfma_f32_16x16x32_bf16 v[92:95], v[72:75], a[48:51], v[40:43]
    v_exp_f32 v99, v99
    v_mfma_f32_16x16x32_bf16 v[92:95], v[76:79], a[52:55], v[92:95]
    s_add_u32 s28, s49, s89
    v_add_f32 v16, v16, v96
    v_add_f32 v17, v17, v97
    v_mfma_f32_16x16x32_bf16 v[92:95], v[80:83], a[56:59], v[92:95]
    v_cvt_pk_bf16_f32 v108, v96, v97
    v_mfma_f32_16x16x32_bf16 v[92:95], v[84:87], a[60:63], v[92:95]
    buffer_load_dwordx4 v26, s[16:19], s28 offen lds
    v_exp_f32 v100, v100
    v_mfma_f32_16x16x32_bf16 v[148:151], v[112:115], v[104:107], v[148:151]
    v_exp_f32 v101, v101
    v_mfma_f32_16x16x32_bf16 v[176:179], v[116:119], v[104:107], v[176:179]
    s_add_u32 m0, m0, s53
    v_add_f32 v16, v16, v98
    v_add_f32 v17, v17, v99
    v_mfma_f32_16x16x32_bf16 v[204:207], v[120:123], v[104:107], v[204:207]
    v_cvt_pk_bf16_f32 v109, v98, v99
    v_mfma_f32_16x16x32_bf16 v[232:235], v[124:127], v[104:107], v[232:235]
    s_add_u32 s28, s49, s90
    v_exp_f32 v102, v102
    v_mfma_f32_16x16x32_bf16 a[116:119], v[128:131], v[104:107], a[116:119]
    v_exp_f32 v103, v103
    v_mfma_f32_16x16x32_bf16 a[144:147], v[132:135], v[104:107], a[144:147]
    buffer_load_dwordx4 v26, s[16:19], s28 offen lds
    v_add_f32 v16, v16, v100
    v_add_f32 v17, v17, v101
    v_mfma_f32_16x16x32_bf16 a[172:175], v[136:139], v[104:107], a[172:175]
    v_cvt_pk_bf16_f32 v110, v100, v101
    v_add_f32 v16, v16, v102
    v_mfma_f32_16x16x32_bf16 a[200:203], v[140:143], v[104:107], a[200:203]
    s_add_u32 m0, m0, s53
    v_add_f32 v17, v17, v103
    v_cvt_pk_bf16_f32 v111, v102, v103
    v_mfma_f32_16x16x32_bf16 v[96:99], v[56:59], a[64:67], v[44:47]
    v_mfma_f32_16x16x32_bf16 v[96:99], v[60:63], a[68:71], v[96:99]
    s_add_u32 s28, s49, s91
    v_exp_f32 v88, v88
    v_mfma_f32_16x16x32_bf16 v[96:99], v[64:67], a[72:75], v[96:99]
    v_exp_f32 v89, v89
    v_mfma_f32_16x16x32_bf16 v[96:99], v[68:71], a[76:79], v[96:99]
    buffer_load_dwordx4 v26, s[16:19], s28 offen lds
    v_exp_f32 v90, v90
    v_mfma_f32_16x16x32_bf16 v[100:103], v[72:75], a[64:67], v[44:47]
    v_exp_f32 v91, v91
    v_mfma_f32_16x16x32_bf16 v[100:103], v[76:79], a[68:71], v[100:103]
    s_add_u32 m0, m0, s53
    v_add_f32 v18, v18, v88
    v_add_f32 v19, v19, v89
    v_mfma_f32_16x16x32_bf16 v[100:103], v[80:83], a[72:75], v[100:103]
    v_cvt_pk_bf16_f32 v104, v88, v89
    v_mfma_f32_16x16x32_bf16 v[100:103], v[84:87], a[76:79], v[100:103]
    s_add_u32 s28, s49, s92
    v_exp_f32 v92, v92
    v_mfma_f32_16x16x32_bf16 v[152:155], v[112:115], v[108:111], v[152:155]
    v_exp_f32 v93, v93
    v_mfma_f32_16x16x32_bf16 v[180:183], v[116:119], v[108:111], v[180:183]
    buffer_load_dwordx4 v26, s[16:19], s28 offen lds
    v_add_f32 v18, v18, v90
    v_add_f32 v19, v19, v91
    v_mfma_f32_16x16x32_bf16 v[208:211], v[120:123], v[108:111], v[208:211]
    v_cvt_pk_bf16_f32 v105, v90, v91
    v_mfma_f32_16x16x32_bf16 v[236:239], v[124:127], v[108:111], v[236:239]
    s_add_u32 m0, m0, s53
    v_exp_f32 v94, v94
    v_mfma_f32_16x16x32_bf16 a[120:123], v[128:131], v[108:111], a[120:123]
    v_exp_f32 v95, v95
    v_mfma_f32_16x16x32_bf16 a[148:151], v[132:135], v[108:111], a[148:151]
    s_add_u32 s28, s49, s93
    v_add_f32 v18, v18, v92
    v_add_f32 v19, v19, v93
    v_mfma_f32_16x16x32_bf16 a[176:179], v[136:139], v[108:111], a[176:179]
    v_cvt_pk_bf16_f32 v106, v92, v93
    v_add_f32 v18, v18, v94
    v_mfma_f32_16x16x32_bf16 a[204:207], v[140:143], v[108:111], a[204:207]
    buffer_load_dwordx4 v26, s[16:19], s28 offen lds
    v_add_f32 v19, v19, v95
    v_cvt_pk_bf16_f32 v107, v94, v95
    v_mfma_f32_16x16x32_bf16 v[88:91], v[56:59], a[80:83], v[48:51]
    v_mfma_f32_16x16x32_bf16 v[88:91], v[60:63], a[84:87], v[88:91]
    s_add_u32 m0, m0, s53
    v_exp_f32 v96, v96
    v_mfma_f32_16x16x32_bf16 v[88:91], v[64:67], a[88:91], v[88:91]
    v_exp_f32 v97, v97
    v_mfma_f32_16x16x32_bf16 v[88:91], v[68:71], a[92:95], v[88:91]
    s_add_u32 s28, s49, s94
    v_exp_f32 v98, v98
    v_mfma_f32_16x16x32_bf16 v[92:95], v[72:75], a[80:83], v[48:51]
    v_exp_f32 v99, v99
    v_mfma_f32_16x16x32_bf16 v[92:95], v[76:79], a[84:87], v[92:95]
    buffer_load_dwordx4 v26, s[16:19], s28 offen lds
    v_add_f32 v20, v20, v96
    v_add_f32 v21, v21, v97
    v_mfma_f32_16x16x32_bf16 v[92:95], v[80:83], a[88:91], v[92:95]
    v_cvt_pk_bf16_f32 v108, v96, v97
    v_mfma_f32_16x16x32_bf16 v[92:95], v[84:87], a[92:95], v[92:95]
    s_add_u32 m0, m0, s53
    v_exp_f32 v100, v100
    v_mfma_f32_16x16x32_bf16 v[156:159], v[112:115], v[104:107], v[156:159]
    v_exp_f32 v101, v101
    v_mfma_f32_16x16x32_bf16 v[184:187], v[116:119], v[104:107], v[184:187]
    s_add_u32 s28, s49, s95
    v_add_f32 v20, v20, v98
    v_add_f32 v21, v21, v99
    v_mfma_f32_16x16x32_bf16 v[212:215], v[120:123], v[104:107], v[212:215]
    v_cvt_pk_bf16_f32 v109, v98, v99
    v_mfma_f32_16x16x32_bf16 v[240:243], v[124:127], v[104:107], v[240:243]
    buffer_load_dwordx4 v26, s[16:19], s28 offen lds
    v_exp_f32 v102, v102
    v_mfma_f32_16x16x32_bf16 a[124:127], v[128:131], v[104:107], a[124:127]
    v_exp_f32 v103, v103
    v_mfma_f32_16x16x32_bf16 a[152:155], v[132:135], v[104:107], a[152:155]
    v_add_f32 v20, v20, v100
    v_add_f32 v21, v21, v101
    v_mfma_f32_16x16x32_bf16 a[180:183], v[136:139], v[104:107], a[180:183]
    v_cvt_pk_bf16_f32 v110, v100, v101
    v_add_f32 v20, v20, v102
    v_mfma_f32_16x16x32_bf16 a[208:211], v[140:143], v[104:107], a[208:211]
    v_add_f32 v21, v21, v103
    v_cvt_pk_bf16_f32 v111, v102, v103
    s_waitcnt vmcnt(16) lgkmcnt(0)
    s_barrier
    v_mfma_f32_16x16x32_bf16 v[96:99], v[56:59], a[96:99], v[52:55]
    s_add_u32 m0, s33, 25344
    v_mfma_f32_16x16x32_bf16 v[96:99], v[60:63], a[100:103], v[96:99]
    s_mov_b32 s49, s50
    v_exp_f32 v88, v88
    v_mfma_f32_16x16x32_bf16 v[96:99], v[64:67], a[104:107], v[96:99]
    s_add_u32 s50, s50, s51
    v_exp_f32 v89, v89
    v_mfma_f32_16x16x32_bf16 v[96:99], v[68:71], a[108:111], v[96:99]
    s_add_u32 s82, s82, 1
    v_exp_f32 v90, v90
    v_mfma_f32_16x16x32_bf16 v[100:103], v[72:75], a[96:99], v[52:55]
    s_cmp_eq_u32 s82, 20
    v_exp_f32 v91, v91
    v_mfma_f32_16x16x32_bf16 v[100:103], v[76:79], a[100:103], v[100:103]
    s_cselect_b32 s29, s83, 0
    v_add_f32 v22, v22, v88
    v_add_f32 v23, v23, v89
    v_mfma_f32_16x16x32_bf16 v[100:103], v[80:83], a[104:107], v[100:103]
    s_sub_u32 s50, s50, s29
    v_cvt_pk_bf16_f32 v104, v88, v89
    v_mfma_f32_16x16x32_bf16 v[100:103], v[84:87], a[108:111], v[100:103]
    v_exp_f32 v92, v92
    v_mfma_f32_16x16x32_bf16 v[160:163], v[112:115], v[108:111], v[160:163]
    s_add_u32 s28, s49, s88
    v_exp_f32 v93, v93
    v_mfma_f32_16x16x32_bf16 v[188:191], v[116:119], v[108:111], v[188:191]
    buffer_load_dwordx4 v26, s[16:19], s28 offen lds
    v_add_f32 v22, v22, v90
    v_add_f32 v23, v23, v91
    v_mfma_f32_16x16x32_bf16 v[216:219], v[120:123], v[108:111], v[216:219]
    s_add_u32 m0, m0, s53
    v_cvt_pk_bf16_f32 v105, v90, v91
    v_mfma_f32_16x16x32_bf16 v[244:247], v[124:127], v[108:111], v[244:247]
    s_add_u32 s28, s49, s89
    v_exp_f32 v94, v94
    v_mfma_f32_16x16x32_bf16 a[128:131], v[128:131], v[108:111], a[128:131]
    buffer_load_dwordx4 v26, s[16:19], s28 offen lds
    v_exp_f32 v95, v95
    v_mfma_f32_16x16x32_bf16 a[156:159], v[132:135], v[108:111], a[156:159]
    s_add_u32 m0, m0, s53
    v_add_f32 v22, v22, v92
    v_add_f32 v23, v23, v93
    v_mfma_f32_16x16x32_bf16 a[184:187], v[136:139], v[108:111], a[184:187]
    s_add_u32 s28, s49, s90
    v_cvt_pk_bf16_f32 v106, v92, v93
    v_add_f32 v22, v22, v94
    v_mfma_f32_16x16x32_bf16 a[212:215], v[140:143], v[108:111], a[212:215]
    buffer_load_dwordx4 v26, s[16:19], s28 offen lds
    v_add_f32 v23, v23, v95
    v_cvt_pk_bf16_f32 v107, v94, v95
    s_nop 1
    v_mfma_f32_16x16x32_bf16 v[164:167], v[112:115], v[104:107], v[164:167]
    s_add_u32 m0, m0, s53
    s_add_u32 s28, s49, s91
    v_exp_f32 v96, v96
    v_mfma_f32_16x16x32_bf16 v[192:195], v[116:119], v[104:107], v[192:195]
    buffer_load_dwordx4 v26, s[16:19], s28 offen lds
    s_add_u32 m0, m0, s53
    v_exp_f32 v97, v97
    v_exp_f32 v98, v98
    v_mfma_f32_16x16x32_bf16 v[220:223], v[120:123], v[104:107], v[220:223]
    s_add_u32 s28, s49, s92
    buffer_load_dwordx4 v26, s[16:19], s28 offen lds
    v_exp_f32 v99, v99
    v_add_f32 v24, v24, v96
    v_add_f32 v25, v25, v97
    v_mfma_f32_16x16x32_bf16 v[248:251], v[124:127], v[104:107], v[248:251]
    s_add_u32 m0, m0, s53
    v_cvt_pk_bf16_f32 v108, v96, v97
    v_exp_f32 v100, v100
    v_mfma_f32_16x16x32_bf16 a[132:135], v[128:131], v[104:107], a[132:135]
    s_add_u32 s28, s49, s93
    buffer_load_dwordx4 v26, s[16:19], s28 offen lds
    v_exp_f32 v101, v101
    v_add_f32 v24, v24, v98
    v_add_f32 v25, v25, v99
    v_mfma_f32_16x16x32_bf16 a[160:163], v[132:135], v[104:107], a[160:163]
    s_add_u32 m0, m0, s53
    s_add_u32 s28, s49, s94
    v_cvt_pk_bf16_f32 v109, v98, v99
    v_exp_f32 v102, v102
    v_mfma_f32_16x16x32_bf16 a[188:191], v[136:139], v[104:107], a[188:191]
    buffer_load_dwordx4 v26, s[16:19], s28 offen lds
    s_add_u32 m0, m0, s53
    v_exp_f32 v103, v103
    v_add_f32 v24, v24, v100
    v_add_f32 v25, v25, v101
    v_mfma_f32_16x16x32_bf16 a[216:219], v[140:143], v[104:107], a[216:219]
    s_add_u32 s28, s49, s95
    buffer_load_dwordx4 v26, s[16:19], s28 offen lds
    v_cvt_pk_bf16_f32 v110, v100, v101
    v_add_f32 v24, v24, v102
    v_add_f32 v25, v25, v103
    v_cvt_pk_bf16_f32 v111, v102, v103
    s_branch L_at_aepi
L_at_atailB:
    v_mfma_f32_16x16x32_bf16 v[88:91], v[56:59], a[16:19], v[32:35]
    v_mfma_f32_16x16x32_bf16 v[88:91], v[60:63], a[20:23], v[88:91]
    v_exp_f32 v96, v96
    v_mfma_f32_16x16x32_bf16 v[88:91], v[64:67], a[24:27], v[88:91]
    v_exp_f32 v97, v97
    v_mfma_f32_16x16x32_bf16 v[88:91], v[68:71], a[28:31], v[88:91]
    v_exp_f32 v98, v98
    v_mfma_f32_16x16x32_bf16 v[92:95], v[72:75], a[16:19], v[32:35]
    v_exp_f32 v99, v99
    v_mfma_f32_16x16x32_bf16 v[92:95], v[76:79], a[20:23], v[92:95]
    v_add_f32 v12, v12, v96
    v_add_f32 v13, v13, v97
    v_mfma_f32_16x16x32_bf16 v[92:95], v[80:83], a[24:27], v[92:95]
    v_cvt_pk_bf16_f32 v108, v96, v97
    v_mfma_f32_16x16x32_bf16 v[92:95], v[84:87], a[28:31], v[92:95]
    v_exp_f32 v100, v100
    v_mfma_f32_16x16x32_bf16 v[168:171], v[112:115], v[104:107], v[168:171]
    ds_read_b64_tr_b16 v[112:113], v9 offset:8448
    ds_read_b64_tr_b16 v[114:115], v9 offset:8960
    v_exp_f32 v101, v101
    v_mfma_f32_16x16x32_bf16 v[196:199], v[116:119], v[104:107], v[196:199]
    ds_read_b64_tr_b16 v[116:117], v9 offset:8480
    ds_read_b64_tr_b16 v[118:119], v9 offset:8992
    v_add_f32 v12, v12, v98
    v_add_f32 v13, v13, v99
    v_mfma_f32_16x16x32_bf16 v[224:227], v[120:123], v[104:107], v[224:227]
    ds_read_b64_tr_b16 v[120:121], v9 offset:8512
    ds_read_b64_tr_b16 v[122:123], v9 offset:9024
    v_cvt_pk_bf16_f32 v109, v98, v99
    v_mfma_f32_16x16x32_bf16 v[252:255], v[124:127], v[104:107], v[252:255]
    ds_read_b64_tr_b16 v[124:125], v9 offset:8544
    ds_read_b64_tr_b16 v[126:127], v9 offset:9056
    v_exp_f32 v102, v102
    v_mfma_f32_16x16x32_bf16 a[136:139], v[128:131], v[104:107], a[136:139]
    ds_read_b64_tr_b16 v[128:129], v9 offset:8576
    ds_read_b64_tr_b16 v[130:131], v9 offset:9088
    v_exp_f32 v103, v103
    v_mfma_f32_16x16x32_bf16 a[164:167], v[132:135], v[104:107], a[164:167]
    ds_read_b64_tr_b16 v[132:133], v9 offset:8608
    ds_read_b64_tr_b16 v[134:135], v9 offset:9120
    v_add_f32 v12, v12, v100
    v_add_f32 v13, v13, v101
    v_mfma_f32_16x16x32_bf16 a[192:195], v[136:139], v[104:107], a[192:195]
    ds_read_b64_tr_b16 v[136:137], v9 offset:8640
    ds_read_b64_tr_b16 v[138:139], v9 offset:9152
    v_cvt_pk_bf16_f32 v110, v100, v101
    v_add_f32 v12, v12, v102
    v_mfma_f32_16x16x32_bf16 a[220:223], v[140:143], v[104:107], a[220:223]
    ds_read_b64_tr_b16 v[140:141], v9 offset:8672
    ds_read_b64_tr_b16 v[142:143], v9 offset:9184
    v_add_f32 v13, v13, v103
    v_cvt_pk_bf16_f32 v111, v102, v103
    v_mfma_f32_16x16x32_bf16 v[96:99], v[56:59], a[32:35], v[36:39]
    v_mfma_f32_16x16x32_bf16 v[96:99], v[60:63], a[36:39], v[96:99]
    s_add_u32 s29, s34, s100
    v_exp_f32 v88, v88
    v_mfma_f32_16x16x32_bf16 v[96:99], v[64:67], a[40:43], v[96:99]
    v_exp_f32 v89, v89
    v_mfma_f32_16x16x32_bf16 v[96:99], v[68:71], a[44:47], v[96:99]
    s_bfe_u32 s28, s29, 0x20003
    v_exp_f32 v90, v90
    v_mfma_f32_16x16x32_bf16 v[100:103], v[72:75], a[32:35], v[36:39]
    v_exp_f32 v91, v91
    v_mfma_f32_16x16x32_bf16 v[100:103], v[76:79], a[36:39], v[100:103]
    s_lshl_b32 s28, s28, 16
    v_add_f32 v14, v14, v88
    v_add_f32 v15, v15, v89
    v_mfma_f32_16x16x32_bf16 v[100:103], v[80:83], a[40:43], v[100:103]
    v_cvt_pk_bf16_f32 v104, v88, v89
    v_mfma_f32_16x16x32_bf16 v[100:103], v[84:87], a[44:47], v[100:103]
    v_exp_f32 v92, v92
    s_waitcnt lgkmcnt(0)
    v_mfma_f32_16x16x32_bf16 v[144:147], v[112:115], v[108:111], v[144:147]
    s_and_b32 s29, s29, 7
    v_exp_f32 v93, v93
    v_mfma_f32_16x16x32_bf16 v[172:175], v[116:119], v[108:111], v[172:175]
    v_add_f32 v14, v14, v90
    v_add_f32 v15, v15, v91
    v_mfma_f32_16x16x32_bf16 v[200:203], v[120:123], v[108:111], v[200:203]
    s_lshl_b32 s29, s29, 11
    v_cvt_pk_bf16_f32 v105, v90, v91
    v_mfma_f32_16x16x32_bf16 v[228:231], v[124:127], v[108:111], v[228:231]
    v_exp_f32 v94, v94
    v_mfma_f32_16x16x32_bf16 a[112:115], v[128:131], v[108:111], a[112:115]
    s_add_u32 s29, s28, s29
    v_exp_f32 v95, v95
    v_mfma_f32_16x16x32_bf16 a[140:143], v[132:135], v[108:111], a[140:143]
    v_add_f32 v14, v14, v92
    v_add_f32 v15, v15, v93
    v_mfma_f32_16x16x32_bf16 a[168:171], v[136:139], v[108:111], a[168:171]
    s_lshr_b32 s28, s34, 5
    v_cvt_pk_bf16_f32 v106, v92, v93
    v_add_f32 v14, v14, v94
    v_mfma_f32_16x16x32_bf16 a[196:199], v[140:143], v[108:111], a[196:199]
    v_add_f32 v15, v15, v95
    v_cvt_pk_bf16_f32 v107, v94, v95
    v_mfma_f32_16x16x32_bf16 v[88:91], v[56:59], a[48:51], v[40:43]
    v_mfma_f32_16x16x32_bf16 v[88:91], v[60:63], a[52:55], v[88:91]
    s_lshl_b32 s28, s28, 19
    v_exp_f32 v96, v96
    v_mfma_f32_16x16x32_bf16 v[88:91], v[64:67], a[56:59], v[88:91]
    v_exp_f32 v97, v97
    v_mfma_f32_16x16x32_bf16 v[88:91], v[68:71], a[60:63], v[88:91]
    s_add_u32 s49, s28, s29
    v_exp_f32 v98, v98
    v_mfma_f32_16x16x32_bf16 v[92:95], v[72:75], a[48:51], v[40:43]
    v_exp_f32 v99, v99
    v_mfma_f32_16x16x32_bf16 v[92:95], v[76:79], a[52:55], v[92:95]
    s_add_u32 m0, s33, 0
    v_add_f32 v16, v16, v96
    v_add_f32 v17, v17, v97
    v_mfma_f32_16x16x32_bf16 v[92:95], v[80:83], a[56:59], v[92:95]
    v_cvt_pk_bf16_f32 v108, v96, v97
    v_mfma_f32_16x16x32_bf16 v[92:95], v[84:87], a[60:63], v[92:95]
    v_exp_f32 v100, v100
    v_mfma_f32_16x16x32_bf16 v[148:151], v[112:115], v[104:107], v[148:151]
    s_add_u32 s34, s34, 1
    v_exp_f32 v101, v101
    v_mfma_f32_16x16x32_bf16 v[176:179], v[116:119], v[104:107], v[176:179]
    v_add_f32 v16, v16, v98
    v_add_f32 v17, v17, v99
    v_mfma_f32_16x16x32_bf16 v[204:207], v[120:123], v[104:107], v[204:207]
    buffer_load_dwordx4 v7, s[4:7], s49 offen offset:0 nt lds
    v_cvt_pk_bf16_f32 v109, v98, v99
    v_mfma_f32_16x16x32_bf16 v[232:235], v[124:127], v[104:107], v[232:235]
    v_exp_f32 v102, v102
    v_mfma_f32_16x16x32_bf16 a[116:119], v[128:131], v[104:107], a[116:119]
    s_add_u32 m0, m0, s96
    v_exp_f32 v103, v103
    v_mfma_f32_16x16x32_bf16 a[144:147], v[132:135], v[104:107], a[144:147]
    v_add_f32 v16, v16, v100
    v_add_f32 v17, v17, v101
    v_mfma_f32_16x16x32_bf16 a[172:175], v[136:139], v[104:107], a[172:175]
    buffer_load_dwordx4 v7, s[4:7], s49 offen offset:256 nt lds
    v_cvt_pk_bf16_f32 v110, v100, v101
    v_add_f32 v16, v16, v102
    v_mfma_f32_16x16x32_bf16 a[200:203], v[140:143], v[104:107], a[200:203]
    v_add_f32 v17, v17, v103
    v_cvt_pk_bf16_f32 v111, v102, v103
    v_mfma_f32_16x16x32_bf16 v[96:99], v[56:59], a[64:67], v[44:47]
    v_mfma_f32_16x16x32_bf16 v[96:99], v[60:63], a[68:71], v[96:99]
    s_add_u32 m0, m0, s97
    v_exp_f32 v88, v88
    v_mfma_f32_16x16x32_bf16 v[96:99], v[64:67], a[72:75], v[96:99]
    v_exp_f32 v89, v89
    v_mfma_f32_16x16x32_bf16 v[96:99], v[68:71], a[76:79], v[96:99]
    buffer_load_dwordx4 v7, s[4:7], s49 offen offset:512 nt lds
    v_exp_f32 v90, v90
    v_mfma_f32_16x16x32_bf16 v[100:103], v[72:75], a[64:67], v[44:47]
    v_exp_f32 v91, v91
    v_mfma_f32_16x16x32_bf16 v[100:103], v[76:79], a[68:71], v[100:103]
    s_add_u32 m0, m0, s96
    v_add_f32 v18, v18, v88
    v_add_f32 v19, v19, v89
    v_mfma_f32_16x16x32_bf16 v[100:103], v[80:83], a[72:75], v[100:103]
    v_cvt_pk_bf16_f32 v104, v88, v89
    v_mfma_f32_16x16x32_bf16 v[100:103], v[84:87], a[76:79], v[100:103]
    v_exp_f32 v92, v92
    v_mfma_f32_16x16x32_bf16 v[152:155], v[112:115], v[108:111], v[152:155]
    buffer_load_dwordx4 v7, s[4:7], s49 offen offset:768 nt lds
    v_exp_f32 v93, v93
    v_mfma_f32_16x16x32_bf16 v[180:183], v[116:119], v[108:111], v[180:183]
    v_add_f32 v18, v18, v90
    v_add_f32 v19, v19, v91
    v_mfma_f32_16x16x32_bf16 v[208:211], v[120:123], v[108:111], v[208:211]
    s_add_u32 m0, m0, s97
    v_cvt_pk_bf16_f32 v105, v90, v91
    v_mfma_f32_16x16x32_bf16 v[236:239], v[124:127], v[108:111], v[236:239]
    v_exp_f32 v94, v94
    v_mfma_f32_16x16x32_bf16 a[120:123], v[128:131], v[108:111], a[120:123]
    buffer_load_dwordx4 v7, s[4:7], s49 offen offset:1024 nt lds
    v_exp_f32 v95, v95
    v_mfma_f32_16x16x32_bf16 a[148:151], v[132:135], v[108:111], a[148:151]
    v_add_f32 v18, v18, v92
    v_add_f32 v19, v19, v93
    v_mfma_f32_16x16x32_bf16 a[176:179], v[136:139], v[108:111], a[176:179]
    s_add_u32 m0, m0, s96
    v_cvt_pk_bf16_f32 v106, v92, v93
    v_add_f32 v18, v18, v94
    v_mfma_f32_16x16x32_bf16 a[204:207], v[140:143], v[108:111], a[204:207]
    v_add_f32 v19, v19, v95
    v_cvt_pk_bf16_f32 v107, v94, v95
    v_mfma_f32_16x16x32_bf16 v[88:91], v[56:59], a[80:83], v[48:51]
    v_mfma_f32_16x16x32_bf16 v[88:91], v[60:63], a[84:87], v[88:91]
    buffer_load_dwordx4 v7, s[4:7], s49 offen offset:1280 nt lds
    v_exp_f32 v96, v96
    v_mfma_f32_16x16x32_bf16 v[88:91], v[64:67], a[88:91], v[88:91]
    v_exp_f32 v97, v97
    v_mfma_f32_16x16x32_bf16 v[88:91], v[68:71], a[92:95], v[88:91]
    s_add_u32 m0, m0, s97
    v_exp_f32 v98, v98
    v_mfma_f32_16x16x32_bf16 v[92:95], v[72:75], a[80:83], v[48:51]
    v_exp_f32 v99, v99
    v_mfma_f32_16x16x32_bf16 v[92:95], v[76:79], a[84:87], v[92:95]
    buffer_load_dwordx4 v7, s[4:7], s49 offen offset:1536 nt lds
    v_add_f32 v20, v20, v96
    v_add_f32 v21, v21, v97
    v_mfma_f32_16x16x32_bf16 v[92:95], v[80:83], a[88:91], v[92:95]
    v_cvt_pk_bf16_f32 v108, v96, v97
    v_mfma_f32_16x16x32_bf16 v[92:95], v[84:87], a[92:95], v[92:95]
    v_exp_f32 v100, v100
    v_mfma_f32_16x16x32_bf16 v[156:159], v[112:115], v[104:107], v[156:159]
    s_add_u32 m0, m0, s96
    v_exp_f32 v101, v101
    v_mfma_f32_16x16x32_bf16 v[184:187], v[116:119], v[104:107], v[184:187]
    v_add_f32 v20, v20, v98
    v_add_f32 v21, v21, v99
    v_mfma_f32_16x16x32_bf16 v[212:215], v[120:123], v[104:107], v[212:215]
    buffer_load_dwordx4 v7, s[4:7], s49 offen offset:1792 nt lds
    v_cvt_pk_bf16_f32 v109, v98, v99
    v_mfma_f32_16x16x32_bf16 v[240:243], v[124:127], v[104:107], v[240:243]
    v_exp_f32 v102, v102
    v_mfma_f32_16x16x32_bf16 a[124:127], v[128:131], v[104:107], a[124:127]
    v_exp_f32 v103, v103
    v_mfma_f32_16x16x32_bf16 a[152:155], v[132:135], v[104:107], a[152:155]
    v_add_f32 v20, v20, v100
    v_add_f32 v21, v21, v101
    v_mfma_f32_16x16x32_bf16 a[180:183], v[136:139], v[104:107], a[180:183]
    v_cvt_pk_bf16_f32 v110, v100, v101
    v_add_f32 v20, v20, v102
    v_mfma_f32_16x16x32_bf16 a[208:211], v[140:143], v[104:107], a[208:211]
    v_add_f32 v21, v21, v103
    v_cvt_pk_bf16_f32 v111, v102, v103
    s_waitcnt vmcnt(16) lgkmcnt(0)
    s_barrier
    v_mfma_f32_16x16x32_bf16 v[96:99], v[56:59], a[96:99], v[52:55]
    ds_read_b128 v[56:59], v8 offset:16896
    v_mfma_f32_16x16x32_bf16 v[96:99], v[60:63], a[100:103], v[96:99]
    ds_read_b128 v[60:63], v8 offset:16960
    v_exp_f32 v88, v88
    v_mfma_f32_16x16x32_bf16 v[96:99], v[64:67], a[104:107], v[96:99]
    ds_read_b128 v[64:67], v8 offset:17024
    v_exp_f32 v89, v89
    v_mfma_f32_16x16x32_bf16 v[96:99], v[68:71], a[108:111], v[96:99]
    ds_read_b128 v[68:71], v8 offset:17088
    v_exp_f32 v90, v90
    v_mfma_f32_16x16x32_bf16 v[100:103], v[72:75], a[96:99], v[52:55]
    ds_read_b128 v[72:75], v8 offset:17408
    v_exp_f32 v91, v91
    v_mfma_f32_16x16x32_bf16 v[100:103], v[76:79], a[100:103], v[100:103]
    ds_read_b128 v[76:79], v8 offset:17472
    v_add_f32 v22, v22, v88
    v_add_f32 v23, v23, v89
    v_mfma_f32_16x16x32_bf16 v[100:103], v[80:83], a[104:107], v[100:103]
    ds_read_b128 v[80:83], v8 offset:17536
    v_cvt_pk_bf16_f32 v104, v88, v89
    v_mfma_f32_16x16x32_bf16 v[100:103], v[84:87], a[108:111], v[100:103]
    ds_read_b128 v[84:87], v8 offset:17600
    v_exp_f32 v92, v92
    v_mfma_f32_16x16x32_bf16 v[160:163], v[112:115], v[108:111], v[160:163]
    v_exp_f32 v93, v93
    v_mfma_f32_16x16x32_bf16 v[188:191], v[116:119], v[108:111], v[188:191]
    v_add_f32 v22, v22, v90
    v_add_f32 v23, v23, v91
    v_mfma_f32_16x16x32_bf16 v[216:219], v[120:123], v[108:111], v[216:219]
    v_cvt_pk_bf16_f32 v105, v90, v91
    v_mfma_f32_16x16x32_bf16 v[244:247], v[124:127], v[108:111], v[244:247]
    v_exp_f32 v94, v94
    v_mfma_f32_16x16x32_bf16 a[128:131], v[128:131], v[108:111], a[128:131]
    v_exp_f32 v95, v95
    v_mfma_f32_16x16x32_bf16 a[156:159], v[132:135], v[108:111], a[156:159]
    v_add_f32 v22, v22, v92
    v_add_f32 v23, v23, v93
    v_mfma_f32_16x16x32_bf16 a[184:187], v[136:139], v[108:111], a[184:187]
    v_cvt_pk_bf16_f32 v106, v92, v93
    v_add_f32 v22, v22, v94
    v_mfma_f32_16x16x32_bf16 a[212:215], v[140:143], v[108:111], a[212:215]
    v_add_f32 v23, v23, v95
    v_cvt_pk_bf16_f32 v107, v94, v95
    s_waitcnt lgkmcnt(0)
    v_mfma_f32_16x16x32_bf16 v[88:91], v[56:59], a[0:3], v[28:31]
    v_mfma_f32_16x16x32_bf16 v[88:91], v[60:63], a[4:7], v[88:91]
    v_exp_f32 v96, v96
    v_mfma_f32_16x16x32_bf16 v[88:91], v[64:67], a[8:11], v[88:91]
    v_exp_f32 v97, v97
    v_mfma_f32_16x16x32_bf16 v[88:91], v[68:71], a[12:15], v[88:91]
    v_exp_f32 v98, v98
    v_mfma_f32_16x16x32_bf16 v[92:95], v[72:75], a[0:3], v[28:31]
    v_exp_f32 v99, v99
    v_mfma_f32_16x16x32_bf16 v[92:95], v[76:79], a[4:7], v[92:95]
    v_add_f32 v24, v24, v96
    v_add_f32 v25, v25, v97
    v_mfma_f32_16x16x32_bf16 v[92:95], v[80:83], a[8:11], v[92:95]
    v_cvt_pk_bf16_f32 v108, v96, v97
    v_mfma_f32_16x16x32_bf16 v[92:95], v[84:87], a[12:15], v[92:95]
    v_exp_f32 v100, v100
    v_mfma_f32_16x16x32_bf16 v[164:167], v[112:115], v[104:107], v[164:167]
    v_exp_f32 v101, v101
    v_mfma_f32_16x16x32_bf16 v[192:195], v[116:119], v[104:107], v[192:195]
    v_add_f32 v24, v24, v98
    v_add_f32 v25, v25, v99
    v_mfma_f32_16x16x32_bf16 v[220:223], v[120:123], v[104:107], v[220:223]
    v_cvt_pk_bf16_f32 v109, v98, v99
    v_mfma_f32_16x16x32_bf16 v[248:251], v[124:127], v[104:107], v[248:251]
    v_exp_f32 v102, v102
    v_mfma_f32_16x16x32_bf16 a[132:135], v[128:131], v[104:107], a[132:135]
    v_exp_f32 v103, v103
    v_mfma_f32_16x16x32_bf16 a[160:163], v[132:135], v[104:107], a[160:163]
    v_add_f32 v24, v24, v100
    v_add_f32 v25, v25, v101
    v_mfma_f32_16x16x32_bf16 a[188:191], v[136:139], v[104:107], a[188:191]
    v_cvt_pk_bf16_f32 v110, v100, v101
    v_add_f32 v24, v24, v102
    v_mfma_f32_16x16x32_bf16 a[216:219], v[140:143], v[104:107], a[216:219]
    v_add_f32 v25, v25, v103
    v_cvt_pk_bf16_f32 v111, v102, v103
    v_mfma_f32_16x16x32_bf16 v[96:99], v[56:59], a[16:19], v[32:35]
    v_mfma_f32_16x16x32_bf16 v[96:99], v[60:63], a[20:23], v[96:99]
    v_exp_f32 v88, v88
    v_mfma_f32_16x16x32_bf16 v[96:99], v[64:67], a[24:27], v[96:99]
    v_exp_f32 v89, v89
    v_mfma_f32_16x16x32_bf16 v[96:99], v[68:71], a[28:31], v[96:99]
    v_exp_f32 v90, v90
    v_mfma_f32_16x16x32_bf16 v[100:103], v[72:75], a[16:19], v[32:35]
    v_exp_f32 v91, v91
    v_mfma_f32_16x16x32_bf16 v[100:103], v[76:79], a[20:23], v[100:103]
    v_add_f32 v12, v12, v88
    v_add_f32 v13, v13, v89
    v_mfma_f32_16x16x32_bf16 v[100:103], v[80:83], a[24:27], v[100:103]
    v_cvt_pk_bf16_f32 v104, v88, v89
    v_mfma_f32_16x16x32_bf16 v[100:103], v[84:87], a[28:31], v[100:103]
    v_exp_f32 v92, v92
    v_mfma_f32_16x16x32_bf16 v[168:171], v[112:115], v[108:111], v[168:171]
    ds_read_b64_tr_b16 v[112:113], v9 offset:16896
    ds_read_b64_tr_b16 v[114:115], v9 offset:17408
    v_exp_f32 v93, v93
    v_mfma_f32_16x16x32_bf16 v[196:199], v[116:119], v[108:111], v[196:199]
    ds_read_b64_tr_b16 v[116:117], v9 offset:16928
    ds_read_b64_tr_b16 v[118:119], v9 offset:17440
    v_add_f32 v12, v12, v90
    v_add_f32 v13, v13, v91
    v_mfma_f32_16x16x32_bf16 v[224:227], v[120:123], v[108:111], v[224:227]
    ds_read_b64_tr_b16 v[120:121], v9 offset:16960
    ds_read_b64_tr_b16 v[122:123], v9 offset:17472
    v_cvt_pk_bf16_f32 v105, v90, v91
    v_mfma_f32_16x16x32_bf16 v[252:255], v[124:127], v[108:111], v[252:255]
    ds_read_b64_tr_b16 v[124:125], v9 offset:16992
    ds_read_b64_tr_b16 v[126:127], v9 offset:17504
    v_exp_f32 v94, v94
    v_mfma_f32_16x16x32_bf16 a[136:139], v[128:131], v[108:111], a[136:139]
    ds_read_b64_tr_b16 v[128:129], v9 offset:17024
    ds_read_b64_tr_b16 v[130:131], v9 offset:17536
    v_exp_f32 v95, v95
    v_mfma_f32_16x16x32_bf16 a[164:167], v[132:135], v[108:111], a[164:167]
    ds_read_b64_tr_b16 v[132:133], v9 offset:17056
    ds_read_b64_tr_b16 v[134:135], v9 offset:17568
    v_add_f32 v12, v12, v92
    v_add_f32 v13, v13, v93
    v_mfma_f32_16x16x32_bf16 a[192:195], v[136:139], v[108:111], a[192:195]
    ds_read_b64_tr_b16 v[136:137], v9 offset:17088
    ds_read_b64_tr_b16 v[138:139], v9 offset:17600
    v_cvt_pk_bf16_f32 v106, v92, v93
    v_add_f32 v12, v12, v94
    v_mfma_f32_16x16x32_bf16 a[220:223], v[140:143], v[108:111], a[220:223]
    ds_read_b64_tr_b16 v[140:141], v9 offset:17120
    ds_read_b64_tr_b16 v[142:143], v9 offset:17632
    v_add_f32 v13, v13, v95
    v_cvt_pk_bf16_f32 v107, v94, v95
    v_mfma_f32_16x16x32_bf16 v[88:91], v[56:59], a[32:35], v[36:39]
    v_mfma_f32_16x16x32_bf16 v[88:91], v[60:63], a[36:39], v[88:91]
    s_add_u32 s29, s34, s100
    v_exp_f32 v96, v96
    v_mfma_f32_16x16x32_bf16 v[88:91], v[64:67], a[40:43], v[88:91]
    v_exp_f32 v97, v97
    v_mfma_f32_16x16x32_bf16 v[88:91], v[68:71], a[44:47], v[88:91]
    s_bfe_u32 s28, s29, 0x20003
    v_exp_f32 v98, v98
    v_mfma_f32_16x16x32_bf16 v[92:95], v[72:75], a[32:35], v[36:39]
    v_exp_f32 v99, v99
    v_mfma_f32_16x16x32_bf16 v[92:95], v[76:79], a[36:39], v[92:95]
    s_lshl_b32 s28, s28, 16
    v_add_f32 v14, v14, v96
    v_add_f32 v15, v15, v97
    v_mfma_f32_16x16x32_bf16 v[92:95], v[80:83], a[40:43], v[92:95]
    v_cvt_pk_bf16_f32 v108, v96, v97
    v_mfma_f32_16x16x32_bf16 v[92:95], v[84:87], a[44:47], v[92:95]
    v_exp_f32 v100, v100
    s_waitcnt lgkmcnt(0)
    v_mfma_f32_16x16x32_bf16 v[144:147], v[112:115], v[104:107], v[144:147]
    s_and_b32 s29, s29, 7
    v_exp_f32 v101, v101
    v_mfma_f32_16x16x32_bf16 v[172:175], v[116:119], v[104:107], v[172:175]
    v_add_f32 v14, v14, v98
    v_add_f32 v15, v15, v99
    v_mfma_f32_16x16x32_bf16 v[200:203], v[120:123], v[104:107], v[200:203]
    s_lshl_b32 s29, s29, 11
    v_cvt_pk_bf16_f32 v109, v98, v99
    v_mfma_f32_16x16x32_bf16 v[228:231], v[124:127], v[104:107], v[228:231]
    v_exp_f32 v102, v102
    v_mfma_f32_16x16x32_bf16 a[112:115], v[128:131], v[104:107], a[112:115]
    s_add_u32 s29, s28, s29
    v_exp_f32 v103, v103
    v_mfma_f32_16x16x32_bf16 a[140:143], v[132:135], v[104:107], a[140:143]
    v_add_f32 v14, v14, v100
    v_add_f32 v15, v15, v101
    v_mfma_f32_16x16x32_bf16 a[168:171], v[136:139], v[104:107], a[168:171]
    s_lshr_b32 s28, s34, 5
    v_cvt_pk_bf16_f32 v110, v100, v101
    v_add_f32 v14, v14, v102
    v_mfma_f32_16x16x32_bf16 a[196:199], v[140:143], v[104:107], a[196:199]
    v_add_f32 v15, v15, v103
    v_cvt_pk_bf16_f32 v111, v102, v103
    v_mfma_f32_16x16x32_bf16 v[96:99], v[56:59], a[48:51], v[40:43]
    v_mfma_f32_16x16x32_bf16 v[96:99], v[60:63], a[52:55], v[96:99]
    s_lshl_b32 s28, s28, 19
    v_exp_f32 v88, v88
    v_mfma_f32_16x16x32_bf16 v[96:99], v[64:67], a[56:59], v[96:99]
    v_exp_f32 v89, v89
    v_mfma_f32_16x16x32_bf16 v[96:99], v[68:71], a[60:63], v[96:99]
    s_add_u32 s49, s28, s29
    v_exp_f32 v90, v90
    v_mfma_f32_16x16x32_bf16 v[100:103], v[72:75], a[48:51], v[40:43]
    v_exp_f32 v91, v91
    v_mfma_f32_16x16x32_bf16 v[100:103], v[76:79], a[52:55], v[100:103]
    s_add_u32 m0, s33, 8448
    v_add_f32 v16, v16, v88
    v_add_f32 v17, v17, v89
    v_mfma_f32_16x16x32_bf16 v[100:103], v[80:83], a[56:59], v[100:103]
    v_cvt_pk_bf16_f32 v104, v88, v89
    v_mfma_f32_16x16x32_bf16 v[100:103], v[84:87], a[60:63], v[100:103]
    v_exp_f32 v92, v92
    v_mfma_f32_16x16x32_bf16 v[148:151], v[112:115], v[108:111], v[148:151]
    s_add_u32 s34, s34, 1
    v_exp_f32 v93, v93
    v_mfma_f32_16x16x32_bf16 v[176:179], v[116:119], v[108:111], v[176:179]
    v_add_f32 v16, v16, v90
    v_add_f32 v17, v17, v91
    v_mfma_f32_16x16x32_bf16 v[204:207], v[120:123], v[108:111], v[204:207]
    buffer_load_dwordx4 v7, s[4:7], s49 offen offset:0 nt lds
    v_cvt_pk_bf16_f32 v105, v90, v91
    v_mfma_f32_16x16x32_bf16 v[232:235], v[124:127], v[108:111], v[232:235]
    v_exp_f32 v94, v94
    v_mfma_f32_16x16x32_bf16 a[116:119], v[128:131], v[108:111], a[116:119]
    s_add_u32 m0, m0, s96
    v_exp_f32 v95, v95
    v_mfma_f32_16x16x32_bf16 a[144:147], v[132:135], v[108:111], a[144:147]
    v_add_f32 v16, v16, v92
    v_add_f32 v17, v17, v93
    v_mfma_f32_16x16x32_bf16 a[172:175], v[136:139], v[108:111], a[172:175]
    buffer_load_dwordx4 v7, s[4:7], s49 offen offset:256 nt lds
    v_cvt_pk_bf16_f32 v106, v92, v93
    v_add_f32 v16, v16, v94
    v_mfma_f32_16x16x32_bf16 a[200:203], v[140:143], v[108:111], a[200:203]
    v_add_f32 v17, v17, v95
    v_cvt_pk_bf16_f32 v107, v94, v95
    v_mfma_f32_16x16x32_bf16 v[88:91], v[56:59], a[64:67], v[44:47]
    v_mfma_f32_16x16x32_bf16 v[88:91], v[60:63], a[68:71], v[88:91]
    s_add_u32 m0, m0, s97
    v_exp_f32 v96, v96
    v_mfma_f32_16x16x32_bf16 v[88:91], v[64:67], a[72:75], v[88:91]
    v_exp_f32 v97, v97
    v_mfma_f32_16x16x32_bf16 v[88:91], v[68:71], a[76:79], v[88:91]
    buffer_load_dwordx4 v7, s[4:7], s49 offen offset:512 nt lds
    v_exp_f32 v98, v98
    v_mfma_f32_16x16x32_bf16 v[92:95], v[72:75], a[64:67], v[44:47]
    v_exp_f32 v99, v99
    v_mfma_f32_16x16x32_bf16 v[92:95], v[76:79], a[68:71], v[92:95]
    s_add_u32 m0, m0, s96
    v_add_f32 v18, v18, v96
    v_add_f32 v19, v19, v97
    v_mfma_f32_16x16x32_bf16 v[92:95], v[80:83], a[72:75], v[92:95]
    v_cvt_pk_bf16_f32 v108, v96, v97
    v_mfma_f32_16x16x32_bf16 v[92:95], v[84:87], a[76:79], v[92:95]
    v_exp_f32 v100, v100
    v_mfma_f32_16x16x32_bf16 v[152:155], v[112:115], v[104:107], v[152:155]
    buffer_load_dwordx4 v7, s[4:7], s49 offen offset:768 nt lds
    v_exp_f32 v101, v101
    v_mfma_f32_16x16x32_bf16 v[180:183], v[116:119], v[104:107], v[180:183]
    v_add_f32 v18, v18, v98
    v_add_f32 v19, v19, v99
    v_mfma_f32_16x16x32_bf16 v[208:211], v[120:123], v[104:107], v[208:211]
    s_add_u32 m0, m0, s97
    v_cvt_pk_bf16_f32 v109, v98, v99
    v_mfma_f32_16x16x32_bf16 v[236:239], v[124:127], v[104:107], v[236:239]
    v_exp_f32 v102, v102
    v_mfma_f32_16x16x32_bf16 a[120:123], v[128:131], v[104:107], a[120:123]
    buffer_load_dwordx4 v7, s[4:7], s49 offen offset:1024 nt lds
    v_exp_f32 v103, v103
    v_mfma_f32_16x16x32_bf16 a[148:151], v[132:135], v[104:107], a[148:151]
    v_add_f32 v18, v18, v100
    v_add_f32 v19, v19, v101
    v_mfma_f32_16x16x32_bf16 a[176:179], v[136:139], v[104:107], a[176:179]
    s_add_u32 m0, m0, s96
    v_cvt_pk_bf16_f32 v110, v100, v101
    v_add_f32 v18, v18, v102
    v_mfma_f32_16x16x32_bf16 a[204:207], v[140:143], v[104:107], a[204:207]
    v_add_f32 v19, v19, v103
    v_cvt_pk_bf16_f32 v111, v102, v103
    v_mfma_f32_16x16x32_bf16 v[96:99], v[56:59], a[80:83], v[48:51]
    v_mfma_f32_16x16x32_bf16 v[96:99], v[60:63], a[84:87], v[96:99]
    buffer_load_dwordx4 v7, s[4:7], s49 offen offset:1280 nt lds
    v_exp_f32 v88, v88
    v_mfma_f32_16x16x32_bf16 v[96:99], v[64:67], a[88:91], v[96:99]
    v_exp_f32 v89, v89
    v_mfma_f32_16x16x32_bf16 v[96:99], v[68:71], a[92:95], v[96:99]
    s_add_u32 m0, m0, s97
    v_exp_f32 v90, v90
    v_mfma_f32_16x16x32_bf16 v[100:103], v[72:75], a[80:83], v[48:51]
    v_exp_f32 v91, v91
    v_mfma_f32_16x16x32_bf16 v[100:103], v[76:79], a[84:87], v[100:103]
    buffer_load_dwordx4 v7, s[4:7], s49 offen offset:1536 nt lds
    v_add_f32 v20, v20, v88
    v_add_f32 v21, v21, v89
    v_mfma_f32_16x16x32_bf16 v[100:103], v[80:83], a[88:91], v[100:103]
    v_cvt_pk_bf16_f32 v104, v88, v89
    v_mfma_f32_16x16x32_bf16 v[100:103], v[84:87], a[92:95], v[100:103]
    v_exp_f32 v92, v92
    v_mfma_f32_16x16x32_bf16 v[156:159], v[112:115], v[108:111], v[156:159]
    s_add_u32 m0, m0, s96
    v_exp_f32 v93, v93
    v_mfma_f32_16x16x32_bf16 v[184:187], v[116:119], v[108:111], v[184:187]
    v_add_f32 v20, v20, v90
    v_add_f32 v21, v21, v91
    v_mfma_f32_16x16x32_bf16 v[212:215], v[120:123], v[108:111], v[212:215]
    buffer_load_dwordx4 v7, s[4:7], s49 offen offset:1792 nt lds
    v_cvt_pk_bf16_f32 v105, v90, v91
    v_mfma_f32_16x16x32_bf16 v[240:243], v[124:127], v[108:111], v[240:243]
    v_exp_f32 v94, v94
    v_mfma_f32_16x16x32_bf16 a[124:127], v[128:131], v[108:111], a[124:127]
    v_exp_f32 v95, v95
    v_mfma_f32_16x16x32_bf16 a[152:155], v[132:135], v[108:111], a[152:155]
    v_add_f32 v20, v20, v92
    v_add_f32 v21, v21, v93
    v_mfma_f32_16x16x32_bf16 a[180:183], v[136:139], v[108:111], a[180:183]
    v_cvt_pk_bf16_f32 v106, v92, v93
    v_add_f32 v20, v20, v94
    v_mfma_f32_16x16x32_bf16 a[208:211], v[140:143], v[108:111], a[208:211]
    v_add_f32 v21, v21, v95
    v_cvt_pk_bf16_f32 v107, v94, v95
    s_waitcnt vmcnt(16) lgkmcnt(0)
    s_barrier
    v_mfma_f32_16x16x32_bf16 v[88:91], v[56:59], a[96:99], v[52:55]
    ds_read_b128 v[56:59], v8 offset:25344
    v_mfma_f32_16x16x32_bf16 v[88:91], v[60:63], a[100:103], v[88:91]
    ds_read_b128 v[60:63], v8 offset:25408
    v_exp_f32 v96, v96
    v_mfma_f32_16x16x32_bf16 v[88:91], v[64:67], a[104:107], v[88:91]
    ds_read_b128 v[64:67], v8 offset:25472
    v_exp_f32 v97, v97
    v_mfma_f32_16x16x32_bf16 v[88:91], v[68:71], a[108:111], v[88:91]
    ds_read_b128 v[68:71], v8 offset:25536
    v_exp_f32 v98, v98
    v_mfma_f32_16x16x32_bf16 v[92:95], v[72:75], a[96:99], v[52:55]
    ds_read_b128 v[72:75], v8 offset:25856
    v_exp_f32 v99, v99
    v_mfma_f32_16x16x32_bf16 v[92:95], v[76:79], a[100:103], v[92:95]
    ds_read_b128 v[76:79], v8 offset:25920
    v_add_f32 v22, v22, v96
    v_add_f32 v23, v23, v97
    v_mfma_f32_16x16x32_bf16 v[92:95], v[80:83], a[104:107], v[92:95]
    ds_read_b128 v[80:83], v8 offset:25984
    v_cvt_pk_bf16_f32 v108, v96, v97
    v_mfma_f32_16x16x32_bf16 v[92:95], v[84:87], a[108:111], v[92:95]
    ds_read_b128 v[84:87], v8 offset:26048
    v_exp_f32 v100, v100
    v_mfma_f32_16x16x32_bf16 v[160:163], v[112:115], v[104:107], v[160:163]
    v_exp_f32 v101, v101
    v_mfma_f32_16x16x32_bf16 v[188:191], v[116:119], v[104:107], v[188:191]
    v_add_f32 v22, v22, v98
    v_add_f32 v23, v23, v99
    v_mfma_f32_16x16x32_bf16 v[216:219], v[120:123], v[104:107], v[216:219]
    v_cvt_pk_bf16_f32 v109, v98, v99
    v_mfma_f32_16x16x32_bf16 v[244:247], v[124:127], v[104:107], v[244:247]
    v_exp_f32 v102, v102
    v_mfma_f32_16x16x32_bf16 a[128:131], v[128:131], v[104:107], a[128:131]
    v_exp_f32 v103, v103
    v_mfma_f32_16x16x32_bf16 a[156:159], v[132:135], v[104:107], a[156:159]
    v_add_f32 v22, v22, v100
    v_add_f32 v23, v23, v101
    v_mfma_f32_16x16x32_bf16 a[184:187], v[136:139], v[104:107], a[184:187]
    v_cvt_pk_bf16_f32 v110, v100, v101
    v_add_f32 v22, v22, v102
    v_mfma_f32_16x16x32_bf16 a[212:215], v[140:143], v[104:107], a[212:215]
    v_add_f32 v23, v23, v103
    v_cvt_pk_bf16_f32 v111, v102, v103
    s_waitcnt lgkmcnt(0)
    v_mfma_f32_16x16x32_bf16 v[96:99], v[56:59], a[0:3], v[28:31]
    v_mfma_f32_16x16x32_bf16 v[96:99], v[60:63], a[4:7], v[96:99]
    v_exp_f32 v88, v88
    v_mfma_f32_16x16x32_bf16 v[96:99], v[64:67], a[8:11], v[96:99]
    v_exp_f32 v89, v89
    v_mfma_f32_16x16x32_bf16 v[96:99], v[68:71], a[12:15], v[96:99]
    v_exp_f32 v90, v90
    v_mfma_f32_16x16x32_bf16 v[100:103], v[72:75], a[0:3], v[28:31]
    v_exp_f32 v91, v91
    v_mfma_f32_16x16x32_bf16 v[100:103], v[76:79], a[4:7], v[100:103]
    v_add_f32 v24, v24, v88
    v_add_f32 v25, v25, v89
    v_mfma_f32_16x16x32_bf16 v[100:103], v[80:83], a[8:11], v[100:103]
    v_cvt_pk_bf16_f32 v104, v88, v89
    v_mfma_f32_16x16x32_bf16 v[100:103], v[84:87], a[12:15], v[100:103]
    v_exp_f32 v92, v92
    v_mfma_f32_16x16x32_bf16 v[164:167], v[112:115], v[108:111], v[164:167]
    v_exp_f32 v93, v93
    v_mfma_f32_16x16x32_bf16 v[192:195], v[116:119], v[108:111], v[192:195]
    v_add_f32 v24, v24, v90
    v_add_f32 v25, v25, v91
    v_mfma_f32_16x16x32_bf16 v[220:223], v[120:123], v[108:111], v[220:223]
    v_cvt_pk_bf16_f32 v105, v90, v91
    v_mfma_f32_16x16x32_bf16 v[248:251], v[124:127], v[108:111], v[248:251]
    v_exp_f32 v94, v94
    v_mfma_f32_16x16x32_bf16 a[132:135], v[128:131], v[108:111], a[132:135]
    v_exp_f32 v95, v95
    v_mfma_f32_16x16x32_bf16 a[160:163], v[132:135], v[108:111], a[160:163]
    v_add_f32 v24, v24, v92
    v_add_f32 v25, v25, v93
    v_mfma_f32_16x16x32_bf16 a[188:191], v[136:139], v[108:111], a[188:191]
    v_cvt_pk_bf16_f32 v106, v92, v93
    v_add_f32 v24, v24, v94
    v_mfma_f32_16x16x32_bf16 a[216:219], v[140:143], v[108:111], a[216:219]
    v_add_f32 v25, v25, v95
    v_cvt_pk_bf16_f32 v107, v94, v95
    v_mfma_f32_16x16x32_bf16 v[88:91], v[56:59], a[16:19], v[32:35]
    v_mfma_f32_16x16x32_bf16 v[88:91], v[60:63], a[20:23], v[88:91]
    v_exp_f32 v96, v96
    v_mfma_f32_16x16x32_bf16 v[88:91], v[64:67], a[24:27], v[88:91]
    v_exp_f32 v97, v97
    v_mfma_f32_16x16x32_bf16 v[88:91], v[68:71], a[28:31], v[88:91]
    v_exp_f32 v98, v98
    v_mfma_f32_16x16x32_bf16 v[92:95], v[72:75], a[16:19], v[32:35]
    v_exp_f32 v99, v99
    v_mfma_f32_16x16x32_bf16 v[92:95], v[76:79], a[20:23], v[92:95]
    v_add_f32 v12, v12, v96
    v_add_f32 v13, v13, v97
    v_mfma_f32_16x16x32_bf16 v[92:95], v[80:83], a[24:27], v[92:95]
    v_cvt_pk_bf16_f32 v108, v96, v97
    v_mfma_f32_16x16x32_bf16 v[92:95], v[84:87], a[28:31], v[92:95]
    v_exp_f32 v100, v100
    v_mfma_f32_16x16x32_bf16 v[168:171], v[112:115], v[104:107], v[168:171]
    ds_read_b64_tr_b16 v[112:113], v9 offset:25344
    ds_read_b64_tr_b16 v[114:115], v9 offset:25856
    v_exp_f32 v101, v101
    v_mfma_f32_16x16x32_bf16 v[196:199], v[116:119], v[104:107], v[196:199]
    ds_read_b64_tr_b16 v[116:117], v9 offset:25376
    ds_read_b64_tr_b16 v[118:119], v9 offset:25888
    v_add_f32 v12, v12, v98
    v_add_f32 v13, v13, v99
    v_mfma_f32_16x16x32_bf16 v[224:227], v[120:123], v[104:107], v[224:227]
    ds_read_b64_tr_b16 v[120:121], v9 offset:25408
    ds_read_b64_tr_b16 v[122:123], v9 offset:25920
    v_cvt_pk_bf16_f32 v109, v98, v99
    v_mfma_f32_16x16x32_bf16 v[252:255], v[124:127], v[104:107], v[252:255]
    ds_read_b64_tr_b16 v[124:125], v9 offset:25440
    ds_read_b64_tr_b16 v[126:127], v9 offset:25952
    v_exp_f32 v102, v102
    v_mfma_f32_16x16x32_bf16 a[136:139], v[128:131], v[104:107], a[136:139]
    ds_read_b64_tr_b16 v[128:129], v9 offset:25472
    ds_read_b64_tr_b16 v[130:131], v9 offset:25984
    v_exp_f32 v103, v103
    v_mfma_f32_16x16x32_bf16 a[164:167], v[132:135], v[104:107], a[164:167]
    ds_read_b64_tr_b16 v[132:133], v9 offset:25504
    ds_read_b64_tr_b16 v[134:135], v9 offset:26016
    v_add_f32 v12, v12, v100
    v_add_f32 v13, v13, v101
    v_mfma_f32_16x16x32_bf16 a[192:195], v[136:139], v[104:107], a[192:195]
    ds_read_b64_tr_b16 v[136:137], v9 offset:25536
    ds_read_b64_tr_b16 v[138:139], v9 offset:26048
    v_cvt_pk_bf16_f32 v110, v100, v101
    v_add_f32 v12, v12, v102
    v_mfma_f32_16x16x32_bf16 a[220:223], v[140:143], v[104:107], a[220:223]
    ds_read_b64_tr_b16 v[140:141], v9 offset:25568
    ds_read_b64_tr_b16 v[142:143], v9 offset:26080
    v_add_f32 v13, v13, v103
    v_cvt_pk_bf16_f32 v111, v102, v103
    v_mfma_f32_16x16x32_bf16 v[96:99], v[56:59], a[32:35], v[36:39]
    v_mfma_f32_16x16x32_bf16 v[96:99], v[60:63], a[36:39], v[96:99]
    s_add_u32 s29, s34, s100
    v_exp_f32 v88, v88
    v_mfma_f32_16x16x32_bf16 v[96:99], v[64:67], a[40:43], v[96:99]
    v_exp_f32 v89, v89
    v_mfma_f32_16x16x32_bf16 v[96:99], v[68:71], a[44:47], v[96:99]
    s_bfe_u32 s28, s29, 0x20003
    v_exp_f32 v90, v90
    v_mfma_f32_16x16x32_bf16 v[100:103], v[72:75], a[32:35], v[36:39]
    v_exp_f32 v91, v91
    v_mfma_f32_16x16x32_bf16 v[100:103], v[76:79], a[36:39], v[100:103]
    s_lshl_b32 s28, s28, 16
    v_add_f32 v14, v14, v88
    v_add_f32 v15, v15, v89
    v_mfma_f32_16x16x32_bf16 v[100:103], v[80:83], a[40:43], v[100:103]
    v_cvt_pk_bf16_f32 v104, v88, v89
    v_mfma_f32_16x16x32_bf16 v[100:103], v[84:87], a[44:47], v[100:103]
    v_exp_f32 v92, v92
    s_waitcnt lgkmcnt(0)
    v_mfma_f32_16x16x32_bf16 v[144:147], v[112:115], v[108:111], v[144:147]
    s_and_b32 s29, s29, 7
    v_exp_f32 v93, v93
    v_mfma_f32_16x16x32_bf16 v[172:175], v[116:119], v[108:111], v[172:175]
    v_add_f32 v14, v14, v90
    v_add_f32 v15, v15, v91
    v_mfma_f32_16x16x32_bf16 v[200:203], v[120:123], v[108:111], v[200:203]
    s_lshl_b32 s29, s29, 11
    v_cvt_pk_bf16_f32 v105, v90, v91
    v_mfma_f32_16x16x32_bf16 v[228:231], v[124:127], v[108:111], v[228:231]
    v_exp_f32 v94, v94
    v_mfma_f32_16x16x32_bf16 a[112:115], v[128:131], v[108:111], a[112:115]
    s_add_u32 s29, s28, s29
    v_exp_f32 v95, v95
    v_mfma_f32_16x16x32_bf16 a[140:143], v[132:135], v[108:111], a[140:143]
    v_add_f32 v14, v14, v92
    v_add_f32 v15, v15, v93
    v_mfma_f32_16x16x32_bf16 a[168:171], v[136:139], v[108:111], a[168:171]
    s_lshr_b32 s28, s34, 5
    v_cvt_pk_bf16_f32 v106, v92, v93
    v_add_f32 v14, v14, v94
    v_mfma_f32_16x16x32_bf16 a[196:199], v[140:143], v[108:111], a[196:199]
    v_add_f32 v15, v15, v95
    v_cvt_pk_bf16_f32 v107, v94, v95
    v_mfma_f32_16x16x32_bf16 v[88:91], v[56:59], a[48:51], v[40:43]
    v_mfma_f32_16x16x32_bf16 v[88:91], v[60:63], a[52:55], v[88:91]
    s_lshl_b32 s28, s28, 19
    v_exp_f32 v96, v96
    v_mfma_f32_16x16x32_bf16 v[88:91], v[64:67], a[56:59], v[88:91]
    v_exp_f32 v97, v97
    v_mfma_f32_16x16x32_bf16 v[88:91], v[68:71], a[60:63], v[88:91]
    s_add_u32 s49, s28, s29
    v_exp_f32 v98, v98
    v_mfma_f32_16x16x32_bf16 v[92:95], v[72:75], a[48:51], v[40:43]
    v_exp_f32 v99, v99
    v_mfma_f32_16x16x32_bf16 v[92:95], v[76:79], a[52:55], v[92:95]
    s_add_u32 m0, s33, 16896
    v_add_f32 v16, v16, v96
    v_add_f32 v17, v17, v97
    v_mfma_f32_16x16x32_bf16 v[92:95], v[80:83], a[56:59], v[92:95]
    v_cvt_pk_bf16_f32 v108, v96, v97
    v_mfma_f32_16x16x32_bf16 v[92:95], v[84:87], a[60:63], v[92:95]
    v_exp_f32 v100, v100
    v_mfma_f32_16x16x32_bf16 v[148:151], v[112:115], v[104:107], v[148:151]
    s_add_u32 s34, s34, 1
    v_exp_f32 v101, v101
    v_mfma_f32_16x16x32_bf16 v[176:179], v[116:119], v[104:107], v[176:179]
    v_add_f32 v16, v16, v98
    v_add_f32 v17, v17, v99
    v_mfma_f32_16x16x32_bf16 v[204:207], v[120:123], v[104:107], v[204:207]
    buffer_load_dwordx4 v7, s[4:7], s49 offen offset:0 nt lds
    v_cvt_pk_bf16_f32 v109, v98, v99
    v_mfma_f32_16x16x32_bf16 v[232:235], v[124:127], v[104:107], v[232:235]
    v_exp_f32 v102, v102
    v_mfma_f32_16x16x32_bf16 a[116:119], v[128:131], v[104:107], a[116:119]
    s_add_u32 m0, m0, s96
    v_exp_f32 v103, v103
    v_mfma_f32_16x16x32_bf16 a[144:147], v[132:135], v[104:107], a[144:147]
    v_add_f32 v16, v16, v100
    v_add_f32 v17, v17, v101
    v_mfma_f32_16x16x32_bf16 a[172:175], v[136:139], v[104:107], a[172:175]
    buffer_load_dwordx4 v7, s[4:7], s49 offen offset:256 nt lds
    v_cvt_pk_bf16_f32 v110, v100, v101
    v_add_f32 v16, v16, v102
    v_mfma_f32_16x16x32_bf16 a[200:203], v[140:143], v[104:107], a[200:203]
    v_add_f32 v17, v17, v103
    v_cvt_pk_bf16_f32 v111, v102, v103
    v_mfma_f32_16x16x32_bf16 v[96:99], v[56:59], a[64:67], v[44:47]
    v_mfma_f32_16x16x32_bf16 v[96:99], v[60:63], a[68:71], v[96:99]
    s_add_u32 m0, m0, s97
    v_exp_f32 v88, v88
    v_mfma_f32_16x16x32_bf16 v[96:99], v[64:67], a[72:75], v[96:99]
    v_exp_f32 v89, v89
    v_mfma_f32_16x16x32_bf16 v[96:99], v[68:71], a[76:79], v[96:99]
    buffer_load_dwordx4 v7, s[4:7], s49 offen offset:512 nt lds
    v_exp_f32 v90, v90
    v_mfma_f32_16x16x32_bf16 v[100:103], v[72:75], a[64:67], v[44:47]
    v_exp_f32 v91, v91
    v_mfma_f32_16x16x32_bf16 v[100:103], v[76:79], a[68:71], v[100:103]
    s_add_u32 m0, m0, s96
    v_add_f32 v18, v18, v88
    v_add_f32 v19, v19, v89
    v_mfma_f32_16x16x32_bf16 v[100:103], v[80:83], a[72:75], v[100:103]
    v_cvt_pk_bf16_f32 v104, v88, v89
    v_mfma_f32_16x16x32_bf16 v[100:103], v[84:87], a[76:79], v[100:103]
    v_exp_f32 v92, v92
    v_mfma_f32_16x16x32_bf16 v[152:155], v[112:115], v[108:111], v[152:155]
    buffer_load_dwordx4 v7, s[4:7], s49 offen offset:768 nt lds
    v_exp_f32 v93, v93
    v_mfma_f32_16x16x32_bf16 v[180:183], v[116:119], v[108:111], v[180:183]
    v_add_f32 v18, v18, v90
    v_add_f32 v19, v19, v91
    v_mfma_f32_16x16x32_bf16 v[208:211], v[120:123], v[108:111], v[208:211]
    s_add_u32 m0, m0, s97
    v_cvt_pk_bf16_f32 v105, v90, v91
    v_mfma_f32_16x16x32_bf16 v[236:239], v[124:127], v[108:111], v[236:239]
    v_exp_f32 v94, v94
    v_mfma_f32_16x16x32_bf16 a[120:123], v[128:131], v[108:111], a[120:123]
    buffer_load_dwordx4 v7, s[4:7], s49 offen offset:1024 nt lds
    v_exp_f32 v95, v95
    v_mfma_f32_16x16x32_bf16 a[148:151], v[132:135], v[108:111], a[148:151]
    v_add_f32 v18, v18, v92
    v_add_f32 v19, v19, v93
    v_mfma_f32_16x16x32_bf16 a[176:179], v[136:139], v[108:111], a[176:179]
    s_add_u32 m0, m0, s96
    v_cvt_pk_bf16_f32 v106, v92, v93
    v_add_f32 v18, v18, v94
    v_mfma_f32_16x16x32_bf16 a[204:207], v[140:143], v[108:111], a[204:207]
    v_add_f32 v19, v19, v95
    v_cvt_pk_bf16_f32 v107, v94, v95
    v_mfma_f32_16x16x32_bf16 v[88:91], v[56:59], a[80:83], v[48:51]
    v_mfma_f32_16x16x32_bf16 v[88:91], v[60:63], a[84:87], v[88:91]
    buffer_load_dwordx4 v7, s[4:7], s49 offen offset:1280 nt lds
    v_exp_f32 v96, v96
    v_mfma_f32_16x16x32_bf16 v[88:91], v[64:67], a[88:91], v[88:91]
    v_exp_f32 v97, v97
    v_mfma_f32_16x16x32_bf16 v[88:91], v[68:71], a[92:95], v[88:91]
    s_add_u32 m0, m0, s97
    v_exp_f32 v98, v98
    v_mfma_f32_16x16x32_bf16 v[92:95], v[72:75], a[80:83], v[48:51]
    v_exp_f32 v99, v99
    v_mfma_f32_16x16x32_bf16 v[92:95], v[76:79], a[84:87], v[92:95]
    buffer_load_dwordx4 v7, s[4:7], s49 offen offset:1536 nt lds
    v_add_f32 v20, v20, v96
    v_add_f32 v21, v21, v97
    v_mfma_f32_16x16x32_bf16 v[92:95], v[80:83], a[88:91], v[92:95]
    v_cvt_pk_bf16_f32 v108, v96, v97
    v_mfma_f32_16x16x32_bf16 v[92:95], v[84:87], a[92:95], v[92:95]
    v_exp_f32 v100, v100
    v_mfma_f32_16x16x32_bf16 v[156:159], v[112:115], v[104:107], v[156:159]
    s_add_u32 m0, m0, s96
    v_exp_f32 v101, v101
    v_mfma_f32_16x16x32_bf16 v[184:187], v[116:119], v[104:107], v[184:187]
    v_add_f32 v20, v20, v98
    v_add_f32 v21, v21, v99
    v_mfma_f32_16x16x32_bf16 v[212:215], v[120:123], v[104:107], v[212:215]
    buffer_load_dwordx4 v7, s[4:7], s49 offen offset:1792 nt lds
    v_cvt_pk_bf16_f32 v109, v98, v99
    v_mfma_f32_16x16x32_bf16 v[240:243], v[124:127], v[104:107], v[240:243]
    v_exp_f32 v102, v102
    v_mfma_f32_16x16x32_bf16 a[124:127], v[128:131], v[104:107], a[124:127]
    v_exp_f32 v103, v103
    v_mfma_f32_16x16x32_bf16 a[152:155], v[132:135], v[104:107], a[152:155]
    v_add_f32 v20, v20, v100
    v_add_f32 v21, v21, v101
    v_mfma_f32_16x16x32_bf16 a[180:183], v[136:139], v[104:107], a[180:183]
    v_cvt_pk_bf16_f32 v110, v100, v101
    v_add_f32 v20, v20, v102
    v_mfma_f32_16x16x32_bf16 a[208:211], v[140:143], v[104:107], a[208:211]
    v_add_f32 v21, v21, v103
    v_cvt_pk_bf16_f32 v111, v102, v103
    s_waitcnt vmcnt(16) lgkmcnt(0)
    s_barrier
    v_mfma_f32_16x16x32_bf16 v[96:99], v[56:59], a[96:99], v[52:55]
    ds_read_b128 v[56:59], v8 offset:0
    s_add_u32 s29, s34, s100
    v_mfma_f32_16x16x32_bf16 v[96:99], v[60:63], a[100:103], v[96:99]
    ds_read_b128 v[60:63], v8 offset:64
    s_bfe_u32 s28, s29, 0x20003
    v_exp_f32 v88, v88
    v_mfma_f32_16x16x32_bf16 v[96:99], v[64:67], a[104:107], v[96:99]
    ds_read_b128 v[64:67], v8 offset:128
    s_lshl_b32 s28, s28, 16
    v_exp_f32 v89, v89
    v_mfma_f32_16x16x32_bf16 v[96:99], v[68:71], a[108:111], v[96:99]
    ds_read_b128 v[68:71], v8 offset:192
    s_and_b32 s29, s29, 7
    v_exp_f32 v90, v90
    v_mfma_f32_16x16x32_bf16 v[100:103], v[72:75], a[96:99], v[52:55]
    ds_read_b128 v[72:75], v8 offset:512
    s_lshl_b32 s29, s29, 11
    v_exp_f32 v91, v91
    v_mfma_f32_16x16x32_bf16 v[100:103], v[76:79], a[100:103], v[100:103]
    ds_read_b128 v[76:79], v8 offset:576
    s_add_u32 s29, s28, s29
    v_add_f32 v22, v22, v88
    v_add_f32 v23, v23, v89
    v_mfma_f32_16x16x32_bf16 v[100:103], v[80:83], a[104:107], v[100:103]
    ds_read_b128 v[80:83], v8 offset:640
    s_lshr_b32 s28, s34, 5
    v_cvt_pk_bf16_f32 v104, v88, v89
    v_mfma_f32_16x16x32_bf16 v[100:103], v[84:87], a[108:111], v[100:103]
    ds_read_b128 v[84:87], v8 offset:704
    s_lshl_b32 s28, s28, 19
    v_exp_f32 v92, v92
    v_mfma_f32_16x16x32_bf16 v[160:163], v[112:115], v[108:111], v[160:163]
    s_add_u32 s49, s28, s29
    s_add_u32 m0, s33, 25344
    v_exp_f32 v93, v93
    v_mfma_f32_16x16x32_bf16 v[188:191], v[116:119], v[108:111], v[188:191]
    s_add_u32 s34, s34, 1
    v_add_f32 v22, v22, v90
    v_add_f32 v23, v23, v91
    v_mfma_f32_16x16x32_bf16 v[216:219], v[120:123], v[108:111], v[216:219]
    s_nop 0
    v_cvt_pk_bf16_f32 v105, v90, v91
    v_mfma_f32_16x16x32_bf16 v[244:247], v[124:127], v[108:111], v[244:247]
    buffer_load_dwordx4 v7, s[4:7], s49 offen offset:0 nt lds
    v_exp_f32 v94, v94
    v_mfma_f32_16x16x32_bf16 a[128:131], v[128:131], v[108:111], a[128:131]
    s_add_u32 m0, m0, s96
    v_exp_f32 v95, v95
    v_mfma_f32_16x16x32_bf16 a[156:159], v[132:135], v[108:111], a[156:159]
    s_nop 0
    v_add_f32 v22, v22, v92
    v_add_f32 v23, v23, v93
    v_mfma_f32_16x16x32_bf16 a[184:187], v[136:139], v[108:111], a[184:187]
    buffer_load_dwordx4 v7, s[4:7], s49 offen offset:256 nt lds
    v_cvt_pk_bf16_f32 v106, v92, v93
    v_add_f32 v22, v22, v94
    v_mfma_f32_16x16x32_bf16 a[212:215], v[140:143], v[108:111], a[212:215]
    s_add_u32 m0, m0, s97
    v_add_f32 v23, v23, v95
    v_cvt_pk_bf16_f32 v107, v94, v95
    s_lshl_b32 s30, s2, 2
    s_add_u32 s30, s30, s20
    s_mul_i32 s30, s30, 28672
    v_lshlrev_b32 v4, 4, v1
    buffer_load_dwordx4 a[0:3], v4, s[12:15], s30 offen offset:0
    buffer_load_dwordx4 a[4:7], v4, s[12:15], s30 offen offset:1024
    buffer_load_dwordx4 a[8:11], v4, s[12:15], s30 offen offset:2048
    buffer_load_dwordx4 a[12:15], v4, s[12:15], s30 offen offset:3072
    s_add_u32 s30, s30, 4096
    buffer_load_dwordx4 a[16:19], v4, s[12:15], s30 offen offset:0
    buffer_load_dwordx4 a[20:23], v4, s[12:15], s30 offen offset:1024
    buffer_load_dwordx4 a[24:27], v4, s[12:15], s30 offen offset:2048
    buffer_load_dwordx4 a[28:31], v4, s[12:15], s30 offen offset:3072
    s_add_u32 s30, s30, 4096
    buffer_load_dwordx4 a[32:35], v4, s[12:15], s30 offen offset:0
    buffer_load_dwordx4 a[36:39], v4, s[12:15], s30 offen offset:1024
    buffer_load_dwordx4 a[40:43], v4, s[12:15], s30 offen offset:2048
    buffer_load_dwordx4 a[44:47], v4, s[12:15], s30 offen offset:3072
    s_add_u32 s30, s30, 4096
    buffer_load_dwordx4 a[48:51], v4, s[12:15], s30 offen offset:0
    buffer_load_dwordx4 a[52:55], v4, s[12:15], s30 offen offset:1024
    buffer_load_dwordx4 a[56:59], v4, s[12:15], s30 offen offset:2048
    buffer_load_dwordx4 a[60:63], v4, s[12:15], s30 offen offset:3072
    s_add_u32 s30, s30, 4096
    buffer_load_dwordx4 a[64:67], v4, s[12:15], s30 offen offset:0
    buffer_load_dwordx4 a[68:71], v4, s[12:15], s30 offen offset:1024
    buffer_load_dwordx4 a[72:75], v4, s[12:15], s30 offen offset:2048
    buffer_load_dwordx4 a[76:79], v4, s[12:15], s30 offen offset:3072
    s_add_u32 s30, s30, 4096
    buffer_load_dwordx4 a[80:83], v4, s[12:15], s30 offen offset:0
    buffer_load_dwordx4 a[84:87], v4, s[12:15], s30 offen offset:1024
    buffer_load_dwordx4 a[88:91], v4, s[12:15], s30 offen offset:2048
    buffer_load_dwordx4 a[92:95], v4, s[12:15], s30 offen offset:3072
    s_add_u32 s30, s30, 4096
    buffer_load_dwordx4 a[96:99], v4, s[12:15], s30 offen offset:0
    buffer_load_dwordx4 a[100:103], v4, s[12:15], s30 offen offset:1024
    buffer_load_dwordx4 a[104:107], v4, s[12:15], s30 offen offset:2048
    buffer_load_dwordx4 a[108:111], v4, s[12:15], s30 offen offset:3072
    s_nop 1
    v_mfma_f32_16x16x32_bf16 v[164:167], v[112:115], v[104:107], v[164:167]
    s_nop 0
    buffer_load_dwordx4 v7, s[4:7], s49 offen offset:512 nt lds
    v_exp_f32 v96, v96
    v_mfma_f32_16x16x32_bf16 v[192:195], v[116:119], v[104:107], v[192:195]
    s_add_u32 m0, m0, s96
    s_nop 0
    v_exp_f32 v97, v97
    v_exp_f32 v98, v98
    v_mfma_f32_16x16x32_bf16 v[220:223], v[120:123], v[104:107], v[220:223]
    buffer_load_dwordx4 v7, s[4:7], s49 offen offset:768 nt lds
    s_add_u32 m0, m0, s97
    v_exp_f32 v99, v99
    v_add_f32 v24, v24, v96
    v_add_f32 v25, v25, v97
    v_mfma_f32_16x16x32_bf16 v[248:251], v[124:127], v[104:107], v[248:251]
    s_nop 0
    buffer_load_dwordx4 v7, s[4:7], s49 offen offset:1024 nt lds
    v_cvt_pk_bf16_f32 v108, v96, v97
    v_exp_f32 v100, v100
    v_mfma_f32_16x16x32_bf16 a[132:135], v[128:131], v[104:107], a[132:135]
    s_add_u32 m0, m0, s96
    s_nop 0
    buffer_load_dwordx4 v7, s[4:7], s49 offen offset:1280 nt lds
    v_exp_f32 v101, v101
    v_add_f32 v24, v24, v98
    v_add_f32 v25, v25, v99
    v_mfma_f32_16x16x32_bf16 a[160:163], v[132:135], v[104:107], a[160:163]
    s_add_u32 m0, m0, s97
    s_nop 0
    v_cvt_pk_bf16_f32 v109, v98, v99
    v_exp_f32 v102, v102
    v_mfma_f32_16x16x32_bf16 a[188:191], v[136:139], v[104:107], a[188:191]
    buffer_load_dwordx4 v7, s[4:7], s49 offen offset:1536 nt lds
    s_add_u32 m0, m0, s96
    v_exp_f32 v103, v103
    v_add_f32 v24, v24, v100
    v_add_f32 v25, v25, v101
    v_mfma_f32_16x16x32_bf16 a[216:219], v[140:143], v[104:107], a[216:219]
    s_nop 0
    buffer_load_dwordx4 v7, s[4:7], s49 offen offset:1792 nt lds
    v_cvt_pk_bf16_f32 v110, v100, v101
    v_add_f32 v24, v24, v102
    v_add_f32 v25, v25, v103
    v_cvt_pk_bf16_f32 v111, v102, v103
L_at_aepi:
    s_nop 1
    s_waitcnt lgkmcnt(0)
    v_mfma_f32_16x16x32_bf16 v[168:171], v[112:115], v[108:111], v[168:171]
    v_add_f32 v12, v12, v13
    v_add_f32 v14, v14, v15
    v_add_f32 v16, v16, v17
    v_add_f32 v18, v18, v19
    v_add_f32 v20, v20, v21
    v_add_f32 v22, v22, v23
    v_mfma_f32_16x16x32_bf16 v[196:199], v[116:119], v[108:111], v[196:199]
    v_add_f32 v24, v24, v25
    v_mov_b32 v88, v12
    v_mov_b32 v89, v14
    v_mov_b32 v90, v16
    v_mov_b32 v91, v18
    v_mov_b32 v92, v20
    v_mfma_f32_16x16x32_bf16 v[224:227], v[120:123], v[108:111], v[224:227]
    v_mov_b32 v93, v22
    v_mov_b32 v94, v24
    v_permlane16_swap_b32 v12, v88
    v_permlane16_swap_b32 v14, v89
    v_permlane16_swap_b32 v16, v90
    v_permlane16_swap_b32 v18, v91
    v_mfma_f32_16x16x32_bf16 v[252:255], v[124:127], v[108:111], v[252:255]
    v_permlane16_swap_b32 v20, v92
    v_permlane16_swap_b32 v22, v93
    v_permlane16_swap_b32 v24, v94
    v_add_f32 v12, v12, v88
    v_add_f32 v14, v14, v89
    v_add_f32 v16, v16, v90
    v_mfma_f32_16x16x32_bf16 a[136:139], v[128:131], v[108:111], a[136:139]
    v_add_f32 v18, v18, v91
    v_add_f32 v20, v20, v92
    v_add_f32 v22, v22, v93
    v_add_f32 v24, v24, v94
    v_mov_b32 v88, v12
    v_mov_b32 v89, v14
    v_mfma_f32_16x16x32_bf16 a[164:167], v[132:135], v[108:111], a[164:167]
    v_mov_b32 v90, v16
    v_mov_b32 v91, v18
    v_mov_b32 v92, v20
    v_mov_b32 v93, v22
    v_mov_b32 v94, v24
    v_permlane32_swap_b32 v12, v88
    v_mfma_f32_16x16x32_bf16 a[192:195], v[136:139], v[108:111], a[192:195]
    v_permlane32_swap_b32 v14, v89
    v_permlane32_swap_b32 v16, v90
    v_permlane32_swap_b32 v18, v91
    v_permlane32_swap_b32 v20, v92
    v_permlane32_swap_b32 v22, v93
    v_permlane32_swap_b32 v24, v94
    v_mfma_f32_16x16x32_bf16 a[220:223], v[140:143], v[108:111], a[220:223]
    v_add_f32 v12, v12, v88
    v_add_f32 v14, v14, v89
    v_add_f32 v16, v16, v90
    v_add_f32 v18, v18, v91
    v_add_f32 v20, v20, v92
    v_add_f32 v22, v22, v93
    v_add_f32 v24, v24, v94
    v_rcp_f32 v28, v12
    v_rcp_f32 v32, v14
    v_rcp_f32 v36, v16
    v_rcp_f32 v40, v18
    v_rcp_f32 v44, v20
    v_rcp_f32 v48, v22
    v_rcp_f32 v52, v24
    v_add_f32 v90, v12, v14
    v_add_f32 v91, v16, v18
    v_add_f32 v92, v20, v22
    v_add_f32 v90, v90, v24
    v_add_f32 v91, v91, v92
    v_add_f32 v90, v90, v91
    v_cmp_nge_f32 vcc, s32, v90
    v_mov_b32 v12, 0xff800000
    v_mov_b32 v14, 0xff800000
    v_mov_b32 v16, 0xff800000
    v_mov_b32 v18, 0xff800000
    v_mov_b32 v20, 0xff800000
    v_mov_b32 v22, 0xff800000
    v_mov_b32 v24, 0xff800000
    s_cmp_eq_u64 vcc, 0
    s_cbranch_scc1 L_at_noflag
    s_lshl_b32 s29, s21, 2
    s_add_u32 s29, s29, 75996
    v_mov_b32 v90, s29
    v_mov_b32 v91, 1
    ds_write_b32 v90, v91
L_at_noflag:
    s_mul_i32 s31, s21, 114688
    s_add_u32 s31, s31, s24
    s_sub_u32 s31, s31, 114688
    v_pk_mul_f32 v[144:145], v[144:145], v[28:29] op_sel_hi:[1,0]
    v_pk_mul_f32 v[146:147], v[146:147], v[28:29] op_sel_hi:[1,0]
    v_pk_mul_f32 v[148:149], v[148:149], v[32:33] op_sel_hi:[1,0]
    v_pk_mul_f32 v[150:151], v[150:151], v[32:33] op_sel_hi:[1,0]
    v_pk_mul_f32 v[152:153], v[152:153], v[36:37] op_sel_hi:[1,0]
    v_pk_mul_f32 v[154:155], v[154:155], v[36:37] op_sel_hi:[1,0]
    v_pk_mul_f32 v[156:157], v[156:157], v[40:41] op_sel_hi:[1,0]
    v_pk_mul_f32 v[158:159], v[158:159], v[40:41] op_sel_hi:[1,0]
    v_pk_mul_f32 v[160:161], v[160:161], v[44:45] op_sel_hi:[1,0]
    v_pk_mul_f32 v[162:163], v[162:163], v[44:45] op_sel_hi:[1,0]
    v_pk_mul_f32 v[164:165], v[164:165], v[48:49] op_sel_hi:[1,0]
    v_pk_mul_f32 v[166:167], v[166:167], v[48:49] op_sel_hi:[1,0]
    v_pk_mul_f32 v[168:169], v[168:169], v[52:53] op_sel_hi:[1,0]
    v_pk_mul_f32 v[170:171], v[170:171], v[52:53] op_sel_hi:[1,0]
    v_pk_mul_f32 v[172:173], v[172:173], v[28:29] op_sel_hi:[1,0]
    v_pk_mul_f32 v[174:175], v[174:175], v[28:29] op_sel_hi:[1,0]
    v_pk_mul_f32 v[176:177], v[176:177], v[32:33] op_sel_hi:[1,0]
    v_pk_mul_f32 v[178:179], v[178:179], v[32:33] op_sel_hi:[1,0]
    v_pk_mul_f32 v[180:181], v[180:181], v[36:37] op_sel_hi:[1,0]
    v_pk_mul_f32 v[182:183], v[182:183], v[36:37] op_sel_hi:[1,0]
    v_pk_mul_f32 v[184:185], v[184:185], v[40:41] op_sel_hi:[1,0]
    v_pk_mul_f32 v[186:187], v[186:187], v[40:41] op_sel_hi:[1,0]
    v_pk_mul_f32 v[188:189], v[188:189], v[44:45] op_sel_hi:[1,0]
    v_pk_mul_f32 v[190:191], v[190:191], v[44:45] op_sel_hi:[1,0]
    v_pk_mul_f32 v[192:193], v[192:193], v[48:49] op_sel_hi:[1,0]
    v_pk_mul_f32 v[194:195], v[194:195], v[48:49] op_sel_hi:[1,0]
    v_pk_mul_f32 v[196:197], v[196:197], v[52:53] op_sel_hi:[1,0]
    v_pk_mul_f32 v[198:199], v[198:199], v[52:53] op_sel_hi:[1,0]
    v_cvt_pk_bf16_f32 v88, v144, v145
    v_cvt_pk_bf16_f32 v89, v146, v147
    v_cvt_pk_bf16_f32 v90, v172, v173
    v_cvt_pk_bf16_f32 v91, v174, v175
    v_cvt_pk_bf16_f32 v92, v148, v149
    v_cvt_pk_bf16_f32 v93, v150, v151
    v_cvt_pk_bf16_f32 v94, v176, v177
    v_cvt_pk_bf16_f32 v95, v178, v179
    v_cvt_pk_bf16_f32 v96, v152, v153
    v_cvt_pk_bf16_f32 v97, v154, v155
    v_cvt_pk_bf16_f32 v98, v180, v181
    v_cvt_pk_bf16_f32 v99, v182, v183
    v_cvt_pk_bf16_f32 v100, v156, v157
    v_cvt_pk_bf16_f32 v101, v158, v159
    v_cvt_pk_bf16_f32 v102, v184, v185
    v_cvt_pk_bf16_f32 v103, v186, v187
    v_cvt_pk_bf16_f32 v104, v160, v161
    v_cvt_pk_bf16_f32 v105, v162, v163
    v_cvt_pk_bf16_f32 v106, v188, v189
    v_cvt_pk_bf16_f32 v107, v190, v191
    v_cvt_pk_bf16_f32 v108, v164, v165
    v_cvt_pk_bf16_f32 v109, v166, v167
    v_cvt_pk_bf16_f32 v110, v192, v193
    v_cvt_pk_bf16_f32 v111, v194, v195
    v_cvt_pk_bf16_f32 v112, v168, v169
    v_cvt_pk_bf16_f32 v113, v170, v171
    v_cvt_pk_bf16_f32 v114, v196, v197
    v_cvt_pk_bf16_f32 v115, v198, v199
    s_nop 1
    v_permlane16_swap_b32 v88, v90
    v_permlane16_swap_b32 v89, v91
    v_permlane16_swap_b32 v92, v94
    v_permlane16_swap_b32 v93, v95
    v_permlane16_swap_b32 v96, v98
    v_permlane16_swap_b32 v97, v99
    v_permlane16_swap_b32 v100, v102
    v_permlane16_swap_b32 v101, v103
    v_permlane16_swap_b32 v104, v106
    v_permlane16_swap_b32 v105, v107
    v_permlane16_swap_b32 v108, v110
    v_permlane16_swap_b32 v109, v111
    v_permlane16_swap_b32 v112, v114
    v_permlane16_swap_b32 v113, v115
    s_mov_b32 s28, s31
    buffer_store_dwordx4 v[88:91], v10, s[12:15], s28 offen offset:0
    s_add_u32 s28, s28, 4096
    buffer_store_dwordx4 v[92:95], v10, s[12:15], s28 offen offset:0
    s_add_u32 s28, s28, 4096
    buffer_store_dwordx4 v[96:99], v10, s[12:15], s28 offen offset:0
    s_add_u32 s28, s28, 4096
    buffer_store_dwordx4 v[100:103], v10, s[12:15], s28 offen offset:0
    s_add_u32 s28, s28, 4096
    buffer_store_dwordx4 v[104:107], v10, s[12:15], s28 offen offset:0
    s_add_u32 s28, s28, 4096
    buffer_store_dwordx4 v[108:111], v10, s[12:15], s28 offen offset:0
    s_add_u32 s28, s28, 4096
    buffer_store_dwordx4 v[112:115], v10, s[12:15], s28 offen offset:0
    v_pk_mul_f32 v[200:201], v[200:201], v[28:29] op_sel_hi:[1,0]
    v_pk_mul_f32 v[202:203], v[202:203], v[28:29] op_sel_hi:[1,0]
    v_pk_mul_f32 v[204:205], v[204:205], v[32:33] op_sel_hi:[1,0]
    v_pk_mul_f32 v[206:207], v[206:207], v[32:33] op_sel_hi:[1,0]
    v_pk_mul_f32 v[208:209], v[208:209], v[36:37] op_sel_hi:[1,0]
    v_pk_mul_f32 v[210:211], v[210:211], v[36:37] op_sel_hi:[1,0]
    v_pk_mul_f32 v[212:213], v[212:213], v[40:41] op_sel_hi:[1,0]
    v_pk_mul_f32 v[214:215], v[214:215], v[40:41] op_sel_hi:[1,0]
    v_pk_mul_f32 v[216:217], v[216:217], v[44:45] op_sel_hi:[1,0]
    v_pk_mul_f32 v[218:219], v[218:219], v[44:45] op_sel_hi:[1,0]
    v_pk_mul_f32 v[220:221], v[220:221], v[48:49] op_sel_hi:[1,0]
    v_pk_mul_f32 v[222:223], v[222:223], v[48:49] op_sel_hi:[1,0]
    v_pk_mul_f32 v[224:225], v[224:225], v[52:53] op_sel_hi:[1,0]
    v_pk_mul_f32 v[226:227], v[226:227], v[52:53] op_sel_hi:[1,0]
    v_pk_mul_f32 v[228:229], v[228:229], v[28:29] op_sel_hi:[1,0]
    v_pk_mul_f32 v[230:231], v[230:231], v[28:29] op_sel_hi:[1,0]
    v_pk_mul_f32 v[232:233], v[232:233], v[32:33] op_sel_hi:[1,0]
    v_pk_mul_f32 v[234:235], v[234:235], v[32:33] op_sel_hi:[1,0]
    v_pk_mul_f32 v[236:237], v[236:237], v[36:37] op_sel_hi:[1,0]
    v_pk_mul_f32 v[238:239], v[238:239], v[36:37] op_sel_hi:[1,0]
    v_pk_mul_f32 v[240:241], v[240:241], v[40:41] op_sel_hi:[1,0]
    v_pk_mul_f32 v[242:243], v[242:243], v[40:41] op_sel_hi:[1,0]
    v_pk_mul_f32 v[244:245], v[244:245], v[44:45] op_sel_hi:[1,0]
    v_pk_mul_f32 v[246:247], v[246:247], v[44:45] op_sel_hi:[1,0]
    v_pk_mul_f32 v[248:249], v[248:249], v[48:49] op_sel_hi:[1,0]
    v_pk_mul_f32 v[250:251], v[250:251], v[48:49] op_sel_hi:[1,0]
    v_pk_mul_f32 v[252:253], v[252:253], v[52:53] op_sel_hi:[1,0]
    v_pk_mul_f32 v[254:255], v[254:255], v[52:53] op_sel_hi:[1,0]
    v_cvt_pk_bf16_f32 v116, v200, v201
    v_cvt_pk_bf16_f32 v117, v202, v203
    v_cvt_pk_bf16_f32 v118, v228, v229
    v_cvt_pk_bf16_f32 v119, v230, v231
    v_cvt_pk_bf16_f32 v120, v204, v205
    v_cvt_pk_bf16_f32 v121, v206, v207
    v_cvt_pk_bf16_f32 v122, v232, v233
    v_cvt_pk_bf16_f32 v123, v234, v235
    v_cvt_pk_bf16_f32 v124, v208, v209
    v_cvt_pk_bf16_f32 v125, v210, v211
    v_cvt_pk_bf16_f32 v126, v236, v237
    v_cvt_pk_bf16_f32 v127, v238, v239
    v_cvt_pk_bf16_f32 v128, v212, v213
    v_cvt_pk_bf16_f32 v129, v214, v215
    v_cvt_pk_bf16_f32 v130, v240, v241
    v_cvt_pk_bf16_f32 v131, v242, v243
    v_cvt_pk_bf16_f32 v132, v216, v217
    v_cvt_pk_bf16_f32 v133, v218, v219
    v_cvt_pk_bf16_f32 v134, v244, v245
    v_cvt_pk_bf16_f32 v135, v246, v247
    v_cvt_pk_bf16_f32 v136, v220, v221
    v_cvt_pk_bf16_f32 v137, v222, v223
    v_cvt_pk_bf16_f32 v138, v248, v249
    v_cvt_pk_bf16_f32 v139, v250, v251
    v_cvt_pk_bf16_f32 v140, v224, v225
    v_cvt_pk_bf16_f32 v141, v226, v227
    v_cvt_pk_bf16_f32 v142, v252, v253
    v_cvt_pk_bf16_f32 v143, v254, v255
    s_nop 1
    v_permlane16_swap_b32 v116, v118
    v_permlane16_swap_b32 v117, v119
    v_permlane16_swap_b32 v120, v122
    v_permlane16_swap_b32 v121, v123
    v_permlane16_swap_b32 v124, v126
    v_permlane16_swap_b32 v125, v127
    v_permlane16_swap_b32 v128, v130
    v_permlane16_swap_b32 v129, v131
    v_permlane16_swap_b32 v132, v134
    v_permlane16_swap_b32 v133, v135
    v_permlane16_swap_b32 v136, v138
    v_permlane16_swap_b32 v137, v139
    v_permlane16_swap_b32 v140, v142
    v_permlane16_swap_b32 v141, v143
    s_mov_b32 s28, s31
    buffer_store_dwordx4 v[116:119], v10, s[12:15], s28 offen offset:1024
    s_add_u32 s28, s28, 4096
    buffer_store_dwordx4 v[120:123], v10, s[12:15], s28 offen offset:1024
    s_add_u32 s28, s28, 4096
    buffer_store_dwordx4 v[124:127], v10, s[12:15], s28 offen offset:1024
    s_add_u32 s28, s28, 4096
    buffer_store_dwordx4 v[128:131], v10, s[12:15], s28 offen offset:1024
    s_add_u32 s28, s28, 4096
    buffer_store_dwordx4 v[132:135], v10, s[12:15], s28 offen offset:1024
    s_add_u32 s28, s28, 4096
    buffer_store_dwordx4 v[136:139], v10, s[12:15], s28 offen offset:1024
    s_add_u32 s28, s28, 4096
    buffer_store_dwordx4 v[140:143], v10, s[12:15], s28 offen offset:1024
    v_accvgpr_read_b32 v144, a112
    v_accvgpr_read_b32 v145, a113
    v_accvgpr_read_b32 v146, a114
    v_accvgpr_read_b32 v147, a115
    v_accvgpr_read_b32 v148, a116
    v_accvgpr_read_b32 v149, a117
    v_accvgpr_read_b32 v150, a118
    v_accvgpr_read_b32 v151, a119
    v_accvgpr_read_b32 v152, a120
    v_accvgpr_read_b32 v153, a121
    v_accvgpr_read_b32 v154, a122
    v_accvgpr_read_b32 v155, a123
    v_accvgpr_read_b32 v156, a124
    v_accvgpr_read_b32 v157, a125
    v_accvgpr_read_b32 v158, a126
    v_accvgpr_read_b32 v159, a127
    v_accvgpr_read_b32 v160, a128
    v_accvgpr_read_b32 v161, a129
    v_accvgpr_read_b32 v162, a130
    v_accvgpr_read_b32 v163, a131
    v_accvgpr_read_b32 v164, a132
    v_accvgpr_read_b32 v165, a133
    v_accvgpr_read_b32 v166, a134
    v_accvgpr_read_b32 v167, a135
    v_accvgpr_read_b32 v168, a136
    v_accvgpr_read_b32 v169, a137
    v_accvgpr_read_b32 v170, a138
    v_accvgpr_read_b32 v171, a139
    v_accvgpr_read_b32 v172, a140
    v_accvgpr_read_b32 v173, a141
    v_accvgpr_read_b32 v174, a142
    v_accvgpr_read_b32 v175, a143
    v_accvgpr_read_b32 v176, a144
    v_accvgpr_read_b32 v177, a145
    v_accvgpr_read_b32 v178, a146
    v_accvgpr_read_b32 v179, a147
    v_accvgpr_read_b32 v180, a148
    v_accvgpr_read_b32 v181, a149
    v_accvgpr_read_b32 v182, a150
    v_accvgpr_read_b32 v183, a151
    v_accvgpr_read_b32 v184, a152
    v_accvgpr_read_b32 v185, a153
    v_accvgpr_read_b32 v186, a154
    v_accvgpr_read_b32 v187, a155
    v_accvgpr_read_b32 v188, a156
    v_accvgpr_read_b32 v189, a157
    v_accvgpr_read_b32 v190, a158
    v_accvgpr_read_b32 v191, a159
    v_accvgpr_read_b32 v192, a160
    v_accvgpr_read_b32 v193, a161
    v_accvgpr_read_b32 v194, a162
    v_accvgpr_read_b32 v195, a163
    v_accvgpr_read_b32 v196, a164
    v_accvgpr_read_b32 v197, a165
    v_accvgpr_read_b32 v198, a166
    v_accvgpr_read_b32 v199, a167
    v_pk_mul_f32 v[144:145], v[144:145], v[28:29] op_sel_hi:[1,0]
    v_pk_mul_f32 v[146:147], v[146:147], v[28:29] op_sel_hi:[1,0]
    v_pk_mul_f32 v[148:149], v[148:149], v[32:33] op_sel_hi:[1,0]
    v_pk_mul_f32 v[150:151], v[150:151], v[32:33] op_sel_hi:[1,0]
    v_pk_mul_f32 v[152:153], v[152:153], v[36:37] op_sel_hi:[1,0]
    v_pk_mul_f32 v[154:155], v[154:155], v[36:37] op_sel_hi:[1,0]
    v_pk_mul_f32 v[156:157], v[156:157], v[40:41] op_sel_hi:[1,0]
    v_pk_mul_f32 v[158:159], v[158:159], v[40:41] op_sel_hi:[1,0]
    v_pk_mul_f32 v[160:161], v[160:161], v[44:45] op_sel_hi:[1,0]
    v_pk_mul_f32 v[162:163], v[162:163], v[44:45] op_sel_hi:[1,0]
    v_pk_mul_f32 v[164:165], v[164:165], v[48:49] op_sel_hi:[1,0]
    v_pk_mul_f32 v[166:167], v[166:167], v[48:49] op_sel_hi:[1,0]
    v_pk_mul_f32 v[168:169], v[168:169], v[52:53] op_sel_hi:[1,0]
    v_pk_mul_f32 v[170:171], v[170:171], v[52:53] op_sel_hi:[1,0]
    v_pk_mul_f32 v[172:173], v[172:173], v[28:29] op_sel_hi:[1,0]
    v_pk_mul_f32 v[174:175], v[174:175], v[28:29] op_sel_hi:[1,0]
    v_pk_mul_f32 v[176:177], v[176:177], v[32:33] op_sel_hi:[1,0]
    v_pk_mul_f32 v[178:179], v[178:179], v[32:33] op_sel_hi:[1,0]
    v_pk_mul_f32 v[180:181], v[180:181], v[36:37] op_sel_hi:[1,0]
    v_pk_mul_f32 v[182:183], v[182:183], v[36:37] op_sel_hi:[1,0]
    v_pk_mul_f32 v[184:185], v[184:185], v[40:41] op_sel_hi:[1,0]
    v_pk_mul_f32 v[186:187], v[186:187], v[40:41] op_sel_hi:[1,0]
    v_pk_mul_f32 v[188:189], v[188:189], v[44:45] op_sel_hi:[1,0]
    v_pk_mul_f32 v[190:191], v[190:191], v[44:45] op_sel_hi:[1,0]
    v_pk_mul_f32 v[192:193], v[192:193], v[48:49] op_sel_hi:[1,0]
    v_pk_mul_f32 v[194:195], v[194:195], v[48:49] op_sel_hi:[1,0]
    v_pk_mul_f32 v[196:197], v[196:197], v[52:53] op_sel_hi:[1,0]
    v_pk_mul_f32 v[198:199], v[198:199], v[52:53] op_sel_hi:[1,0]
    v_cvt_pk_bf16_f32 v88, v144, v145
    v_cvt_pk_bf16_f32 v89, v146, v147
    v_cvt_pk_bf16_f32 v90, v172, v173
    v_cvt_pk_bf16_f32 v91, v174, v175
    v_cvt_pk_bf16_f32 v92, v148, v149
    v_cvt_pk_bf16_f32 v93, v150, v151
    v_cvt_pk_bf16_f32 v94, v176, v177
    v_cvt_pk_bf16_f32 v95, v178, v179
    v_cvt_pk_bf16_f32 v96, v152, v153
    v_cvt_pk_bf16_f32 v97, v154, v155
    v_cvt_pk_bf16_f32 v98, v180, v181
    v_cvt_pk_bf16_f32 v99, v182, v183
    v_cvt_pk_bf16_f32 v100, v156, v157
    v_cvt_pk_bf16_f32 v101, v158, v159
    v_cvt_pk_bf16_f32 v102, v184, v185
    v_cvt_pk_bf16_f32 v103, v186, v187
    v_cvt_pk_bf16_f32 v104, v160, v161
    v_cvt_pk_bf16_f32 v105, v162, v163
    v_cvt_pk_bf16_f32 v106, v188, v189
    v_cvt_pk_bf16_f32 v107, v190, v191
    v_cvt_pk_bf16_f32 v108, v164, v165
    v_cvt_pk_bf16_f32 v109, v166, v167
    v_cvt_pk_bf16_f32 v110, v192, v193
    v_cvt_pk_bf16_f32 v111, v194, v195
    v_cvt_pk_bf16_f32 v112, v168, v169
    v_cvt_pk_bf16_f32 v113, v170, v171
    v_cvt_pk_bf16_f32 v114, v196, v197
    v_cvt_pk_bf16_f32 v115, v198, v199
    s_nop 1
    v_permlane16_swap_b32 v88, v90
    v_permlane16_swap_b32 v89, v91
    v_permlane16_swap_b32 v92, v94
    v_permlane16_swap_b32 v93, v95
    v_permlane16_swap_b32 v96, v98
    v_permlane16_swap_b32 v97, v99
    v_permlane16_swap_b32 v100, v102
    v_permlane16_swap_b32 v101, v103
    v_permlane16_swap_b32 v104, v106
    v_permlane16_swap_b32 v105, v107
    v_permlane16_swap_b32 v108, v110
    v_permlane16_swap_b32 v109, v111
    v_permlane16_swap_b32 v112, v114
    v_permlane16_swap_b32 v113, v115
    s_mov_b32 s28, s31
    buffer_store_dwordx4 v[88:91], v10, s[12:15], s28 offen offset:2048
    s_add_u32 s28, s28, 4096
    buffer_store_dwordx4 v[92:95], v10, s[12:15], s28 offen offset:2048
    s_add_u32 s28, s28, 4096
    buffer_store_dwordx4 v[96:99], v10, s[12:15], s28 offen offset:2048
    s_add_u32 s28, s28, 4096
    buffer_store_dwordx4 v[100:103], v10, s[12:15], s28 offen offset:2048
    s_add_u32 s28, s28, 4096
    buffer_store_dwordx4 v[104:107], v10, s[12:15], s28 offen offset:2048
    s_add_u32 s28, s28, 4096
    buffer_store_dwordx4 v[108:111], v10, s[12:15], s28 offen offset:2048
    s_add_u32 s28, s28, 4096
    buffer_store_dwordx4 v[112:115], v10, s[12:15], s28 offen offset:2048
    v_accvgpr_read_b32 v200, a168
    v_accvgpr_read_b32 v201, a169
    v_accvgpr_read_b32 v202, a170
    v_accvgpr_read_b32 v203, a171
    v_accvgpr_read_b32 v204, a172
    v_accvgpr_read_b32 v205, a173
    v_accvgpr_read_b32 v206, a174
    v_accvgpr_read_b32 v207, a175
    v_accvgpr_read_b32 v208, a176
    v_accvgpr_read_b32 v209, a177
    v_accvgpr_read_b32 v210, a178
    v_accvgpr_read_b32 v211, a179
    v_accvgpr_read_b32 v212, a180
    v_accvgpr_read_b32 v213, a181
    v_accvgpr_read_b32 v214, a182
    v_accvgpr_read_b32 v215, a183
    v_accvgpr_read_b32 v216, a184
    v_accvgpr_read_b32 v217, a185
    v_accvgpr_read_b32 v218, a186
    v_accvgpr_read_b32 v219, a187
    v_accvgpr_read_b32 v220, a188
    v_accvgpr_read_b32 v221, a189
    v_accvgpr_read_b32 v222, a190
    v_accvgpr_read_b32 v223, a191
    v_accvgpr_read_b32 v224, a192
    v_accvgpr_read_b32 v225, a193
    v_accvgpr_read_b32 v226, a194
    v_accvgpr_read_b32 v227, a195
    v_accvgpr_read_b32 v228, a196
    v_accvgpr_read_b32 v229, a197
    v_accvgpr_read_b32 v230, a198
    v_accvgpr_read_b32 v231, a199
    v_accvgpr_read_b32 v232, a200
    v_accvgpr_read_b32 v233, a201
    v_accvgpr_read_b32 v234, a202
    v_accvgpr_read_b32 v235, a203
    v_accvgpr_read_b32 v236, a204
    v_accvgpr_read_b32 v237, a205
    v_accvgpr_read_b32 v238, a206
    v_accvgpr_read_b32 v239, a207
    v_accvgpr_read_b32 v240, a208
    v_accvgpr_read_b32 v241, a209
    v_accvgpr_read_b32 v242, a210
    v_accvgpr_read_b32 v243, a211
    v_accvgpr_read_b32 v244, a212
    v_accvgpr_read_b32 v245, a213
    v_accvgpr_read_b32 v246, a214
    v_accvgpr_read_b32 v247, a215
    v_accvgpr_read_b32 v248, a216
    v_accvgpr_read_b32 v249, a217
    v_accvgpr_read_b32 v250, a218
    v_accvgpr_read_b32 v251, a219
    v_accvgpr_read_b32 v252, a220
    v_accvgpr_read_b32 v253, a221
    v_accvgpr_read_b32 v254, a222
    v_accvgpr_read_b32 v255, a223
    v_pk_mul_f32 v[200:201], v[200:201], v[28:29] op_sel_hi:[1,0]
    v_pk_mul_f32 v[202:203], v[202:203], v[28:29] op_sel_hi:[1,0]
    v_pk_mul_f32 v[204:205], v[204:205], v[32:33] op_sel_hi:[1,0]
    v_pk_mul_f32 v[206:207], v[206:207], v[32:33] op_sel_hi:[1,0]
    v_pk_mul_f32 v[208:209], v[208:209], v[36:37] op_sel_hi:[1,0]
    v_pk_mul_f32 v[210:211], v[210:211], v[36:37] op_sel_hi:[1,0]
    v_pk_mul_f32 v[212:213], v[212:213], v[40:41] op_sel_hi:[1,0]
    v_pk_mul_f32 v[214:215], v[214:215], v[40:41] op_sel_hi:[1,0]
    v_pk_mul_f32 v[216:217], v[216:217], v[44:45] op_sel_hi:[1,0]
    v_pk_mul_f32 v[218:219], v[218:219], v[44:45] op_sel_hi:[1,0]
    v_pk_mul_f32 v[220:221], v[220:221], v[48:49] op_sel_hi:[1,0]
    v_pk_mul_f32 v[222:223], v[222:223], v[48:49] op_sel_hi:[1,0]
    v_pk_mul_f32 v[224:225], v[224:225], v[52:53] op_sel_hi:[1,0]
    v_pk_mul_f32 v[226:227], v[226:227], v[52:53] op_sel_hi:[1,0]
    v_pk_mul_f32 v[228:229], v[228:229], v[28:29] op_sel_hi:[1,0]
    v_pk_mul_f32 v[230:231], v[230:231], v[28:29] op_sel_hi:[1,0]
    v_pk_mul_f32 v[232:233], v[232:233], v[32:33] op_sel_hi:[1,0]
    v_pk_mul_f32 v[234:235], v[234:235], v[32:33] op_sel_hi:[1,0]
    v_pk_mul_f32 v[236:237], v[236:237], v[36:37] op_sel_hi:[1,0]
    v_pk_mul_f32 v[238:239], v[238:239], v[36:37] op_sel_hi:[1,0]
    v_pk_mul_f32 v[240:241], v[240:241], v[40:41] op_sel_hi:[1,0]
    v_pk_mul_f32 v[242:243], v[242:243], v[40:41] op_sel_hi:[1,0]
    v_pk_mul_f32 v[244:245], v[244:245], v[44:45] op_sel_hi:[1,0]
    v_pk_mul_f32 v[246:247], v[246:247], v[44:45] op_sel_hi:[1,0]
    v_pk_mul_f32 v[248:249], v[248:249], v[48:49] op_sel_hi:[1,0]
    v_pk_mul_f32 v[250:251], v[250:251], v[48:49] op_sel_hi:[1,0]
    v_pk_mul_f32 v[252:253], v[252:253], v[52:53] op_sel_hi:[1,0]
    v_pk_mul_f32 v[254:255], v[254:255], v[52:53] op_sel_hi:[1,0]
    v_cvt_pk_bf16_f32 v116, v200, v201
    v_cvt_pk_bf16_f32 v117, v202, v203
    v_cvt_pk_bf16_f32 v118, v228, v229
    v_cvt_pk_bf16_f32 v119, v230, v231
    v_cvt_pk_bf16_f32 v120, v204, v205
    v_cvt_pk_bf16_f32 v121, v206, v207
    v_cvt_pk_bf16_f32 v122, v232, v233
    v_cvt_pk_bf16_f32 v123, v234, v235
    v_cvt_pk_bf16_f32 v124, v208, v209
    v_cvt_pk_bf16_f32 v125, v210, v211
    v_cvt_pk_bf16_f32 v126, v236, v237
    v_cvt_pk_bf16_f32 v127, v238, v239
    v_cvt_pk_bf16_f32 v128, v212, v213
    v_cvt_pk_bf16_f32 v129, v214, v215
    v_cvt_pk_bf16_f32 v130, v240, v241
    v_cvt_pk_bf16_f32 v131, v242, v243
    v_cvt_pk_bf16_f32 v132, v216, v217
    v_cvt_pk_bf16_f32 v133, v218, v219
    v_cvt_pk_bf16_f32 v134, v244, v245
    v_cvt_pk_bf16_f32 v135, v246, v247
    v_cvt_pk_bf16_f32 v136, v220, v221
    v_cvt_pk_bf16_f32 v137, v222, v223
    v_cvt_pk_bf16_f32 v138, v248, v249
    v_cvt_pk_bf16_f32 v139, v250, v251
    v_cvt_pk_bf16_f32 v140, v224, v225
    v_cvt_pk_bf16_f32 v141, v226, v227
    v_cvt_pk_bf16_f32 v142, v252, v253
    v_cvt_pk_bf16_f32 v143, v254, v255
    s_nop 1
    v_permlane16_swap_b32 v116, v118
    v_permlane16_swap_b32 v117, v119
    v_permlane16_swap_b32 v120, v122
    v_permlane16_swap_b32 v121, v123
    v_permlane16_swap_b32 v124, v126
    v_permlane16_swap_b32 v125, v127
    v_permlane16_swap_b32 v128, v130
    v_permlane16_swap_b32 v129, v131
    v_permlane16_swap_b32 v132, v134
    v_permlane16_swap_b32 v133, v135
    v_permlane16_swap_b32 v136, v138
    v_permlane16_swap_b32 v137, v139
    v_permlane16_swap_b32 v140, v142
    v_permlane16_swap_b32 v141, v143
    s_mov_b32 s28, s31
    buffer_store_dwordx4 v[116:119], v10, s[12:15], s28 offen offset:3072
    s_add_u32 s28, s28, 4096
    buffer_store_dwordx4 v[120:123], v10, s[12:15], s28 offen offset:3072
    s_add_u32 s28, s28, 4096
    buffer_store_dwordx4 v[124:127], v10, s[12:15], s28 offen offset:3072
    s_add_u32 s28, s28, 4096
    buffer_store_dwordx4 v[128:131], v10, s[12:15], s28 offen offset:3072
    s_add_u32 s28, s28, 4096
    buffer_store_dwordx4 v[132:135], v10, s[12:15], s28 offen offset:3072
    s_add_u32 s28, s28, 4096
    buffer_store_dwordx4 v[136:139], v10, s[12:15], s28 offen offset:3072
    s_add_u32 s28, s28, 4096
    buffer_store_dwordx4 v[140:143], v10, s[12:15], s28 offen offset:3072
    s_nop 1
    s_cmp_lg_u32 s71, 2
    s_cbranch_scc1 L_at_nowo2
    s_mov_b32 s71, 3
    v_lshrrev_b32 v2, 4, v1
    v_bfe_u32 v3, v1, 2, 2
    v_lshl_add_u32 v3, v2, 3, v3
    v_mul_u32_u24 v3, 160, v3
    v_and_b32 v4, 3, v1
    v_lshl_add_u32 v3, v4, 3, v3
    s_mul_i32 s31, s20, 7168
    s_add_u32 s31, s31, 135168
    v_add_u32 v3, s31, v3
    v_lshlrev_b32 v4, 4, v1
    s_mul_i32 s28, s2, 40960
    s_mul_i32 s29, s20, 10240
    s_add_u32 s28, s28, s29
    s_add_u32 s28, s28, 117445632
    ds_read_b64_tr_b16 v[112:113], v3 offset:0
    ds_read_b64_tr_b16 v[114:115], v3 offset:640
    ds_read_b64_tr_b16 v[116:117], v3 offset:32
    ds_read_b64_tr_b16 v[118:119], v3 offset:672
    ds_read_b64_tr_b16 v[120:121], v3 offset:64
    ds_read_b64_tr_b16 v[122:123], v3 offset:704
    ds_read_b64_tr_b16 v[124:125], v3 offset:96
    ds_read_b64_tr_b16 v[126:127], v3 offset:736
    ds_read_b64_tr_b16 v[128:129], v3 offset:128
    ds_read_b64_tr_b16 v[130:131], v3 offset:768
    s_waitcnt lgkmcnt(0)
    buffer_store_dwordx4 v[112:115], v4, s[12:15], s28 offen offset:0
    buffer_store_dwordx4 v[116:119], v4, s[12:15], s28 offen offset:1024
    buffer_store_dwordx4 v[120:123], v4, s[12:15], s28 offen offset:2048
    buffer_store_dwordx4 v[124:127], v4, s[12:15], s28 offen offset:3072
    s_add_u32 s28, s28, 4096
    buffer_store_dwordx4 v[128:131], v4, s[12:15], s28 offen offset:0
    s_nop 1
L_at_nowo2:
    s_mov_b32 s68, 3
    s_cmp_ge_u32 s21, 2
    s_cbranch_scc1 L_at_fin
    s_cmp_eq_u32 s69, 0
    s_cbranch_scc1 L_at_round
    s_waitcnt vmcnt(28)
    s_branch L_at_pre
L_at_fin:
    s_waitcnt lgkmcnt(0)
    s_barrier
    s_cmp_le_u32 s21, s27
    s_cbranch_scc1 L_at_nofb_8455
    s_sub_u32 s28, s21, 1
    s_cmp_eq_u32 s28, s23
    s_cbranch_scc1 L_at_nofb_8455
    s_lshl_b32 s29, s28, 2
    s_add_u32 s29, s29, 76000
    v_mov_b32 v4, s29
    ds_read_b32 v4, v4
    s_waitcnt lgkmcnt(0)
    v_readfirstlane_b32 s29, v4
    s_nop 3
    s_cmp_lg_u32 s29, 0
    s_cbranch_scc1 L_at_fallback
L_at_nofb_8455:
    s_branch L_at_end
L_at_fallback:
    s_sub_u32 s27, s21, 1
    s_mov_b32 s23, s27
    s_mov_b32 s25, 1
    s_mov_b32 s69, 0
    s_mov_b32 s70, 0
    s_mov_b32 s68, 0
    v_mov_b32 v12, 0xff800000
    v_mov_b32 v14, 0xff800000
    v_mov_b32 v16, 0xff800000
    v_mov_b32 v18, 0xff800000
    v_mov_b32 v20, 0xff800000
    v_mov_b32 v22, 0xff800000
    v_mov_b32 v24, 0xff800000
    s_waitcnt vmcnt(0) lgkmcnt(0)
    s_barrier
    s_branch L_at_start
L_at_maxpass:
    s_mov_b32 s25, 0
    s_waitcnt lgkmcnt(0)
    v_and_b32 v2, 15, v1
    v_lshlrev_b32 v2, 8, v2
    v_bfe_u32 v3, v1, 4, 1
    v_lshl_add_u32 v2, v3, 5, v2
    v_bfe_u32 v3, v1, 5, 1
    v_lshl_add_u32 v4, v3, 4, v2
    v_add_u32 v5, 4096, v4
    s_lshl_b32 s29, s21, 19
    s_mov_b32 s22, 0
L_at_mp:
    buffer_load_dwordx4 v[112:115], v4, s[8:11], s29 offen offset:0
    buffer_load_dwordx4 v[116:119], v4, s[8:11], s29 offen offset:64
    buffer_load_dwordx4 v[120:123], v4, s[8:11], s29 offen offset:128
    buffer_load_dwordx4 v[124:127], v4, s[8:11], s29 offen offset:192
    buffer_load_dwordx4 v[128:131], v5, s[8:11], s29 offen offset:0
    buffer_load_dwordx4 v[132:135], v5, s[8:11], s29 offen offset:64
    buffer_load_dwordx4 v[136:139], v5, s[8:11], s29 offen offset:128
    buffer_load_dwordx4 v[140:143], v5, s[8:11], s29 offen offset:192
    s_waitcnt vmcnt(0)
    v_mfma_f32_16x16x32_bf16 v[88:91], v[112:115], a[0:3], 0
    v_mfma_f32_16x16x32_bf16 v[88:91], v[116:119], a[4:7], v[88:91]
    v_mfma_f32_16x16x32_bf16 v[88:91], v[120:123], a[8:11], v[88:91]
    v_mfma_f32_16x16x32_bf16 v[88:91], v[124:127], a[12:15], v[88:91]
    v_mfma_f32_16x16x32_bf16 v[92:95], v[128:131], a[0:3], 0
    v_mfma_f32_16x16x32_bf16 v[92:95], v[132:135], a[4:7], v[92:95]
    v_mfma_f32_16x16x32_bf16 v[92:95], v[136:139], a[8:11], v[92:95]
    v_mfma_f32_16x16x32_bf16 v[92:95], v[140:143], a[12:15], v[92:95]
    s_nop 9
    v_max3_f32 v12, v88, v89, v12
    v_max3_f32 v12, v90, v91, v12
    v_max3_f32 v12, v92, v93, v12
    v_max3_f32 v12, v94, v95, v12
    s_nop 3
    v_mfma_f32_16x16x32_bf16 v[88:91], v[112:115], a[16:19], 0
    v_mfma_f32_16x16x32_bf16 v[88:91], v[116:119], a[20:23], v[88:91]
    v_mfma_f32_16x16x32_bf16 v[88:91], v[120:123], a[24:27], v[88:91]
    v_mfma_f32_16x16x32_bf16 v[88:91], v[124:127], a[28:31], v[88:91]
    v_mfma_f32_16x16x32_bf16 v[92:95], v[128:131], a[16:19], 0
    v_mfma_f32_16x16x32_bf16 v[92:95], v[132:135], a[20:23], v[92:95]
    v_mfma_f32_16x16x32_bf16 v[92:95], v[136:139], a[24:27], v[92:95]
    v_mfma_f32_16x16x32_bf16 v[92:95], v[140:143], a[28:31], v[92:95]
    s_nop 9
    v_max3_f32 v14, v88, v89, v14
    v_max3_f32 v14, v90, v91, v14
    v_max3_f32 v14, v92, v93, v14
    v_max3_f32 v14, v94, v95, v14
    s_nop 3
    v_mfma_f32_16x16x32_bf16 v[88:91], v[112:115], a[32:35], 0
    v_mfma_f32_16x16x32_bf16 v[88:91], v[116:119], a[36:39], v[88:91]
    v_mfma_f32_16x16x32_bf16 v[88:91], v[120:123], a[40:43], v[88:91]
    v_mfma_f32_16x16x32_bf16 v[88:91], v[124:127], a[44:47], v[88:91]
    v_mfma_f32_16x16x32_bf16 v[92:95], v[128:131], a[32:35], 0
    v_mfma_f32_16x16x32_bf16 v[92:95], v[132:135], a[36:39], v[92:95]
    v_mfma_f32_16x16x32_bf16 v[92:95], v[136:139], a[40:43], v[92:95]
    v_mfma_f32_16x16x32_bf16 v[92:95], v[140:143], a[44:47], v[92:95]
    s_nop 9
    v_max3_f32 v16, v88, v89, v16
    v_max3_f32 v16, v90, v91, v16
    v_max3_f32 v16, v92, v93, v16
    v_max3_f32 v16, v94, v95, v16
    s_nop 3
    v_mfma_f32_16x16x32_bf16 v[88:91], v[112:115], a[48:51], 0
    v_mfma_f32_16x16x32_bf16 v[88:91], v[116:119], a[52:55], v[88:91]
    v_mfma_f32_16x16x32_bf16 v[88:91], v[120:123], a[56:59], v[88:91]
    v_mfma_f32_16x16x32_bf16 v[88:91], v[124:127], a[60:63], v[88:91]
    v_mfma_f32_16x16x32_bf16 v[92:95], v[128:131], a[48:51], 0
    v_mfma_f32_16x16x32_bf16 v[92:95], v[132:135], a[52:55], v[92:95]
    v_mfma_f32_16x16x32_bf16 v[92:95], v[136:139], a[56:59], v[92:95]
    v_mfma_f32_16x16x32_bf16 v[92:95], v[140:143], a[60:63], v[92:95]
    s_nop 9
    v_max3_f32 v18, v88, v89, v18
    v_max3_f32 v18, v90, v91, v18
    v_max3_f32 v18, v92, v93, v18
    v_max3_f32 v18, v94, v95, v18
    s_nop 3
    v_mfma_f32_16x16x32_bf16 v[88:91], v[112:115], a[64:67], 0
    v_mfma_f32_16x16x32_bf16 v[88:91], v[116:119], a[68:71], v[88:91]
    v_mfma_f32_16x16x32_bf16 v[88:91], v[120:123], a[72:75], v[88:91]
    v_mfma_f32_16x16x32_bf16 v[88:91], v[124:127], a[76:79], v[88:91]
    v_mfma_f32_16x16x32_bf16 v[92:95], v[128:131], a[64:67], 0
    v_mfma_f32_16x16x32_bf16 v[92:95], v[132:135], a[68:71], v[92:95]
    v_mfma_f32_16x16x32_bf16 v[92:95], v[136:139], a[72:75], v[92:95]
    v_mfma_f32_16x16x32_bf16 v[92:95], v[140:143], a[76:79], v[92:95]
    s_nop 9
    v_max3_f32 v20, v88, v89, v20
    v_max3_f32 v20, v90, v91, v20
    v_max3_f32 v20, v92, v93, v20
    v_max3_f32 v20, v94, v95, v20
    s_nop 3
    v_mfma_f32_16x16x32_bf16 v[88:91], v[112:115], a[80:83], 0
    v_mfma_f32_16x16x32_bf16 v[88:91], v[116:119], a[84:87], v[88:91]
    v_mfma_f32_16x16x32_bf16 v[88:91], v[120:123], a[88:91], v[88:91]
    v_mfma_f32_16x16x32_bf16 v[88:91], v[124:127], a[92:95], v[88:91]
    v_mfma_f32_16x16x32_bf16 v[92:95], v[128:131], a[80:83], 0
    v_mfma_f32_16x16x32_bf16 v[92:95], v[132:135], a[84:87], v[92:95]
    v_mfma_f32_16x16x32_bf16 v[92:95], v[136:139], a[88:91], v[92:95]
    v_mfma_f32_16x16x32_bf16 v[92:95], v[140:143], a[92:95], v[92:95]
    s_nop 9
    v_max3_f32 v22, v88, v89, v22
    v_max3_f32 v22, v90, v91, v22
    v_max3_f32 v22, v92, v93, v22
    v_max3_f32 v22, v94, v95, v22
    s_nop 3
    v_mfma_f32_16x16x32_bf16 v[88:91], v[112:115], a[96:99], 0
    v_mfma_f32_16x16x32_bf16 v[88:91], v[116:119], a[100:103], v[88:91]
    v_mfma_f32_16x16x32_bf16 v[88:91], v[120:123], a[104:107], v[88:91]
    v_mfma_f32_16x16x32_bf16 v[88:91], v[124:127], a[108:111], v[88:91]
    v_mfma_f32_16x16x32_bf16 v[92:95], v[128:131], a[96:99], 0
    v_mfma_f32_16x16x32_bf16 v[92:95], v[132:135], a[100:103], v[92:95]
    v_mfma_f32_16x16x32_bf16 v[92:95], v[136:139], a[104:107], v[92:95]
    v_mfma_f32_16x16x32_bf16 v[92:95], v[140:143], a[108:111], v[92:95]
    s_nop 9
    v_max3_f32 v24, v88, v89, v24
    v_max3_f32 v24, v90, v91, v24
    v_max3_f32 v24, v92, v93, v24
    v_max3_f32 v24, v94, v95, v24
    s_nop 3
    s_add_u32 s29, s29, 8192
    s_add_u32 s22, s22, 1
    s_cmp_lt_u32 s22, 32
    s_cbranch_scc1 L_at_mp
    s_branch L_at_pre
L_at_end:
    s_endpgm
.globl op_kernel
.p2align 8
.type op_kernel,@function
op_kernel:
    s_cmp_ge_u32 s2, 256
    s_cbranch_scc1 L_op_end
    s_load_dwordx2 s[36:37], s[0:1], 32
    s_load_dwordx2 s[38:39], s[0:1], 72
    s_load_dwordx2 s[40:41], s[0:1], 80
    s_load_dwordx2 s[44:45], s[0:1], 96
    v_and_b32 v1, 63, v0
    v_lshrrev_b32 v2, 6, v0
    s_nop 0
    v_readfirstlane_b32 s20, v2
    s_and_b32 s3, s2, 7
    s_lshl_b32 s3, s3, 3
    s_lshr_b32 s30, s2, 5
    s_add_u32 s3, s3, s30
    s_bfe_u32 s31, s2, 0x20003
    s_waitcnt lgkmcnt(0)
    s_cmp_ge_u32 s3, 32
    s_add_u32 s44, s44, 0
    s_addc_u32 s45, s45, 0
    s_mov_b32 s8, s44
    s_mov_b32 s9, s45
    s_mov_b32 s10, 127926272
    s_mov_b32 s11, 0x20000
    s_mov_b32 s4, s44
    s_mov_b32 s5, s45
    s_mov_b32 s6, 127926272
    s_mov_b32 s7, 0x20000
    s_mov_b32 s12, s40
    s_mov_b32 s13, s41
    s_mov_b32 s14, 9175040
    s_mov_b32 s15, 0x20000
    s_lshr_b32 s22, s3, 1
    s_mul_i32 s22, s22, 1835008
    s_and_b32 s23, s3, 1
    s_mul_i32 s23, s23, 28672
    s_add_u32 s22, s22, s23
    s_lshl_b32 s23, s20, 10
    s_add_u32 s22, s22, s23
    s_add_u32 s25, s22, 58720256
    s_lshr_b32 s22, s3, 5
    s_lshl_b32 s22, s22, 7
    s_add_u32 s22, s22, s20
    s_mul_i32 s22, s22, 40960
    s_mul_i32 s23, s31, 10240
    s_add_u32 s22, s22, s23
    s_add_u32 s26, s22, 117440512
    s_mul_i32 s27, s20, 40960
    v_lshlrev_b32 v6, 4, v1
    v_add_u32 v7, s27, v6
    v_bfe_u32 v4, v1, 4, 1
    v_lshlrev_b32 v4, 5, v4
    v_and_b32 v2, 15, v1
    v_mul_u32_u24 v2, 2560, v2
    v_add_u32 v2, v2, v4
    v_bfe_u32 v4, v1, 5, 1
    v_lshl_add_u32 v9, v4, 4, v2
    s_add_u32 m0, s27, 0
    s_mov_b32 s23, s26
    buffer_load_dwordx4 v6, s[8:11], s23 offen offset:0 lds
    buffer_load_dwordx4 v6, s[8:11], s23 offen offset:1024 lds
    buffer_load_dwordx4 v6, s[8:11], s23 offen offset:2048 lds
    buffer_load_dwordx4 v6, s[8:11], s23 offen offset:3072 lds
    s_add_u32 m0, s27, 4096
    s_add_u32 s23, s23, 4096
    buffer_load_dwordx4 v6, s[8:11], s23 offen offset:0 lds
    buffer_load_dwordx4 v6, s[8:11], s23 offen offset:1024 lds
    buffer_load_dwordx4 v6, s[8:11], s23 offen offset:2048 lds
    buffer_load_dwordx4 v6, s[8:11], s23 offen offset:3072 lds
    s_add_u32 m0, s27, 8192
    s_add_u32 s23, s23, 4096
    buffer_load_dwordx4 v6, s[8:11], s23 offen offset:0 lds
    buffer_load_dwordx4 v6, s[8:11], s23 offen offset:1024 lds
    s_add_u32 s26, s26, 163840
    s_mov_b32 s22, s25
    buffer_load_dwordx4 v[84:87], v6, s[4:7], s22 offen
    s_add_u32 s22, s22, 4096
    buffer_load_dwordx4 v[88:91], v6, s[4:7], s22 offen
    s_add_u32 s22, s22, 4096
    buffer_load_dwordx4 v[92:95], v6, s[4:7], s22 offen
    s_add_u32 s22, s22, 4096
    buffer_load_dwordx4 v[96:99], v6, s[4:7], s22 offen
    s_add_u32 s22, s22, 4096
    buffer_load_dwordx4 v[100:103], v6, s[4:7], s22 offen
    s_add_u32 s22, s22, 4096
    buffer_load_dwordx4 v[104:107], v6, s[4:7], s22 offen
    s_add_u32 s22, s22, 4096
    buffer_load_dwordx4 v[108:111], v6, s[4:7], s22 offen
    s_add_u32 s25, s25, 57344
    s_add_u32 m0, s27, 10240
    s_mov_b32 s23, s26
    buffer_load_dwordx4 v6, s[8:11], s23 offen offset:0 lds
    buffer_load_dwordx4 v6, s[8:11], s23 offen offset:1024 lds
    buffer_load_dwordx4 v6, s[8:11], s23 offen offset:2048 lds
    buffer_load_dwordx4 v6, s[8:11], s23 offen offset:3072 lds
    s_add_u32 m0, s27, 14336
    s_add_u32 s23, s23, 4096
    buffer_load_dwordx4 v6, s[8:11], s23 offen offset:0 lds
    buffer_load_dwordx4 v6, s[8:11], s23 offen offset:1024 lds
    buffer_load_dwordx4 v6, s[8:11], s23 offen offset:2048 lds
    buffer_load_dwordx4 v6, s[8:11], s23 offen offset:3072 lds
    s_add_u32 m0, s27, 18432
    s_add_u32 s23, s23, 4096
    buffer_load_dwordx4 v6, s[8:11], s23 offen offset:0 lds
    buffer_load_dwordx4 v6, s[8:11], s23 offen offset:1024 lds
    s_add_u32 s26, s26, 163840
    s_lshl_b32 s22, s20, 11
    v_add_u32 v2, s22, v6
    v_add_u32 v3, 40960, v2
    v_add_u32 v4, 81920, v2
    v_add_u32 v5, 122880, v2
    s_and_b32 s22, s3, 31
    s_mul_i32 s22, s22, 286720
    s_lshr_b32 s32, s3, 5
    s_mul_i32 s32, s32, 1280
    s_add_u32 s22, s22, s32
    s_mul_i32 s32, s31, 320
    s_add_u32 s24, s22, s32
    s_waitcnt vmcnt(17)
    ds_read_b128 v[44:47], v7 offset:0
    ds_read_b128 v[48:51], v7 offset:1024
    ds_read_b128 v[52:55], v7 offset:2048
    ds_read_b128 v[56:59], v7 offset:3072
    ds_read_b128 v[60:63], v7 offset:4096
    ds_read_b128 v[64:67], v7 offset:5120
    ds_read_b128 v[68:71], v7 offset:6144
    ds_read_b128 v[72:75], v7 offset:7168
    ds_read_b128 v[76:79], v7 offset:8192
    ds_read_b128 v[80:83], v7 offset:9216
    s_waitcnt vmcnt(0) lgkmcnt(7)
    v_mfma_f32_16x16x32_bf16 a[0:3], v[44:47], v[84:87], 0
    s_mov_b32 s22, s25
    v_mfma_f32_16x16x32_bf16 a[4:7], v[44:47], v[88:91], 0
    buffer_load_dwordx4 v[112:115], v6, s[4:7], s22 offen
    v_mfma_f32_16x16x32_bf16 a[8:11], v[44:47], v[92:95], 0
    s_add_u32 s22, s22, 4096
    v_mfma_f32_16x16x32_bf16 a[12:15], v[44:47], v[96:99], 0
    buffer_load_dwordx4 v[116:119], v6, s[4:7], s22 offen
    v_mfma_f32_16x16x32_bf16 a[16:19], v[44:47], v[100:103], 0
    s_add_u32 s22, s22, 4096
    v_mfma_f32_16x16x32_bf16 a[20:23], v[44:47], v[104:107], 0
    buffer_load_dwordx4 v[120:123], v6, s[4:7], s22 offen
    v_mfma_f32_16x16x32_bf16 a[24:27], v[44:47], v[108:111], 0
    ds_read_b128 v[44:47], v7 offset:10240
    v_mfma_f32_16x16x32_bf16 a[28:31], v[48:51], v[84:87], 0
    s_add_u32 s22, s22, 4096
    v_mfma_f32_16x16x32_bf16 a[32:35], v[48:51], v[88:91], 0
    buffer_load_dwordx4 v[124:127], v6, s[4:7], s22 offen
    v_mfma_f32_16x16x32_bf16 a[36:39], v[48:51], v[92:95], 0
    s_add_u32 s22, s22, 4096
    v_mfma_f32_16x16x32_bf16 a[40:43], v[48:51], v[96:99], 0
    buffer_load_dwordx4 v[128:131], v6, s[4:7], s22 offen
    v_mfma_f32_16x16x32_bf16 a[44:47], v[48:51], v[100:103], 0
    s_add_u32 s22, s22, 4096
    v_mfma_f32_16x16x32_bf16 a[48:51], v[48:51], v[104:107], 0
    buffer_load_dwordx4 v[132:135], v6, s[4:7], s22 offen
    v_mfma_f32_16x16x32_bf16 a[52:55], v[48:51], v[108:111], 0
    ds_read_b128 v[48:51], v7 offset:11264
    s_waitcnt lgkmcnt(2)
    v_mfma_f32_16x16x32_bf16 a[56:59], v[52:55], v[84:87], 0
    s_add_u32 s22, s22, 4096
    v_mfma_f32_16x16x32_bf16 a[60:63], v[52:55], v[88:91], 0
    buffer_load_dwordx4 v[136:139], v6, s[4:7], s22 offen
    v_mfma_f32_16x16x32_bf16 a[64:67], v[52:55], v[92:95], 0
    s_add_u32 s25, s25, 57344
    v_mfma_f32_16x16x32_bf16 a[68:71], v[52:55], v[96:99], 0
    s_add_u32 m0, s27, 20480
    v_mfma_f32_16x16x32_bf16 a[72:75], v[52:55], v[100:103], 0
    s_mov_b32 s23, s26
    v_mfma_f32_16x16x32_bf16 a[76:79], v[52:55], v[104:107], 0
    buffer_load_dwordx4 v6, s[8:11], s23 offen offset:0 lds
    v_mfma_f32_16x16x32_bf16 a[80:83], v[52:55], v[108:111], 0
    ds_read_b128 v[52:55], v7 offset:12288
    v_mfma_f32_16x16x32_bf16 a[84:87], v[56:59], v[84:87], 0
    buffer_load_dwordx4 v6, s[8:11], s23 offen offset:1024 lds
    v_mfma_f32_16x16x32_bf16 a[88:91], v[56:59], v[88:91], 0
    buffer_load_dwordx4 v6, s[8:11], s23 offen offset:2048 lds
    v_mfma_f32_16x16x32_bf16 a[92:95], v[56:59], v[92:95], 0
    buffer_load_dwordx4 v6, s[8:11], s23 offen offset:3072 lds
    v_mfma_f32_16x16x32_bf16 a[96:99], v[56:59], v[96:99], 0
    s_add_u32 m0, s27, 24576
    v_mfma_f32_16x16x32_bf16 a[100:103], v[56:59], v[100:103], 0
    s_add_u32 s23, s23, 4096
    v_mfma_f32_16x16x32_bf16 a[104:107], v[56:59], v[104:107], 0
    buffer_load_dwordx4 v6, s[8:11], s23 offen offset:0 lds
    v_mfma_f32_16x16x32_bf16 a[108:111], v[56:59], v[108:111], 0
    ds_read_b128 v[56:59], v7 offset:13312
    v_mfma_f32_16x16x32_bf16 a[112:115], v[60:63], v[84:87], 0
    buffer_load_dwordx4 v6, s[8:11], s23 offen offset:1024 lds
    v_mfma_f32_16x16x32_bf16 a[116:119], v[60:63], v[88:91], 0
    buffer_load_dwordx4 v6, s[8:11], s23 offen offset:2048 lds
    v_mfma_f32_16x16x32_bf16 a[120:123], v[60:63], v[92:95], 0
    buffer_load_dwordx4 v6, s[8:11], s23 offen offset:3072 lds
    v_mfma_f32_16x16x32_bf16 a[124:127], v[60:63], v[96:99], 0
    s_add_u32 m0, s27, 28672
    v_mfma_f32_16x16x32_bf16 a[128:131], v[60:63], v[100:103], 0
    s_add_u32 s23, s23, 4096
    v_mfma_f32_16x16x32_bf16 a[132:135], v[60:63], v[104:107], 0
    buffer_load_dwordx4 v6, s[8:11], s23 offen offset:0 lds
    v_mfma_f32_16x16x32_bf16 a[136:139], v[60:63], v[108:111], 0
    ds_read_b128 v[60:63], v7 offset:14336
    v_mfma_f32_16x16x32_bf16 a[140:143], v[64:67], v[84:87], 0
    buffer_load_dwordx4 v6, s[8:11], s23 offen offset:1024 lds
    v_mfma_f32_16x16x32_bf16 a[144:147], v[64:67], v[88:91], 0
    s_add_u32 s26, s26, 163840
    v_mfma_f32_16x16x32_bf16 a[148:151], v[64:67], v[92:95], 0
    s_mov_b32 s22, s25
    v_mfma_f32_16x16x32_bf16 a[152:155], v[64:67], v[96:99], 0
    buffer_load_dwordx4 v[140:143], v6, s[4:7], s22 offen
    v_mfma_f32_16x16x32_bf16 a[156:159], v[64:67], v[100:103], 0
    s_add_u32 s22, s22, 4096
    v_mfma_f32_16x16x32_bf16 a[160:163], v[64:67], v[104:107], 0
    buffer_load_dwordx4 v[144:147], v6, s[4:7], s22 offen
    v_mfma_f32_16x16x32_bf16 a[164:167], v[64:67], v[108:111], 0
    ds_read_b128 v[64:67], v7 offset:15360
    v_mfma_f32_16x16x32_bf16 a[168:171], v[68:71], v[84:87], 0
    s_add_u32 s22, s22, 4096
    v_mfma_f32_16x16x32_bf16 a[172:175], v[68:71], v[88:91], 0
    buffer_load_dwordx4 v[148:151], v6, s[4:7], s22 offen
    v_mfma_f32_16x16x32_bf16 a[176:179], v[68:71], v[92:95], 0
    s_add_u32 s22, s22, 4096
    v_mfma_f32_16x16x32_bf16 a[180:183], v[68:71], v[96:99], 0
    buffer_load_dwordx4 v[152:155], v6, s[4:7], s22 offen
    v_mfma_f32_16x16x32_bf16 a[184:187], v[68:71], v[100:103], 0
    s_add_u32 s22, s22, 4096
    v_mfma_f32_16x16x32_bf16 a[188:191], v[68:71], v[104:107], 0
    buffer_load_dwordx4 v[156:159], v6, s[4:7], s22 offen
    v_mfma_f32_16x16x32_bf16 a[192:195], v[68:71], v[108:111], 0
    ds_read_b128 v[68:71], v7 offset:16384
    v_mfma_f32_16x16x32_bf16 a[196:199], v[72:75], v[84:87], 0
    s_add_u32 s22, s22, 4096
    v_mfma_f32_16x16x32_bf16 a[200:203], v[72:75], v[88:91], 0
    buffer_load_dwordx4 v[160:163], v6, s[4:7], s22 offen
    v_mfma_f32_16x16x32_bf16 a[204:207], v[72:75], v[92:95], 0
    s_add_u32 s22, s22, 4096
    v_mfma_f32_16x16x32_bf16 a[208:211], v[72:75], v[96:99], 0
    buffer_load_dwordx4 v[164:167], v6, s[4:7], s22 offen
    v_mfma_f32_16x16x32_bf16 a[212:215], v[72:75], v[100:103], 0
    s_add_u32 s25, s25, 57344
    v_mfma_f32_16x16x32_bf16 a[216:219], v[72:75], v[104:107], 0
    v_mfma_f32_16x16x32_bf16 a[220:223], v[72:75], v[108:111], 0
    ds_read_b128 v[72:75], v7 offset:17408
    v_mfma_f32_16x16x32_bf16 a[224:227], v[76:79], v[84:87], 0
    v_mfma_f32_16x16x32_bf16 a[228:231], v[76:79], v[88:91], 0
    v_mfma_f32_16x16x32_bf16 a[232:235], v[76:79], v[92:95], 0
    v_mfma_f32_16x16x32_bf16 a[236:239], v[76:79], v[96:99], 0
    v_mfma_f32_16x16x32_bf16 a[240:243], v[76:79], v[100:103], 0
    v_mfma_f32_16x16x32_bf16 a[244:247], v[76:79], v[104:107], 0
    v_mfma_f32_16x16x32_bf16 a[248:251], v[76:79], v[108:111], 0
    ds_read_b128 v[76:79], v7 offset:18432
    v_mfma_f32_16x16x32_bf16 a[252:255], v[80:83], v[84:87], 0
    v_mfma_f32_16x16x32_bf16 v[20:23], v[80:83], v[88:91], 0
    v_mfma_f32_16x16x32_bf16 v[24:27], v[80:83], v[92:95], 0
    v_mfma_f32_16x16x32_bf16 v[28:31], v[80:83], v[96:99], 0
    v_mfma_f32_16x16x32_bf16 v[32:35], v[80:83], v[100:103], 0
    v_mfma_f32_16x16x32_bf16 v[36:39], v[80:83], v[104:107], 0
    v_mfma_f32_16x16x32_bf16 v[40:43], v[80:83], v[108:111], 0
    ds_read_b128 v[80:83], v7 offset:19456
    s_waitcnt vmcnt(7) lgkmcnt(7)
    v_mfma_f32_16x16x32_bf16 a[0:3], v[44:47], v[112:115], a[0:3]
    v_mfma_f32_16x16x32_bf16 a[4:7], v[44:47], v[116:119], a[4:7]
    v_mfma_f32_16x16x32_bf16 a[8:11], v[44:47], v[120:123], a[8:11]
    v_mfma_f32_16x16x32_bf16 a[12:15], v[44:47], v[124:127], a[12:15]
    v_mfma_f32_16x16x32_bf16 a[16:19], v[44:47], v[128:131], a[16:19]
    v_mfma_f32_16x16x32_bf16 a[20:23], v[44:47], v[132:135], a[20:23]
    v_mfma_f32_16x16x32_bf16 a[24:27], v[44:47], v[136:139], a[24:27]
    ds_read_b128 v[44:47], v7 offset:20480
    v_mfma_f32_16x16x32_bf16 a[28:31], v[48:51], v[112:115], a[28:31]
    v_mfma_f32_16x16x32_bf16 a[32:35], v[48:51], v[116:119], a[32:35]
    v_mfma_f32_16x16x32_bf16 a[36:39], v[48:51], v[120:123], a[36:39]
    v_mfma_f32_16x16x32_bf16 a[40:43], v[48:51], v[124:127], a[40:43]
    v_mfma_f32_16x16x32_bf16 a[44:47], v[48:51], v[128:131], a[44:47]
    v_mfma_f32_16x16x32_bf16 a[48:51], v[48:51], v[132:135], a[48:51]
    v_mfma_f32_16x16x32_bf16 a[52:55], v[48:51], v[136:139], a[52:55]
    ds_read_b128 v[48:51], v7 offset:21504
    s_waitcnt lgkmcnt(2)
    v_mfma_f32_16x16x32_bf16 a[56:59], v[52:55], v[112:115], a[56:59]
    s_add_u32 m0, s27, 30720
    v_mfma_f32_16x16x32_bf16 a[60:63], v[52:55], v[116:119], a[60:63]
    s_mov_b32 s23, s26
    v_mfma_f32_16x16x32_bf16 a[64:67], v[52:55], v[120:123], a[64:67]
    buffer_load_dwordx4 v6, s[8:11], s23 offen offset:0 lds
    v_mfma_f32_16x16x32_bf16 a[68:71], v[52:55], v[124:127], a[68:71]
    buffer_load_dwordx4 v6, s[8:11], s23 offen offset:1024 lds
    v_mfma_f32_16x16x32_bf16 a[72:75], v[52:55], v[128:131], a[72:75]
    buffer_load_dwordx4 v6, s[8:11], s23 offen offset:2048 lds
    v_mfma_f32_16x16x32_bf16 a[76:79], v[52:55], v[132:135], a[76:79]
    buffer_load_dwordx4 v6, s[8:11], s23 offen offset:3072 lds
    v_mfma_f32_16x16x32_bf16 a[80:83], v[52:55], v[136:139], a[80:83]
    ds_read_b128 v[52:55], v7 offset:22528
    v_mfma_f32_16x16x32_bf16 a[84:87], v[56:59], v[112:115], a[84:87]
    s_add_u32 m0, s27, 34816
    v_mfma_f32_16x16x32_bf16 a[88:91], v[56:59], v[116:119], a[88:91]
    s_add_u32 s23, s23, 4096
    v_mfma_f32_16x16x32_bf16 a[92:95], v[56:59], v[120:123], a[92:95]
    buffer_load_dwordx4 v6, s[8:11], s23 offen offset:0 lds
    v_mfma_f32_16x16x32_bf16 a[96:99], v[56:59], v[124:127], a[96:99]
    buffer_load_dwordx4 v6, s[8:11], s23 offen offset:1024 lds
    v_mfma_f32_16x16x32_bf16 a[100:103], v[56:59], v[128:131], a[100:103]
    buffer_load_dwordx4 v6, s[8:11], s23 offen offset:2048 lds
    v_mfma_f32_16x16x32_bf16 a[104:107], v[56:59], v[132:135], a[104:107]
    buffer_load_dwordx4 v6, s[8:11], s23 offen offset:3072 lds
    v_mfma_f32_16x16x32_bf16 a[108:111], v[56:59], v[136:139], a[108:111]
    ds_read_b128 v[56:59], v7 offset:23552
    v_mfma_f32_16x16x32_bf16 a[112:115], v[60:63], v[112:115], a[112:115]
    s_add_u32 m0, s27, 38912
    v_mfma_f32_16x16x32_bf16 a[116:119], v[60:63], v[116:119], a[116:119]
    s_add_u32 s23, s23, 4096
    v_mfma_f32_16x16x32_bf16 a[120:123], v[60:63], v[120:123], a[120:123]
    buffer_load_dwordx4 v6, s[8:11], s23 offen offset:0 lds
    v_mfma_f32_16x16x32_bf16 a[124:127], v[60:63], v[124:127], a[124:127]
    buffer_load_dwordx4 v6, s[8:11], s23 offen offset:1024 lds
    v_mfma_f32_16x16x32_bf16 a[128:131], v[60:63], v[128:131], a[128:131]
    s_add_u32 s26, s26, 163840
    v_mfma_f32_16x16x32_bf16 a[132:135], v[60:63], v[132:135], a[132:135]
    s_mov_b32 s22, s25
    v_mfma_f32_16x16x32_bf16 a[136:139], v[60:63], v[136:139], a[136:139]
    ds_read_b128 v[60:63], v7 offset:24576
    v_mfma_f32_16x16x32_bf16 a[140:143], v[64:67], v[112:115], a[140:143]
    buffer_load_dwordx4 v[168:171], v6, s[4:7], s22 offen
    v_mfma_f32_16x16x32_bf16 a[144:147], v[64:67], v[116:119], a[144:147]
    s_add_u32 s22, s22, 4096
    v_mfma_f32_16x16x32_bf16 a[148:151], v[64:67], v[120:123], a[148:151]
    buffer_load_dwordx4 v[172:175], v6, s[4:7], s22 offen
    v_mfma_f32_16x16x32_bf16 a[152:155], v[64:67], v[124:127], a[152:155]
    s_add_u32 s22, s22, 4096
    v_mfma_f32_16x16x32_bf16 a[156:159], v[64:67], v[128:131], a[156:159]
    buffer_load_dwordx4 v[176:179], v6, s[4:7], s22 offen
    v_mfma_f32_16x16x32_bf16 a[160:163], v[64:67], v[132:135], a[160:163]
    s_add_u32 s22, s22, 4096
    v_mfma_f32_16x16x32_bf16 a[164:167], v[64:67], v[136:139], a[164:167]
    ds_read_b128 v[64:67], v7 offset:25600
    v_mfma_f32_16x16x32_bf16 a[168:171], v[68:71], v[112:115], a[168:171]
    buffer_load_dwordx4 v[180:183], v6, s[4:7], s22 offen
    v_mfma_f32_16x16x32_bf16 a[172:175], v[68:71], v[116:119], a[172:175]
    s_add_u32 s22, s22, 4096
    v_mfma_f32_16x16x32_bf16 a[176:179], v[68:71], v[120:123], a[176:179]
    buffer_load_dwordx4 v[184:187], v6, s[4:7], s22 offen
    v_mfma_f32_16x16x32_bf16 a[180:183], v[68:71], v[124:127], a[180:183]
    s_add_u32 s22, s22, 4096
    v_mfma_f32_16x16x32_bf16 a[184:187], v[68:71], v[128:131], a[184:187]
    buffer_load_dwordx4 v[188:191], v6, s[4:7], s22 offen
    v_mfma_f32_16x16x32_bf16 a[188:191], v[68:71], v[132:135], a[188:191]
    s_add_u32 s22, s22, 4096
    v_mfma_f32_16x16x32_bf16 a[192:195], v[68:71], v[136:139], a[192:195]
    ds_read_b128 v[68:71], v7 offset:26624
    v_mfma_f32_16x16x32_bf16 a[196:199], v[72:75], v[112:115], a[196:199]
    buffer_load_dwordx4 v[192:195], v6, s[4:7], s22 offen
    v_mfma_f32_16x16x32_bf16 a[200:203], v[72:75], v[116:119], a[200:203]
    s_add_u32 s25, s25, 57344
    v_mfma_f32_16x16x32_bf16 a[204:207], v[72:75], v[120:123], a[204:207]
    s_add_u32 m0, s27, 0
    v_mfma_f32_16x16x32_bf16 a[208:211], v[72:75], v[124:127], a[208:211]
    s_mov_b32 s23, s26
    v_mfma_f32_16x16x32_bf16 a[212:215], v[72:75], v[128:131], a[212:215]
    buffer_load_dwordx4 v6, s[8:11], s23 offen offset:0 lds
    v_mfma_f32_16x16x32_bf16 a[216:219], v[72:75], v[132:135], a[216:219]
    buffer_load_dwordx4 v6, s[8:11], s23 offen offset:1024 lds
    v_mfma_f32_16x16x32_bf16 a[220:223], v[72:75], v[136:139], a[220:223]
    ds_read_b128 v[72:75], v7 offset:27648
    v_mfma_f32_16x16x32_bf16 a[224:227], v[76:79], v[112:115], a[224:227]
    buffer_load_dwordx4 v6, s[8:11], s23 offen offset:2048 lds
    v_mfma_f32_16x16x32_bf16 a[228:231], v[76:79], v[116:119], a[228:231]
    buffer_load_dwordx4 v6, s[8:11], s23 offen offset:3072 lds
    v_mfma_f32_16x16x32_bf16 a[232:235], v[76:79], v[120:123], a[232:235]
    s_add_u32 m0, s27, 4096
    v_mfma_f32_16x16x32_bf16 a[236:239], v[76:79], v[124:127], a[236:239]
    s_add_u32 s23, s23, 4096
    v_mfma_f32_16x16x32_bf16 a[240:243], v[76:79], v[128:131], a[240:243]
    buffer_load_dwordx4 v6, s[8:11], s23 offen offset:0 lds
    v_mfma_f32_16x16x32_bf16 a[244:247], v[76:79], v[132:135], a[244:247]
    buffer_load_dwordx4 v6, s[8:11], s23 offen offset:1024 lds
    v_mfma_f32_16x16x32_bf16 a[248:251], v[76:79], v[136:139], a[248:251]
    ds_read_b128 v[76:79], v7 offset:28672
    v_mfma_f32_16x16x32_bf16 a[252:255], v[80:83], v[112:115], a[252:255]
    buffer_load_dwordx4 v6, s[8:11], s23 offen offset:2048 lds
    v_mfma_f32_16x16x32_bf16 v[20:23], v[80:83], v[116:119], v[20:23]
    buffer_load_dwordx4 v6, s[8:11], s23 offen offset:3072 lds
    v_mfma_f32_16x16x32_bf16 v[24:27], v[80:83], v[120:123], v[24:27]
    s_add_u32 m0, s27, 8192
    v_mfma_f32_16x16x32_bf16 v[28:31], v[80:83], v[124:127], v[28:31]
    s_add_u32 s23, s23, 4096
    v_mfma_f32_16x16x32_bf16 v[32:35], v[80:83], v[128:131], v[32:35]
    buffer_load_dwordx4 v6, s[8:11], s23 offen offset:0 lds
    v_mfma_f32_16x16x32_bf16 v[36:39], v[80:83], v[132:135], v[36:39]
    buffer_load_dwordx4 v6, s[8:11], s23 offen offset:1024 lds
    v_mfma_f32_16x16x32_bf16 v[40:43], v[80:83], v[136:139], v[40:43]
    ds_read_b128 v[80:83], v7 offset:29696
    s_add_u32 s26, s26, 163840
    s_waitcnt vmcnt(17) lgkmcnt(7)
    v_mfma_f32_16x16x32_bf16 a[0:3], v[44:47], v[140:143], a[0:3]
    s_mov_b32 s22, s25
    v_mfma_f32_16x16x32_bf16 a[4:7], v[44:47], v[144:147], a[4:7]
    buffer_load_dwordx4 v[84:87], v6, s[4:7], s22 offen
    v_mfma_f32_16x16x32_bf16 a[8:11], v[44:47], v[148:151], a[8:11]
    s_add_u32 s22, s22, 4096
    v_mfma_f32_16x16x32_bf16 a[12:15], v[44:47], v[152:155], a[12:15]
    buffer_load_dwordx4 v[88:91], v6, s[4:7], s22 offen
    v_mfma_f32_16x16x32_bf16 a[16:19], v[44:47], v[156:159], a[16:19]
    s_add_u32 s22, s22, 4096
    v_mfma_f32_16x16x32_bf16 a[20:23], v[44:47], v[160:163], a[20:23]
    buffer_load_dwordx4 v[92:95], v6, s[4:7], s22 offen
    v_mfma_f32_16x16x32_bf16 a[24:27], v[44:47], v[164:167], a[24:27]
    ds_read_b128 v[44:47], v7 offset:30720
    v_mfma_f32_16x16x32_bf16 a[28:31], v[48:51], v[140:143], a[28:31]
    s_add_u32 s22, s22, 4096
    v_mfma_f32_16x16x32_bf16 a[32:35], v[48:51], v[144:147], a[32:35]
    buffer_load_dwordx4 v[96:99], v6, s[4:7], s22 offen
    v_mfma_f32_16x16x32_bf16 a[36:39], v[48:51], v[148:151], a[36:39]
    s_add_u32 s22, s22, 4096
    v_mfma_f32_16x16x32_bf16 a[40:43], v[48:51], v[152:155], a[40:43]
    buffer_load_dwordx4 v[100:103], v6, s[4:7], s22 offen
    v_mfma_f32_16x16x32_bf16 a[44:47], v[48:51], v[156:159], a[44:47]
    s_add_u32 s22, s22, 4096
    v_mfma_f32_16x16x32_bf16 a[48:51], v[48:51], v[160:163], a[48:51]
    buffer_load_dwordx4 v[104:107], v6, s[4:7], s22 offen
    v_mfma_f32_16x16x32_bf16 a[52:55], v[48:51], v[164:167], a[52:55]
    ds_read_b128 v[48:51], v7 offset:31744
    s_waitcnt lgkmcnt(2)
    v_mfma_f32_16x16x32_bf16 a[56:59], v[52:55], v[140:143], a[56:59]
    s_add_u32 s22, s22, 4096
    v_mfma_f32_16x16x32_bf16 a[60:63], v[52:55], v[144:147], a[60:63]
    buffer_load_dwordx4 v[108:111], v6, s[4:7], s22 offen
    v_mfma_f32_16x16x32_bf16 a[64:67], v[52:55], v[148:151], a[64:67]
    s_add_u32 s25, s25, 57344
    v_mfma_f32_16x16x32_bf16 a[68:71], v[52:55], v[152:155], a[68:71]
    s_add_u32 m0, s27, 10240
    v_mfma_f32_16x16x32_bf16 a[72:75], v[52:55], v[156:159], a[72:75]
    s_mov_b32 s23, s26
    v_mfma_f32_16x16x32_bf16 a[76:79], v[52:55], v[160:163], a[76:79]
    buffer_load_dwordx4 v6, s[8:11], s23 offen offset:0 lds
    v_mfma_f32_16x16x32_bf16 a[80:83], v[52:55], v[164:167], a[80:83]
    ds_read_b128 v[52:55], v7 offset:32768
    v_mfma_f32_16x16x32_bf16 a[84:87], v[56:59], v[140:143], a[84:87]
    buffer_load_dwordx4 v6, s[8:11], s23 offen offset:1024 lds
    v_mfma_f32_16x16x32_bf16 a[88:91], v[56:59], v[144:147], a[88:91]
    buffer_load_dwordx4 v6, s[8:11], s23 offen offset:2048 lds
    v_mfma_f32_16x16x32_bf16 a[92:95], v[56:59], v[148:151], a[92:95]
    buffer_load_dwordx4 v6, s[8:11], s23 offen offset:3072 lds
    v_mfma_f32_16x16x32_bf16 a[96:99], v[56:59], v[152:155], a[96:99]
    s_add_u32 m0, s27, 14336
    v_mfma_f32_16x16x32_bf16 a[100:103], v[56:59], v[156:159], a[100:103]
    s_add_u32 s23, s23, 4096
    v_mfma_f32_16x16x32_bf16 a[104:107], v[56:59], v[160:163], a[104:107]
    buffer_load_dwordx4 v6, s[8:11], s23 offen offset:0 lds
    v_mfma_f32_16x16x32_bf16 a[108:111], v[56:59], v[164:167], a[108:111]
    ds_read_b128 v[56:59], v7 offset:33792
    v_mfma_f32_16x16x32_bf16 a[112:115], v[60:63], v[140:143], a[112:115]
    buffer_load_dwordx4 v6, s[8:11], s23 offen offset:1024 lds
    v_mfma_f32_16x16x32_bf16 a[116:119], v[60:63], v[144:147], a[116:119]
    buffer_load_dwordx4 v6, s[8:11], s23 offen offset:2048 lds
    v_mfma_f32_16x16x32_bf16 a[120:123], v[60:63], v[148:151], a[120:123]
    buffer_load_dwordx4 v6, s[8:11], s23 offen offset:3072 lds
    v_mfma_f32_16x16x32_bf16 a[124:127], v[60:63], v[152:155], a[124:127]
    s_add_u32 m0, s27, 18432
    v_mfma_f32_16x16x32_bf16 a[128:131], v[60:63], v[156:159], a[128:131]
    s_add_u32 s23, s23, 4096
    v_mfma_f32_16x16x32_bf16 a[132:135], v[60:63], v[160:163], a[132:135]
    buffer_load_dwordx4 v6, s[8:11], s23 offen offset:0 lds
    v_mfma_f32_16x16x32_bf16 a[136:139], v[60:63], v[164:167], a[136:139]
    ds_read_b128 v[60:63], v7 offset:34816
    v_mfma_f32_16x16x32_bf16 a[140:143], v[64:67], v[140:143], a[140:143]
    buffer_load_dwordx4 v6, s[8:11], s23 offen offset:1024 lds
    v_mfma_f32_16x16x32_bf16 a[144:147], v[64:67], v[144:147], a[144:147]
    s_add_u32 s26, s26, 163840
    v_mfma_f32_16x16x32_bf16 a[148:151], v[64:67], v[148:151], a[148:151]
    s_mov_b32 s22, s25
    v_mfma_f32_16x16x32_bf16 a[152:155], v[64:67], v[152:155], a[152:155]
    buffer_load_dwordx4 v[112:115], v6, s[4:7], s22 offen
    v_mfma_f32_16x16x32_bf16 a[156:159], v[64:67], v[156:159], a[156:159]
    s_add_u32 s22, s22, 4096
    v_mfma_f32_16x16x32_bf16 a[160:163], v[64:67], v[160:163], a[160:163]
    buffer_load_dwordx4 v[116:119], v6, s[4:7], s22 offen
    v_mfma_f32_16x16x32_bf16 a[164:167], v[64:67], v[164:167], a[164:167]
    ds_read_b128 v[64:67], v7 offset:35840
    v_mfma_f32_16x16x32_bf16 a[168:171], v[68:71], v[140:143], a[168:171]
    s_add_u32 s22, s22, 4096
    v_mfma_f32_16x16x32_bf16 a[172:175], v[68:71], v[144:147], a[172:175]
    buffer_load_dwordx4 v[120:123], v6, s[4:7], s22 offen
    v_mfma_f32_16x16x32_bf16 a[176:179], v[68:71], v[148:151], a[176:179]
    s_add_u32 s22, s22, 4096
    v_mfma_f32_16x16x32_bf16 a[180:183], v[68:71], v[152:155], a[180:183]
    buffer_load_dwordx4 v[124:127], v6, s[4:7], s22 offen
    v_mfma_f32_16x16x32_bf16 a[184:187], v[68:71], v[156:159], a[184:187]
    s_add_u32 s22, s22, 4096
    v_mfma_f32_16x16x32_bf16 a[188:191], v[68:71], v[160:163], a[188:191]
    buffer_load_dwordx4 v[128:131], v6, s[4:7], s22 offen
    v_mfma_f32_16x16x32_bf16 a[192:195], v[68:71], v[164:167], a[192:195]
    ds_read_b128 v[68:71], v7 offset:36864
    v_mfma_f32_16x16x32_bf16 a[196:199], v[72:75], v[140:143], a[196:199]
    s_add_u32 s22, s22, 4096
    v_mfma_f32_16x16x32_bf16 a[200:203], v[72:75], v[144:147], a[200:203]
    buffer_load_dwordx4 v[132:135], v6, s[4:7], s22 offen
    v_mfma_f32_16x16x32_bf16 a[204:207], v[72:75], v[148:151], a[204:207]
    s_add_u32 s22, s22, 4096
    v_mfma_f32_16x16x32_bf16 a[208:211], v[72:75], v[152:155], a[208:211]
    buffer_load_dwordx4 v[136:139], v6, s[4:7], s22 offen
    v_mfma_f32_16x16x32_bf16 a[212:215], v[72:75], v[156:159], a[212:215]
    s_add_u32 s25, s25, 57344
    v_mfma_f32_16x16x32_bf16 a[216:219], v[72:75], v[160:163], a[216:219]
    v_mfma_f32_16x16x32_bf16 a[220:223], v[72:75], v[164:167], a[220:223]
    ds_read_b128 v[72:75], v7 offset:37888
    v_mfma_f32_16x16x32_bf16 a[224:227], v[76:79], v[140:143], a[224:227]
    v_mfma_f32_16x16x32_bf16 a[228:231], v[76:79], v[144:147], a[228:231]
    v_mfma_f32_16x16x32_bf16 a[232:235], v[76:79], v[148:151], a[232:235]
    v_mfma_f32_16x16x32_bf16 a[236:239], v[76:79], v[152:155], a[236:239]
    v_mfma_f32_16x16x32_bf16 a[240:243], v[76:79], v[156:159], a[240:243]
    v_mfma_f32_16x16x32_bf16 a[244:247], v[76:79], v[160:163], a[244:247]
    v_mfma_f32_16x16x32_bf16 a[248:251], v[76:79], v[164:167], a[248:251]
    ds_read_b128 v[76:79], v7 offset:38912
    v_mfma_f32_16x16x32_bf16 a[252:255], v[80:83], v[140:143], a[252:255]
    v_mfma_f32_16x16x32_bf16 v[20:23], v[80:83], v[144:147], v[20:23]
    v_mfma_f32_16x16x32_bf16 v[24:27], v[80:83], v[148:151], v[24:27]
    v_mfma_f32_16x16x32_bf16 v[28:31], v[80:83], v[152:155], v[28:31]
    v_mfma_f32_16x16x32_bf16 v[32:35], v[80:83], v[156:159], v[32:35]
    v_mfma_f32_16x16x32_bf16 v[36:39], v[80:83], v[160:163], v[36:39]
    v_mfma_f32_16x16x32_bf16 v[40:43], v[80:83], v[164:167], v[40:43]
    ds_read_b128 v[80:83], v7 offset:39936
    s_waitcnt vmcnt(24) lgkmcnt(7)
    v_mfma_f32_16x16x32_bf16 a[0:3], v[44:47], v[168:171], a[0:3]
    v_mfma_f32_16x16x32_bf16 a[4:7], v[44:47], v[172:175], a[4:7]
    v_mfma_f32_16x16x32_bf16 a[8:11], v[44:47], v[176:179], a[8:11]
    v_mfma_f32_16x16x32_bf16 a[12:15], v[44:47], v[180:183], a[12:15]
    v_mfma_f32_16x16x32_bf16 a[16:19], v[44:47], v[184:187], a[16:19]
    v_mfma_f32_16x16x32_bf16 a[20:23], v[44:47], v[188:191], a[20:23]
    v_mfma_f32_16x16x32_bf16 a[24:27], v[44:47], v[192:195], a[24:27]
    ds_read_b128 v[44:47], v7 offset:0
    v_mfma_f32_16x16x32_bf16 a[28:31], v[48:51], v[168:171], a[28:31]
    v_mfma_f32_16x16x32_bf16 a[32:35], v[48:51], v[172:175], a[32:35]
    v_mfma_f32_16x16x32_bf16 a[36:39], v[48:51], v[176:179], a[36:39]
    v_mfma_f32_16x16x32_bf16 a[40:43], v[48:51], v[180:183], a[40:43]
    v_mfma_f32_16x16x32_bf16 a[44:47], v[48:51], v[184:187], a[44:47]
    v_mfma_f32_16x16x32_bf16 a[48:51], v[48:51], v[188:191], a[48:51]
    v_mfma_f32_16x16x32_bf16 a[52:55], v[48:51], v[192:195], a[52:55]
    ds_read_b128 v[48:51], v7 offset:1024
    s_waitcnt lgkmcnt(2)
    v_mfma_f32_16x16x32_bf16 a[56:59], v[52:55], v[168:171], a[56:59]
    s_add_u32 m0, s27, 20480
    v_mfma_f32_16x16x32_bf16 a[60:63], v[52:55], v[172:175], a[60:63]
    s_mov_b32 s23, s26
    v_mfma_f32_16x16x32_bf16 a[64:67], v[52:55], v[176:179], a[64:67]
    buffer_load_dwordx4 v6, s[8:11], s23 offen offset:0 lds
    v_mfma_f32_16x16x32_bf16 a[68:71], v[52:55], v[180:183], a[68:71]
    buffer_load_dwordx4 v6, s[8:11], s23 offen offset:1024 lds
    v_mfma_f32_16x16x32_bf16 a[72:75], v[52:55], v[184:187], a[72:75]
    buffer_load_dwordx4 v6, s[8:11], s23 offen offset:2048 lds
    v_mfma_f32_16x16x32_bf16 a[76:79], v[52:55], v[188:191], a[76:79]
    buffer_load_dwordx4 v6, s[8:11], s23 offen offset:3072 lds
    v_mfma_f32_16x16x32_bf16 a[80:83], v[52:55], v[192:195], a[80:83]
    ds_read_b128 v[52:55], v7 offset:2048
    v_mfma_f32_16x16x32_bf16 a[84:87], v[56:59], v[168:171], a[84:87]
    s_add_u32 m0, s27, 24576
    v_mfma_f32_16x16x32_bf16 a[88:91], v[56:59], v[172:175], a[88:91]
    s_add_u32 s23, s23, 4096
    v_mfma_f32_16x16x32_bf16 a[92:95], v[56:59], v[176:179], a[92:95]
    buffer_load_dwordx4 v6, s[8:11], s23 offen offset:0 lds
    v_mfma_f32_16x16x32_bf16 a[96:99], v[56:59], v[180:183], a[96:99]
    buffer_load_dwordx4 v6, s[8:11], s23 offen offset:1024 lds
    v_mfma_f32_16x16x32_bf16 a[100:103], v[56:59], v[184:187], a[100:103]
    buffer_load_dwordx4 v6, s[8:11], s23 offen offset:2048 lds
    v_mfma_f32_16x16x32_bf16 a[104:107], v[56:59], v[188:191], a[104:107]
    buffer_load_dwordx4 v6, s[8:11], s23 offen offset:3072 lds
    v_mfma_f32_16x16x32_bf16 a[108:111], v[56:59], v[192:195], a[108:111]
    ds_read_b128 v[56:59], v7 offset:3072
    v_mfma_f32_16x16x32_bf16 a[112:115], v[60:63], v[168:171], a[112:115]
    s_add_u32 m0, s27, 28672
    v_mfma_f32_16x16x32_bf16 a[116:119], v[60:63], v[172:175], a[116:119]
    s_add_u32 s23, s23, 4096
    v_mfma_f32_16x16x32_bf16 a[120:123], v[60:63], v[176:179], a[120:123]
    buffer_load_dwordx4 v6, s[8:11], s23 offen offset:0 lds
    v_mfma_f32_16x16x32_bf16 a[124:127], v[60:63], v[180:183], a[124:127]
    buffer_load_dwordx4 v6, s[8:11], s23 offen offset:1024 lds
    v_mfma_f32_16x16x32_bf16 a[128:131], v[60:63], v[184:187], a[128:131]
    s_add_u32 s26, s26, 163840
    v_mfma_f32_16x16x32_bf16 a[132:135], v[60:63], v[188:191], a[132:135]
    s_mov_b32 s22, s25
    v_mfma_f32_16x16x32_bf16 a[136:139], v[60:63], v[192:195], a[136:139]
    ds_read_b128 v[60:63], v7 offset:4096
    v_mfma_f32_16x16x32_bf16 a[140:143], v[64:67], v[168:171], a[140:143]
    buffer_load_dwordx4 v[140:143], v6, s[4:7], s22 offen
    v_mfma_f32_16x16x32_bf16 a[144:147], v[64:67], v[172:175], a[144:147]
    s_add_u32 s22, s22, 4096
    v_mfma_f32_16x16x32_bf16 a[148:151], v[64:67], v[176:179], a[148:151]
    buffer_load_dwordx4 v[144:147], v6, s[4:7], s22 offen
    v_mfma_f32_16x16x32_bf16 a[152:155], v[64:67], v[180:183], a[152:155]
    s_add_u32 s22, s22, 4096
    v_mfma_f32_16x16x32_bf16 a[156:159], v[64:67], v[184:187], a[156:159]
    buffer_load_dwordx4 v[148:151], v6, s[4:7], s22 offen
    v_mfma_f32_16x16x32_bf16 a[160:163], v[64:67], v[188:191], a[160:163]
    s_add_u32 s22, s22, 4096
    v_mfma_f32_16x16x32_bf16 a[164:167], v[64:67], v[192:195], a[164:167]
    ds_read_b128 v[64:67], v7 offset:5120
    v_mfma_f32_16x16x32_bf16 a[168:171], v[68:71], v[168:171], a[168:171]
    buffer_load_dwordx4 v[152:155], v6, s[4:7], s22 offen
    v_mfma_f32_16x16x32_bf16 a[172:175], v[68:71], v[172:175], a[172:175]
    s_add_u32 s22, s22, 4096
    v_mfma_f32_16x16x32_bf16 a[176:179], v[68:71], v[176:179], a[176:179]
    buffer_load_dwordx4 v[156:159], v6, s[4:7], s22 offen
    v_mfma_f32_16x16x32_bf16 a[180:183], v[68:71], v[180:183], a[180:183]
    s_add_u32 s22, s22, 4096
    v_mfma_f32_16x16x32_bf16 a[184:187], v[68:71], v[184:187], a[184:187]
    buffer_load_dwordx4 v[160:163], v6, s[4:7], s22 offen
    v_mfma_f32_16x16x32_bf16 a[188:191], v[68:71], v[188:191], a[188:191]
    s_add_u32 s22, s22, 4096
    v_mfma_f32_16x16x32_bf16 a[192:195], v[68:71], v[192:195], a[192:195]
    ds_read_b128 v[68:71], v7 offset:6144
    v_mfma_f32_16x16x32_bf16 a[196:199], v[72:75], v[168:171], a[196:199]
    buffer_load_dwordx4 v[164:167], v6, s[4:7], s22 offen
    v_mfma_f32_16x16x32_bf16 a[200:203], v[72:75], v[172:175], a[200:203]
    s_add_u32 s25, s25, 57344
    v_mfma_f32_16x16x32_bf16 a[204:207], v[72:75], v[176:179], a[204:207]
    s_add_u32 m0, s27, 30720
    v_mfma_f32_16x16x32_bf16 a[208:211], v[72:75], v[180:183], a[208:211]
    s_mov_b32 s23, s26
    v_mfma_f32_16x16x32_bf16 a[212:215], v[72:75], v[184:187], a[212:215]
    buffer_load_dwordx4 v6, s[8:11], s23 offen offset:0 lds
    v_mfma_f32_16x16x32_bf16 a[216:219], v[72:75], v[188:191], a[216:219]
    buffer_load_dwordx4 v6, s[8:11], s23 offen offset:1024 lds
    v_mfma_f32_16x16x32_bf16 a[220:223], v[72:75], v[192:195], a[220:223]
    ds_read_b128 v[72:75], v7 offset:7168
    v_mfma_f32_16x16x32_bf16 a[224:227], v[76:79], v[168:171], a[224:227]
    buffer_load_dwordx4 v6, s[8:11], s23 offen offset:2048 lds
    v_mfma_f32_16x16x32_bf16 a[228:231], v[76:79], v[172:175], a[228:231]
    buffer_load_dwordx4 v6, s[8:11], s23 offen offset:3072 lds
    v_mfma_f32_16x16x32_bf16 a[232:235], v[76:79], v[176:179], a[232:235]
    s_add_u32 m0, s27, 34816
    v_mfma_f32_16x16x32_bf16 a[236:239], v[76:79], v[180:183], a[236:239]
    s_add_u32 s23, s23, 4096
    v_mfma_f32_16x16x32_bf16 a[240:243], v[76:79], v[184:187], a[240:243]
    buffer_load_dwordx4 v6, s[8:11], s23 offen offset:0 lds
    v_mfma_f32_16x16x32_bf16 a[244:247], v[76:79], v[188:191], a[244:247]
    buffer_load_dwordx4 v6, s[8:11], s23 offen offset:1024 lds
    v_mfma_f32_16x16x32_bf16 a[248:251], v[76:79], v[192:195], a[248:251]
    ds_read_b128 v[76:79], v7 offset:8192
    v_mfma_f32_16x16x32_bf16 a[252:255], v[80:83], v[168:171], a[252:255]
    buffer_load_dwordx4 v6, s[8:11], s23 offen offset:2048 lds
    v_mfma_f32_16x16x32_bf16 v[20:23], v[80:83], v[172:175], v[20:23]
    buffer_load_dwordx4 v6, s[8:11], s23 offen offset:3072 lds
    v_mfma_f32_16x16x32_bf16 v[24:27], v[80:83], v[176:179], v[24:27]
    s_add_u32 m0, s27, 38912
    v_mfma_f32_16x16x32_bf16 v[28:31], v[80:83], v[180:183], v[28:31]
    s_add_u32 s23, s23, 4096
    v_mfma_f32_16x16x32_bf16 v[32:35], v[80:83], v[184:187], v[32:35]
    buffer_load_dwordx4 v6, s[8:11], s23 offen offset:0 lds
    v_mfma_f32_16x16x32_bf16 v[36:39], v[80:83], v[188:191], v[36:39]
    buffer_load_dwordx4 v6, s[8:11], s23 offen offset:1024 lds
    v_mfma_f32_16x16x32_bf16 v[40:43], v[80:83], v[192:195], v[40:43]
    ds_read_b128 v[80:83], v7 offset:9216
    s_add_u32 s26, s26, 163840
    s_mov_b32 s21, 0
L_op_loop:
    s_waitcnt vmcnt(34) lgkmcnt(7)
    v_mfma_f32_16x16x32_bf16 a[0:3], v[44:47], v[84:87], a[0:3]
    s_mov_b32 s22, s25
    v_mfma_f32_16x16x32_bf16 a[4:7], v[44:47], v[88:91], a[4:7]
    buffer_load_dwordx4 v[168:171], v6, s[4:7], s22 offen
    v_mfma_f32_16x16x32_bf16 a[8:11], v[44:47], v[92:95], a[8:11]
    s_add_u32 s22, s22, 4096
    v_mfma_f32_16x16x32_bf16 a[12:15], v[44:47], v[96:99], a[12:15]
    buffer_load_dwordx4 v[172:175], v6, s[4:7], s22 offen
    v_mfma_f32_16x16x32_bf16 a[16:19], v[44:47], v[100:103], a[16:19]
    s_add_u32 s22, s22, 4096
    v_mfma_f32_16x16x32_bf16 a[20:23], v[44:47], v[104:107], a[20:23]
    buffer_load_dwordx4 v[176:179], v6, s[4:7], s22 offen
    v_mfma_f32_16x16x32_bf16 a[24:27], v[44:47], v[108:111], a[24:27]
    ds_read_b128 v[44:47], v7 offset:10240
    v_mfma_f32_16x16x32_bf16 a[28:31], v[48:51], v[84:87], a[28:31]
    s_add_u32 s22, s22, 4096
    v_mfma_f32_16x16x32_bf16 a[32:35], v[48:51], v[88:91], a[32:35]
    buffer_load_dwordx4 v[180:183], v6, s[4:7], s22 offen
    v_mfma_f32_16x16x32_bf16 a[36:39], v[48:51], v[92:95], a[36:39]
    s_add_u32 s22, s22, 4096
    v_mfma_f32_16x16x32_bf16 a[40:43], v[48:51], v[96:99], a[40:43]
    buffer_load_dwordx4 v[184:187], v6, s[4:7], s22 offen
    v_mfma_f32_16x16x32_bf16 a[44:47], v[48:51], v[100:103], a[44:47]
    s_add_u32 s22, s22, 4096
    v_mfma_f32_16x16x32_bf16 a[48:51], v[48:51], v[104:107], a[48:51]
    buffer_load_dwordx4 v[188:191], v6, s[4:7], s22 offen
    v_mfma_f32_16x16x32_bf16 a[52:55], v[48:51], v[108:111], a[52:55]
    ds_read_b128 v[48:51], v7 offset:11264
    s_waitcnt lgkmcnt(2)
    v_mfma_f32_16x16x32_bf16 a[56:59], v[52:55], v[84:87], a[56:59]
    s_add_u32 s22, s22, 4096
    v_mfma_f32_16x16x32_bf16 a[60:63], v[52:55], v[88:91], a[60:63]
    buffer_load_dwordx4 v[192:195], v6, s[4:7], s22 offen
    v_mfma_f32_16x16x32_bf16 a[64:67], v[52:55], v[92:95], a[64:67]
    s_add_u32 s25, s25, 57344
    v_mfma_f32_16x16x32_bf16 a[68:71], v[52:55], v[96:99], a[68:71]
    s_add_u32 m0, s27, 0
    v_mfma_f32_16x16x32_bf16 a[72:75], v[52:55], v[100:103], a[72:75]
    s_mov_b32 s23, s26
    v_mfma_f32_16x16x32_bf16 a[76:79], v[52:55], v[104:107], a[76:79]
    buffer_load_dwordx4 v6, s[8:11], s23 offen offset:0 lds
    v_mfma_f32_16x16x32_bf16 a[80:83], v[52:55], v[108:111], a[80:83]
    ds_read_b128 v[52:55], v7 offset:12288
    v_mfma_f32_16x16x32_bf16 a[84:87], v[56:59], v[84:87], a[84:87]
    buffer_load_dwordx4 v6, s[8:11], s23 offen offset:1024 lds
    v_mfma_f32_16x16x32_bf16 a[88:91], v[56:59], v[88:91], a[88:91]
    buffer_load_dwordx4 v6, s[8:11], s23 offen offset:2048 lds
    v_mfma_f32_16x16x32_bf16 a[92:95], v[56:59], v[92:95], a[92:95]
    buffer_load_dwordx4 v6, s[8:11], s23 offen offset:3072 lds
    v_mfma_f32_16x16x32_bf16 a[96:99], v[56:59], v[96:99], a[96:99]
    s_add_u32 m0, s27, 4096
    v_mfma_f32_16x16x32_bf16 a[100:103], v[56:59], v[100:103], a[100:103]
    s_add_u32 s23, s23, 4096
    v_mfma_f32_16x16x32_bf16 a[104:107], v[56:59], v[104:107], a[104:107]
    buffer_load_dwordx4 v6, s[8:11], s23 offen offset:0 lds
    v_mfma_f32_16x16x32_bf16 a[108:111], v[56:59], v[108:111], a[108:111]
    ds_read_b128 v[56:59], v7 offset:13312
    v_mfma_f32_16x16x32_bf16 a[112:115], v[60:63], v[84:87], a[112:115]
    buffer_load_dwordx4 v6, s[8:11], s23 offen offset:1024 lds
    v_mfma_f32_16x16x32_bf16 a[116:119], v[60:63], v[88:91], a[116:119]
    buffer_load_dwordx4 v6, s[8:11], s23 offen offset:2048 lds
    v_mfma_f32_16x16x32_bf16 a[120:123], v[60:63], v[92:95], a[120:123]
    buffer_load_dwordx4 v6, s[8:11], s23 offen offset:3072 lds
    v_mfma_f32_16x16x32_bf16 a[124:127], v[60:63], v[96:99], a[124:127]
    s_add_u32 m0, s27, 8192
    v_mfma_f32_16x16x32_bf16 a[128:131], v[60:63], v[100:103], a[128:131]
    s_add_u32 s23, s23, 4096
    v_mfma_f32_16x16x32_bf16 a[132:135], v[60:63], v[104:107], a[132:135]
    buffer_load_dwordx4 v6, s[8:11], s23 offen offset:0 lds
    v_mfma_f32_16x16x32_bf16 a[136:139], v[60:63], v[108:111], a[136:139]
    ds_read_b128 v[60:63], v7 offset:14336
    v_mfma_f32_16x16x32_bf16 a[140:143], v[64:67], v[84:87], a[140:143]
    buffer_load_dwordx4 v6, s[8:11], s23 offen offset:1024 lds
    v_mfma_f32_16x16x32_bf16 a[144:147], v[64:67], v[88:91], a[144:147]
    s_add_u32 s26, s26, 163840
    v_mfma_f32_16x16x32_bf16 a[148:151], v[64:67], v[92:95], a[148:151]
    v_mfma_f32_16x16x32_bf16 a[152:155], v[64:67], v[96:99], a[152:155]
    v_mfma_f32_16x16x32_bf16 a[156:159], v[64:67], v[100:103], a[156:159]
    v_mfma_f32_16x16x32_bf16 a[160:163], v[64:67], v[104:107], a[160:163]
    v_mfma_f32_16x16x32_bf16 a[164:167], v[64:67], v[108:111], a[164:167]
    ds_read_b128 v[64:67], v7 offset:15360
    v_mfma_f32_16x16x32_bf16 a[168:171], v[68:71], v[84:87], a[168:171]
    v_mfma_f32_16x16x32_bf16 a[172:175], v[68:71], v[88:91], a[172:175]
    v_mfma_f32_16x16x32_bf16 a[176:179], v[68:71], v[92:95], a[176:179]
    v_mfma_f32_16x16x32_bf16 a[180:183], v[68:71], v[96:99], a[180:183]
    v_mfma_f32_16x16x32_bf16 a[184:187], v[68:71], v[100:103], a[184:187]
    v_mfma_f32_16x16x32_bf16 a[188:191], v[68:71], v[104:107], a[188:191]
    v_mfma_f32_16x16x32_bf16 a[192:195], v[68:71], v[108:111], a[192:195]
    ds_read_b128 v[68:71], v7 offset:16384
    v_mfma_f32_16x16x32_bf16 a[196:199], v[72:75], v[84:87], a[196:199]
    v_mfma_f32_16x16x32_bf16 a[200:203], v[72:75], v[88:91], a[200:203]
    v_mfma_f32_16x16x32_bf16 a[204:207], v[72:75], v[92:95], a[204:207]
    v_mfma_f32_16x16x32_bf16 a[208:211], v[72:75], v[96:99], a[208:211]
    v_mfma_f32_16x16x32_bf16 a[212:215], v[72:75], v[100:103], a[212:215]
    v_mfma_f32_16x16x32_bf16 a[216:219], v[72:75], v[104:107], a[216:219]
    v_mfma_f32_16x16x32_bf16 a[220:223], v[72:75], v[108:111], a[220:223]
    ds_read_b128 v[72:75], v7 offset:17408
    v_mfma_f32_16x16x32_bf16 a[224:227], v[76:79], v[84:87], a[224:227]
    v_mfma_f32_16x16x32_bf16 a[228:231], v[76:79], v[88:91], a[228:231]
    v_mfma_f32_16x16x32_bf16 a[232:235], v[76:79], v[92:95], a[232:235]
    v_mfma_f32_16x16x32_bf16 a[236:239], v[76:79], v[96:99], a[236:239]
    v_mfma_f32_16x16x32_bf16 a[240:243], v[76:79], v[100:103], a[240:243]
    v_mfma_f32_16x16x32_bf16 a[244:247], v[76:79], v[104:107], a[244:247]
    v_mfma_f32_16x16x32_bf16 a[248:251], v[76:79], v[108:111], a[248:251]
    ds_read_b128 v[76:79], v7 offset:18432
    v_mfma_f32_16x16x32_bf16 a[252:255], v[80:83], v[84:87], a[252:255]
    v_mfma_f32_16x16x32_bf16 v[20:23], v[80:83], v[88:91], v[20:23]
    v_mfma_f32_16x16x32_bf16 v[24:27], v[80:83], v[92:95], v[24:27]
    v_mfma_f32_16x16x32_bf16 v[28:31], v[80:83], v[96:99], v[28:31]
    v_mfma_f32_16x16x32_bf16 v[32:35], v[80:83], v[100:103], v[32:35]
    v_mfma_f32_16x16x32_bf16 v[36:39], v[80:83], v[104:107], v[36:39]
    v_mfma_f32_16x16x32_bf16 v[40:43], v[80:83], v[108:111], v[40:43]
    ds_read_b128 v[80:83], v7 offset:19456
    s_waitcnt vmcnt(34) lgkmcnt(7)
    v_mfma_f32_16x16x32_bf16 a[0:3], v[44:47], v[112:115], a[0:3]
    s_mov_b32 s22, s25
    v_mfma_f32_16x16x32_bf16 a[4:7], v[44:47], v[116:119], a[4:7]
    buffer_load_dwordx4 v[84:87], v6, s[4:7], s22 offen
    v_mfma_f32_16x16x32_bf16 a[8:11], v[44:47], v[120:123], a[8:11]
    s_add_u32 s22, s22, 4096
    v_mfma_f32_16x16x32_bf16 a[12:15], v[44:47], v[124:127], a[12:15]
    buffer_load_dwordx4 v[88:91], v6, s[4:7], s22 offen
    v_mfma_f32_16x16x32_bf16 a[16:19], v[44:47], v[128:131], a[16:19]
    s_add_u32 s22, s22, 4096
    v_mfma_f32_16x16x32_bf16 a[20:23], v[44:47], v[132:135], a[20:23]
    buffer_load_dwordx4 v[92:95], v6, s[4:7], s22 offen
    v_mfma_f32_16x16x32_bf16 a[24:27], v[44:47], v[136:139], a[24:27]
    ds_read_b128 v[44:47], v7 offset:20480
    v_mfma_f32_16x16x32_bf16 a[28:31], v[48:51], v[112:115], a[28:31]
    s_add_u32 s22, s22, 4096
    v_mfma_f32_16x16x32_bf16 a[32:35], v[48:51], v[116:119], a[32:35]
    buffer_load_dwordx4 v[96:99], v6, s[4:7], s22 offen
    v_mfma_f32_16x16x32_bf16 a[36:39], v[48:51], v[120:123], a[36:39]
    s_add_u32 s22, s22, 4096
    v_mfma_f32_16x16x32_bf16 a[40:43], v[48:51], v[124:127], a[40:43]
    buffer_load_dwordx4 v[100:103], v6, s[4:7], s22 offen
    v_mfma_f32_16x16x32_bf16 a[44:47], v[48:51], v[128:131], a[44:47]
    s_add_u32 s22, s22, 4096
    v_mfma_f32_16x16x32_bf16 a[48:51], v[48:51], v[132:135], a[48:51]
    buffer_load_dwordx4 v[104:107], v6, s[4:7], s22 offen
    v_mfma_f32_16x16x32_bf16 a[52:55], v[48:51], v[136:139], a[52:55]
    ds_read_b128 v[48:51], v7 offset:21504
    s_waitcnt lgkmcnt(2)
    v_mfma_f32_16x16x32_bf16 a[56:59], v[52:55], v[112:115], a[56:59]
    s_add_u32 s22, s22, 4096
    v_mfma_f32_16x16x32_bf16 a[60:63], v[52:55], v[116:119], a[60:63]
    buffer_load_dwordx4 v[108:111], v6, s[4:7], s22 offen
    v_mfma_f32_16x16x32_bf16 a[64:67], v[52:55], v[120:123], a[64:67]
    s_add_u32 s25, s25, 57344
    v_mfma_f32_16x16x32_bf16 a[68:71], v[52:55], v[124:127], a[68:71]
    s_add_u32 m0, s27, 10240
    v_mfma_f32_16x16x32_bf16 a[72:75], v[52:55], v[128:131], a[72:75]
    s_mov_b32 s23, s26
    v_mfma_f32_16x16x32_bf16 a[76:79], v[52:55], v[132:135], a[76:79]
    buffer_load_dwordx4 v6, s[8:11], s23 offen offset:0 lds
    v_mfma_f32_16x16x32_bf16 a[80:83], v[52:55], v[136:139], a[80:83]
    ds_read_b128 v[52:55], v7 offset:22528
    v_mfma_f32_16x16x32_bf16 a[84:87], v[56:59], v[112:115], a[84:87]
    buffer_load_dwordx4 v6, s[8:11], s23 offen offset:1024 lds
    v_mfma_f32_16x16x32_bf16 a[88:91], v[56:59], v[116:119], a[88:91]
    buffer_load_dwordx4 v6, s[8:11], s23 offen offset:2048 lds
    v_mfma_f32_16x16x32_bf16 a[92:95], v[56:59], v[120:123], a[92:95]
    buffer_load_dwordx4 v6, s[8:11], s23 offen offset:3072 lds
    v_mfma_f32_16x16x32_bf16 a[96:99], v[56:59], v[124:127], a[96:99]
    s_add_u32 m0, s27, 14336
    v_mfma_f32_16x16x32_bf16 a[100:103], v[56:59], v[128:131], a[100:103]
    s_add_u32 s23, s23, 4096
    v_mfma_f32_16x16x32_bf16 a[104:107], v[56:59], v[132:135], a[104:107]
    buffer_load_dwordx4 v6, s[8:11], s23 offen offset:0 lds
    v_mfma_f32_16x16x32_bf16 a[108:111], v[56:59], v[136:139], a[108:111]
    ds_read_b128 v[56:59], v7 offset:23552
    v_mfma_f32_16x16x32_bf16 a[112:115], v[60:63], v[112:115], a[112:115]
    buffer_load_dwordx4 v6, s[8:11], s23 offen offset:1024 lds
    v_mfma_f32_16x16x32_bf16 a[116:119], v[60:63], v[116:119], a[116:119]
    buffer_load_dwordx4 v6, s[8:11], s23 offen offset:2048 lds
    v_mfma_f32_16x16x32_bf16 a[120:123], v[60:63], v[120:123], a[120:123]
    buffer_load_dwordx4 v6, s[8:11], s23 offen offset:3072 lds
    v_mfma_f32_16x16x32_bf16 a[124:127], v[60:63], v[124:127], a[124:127]
    s_add_u32 m0, s27, 18432
    v_mfma_f32_16x16x32_bf16 a[128:131], v[60:63], v[128:131], a[128:131]
    s_add_u32 s23, s23, 4096
    v_mfma_f32_16x16x32_bf16 a[132:135], v[60:63], v[132:135], a[132:135]
    buffer_load_dwordx4 v6, s[8:11], s23 offen offset:0 lds
    v_mfma_f32_16x16x32_bf16 a[136:139], v[60:63], v[136:139], a[136:139]
    ds_read_b128 v[60:63], v7 offset:24576
    v_mfma_f32_16x16x32_bf16 a[140:143], v[64:67], v[112:115], a[140:143]
    buffer_load_dwordx4 v6, s[8:11], s23 offen offset:1024 lds
    v_mfma_f32_16x16x32_bf16 a[144:147], v[64:67], v[116:119], a[144:147]
    s_add_u32 s26, s26, 163840
    v_mfma_f32_16x16x32_bf16 a[148:151], v[64:67], v[120:123], a[148:151]
    v_mfma_f32_16x16x32_bf16 a[152:155], v[64:67], v[124:127], a[152:155]
    v_mfma_f32_16x16x32_bf16 a[156:159], v[64:67], v[128:131], a[156:159]
    v_mfma_f32_16x16x32_bf16 a[160:163], v[64:67], v[132:135], a[160:163]
    v_mfma_f32_16x16x32_bf16 a[164:167], v[64:67], v[136:139], a[164:167]
    ds_read_b128 v[64:67], v7 offset:25600
    v_mfma_f32_16x16x32_bf16 a[168:171], v[68:71], v[112:115], a[168:171]
    v_mfma_f32_16x16x32_bf16 a[172:175], v[68:71], v[116:119], a[172:175]
    v_mfma_f32_16x16x32_bf16 a[176:179], v[68:71], v[120:123], a[176:179]
    v_mfma_f32_16x16x32_bf16 a[180:183], v[68:71], v[124:127], a[180:183]
    v_mfma_f32_16x16x32_bf16 a[184:187], v[68:71], v[128:131], a[184:187]
    v_mfma_f32_16x16x32_bf16 a[188:191], v[68:71], v[132:135], a[188:191]
    v_mfma_f32_16x16x32_bf16 a[192:195], v[68:71], v[136:139], a[192:195]
    ds_read_b128 v[68:71], v7 offset:26624
    v_mfma_f32_16x16x32_bf16 a[196:199], v[72:75], v[112:115], a[196:199]
    v_mfma_f32_16x16x32_bf16 a[200:203], v[72:75], v[116:119], a[200:203]
    v_mfma_f32_16x16x32_bf16 a[204:207], v[72:75], v[120:123], a[204:207]
    v_mfma_f32_16x16x32_bf16 a[208:211], v[72:75], v[124:127], a[208:211]
    v_mfma_f32_16x16x32_bf16 a[212:215], v[72:75], v[128:131], a[212:215]
    v_mfma_f32_16x16x32_bf16 a[216:219], v[72:75], v[132:135], a[216:219]
    v_mfma_f32_16x16x32_bf16 a[220:223], v[72:75], v[136:139], a[220:223]
    ds_read_b128 v[72:75], v7 offset:27648
    v_mfma_f32_16x16x32_bf16 a[224:227], v[76:79], v[112:115], a[224:227]
    v_mfma_f32_16x16x32_bf16 a[228:231], v[76:79], v[116:119], a[228:231]
    v_mfma_f32_16x16x32_bf16 a[232:235], v[76:79], v[120:123], a[232:235]
    v_mfma_f32_16x16x32_bf16 a[236:239], v[76:79], v[124:127], a[236:239]
    v_mfma_f32_16x16x32_bf16 a[240:243], v[76:79], v[128:131], a[240:243]
    v_mfma_f32_16x16x32_bf16 a[244:247], v[76:79], v[132:135], a[244:247]
    v_mfma_f32_16x16x32_bf16 a[248:251], v[76:79], v[136:139], a[248:251]
    ds_read_b128 v[76:79], v7 offset:28672
    v_mfma_f32_16x16x32_bf16 a[252:255], v[80:83], v[112:115], a[252:255]
    v_mfma_f32_16x16x32_bf16 v[20:23], v[80:83], v[116:119], v[20:23]
    v_mfma_f32_16x16x32_bf16 v[24:27], v[80:83], v[120:123], v[24:27]
    v_mfma_f32_16x16x32_bf16 v[28:31], v[80:83], v[124:127], v[28:31]
    v_mfma_f32_16x16x32_bf16 v[32:35], v[80:83], v[128:131], v[32:35]
    v_mfma_f32_16x16x32_bf16 v[36:39], v[80:83], v[132:135], v[36:39]
    v_mfma_f32_16x16x32_bf16 v[40:43], v[80:83], v[136:139], v[40:43]
    ds_read_b128 v[80:83], v7 offset:29696
    s_waitcnt vmcnt(34) lgkmcnt(7)
    v_mfma_f32_16x16x32_bf16 a[0:3], v[44:47], v[140:143], a[0:3]
    s_mov_b32 s22, s25
    v_mfma_f32_16x16x32_bf16 a[4:7], v[44:47], v[144:147], a[4:7]
    buffer_load_dwordx4 v[112:115], v6, s[4:7], s22 offen
    v_mfma_f32_16x16x32_bf16 a[8:11], v[44:47], v[148:151], a[8:11]
    s_add_u32 s22, s22, 4096
    v_mfma_f32_16x16x32_bf16 a[12:15], v[44:47], v[152:155], a[12:15]
    buffer_load_dwordx4 v[116:119], v6, s[4:7], s22 offen
    v_mfma_f32_16x16x32_bf16 a[16:19], v[44:47], v[156:159], a[16:19]
    s_add_u32 s22, s22, 4096
    v_mfma_f32_16x16x32_bf16 a[20:23], v[44:47], v[160:163], a[20:23]
    buffer_load_dwordx4 v[120:123], v6, s[4:7], s22 offen
    v_mfma_f32_16x16x32_bf16 a[24:27], v[44:47], v[164:167], a[24:27]
    ds_read_b128 v[44:47], v7 offset:30720
    v_mfma_f32_16x16x32_bf16 a[28:31], v[48:51], v[140:143], a[28:31]
    s_add_u32 s22, s22, 4096
    v_mfma_f32_16x16x32_bf16 a[32:35], v[48:51], v[144:147], a[32:35]
    buffer_load_dwordx4 v[124:127], v6, s[4:7], s22 offen
    v_mfma_f32_16x16x32_bf16 a[36:39], v[48:51], v[148:151], a[36:39]
    s_add_u32 s22, s22, 4096
    v_mfma_f32_16x16x32_bf16 a[40:43], v[48:51], v[152:155], a[40:43]
    buffer_load_dwordx4 v[128:131], v6, s[4:7], s22 offen
    v_mfma_f32_16x16x32_bf16 a[44:47], v[48:51], v[156:159], a[44:47]
    s_add_u32 s22, s22, 4096
    v_mfma_f32_16x16x32_bf16 a[48:51], v[48:51], v[160:163], a[48:51]
    buffer_load_dwordx4 v[132:135], v6, s[4:7], s22 offen
    v_mfma_f32_16x16x32_bf16 a[52:55], v[48:51], v[164:167], a[52:55]
    ds_read_b128 v[48:51], v7 offset:31744
    s_waitcnt lgkmcnt(2)
    v_mfma_f32_16x16x32_bf16 a[56:59], v[52:55], v[140:143], a[56:59]
    s_add_u32 s22, s22, 4096
    v_mfma_f32_16x16x32_bf16 a[60:63], v[52:55], v[144:147], a[60:63]
    buffer_load_dwordx4 v[136:139], v6, s[4:7], s22 offen
    v_mfma_f32_16x16x32_bf16 a[64:67], v[52:55], v[148:151], a[64:67]
    s_add_u32 s25, s25, 57344
    v_mfma_f32_16x16x32_bf16 a[68:71], v[52:55], v[152:155], a[68:71]
    s_add_u32 m0, s27, 20480
    v_mfma_f32_16x16x32_bf16 a[72:75], v[52:55], v[156:159], a[72:75]
    s_mov_b32 s23, s26
    v_mfma_f32_16x16x32_bf16 a[76:79], v[52:55], v[160:163], a[76:79]
    buffer_load_dwordx4 v6, s[8:11], s23 offen offset:0 lds
    v_mfma_f32_16x16x32_bf16 a[80:83], v[52:55], v[164:167], a[80:83]
    ds_read_b128 v[52:55], v7 offset:32768
    v_mfma_f32_16x16x32_bf16 a[84:87], v[56:59], v[140:143], a[84:87]
    buffer_load_dwordx4 v6, s[8:11], s23 offen offset:1024 lds
    v_mfma_f32_16x16x32_bf16 a[88:91], v[56:59], v[144:147], a[88:91]
    buffer_load_dwordx4 v6, s[8:11], s23 offen offset:2048 lds
    v_mfma_f32_16x16x32_bf16 a[92:95], v[56:59], v[148:151], a[92:95]
    buffer_load_dwordx4 v6, s[8:11], s23 offen offset:3072 lds
    v_mfma_f32_16x16x32_bf16 a[96:99], v[56:59], v[152:155], a[96:99]
    s_add_u32 m0, s27, 24576
    v_mfma_f32_16x16x32_bf16 a[100:103], v[56:59], v[156:159], a[100:103]
    s_add_u32 s23, s23, 4096
    v_mfma_f32_16x16x32_bf16 a[104:107], v[56:59], v[160:163], a[104:107]
    buffer_load_dwordx4 v6, s[8:11], s23 offen offset:0 lds
    v_mfma_f32_16x16x32_bf16 a[108:111], v[56:59], v[164:167], a[108:111]
    ds_read_b128 v[56:59], v7 offset:33792
    v_mfma_f32_16x16x32_bf16 a[112:115], v[60:63], v[140:143], a[112:115]
    buffer_load_dwordx4 v6, s[8:11], s23 offen offset:1024 lds
    v_mfma_f32_16x16x32_bf16 a[116:119], v[60:63], v[144:147], a[116:119]
    buffer_load_dwordx4 v6, s[8:11], s23 offen offset:2048 lds
    v_mfma_f32_16x16x32_bf16 a[120:123], v[60:63], v[148:151], a[120:123]
    buffer_load_dwordx4 v6, s[8:11], s23 offen offset:3072 lds
    v_mfma_f32_16x16x32_bf16 a[124:127], v[60:63], v[152:155], a[124:127]
    s_add_u32 m0, s27, 28672
    v_mfma_f32_16x16x32_bf16 a[128:131], v[60:63], v[156:159], a[128:131]
    s_add_u32 s23, s23, 4096
    v_mfma_f32_16x16x32_bf16 a[132:135], v[60:63], v[160:163], a[132:135]
    buffer_load_dwordx4 v6, s[8:11], s23 offen offset:0 lds
    v_mfma_f32_16x16x32_bf16 a[136:139], v[60:63], v[164:167], a[136:139]
    ds_read_b128 v[60:63], v7 offset:34816
    v_mfma_f32_16x16x32_bf16 a[140:143], v[64:67], v[140:143], a[140:143]
    buffer_load_dwordx4 v6, s[8:11], s23 offen offset:1024 lds
    v_mfma_f32_16x16x32_bf16 a[144:147], v[64:67], v[144:147], a[144:147]
    s_add_u32 s26, s26, 163840
    v_mfma_f32_16x16x32_bf16 a[148:151], v[64:67], v[148:151], a[148:151]
    v_mfma_f32_16x16x32_bf16 a[152:155], v[64:67], v[152:155], a[152:155]
    v_mfma_f32_16x16x32_bf16 a[156:159], v[64:67], v[156:159], a[156:159]
    v_mfma_f32_16x16x32_bf16 a[160:163], v[64:67], v[160:163], a[160:163]
    v_mfma_f32_16x16x32_bf16 a[164:167], v[64:67], v[164:167], a[164:167]
    ds_read_b128 v[64:67], v7 offset:35840
    v_mfma_f32_16x16x32_bf16 a[168:171], v[68:71], v[140:143], a[168:171]
    v_mfma_f32_16x16x32_bf16 a[172:175], v[68:71], v[144:147], a[172:175]
    v_mfma_f32_16x16x32_bf16 a[176:179], v[68:71], v[148:151], a[176:179]
    v_mfma_f32_16x16x32_bf16 a[180:183], v[68:71], v[152:155], a[180:183]
    v_mfma_f32_16x16x32_bf16 a[184:187], v[68:71], v[156:159], a[184:187]
    v_mfma_f32_16x16x32_bf16 a[188:191], v[68:71], v[160:163], a[188:191]
    v_mfma_f32_16x16x32_bf16 a[192:195], v[68:71], v[164:167], a[192:195]
    ds_read_b128 v[68:71], v7 offset:36864
    v_mfma_f32_16x16x32_bf16 a[196:199], v[72:75], v[140:143], a[196:199]
    v_mfma_f32_16x16x32_bf16 a[200:203], v[72:75], v[144:147], a[200:203]
    v_mfma_f32_16x16x32_bf16 a[204:207], v[72:75], v[148:151], a[204:207]
    v_mfma_f32_16x16x32_bf16 a[208:211], v[72:75], v[152:155], a[208:211]
    v_mfma_f32_16x16x32_bf16 a[212:215], v[72:75], v[156:159], a[212:215]
    v_mfma_f32_16x16x32_bf16 a[216:219], v[72:75], v[160:163], a[216:219]
    v_mfma_f32_16x16x32_bf16 a[220:223], v[72:75], v[164:167], a[220:223]
    ds_read_b128 v[72:75], v7 offset:37888
    v_mfma_f32_16x16x32_bf16 a[224:227], v[76:79], v[140:143], a[224:227]
    v_mfma_f32_16x16x32_bf16 a[228:231], v[76:79], v[144:147], a[228:231]
    v_mfma_f32_16x16x32_bf16 a[232:235], v[76:79], v[148:151], a[232:235]
    v_mfma_f32_16x16x32_bf16 a[236:239], v[76:79], v[152:155], a[236:239]
    v_mfma_f32_16x16x32_bf16 a[240:243], v[76:79], v[156:159], a[240:243]
    v_mfma_f32_16x16x32_bf16 a[244:247], v[76:79], v[160:163], a[244:247]
    v_mfma_f32_16x16x32_bf16 a[248:251], v[76:79], v[164:167], a[248:251]
    ds_read_b128 v[76:79], v7 offset:38912
    v_mfma_f32_16x16x32_bf16 a[252:255], v[80:83], v[140:143], a[252:255]
    v_mfma_f32_16x16x32_bf16 v[20:23], v[80:83], v[144:147], v[20:23]
    v_mfma_f32_16x16x32_bf16 v[24:27], v[80:83], v[148:151], v[24:27]
    v_mfma_f32_16x16x32_bf16 v[28:31], v[80:83], v[152:155], v[28:31]
    v_mfma_f32_16x16x32_bf16 v[32:35], v[80:83], v[156:159], v[32:35]
    v_mfma_f32_16x16x32_bf16 v[36:39], v[80:83], v[160:163], v[36:39]
    v_mfma_f32_16x16x32_bf16 v[40:43], v[80:83], v[164:167], v[40:43]
    ds_read_b128 v[80:83], v7 offset:39936
    s_waitcnt vmcnt(34) lgkmcnt(7)
    v_mfma_f32_16x16x32_bf16 a[0:3], v[44:47], v[168:171], a[0:3]
    s_mov_b32 s22, s25
    v_mfma_f32_16x16x32_bf16 a[4:7], v[44:47], v[172:175], a[4:7]
    buffer_load_dwordx4 v[140:143], v6, s[4:7], s22 offen
    v_mfma_f32_16x16x32_bf16 a[8:11], v[44:47], v[176:179], a[8:11]
    s_add_u32 s22, s22, 4096
    v_mfma_f32_16x16x32_bf16 a[12:15], v[44:47], v[180:183], a[12:15]
    buffer_load_dwordx4 v[144:147], v6, s[4:7], s22 offen
    v_mfma_f32_16x16x32_bf16 a[16:19], v[44:47], v[184:187], a[16:19]
    s_add_u32 s22, s22, 4096
    v_mfma_f32_16x16x32_bf16 a[20:23], v[44:47], v[188:191], a[20:23]
    buffer_load_dwordx4 v[148:151], v6, s[4:7], s22 offen
    v_mfma_f32_16x16x32_bf16 a[24:27], v[44:47], v[192:195], a[24:27]
    ds_read_b128 v[44:47], v7 offset:0
    v_mfma_f32_16x16x32_bf16 a[28:31], v[48:51], v[168:171], a[28:31]
    s_add_u32 s22, s22, 4096
    v_mfma_f32_16x16x32_bf16 a[32:35], v[48:51], v[172:175], a[32:35]
    buffer_load_dwordx4 v[152:155], v6, s[4:7], s22 offen
    v_mfma_f32_16x16x32_bf16 a[36:39], v[48:51], v[176:179], a[36:39]
    s_add_u32 s22, s22, 4096
    v_mfma_f32_16x16x32_bf16 a[40:43], v[48:51], v[180:183], a[40:43]
    buffer_load_dwordx4 v[156:159], v6, s[4:7], s22 offen
    v_mfma_f32_16x16x32_bf16 a[44:47], v[48:51], v[184:187], a[44:47]
    s_add_u32 s22, s22, 4096
    v_mfma_f32_16x16x32_bf16 a[48:51], v[48:51], v[188:191], a[48:51]
    buffer_load_dwordx4 v[160:163], v6, s[4:7], s22 offen
    v_mfma_f32_16x16x32_bf16 a[52:55], v[48:51], v[192:195], a[52:55]
    ds_read_b128 v[48:51], v7 offset:1024
    s_waitcnt lgkmcnt(2)
    v_mfma_f32_16x16x32_bf16 a[56:59], v[52:55], v[168:171], a[56:59]
    s_add_u32 s22, s22, 4096
    v_mfma_f32_16x16x32_bf16 a[60:63], v[52:55], v[172:175], a[60:63]
    buffer_load_dwordx4 v[164:167], v6, s[4:7], s22 offen
    v_mfma_f32_16x16x32_bf16 a[64:67], v[52:55], v[176:179], a[64:67]
    s_add_u32 s25, s25, 57344
    v_mfma_f32_16x16x32_bf16 a[68:71], v[52:55], v[180:183], a[68:71]
    s_add_u32 m0, s27, 30720
    v_mfma_f32_16x16x32_bf16 a[72:75], v[52:55], v[184:187], a[72:75]
    s_mov_b32 s23, s26
    v_mfma_f32_16x16x32_bf16 a[76:79], v[52:55], v[188:191], a[76:79]
    buffer_load_dwordx4 v6, s[8:11], s23 offen offset:0 lds
    v_mfma_f32_16x16x32_bf16 a[80:83], v[52:55], v[192:195], a[80:83]
    ds_read_b128 v[52:55], v7 offset:2048
    v_mfma_f32_16x16x32_bf16 a[84:87], v[56:59], v[168:171], a[84:87]
    buffer_load_dwordx4 v6, s[8:11], s23 offen offset:1024 lds
    v_mfma_f32_16x16x32_bf16 a[88:91], v[56:59], v[172:175], a[88:91]
    buffer_load_dwordx4 v6, s[8:11], s23 offen offset:2048 lds
    v_mfma_f32_16x16x32_bf16 a[92:95], v[56:59], v[176:179], a[92:95]
    buffer_load_dwordx4 v6, s[8:11], s23 offen offset:3072 lds
    v_mfma_f32_16x16x32_bf16 a[96:99], v[56:59], v[180:183], a[96:99]
    s_add_u32 m0, s27, 34816
    v_mfma_f32_16x16x32_bf16 a[100:103], v[56:59], v[184:187], a[100:103]
    s_add_u32 s23, s23, 4096
    v_mfma_f32_16x16x32_bf16 a[104:107], v[56:59], v[188:191], a[104:107]
    buffer_load_dwordx4 v6, s[8:11], s23 offen offset:0 lds
    v_mfma_f32_16x16x32_bf16 a[108:111], v[56:59], v[192:195], a[108:111]
    ds_read_b128 v[56:59], v7 offset:3072
    v_mfma_f32_16x16x32_bf16 a[112:115], v[60:63], v[168:171], a[112:115]
    buffer_load_dwordx4 v6, s[8:11], s23 offen offset:1024 lds
    v_mfma_f32_16x16x32_bf16 a[116:119], v[60:63], v[172:175], a[116:119]
    buffer_load_dwordx4 v6, s[8:11], s23 offen offset:2048 lds
    v_mfma_f32_16x16x32_bf16 a[120:123], v[60:63], v[176:179], a[120:123]
    buffer_load_dwordx4 v6, s[8:11], s23 offen offset:3072 lds
    v_mfma_f32_16x16x32_bf16 a[124:127], v[60:63], v[180:183], a[124:127]
    s_add_u32 m0, s27, 38912
    v_mfma_f32_16x16x32_bf16 a[128:131], v[60:63], v[184:187], a[128:131]
    s_add_u32 s23, s23, 4096
    v_mfma_f32_16x16x32_bf16 a[132:135], v[60:63], v[188:191], a[132:135]
    buffer_load_dwordx4 v6, s[8:11], s23 offen offset:0 lds
    v_mfma_f32_16x16x32_bf16 a[136:139], v[60:63], v[192:195], a[136:139]
    ds_read_b128 v[60:63], v7 offset:4096
    v_mfma_f32_16x16x32_bf16 a[140:143], v[64:67], v[168:171], a[140:143]
    buffer_load_dwordx4 v6, s[8:11], s23 offen offset:1024 lds
    v_mfma_f32_16x16x32_bf16 a[144:147], v[64:67], v[172:175], a[144:147]
    s_add_u32 s26, s26, 163840
    v_mfma_f32_16x16x32_bf16 a[148:151], v[64:67], v[176:179], a[148:151]
    v_mfma_f32_16x16x32_bf16 a[152:155], v[64:67], v[180:183], a[152:155]
    v_mfma_f32_16x16x32_bf16 a[156:159], v[64:67], v[184:187], a[156:159]
    v_mfma_f32_16x16x32_bf16 a[160:163], v[64:67], v[188:191], a[160:163]
    v_mfma_f32_16x16x32_bf16 a[164:167], v[64:67], v[192:195], a[164:167]
    ds_read_b128 v[64:67], v7 offset:5120
    v_mfma_f32_16x16x32_bf16 a[168:171], v[68:71], v[168:171], a[168:171]
    v_mfma_f32_16x16x32_bf16 a[172:175], v[68:71], v[172:175], a[172:175]
    v_mfma_f32_16x16x32_bf16 a[176:179], v[68:71], v[176:179], a[176:179]
    v_mfma_f32_16x16x32_bf16 a[180:183], v[68:71], v[180:183], a[180:183]
    v_mfma_f32_16x16x32_bf16 a[184:187], v[68:71], v[184:187], a[184:187]
    v_mfma_f32_16x16x32_bf16 a[188:191], v[68:71], v[188:191], a[188:191]
    v_mfma_f32_16x16x32_bf16 a[192:195], v[68:71], v[192:195], a[192:195]
    ds_read_b128 v[68:71], v7 offset:6144
    v_mfma_f32_16x16x32_bf16 a[196:199], v[72:75], v[168:171], a[196:199]
    v_mfma_f32_16x16x32_bf16 a[200:203], v[72:75], v[172:175], a[200:203]
    v_mfma_f32_16x16x32_bf16 a[204:207], v[72:75], v[176:179], a[204:207]
    v_mfma_f32_16x16x32_bf16 a[208:211], v[72:75], v[180:183], a[208:211]
    v_mfma_f32_16x16x32_bf16 a[212:215], v[72:75], v[184:187], a[212:215]
    v_mfma_f32_16x16x32_bf16 a[216:219], v[72:75], v[188:191], a[216:219]
    v_mfma_f32_16x16x32_bf16 a[220:223], v[72:75], v[192:195], a[220:223]
    ds_read_b128 v[72:75], v7 offset:7168
    v_mfma_f32_16x16x32_bf16 a[224:227], v[76:79], v[168:171], a[224:227]
    v_mfma_f32_16x16x32_bf16 a[228:231], v[76:79], v[172:175], a[228:231]
    v_mfma_f32_16x16x32_bf16 a[232:235], v[76:79], v[176:179], a[232:235]
    v_mfma_f32_16x16x32_bf16 a[236:239], v[76:79], v[180:183], a[236:239]
    v_mfma_f32_16x16x32_bf16 a[240:243], v[76:79], v[184:187], a[240:243]
    v_mfma_f32_16x16x32_bf16 a[244:247], v[76:79], v[188:191], a[244:247]
    v_mfma_f32_16x16x32_bf16 a[248:251], v[76:79], v[192:195], a[248:251]
    ds_read_b128 v[76:79], v7 offset:8192
    v_mfma_f32_16x16x32_bf16 a[252:255], v[80:83], v[168:171], a[252:255]
    v_mfma_f32_16x16x32_bf16 v[20:23], v[80:83], v[172:175], v[20:23]
    v_mfma_f32_16x16x32_bf16 v[24:27], v[80:83], v[176:179], v[24:27]
    v_mfma_f32_16x16x32_bf16 v[28:31], v[80:83], v[180:183], v[28:31]
    v_mfma_f32_16x16x32_bf16 v[32:35], v[80:83], v[184:187], v[32:35]
    v_mfma_f32_16x16x32_bf16 v[36:39], v[80:83], v[188:191], v[36:39]
    v_mfma_f32_16x16x32_bf16 v[40:43], v[80:83], v[192:195], v[40:43]
    ds_read_b128 v[80:83], v7 offset:9216
    s_add_u32 s21, s21, 1
    s_cmp_lt_u32 s21, 6
    s_cbranch_scc1 L_op_loop
    s_waitcnt vmcnt(34) lgkmcnt(7)
    v_mfma_f32_16x16x32_bf16 a[0:3], v[44:47], v[84:87], a[0:3]
    s_mov_b32 s22, s25
    v_mfma_f32_16x16x32_bf16 a[4:7], v[44:47], v[88:91], a[4:7]
    buffer_load_dwordx4 v[168:171], v6, s[4:7], s22 offen
    v_mfma_f32_16x16x32_bf16 a[8:11], v[44:47], v[92:95], a[8:11]
    s_add_u32 s22, s22, 4096
    v_mfma_f32_16x16x32_bf16 a[12:15], v[44:47], v[96:99], a[12:15]
    buffer_load_dwordx4 v[172:175], v6, s[4:7], s22 offen
    v_mfma_f32_16x16x32_bf16 a[16:19], v[44:47], v[100:103], a[16:19]
    s_add_u32 s22, s22, 4096
    v_mfma_f32_16x16x32_bf16 a[20:23], v[44:47], v[104:107], a[20:23]
    buffer_load_dwordx4 v[176:179], v6, s[4:7], s22 offen
    v_mfma_f32_16x16x32_bf16 a[24:27], v[44:47], v[108:111], a[24:27]
    ds_read_b128 v[44:47], v7 offset:10240
    v_mfma_f32_16x16x32_bf16 a[28:31], v[48:51], v[84:87], a[28:31]
    s_add_u32 s22, s22, 4096
    v_mfma_f32_16x16x32_bf16 a[32:35], v[48:51], v[88:91], a[32:35]
    buffer_load_dwordx4 v[180:183], v6, s[4:7], s22 offen
    v_mfma_f32_16x16x32_bf16 a[36:39], v[48:51], v[92:95], a[36:39]
    s_add_u32 s22, s22, 4096
    v_mfma_f32_16x16x32_bf16 a[40:43], v[48:51], v[96:99], a[40:43]
    buffer_load_dwordx4 v[184:187], v6, s[4:7], s22 offen
    v_mfma_f32_16x16x32_bf16 a[44:47], v[48:51], v[100:103], a[44:47]
    s_add_u32 s22, s22, 4096
    v_mfma_f32_16x16x32_bf16 a[48:51], v[48:51], v[104:107], a[48:51]
    buffer_load_dwordx4 v[188:191], v6, s[4:7], s22 offen
    v_mfma_f32_16x16x32_bf16 a[52:55], v[48:51], v[108:111], a[52:55]
    ds_read_b128 v[48:51], v7 offset:11264
    s_waitcnt lgkmcnt(2)
    v_mfma_f32_16x16x32_bf16 a[56:59], v[52:55], v[84:87], a[56:59]
    s_add_u32 s22, s22, 4096
    v_mfma_f32_16x16x32_bf16 a[60:63], v[52:55], v[88:91], a[60:63]
    buffer_load_dwordx4 v[192:195], v6, s[4:7], s22 offen
    v_mfma_f32_16x16x32_bf16 a[64:67], v[52:55], v[92:95], a[64:67]
    s_add_u32 s25, s25, 57344
    v_mfma_f32_16x16x32_bf16 a[68:71], v[52:55], v[96:99], a[68:71]
    v_mfma_f32_16x16x32_bf16 a[72:75], v[52:55], v[100:103], a[72:75]
    v_mfma_f32_16x16x32_bf16 a[76:79], v[52:55], v[104:107], a[76:79]
    v_mfma_f32_16x16x32_bf16 a[80:83], v[52:55], v[108:111], a[80:83]
    ds_read_b128 v[52:55], v7 offset:12288
    v_mfma_f32_16x16x32_bf16 a[84:87], v[56:59], v[84:87], a[84:87]
    v_mfma_f32_16x16x32_bf16 a[88:91], v[56:59], v[88:91], a[88:91]
    v_mfma_f32_16x16x32_bf16 a[92:95], v[56:59], v[92:95], a[92:95]
    v_mfma_f32_16x16x32_bf16 a[96:99], v[56:59], v[96:99], a[96:99]
    v_mfma_f32_16x16x32_bf16 a[100:103], v[56:59], v[100:103], a[100:103]
    v_mfma_f32_16x16x32_bf16 a[104:107], v[56:59], v[104:107], a[104:107]
    v_mfma_f32_16x16x32_bf16 a[108:111], v[56:59], v[108:111], a[108:111]
    ds_read_b128 v[56:59], v7 offset:13312
    v_mfma_f32_16x16x32_bf16 a[112:115], v[60:63], v[84:87], a[112:115]
    v_mfma_f32_16x16x32_bf16 a[116:119], v[60:63], v[88:91], a[116:119]
    v_mfma_f32_16x16x32_bf16 a[120:123], v[60:63], v[92:95], a[120:123]
    v_mfma_f32_16x16x32_bf16 a[124:127], v[60:63], v[96:99], a[124:127]
    v_mfma_f32_16x16x32_bf16 a[128:131], v[60:63], v[100:103], a[128:131]
    v_mfma_f32_16x16x32_bf16 a[132:135], v[60:63], v[104:107], a[132:135]
    v_mfma_f32_16x16x32_bf16 a[136:139], v[60:63], v[108:111], a[136:139]
    ds_read_b128 v[60:63], v7 offset:14336
    v_mfma_f32_16x16x32_bf16 a[140:143], v[64:67], v[84:87], a[140:143]
    v_mfma_f32_16x16x32_bf16 a[144:147], v[64:67], v[88:91], a[144:147]
    v_mfma_f32_16x16x32_bf16 a[148:151], v[64:67], v[92:95], a[148:151]
    v_mfma_f32_16x16x32_bf16 a[152:155], v[64:67], v[96:99], a[152:155]
    v_mfma_f32_16x16x32_bf16 a[156:159], v[64:67], v[100:103], a[156:159]
    v_mfma_f32_16x16x32_bf16 a[160:163], v[64:67], v[104:107], a[160:163]
    v_mfma_f32_16x16x32_bf16 a[164:167], v[64:67], v[108:111], a[164:167]
    ds_read_b128 v[64:67], v7 offset:15360
    v_mfma_f32_16x16x32_bf16 a[168:171], v[68:71], v[84:87], a[168:171]
    v_mfma_f32_16x16x32_bf16 a[172:175], v[68:71], v[88:91], a[172:175]
    v_mfma_f32_16x16x32_bf16 a[176:179], v[68:71], v[92:95], a[176:179]
    v_mfma_f32_16x16x32_bf16 a[180:183], v[68:71], v[96:99], a[180:183]
    v_mfma_f32_16x16x32_bf16 a[184:187], v[68:71], v[100:103], a[184:187]
    v_mfma_f32_16x16x32_bf16 a[188:191], v[68:71], v[104:107], a[188:191]
    v_mfma_f32_16x16x32_bf16 a[192:195], v[68:71], v[108:111], a[192:195]
    ds_read_b128 v[68:71], v7 offset:16384
    v_mfma_f32_16x16x32_bf16 a[196:199], v[72:75], v[84:87], a[196:199]
    v_mfma_f32_16x16x32_bf16 a[200:203], v[72:75], v[88:91], a[200:203]
    v_mfma_f32_16x16x32_bf16 a[204:207], v[72:75], v[92:95], a[204:207]
    v_mfma_f32_16x16x32_bf16 a[208:211], v[72:75], v[96:99], a[208:211]
    v_mfma_f32_16x16x32_bf16 a[212:215], v[72:75], v[100:103], a[212:215]
    v_mfma_f32_16x16x32_bf16 a[216:219], v[72:75], v[104:107], a[216:219]
    v_mfma_f32_16x16x32_bf16 a[220:223], v[72:75], v[108:111], a[220:223]
    ds_read_b128 v[72:75], v7 offset:17408
    v_mfma_f32_16x16x32_bf16 a[224:227], v[76:79], v[84:87], a[224:227]
    v_mfma_f32_16x16x32_bf16 a[228:231], v[76:79], v[88:91], a[228:231]
    v_mfma_f32_16x16x32_bf16 a[232:235], v[76:79], v[92:95], a[232:235]
    v_mfma_f32_16x16x32_bf16 a[236:239], v[76:79], v[96:99], a[236:239]
    v_mfma_f32_16x16x32_bf16 a[240:243], v[76:79], v[100:103], a[240:243]
    v_mfma_f32_16x16x32_bf16 a[244:247], v[76:79], v[104:107], a[244:247]
    v_mfma_f32_16x16x32_bf16 a[248:251], v[76:79], v[108:111], a[248:251]
    ds_read_b128 v[76:79], v7 offset:18432
    v_mfma_f32_16x16x32_bf16 a[252:255], v[80:83], v[84:87], a[252:255]
    v_mfma_f32_16x16x32_bf16 v[20:23], v[80:83], v[88:91], v[20:23]
    v_mfma_f32_16x16x32_bf16 v[24:27], v[80:83], v[92:95], v[24:27]
    v_mfma_f32_16x16x32_bf16 v[28:31], v[80:83], v[96:99], v[28:31]
    v_mfma_f32_16x16x32_bf16 v[32:35], v[80:83], v[100:103], v[32:35]
    v_mfma_f32_16x16x32_bf16 v[36:39], v[80:83], v[104:107], v[36:39]
    v_mfma_f32_16x16x32_bf16 v[40:43], v[80:83], v[108:111], v[40:43]
    ds_read_b128 v[80:83], v7 offset:19456
    s_waitcnt vmcnt(24) lgkmcnt(7)
    v_mfma_f32_16x16x32_bf16 a[0:3], v[44:47], v[112:115], a[0:3]
    v_mfma_f32_16x16x32_bf16 a[4:7], v[44:47], v[116:119], a[4:7]
    v_mfma_f32_16x16x32_bf16 a[8:11], v[44:47], v[120:123], a[8:11]
    v_mfma_f32_16x16x32_bf16 a[12:15], v[44:47], v[124:127], a[12:15]
    v_mfma_f32_16x16x32_bf16 a[16:19], v[44:47], v[128:131], a[16:19]
    v_mfma_f32_16x16x32_bf16 a[20:23], v[44:47], v[132:135], a[20:23]
    v_mfma_f32_16x16x32_bf16 a[24:27], v[44:47], v[136:139], a[24:27]
    ds_read_b128 v[44:47], v7 offset:20480
    v_mfma_f32_16x16x32_bf16 a[28:31], v[48:51], v[112:115], a[28:31]
    v_mfma_f32_16x16x32_bf16 a[32:35], v[48:51], v[116:119], a[32:35]
    v_mfma_f32_16x16x32_bf16 a[36:39], v[48:51], v[120:123], a[36:39]
    v_mfma_f32_16x16x32_bf16 a[40:43], v[48:51], v[124:127], a[40:43]
    v_mfma_f32_16x16x32_bf16 a[44:47], v[48:51], v[128:131], a[44:47]
    v_mfma_f32_16x16x32_bf16 a[48:51], v[48:51], v[132:135], a[48:51]
    v_mfma_f32_16x16x32_bf16 a[52:55], v[48:51], v[136:139], a[52:55]
    ds_read_b128 v[48:51], v7 offset:21504
    s_waitcnt lgkmcnt(2)
    v_mfma_f32_16x16x32_bf16 a[56:59], v[52:55], v[112:115], a[56:59]
    v_mfma_f32_16x16x32_bf16 a[60:63], v[52:55], v[116:119], a[60:63]
    v_mfma_f32_16x16x32_bf16 a[64:67], v[52:55], v[120:123], a[64:67]
    v_mfma_f32_16x16x32_bf16 a[68:71], v[52:55], v[124:127], a[68:71]
    v_mfma_f32_16x16x32_bf16 a[72:75], v[52:55], v[128:131], a[72:75]
    v_mfma_f32_16x16x32_bf16 a[76:79], v[52:55], v[132:135], a[76:79]
    v_mfma_f32_16x16x32_bf16 a[80:83], v[52:55], v[136:139], a[80:83]
    ds_read_b128 v[52:55], v7 offset:22528
    v_mfma_f32_16x16x32_bf16 a[84:87], v[56:59], v[112:115], a[84:87]
    v_mfma_f32_16x16x32_bf16 a[88:91], v[56:59], v[116:119], a[88:91]
    v_mfma_f32_16x16x32_bf16 a[92:95], v[56:59], v[120:123], a[92:95]
    v_mfma_f32_16x16x32_bf16 a[96:99], v[56:59], v[124:127], a[96:99]
    v_mfma_f32_16x16x32_bf16 a[100:103], v[56:59], v[128:131], a[100:103]
    v_mfma_f32_16x16x32_bf16 a[104:107], v[56:59], v[132:135], a[104:107]
    v_mfma_f32_16x16x32_bf16 a[108:111], v[56:59], v[136:139], a[108:111]
    ds_read_b128 v[56:59], v7 offset:23552
    v_mfma_f32_16x16x32_bf16 a[112:115], v[60:63], v[112:115], a[112:115]
    v_mfma_f32_16x16x32_bf16 a[116:119], v[60:63], v[116:119], a[116:119]
    v_mfma_f32_16x16x32_bf16 a[120:123], v[60:63], v[120:123], a[120:123]
    v_mfma_f32_16x16x32_bf16 a[124:127], v[60:63], v[124:127], a[124:127]
    v_mfma_f32_16x16x32_bf16 a[128:131], v[60:63], v[128:131], a[128:131]
    v_mfma_f32_16x16x32_bf16 a[132:135], v[60:63], v[132:135], a[132:135]
    v_mfma_f32_16x16x32_bf16 a[136:139], v[60:63], v[136:139], a[136:139]
    ds_read_b128 v[60:63], v7 offset:24576
    v_mfma_f32_16x16x32_bf16 a[140:143], v[64:67], v[112:115], a[140:143]
    v_mfma_f32_16x16x32_bf16 a[144:147], v[64:67], v[116:119], a[144:147]
    v_mfma_f32_16x16x32_bf16 a[148:151], v[64:67], v[120:123], a[148:151]
    v_mfma_f32_16x16x32_bf16 a[152:155], v[64:67], v[124:127], a[152:155]
    v_mfma_f32_16x16x32_bf16 a[156:159], v[64:67], v[128:131], a[156:159]
    v_mfma_f32_16x16x32_bf16 a[160:163], v[64:67], v[132:135], a[160:163]
    v_mfma_f32_16x16x32_bf16 a[164:167], v[64:67], v[136:139], a[164:167]
    ds_read_b128 v[64:67], v7 offset:25600
    v_mfma_f32_16x16x32_bf16 a[168:171], v[68:71], v[112:115], a[168:171]
    v_mfma_f32_16x16x32_bf16 a[172:175], v[68:71], v[116:119], a[172:175]
    v_mfma_f32_16x16x32_bf16 a[176:179], v[68:71], v[120:123], a[176:179]
    v_mfma_f32_16x16x32_bf16 a[180:183], v[68:71], v[124:127], a[180:183]
    v_mfma_f32_16x16x32_bf16 a[184:187], v[68:71], v[128:131], a[184:187]
    v_mfma_f32_16x16x32_bf16 a[188:191], v[68:71], v[132:135], a[188:191]
    v_mfma_f32_16x16x32_bf16 a[192:195], v[68:71], v[136:139], a[192:195]
    ds_read_b128 v[68:71], v7 offset:26624
    v_mfma_f32_16x16x32_bf16 a[196:199], v[72:75], v[112:115], a[196:199]
    v_mfma_f32_16x16x32_bf16 a[200:203], v[72:75], v[116:119], a[200:203]
    v_mfma_f32_16x16x32_bf16 a[204:207], v[72:75], v[120:123], a[204:207]
    v_mfma_f32_16x16x32_bf16 a[208:211], v[72:75], v[124:127], a[208:211]
    v_mfma_f32_16x16x32_bf16 a[212:215], v[72:75], v[128:131], a[212:215]
    v_mfma_f32_16x16x32_bf16 a[216:219], v[72:75], v[132:135], a[216:219]
    v_mfma_f32_16x16x32_bf16 a[220:223], v[72:75], v[136:139], a[220:223]
    ds_read_b128 v[72:75], v7 offset:27648
    v_mfma_f32_16x16x32_bf16 a[224:227], v[76:79], v[112:115], a[224:227]
    v_mfma_f32_16x16x32_bf16 a[228:231], v[76:79], v[116:119], a[228:231]
    v_mfma_f32_16x16x32_bf16 a[232:235], v[76:79], v[120:123], a[232:235]
    v_mfma_f32_16x16x32_bf16 a[236:239], v[76:79], v[124:127], a[236:239]
    v_mfma_f32_16x16x32_bf16 a[240:243], v[76:79], v[128:131], a[240:243]
    v_mfma_f32_16x16x32_bf16 a[244:247], v[76:79], v[132:135], a[244:247]
    v_mfma_f32_16x16x32_bf16 a[248:251], v[76:79], v[136:139], a[248:251]
    ds_read_b128 v[76:79], v7 offset:28672
    v_mfma_f32_16x16x32_bf16 a[252:255], v[80:83], v[112:115], a[252:255]
    v_mfma_f32_16x16x32_bf16 v[20:23], v[80:83], v[116:119], v[20:23]
    v_mfma_f32_16x16x32_bf16 v[24:27], v[80:83], v[120:123], v[24:27]
    v_mfma_f32_16x16x32_bf16 v[28:31], v[80:83], v[124:127], v[28:31]
    v_mfma_f32_16x16x32_bf16 v[32:35], v[80:83], v[128:131], v[32:35]
    v_mfma_f32_16x16x32_bf16 v[36:39], v[80:83], v[132:135], v[36:39]
    v_mfma_f32_16x16x32_bf16 v[40:43], v[80:83], v[136:139], v[40:43]
    ds_read_b128 v[80:83], v7 offset:29696
    s_waitcnt vmcnt(7) lgkmcnt(7)
    v_mfma_f32_16x16x32_bf16 a[0:3], v[44:47], v[140:143], a[0:3]
    v_mfma_f32_16x16x32_bf16 a[4:7], v[44:47], v[144:147], a[4:7]
    v_mfma_f32_16x16x32_bf16 a[8:11], v[44:47], v[148:151], a[8:11]
    v_mfma_f32_16x16x32_bf16 a[12:15], v[44:47], v[152:155], a[12:15]
    v_mfma_f32_16x16x32_bf16 a[16:19], v[44:47], v[156:159], a[16:19]
    v_mfma_f32_16x16x32_bf16 a[20:23], v[44:47], v[160:163], a[20:23]
    v_mfma_f32_16x16x32_bf16 a[24:27], v[44:47], v[164:167], a[24:27]
    ds_read_b128 v[44:47], v7 offset:30720
    v_mfma_f32_16x16x32_bf16 a[28:31], v[48:51], v[140:143], a[28:31]
    v_mfma_f32_16x16x32_bf16 a[32:35], v[48:51], v[144:147], a[32:35]
    v_mfma_f32_16x16x32_bf16 a[36:39], v[48:51], v[148:151], a[36:39]
    v_mfma_f32_16x16x32_bf16 a[40:43], v[48:51], v[152:155], a[40:43]
    v_mfma_f32_16x16x32_bf16 a[44:47], v[48:51], v[156:159], a[44:47]
    v_mfma_f32_16x16x32_bf16 a[48:51], v[48:51], v[160:163], a[48:51]
    v_mfma_f32_16x16x32_bf16 a[52:55], v[48:51], v[164:167], a[52:55]
    ds_read_b128 v[48:51], v7 offset:31744
    s_waitcnt lgkmcnt(2)
    v_mfma_f32_16x16x32_bf16 a[56:59], v[52:55], v[140:143], a[56:59]
    v_mfma_f32_16x16x32_bf16 a[60:63], v[52:55], v[144:147], a[60:63]
    v_mfma_f32_16x16x32_bf16 a[64:67], v[52:55], v[148:151], a[64:67]
    v_mfma_f32_16x16x32_bf16 a[68:71], v[52:55], v[152:155], a[68:71]
    v_mfma_f32_16x16x32_bf16 a[72:75], v[52:55], v[156:159], a[72:75]
    v_mfma_f32_16x16x32_bf16 a[76:79], v[52:55], v[160:163], a[76:79]
    v_mfma_f32_16x16x32_bf16 a[80:83], v[52:55], v[164:167], a[80:83]
    ds_read_b128 v[52:55], v7 offset:32768
    v_mfma_f32_16x16x32_bf16 a[84:87], v[56:59], v[140:143], a[84:87]
    v_mfma_f32_16x16x32_bf16 a[88:91], v[56:59], v[144:147], a[88:91]
    v_mfma_f32_16x16x32_bf16 a[92:95], v[56:59], v[148:151], a[92:95]
    v_mfma_f32_16x16x32_bf16 a[96:99], v[56:59], v[152:155], a[96:99]
    v_mfma_f32_16x16x32_bf16 a[100:103], v[56:59], v[156:159], a[100:103]
    v_mfma_f32_16x16x32_bf16 a[104:107], v[56:59], v[160:163], a[104:107]
    v_mfma_f32_16x16x32_bf16 a[108:111], v[56:59], v[164:167], a[108:111]
    ds_read_b128 v[56:59], v7 offset:33792
    v_mfma_f32_16x16x32_bf16 a[112:115], v[60:63], v[140:143], a[112:115]
    v_mfma_f32_16x16x32_bf16 a[116:119], v[60:63], v[144:147], a[116:119]
    v_mfma_f32_16x16x32_bf16 a[120:123], v[60:63], v[148:151], a[120:123]
    v_mfma_f32_16x16x32_bf16 a[124:127], v[60:63], v[152:155], a[124:127]
    v_mfma_f32_16x16x32_bf16 a[128:131], v[60:63], v[156:159], a[128:131]
    v_mfma_f32_16x16x32_bf16 a[132:135], v[60:63], v[160:163], a[132:135]
    v_mfma_f32_16x16x32_bf16 a[136:139], v[60:63], v[164:167], a[136:139]
    ds_read_b128 v[60:63], v7 offset:34816
    v_mfma_f32_16x16x32_bf16 a[140:143], v[64:67], v[140:143], a[140:143]
    v_mfma_f32_16x16x32_bf16 a[144:147], v[64:67], v[144:147], a[144:147]
    v_mfma_f32_16x16x32_bf16 a[148:151], v[64:67], v[148:151], a[148:151]
    v_mfma_f32_16x16x32_bf16 a[152:155], v[64:67], v[152:155], a[152:155]
    v_mfma_f32_16x16x32_bf16 a[156:159], v[64:67], v[156:159], a[156:159]
    v_mfma_f32_16x16x32_bf16 a[160:163], v[64:67], v[160:163], a[160:163]
    v_mfma_f32_16x16x32_bf16 a[164:167], v[64:67], v[164:167], a[164:167]
    ds_read_b128 v[64:67], v7 offset:35840
    v_mfma_f32_16x16x32_bf16 a[168:171], v[68:71], v[140:143], a[168:171]
    v_mfma_f32_16x16x32_bf16 a[172:175], v[68:71], v[144:147], a[172:175]
    v_mfma_f32_16x16x32_bf16 a[176:179], v[68:71], v[148:151], a[176:179]
    v_mfma_f32_16x16x32_bf16 a[180:183], v[68:71], v[152:155], a[180:183]
    v_mfma_f32_16x16x32_bf16 a[184:187], v[68:71], v[156:159], a[184:187]
    v_mfma_f32_16x16x32_bf16 a[188:191], v[68:71], v[160:163], a[188:191]
    v_mfma_f32_16x16x32_bf16 a[192:195], v[68:71], v[164:167], a[192:195]
    ds_read_b128 v[68:71], v7 offset:36864
    v_mfma_f32_16x16x32_bf16 a[196:199], v[72:75], v[140:143], a[196:199]
    v_mfma_f32_16x16x32_bf16 a[200:203], v[72:75], v[144:147], a[200:203]
    v_mfma_f32_16x16x32_bf16 a[204:207], v[72:75], v[148:151], a[204:207]
    v_mfma_f32_16x16x32_bf16 a[208:211], v[72:75], v[152:155], a[208:211]
    v_mfma_f32_16x16x32_bf16 a[212:215], v[72:75], v[156:159], a[212:215]
    v_mfma_f32_16x16x32_bf16 a[216:219], v[72:75], v[160:163], a[216:219]
    v_mfma_f32_16x16x32_bf16 a[220:223], v[72:75], v[164:167], a[220:223]
    ds_read_b128 v[72:75], v7 offset:37888
    v_mfma_f32_16x16x32_bf16 a[224:227], v[76:79], v[140:143], a[224:227]
    v_mfma_f32_16x16x32_bf16 a[228:231], v[76:79], v[144:147], a[228:231]
    v_mfma_f32_16x16x32_bf16 a[232:235], v[76:79], v[148:151], a[232:235]
    v_mfma_f32_16x16x32_bf16 a[236:239], v[76:79], v[152:155], a[236:239]
    v_mfma_f32_16x16x32_bf16 a[240:243], v[76:79], v[156:159], a[240:243]
    v_mfma_f32_16x16x32_bf16 a[244:247], v[76:79], v[160:163], a[244:247]
    v_mfma_f32_16x16x32_bf16 a[248:251], v[76:79], v[164:167], a[248:251]
    ds_read_b128 v[76:79], v7 offset:38912
    v_mfma_f32_16x16x32_bf16 a[252:255], v[80:83], v[140:143], a[252:255]
    v_mfma_f32_16x16x32_bf16 v[20:23], v[80:83], v[144:147], v[20:23]
    v_mfma_f32_16x16x32_bf16 v[24:27], v[80:83], v[148:151], v[24:27]
    v_mfma_f32_16x16x32_bf16 v[28:31], v[80:83], v[152:155], v[28:31]
    v_mfma_f32_16x16x32_bf16 v[32:35], v[80:83], v[156:159], v[32:35]
    v_mfma_f32_16x16x32_bf16 v[36:39], v[80:83], v[160:163], v[36:39]
    v_mfma_f32_16x16x32_bf16 v[40:43], v[80:83], v[164:167], v[40:43]
    ds_read_b128 v[80:83], v7 offset:39936
    s_waitcnt vmcnt(0) lgkmcnt(7)
    v_mfma_f32_16x16x32_bf16 a[0:3], v[44:47], v[168:171], a[0:3]
    v_mfma_f32_16x16x32_bf16 a[4:7], v[44:47], v[172:175], a[4:7]
    v_mfma_f32_16x16x32_bf16 a[8:11], v[44:47], v[176:179], a[8:11]
    v_mfma_f32_16x16x32_bf16 a[12:15], v[44:47], v[180:183], a[12:15]
    v_mfma_f32_16x16x32_bf16 a[16:19], v[44:47], v[184:187], a[16:19]
    v_mfma_f32_16x16x32_bf16 a[20:23], v[44:47], v[188:191], a[20:23]
    v_mfma_f32_16x16x32_bf16 a[24:27], v[44:47], v[192:195], a[24:27]
    v_mfma_f32_16x16x32_bf16 a[28:31], v[48:51], v[168:171], a[28:31]
    v_mfma_f32_16x16x32_bf16 a[32:35], v[48:51], v[172:175], a[32:35]
    v_mfma_f32_16x16x32_bf16 a[36:39], v[48:51], v[176:179], a[36:39]
    v_mfma_f32_16x16x32_bf16 a[40:43], v[48:51], v[180:183], a[40:43]
    v_mfma_f32_16x16x32_bf16 a[44:47], v[48:51], v[184:187], a[44:47]
    v_mfma_f32_16x16x32_bf16 a[48:51], v[48:51], v[188:191], a[48:51]
    v_mfma_f32_16x16x32_bf16 a[52:55], v[48:51], v[192:195], a[52:55]
    s_waitcnt lgkmcnt(0)
    v_mfma_f32_16x16x32_bf16 a[56:59], v[52:55], v[168:171], a[56:59]
    v_mfma_f32_16x16x32_bf16 a[60:63], v[52:55], v[172:175], a[60:63]
    ds_write_b128 v7, a[0:3] offset:0
    v_mfma_f32_16x16x32_bf16 a[64:67], v[52:55], v[176:179], a[64:67]
    ds_write_b128 v7, a[28:31] offset:1024
    v_mfma_f32_16x16x32_bf16 a[68:71], v[52:55], v[180:183], a[68:71]
    ds_write_b128 v7, a[4:7] offset:2048
    v_mfma_f32_16x16x32_bf16 a[72:75], v[52:55], v[184:187], a[72:75]
    ds_write_b128 v7, a[32:35] offset:3072
    v_mfma_f32_16x16x32_bf16 a[76:79], v[52:55], v[188:191], a[76:79]
    ds_write_b128 v7, a[8:11] offset:4096
    v_mfma_f32_16x16x32_bf16 a[80:83], v[52:55], v[192:195], a[80:83]
    ds_write_b128 v7, a[36:39] offset:5120
    v_mfma_f32_16x16x32_bf16 a[84:87], v[56:59], v[168:171], a[84:87]
    ds_write_b128 v7, a[12:15] offset:6144
    v_mfma_f32_16x16x32_bf16 a[88:91], v[56:59], v[172:175], a[88:91]
    ds_write_b128 v7, a[40:43] offset:7168
    v_mfma_f32_16x16x32_bf16 a[92:95], v[56:59], v[176:179], a[92:95]
    ds_write_b128 v7, a[16:19] offset:8192
    v_mfma_f32_16x16x32_bf16 a[96:99], v[56:59], v[180:183], a[96:99]
    ds_write_b128 v7, a[44:47] offset:9216
    v_mfma_f32_16x16x32_bf16 a[100:103], v[56:59], v[184:187], a[100:103]
    ds_write_b128 v7, a[20:23] offset:10240
    v_mfma_f32_16x16x32_bf16 a[104:107], v[56:59], v[188:191], a[104:107]
    ds_write_b128 v7, a[48:51] offset:11264
    v_mfma_f32_16x16x32_bf16 a[108:111], v[56:59], v[192:195], a[108:111]
    ds_write_b128 v7, a[24:27] offset:12288
    v_mfma_f32_16x16x32_bf16 a[112:115], v[60:63], v[168:171], a[112:115]
    ds_write_b128 v7, a[52:55] offset:13312
    v_mfma_f32_16x16x32_bf16 a[116:119], v[60:63], v[172:175], a[116:119]
    ds_write_b128 v7, a[56:59] offset:14336
    v_mfma_f32_16x16x32_bf16 a[120:123], v[60:63], v[176:179], a[120:123]
    ds_write_b128 v7, a[84:87] offset:15360
    v_mfma_f32_16x16x32_bf16 a[124:127], v[60:63], v[180:183], a[124:127]
    ds_write_b128 v7, a[60:63] offset:16384
    v_mfma_f32_16x16x32_bf16 a[128:131], v[60:63], v[184:187], a[128:131]
    ds_write_b128 v7, a[88:91] offset:17408
    v_mfma_f32_16x16x32_bf16 a[132:135], v[60:63], v[188:191], a[132:135]
    ds_write_b128 v7, a[64:67] offset:18432
    v_mfma_f32_16x16x32_bf16 a[136:139], v[60:63], v[192:195], a[136:139]
    ds_write_b128 v7, a[92:95] offset:19456
    v_mfma_f32_16x16x32_bf16 a[140:143], v[64:67], v[168:171], a[140:143]
    ds_write_b128 v7, a[68:71] offset:20480
    v_mfma_f32_16x16x32_bf16 a[144:147], v[64:67], v[172:175], a[144:147]
    ds_write_b128 v7, a[96:99] offset:21504
    v_mfma_f32_16x16x32_bf16 a[148:151], v[64:67], v[176:179], a[148:151]
    ds_write_b128 v7, a[72:75] offset:22528
    v_mfma_f32_16x16x32_bf16 a[152:155], v[64:67], v[180:183], a[152:155]
    ds_write_b128 v7, a[100:103] offset:23552
    v_mfma_f32_16x16x32_bf16 a[156:159], v[64:67], v[184:187], a[156:159]
    ds_write_b128 v7, a[76:79] offset:24576
    v_mfma_f32_16x16x32_bf16 a[160:163], v[64:67], v[188:191], a[160:163]
    ds_write_b128 v7, a[104:107] offset:25600
    v_mfma_f32_16x16x32_bf16 a[164:167], v[64:67], v[192:195], a[164:167]
    ds_write_b128 v7, a[80:83] offset:26624
    v_mfma_f32_16x16x32_bf16 a[168:171], v[68:71], v[168:171], a[168:171]
    ds_write_b128 v7, a[108:111] offset:27648
    v_mfma_f32_16x16x32_bf16 a[172:175], v[68:71], v[172:175], a[172:175]
    ds_write_b128 v7, a[112:115] offset:28672
    v_mfma_f32_16x16x32_bf16 a[176:179], v[68:71], v[176:179], a[176:179]
    ds_write_b128 v7, a[140:143] offset:29696
    v_mfma_f32_16x16x32_bf16 a[180:183], v[68:71], v[180:183], a[180:183]
    ds_write_b128 v7, a[116:119] offset:30720
    v_mfma_f32_16x16x32_bf16 a[184:187], v[68:71], v[184:187], a[184:187]
    ds_write_b128 v7, a[144:147] offset:31744
    v_mfma_f32_16x16x32_bf16 a[188:191], v[68:71], v[188:191], a[188:191]
    ds_write_b128 v7, a[120:123] offset:32768
    v_mfma_f32_16x16x32_bf16 a[192:195], v[68:71], v[192:195], a[192:195]
    ds_write_b128 v7, a[148:151] offset:33792
    v_mfma_f32_16x16x32_bf16 a[196:199], v[72:75], v[168:171], a[196:199]
    ds_write_b128 v7, a[124:127] offset:34816
    v_mfma_f32_16x16x32_bf16 a[200:203], v[72:75], v[172:175], a[200:203]
    ds_write_b128 v7, a[152:155] offset:35840
    v_mfma_f32_16x16x32_bf16 a[204:207], v[72:75], v[176:179], a[204:207]
    ds_write_b128 v7, a[128:131] offset:36864
    v_mfma_f32_16x16x32_bf16 a[208:211], v[72:75], v[180:183], a[208:211]
    ds_write_b128 v7, a[156:159] offset:37888
    v_mfma_f32_16x16x32_bf16 a[212:215], v[72:75], v[184:187], a[212:215]
    ds_write_b128 v7, a[132:135] offset:38912
    v_mfma_f32_16x16x32_bf16 a[216:219], v[72:75], v[188:191], a[216:219]
    ds_write_b128 v7, a[160:163] offset:39936
    v_mfma_f32_16x16x32_bf16 a[220:223], v[72:75], v[192:195], a[220:223]
    v_mfma_f32_16x16x32_bf16 a[224:227], v[76:79], v[168:171], a[224:227]
    v_mfma_f32_16x16x32_bf16 a[228:231], v[76:79], v[172:175], a[228:231]
    v_mfma_f32_16x16x32_bf16 a[232:235], v[76:79], v[176:179], a[232:235]
    v_mfma_f32_16x16x32_bf16 a[236:239], v[76:79], v[180:183], a[236:239]
    v_mfma_f32_16x16x32_bf16 a[240:243], v[76:79], v[184:187], a[240:243]
    v_mfma_f32_16x16x32_bf16 a[244:247], v[76:79], v[188:191], a[244:247]
    v_mfma_f32_16x16x32_bf16 a[248:251], v[76:79], v[192:195], a[248:251]
    v_mfma_f32_16x16x32_bf16 a[252:255], v[80:83], v[168:171], a[252:255]
    v_mfma_f32_16x16x32_bf16 v[20:23], v[80:83], v[172:175], v[20:23]
    v_mfma_f32_16x16x32_bf16 v[24:27], v[80:83], v[176:179], v[24:27]
    v_mfma_f32_16x16x32_bf16 v[28:31], v[80:83], v[180:183], v[28:31]
    v_mfma_f32_16x16x32_bf16 v[32:35], v[80:83], v[184:187], v[32:35]
    v_mfma_f32_16x16x32_bf16 v[36:39], v[80:83], v[188:191], v[36:39]
    v_mfma_f32_16x16x32_bf16 v[40:43], v[80:83], v[192:195], v[40:43]
    s_waitcnt lgkmcnt(0)
    s_barrier
    ds_read_b128 v[44:47], v2 offset:0
    ds_read_b128 v[48:51], v2 offset:1024
    ds_read_b128 v[52:55], v3 offset:0
    ds_read_b128 v[56:59], v3 offset:1024
    ds_read_b128 v[60:63], v4 offset:0
    ds_read_b128 v[64:67], v4 offset:1024
    ds_read_b128 v[68:71], v5 offset:0
    ds_read_b128 v[72:75], v5 offset:1024
    ds_read_b128 v[76:79], v2 offset:8192
    ds_read_b128 v[80:83], v2 offset:9216
    ds_read_b128 v[84:87], v3 offset:8192
    ds_read_b128 v[88:91], v3 offset:9216
    ds_read_b128 v[92:95], v4 offset:8192
    ds_read_b128 v[96:99], v4 offset:9216
    ds_read_b128 v[100:103], v5 offset:8192
    ds_read_b128 v[104:107], v5 offset:9216
    ds_read_b128 v[108:111], v2 offset:16384
    ds_read_b128 v[112:115], v2 offset:17408
    ds_read_b128 v[116:119], v3 offset:16384
    ds_read_b128 v[120:123], v3 offset:17408
    ds_read_b128 v[124:127], v4 offset:16384
    ds_read_b128 v[128:131], v4 offset:17408
    ds_read_b128 v[132:135], v5 offset:16384
    ds_read_b128 v[136:139], v5 offset:17408
    ds_read_b128 v[140:143], v2 offset:24576
    ds_read_b128 v[144:147], v2 offset:25600
    ds_read_b128 v[148:151], v3 offset:24576
    ds_read_b128 v[152:155], v3 offset:25600
    ds_read_b128 v[156:159], v4 offset:24576
    ds_read_b128 v[160:163], v4 offset:25600
    ds_read_b128 v[164:167], v5 offset:24576
    ds_read_b128 v[168:171], v5 offset:25600
    ds_read_b128 v[172:175], v2 offset:32768
    ds_read_b128 v[176:179], v2 offset:33792
    ds_read_b128 v[180:183], v3 offset:32768
    ds_read_b128 v[184:187], v3 offset:33792
    ds_read_b128 v[188:191], v4 offset:32768
    ds_read_b128 v[192:195], v4 offset:33792
    ds_read_b128 v[196:199], v5 offset:32768
    ds_read_b128 v[200:203], v5 offset:33792
    s_waitcnt lgkmcnt(0)
    s_barrier
    ds_write_b128 v7, a[136:139] offset:0
    v_pk_add_f32 v[44:45], v[44:45], v[52:53]
    v_pk_add_f32 v[60:61], v[60:61], v[68:69]
    v_pk_add_f32 v[46:47], v[46:47], v[54:55]
    v_pk_add_f32 v[62:63], v[62:63], v[70:71]
    ds_write_b128 v7, a[164:167] offset:1024
    v_pk_add_f32 v[48:49], v[48:49], v[56:57]
    v_pk_add_f32 v[64:65], v[64:65], v[72:73]
    v_pk_add_f32 v[50:51], v[50:51], v[58:59]
    v_pk_add_f32 v[66:67], v[66:67], v[74:75]
    ds_write_b128 v7, a[168:171] offset:2048
    v_pk_add_f32 v[44:45], v[44:45], v[60:61]
    v_pk_add_f32 v[46:47], v[46:47], v[62:63]
    v_pk_add_f32 v[48:49], v[48:49], v[64:65]
    v_pk_add_f32 v[50:51], v[50:51], v[66:67]
    ds_write_b128 v7, a[196:199] offset:3072
    v_cvt_pk_bf16_f32 v52, v44, v45
    v_cvt_pk_bf16_f32 v53, v46, v47
    v_cvt_pk_bf16_f32 v54, v48, v49
    v_cvt_pk_bf16_f32 v55, v50, v51
    ds_write_b128 v7, a[172:175] offset:4096
    s_add_u32 s22, s20, 0
    s_mul_i32 s23, s22, 9363
    s_lshr_b32 s23, s23, 16
    v_permlane16_swap_b32 v52, v54
    ds_write_b128 v7, a[200:203] offset:5120
    v_permlane16_swap_b32 v53, v55
    s_mul_i32 s30, s23, 7
    s_sub_u32 s30, s22, s30
    s_mul_i32 s30, s30, 40960
    ds_write_b128 v7, a[176:179] offset:6144
    s_lshl_b32 s23, s23, 6
    s_add_u32 s30, s30, s23
    s_add_u32 s30, s30, s24
    buffer_store_dwordx4 v[52:55], v9, s[12:15], s30 offen
    ds_write_b128 v7, a[204:207] offset:7168
    v_pk_add_f32 v[76:77], v[76:77], v[84:85]
    v_pk_add_f32 v[92:93], v[92:93], v[100:101]
    v_pk_add_f32 v[78:79], v[78:79], v[86:87]
    v_pk_add_f32 v[94:95], v[94:95], v[102:103]
    ds_write_b128 v7, a[180:183] offset:8192
    v_pk_add_f32 v[80:81], v[80:81], v[88:89]
    v_pk_add_f32 v[96:97], v[96:97], v[104:105]
    v_pk_add_f32 v[82:83], v[82:83], v[90:91]
    v_pk_add_f32 v[98:99], v[98:99], v[106:107]
    ds_write_b128 v7, a[208:211] offset:9216
    v_pk_add_f32 v[76:77], v[76:77], v[92:93]
    v_pk_add_f32 v[78:79], v[78:79], v[94:95]
    v_pk_add_f32 v[80:81], v[80:81], v[96:97]
    v_pk_add_f32 v[82:83], v[82:83], v[98:99]
    ds_write_b128 v7, a[184:187] offset:10240
    v_cvt_pk_bf16_f32 v84, v76, v77
    v_cvt_pk_bf16_f32 v85, v78, v79
    v_cvt_pk_bf16_f32 v86, v80, v81
    v_cvt_pk_bf16_f32 v87, v82, v83
    ds_write_b128 v7, a[212:215] offset:11264
    s_add_u32 s22, s20, 4
    s_mul_i32 s23, s22, 9363
    s_lshr_b32 s23, s23, 16
    v_permlane16_swap_b32 v84, v86
    ds_write_b128 v7, a[188:191] offset:12288
    v_permlane16_swap_b32 v85, v87
    s_mul_i32 s30, s23, 7
    s_sub_u32 s30, s22, s30
    s_mul_i32 s30, s30, 40960
    ds_write_b128 v7, a[216:219] offset:13312
    s_lshl_b32 s23, s23, 6
    s_add_u32 s30, s30, s23
    s_add_u32 s30, s30, s24
    buffer_store_dwordx4 v[84:87], v9, s[12:15], s30 offen
    ds_write_b128 v7, a[192:195] offset:14336
    v_pk_add_f32 v[108:109], v[108:109], v[116:117]
    v_pk_add_f32 v[124:125], v[124:125], v[132:133]
    v_pk_add_f32 v[110:111], v[110:111], v[118:119]
    v_pk_add_f32 v[126:127], v[126:127], v[134:135]
    ds_write_b128 v7, a[220:223] offset:15360
    v_pk_add_f32 v[112:113], v[112:113], v[120:121]
    v_pk_add_f32 v[128:129], v[128:129], v[136:137]
    v_pk_add_f32 v[114:115], v[114:115], v[122:123]
    v_pk_add_f32 v[130:131], v[130:131], v[138:139]
    ds_write_b128 v7, a[224:227] offset:16384
    v_pk_add_f32 v[108:109], v[108:109], v[124:125]
    v_pk_add_f32 v[110:111], v[110:111], v[126:127]
    v_pk_add_f32 v[112:113], v[112:113], v[128:129]
    v_pk_add_f32 v[114:115], v[114:115], v[130:131]
    ds_write_b128 v7, a[252:255] offset:17408
    v_cvt_pk_bf16_f32 v116, v108, v109
    v_cvt_pk_bf16_f32 v117, v110, v111
    v_cvt_pk_bf16_f32 v118, v112, v113
    v_cvt_pk_bf16_f32 v119, v114, v115
    ds_write_b128 v7, a[228:231] offset:18432
    s_add_u32 s22, s20, 8
    s_mul_i32 s23, s22, 9363
    s_lshr_b32 s23, s23, 16
    v_permlane16_swap_b32 v116, v118
    ds_write_b128 v7, v[20:23] offset:19456
    v_permlane16_swap_b32 v117, v119
    s_mul_i32 s30, s23, 7
    s_sub_u32 s30, s22, s30
    s_mul_i32 s30, s30, 40960
    ds_write_b128 v7, a[232:235] offset:20480
    s_lshl_b32 s23, s23, 6
    s_add_u32 s30, s30, s23
    s_add_u32 s30, s30, s24
    buffer_store_dwordx4 v[116:119], v9, s[12:15], s30 offen
    ds_write_b128 v7, v[24:27] offset:21504
    v_pk_add_f32 v[140:141], v[140:141], v[148:149]
    v_pk_add_f32 v[156:157], v[156:157], v[164:165]
    v_pk_add_f32 v[142:143], v[142:143], v[150:151]
    v_pk_add_f32 v[158:159], v[158:159], v[166:167]
    ds_write_b128 v7, a[236:239] offset:22528
    v_pk_add_f32 v[144:145], v[144:145], v[152:153]
    v_pk_add_f32 v[160:161], v[160:161], v[168:169]
    v_pk_add_f32 v[146:147], v[146:147], v[154:155]
    v_pk_add_f32 v[162:163], v[162:163], v[170:171]
    ds_write_b128 v7, v[28:31] offset:23552
    v_pk_add_f32 v[140:141], v[140:141], v[156:157]
    v_pk_add_f32 v[142:143], v[142:143], v[158:159]
    v_pk_add_f32 v[144:145], v[144:145], v[160:161]
    v_pk_add_f32 v[146:147], v[146:147], v[162:163]
    ds_write_b128 v7, a[240:243] offset:24576
    v_cvt_pk_bf16_f32 v148, v140, v141
    v_cvt_pk_bf16_f32 v149, v142, v143
    v_cvt_pk_bf16_f32 v150, v144, v145
    v_cvt_pk_bf16_f32 v151, v146, v147
    ds_write_b128 v7, v[32:35] offset:25600
    s_add_u32 s22, s20, 12
    s_mul_i32 s23, s22, 9363
    s_lshr_b32 s23, s23, 16
    v_permlane16_swap_b32 v148, v150
    ds_write_b128 v7, a[244:247] offset:26624
    v_permlane16_swap_b32 v149, v151
    s_mul_i32 s30, s23, 7
    s_sub_u32 s30, s22, s30
    s_mul_i32 s30, s30, 40960
    ds_write_b128 v7, v[36:39] offset:27648
    s_lshl_b32 s23, s23, 6
    s_add_u32 s30, s30, s23
    s_add_u32 s30, s30, s24
    buffer_store_dwordx4 v[148:151], v9, s[12:15], s30 offen
    ds_write_b128 v7, a[248:251] offset:28672
    v_pk_add_f32 v[172:173], v[172:173], v[180:181]
    v_pk_add_f32 v[188:189], v[188:189], v[196:197]
    v_pk_add_f32 v[174:175], v[174:175], v[182:183]
    v_pk_add_f32 v[190:191], v[190:191], v[198:199]
    ds_write_b128 v7, v[40:43] offset:29696
    v_pk_add_f32 v[176:177], v[176:177], v[184:185]
    v_pk_add_f32 v[192:193], v[192:193], v[200:201]
    v_pk_add_f32 v[178:179], v[178:179], v[186:187]
    v_pk_add_f32 v[194:195], v[194:195], v[202:203]
    v_pk_add_f32 v[172:173], v[172:173], v[188:189]
    v_pk_add_f32 v[174:175], v[174:175], v[190:191]
    v_pk_add_f32 v[176:177], v[176:177], v[192:193]
    v_pk_add_f32 v[178:179], v[178:179], v[194:195]
    v_cvt_pk_bf16_f32 v180, v172, v173
    v_cvt_pk_bf16_f32 v181, v174, v175
    v_cvt_pk_bf16_f32 v182, v176, v177
    v_cvt_pk_bf16_f32 v183, v178, v179
    s_add_u32 s22, s20, 16
    s_mul_i32 s23, s22, 9363
    s_lshr_b32 s23, s23, 16
    v_permlane16_swap_b32 v180, v182
    v_permlane16_swap_b32 v181, v183
    s_mul_i32 s30, s23, 7
    s_sub_u32 s30, s22, s30
    s_mul_i32 s30, s30, 40960
    s_lshl_b32 s23, s23, 6
    s_add_u32 s30, s30, s23
    s_add_u32 s30, s30, s24
    buffer_store_dwordx4 v[180:183], v9, s[12:15], s30 offen
    s_waitcnt lgkmcnt(0)
    s_barrier
    ds_read_b128 v[44:47], v2 offset:0
    ds_read_b128 v[48:51], v2 offset:1024
    ds_read_b128 v[52:55], v3 offset:0
    ds_read_b128 v[56:59], v3 offset:1024
    ds_read_b128 v[60:63], v4 offset:0
    ds_read_b128 v[64:67], v4 offset:1024
    ds_read_b128 v[68:71], v5 offset:0
    ds_read_b128 v[72:75], v5 offset:1024
    ds_read_b128 v[76:79], v2 offset:8192
    ds_read_b128 v[80:83], v2 offset:9216
    ds_read_b128 v[84:87], v3 offset:8192
    ds_read_b128 v[88:91], v3 offset:9216
    ds_read_b128 v[92:95], v4 offset:8192
    ds_read_b128 v[96:99], v4 offset:9216
    ds_read_b128 v[100:103], v5 offset:8192
    ds_read_b128 v[104:107], v5 offset:9216
    ds_read_b128 v[108:111], v2 offset:16384
    ds_read_b128 v[112:115], v2 offset:17408
    ds_read_b128 v[116:119], v3 offset:16384
    ds_read_b128 v[120:123], v3 offset:17408
    ds_read_b128 v[124:127], v4 offset:16384
    ds_read_b128 v[128:131], v4 offset:17408
    ds_read_b128 v[132:135], v5 offset:16384
    ds_read_b128 v[136:139], v5 offset:17408
    ds_read_b128 v[140:143], v2 offset:24576
    ds_read_b128 v[144:147], v2 offset:25600
    ds_read_b128 v[148:151], v3 offset:24576
    ds_read_b128 v[152:155], v3 offset:25600
    ds_read_b128 v[156:159], v4 offset:24576
    ds_read_b128 v[160:163], v4 offset:25600
    ds_read_b128 v[164:167], v5 offset:24576
    ds_read_b128 v[168:171], v5 offset:25600
    s_waitcnt lgkmcnt(15)
    v_pk_add_f32 v[44:45], v[44:45], v[52:53]
    v_pk_add_f32 v[60:61], v[60:61], v[68:69]
    v_pk_add_f32 v[46:47], v[46:47], v[54:55]
    v_pk_add_f32 v[62:63], v[62:63], v[70:71]
    v_pk_add_f32 v[48:49], v[48:49], v[56:57]
    v_pk_add_f32 v[64:65], v[64:65], v[72:73]
    v_pk_add_f32 v[50:51], v[50:51], v[58:59]
    v_pk_add_f32 v[66:67], v[66:67], v[74:75]
    v_pk_add_f32 v[44:45], v[44:45], v[60:61]
    v_pk_add_f32 v[46:47], v[46:47], v[62:63]
    v_pk_add_f32 v[48:49], v[48:49], v[64:65]
    v_pk_add_f32 v[50:51], v[50:51], v[66:67]
    v_cvt_pk_bf16_f32 v52, v44, v45
    v_cvt_pk_bf16_f32 v53, v46, v47
    v_cvt_pk_bf16_f32 v54, v48, v49
    v_cvt_pk_bf16_f32 v55, v50, v51
    s_add_u32 s22, s20, 20
    s_mul_i32 s23, s22, 9363
    s_lshr_b32 s23, s23, 16
    v_permlane16_swap_b32 v52, v54
    v_permlane16_swap_b32 v53, v55
    s_mul_i32 s30, s23, 7
    s_sub_u32 s30, s22, s30
    s_mul_i32 s30, s30, 40960
    s_lshl_b32 s23, s23, 6
    s_add_u32 s30, s30, s23
    s_add_u32 s30, s30, s24
    buffer_store_dwordx4 v[52:55], v9, s[12:15], s30 offen
    s_waitcnt lgkmcnt(15)
    v_pk_add_f32 v[76:77], v[76:77], v[84:85]
    v_pk_add_f32 v[92:93], v[92:93], v[100:101]
    v_pk_add_f32 v[78:79], v[78:79], v[86:87]
    v_pk_add_f32 v[94:95], v[94:95], v[102:103]
    v_pk_add_f32 v[80:81], v[80:81], v[88:89]
    v_pk_add_f32 v[96:97], v[96:97], v[104:105]
    v_pk_add_f32 v[82:83], v[82:83], v[90:91]
    v_pk_add_f32 v[98:99], v[98:99], v[106:107]
    v_pk_add_f32 v[76:77], v[76:77], v[92:93]
    v_pk_add_f32 v[78:79], v[78:79], v[94:95]
    v_pk_add_f32 v[80:81], v[80:81], v[96:97]
    v_pk_add_f32 v[82:83], v[82:83], v[98:99]
    v_cvt_pk_bf16_f32 v84, v76, v77
    v_cvt_pk_bf16_f32 v85, v78, v79
    v_cvt_pk_bf16_f32 v86, v80, v81
    v_cvt_pk_bf16_f32 v87, v82, v83
    s_add_u32 s22, s20, 24
    s_mul_i32 s23, s22, 9363
    s_lshr_b32 s23, s23, 16
    v_permlane16_swap_b32 v84, v86
    v_permlane16_swap_b32 v85, v87
    s_mul_i32 s30, s23, 7
    s_sub_u32 s30, s22, s30
    s_mul_i32 s30, s30, 40960
    s_lshl_b32 s23, s23, 6
    s_add_u32 s30, s30, s23
    s_add_u32 s30, s30, s24
    buffer_store_dwordx4 v[84:87], v9, s[12:15], s30 offen
    s_waitcnt lgkmcnt(8)
    v_pk_add_f32 v[108:109], v[108:109], v[116:117]
    v_pk_add_f32 v[124:125], v[124:125], v[132:133]
    v_pk_add_f32 v[110:111], v[110:111], v[118:119]
    v_pk_add_f32 v[126:127], v[126:127], v[134:135]
    v_pk_add_f32 v[112:113], v[112:113], v[120:121]
    v_pk_add_f32 v[128:129], v[128:129], v[136:137]
    v_pk_add_f32 v[114:115], v[114:115], v[122:123]
    v_pk_add_f32 v[130:131], v[130:131], v[138:139]
    v_pk_add_f32 v[108:109], v[108:109], v[124:125]
    v_pk_add_f32 v[110:111], v[110:111], v[126:127]
    v_pk_add_f32 v[112:113], v[112:113], v[128:129]
    v_pk_add_f32 v[114:115], v[114:115], v[130:131]
    v_cvt_pk_bf16_f32 v116, v108, v109
    v_cvt_pk_bf16_f32 v117, v110, v111
    v_cvt_pk_bf16_f32 v118, v112, v113
    v_cvt_pk_bf16_f32 v119, v114, v115
    s_add_u32 s22, s20, 28
    s_mul_i32 s23, s22, 9363
    s_lshr_b32 s23, s23, 16
    v_permlane16_swap_b32 v116, v118
    v_permlane16_swap_b32 v117, v119
    s_mul_i32 s30, s23, 7
    s_sub_u32 s30, s22, s30
    s_mul_i32 s30, s30, 40960
    s_lshl_b32 s23, s23, 6
    s_add_u32 s30, s30, s23
    s_add_u32 s30, s30, s24
    buffer_store_dwordx4 v[116:119], v9, s[12:15], s30 offen
    s_waitcnt lgkmcnt(0)
    v_pk_add_f32 v[140:141], v[140:141], v[148:149]
    v_pk_add_f32 v[156:157], v[156:157], v[164:165]
    v_pk_add_f32 v[142:143], v[142:143], v[150:151]
    v_pk_add_f32 v[158:159], v[158:159], v[166:167]
    v_pk_add_f32 v[144:145], v[144:145], v[152:153]
    v_pk_add_f32 v[160:161], v[160:161], v[168:169]
    v_pk_add_f32 v[146:147], v[146:147], v[154:155]
    v_pk_add_f32 v[162:163], v[162:163], v[170:171]
    v_pk_add_f32 v[140:141], v[140:141], v[156:157]
    v_pk_add_f32 v[142:143], v[142:143], v[158:159]
    v_pk_add_f32 v[144:145], v[144:145], v[160:161]
    v_pk_add_f32 v[146:147], v[146:147], v[162:163]
    v_cvt_pk_bf16_f32 v148, v140, v141
    v_cvt_pk_bf16_f32 v149, v142, v143
    v_cvt_pk_bf16_f32 v150, v144, v145
    v_cvt_pk_bf16_f32 v151, v146, v147
    s_add_u32 s22, s20, 32
    s_mul_i32 s23, s22, 9363
    s_lshr_b32 s23, s23, 16
    v_permlane16_swap_b32 v148, v150
    v_permlane16_swap_b32 v149, v151
    s_mul_i32 s30, s23, 7
    s_sub_u32 s30, s22, s30
    s_mul_i32 s30, s30, 40960
    s_lshl_b32 s23, s23, 6
    s_add_u32 s30, s30, s23
    s_add_u32 s30, s30, s24
    s_cmp_ge_u32 s22, 35
    s_cselect_b32 s23, 0x40000000, 0
    s_add_u32 s30, s30, s23
    buffer_store_dwordx4 v[148:151], v9, s[12:15], s30 offen
L_op_end:
    s_endpgm
L_code_end:
.section .rodata,"a"
.p2align 6
.amdhsa_kernel fused_kernel
  .amdhsa_next_free_vgpr 512
  .amdhsa_next_free_sgpr 102
  .amdhsa_accum_offset 256
  .amdhsa_group_segment_fixed_size 0
  .amdhsa_kernarg_size 104
  .amdhsa_user_sgpr_count 2
  .amdhsa_user_sgpr_kernarg_segment_ptr 1
  .amdhsa_system_sgpr_workgroup_id_x 1
.end_amdhsa_kernel
.p2align 6
.amdhsa_kernel op_kernel
  .amdhsa_next_free_vgpr 512
  .amdhsa_next_free_sgpr 102
  .amdhsa_accum_offset 256
  .amdhsa_group_segment_fixed_size 0
  .amdhsa_kernarg_size 104
  .amdhsa_user_sgpr_count 2
  .amdhsa_user_sgpr_kernarg_segment_ptr 1
  .amdhsa_system_sgpr_workgroup_id_x 1
.end_amdhsa_kernel
```

```asm
; @launch kernel=fused_kernel grid=(256,1,1) block=(256,1,1) lds=163840
; @launch kernel=op_kernel grid=(256,1,1) block=(256,1,1) lds=163840
.amdgcn_target "amdgcn-amd-amdhsa--gfx950"
.text
.globl fused_kernel
.p2align 8
.type fused_kernel,@function
fused_kernel:
    s_cmp_ge_u32 s2, 256
    s_cbranch_scc1 L_at_end
    s_and_b32 s3, s2, 7
    s_lshl_b32 s3, s3, 5
    s_lshr_b32 s36, s2, 6
    s_lshl_b32 s36, s36, 3
    s_or_b32 s3, s3, s36
    s_bfe_u32 s36, s2, 0x30003
    s_or_b32 s2, s3, s36
    s_load_dwordx8 s[36:43], s[0:1], 0
    s_load_dwordx8 s[56:63], s[0:1], 40
    s_load_dwordx2 s[44:45], s[0:1], 96
    s_load_dwordx2 s[84:85], s[0:1], 32
    s_load_dwordx2 s[86:87], s[0:1], 72
    v_and_b32 v1, 63, v0
    v_lshrrev_b32 v2, 6, v0
    s_nop 0
    v_readfirstlane_b32 s20, v2
    s_waitcnt lgkmcnt(0)
    s_and_b32 s48, s20, 1
    s_lshr_b32 s35, s20, 1
    s_cmp_ge_u32 s2, 128
    s_cselect_b32 s36, s56, s36
    s_cselect_b32 s37, s57, s37
    s_cselect_b32 s38, s58, s38
    s_cselect_b32 s39, s59, s39
    s_cselect_b32 s40, s60, s40
    s_cselect_b32 s41, s61, s41
    s_cselect_b32 s42, s62, s42
    s_cselect_b32 s43, s63, s43
    s_cselect_b32 s84, s86, s84
    s_cselect_b32 s85, s87, s85
    s_mov_b32 s86, 5242880
    s_mov_b32 s87, 0x20000
    s_and_b32 s28, s2, 127
    s_lshl_b32 s29, s28, 20
    s_lshl_b32 s30, s35, 18
    s_add_u32 s29, s29, s30
    s_add_u32 s38, s38, s29
    s_addc_u32 s39, s39, 0
    s_add_u32 s40, s40, s29
    s_addc_u32 s41, s41, 0
    s_sub_u32 s30, 0x100000, s30
    s_mov_b32 s8, s38
    s_mov_b32 s9, s39
    s_mov_b32 s10, s30
    s_mov_b32 s11, 0x20000
    s_cmp_eq_u32 s48, 0
    s_cselect_b32 s4, s38, s40
    s_cselect_b32 s5, s39, s41
    s_mov_b32 s6, s30
    s_mov_b32 s7, 0x20000
    s_cselect_b32 s16, s42, s36
    s_cselect_b32 s17, s43, s37
    s_mov_b32 s28, 5242880
    s_mov_b32 s29, 4587520
    s_cselect_b32 s18, s28, s29
    s_mov_b32 s19, 0x20000
    s_mov_b32 s28, 262144
    s_mov_b32 s29, 64
    s_cselect_b32 s51, s28, s29
    s_cselect_b32 s52, 512, 0
    s_mov_b32 s28, 1056
    s_mov_b32 s29, 1024
    s_cselect_b32 s53, s28, s29
    s_mov_b32 s28, 0
    s_mov_b32 s29, 0
    s_cselect_b32 s88, s28, s29
    s_mov_b32 s28, 8192
    s_mov_b32 s29, 20480
    s_cselect_b32 s89, s28, s29
    s_mov_b32 s28, 16384
    s_mov_b32 s29, 40960
    s_cselect_b32 s90, s28, s29
    s_mov_b32 s28, 24576
    s_mov_b32 s29, 61440
    s_cselect_b32 s91, s28, s29
    s_mov_b32 s28, 65536
    s_mov_b32 s29, 81920
    s_cselect_b32 s92, s28, s29
    s_mov_b32 s28, 73728
    s_mov_b32 s29, 102400
    s_cselect_b32 s93, s28, s29
    s_mov_b32 s28, 81920
    s_mov_b32 s29, 122880
    s_cselect_b32 s94, s28, s29
    s_mov_b32 s28, 90112
    s_mov_b32 s29, 1073741824
    s_cselect_b32 s95, s28, s29
    s_and_b32 s28, s2, 7
    s_lshl_b32 s28, s28, 2
    s_add_u32 s28, s28, s35
    s_lshl_b32 s28, s28, 8
    s_bfe_u32 s29, s2, 262147
    s_lshl_b32 s29, s29, 1
    s_add_u32 s29, s29, s35
    s_mul_i32 s29, s29, 143360
    s_cmp_eq_u32 s48, 0
    s_cselect_b32 s55, s28, s29
    s_add_u32 s12, s44, 0
    s_addc_u32 s13, s45, 0
    s_mov_b32 s14, 127926272
    s_mov_b32 s15, 0x20000
    s_lshl_b32 s28, s2, 2
    s_add_u32 s28, s28, s35
    s_mul_i32 s24, s28, 57344
    s_mul_i32 s28, s48, 28672
    s_add_u32 s24, s24, s28
    s_add_u32 s24, s24, 58720256
    s_mov_b32 s23, -1
    s_mov_b32 s60, s42
    s_mov_b32 s61, s43
    s_mov_b32 s62, 5242880
    s_mov_b32 s63, 0x20000
    s_mov_b32 s27, 0
    s_mov_b32 s25, 0
    s_mov_b32 s68, 0
    s_mov_b32 s71, 0
    s_lshr_b32 s26, s2, 3
    s_lshr_b32 s28, s2, 1
    s_add_u32 s26, s26, s28
    s_and_b32 s26, s26, 3
    s_mul_i32 s26, s26, 5
    s_mul_i32 s83, s51, 20
    s_and_b32 s69, s2, 1
    s_min_u32 s69, s69, 1
    s_bfe_u32 s3, s2, 0x10005
    s_xor_b32 s3, s3, 1
    s_and_b32 s69, s2, s3
    s_nop 0
    s_mov_b32 s70, s69
    s_mov_b32 s32, 0x4e800000
    s_mov_b32 s54, 0x3e0293ee
    s_lshl_b32 s28, s48, 1
    s_add_u32 s28, s28, s35
    s_mul_i32 s33, s28, 33792
    v_lshlrev_b32 v6, 4, v1
    v_lshrrev_b32 v2, 4, v1
    v_and_b32 v3, 15, v1
    v_lshlrev_b32 v4, 4, v3
    v_lshl_add_u32 v7, v2, 14, v4
    v_bfe_u32 v5, v1, 4, 1
    v_lshl_add_u32 v26, v5, 15, v4
    v_bfe_u32 v5, v1, 5, 1
    v_lshl_add_u32 v26, v5, 17, v26
    v_mul_u32_u24 v27, 1280, v3
    v_lshl_add_u32 v27, v2, 4, v27
    v_lshrrev_b32 v5, 4, v1
    v_and_b32 v27, 1, v5
    v_lshlrev_b32 v27, 1, v27
    v_lshrrev_b32 v5, 1, v5
    v_mul_u32_u24 v5, 3, v5
    v_xor_b32 v27, v27, v5
    v_and_b32 v5, 3, v1
    v_xor_b32 v27, v27, v5
    v_lshlrev_b32 v27, 4, v27
    v_lshrrev_b32 v5, 2, v1
    v_mul_u32_u24 v5, 1280, v5
    v_add_u32 v27, v27, v5
    s_cmp_eq_u32 s48, 0
    s_cselect_b64 vcc, -1, 0
    s_nop 1
    v_cndmask_b32 v26, v27, v26, vcc
    s_add_u32 s28, s48, 2
    s_mul_i32 s28, s28, 33792
    v_bfe_u32 v5, v1, 2, 2
    v_and_b32 v27, 1, v5
    v_lshlrev_b32 v27, 1, v27
    v_lshrrev_b32 v5, 1, v5
    v_mul_u32_u24 v5, 3, v5
    v_xor_b32 v27, v27, v5
    v_xor_b32 v27, v27, v2
    v_lshlrev_b32 v27, 4, v27
    v_lshl_add_u32 v27, v3, 6, v27
    v_add_u32 v27, s28, v27
    v_bfe_u32 v5, v1, 4, 1
    v_lshl_add_u32 v4, v5, 9, v4
    v_bfe_u32 v5, v1, 5, 1
    v_lshl_add_u32 v10, v5, 8, v4
    v_and_b32 v4, 7, v3
    v_lshlrev_b32 v8, 10, v4
    v_and_b32 v5, 1, v3
    v_lshl_add_u32 v8, v5, 4, v8
    v_bfe_u32 v5, v3, 1, 2
    v_lshl_add_u32 v8, v5, 6, v8
    v_lshrrev_b32 v5, 3, v3
    v_lshl_add_u32 v8, v5, 8, v8
    v_bfe_u32 v5, v1, 4, 1
    v_lshl_add_u32 v8, v5, 5, v8
    v_bfe_u32 v5, v1, 5, 1
    v_lshl_add_u32 v8, v5, 4, v8
    s_mul_i32 s28, s35, 33792
    v_add_u32 v8, s28, v8
    v_bfe_u32 v3, v1, 2, 2
    v_bfe_u32 v5, v1, 4, 1
    v_lshl_add_u32 v4, v5, 2, v3
    v_mul_u32_u24 v4, 1056, v4
    v_bfe_u32 v5, v1, 5, 1
    v_lshl_add_u32 v4, v5, 9, v4
    v_and_b32 v5, 3, v1
    v_lshl_add_u32 v4, v5, 3, v4
    v_add_u32 v11, s28, v4
    v_lshl_add_u32 v3, v2, 2, v3
    v_and_b32 v4, 7, v3
    v_mul_u32_u24 v4, 1056, v4
    v_lshrrev_b32 v5, 3, v3
    v_lshl_add_u32 v4, v5, 8, v4
    v_and_b32 v5, 3, v1
    v_lshl_add_u32 v4, v5, 3, v4
    s_add_u32 s28, s28, 67584
    v_add_u32 v9, s28, v4
    v_mov_b32 v12, 0xff800000
    v_mov_b32 v14, 0xff800000
    v_mov_b32 v16, 0xff800000
    v_mov_b32 v18, 0xff800000
    v_mov_b32 v20, 0xff800000
    v_mov_b32 v22, 0xff800000
    v_mov_b32 v24, 0xff800000
    v_mov_b32 v2, 0x3f803f80
    v_accvgpr_write_b32 a252, v2
    v_accvgpr_write_b32 a253, v2
    v_accvgpr_write_b32 a254, v2
    v_accvgpr_write_b32 a255, v2
    v_and_b32 v2, 3, v1
    v_lshlrev_b32 v2, 2, v2
    v_add_u32 v2, 76000, v2
    v_mov_b32 v3, 0
    ds_write_b32 v2, v3
    s_cmp_eq_u32 s48, 0
    s_mov_b32 s28, 784
    s_mov_b32 s29, 800
    s_cselect_b32 s96, s28, s29
    s_mov_b32 s28, 816
    s_cselect_b32 s97, s28, s29
    v_lshrrev_b32 v2, 1, v1
    v_lshlrev_b32 v2, 13, v2
    v_and_b32 v3, 1, v1
    v_lshl_add_u32 v2, v3, 7, v2
    v_lshlrev_b32 v3, 7, v1
    s_bfe_u32 s28, s2, 0x20003
    s_lshl_b32 s28, s28, 18
    s_and_b32 s29, s2, 7
    s_mul_i32 s29, s29, 17920
    s_cmp_eq_u32 s48, 0
    s_cselect_b64 vcc, -1, 0
    s_cselect_b32 s100, s28, s29
    s_add_u32 s100, s100, s55
    s_cmp_eq_u32 s48, 0
    s_mov_b32 s28, 1048576
    s_mov_b32 s29, 8192
    s_cselect_b32 s99, s28, s29
    v_cndmask_b32 v6, v3, v2, vcc
    s_mul_i32 s100, s2, 11
    s_lshr_b32 s28, s2, 5
    s_mul_i32 s28, s28, 7
    s_add_u32 s100, s100, s28
    s_lshl_b32 s28, s35, 4
    s_add_u32 s100, s100, s28
    s_and_b32 s100, s100, 31
L_at_start:
    s_mov_b32 s21, s27
    s_lshl_b32 s34, s27, 5
    s_add_u32 s31, s21, s70
    s_mul_i32 s50, s31, s52
    s_mov_b32 s101, s31
    s_add_u32 s50, s50, s55
    s_cmp_ge_u32 s31, 2
    s_cselect_b32 s28, 0x40000000, 0
    s_add_u32 s50, s50, s28
    s_mov_b32 s82, s26
    s_mul_i32 s28, s26, s51
    s_add_u32 s50, s50, s28
    s_add_u32 m0, s33, 0
    s_mov_b32 s49, s50
    s_add_u32 s50, s50, s51
    s_add_u32 s82, s82, 1
    s_cmp_eq_u32 s82, 20
    s_cselect_b32 s29, s83, 0
    s_sub_u32 s50, s50, s29
    s_add_u32 s28, s49, s88
    buffer_load_dwordx4 v26, s[16:19], s28 offen lds
    s_add_u32 m0, m0, s53
    s_add_u32 s28, s49, s89
    buffer_load_dwordx4 v26, s[16:19], s28 offen lds
    s_add_u32 m0, m0, s53
    s_add_u32 s28, s49, s90
    buffer_load_dwordx4 v26, s[16:19], s28 offen lds
    s_add_u32 m0, m0, s53
    s_add_u32 s28, s49, s91
    buffer_load_dwordx4 v26, s[16:19], s28 offen lds
    s_add_u32 m0, m0, s53
    s_add_u32 s28, s49, s92
    buffer_load_dwordx4 v26, s[16:19], s28 offen lds
    s_add_u32 m0, m0, s53
    s_add_u32 s28, s49, s93
    buffer_load_dwordx4 v26, s[16:19], s28 offen lds
    s_add_u32 m0, m0, s53
    s_add_u32 s28, s49, s94
    buffer_load_dwordx4 v26, s[16:19], s28 offen lds
    s_add_u32 m0, m0, s53
    s_add_u32 s28, s49, s95
    buffer_load_dwordx4 v26, s[16:19], s28 offen lds
    s_add_u32 m0, s33, 8448
    s_mov_b32 s49, s50
    s_add_u32 s50, s50, s51
    s_add_u32 s82, s82, 1
    s_cmp_eq_u32 s82, 20
    s_cselect_b32 s29, s83, 0
    s_sub_u32 s50, s50, s29
    s_add_u32 s28, s49, s88
    buffer_load_dwordx4 v26, s[16:19], s28 offen lds
    s_add_u32 m0, m0, s53
    s_add_u32 s28, s49, s89
    buffer_load_dwordx4 v26, s[16:19], s28 offen lds
    s_add_u32 m0, m0, s53
    s_add_u32 s28, s49, s90
    buffer_load_dwordx4 v26, s[16:19], s28 offen lds
    s_add_u32 m0, m0, s53
    s_add_u32 s28, s49, s91
    buffer_load_dwordx4 v26, s[16:19], s28 offen lds
    s_add_u32 m0, m0, s53
    s_add_u32 s28, s49, s92
    buffer_load_dwordx4 v26, s[16:19], s28 offen lds
    s_add_u32 m0, m0, s53
    s_add_u32 s28, s49, s93
    buffer_load_dwordx4 v26, s[16:19], s28 offen lds
    s_add_u32 m0, m0, s53
    s_add_u32 s28, s49, s94
    buffer_load_dwordx4 v26, s[16:19], s28 offen lds
    s_add_u32 m0, m0, s53
    s_add_u32 s28, s49, s95
    buffer_load_dwordx4 v26, s[16:19], s28 offen lds
    s_add_u32 m0, s33, 16896
    s_mov_b32 s49, s50
    s_add_u32 s50, s50, s51
    s_add_u32 s82, s82, 1
    s_cmp_eq_u32 s82, 20
    s_cselect_b32 s29, s83, 0
    s_sub_u32 s50, s50, s29
    s_add_u32 s28, s49, s88
    buffer_load_dwordx4 v26, s[16:19], s28 offen lds
    s_add_u32 m0, m0, s53
    s_add_u32 s28, s49, s89
    buffer_load_dwordx4 v26, s[16:19], s28 offen lds
    s_add_u32 m0, m0, s53
    s_add_u32 s28, s49, s90
    buffer_load_dwordx4 v26, s[16:19], s28 offen lds
    s_add_u32 m0, m0, s53
    s_add_u32 s28, s49, s91
    buffer_load_dwordx4 v26, s[16:19], s28 offen lds
    s_add_u32 m0, m0, s53
    s_add_u32 s28, s49, s92
    buffer_load_dwordx4 v26, s[16:19], s28 offen lds
    s_add_u32 m0, m0, s53
    s_add_u32 s28, s49, s93
    buffer_load_dwordx4 v26, s[16:19], s28 offen lds
    s_add_u32 m0, m0, s53
    s_add_u32 s28, s49, s94
    buffer_load_dwordx4 v26, s[16:19], s28 offen lds
    s_add_u32 m0, m0, s53
    s_add_u32 s28, s49, s95
    buffer_load_dwordx4 v26, s[16:19], s28 offen lds
    s_add_u32 m0, s33, 25344
    s_mov_b32 s49, s50
    s_add_u32 s50, s50, s51
    s_add_u32 s82, s82, 1
    s_cmp_eq_u32 s82, 20
    s_cselect_b32 s29, s83, 0
    s_sub_u32 s50, s50, s29
    s_add_u32 s28, s49, s88
    buffer_load_dwordx4 v26, s[16:19], s28 offen lds
    s_add_u32 m0, m0, s53
    s_add_u32 s28, s49, s89
    buffer_load_dwordx4 v26, s[16:19], s28 offen lds
    s_add_u32 m0, m0, s53
    s_add_u32 s28, s49, s90
    buffer_load_dwordx4 v26, s[16:19], s28 offen lds
    s_add_u32 m0, m0, s53
    s_add_u32 s28, s49, s91
    buffer_load_dwordx4 v26, s[16:19], s28 offen lds
    s_add_u32 m0, m0, s53
    s_add_u32 s28, s49, s92
    buffer_load_dwordx4 v26, s[16:19], s28 offen lds
    s_add_u32 m0, m0, s53
    s_add_u32 s28, s49, s93
    buffer_load_dwordx4 v26, s[16:19], s28 offen lds
    s_add_u32 m0, m0, s53
    s_add_u32 s28, s49, s94
    buffer_load_dwordx4 v26, s[16:19], s28 offen lds
    s_add_u32 m0, m0, s53
    s_add_u32 s28, s49, s95
    buffer_load_dwordx4 v26, s[16:19], s28 offen lds
    s_waitcnt vmcnt(24) lgkmcnt(0)
    s_barrier
L_at_round:
    ds_read_b64_tr_b16 v[112:113], v11 offset:0
    ds_read_b64_tr_b16 v[114:115], v11 offset:256
    ds_read_b64_tr_b16 v[116:117], v11 offset:32
    ds_read_b64_tr_b16 v[118:119], v11 offset:288
    ds_read_b64_tr_b16 v[120:121], v11 offset:64
    ds_read_b64_tr_b16 v[122:123], v11 offset:320
    ds_read_b64_tr_b16 v[124:125], v11 offset:96
    ds_read_b64_tr_b16 v[126:127], v11 offset:352
    ds_read_b64_tr_b16 v[128:129], v11 offset:128
    ds_read_b64_tr_b16 v[130:131], v11 offset:384
    ds_read_b64_tr_b16 v[132:133], v11 offset:160
    ds_read_b64_tr_b16 v[134:135], v11 offset:416
    ds_read_b64_tr_b16 v[136:137], v11 offset:192
    ds_read_b64_tr_b16 v[138:139], v11 offset:448
    ds_read_b64_tr_b16 v[140:141], v11 offset:224
    ds_read_b64_tr_b16 v[142:143], v11 offset:480
    ds_read_b128 v[56:59], v27 offset:0
    ds_read_b128 v[60:63], v27 offset:1024
    ds_read_b128 v[64:67], v27 offset:2048
    ds_read_b128 v[68:71], v27 offset:3072
    ds_read_b128 v[72:75], v27 offset:4096
    ds_read_b128 v[76:79], v27 offset:5120
    ds_read_b128 v[80:83], v27 offset:6144
    s_waitcnt lgkmcnt(0)
    s_waitcnt lgkmcnt(14)
    v_mfma_f32_16x16x32_bf16 v[144:147], v[112:115], v[56:59], 0
    s_add_u32 m0, s33, 0
    v_mfma_f32_16x16x32_bf16 v[148:151], v[112:115], v[60:63], 0
    s_mov_b32 s49, s50
    v_mfma_f32_16x16x32_bf16 v[152:155], v[112:115], v[64:67], 0
    s_add_u32 s50, s50, s51
    v_mfma_f32_16x16x32_bf16 v[156:159], v[112:115], v[68:71], 0
    s_add_u32 s82, s82, 1
    v_mfma_f32_16x16x32_bf16 v[160:163], v[112:115], v[72:75], 0
    s_cmp_eq_u32 s82, 20
    v_mfma_f32_16x16x32_bf16 v[164:167], v[112:115], v[76:79], 0
    s_cselect_b32 s29, s83, 0
    v_mfma_f32_16x16x32_bf16 v[168:171], v[112:115], v[80:83], 0
    s_sub_u32 s50, s50, s29
    s_cmp_eq_u32 s68, 0
    s_cbranch_scc1 L_bw1_434
    s_sub_u32 s68, s68, 1
    s_waitcnt vmcnt(44) lgkmcnt(0)
    s_branch L_bw2_434
L_bw1_434:
    s_waitcnt vmcnt(16) lgkmcnt(0)
L_bw2_434:
    s_barrier
    s_cmp_le_u32 s21, s27
    s_cbranch_scc1 L_at_nofb_443
    s_sub_u32 s28, s21, 1
    s_cmp_eq_u32 s28, s23
    s_cbranch_scc1 L_at_nofb_443
    s_lshl_b32 s29, s28, 2
    s_add_u32 s29, s29, 76000
    v_mov_b32 v4, s29
    ds_read_b32 v4, v4
    s_waitcnt lgkmcnt(0)
    v_readfirstlane_b32 s29, v4
    s_nop 3
    s_cmp_lg_u32 s29, 0
    s_cbranch_scc1 L_at_fallback
L_at_nofb_443:
    ds_read_b64_tr_b16 v[112:113], v11 offset:8448
    v_mfma_f32_16x16x32_bf16 v[172:175], v[116:119], v[56:59], 0
    ds_read_b64_tr_b16 v[114:115], v11 offset:8704
    v_mfma_f32_16x16x32_bf16 v[176:179], v[116:119], v[60:63], 0
    ds_read_b128 v[28:31], v27 offset:8448
    v_mfma_f32_16x16x32_bf16 v[180:183], v[116:119], v[64:67], 0
    s_add_u32 s28, s49, s88
    buffer_load_dwordx4 v26, s[16:19], s28 offen lds
    v_mfma_f32_16x16x32_bf16 v[184:187], v[116:119], v[68:71], 0
    s_add_u32 m0, m0, s53
    ds_read_b128 v[32:35], v27 offset:9472
    v_mfma_f32_16x16x32_bf16 v[188:191], v[116:119], v[72:75], 0
    ds_read_b128 v[36:39], v27 offset:10496
    v_mfma_f32_16x16x32_bf16 v[192:195], v[116:119], v[76:79], 0
    ds_read_b128 v[40:43], v27 offset:11520
    v_mfma_f32_16x16x32_bf16 v[196:199], v[116:119], v[80:83], 0
    ds_read_b128 v[44:47], v27 offset:12544
    v_mfma_f32_16x16x32_bf16 v[200:203], v[120:123], v[56:59], 0
    ds_read_b128 v[48:51], v27 offset:13568
    v_mfma_f32_16x16x32_bf16 v[204:207], v[120:123], v[60:63], 0
    s_add_u32 s28, s49, s89
    buffer_load_dwordx4 v26, s[16:19], s28 offen lds
    v_mfma_f32_16x16x32_bf16 v[208:211], v[120:123], v[64:67], 0
    s_add_u32 m0, m0, s53
    ds_read_b128 v[52:55], v27 offset:14592
    v_mfma_f32_16x16x32_bf16 v[212:215], v[120:123], v[68:71], 0
    ds_read_b64_tr_b16 v[116:117], v11 offset:8480
    v_mfma_f32_16x16x32_bf16 v[216:219], v[120:123], v[72:75], 0
    ds_read_b64_tr_b16 v[118:119], v11 offset:8736
    v_mfma_f32_16x16x32_bf16 v[220:223], v[120:123], v[76:79], 0
    v_mfma_f32_16x16x32_bf16 v[224:227], v[120:123], v[80:83], 0
    ds_read_b64_tr_b16 v[120:121], v11 offset:8512
    v_mfma_f32_16x16x32_bf16 v[228:231], v[124:127], v[56:59], 0
    s_add_u32 s28, s49, s90
    buffer_load_dwordx4 v26, s[16:19], s28 offen lds
    v_mfma_f32_16x16x32_bf16 v[232:235], v[124:127], v[60:63], 0
    s_add_u32 m0, m0, s53
    ds_read_b64_tr_b16 v[122:123], v11 offset:8768
    v_mfma_f32_16x16x32_bf16 v[236:239], v[124:127], v[64:67], 0
    v_mfma_f32_16x16x32_bf16 v[240:243], v[124:127], v[68:71], 0
    v_mfma_f32_16x16x32_bf16 v[244:247], v[124:127], v[72:75], 0
    v_mfma_f32_16x16x32_bf16 v[248:251], v[124:127], v[76:79], 0
    v_mfma_f32_16x16x32_bf16 v[252:255], v[124:127], v[80:83], 0
    s_add_u32 s28, s49, s91
    buffer_load_dwordx4 v26, s[16:19], s28 offen lds
    v_mfma_f32_16x16x32_bf16 a[112:115], v[128:131], v[56:59], 0
    s_add_u32 m0, m0, s53
    ds_read_b64_tr_b16 v[124:125], v11 offset:8544
    v_mfma_f32_16x16x32_bf16 a[116:119], v[128:131], v[60:63], 0
    ds_read_b64_tr_b16 v[126:127], v11 offset:8800
    v_mfma_f32_16x16x32_bf16 a[120:123], v[128:131], v[64:67], 0
    v_mfma_f32_16x16x32_bf16 a[124:127], v[128:131], v[68:71], 0
    v_mfma_f32_16x16x32_bf16 a[128:131], v[128:131], v[72:75], 0
    v_mfma_f32_16x16x32_bf16 a[132:135], v[128:131], v[76:79], 0
    s_add_u32 s28, s49, s92
    buffer_load_dwordx4 v26, s[16:19], s28 offen lds
    v_mfma_f32_16x16x32_bf16 a[136:139], v[128:131], v[80:83], 0
    s_add_u32 m0, m0, s53
    ds_read_b64_tr_b16 v[128:129], v11 offset:8576
    v_mfma_f32_16x16x32_bf16 a[140:143], v[132:135], v[56:59], 0
    ds_read_b64_tr_b16 v[130:131], v11 offset:8832
    v_mfma_f32_16x16x32_bf16 a[144:147], v[132:135], v[60:63], 0
    v_mfma_f32_16x16x32_bf16 a[148:151], v[132:135], v[64:67], 0
    v_mfma_f32_16x16x32_bf16 a[152:155], v[132:135], v[68:71], 0
    v_mfma_f32_16x16x32_bf16 a[156:159], v[132:135], v[72:75], 0
    s_add_u32 s28, s49, s93
    buffer_load_dwordx4 v26, s[16:19], s28 offen lds
    v_mfma_f32_16x16x32_bf16 a[160:163], v[132:135], v[76:79], 0
    s_add_u32 m0, m0, s53
    v_mfma_f32_16x16x32_bf16 a[164:167], v[132:135], v[80:83], 0
    ds_read_b64_tr_b16 v[132:133], v11 offset:8608
    v_mfma_f32_16x16x32_bf16 a[168:171], v[136:139], v[56:59], 0
    ds_read_b64_tr_b16 v[134:135], v11 offset:8864
    v_mfma_f32_16x16x32_bf16 a[172:175], v[136:139], v[60:63], 0
    v_mfma_f32_16x16x32_bf16 a[176:179], v[136:139], v[64:67], 0
    v_mfma_f32_16x16x32_bf16 a[180:183], v[136:139], v[68:71], 0
    s_add_u32 s28, s49, s94
    buffer_load_dwordx4 v26, s[16:19], s28 offen lds
    v_mfma_f32_16x16x32_bf16 a[184:187], v[136:139], v[72:75], 0
    s_add_u32 m0, m0, s53
    v_mfma_f32_16x16x32_bf16 a[188:191], v[136:139], v[76:79], 0
    v_mfma_f32_16x16x32_bf16 a[192:195], v[136:139], v[80:83], 0
    ds_read_b64_tr_b16 v[136:137], v11 offset:8640
    v_mfma_f32_16x16x32_bf16 a[196:199], v[140:143], v[56:59], 0
    ds_read_b64_tr_b16 v[138:139], v11 offset:8896
    v_mfma_f32_16x16x32_bf16 a[200:203], v[140:143], v[60:63], 0
    v_mfma_f32_16x16x32_bf16 a[204:207], v[140:143], v[64:67], 0
    s_add_u32 s28, s49, s95
    buffer_load_dwordx4 v26, s[16:19], s28 offen lds
    v_mfma_f32_16x16x32_bf16 a[208:211], v[140:143], v[68:71], 0
    v_mfma_f32_16x16x32_bf16 a[212:215], v[140:143], v[72:75], 0
    v_mfma_f32_16x16x32_bf16 a[216:219], v[140:143], v[76:79], 0
    v_mfma_f32_16x16x32_bf16 a[220:223], v[140:143], v[80:83], 0
    ds_read_b64_tr_b16 v[140:141], v11 offset:8672
    ds_read_b64_tr_b16 v[142:143], v11 offset:8928
    s_waitcnt lgkmcnt(14)
    v_mfma_f32_16x16x32_bf16 v[144:147], v[112:115], v[28:31], v[144:147]
    s_add_u32 m0, s33, 8448
    v_mfma_f32_16x16x32_bf16 v[148:151], v[112:115], v[32:35], v[148:151]
    s_mov_b32 s49, s50
    v_mfma_f32_16x16x32_bf16 v[152:155], v[112:115], v[36:39], v[152:155]
    s_add_u32 s50, s50, s51
    v_mfma_f32_16x16x32_bf16 v[156:159], v[112:115], v[40:43], v[156:159]
    s_add_u32 s82, s82, 1
    v_mfma_f32_16x16x32_bf16 v[160:163], v[112:115], v[44:47], v[160:163]
    s_cmp_eq_u32 s82, 20
    v_mfma_f32_16x16x32_bf16 v[164:167], v[112:115], v[48:51], v[164:167]
    s_cselect_b32 s29, s83, 0
    v_mfma_f32_16x16x32_bf16 v[168:171], v[112:115], v[52:55], v[168:171]
    s_sub_u32 s50, s50, s29
    s_cmp_eq_u32 s68, 0
    s_cbranch_scc1 L_bw1_568
    s_sub_u32 s68, s68, 1
    s_waitcnt vmcnt(44) lgkmcnt(0)
    s_branch L_bw2_568
L_bw1_568:
    s_waitcnt vmcnt(16) lgkmcnt(0)
L_bw2_568:
    s_barrier
    ds_read_b64_tr_b16 v[112:113], v11 offset:16896
    v_mfma_f32_16x16x32_bf16 v[172:175], v[116:119], v[28:31], v[172:175]
    ds_read_b64_tr_b16 v[114:115], v11 offset:17152
    v_mfma_f32_16x16x32_bf16 v[176:179], v[116:119], v[32:35], v[176:179]
    ds_read_b128 v[56:59], v27 offset:16896
    v_mfma_f32_16x16x32_bf16 v[180:183], v[116:119], v[36:39], v[180:183]
    s_add_u32 s28, s49, s88
    buffer_load_dwordx4 v26, s[16:19], s28 offen lds
    v_mfma_f32_16x16x32_bf16 v[184:187], v[116:119], v[40:43], v[184:187]
    s_add_u32 m0, m0, s53
    ds_read_b128 v[60:63], v27 offset:17920
    v_mfma_f32_16x16x32_bf16 v[188:191], v[116:119], v[44:47], v[188:191]
    ds_read_b128 v[64:67], v27 offset:18944
    v_mfma_f32_16x16x32_bf16 v[192:195], v[116:119], v[48:51], v[192:195]
    ds_read_b128 v[68:71], v27 offset:19968
    v_mfma_f32_16x16x32_bf16 v[196:199], v[116:119], v[52:55], v[196:199]
    ds_read_b128 v[72:75], v27 offset:20992
    v_mfma_f32_16x16x32_bf16 v[200:203], v[120:123], v[28:31], v[200:203]
    ds_read_b128 v[76:79], v27 offset:22016
    v_mfma_f32_16x16x32_bf16 v[204:207], v[120:123], v[32:35], v[204:207]
    s_add_u32 s28, s49, s89
    buffer_load_dwordx4 v26, s[16:19], s28 offen lds
    v_mfma_f32_16x16x32_bf16 v[208:211], v[120:123], v[36:39], v[208:211]
    s_add_u32 m0, m0, s53
    ds_read_b128 v[80:83], v27 offset:23040
    v_mfma_f32_16x16x32_bf16 v[212:215], v[120:123], v[40:43], v[212:215]
    ds_read_b64_tr_b16 v[116:117], v11 offset:16928
    v_mfma_f32_16x16x32_bf16 v[216:219], v[120:123], v[44:47], v[216:219]
    ds_read_b64_tr_b16 v[118:119], v11 offset:17184
    v_mfma_f32_16x16x32_bf16 v[220:223], v[120:123], v[48:51], v[220:223]
    v_mfma_f32_16x16x32_bf16 v[224:227], v[120:123], v[52:55], v[224:227]
    ds_read_b64_tr_b16 v[120:121], v11 offset:16960
    v_mfma_f32_16x16x32_bf16 v[228:231], v[124:127], v[28:31], v[228:231]
    s_add_u32 s28, s49, s90
    buffer_load_dwordx4 v26, s[16:19], s28 offen lds
    v_mfma_f32_16x16x32_bf16 v[232:235], v[124:127], v[32:35], v[232:235]
    s_add_u32 m0, m0, s53
    ds_read_b64_tr_b16 v[122:123], v11 offset:17216
    v_mfma_f32_16x16x32_bf16 v[236:239], v[124:127], v[36:39], v[236:239]
    v_mfma_f32_16x16x32_bf16 v[240:243], v[124:127], v[40:43], v[240:243]
    v_mfma_f32_16x16x32_bf16 v[244:247], v[124:127], v[44:47], v[244:247]
    v_mfma_f32_16x16x32_bf16 v[248:251], v[124:127], v[48:51], v[248:251]
    v_mfma_f32_16x16x32_bf16 v[252:255], v[124:127], v[52:55], v[252:255]
    s_add_u32 s28, s49, s91
    buffer_load_dwordx4 v26, s[16:19], s28 offen lds
    v_mfma_f32_16x16x32_bf16 a[112:115], v[128:131], v[28:31], a[112:115]
    s_add_u32 m0, m0, s53
    ds_read_b64_tr_b16 v[124:125], v11 offset:16992
    v_mfma_f32_16x16x32_bf16 a[116:119], v[128:131], v[32:35], a[116:119]
    ds_read_b64_tr_b16 v[126:127], v11 offset:17248
    v_mfma_f32_16x16x32_bf16 a[120:123], v[128:131], v[36:39], a[120:123]
    v_mfma_f32_16x16x32_bf16 a[124:127], v[128:131], v[40:43], a[124:127]
    v_mfma_f32_16x16x32_bf16 a[128:131], v[128:131], v[44:47], a[128:131]
    v_mfma_f32_16x16x32_bf16 a[132:135], v[128:131], v[48:51], a[132:135]
    s_add_u32 s28, s49, s92
    buffer_load_dwordx4 v26, s[16:19], s28 offen lds
    v_mfma_f32_16x16x32_bf16 a[136:139], v[128:131], v[52:55], a[136:139]
    s_add_u32 m0, m0, s53
    ds_read_b64_tr_b16 v[128:129], v11 offset:17024
    v_mfma_f32_16x16x32_bf16 a[140:143], v[132:135], v[28:31], a[140:143]
    ds_read_b64_tr_b16 v[130:131], v11 offset:17280
    v_mfma_f32_16x16x32_bf16 a[144:147], v[132:135], v[32:35], a[144:147]
    v_mfma_f32_16x16x32_bf16 a[148:151], v[132:135], v[36:39], a[148:151]
    v_mfma_f32_16x16x32_bf16 a[152:155], v[132:135], v[40:43], a[152:155]
    v_mfma_f32_16x16x32_bf16 a[156:159], v[132:135], v[44:47], a[156:159]
    s_add_u32 s28, s49, s93
    buffer_load_dwordx4 v26, s[16:19], s28 offen lds
    v_mfma_f32_16x16x32_bf16 a[160:163], v[132:135], v[48:51], a[160:163]
    s_add_u32 m0, m0, s53
    v_mfma_f32_16x16x32_bf16 a[164:167], v[132:135], v[52:55], a[164:167]
    ds_read_b64_tr_b16 v[132:133], v11 offset:17056
    v_mfma_f32_16x16x32_bf16 a[168:171], v[136:139], v[28:31], a[168:171]
    ds_read_b64_tr_b16 v[134:135], v11 offset:17312
    v_mfma_f32_16x16x32_bf16 a[172:175], v[136:139], v[32:35], a[172:175]
    v_mfma_f32_16x16x32_bf16 a[176:179], v[136:139], v[36:39], a[176:179]
    v_mfma_f32_16x16x32_bf16 a[180:183], v[136:139], v[40:43], a[180:183]
    s_add_u32 s28, s49, s94
    buffer_load_dwordx4 v26, s[16:19], s28 offen lds
    v_mfma_f32_16x16x32_bf16 a[184:187], v[136:139], v[44:47], a[184:187]
    s_add_u32 m0, m0, s53
    v_mfma_f32_16x16x32_bf16 a[188:191], v[136:139], v[48:51], a[188:191]
    v_mfma_f32_16x16x32_bf16 a[192:195], v[136:139], v[52:55], a[192:195]
    ds_read_b64_tr_b16 v[136:137], v11 offset:17088
    v_mfma_f32_16x16x32_bf16 a[196:199], v[140:143], v[28:31], a[196:199]
    ds_read_b64_tr_b16 v[138:139], v11 offset:17344
    v_mfma_f32_16x16x32_bf16 a[200:203], v[140:143], v[32:35], a[200:203]
    v_mfma_f32_16x16x32_bf16 a[204:207], v[140:143], v[36:39], a[204:207]
    s_add_u32 s28, s49, s95
    buffer_load_dwordx4 v26, s[16:19], s28 offen lds
    v_mfma_f32_16x16x32_bf16 a[208:211], v[140:143], v[40:43], a[208:211]
    v_mfma_f32_16x16x32_bf16 a[212:215], v[140:143], v[44:47], a[212:215]
    v_mfma_f32_16x16x32_bf16 a[216:219], v[140:143], v[48:51], a[216:219]
    v_mfma_f32_16x16x32_bf16 a[220:223], v[140:143], v[52:55], a[220:223]
    ds_read_b64_tr_b16 v[140:141], v11 offset:17120
    ds_read_b64_tr_b16 v[142:143], v11 offset:17376
    s_waitcnt lgkmcnt(14)
    v_mfma_f32_16x16x32_bf16 v[144:147], v[112:115], v[56:59], v[144:147]
    s_add_u32 m0, s33, 16896
    v_mfma_f32_16x16x32_bf16 v[148:151], v[112:115], v[60:63], v[148:151]
    s_mov_b32 s49, s50
    v_mfma_f32_16x16x32_bf16 v[152:155], v[112:115], v[64:67], v[152:155]
    s_add_u32 s50, s50, s51
    v_mfma_f32_16x16x32_bf16 v[156:159], v[112:115], v[68:71], v[156:159]
    s_add_u32 s82, s82, 1
    v_mfma_f32_16x16x32_bf16 v[160:163], v[112:115], v[72:75], v[160:163]
    s_cmp_eq_u32 s82, 20
    v_mfma_f32_16x16x32_bf16 v[164:167], v[112:115], v[76:79], v[164:167]
    s_cselect_b32 s29, s83, 0
    v_mfma_f32_16x16x32_bf16 v[168:171], v[112:115], v[80:83], v[168:171]
    s_sub_u32 s50, s50, s29
    s_cmp_eq_u32 s68, 0
    s_cbranch_scc1 L_bw1_687
    s_sub_u32 s68, s68, 1
    s_waitcnt vmcnt(44) lgkmcnt(0)
    s_branch L_bw2_687
L_bw1_687:
    s_waitcnt vmcnt(16) lgkmcnt(0)
L_bw2_687:
    s_barrier
    ds_read_b64_tr_b16 v[112:113], v11 offset:25344
    v_mfma_f32_16x16x32_bf16 v[172:175], v[116:119], v[56:59], v[172:175]
    ds_read_b64_tr_b16 v[114:115], v11 offset:25600
    v_mfma_f32_16x16x32_bf16 v[176:179], v[116:119], v[60:63], v[176:179]
    ds_read_b128 v[28:31], v27 offset:25344
    v_mfma_f32_16x16x32_bf16 v[180:183], v[116:119], v[64:67], v[180:183]
    s_add_u32 s28, s49, s88
    buffer_load_dwordx4 v26, s[16:19], s28 offen lds
    v_mfma_f32_16x16x32_bf16 v[184:187], v[116:119], v[68:71], v[184:187]
    s_add_u32 m0, m0, s53
    ds_read_b128 v[32:35], v27 offset:26368
    v_mfma_f32_16x16x32_bf16 v[188:191], v[116:119], v[72:75], v[188:191]
    ds_read_b128 v[36:39], v27 offset:27392
    v_mfma_f32_16x16x32_bf16 v[192:195], v[116:119], v[76:79], v[192:195]
    ds_read_b128 v[40:43], v27 offset:28416
    v_mfma_f32_16x16x32_bf16 v[196:199], v[116:119], v[80:83], v[196:199]
    ds_read_b128 v[44:47], v27 offset:29440
    v_mfma_f32_16x16x32_bf16 v[200:203], v[120:123], v[56:59], v[200:203]
    ds_read_b128 v[48:51], v27 offset:30464
    v_mfma_f32_16x16x32_bf16 v[204:207], v[120:123], v[60:63], v[204:207]
    s_add_u32 s28, s49, s89
    buffer_load_dwordx4 v26, s[16:19], s28 offen lds
    v_mfma_f32_16x16x32_bf16 v[208:211], v[120:123], v[64:67], v[208:211]
    s_add_u32 m0, m0, s53
    ds_read_b128 v[52:55], v27 offset:31488
    v_mfma_f32_16x16x32_bf16 v[212:215], v[120:123], v[68:71], v[212:215]
    ds_read_b64_tr_b16 v[116:117], v11 offset:25376
    v_mfma_f32_16x16x32_bf16 v[216:219], v[120:123], v[72:75], v[216:219]
    ds_read_b64_tr_b16 v[118:119], v11 offset:25632
    v_mfma_f32_16x16x32_bf16 v[220:223], v[120:123], v[76:79], v[220:223]
    v_mfma_f32_16x16x32_bf16 v[224:227], v[120:123], v[80:83], v[224:227]
    ds_read_b64_tr_b16 v[120:121], v11 offset:25408
    v_mfma_f32_16x16x32_bf16 v[228:231], v[124:127], v[56:59], v[228:231]
    s_add_u32 s28, s49, s90
    buffer_load_dwordx4 v26, s[16:19], s28 offen lds
    v_mfma_f32_16x16x32_bf16 v[232:235], v[124:127], v[60:63], v[232:235]
    s_add_u32 m0, m0, s53
    ds_read_b64_tr_b16 v[122:123], v11 offset:25664
    v_mfma_f32_16x16x32_bf16 v[236:239], v[124:127], v[64:67], v[236:239]
    v_mfma_f32_16x16x32_bf16 v[240:243], v[124:127], v[68:71], v[240:243]
    v_mfma_f32_16x16x32_bf16 v[244:247], v[124:127], v[72:75], v[244:247]
    v_mfma_f32_16x16x32_bf16 v[248:251], v[124:127], v[76:79], v[248:251]
    v_mfma_f32_16x16x32_bf16 v[252:255], v[124:127], v[80:83], v[252:255]
    s_add_u32 s28, s49, s91
    buffer_load_dwordx4 v26, s[16:19], s28 offen lds
    v_mfma_f32_16x16x32_bf16 a[112:115], v[128:131], v[56:59], a[112:115]
    s_add_u32 m0, m0, s53
    ds_read_b64_tr_b16 v[124:125], v11 offset:25440
    v_mfma_f32_16x16x32_bf16 a[116:119], v[128:131], v[60:63], a[116:119]
    ds_read_b64_tr_b16 v[126:127], v11 offset:25696
    v_mfma_f32_16x16x32_bf16 a[120:123], v[128:131], v[64:67], a[120:123]
    v_mfma_f32_16x16x32_bf16 a[124:127], v[128:131], v[68:71], a[124:127]
    v_mfma_f32_16x16x32_bf16 a[128:131], v[128:131], v[72:75], a[128:131]
    v_mfma_f32_16x16x32_bf16 a[132:135], v[128:131], v[76:79], a[132:135]
    s_add_u32 s28, s49, s92
    buffer_load_dwordx4 v26, s[16:19], s28 offen lds
    v_mfma_f32_16x16x32_bf16 a[136:139], v[128:131], v[80:83], a[136:139]
    s_add_u32 m0, m0, s53
    ds_read_b64_tr_b16 v[128:129], v11 offset:25472
    v_mfma_f32_16x16x32_bf16 a[140:143], v[132:135], v[56:59], a[140:143]
    ds_read_b64_tr_b16 v[130:131], v11 offset:25728
    v_mfma_f32_16x16x32_bf16 a[144:147], v[132:135], v[60:63], a[144:147]
    v_mfma_f32_16x16x32_bf16 a[148:151], v[132:135], v[64:67], a[148:151]
    v_mfma_f32_16x16x32_bf16 a[152:155], v[132:135], v[68:71], a[152:155]
    v_mfma_f32_16x16x32_bf16 a[156:159], v[132:135], v[72:75], a[156:159]
    s_add_u32 s28, s49, s93
    buffer_load_dwordx4 v26, s[16:19], s28 offen lds
    v_mfma_f32_16x16x32_bf16 a[160:163], v[132:135], v[76:79], a[160:163]
    s_add_u32 m0, m0, s53
    v_mfma_f32_16x16x32_bf16 a[164:167], v[132:135], v[80:83], a[164:167]
    ds_read_b64_tr_b16 v[132:133], v11 offset:25504
    v_mfma_f32_16x16x32_bf16 a[168:171], v[136:139], v[56:59], a[168:171]
    ds_read_b64_tr_b16 v[134:135], v11 offset:25760
    v_mfma_f32_16x16x32_bf16 a[172:175], v[136:139], v[60:63], a[172:175]
    v_mfma_f32_16x16x32_bf16 a[176:179], v[136:139], v[64:67], a[176:179]
    v_mfma_f32_16x16x32_bf16 a[180:183], v[136:139], v[68:71], a[180:183]
    s_add_u32 s28, s49, s94
    buffer_load_dwordx4 v26, s[16:19], s28 offen lds
    v_mfma_f32_16x16x32_bf16 a[184:187], v[136:139], v[72:75], a[184:187]
    s_add_u32 m0, m0, s53
    v_mfma_f32_16x16x32_bf16 a[188:191], v[136:139], v[76:79], a[188:191]
    v_mfma_f32_16x16x32_bf16 a[192:195], v[136:139], v[80:83], a[192:195]
    ds_read_b64_tr_b16 v[136:137], v11 offset:25536
    v_mfma_f32_16x16x32_bf16 a[196:199], v[140:143], v[56:59], a[196:199]
    ds_read_b64_tr_b16 v[138:139], v11 offset:25792
    v_mfma_f32_16x16x32_bf16 a[200:203], v[140:143], v[60:63], a[200:203]
    v_mfma_f32_16x16x32_bf16 a[204:207], v[140:143], v[64:67], a[204:207]
    s_add_u32 s28, s49, s95
    buffer_load_dwordx4 v26, s[16:19], s28 offen lds
    v_mfma_f32_16x16x32_bf16 a[208:211], v[140:143], v[68:71], a[208:211]
    v_mfma_f32_16x16x32_bf16 a[212:215], v[140:143], v[72:75], a[212:215]
    v_mfma_f32_16x16x32_bf16 a[216:219], v[140:143], v[76:79], a[216:219]
    v_mfma_f32_16x16x32_bf16 a[220:223], v[140:143], v[80:83], a[220:223]
    ds_read_b64_tr_b16 v[140:141], v11 offset:25568
    ds_read_b64_tr_b16 v[142:143], v11 offset:25824
    s_waitcnt lgkmcnt(14)
    v_mfma_f32_16x16x32_bf16 v[144:147], v[112:115], v[28:31], v[144:147]
    s_add_u32 m0, s33, 25344
    v_mfma_f32_16x16x32_bf16 v[148:151], v[112:115], v[32:35], v[148:151]
    s_mov_b32 s49, s50
    v_mfma_f32_16x16x32_bf16 v[152:155], v[112:115], v[36:39], v[152:155]
    s_add_u32 s50, s50, s51
    v_mfma_f32_16x16x32_bf16 v[156:159], v[112:115], v[40:43], v[156:159]
    s_add_u32 s82, s82, 1
    v_mfma_f32_16x16x32_bf16 v[160:163], v[112:115], v[44:47], v[160:163]
    s_cmp_eq_u32 s82, 20
    v_mfma_f32_16x16x32_bf16 v[164:167], v[112:115], v[48:51], v[164:167]
    s_cselect_b32 s29, s83, 0
    v_mfma_f32_16x16x32_bf16 v[168:171], v[112:115], v[52:55], v[168:171]
    s_sub_u32 s50, s50, s29
    s_waitcnt vmcnt(16) lgkmcnt(0)
    s_barrier
    ds_read_b64_tr_b16 v[112:113], v11 offset:0
    v_mfma_f32_16x16x32_bf16 v[172:175], v[116:119], v[28:31], v[172:175]
    ds_read_b64_tr_b16 v[114:115], v11 offset:256
    v_mfma_f32_16x16x32_bf16 v[176:179], v[116:119], v[32:35], v[176:179]
    ds_read_b128 v[56:59], v27 offset:0
    v_mfma_f32_16x16x32_bf16 v[180:183], v[116:119], v[36:39], v[180:183]
    s_add_u32 s28, s49, s88
    buffer_load_dwordx4 v26, s[16:19], s28 offen lds
    v_mfma_f32_16x16x32_bf16 v[184:187], v[116:119], v[40:43], v[184:187]
    s_add_u32 m0, m0, s53
    ds_read_b128 v[60:63], v27 offset:1024
    v_mfma_f32_16x16x32_bf16 v[188:191], v[116:119], v[44:47], v[188:191]
    ds_read_b128 v[64:67], v27 offset:2048
    v_mfma_f32_16x16x32_bf16 v[192:195], v[116:119], v[48:51], v[192:195]
    ds_read_b128 v[68:71], v27 offset:3072
    v_mfma_f32_16x16x32_bf16 v[196:199], v[116:119], v[52:55], v[196:199]
    ds_read_b128 v[72:75], v27 offset:4096
    v_mfma_f32_16x16x32_bf16 v[200:203], v[120:123], v[28:31], v[200:203]
    ds_read_b128 v[76:79], v27 offset:5120
    v_mfma_f32_16x16x32_bf16 v[204:207], v[120:123], v[32:35], v[204:207]
    s_add_u32 s28, s49, s89
    buffer_load_dwordx4 v26, s[16:19], s28 offen lds
    v_mfma_f32_16x16x32_bf16 v[208:211], v[120:123], v[36:39], v[208:211]
    s_add_u32 m0, m0, s53
    ds_read_b128 v[80:83], v27 offset:6144
    v_mfma_f32_16x16x32_bf16 v[212:215], v[120:123], v[40:43], v[212:215]
    ds_read_b64_tr_b16 v[116:117], v11 offset:32
    v_mfma_f32_16x16x32_bf16 v[216:219], v[120:123], v[44:47], v[216:219]
    ds_read_b64_tr_b16 v[118:119], v11 offset:288
    v_mfma_f32_16x16x32_bf16 v[220:223], v[120:123], v[48:51], v[220:223]
    v_mfma_f32_16x16x32_bf16 v[224:227], v[120:123], v[52:55], v[224:227]
    ds_read_b64_tr_b16 v[120:121], v11 offset:64
    v_mfma_f32_16x16x32_bf16 v[228:231], v[124:127], v[28:31], v[228:231]
    s_add_u32 s28, s49, s90
    buffer_load_dwordx4 v26, s[16:19], s28 offen lds
    v_mfma_f32_16x16x32_bf16 v[232:235], v[124:127], v[32:35], v[232:235]
    s_add_u32 m0, m0, s53
    ds_read_b64_tr_b16 v[122:123], v11 offset:320
    v_mfma_f32_16x16x32_bf16 v[236:239], v[124:127], v[36:39], v[236:239]
    v_mfma_f32_16x16x32_bf16 v[240:243], v[124:127], v[40:43], v[240:243]
    v_mfma_f32_16x16x32_bf16 v[244:247], v[124:127], v[44:47], v[244:247]
    v_mfma_f32_16x16x32_bf16 v[248:251], v[124:127], v[48:51], v[248:251]
    v_mfma_f32_16x16x32_bf16 v[252:255], v[124:127], v[52:55], v[252:255]
    s_add_u32 s28, s49, s91
    buffer_load_dwordx4 v26, s[16:19], s28 offen lds
    v_mfma_f32_16x16x32_bf16 a[112:115], v[128:131], v[28:31], a[112:115]
    s_add_u32 m0, m0, s53
    ds_read_b64_tr_b16 v[124:125], v11 offset:96
    v_mfma_f32_16x16x32_bf16 a[116:119], v[128:131], v[32:35], a[116:119]
    ds_read_b64_tr_b16 v[126:127], v11 offset:352
    v_mfma_f32_16x16x32_bf16 a[120:123], v[128:131], v[36:39], a[120:123]
    v_mfma_f32_16x16x32_bf16 a[124:127], v[128:131], v[40:43], a[124:127]
    v_mfma_f32_16x16x32_bf16 a[128:131], v[128:131], v[44:47], a[128:131]
    v_mfma_f32_16x16x32_bf16 a[132:135], v[128:131], v[48:51], a[132:135]
    s_add_u32 s28, s49, s92
    buffer_load_dwordx4 v26, s[16:19], s28 offen lds
    v_mfma_f32_16x16x32_bf16 a[136:139], v[128:131], v[52:55], a[136:139]
    s_add_u32 m0, m0, s53
    ds_read_b64_tr_b16 v[128:129], v11 offset:128
    v_mfma_f32_16x16x32_bf16 a[140:143], v[132:135], v[28:31], a[140:143]
    ds_read_b64_tr_b16 v[130:131], v11 offset:384
    v_mfma_f32_16x16x32_bf16 a[144:147], v[132:135], v[32:35], a[144:147]
    v_mfma_f32_16x16x32_bf16 a[148:151], v[132:135], v[36:39], a[148:151]
    v_mfma_f32_16x16x32_bf16 a[152:155], v[132:135], v[40:43], a[152:155]
    v_mfma_f32_16x16x32_bf16 a[156:159], v[132:135], v[44:47], a[156:159]
    s_add_u32 s28, s49, s93
    buffer_load_dwordx4 v26, s[16:19], s28 offen lds
    v_mfma_f32_16x16x32_bf16 a[160:163], v[132:135], v[48:51], a[160:163]
    s_add_u32 m0, m0, s53
    v_mfma_f32_16x16x32_bf16 a[164:167], v[132:135], v[52:55], a[164:167]
    ds_read_b64_tr_b16 v[132:133], v11 offset:160
    v_mfma_f32_16x16x32_bf16 a[168:171], v[136:139], v[28:31], a[168:171]
    ds_read_b64_tr_b16 v[134:135], v11 offset:416
    v_mfma_f32_16x16x32_bf16 a[172:175], v[136:139], v[32:35], a[172:175]
    v_mfma_f32_16x16x32_bf16 a[176:179], v[136:139], v[36:39], a[176:179]
    v_mfma_f32_16x16x32_bf16 a[180:183], v[136:139], v[40:43], a[180:183]
    s_add_u32 s28, s49, s94
    buffer_load_dwordx4 v26, s[16:19], s28 offen lds
    v_mfma_f32_16x16x32_bf16 a[184:187], v[136:139], v[44:47], a[184:187]
    s_add_u32 m0, m0, s53
    v_mfma_f32_16x16x32_bf16 a[188:191], v[136:139], v[48:51], a[188:191]
    v_mfma_f32_16x16x32_bf16 a[192:195], v[136:139], v[52:55], a[192:195]
    ds_read_b64_tr_b16 v[136:137], v11 offset:192
    v_mfma_f32_16x16x32_bf16 a[196:199], v[140:143], v[28:31], a[196:199]
    ds_read_b64_tr_b16 v[138:139], v11 offset:448
    v_mfma_f32_16x16x32_bf16 a[200:203], v[140:143], v[32:35], a[200:203]
    v_mfma_f32_16x16x32_bf16 a[204:207], v[140:143], v[36:39], a[204:207]
    s_add_u32 s28, s49, s95
    buffer_load_dwordx4 v26, s[16:19], s28 offen lds
    v_mfma_f32_16x16x32_bf16 a[208:211], v[140:143], v[40:43], a[208:211]
    v_mfma_f32_16x16x32_bf16 a[212:215], v[140:143], v[44:47], a[212:215]
    v_mfma_f32_16x16x32_bf16 a[216:219], v[140:143], v[48:51], a[216:219]
    v_mfma_f32_16x16x32_bf16 a[220:223], v[140:143], v[52:55], a[220:223]
    ds_read_b64_tr_b16 v[140:141], v11 offset:224
    ds_read_b64_tr_b16 v[142:143], v11 offset:480
    s_cmp_lg_u32 s71, 0
    s_cbranch_scc1 L_at_nowo0
    s_mov_b32 s71, 1
    s_mov_b32 s28, 6554
    v_add_u32 v2, 0, v1
    v_mul_u32_u24 v3, s28, v2
    v_lshrrev_b32 v3, 16, v3
    v_mul_u32_u24 v4, 10, v3
    v_sub_u32 v4, v2, v4
    v_mul_u32_u24 v3, 1280, v3
    v_lshl_add_u32 v88, v4, 4, v3
    v_add_u32 v2, 64, v1
    v_mul_u32_u24 v3, s28, v2
    v_lshrrev_b32 v3, 16, v3
    v_mul_u32_u24 v4, 10, v3
    v_sub_u32 v4, v2, v4
    v_mul_u32_u24 v3, 1280, v3
    v_lshl_add_u32 v89, v4, 4, v3
    v_add_u32 v2, 128, v1
    v_mul_u32_u24 v3, s28, v2
    v_lshrrev_b32 v3, 16, v3
    v_mul_u32_u24 v4, 10, v3
    v_sub_u32 v4, v2, v4
    v_mul_u32_u24 v3, 1280, v3
    v_lshl_add_u32 v90, v4, 4, v3
    v_add_u32 v2, 192, v1
    v_mul_u32_u24 v3, s28, v2
    v_lshrrev_b32 v3, 16, v3
    v_mul_u32_u24 v4, 10, v3
    v_sub_u32 v4, v2, v4
    v_mul_u32_u24 v3, 1280, v3
    v_lshl_add_u32 v91, v4, 4, v3
    v_add_u32 v2, 256, v1
    v_mul_u32_u24 v3, s28, v2
    v_lshrrev_b32 v3, 16, v3
    v_mul_u32_u24 v4, 10, v3
    v_sub_u32 v4, v2, v4
    v_mul_u32_u24 v3, 1280, v3
    v_lshl_add_u32 v92, v4, 4, v3
    s_and_b32 s28, s2, 127
    s_mul_i32 s28, s28, 40960
    s_mul_i32 s29, s20, 320
    s_add_u32 s28, s28, s29
    s_add_u32 s28, s28, 0
    s_mul_i32 s31, s20, 7168
    s_add_u32 s31, s31, 135168
    s_add_u32 m0, s31, 0
    s_nop 0
    buffer_load_dwordx4 v88, s[84:87], s28 offen lds
    s_add_u32 m0, s31, 1024
    s_nop 0
    buffer_load_dwordx4 v89, s[84:87], s28 offen lds
    s_add_u32 m0, s31, 2048
    s_nop 0
    buffer_load_dwordx4 v90, s[84:87], s28 offen lds
    s_add_u32 m0, s31, 3072
    s_nop 0
    buffer_load_dwordx4 v91, s[84:87], s28 offen lds
    s_add_u32 m0, s31, 4096
    s_nop 0
    buffer_load_dwordx4 v92, s[84:87], s28 offen lds
L_at_nowo0:
    s_mov_b32 s22, 0
L_at_qploop:
    s_waitcnt lgkmcnt(14)
    v_mfma_f32_16x16x32_bf16 v[144:147], v[112:115], v[56:59], v[144:147]
    s_add_u32 m0, s33, 0
    v_mfma_f32_16x16x32_bf16 v[148:151], v[112:115], v[60:63], v[148:151]
    s_mov_b32 s49, s50
    v_mfma_f32_16x16x32_bf16 v[152:155], v[112:115], v[64:67], v[152:155]
    s_add_u32 s50, s50, s51
    v_mfma_f32_16x16x32_bf16 v[156:159], v[112:115], v[68:71], v[156:159]
    s_add_u32 s82, s82, 1
    v_mfma_f32_16x16x32_bf16 v[160:163], v[112:115], v[72:75], v[160:163]
    s_cmp_eq_u32 s82, 20
    v_mfma_f32_16x16x32_bf16 v[164:167], v[112:115], v[76:79], v[164:167]
    s_cselect_b32 s29, s83, 0
    v_mfma_f32_16x16x32_bf16 v[168:171], v[112:115], v[80:83], v[168:171]
    s_sub_u32 s50, s50, s29
    s_waitcnt vmcnt(16) lgkmcnt(0)
    s_barrier
    ds_read_b64_tr_b16 v[112:113], v11 offset:8448
    v_mfma_f32_16x16x32_bf16 v[172:175], v[116:119], v[56:59], v[172:175]
    ds_read_b64_tr_b16 v[114:115], v11 offset:8704
    v_mfma_f32_16x16x32_bf16 v[176:179], v[116:119], v[60:63], v[176:179]
    ds_read_b128 v[28:31], v27 offset:8448
    v_mfma_f32_16x16x32_bf16 v[180:183], v[116:119], v[64:67], v[180:183]
    s_add_u32 s28, s49, s88
    buffer_load_dwordx4 v26, s[16:19], s28 offen lds
    v_mfma_f32_16x16x32_bf16 v[184:187], v[116:119], v[68:71], v[184:187]
    s_add_u32 m0, m0, s53
    ds_read_b128 v[32:35], v27 offset:9472
    v_mfma_f32_16x16x32_bf16 v[188:191], v[116:119], v[72:75], v[188:191]
    ds_read_b128 v[36:39], v27 offset:10496
    v_mfma_f32_16x16x32_bf16 v[192:195], v[116:119], v[76:79], v[192:195]
    ds_read_b128 v[40:43], v27 offset:11520
    v_mfma_f32_16x16x32_bf16 v[196:199], v[116:119], v[80:83], v[196:199]
    ds_read_b128 v[44:47], v27 offset:12544
    v_mfma_f32_16x16x32_bf16 v[200:203], v[120:123], v[56:59], v[200:203]
    ds_read_b128 v[48:51], v27 offset:13568
    v_mfma_f32_16x16x32_bf16 v[204:207], v[120:123], v[60:63], v[204:207]
    s_add_u32 s28, s49, s89
    buffer_load_dwordx4 v26, s[16:19], s28 offen lds
    v_mfma_f32_16x16x32_bf16 v[208:211], v[120:123], v[64:67], v[208:211]
    s_add_u32 m0, m0, s53
    ds_read_b128 v[52:55], v27 offset:14592
    v_mfma_f32_16x16x32_bf16 v[212:215], v[120:123], v[68:71], v[212:215]
    ds_read_b64_tr_b16 v[116:117], v11 offset:8480
    v_mfma_f32_16x16x32_bf16 v[216:219], v[120:123], v[72:75], v[216:219]
    ds_read_b64_tr_b16 v[118:119], v11 offset:8736
    v_mfma_f32_16x16x32_bf16 v[220:223], v[120:123], v[76:79], v[220:223]
    v_mfma_f32_16x16x32_bf16 v[224:227], v[120:123], v[80:83], v[224:227]
    ds_read_b64_tr_b16 v[120:121], v11 offset:8512
    v_mfma_f32_16x16x32_bf16 v[228:231], v[124:127], v[56:59], v[228:231]
    s_add_u32 s28, s49, s90
    buffer_load_dwordx4 v26, s[16:19], s28 offen lds
    v_mfma_f32_16x16x32_bf16 v[232:235], v[124:127], v[60:63], v[232:235]
    s_add_u32 m0, m0, s53
    ds_read_b64_tr_b16 v[122:123], v11 offset:8768
    v_mfma_f32_16x16x32_bf16 v[236:239], v[124:127], v[64:67], v[236:239]
    v_mfma_f32_16x16x32_bf16 v[240:243], v[124:127], v[68:71], v[240:243]
    v_mfma_f32_16x16x32_bf16 v[244:247], v[124:127], v[72:75], v[244:247]
    v_mfma_f32_16x16x32_bf16 v[248:251], v[124:127], v[76:79], v[248:251]
    v_mfma_f32_16x16x32_bf16 v[252:255], v[124:127], v[80:83], v[252:255]
    s_add_u32 s28, s49, s91
    buffer_load_dwordx4 v26, s[16:19], s28 offen lds
    v_mfma_f32_16x16x32_bf16 a[112:115], v[128:131], v[56:59], a[112:115]
    s_add_u32 m0, m0, s53
    ds_read_b64_tr_b16 v[124:125], v11 offset:8544
    v_mfma_f32_16x16x32_bf16 a[116:119], v[128:131], v[60:63], a[116:119]
    ds_read_b64_tr_b16 v[126:127], v11 offset:8800
    v_mfma_f32_16x16x32_bf16 a[120:123], v[128:131], v[64:67], a[120:123]
    v_mfma_f32_16x16x32_bf16 a[124:127], v[128:131], v[68:71], a[124:127]
    v_mfma_f32_16x16x32_bf16 a[128:131], v[128:131], v[72:75], a[128:131]
    v_mfma_f32_16x16x32_bf16 a[132:135], v[128:131], v[76:79], a[132:135]
    s_add_u32 s28, s49, s92
    buffer_load_dwordx4 v26, s[16:19], s28 offen lds
    v_mfma_f32_16x16x32_bf16 a[136:139], v[128:131], v[80:83], a[136:139]
    s_add_u32 m0, m0, s53
    ds_read_b64_tr_b16 v[128:129], v11 offset:8576
    v_mfma_f32_16x16x32_bf16 a[140:143], v[132:135], v[56:59], a[140:143]
    ds_read_b64_tr_b16 v[130:131], v11 offset:8832
    v_mfma_f32_16x16x32_bf16 a[144:147], v[132:135], v[60:63], a[144:147]
    v_mfma_f32_16x16x32_bf16 a[148:151], v[132:135], v[64:67], a[148:151]
    v_mfma_f32_16x16x32_bf16 a[152:155], v[132:135], v[68:71], a[152:155]
    v_mfma_f32_16x16x32_bf16 a[156:159], v[132:135], v[72:75], a[156:159]
    s_add_u32 s28, s49, s93
    buffer_load_dwordx4 v26, s[16:19], s28 offen lds
    v_mfma_f32_16x16x32_bf16 a[160:163], v[132:135], v[76:79], a[160:163]
    s_add_u32 m0, m0, s53
    v_mfma_f32_16x16x32_bf16 a[164:167], v[132:135], v[80:83], a[164:167]
    ds_read_b64_tr_b16 v[132:133], v11 offset:8608
    v_mfma_f32_16x16x32_bf16 a[168:171], v[136:139], v[56:59], a[168:171]
    ds_read_b64_tr_b16 v[134:135], v11 offset:8864
    v_mfma_f32_16x16x32_bf16 a[172:175], v[136:139], v[60:63], a[172:175]
    v_mfma_f32_16x16x32_bf16 a[176:179], v[136:139], v[64:67], a[176:179]
    v_mfma_f32_16x16x32_bf16 a[180:183], v[136:139], v[68:71], a[180:183]
    s_add_u32 s28, s49, s94
    buffer_load_dwordx4 v26, s[16:19], s28 offen lds
    v_mfma_f32_16x16x32_bf16 a[184:187], v[136:139], v[72:75], a[184:187]
    s_add_u32 m0, m0, s53
    v_mfma_f32_16x16x32_bf16 a[188:191], v[136:139], v[76:79], a[188:191]
    v_mfma_f32_16x16x32_bf16 a[192:195], v[136:139], v[80:83], a[192:195]
    ds_read_b64_tr_b16 v[136:137], v11 offset:8640
    v_mfma_f32_16x16x32_bf16 a[196:199], v[140:143], v[56:59], a[196:199]
    ds_read_b64_tr_b16 v[138:139], v11 offset:8896
    v_mfma_f32_16x16x32_bf16 a[200:203], v[140:143], v[60:63], a[200:203]
    v_mfma_f32_16x16x32_bf16 a[204:207], v[140:143], v[64:67], a[204:207]
    s_add_u32 s28, s49, s95
    buffer_load_dwordx4 v26, s[16:19], s28 offen lds
    v_mfma_f32_16x16x32_bf16 a[208:211], v[140:143], v[68:71], a[208:211]
    v_mfma_f32_16x16x32_bf16 a[212:215], v[140:143], v[72:75], a[212:215]
    v_mfma_f32_16x16x32_bf16 a[216:219], v[140:143], v[76:79], a[216:219]
    v_mfma_f32_16x16x32_bf16 a[220:223], v[140:143], v[80:83], a[220:223]
    ds_read_b64_tr_b16 v[140:141], v11 offset:8672
    ds_read_b64_tr_b16 v[142:143], v11 offset:8928
    s_waitcnt lgkmcnt(14)
    v_mfma_f32_16x16x32_bf16 v[144:147], v[112:115], v[28:31], v[144:147]
    s_add_u32 m0, s33, 8448
    v_mfma_f32_16x16x32_bf16 v[148:151], v[112:115], v[32:35], v[148:151]
    s_mov_b32 s49, s50
    v_mfma_f32_16x16x32_bf16 v[152:155], v[112:115], v[36:39], v[152:155]
    s_add_u32 s50, s50, s51
    v_mfma_f32_16x16x32_bf16 v[156:159], v[112:115], v[40:43], v[156:159]
    s_add_u32 s82, s82, 1
    v_mfma_f32_16x16x32_bf16 v[160:163], v[112:115], v[44:47], v[160:163]
    s_cmp_eq_u32 s82, 20
    v_mfma_f32_16x16x32_bf16 v[164:167], v[112:115], v[48:51], v[164:167]
    s_cselect_b32 s29, s83, 0
    v_mfma_f32_16x16x32_bf16 v[168:171], v[112:115], v[52:55], v[168:171]
    s_sub_u32 s50, s50, s29
    s_waitcnt vmcnt(16) lgkmcnt(0)
    s_barrier
    ds_read_b64_tr_b16 v[112:113], v11 offset:16896
    v_mfma_f32_16x16x32_bf16 v[172:175], v[116:119], v[28:31], v[172:175]
    ds_read_b64_tr_b16 v[114:115], v11 offset:17152
    v_mfma_f32_16x16x32_bf16 v[176:179], v[116:119], v[32:35], v[176:179]
    ds_read_b128 v[56:59], v27 offset:16896
    v_mfma_f32_16x16x32_bf16 v[180:183], v[116:119], v[36:39], v[180:183]
    s_add_u32 s28, s49, s88
    buffer_load_dwordx4 v26, s[16:19], s28 offen lds
    v_mfma_f32_16x16x32_bf16 v[184:187], v[116:119], v[40:43], v[184:187]
    s_add_u32 m0, m0, s53
    ds_read_b128 v[60:63], v27 offset:17920
    v_mfma_f32_16x16x32_bf16 v[188:191], v[116:119], v[44:47], v[188:191]
    ds_read_b128 v[64:67], v27 offset:18944
    v_mfma_f32_16x16x32_bf16 v[192:195], v[116:119], v[48:51], v[192:195]
    ds_read_b128 v[68:71], v27 offset:19968
    v_mfma_f32_16x16x32_bf16 v[196:199], v[116:119], v[52:55], v[196:199]
    ds_read_b128 v[72:75], v27 offset:20992
    v_mfma_f32_16x16x32_bf16 v[200:203], v[120:123], v[28:31], v[200:203]
    ds_read_b128 v[76:79], v27 offset:22016
    v_mfma_f32_16x16x32_bf16 v[204:207], v[120:123], v[32:35], v[204:207]
    s_add_u32 s28, s49, s89
    buffer_load_dwordx4 v26, s[16:19], s28 offen lds
    v_mfma_f32_16x16x32_bf16 v[208:211], v[120:123], v[36:39], v[208:211]
    s_add_u32 m0, m0, s53
    ds_read_b128 v[80:83], v27 offset:23040
    v_mfma_f32_16x16x32_bf16 v[212:215], v[120:123], v[40:43], v[212:215]
    ds_read_b64_tr_b16 v[116:117], v11 offset:16928
    v_mfma_f32_16x16x32_bf16 v[216:219], v[120:123], v[44:47], v[216:219]
    ds_read_b64_tr_b16 v[118:119], v11 offset:17184
    v_mfma_f32_16x16x32_bf16 v[220:223], v[120:123], v[48:51], v[220:223]
    v_mfma_f32_16x16x32_bf16 v[224:227], v[120:123], v[52:55], v[224:227]
    ds_read_b64_tr_b16 v[120:121], v11 offset:16960
    v_mfma_f32_16x16x32_bf16 v[228:231], v[124:127], v[28:31], v[228:231]
    s_add_u32 s28, s49, s90
    buffer_load_dwordx4 v26, s[16:19], s28 offen lds
    v_mfma_f32_16x16x32_bf16 v[232:235], v[124:127], v[32:35], v[232:235]
    s_add_u32 m0, m0, s53
    ds_read_b64_tr_b16 v[122:123], v11 offset:17216
    v_mfma_f32_16x16x32_bf16 v[236:239], v[124:127], v[36:39], v[236:239]
    v_mfma_f32_16x16x32_bf16 v[240:243], v[124:127], v[40:43], v[240:243]
    v_mfma_f32_16x16x32_bf16 v[244:247], v[124:127], v[44:47], v[244:247]
    v_mfma_f32_16x16x32_bf16 v[248:251], v[124:127], v[48:51], v[248:251]
    v_mfma_f32_16x16x32_bf16 v[252:255], v[124:127], v[52:55], v[252:255]
    s_add_u32 s28, s49, s91
    buffer_load_dwordx4 v26, s[16:19], s28 offen lds
    v_mfma_f32_16x16x32_bf16 a[112:115], v[128:131], v[28:31], a[112:115]
    s_add_u32 m0, m0, s53
    ds_read_b64_tr_b16 v[124:125], v11 offset:16992
    v_mfma_f32_16x16x32_bf16 a[116:119], v[128:131], v[32:35], a[116:119]
    ds_read_b64_tr_b16 v[126:127], v11 offset:17248
    v_mfma_f32_16x16x32_bf16 a[120:123], v[128:131], v[36:39], a[120:123]
    v_mfma_f32_16x16x32_bf16 a[124:127], v[128:131], v[40:43], a[124:127]
    v_mfma_f32_16x16x32_bf16 a[128:131], v[128:131], v[44:47], a[128:131]
    v_mfma_f32_16x16x32_bf16 a[132:135], v[128:131], v[48:51], a[132:135]
    s_add_u32 s28, s49, s92
    buffer_load_dwordx4 v26, s[16:19], s28 offen lds
    v_mfma_f32_16x16x32_bf16 a[136:139], v[128:131], v[52:55], a[136:139]
    s_add_u32 m0, m0, s53
    ds_read_b64_tr_b16 v[128:129], v11 offset:17024
    v_mfma_f32_16x16x32_bf16 a[140:143], v[132:135], v[28:31], a[140:143]
    ds_read_b64_tr_b16 v[130:131], v11 offset:17280
    v_mfma_f32_16x16x32_bf16 a[144:147], v[132:135], v[32:35], a[144:147]
    v_mfma_f32_16x16x32_bf16 a[148:151], v[132:135], v[36:39], a[148:151]
    v_mfma_f32_16x16x32_bf16 a[152:155], v[132:135], v[40:43], a[152:155]
    v_mfma_f32_16x16x32_bf16 a[156:159], v[132:135], v[44:47], a[156:159]
    s_add_u32 s28, s49, s93
    buffer_load_dwordx4 v26, s[16:19], s28 offen lds
    v_mfma_f32_16x16x32_bf16 a[160:163], v[132:135], v[48:51], a[160:163]
    s_add_u32 m0, m0, s53
    v_mfma_f32_16x16x32_bf16 a[164:167], v[132:135], v[52:55], a[164:167]
    ds_read_b64_tr_b16 v[132:133], v11 offset:17056
    v_mfma_f32_16x16x32_bf16 a[168:171], v[136:139], v[28:31], a[168:171]
    ds_read_b64_tr_b16 v[134:135], v11 offset:17312
    v_mfma_f32_16x16x32_bf16 a[172:175], v[136:139], v[32:35], a[172:175]
    v_mfma_f32_16x16x32_bf16 a[176:179], v[136:139], v[36:39], a[176:179]
    v_mfma_f32_16x16x32_bf16 a[180:183], v[136:139], v[40:43], a[180:183]
    s_add_u32 s28, s49, s94
    buffer_load_dwordx4 v26, s[16:19], s28 offen lds
    v_mfma_f32_16x16x32_bf16 a[184:187], v[136:139], v[44:47], a[184:187]
    s_add_u32 m0, m0, s53
    v_mfma_f32_16x16x32_bf16 a[188:191], v[136:139], v[48:51], a[188:191]
    v_mfma_f32_16x16x32_bf16 a[192:195], v[136:139], v[52:55], a[192:195]
    ds_read_b64_tr_b16 v[136:137], v11 offset:17088
    v_mfma_f32_16x16x32_bf16 a[196:199], v[140:143], v[28:31], a[196:199]
    ds_read_b64_tr_b16 v[138:139], v11 offset:17344
    v_mfma_f32_16x16x32_bf16 a[200:203], v[140:143], v[32:35], a[200:203]
    v_mfma_f32_16x16x32_bf16 a[204:207], v[140:143], v[36:39], a[204:207]
    s_add_u32 s28, s49, s95
    buffer_load_dwordx4 v26, s[16:19], s28 offen lds
    v_mfma_f32_16x16x32_bf16 a[208:211], v[140:143], v[40:43], a[208:211]
    v_mfma_f32_16x16x32_bf16 a[212:215], v[140:143], v[44:47], a[212:215]
    v_mfma_f32_16x16x32_bf16 a[216:219], v[140:143], v[48:51], a[216:219]
    v_mfma_f32_16x16x32_bf16 a[220:223], v[140:143], v[52:55], a[220:223]
    ds_read_b64_tr_b16 v[140:141], v11 offset:17120
    ds_read_b64_tr_b16 v[142:143], v11 offset:17376
    s_waitcnt lgkmcnt(14)
    v_mfma_f32_16x16x32_bf16 v[144:147], v[112:115], v[56:59], v[144:147]
    s_add_u32 m0, s33, 16896
    v_mfma_f32_16x16x32_bf16 v[148:151], v[112:115], v[60:63], v[148:151]
    s_mov_b32 s49, s50
    v_mfma_f32_16x16x32_bf16 v[152:155], v[112:115], v[64:67], v[152:155]
    s_add_u32 s50, s50, s51
    v_mfma_f32_16x16x32_bf16 v[156:159], v[112:115], v[68:71], v[156:159]
    s_add_u32 s82, s82, 1
    v_mfma_f32_16x16x32_bf16 v[160:163], v[112:115], v[72:75], v[160:163]
    s_cmp_eq_u32 s82, 20
    v_mfma_f32_16x16x32_bf16 v[164:167], v[112:115], v[76:79], v[164:167]
    s_cselect_b32 s29, s83, 0
    v_mfma_f32_16x16x32_bf16 v[168:171], v[112:115], v[80:83], v[168:171]
    s_sub_u32 s50, s50, s29
    s_waitcnt vmcnt(16) lgkmcnt(0)
    s_barrier
    ds_read_b64_tr_b16 v[112:113], v11 offset:25344
    v_mfma_f32_16x16x32_bf16 v[172:175], v[116:119], v[56:59], v[172:175]
    ds_read_b64_tr_b16 v[114:115], v11 offset:25600
    v_mfma_f32_16x16x32_bf16 v[176:179], v[116:119], v[60:63], v[176:179]
    ds_read_b128 v[28:31], v27 offset:25344
    v_mfma_f32_16x16x32_bf16 v[180:183], v[116:119], v[64:67], v[180:183]
    s_add_u32 s28, s49, s88
    buffer_load_dwordx4 v26, s[16:19], s28 offen lds
    v_mfma_f32_16x16x32_bf16 v[184:187], v[116:119], v[68:71], v[184:187]
    s_add_u32 m0, m0, s53
    ds_read_b128 v[32:35], v27 offset:26368
    v_mfma_f32_16x16x32_bf16 v[188:191], v[116:119], v[72:75], v[188:191]
    ds_read_b128 v[36:39], v27 offset:27392
    v_mfma_f32_16x16x32_bf16 v[192:195], v[116:119], v[76:79], v[192:195]
    ds_read_b128 v[40:43], v27 offset:28416
    v_mfma_f32_16x16x32_bf16 v[196:199], v[116:119], v[80:83], v[196:199]
    ds_read_b128 v[44:47], v27 offset:29440
    v_mfma_f32_16x16x32_bf16 v[200:203], v[120:123], v[56:59], v[200:203]
    ds_read_b128 v[48:51], v27 offset:30464
    v_mfma_f32_16x16x32_bf16 v[204:207], v[120:123], v[60:63], v[204:207]
    s_add_u32 s28, s49, s89
    buffer_load_dwordx4 v26, s[16:19], s28 offen lds
    v_mfma_f32_16x16x32_bf16 v[208:211], v[120:123], v[64:67], v[208:211]
    s_add_u32 m0, m0, s53
    ds_read_b128 v[52:55], v27 offset:31488
    v_mfma_f32_16x16x32_bf16 v[212:215], v[120:123], v[68:71], v[212:215]
    ds_read_b64_tr_b16 v[116:117], v11 offset:25376
    v_mfma_f32_16x16x32_bf16 v[216:219], v[120:123], v[72:75], v[216:219]
    ds_read_b64_tr_b16 v[118:119], v11 offset:25632
    v_mfma_f32_16x16x32_bf16 v[220:223], v[120:123], v[76:79], v[220:223]
    v_mfma_f32_16x16x32_bf16 v[224:227], v[120:123], v[80:83], v[224:227]
    ds_read_b64_tr_b16 v[120:121], v11 offset:25408
    v_mfma_f32_16x16x32_bf16 v[228:231], v[124:127], v[56:59], v[228:231]
    s_add_u32 s28, s49, s90
    buffer_load_dwordx4 v26, s[16:19], s28 offen lds
    v_mfma_f32_16x16x32_bf16 v[232:235], v[124:127], v[60:63], v[232:235]
    s_add_u32 m0, m0, s53
    ds_read_b64_tr_b16 v[122:123], v11 offset:25664
    v_mfma_f32_16x16x32_bf16 v[236:239], v[124:127], v[64:67], v[236:239]
    v_mfma_f32_16x16x32_bf16 v[240:243], v[124:127], v[68:71], v[240:243]
    v_mfma_f32_16x16x32_bf16 v[244:247], v[124:127], v[72:75], v[244:247]
    v_mfma_f32_16x16x32_bf16 v[248:251], v[124:127], v[76:79], v[248:251]
    v_mfma_f32_16x16x32_bf16 v[252:255], v[124:127], v[80:83], v[252:255]
    s_add_u32 s28, s49, s91
    buffer_load_dwordx4 v26, s[16:19], s28 offen lds
    v_mfma_f32_16x16x32_bf16 a[112:115], v[128:131], v[56:59], a[112:115]
    s_add_u32 m0, m0, s53
    ds_read_b64_tr_b16 v[124:125], v11 offset:25440
    v_mfma_f32_16x16x32_bf16 a[116:119], v[128:131], v[60:63], a[116:119]
    ds_read_b64_tr_b16 v[126:127], v11 offset:25696
    v_mfma_f32_16x16x32_bf16 a[120:123], v[128:131], v[64:67], a[120:123]
    v_mfma_f32_16x16x32_bf16 a[124:127], v[128:131], v[68:71], a[124:127]
    v_mfma_f32_16x16x32_bf16 a[128:131], v[128:131], v[72:75], a[128:131]
    v_mfma_f32_16x16x32_bf16 a[132:135], v[128:131], v[76:79], a[132:135]
    s_add_u32 s28, s49, s92
    buffer_load_dwordx4 v26, s[16:19], s28 offen lds
    v_mfma_f32_16x16x32_bf16 a[136:139], v[128:131], v[80:83], a[136:139]
    s_add_u32 m0, m0, s53
    ds_read_b64_tr_b16 v[128:129], v11 offset:25472
    v_mfma_f32_16x16x32_bf16 a[140:143], v[132:135], v[56:59], a[140:143]
    ds_read_b64_tr_b16 v[130:131], v11 offset:25728
    v_mfma_f32_16x16x32_bf16 a[144:147], v[132:135], v[60:63], a[144:147]
    v_mfma_f32_16x16x32_bf16 a[148:151], v[132:135], v[64:67], a[148:151]
    v_mfma_f32_16x16x32_bf16 a[152:155], v[132:135], v[68:71], a[152:155]
    v_mfma_f32_16x16x32_bf16 a[156:159], v[132:135], v[72:75], a[156:159]
    s_add_u32 s28, s49, s93
    buffer_load_dwordx4 v26, s[16:19], s28 offen lds
    v_mfma_f32_16x16x32_bf16 a[160:163], v[132:135], v[76:79], a[160:163]
    s_add_u32 m0, m0, s53
    v_mfma_f32_16x16x32_bf16 a[164:167], v[132:135], v[80:83], a[164:167]
    ds_read_b64_tr_b16 v[132:133], v11 offset:25504
    v_mfma_f32_16x16x32_bf16 a[168:171], v[136:139], v[56:59], a[168:171]
    ds_read_b64_tr_b16 v[134:135], v11 offset:25760
    v_mfma_f32_16x16x32_bf16 a[172:175], v[136:139], v[60:63], a[172:175]
    v_mfma_f32_16x16x32_bf16 a[176:179], v[136:139], v[64:67], a[176:179]
    v_mfma_f32_16x16x32_bf16 a[180:183], v[136:139], v[68:71], a[180:183]
    s_add_u32 s28, s49, s94
    buffer_load_dwordx4 v26, s[16:19], s28 offen lds
    v_mfma_f32_16x16x32_bf16 a[184:187], v[136:139], v[72:75], a[184:187]
    s_add_u32 m0, m0, s53
    v_mfma_f32_16x16x32_bf16 a[188:191], v[136:139], v[76:79], a[188:191]
    v_mfma_f32_16x16x32_bf16 a[192:195], v[136:139], v[80:83], a[192:195]
    ds_read_b64_tr_b16 v[136:137], v11 offset:25536
    v_mfma_f32_16x16x32_bf16 a[196:199], v[140:143], v[56:59], a[196:199]
    ds_read_b64_tr_b16 v[138:139], v11 offset:25792
    v_mfma_f32_16x16x32_bf16 a[200:203], v[140:143], v[60:63], a[200:203]
    v_mfma_f32_16x16x32_bf16 a[204:207], v[140:143], v[64:67], a[204:207]
    s_add_u32 s28, s49, s95
    buffer_load_dwordx4 v26, s[16:19], s28 offen lds
    v_mfma_f32_16x16x32_bf16 a[208:211], v[140:143], v[68:71], a[208:211]
    v_mfma_f32_16x16x32_bf16 a[212:215], v[140:143], v[72:75], a[212:215]
    v_mfma_f32_16x16x32_bf16 a[216:219], v[140:143], v[76:79], a[216:219]
    v_mfma_f32_16x16x32_bf16 a[220:223], v[140:143], v[80:83], a[220:223]
    ds_read_b64_tr_b16 v[140:141], v11 offset:25568
    ds_read_b64_tr_b16 v[142:143], v11 offset:25824
    s_waitcnt lgkmcnt(14)
    v_mfma_f32_16x16x32_bf16 v[144:147], v[112:115], v[28:31], v[144:147]
    s_add_u32 m0, s33, 25344
    v_mfma_f32_16x16x32_bf16 v[148:151], v[112:115], v[32:35], v[148:151]
    s_mov_b32 s49, s50
    v_mfma_f32_16x16x32_bf16 v[152:155], v[112:115], v[36:39], v[152:155]
    s_add_u32 s50, s50, s51
    v_mfma_f32_16x16x32_bf16 v[156:159], v[112:115], v[40:43], v[156:159]
    s_add_u32 s82, s82, 1
    v_mfma_f32_16x16x32_bf16 v[160:163], v[112:115], v[44:47], v[160:163]
    s_cmp_eq_u32 s82, 20
    v_mfma_f32_16x16x32_bf16 v[164:167], v[112:115], v[48:51], v[164:167]
    s_cselect_b32 s29, s83, 0
    v_mfma_f32_16x16x32_bf16 v[168:171], v[112:115], v[52:55], v[168:171]
    s_sub_u32 s50, s50, s29
    s_waitcnt vmcnt(16) lgkmcnt(0)
    s_barrier
    ds_read_b64_tr_b16 v[112:113], v11 offset:0
    v_mfma_f32_16x16x32_bf16 v[172:175], v[116:119], v[28:31], v[172:175]
    ds_read_b64_tr_b16 v[114:115], v11 offset:256
    v_mfma_f32_16x16x32_bf16 v[176:179], v[116:119], v[32:35], v[176:179]
    ds_read_b128 v[56:59], v27 offset:0
    v_mfma_f32_16x16x32_bf16 v[180:183], v[116:119], v[36:39], v[180:183]
    s_add_u32 s28, s49, s88
    buffer_load_dwordx4 v26, s[16:19], s28 offen lds
    v_mfma_f32_16x16x32_bf16 v[184:187], v[116:119], v[40:43], v[184:187]
    s_add_u32 m0, m0, s53
    ds_read_b128 v[60:63], v27 offset:1024
    v_mfma_f32_16x16x32_bf16 v[188:191], v[116:119], v[44:47], v[188:191]
    ds_read_b128 v[64:67], v27 offset:2048
    v_mfma_f32_16x16x32_bf16 v[192:195], v[116:119], v[48:51], v[192:195]
    ds_read_b128 v[68:71], v27 offset:3072
    v_mfma_f32_16x16x32_bf16 v[196:199], v[116:119], v[52:55], v[196:199]
    ds_read_b128 v[72:75], v27 offset:4096
    v_mfma_f32_16x16x32_bf16 v[200:203], v[120:123], v[28:31], v[200:203]
    ds_read_b128 v[76:79], v27 offset:5120
    v_mfma_f32_16x16x32_bf16 v[204:207], v[120:123], v[32:35], v[204:207]
    s_add_u32 s28, s49, s89
    buffer_load_dwordx4 v26, s[16:19], s28 offen lds
    v_mfma_f32_16x16x32_bf16 v[208:211], v[120:123], v[36:39], v[208:211]
    s_add_u32 m0, m0, s53
    ds_read_b128 v[80:83], v27 offset:6144
    v_mfma_f32_16x16x32_bf16 v[212:215], v[120:123], v[40:43], v[212:215]
    ds_read_b64_tr_b16 v[116:117], v11 offset:32
    v_mfma_f32_16x16x32_bf16 v[216:219], v[120:123], v[44:47], v[216:219]
    ds_read_b64_tr_b16 v[118:119], v11 offset:288
    v_mfma_f32_16x16x32_bf16 v[220:223], v[120:123], v[48:51], v[220:223]
    v_mfma_f32_16x16x32_bf16 v[224:227], v[120:123], v[52:55], v[224:227]
    ds_read_b64_tr_b16 v[120:121], v11 offset:64
    v_mfma_f32_16x16x32_bf16 v[228:231], v[124:127], v[28:31], v[228:231]
    s_add_u32 s28, s49, s90
    buffer_load_dwordx4 v26, s[16:19], s28 offen lds
    v_mfma_f32_16x16x32_bf16 v[232:235], v[124:127], v[32:35], v[232:235]
    s_add_u32 m0, m0, s53
    ds_read_b64_tr_b16 v[122:123], v11 offset:320
    v_mfma_f32_16x16x32_bf16 v[236:239], v[124:127], v[36:39], v[236:239]
    v_mfma_f32_16x16x32_bf16 v[240:243], v[124:127], v[40:43], v[240:243]
    v_mfma_f32_16x16x32_bf16 v[244:247], v[124:127], v[44:47], v[244:247]
    v_mfma_f32_16x16x32_bf16 v[248:251], v[124:127], v[48:51], v[248:251]
    v_mfma_f32_16x16x32_bf16 v[252:255], v[124:127], v[52:55], v[252:255]
    s_add_u32 s28, s49, s91
    buffer_load_dwordx4 v26, s[16:19], s28 offen lds
    v_mfma_f32_16x16x32_bf16 a[112:115], v[128:131], v[28:31], a[112:115]
    s_add_u32 m0, m0, s53
    ds_read_b64_tr_b16 v[124:125], v11 offset:96
    v_mfma_f32_16x16x32_bf16 a[116:119], v[128:131], v[32:35], a[116:119]
    ds_read_b64_tr_b16 v[126:127], v11 offset:352
    v_mfma_f32_16x16x32_bf16 a[120:123], v[128:131], v[36:39], a[120:123]
    v_mfma_f32_16x16x32_bf16 a[124:127], v[128:131], v[40:43], a[124:127]
    v_mfma_f32_16x16x32_bf16 a[128:131], v[128:131], v[44:47], a[128:131]
    v_mfma_f32_16x16x32_bf16 a[132:135], v[128:131], v[48:51], a[132:135]
    s_add_u32 s28, s49, s92
    buffer_load_dwordx4 v26, s[16:19], s28 offen lds
    v_mfma_f32_16x16x32_bf16 a[136:139], v[128:131], v[52:55], a[136:139]
    s_add_u32 m0, m0, s53
    ds_read_b64_tr_b16 v[128:129], v11 offset:128
    v_mfma_f32_16x16x32_bf16 a[140:143], v[132:135], v[28:31], a[140:143]
    ds_read_b64_tr_b16 v[130:131], v11 offset:384
    v_mfma_f32_16x16x32_bf16 a[144:147], v[132:135], v[32:35], a[144:147]
    v_mfma_f32_16x16x32_bf16 a[148:151], v[132:135], v[36:39], a[148:151]
    v_mfma_f32_16x16x32_bf16 a[152:155], v[132:135], v[40:43], a[152:155]
    v_mfma_f32_16x16x32_bf16 a[156:159], v[132:135], v[44:47], a[156:159]
    s_add_u32 s28, s49, s93
    buffer_load_dwordx4 v26, s[16:19], s28 offen lds
    v_mfma_f32_16x16x32_bf16 a[160:163], v[132:135], v[48:51], a[160:163]
    s_add_u32 m0, m0, s53
    v_mfma_f32_16x16x32_bf16 a[164:167], v[132:135], v[52:55], a[164:167]
    ds_read_b64_tr_b16 v[132:133], v11 offset:160
    v_mfma_f32_16x16x32_bf16 a[168:171], v[136:139], v[28:31], a[168:171]
    ds_read_b64_tr_b16 v[134:135], v11 offset:416
    v_mfma_f32_16x16x32_bf16 a[172:175], v[136:139], v[32:35], a[172:175]
    v_mfma_f32_16x16x32_bf16 a[176:179], v[136:139], v[36:39], a[176:179]
    v_mfma_f32_16x16x32_bf16 a[180:183], v[136:139], v[40:43], a[180:183]
    s_add_u32 s28, s49, s94
    buffer_load_dwordx4 v26, s[16:19], s28 offen lds
    v_mfma_f32_16x16x32_bf16 a[184:187], v[136:139], v[44:47], a[184:187]
    s_add_u32 m0, m0, s53
    v_mfma_f32_16x16x32_bf16 a[188:191], v[136:139], v[48:51], a[188:191]
    v_mfma_f32_16x16x32_bf16 a[192:195], v[136:139], v[52:55], a[192:195]
    ds_read_b64_tr_b16 v[136:137], v11 offset:192
    v_mfma_f32_16x16x32_bf16 a[196:199], v[140:143], v[28:31], a[196:199]
    ds_read_b64_tr_b16 v[138:139], v11 offset:448
    v_mfma_f32_16x16x32_bf16 a[200:203], v[140:143], v[32:35], a[200:203]
    v_mfma_f32_16x16x32_bf16 a[204:207], v[140:143], v[36:39], a[204:207]
    s_add_u32 s28, s49, s95
    buffer_load_dwordx4 v26, s[16:19], s28 offen lds
    v_mfma_f32_16x16x32_bf16 a[208:211], v[140:143], v[40:43], a[208:211]
    v_mfma_f32_16x16x32_bf16 a[212:215], v[140:143], v[44:47], a[212:215]
    v_mfma_f32_16x16x32_bf16 a[216:219], v[140:143], v[48:51], a[216:219]
    v_mfma_f32_16x16x32_bf16 a[220:223], v[140:143], v[52:55], a[220:223]
    ds_read_b64_tr_b16 v[140:141], v11 offset:224
    ds_read_b64_tr_b16 v[142:143], v11 offset:480
    s_add_u32 s22, s22, 1
    s_cmp_lt_u32 s22, 3
    s_cbranch_scc1 L_at_qploop
    s_cmp_lg_u32 s70, 0
    s_cbranch_scc1 L_at_qptailB
    s_waitcnt lgkmcnt(14)
    v_mfma_f32_16x16x32_bf16 v[144:147], v[112:115], v[56:59], v[144:147]
    s_add_u32 s29, s34, s100
    v_mfma_f32_16x16x32_bf16 v[148:151], v[112:115], v[60:63], v[148:151]
    s_bfe_u32 s28, s29, 0x20003
    v_mfma_f32_16x16x32_bf16 v[152:155], v[112:115], v[64:67], v[152:155]
    s_lshl_b32 s28, s28, 16
    v_mfma_f32_16x16x32_bf16 v[156:159], v[112:115], v[68:71], v[156:159]
    s_and_b32 s29, s29, 7
    v_mfma_f32_16x16x32_bf16 v[160:163], v[112:115], v[72:75], v[160:163]
    s_lshl_b32 s29, s29, 11
    v_mfma_f32_16x16x32_bf16 v[164:167], v[112:115], v[76:79], v[164:167]
    s_add_u32 s29, s28, s29
    v_mfma_f32_16x16x32_bf16 v[168:171], v[112:115], v[80:83], v[168:171]
    s_lshr_b32 s28, s34, 5
    s_waitcnt vmcnt(16) lgkmcnt(0)
    s_barrier
    ds_read_b64_tr_b16 v[112:113], v11 offset:8448
    v_mfma_f32_16x16x32_bf16 v[172:175], v[116:119], v[56:59], v[172:175]
    s_lshl_b32 s28, s28, 19
    ds_read_b64_tr_b16 v[114:115], v11 offset:8704
    v_mfma_f32_16x16x32_bf16 v[176:179], v[116:119], v[60:63], v[176:179]
    s_add_u32 s49, s28, s29
    ds_read_b128 v[28:31], v27 offset:8448
    v_mfma_f32_16x16x32_bf16 v[180:183], v[116:119], v[64:67], v[180:183]
    s_add_u32 m0, s33, 0
    ds_read_b128 v[32:35], v27 offset:9472
    v_mfma_f32_16x16x32_bf16 v[184:187], v[116:119], v[68:71], v[184:187]
    s_add_u32 s34, s34, 1
    ds_read_b128 v[36:39], v27 offset:10496
    v_mfma_f32_16x16x32_bf16 v[188:191], v[116:119], v[72:75], v[188:191]
    buffer_load_dwordx4 v7, s[4:7], s49 offen offset:0 nt lds
    v_mfma_f32_16x16x32_bf16 v[192:195], v[116:119], v[76:79], v[192:195]
    s_add_u32 m0, m0, s96
    ds_read_b128 v[40:43], v27 offset:11520
    v_mfma_f32_16x16x32_bf16 v[196:199], v[116:119], v[80:83], v[196:199]
    ds_read_b128 v[44:47], v27 offset:12544
    v_mfma_f32_16x16x32_bf16 v[200:203], v[120:123], v[56:59], v[200:203]
    ds_read_b128 v[48:51], v27 offset:13568
    v_mfma_f32_16x16x32_bf16 v[204:207], v[120:123], v[60:63], v[204:207]
    buffer_load_dwordx4 v7, s[4:7], s49 offen offset:256 nt lds
    v_mfma_f32_16x16x32_bf16 v[208:211], v[120:123], v[64:67], v[208:211]
    s_add_u32 m0, m0, s97
    ds_read_b128 v[52:55], v27 offset:14592
    v_mfma_f32_16x16x32_bf16 v[212:215], v[120:123], v[68:71], v[212:215]
    ds_read_b64_tr_b16 v[116:117], v11 offset:8480
    v_mfma_f32_16x16x32_bf16 v[216:219], v[120:123], v[72:75], v[216:219]
    ds_read_b64_tr_b16 v[118:119], v11 offset:8736
    v_mfma_f32_16x16x32_bf16 v[220:223], v[120:123], v[76:79], v[220:223]
    v_mfma_f32_16x16x32_bf16 v[224:227], v[120:123], v[80:83], v[224:227]
    ds_read_b64_tr_b16 v[120:121], v11 offset:8512
    v_mfma_f32_16x16x32_bf16 v[228:231], v[124:127], v[56:59], v[228:231]
    buffer_load_dwordx4 v7, s[4:7], s49 offen offset:512 nt lds
    v_mfma_f32_16x16x32_bf16 v[232:235], v[124:127], v[60:63], v[232:235]
    s_add_u32 m0, m0, s96
    ds_read_b64_tr_b16 v[122:123], v11 offset:8768
    v_mfma_f32_16x16x32_bf16 v[236:239], v[124:127], v[64:67], v[236:239]
    v_mfma_f32_16x16x32_bf16 v[240:243], v[124:127], v[68:71], v[240:243]
    v_mfma_f32_16x16x32_bf16 v[244:247], v[124:127], v[72:75], v[244:247]
    v_mfma_f32_16x16x32_bf16 v[248:251], v[124:127], v[76:79], v[248:251]
    v_mfma_f32_16x16x32_bf16 v[252:255], v[124:127], v[80:83], v[252:255]
    buffer_load_dwordx4 v7, s[4:7], s49 offen offset:768 nt lds
    v_mfma_f32_16x16x32_bf16 a[112:115], v[128:131], v[56:59], a[112:115]
    s_add_u32 m0, m0, s97
    ds_read_b64_tr_b16 v[124:125], v11 offset:8544
    v_mfma_f32_16x16x32_bf16 a[116:119], v[128:131], v[60:63], a[116:119]
    ds_read_b64_tr_b16 v[126:127], v11 offset:8800
    v_mfma_f32_16x16x32_bf16 a[120:123], v[128:131], v[64:67], a[120:123]
    v_mfma_f32_16x16x32_bf16 a[124:127], v[128:131], v[68:71], a[124:127]
    v_mfma_f32_16x16x32_bf16 a[128:131], v[128:131], v[72:75], a[128:131]
    v_mfma_f32_16x16x32_bf16 a[132:135], v[128:131], v[76:79], a[132:135]
    buffer_load_dwordx4 v7, s[4:7], s49 offen offset:1024 nt lds
    v_mfma_f32_16x16x32_bf16 a[136:139], v[128:131], v[80:83], a[136:139]
    s_add_u32 m0, m0, s96
    ds_read_b64_tr_b16 v[128:129], v11 offset:8576
    v_mfma_f32_16x16x32_bf16 a[140:143], v[132:135], v[56:59], a[140:143]
    ds_read_b64_tr_b16 v[130:131], v11 offset:8832
    v_mfma_f32_16x16x32_bf16 a[144:147], v[132:135], v[60:63], a[144:147]
    v_mfma_f32_16x16x32_bf16 a[148:151], v[132:135], v[64:67], a[148:151]
    v_mfma_f32_16x16x32_bf16 a[152:155], v[132:135], v[68:71], a[152:155]
    v_mfma_f32_16x16x32_bf16 a[156:159], v[132:135], v[72:75], a[156:159]
    buffer_load_dwordx4 v7, s[4:7], s49 offen offset:1280 nt lds
    v_mfma_f32_16x16x32_bf16 a[160:163], v[132:135], v[76:79], a[160:163]
    s_add_u32 m0, m0, s97
    v_mfma_f32_16x16x32_bf16 a[164:167], v[132:135], v[80:83], a[164:167]
    ds_read_b64_tr_b16 v[132:133], v11 offset:8608
    v_mfma_f32_16x16x32_bf16 a[168:171], v[136:139], v[56:59], a[168:171]
    ds_read_b64_tr_b16 v[134:135], v11 offset:8864
    v_mfma_f32_16x16x32_bf16 a[172:175], v[136:139], v[60:63], a[172:175]
    v_mfma_f32_16x16x32_bf16 a[176:179], v[136:139], v[64:67], a[176:179]
    v_mfma_f32_16x16x32_bf16 a[180:183], v[136:139], v[68:71], a[180:183]
    buffer_load_dwordx4 v7, s[4:7], s49 offen offset:1536 nt lds
    v_mfma_f32_16x16x32_bf16 a[184:187], v[136:139], v[72:75], a[184:187]
    s_add_u32 m0, m0, s96
    v_mfma_f32_16x16x32_bf16 a[188:191], v[136:139], v[76:79], a[188:191]
    v_mfma_f32_16x16x32_bf16 a[192:195], v[136:139], v[80:83], a[192:195]
    ds_read_b64_tr_b16 v[136:137], v11 offset:8640
    v_mfma_f32_16x16x32_bf16 a[196:199], v[140:143], v[56:59], a[196:199]
    ds_read_b64_tr_b16 v[138:139], v11 offset:8896
    v_mfma_f32_16x16x32_bf16 a[200:203], v[140:143], v[60:63], a[200:203]
    v_mfma_f32_16x16x32_bf16 a[204:207], v[140:143], v[64:67], a[204:207]
    buffer_load_dwordx4 v7, s[4:7], s49 offen offset:1792 nt lds
    v_mfma_f32_16x16x32_bf16 a[208:211], v[140:143], v[68:71], a[208:211]
    v_mfma_f32_16x16x32_bf16 a[212:215], v[140:143], v[72:75], a[212:215]
    v_mfma_f32_16x16x32_bf16 a[216:219], v[140:143], v[76:79], a[216:219]
    v_mfma_f32_16x16x32_bf16 a[220:223], v[140:143], v[80:83], a[220:223]
    ds_read_b64_tr_b16 v[140:141], v11 offset:8672
    ds_read_b64_tr_b16 v[142:143], v11 offset:8928
    s_waitcnt lgkmcnt(14)
    v_mfma_f32_16x16x32_bf16 v[144:147], v[112:115], v[28:31], v[144:147]
    s_add_u32 s29, s34, s100
    v_mfma_f32_16x16x32_bf16 v[148:151], v[112:115], v[32:35], v[148:151]
    s_bfe_u32 s28, s29, 0x20003
    v_mfma_f32_16x16x32_bf16 v[152:155], v[112:115], v[36:39], v[152:155]
    s_lshl_b32 s28, s28, 16
    v_mfma_f32_16x16x32_bf16 v[156:159], v[112:115], v[40:43], v[156:159]
    s_and_b32 s29, s29, 7
    v_mfma_f32_16x16x32_bf16 v[160:163], v[112:115], v[44:47], v[160:163]
    s_lshl_b32 s29, s29, 11
    v_mfma_f32_16x16x32_bf16 v[164:167], v[112:115], v[48:51], v[164:167]
    s_add_u32 s29, s28, s29
    v_mfma_f32_16x16x32_bf16 v[168:171], v[112:115], v[52:55], v[168:171]
    s_lshr_b32 s28, s34, 5
    s_waitcnt vmcnt(16) lgkmcnt(0)
    s_barrier
    ds_read_b64_tr_b16 v[112:113], v11 offset:16896
    v_mfma_f32_16x16x32_bf16 v[172:175], v[116:119], v[28:31], v[172:175]
    s_lshl_b32 s28, s28, 19
    ds_read_b64_tr_b16 v[114:115], v11 offset:17152
    v_mfma_f32_16x16x32_bf16 v[176:179], v[116:119], v[32:35], v[176:179]
    s_add_u32 s49, s28, s29
    ds_read_b128 v[56:59], v27 offset:16896
    v_mfma_f32_16x16x32_bf16 v[180:183], v[116:119], v[36:39], v[180:183]
    s_add_u32 m0, s33, 8448
    ds_read_b128 v[60:63], v27 offset:17920
    v_mfma_f32_16x16x32_bf16 v[184:187], v[116:119], v[40:43], v[184:187]
    s_add_u32 s34, s34, 1
    ds_read_b128 v[64:67], v27 offset:18944
    v_mfma_f32_16x16x32_bf16 v[188:191], v[116:119], v[44:47], v[188:191]
    buffer_load_dwordx4 v7, s[4:7], s49 offen offset:0 nt lds
    v_mfma_f32_16x16x32_bf16 v[192:195], v[116:119], v[48:51], v[192:195]
    s_add_u32 m0, m0, s96
    ds_read_b128 v[68:71], v27 offset:19968
    v_mfma_f32_16x16x32_bf16 v[196:199], v[116:119], v[52:55], v[196:199]
    ds_read_b128 v[72:75], v27 offset:20992
    v_mfma_f32_16x16x32_bf16 v[200:203], v[120:123], v[28:31], v[200:203]
    ds_read_b128 v[76:79], v27 offset:22016
    v_mfma_f32_16x16x32_bf16 v[204:207], v[120:123], v[32:35], v[204:207]
    buffer_load_dwordx4 v7, s[4:7], s49 offen offset:256 nt lds
    v_mfma_f32_16x16x32_bf16 v[208:211], v[120:123], v[36:39], v[208:211]
    s_add_u32 m0, m0, s97
    ds_read_b128 v[80:83], v27 offset:23040
    v_mfma_f32_16x16x32_bf16 v[212:215], v[120:123], v[40:43], v[212:215]
    ds_read_b64_tr_b16 v[116:117], v11 offset:16928
    v_mfma_f32_16x16x32_bf16 v[216:219], v[120:123], v[44:47], v[216:219]
    ds_read_b64_tr_b16 v[118:119], v11 offset:17184
    v_mfma_f32_16x16x32_bf16 v[220:223], v[120:123], v[48:51], v[220:223]
    v_mfma_f32_16x16x32_bf16 v[224:227], v[120:123], v[52:55], v[224:227]
    ds_read_b64_tr_b16 v[120:121], v11 offset:16960
    v_mfma_f32_16x16x32_bf16 v[228:231], v[124:127], v[28:31], v[228:231]
    buffer_load_dwordx4 v7, s[4:7], s49 offen offset:512 nt lds
    v_mfma_f32_16x16x32_bf16 v[232:235], v[124:127], v[32:35], v[232:235]
    s_add_u32 m0, m0, s96
    ds_read_b64_tr_b16 v[122:123], v11 offset:17216
    v_mfma_f32_16x16x32_bf16 v[236:239], v[124:127], v[36:39], v[236:239]
    v_mfma_f32_16x16x32_bf16 v[240:243], v[124:127], v[40:43], v[240:243]
    v_mfma_f32_16x16x32_bf16 v[244:247], v[124:127], v[44:47], v[244:247]
    v_mfma_f32_16x16x32_bf16 v[248:251], v[124:127], v[48:51], v[248:251]
    v_mfma_f32_16x16x32_bf16 v[252:255], v[124:127], v[52:55], v[252:255]
    buffer_load_dwordx4 v7, s[4:7], s49 offen offset:768 nt lds
    v_mfma_f32_16x16x32_bf16 a[112:115], v[128:131], v[28:31], a[112:115]
    s_add_u32 m0, m0, s97
    ds_read_b64_tr_b16 v[124:125], v11 offset:16992
    v_mfma_f32_16x16x32_bf16 a[116:119], v[128:131], v[32:35], a[116:119]
    ds_read_b64_tr_b16 v[126:127], v11 offset:17248
    v_mfma_f32_16x16x32_bf16 a[120:123], v[128:131], v[36:39], a[120:123]
    v_mfma_f32_16x16x32_bf16 a[124:127], v[128:131], v[40:43], a[124:127]
    v_mfma_f32_16x16x32_bf16 a[128:131], v[128:131], v[44:47], a[128:131]
    v_mfma_f32_16x16x32_bf16 a[132:135], v[128:131], v[48:51], a[132:135]
    buffer_load_dwordx4 v7, s[4:7], s49 offen offset:1024 nt lds
    v_mfma_f32_16x16x32_bf16 a[136:139], v[128:131], v[52:55], a[136:139]
    s_add_u32 m0, m0, s96
    ds_read_b64_tr_b16 v[128:129], v11 offset:17024
    v_mfma_f32_16x16x32_bf16 a[140:143], v[132:135], v[28:31], a[140:143]
    ds_read_b64_tr_b16 v[130:131], v11 offset:17280
    v_mfma_f32_16x16x32_bf16 a[144:147], v[132:135], v[32:35], a[144:147]
    v_mfma_f32_16x16x32_bf16 a[148:151], v[132:135], v[36:39], a[148:151]
    v_mfma_f32_16x16x32_bf16 a[152:155], v[132:135], v[40:43], a[152:155]
    v_mfma_f32_16x16x32_bf16 a[156:159], v[132:135], v[44:47], a[156:159]
    buffer_load_dwordx4 v7, s[4:7], s49 offen offset:1280 nt lds
    v_mfma_f32_16x16x32_bf16 a[160:163], v[132:135], v[48:51], a[160:163]
    s_add_u32 m0, m0, s97
    v_mfma_f32_16x16x32_bf16 a[164:167], v[132:135], v[52:55], a[164:167]
    ds_read_b64_tr_b16 v[132:133], v11 offset:17056
    v_mfma_f32_16x16x32_bf16 a[168:171], v[136:139], v[28:31], a[168:171]
    ds_read_b64_tr_b16 v[134:135], v11 offset:17312
    v_mfma_f32_16x16x32_bf16 a[172:175], v[136:139], v[32:35], a[172:175]
    v_mfma_f32_16x16x32_bf16 a[176:179], v[136:139], v[36:39], a[176:179]
    v_mfma_f32_16x16x32_bf16 a[180:183], v[136:139], v[40:43], a[180:183]
    buffer_load_dwordx4 v7, s[4:7], s49 offen offset:1536 nt lds
    v_mfma_f32_16x16x32_bf16 a[184:187], v[136:139], v[44:47], a[184:187]
    s_add_u32 m0, m0, s96
    v_mfma_f32_16x16x32_bf16 a[188:191], v[136:139], v[48:51], a[188:191]
    v_mfma_f32_16x16x32_bf16 a[192:195], v[136:139], v[52:55], a[192:195]
    ds_read_b64_tr_b16 v[136:137], v11 offset:17088
    v_mfma_f32_16x16x32_bf16 a[196:199], v[140:143], v[28:31], a[196:199]
    ds_read_b64_tr_b16 v[138:139], v11 offset:17344
    v_mfma_f32_16x16x32_bf16 a[200:203], v[140:143], v[32:35], a[200:203]
    v_mfma_f32_16x16x32_bf16 a[204:207], v[140:143], v[36:39], a[204:207]
    buffer_load_dwordx4 v7, s[4:7], s49 offen offset:1792 nt lds
    v_mfma_f32_16x16x32_bf16 a[208:211], v[140:143], v[40:43], a[208:211]
    v_mfma_f32_16x16x32_bf16 a[212:215], v[140:143], v[44:47], a[212:215]
    v_mfma_f32_16x16x32_bf16 a[216:219], v[140:143], v[48:51], a[216:219]
    v_mfma_f32_16x16x32_bf16 a[220:223], v[140:143], v[52:55], a[220:223]
    ds_read_b64_tr_b16 v[140:141], v11 offset:17120
    ds_read_b64_tr_b16 v[142:143], v11 offset:17376
    s_waitcnt lgkmcnt(14)
    v_mfma_f32_16x16x32_bf16 v[144:147], v[112:115], v[56:59], v[144:147]
    s_add_u32 s29, s34, s100
    v_mfma_f32_16x16x32_bf16 v[148:151], v[112:115], v[60:63], v[148:151]
    s_bfe_u32 s28, s29, 0x20003
    v_mfma_f32_16x16x32_bf16 v[152:155], v[112:115], v[64:67], v[152:155]
    s_lshl_b32 s28, s28, 16
    v_mfma_f32_16x16x32_bf16 v[156:159], v[112:115], v[68:71], v[156:159]
    s_and_b32 s29, s29, 7
    v_mfma_f32_16x16x32_bf16 v[160:163], v[112:115], v[72:75], v[160:163]
    s_lshl_b32 s29, s29, 11
    v_mfma_f32_16x16x32_bf16 v[164:167], v[112:115], v[76:79], v[164:167]
    s_add_u32 s29, s28, s29
    v_mfma_f32_16x16x32_bf16 v[168:171], v[112:115], v[80:83], v[168:171]
    s_lshr_b32 s28, s34, 5
    s_waitcnt vmcnt(16) lgkmcnt(0)
    s_barrier
    ds_read_b64_tr_b16 v[112:113], v11 offset:25344
    v_mfma_f32_16x16x32_bf16 v[172:175], v[116:119], v[56:59], v[172:175]
    s_lshl_b32 s28, s28, 19
    ds_read_b64_tr_b16 v[114:115], v11 offset:25600
    v_mfma_f32_16x16x32_bf16 v[176:179], v[116:119], v[60:63], v[176:179]
    s_add_u32 s49, s28, s29
    ds_read_b128 v[28:31], v27 offset:25344
    v_mfma_f32_16x16x32_bf16 v[180:183], v[116:119], v[64:67], v[180:183]
    s_add_u32 m0, s33, 16896
    ds_read_b128 v[32:35], v27 offset:26368
    v_mfma_f32_16x16x32_bf16 v[184:187], v[116:119], v[68:71], v[184:187]
    s_add_u32 s34, s34, 1
    ds_read_b128 v[36:39], v27 offset:27392
    v_mfma_f32_16x16x32_bf16 v[188:191], v[116:119], v[72:75], v[188:191]
    buffer_load_dwordx4 v7, s[4:7], s49 offen offset:0 nt lds
    v_mfma_f32_16x16x32_bf16 v[192:195], v[116:119], v[76:79], v[192:195]
    s_add_u32 m0, m0, s96
    ds_read_b128 v[40:43], v27 offset:28416
    v_mfma_f32_16x16x32_bf16 v[196:199], v[116:119], v[80:83], v[196:199]
    ds_read_b128 v[44:47], v27 offset:29440
    v_mfma_f32_16x16x32_bf16 v[200:203], v[120:123], v[56:59], v[200:203]
    ds_read_b128 v[48:51], v27 offset:30464
    v_mfma_f32_16x16x32_bf16 v[204:207], v[120:123], v[60:63], v[204:207]
    buffer_load_dwordx4 v7, s[4:7], s49 offen offset:256 nt lds
    v_mfma_f32_16x16x32_bf16 v[208:211], v[120:123], v[64:67], v[208:211]
    s_add_u32 m0, m0, s97
    ds_read_b128 v[52:55], v27 offset:31488
    v_mfma_f32_16x16x32_bf16 v[212:215], v[120:123], v[68:71], v[212:215]
    ds_read_b64_tr_b16 v[116:117], v11 offset:25376
    v_mfma_f32_16x16x32_bf16 v[216:219], v[120:123], v[72:75], v[216:219]
    ds_read_b64_tr_b16 v[118:119], v11 offset:25632
    v_mfma_f32_16x16x32_bf16 v[220:223], v[120:123], v[76:79], v[220:223]
    v_mfma_f32_16x16x32_bf16 v[224:227], v[120:123], v[80:83], v[224:227]
    ds_read_b64_tr_b16 v[120:121], v11 offset:25408
    v_mfma_f32_16x16x32_bf16 v[228:231], v[124:127], v[56:59], v[228:231]
    buffer_load_dwordx4 v7, s[4:7], s49 offen offset:512 nt lds
    v_mfma_f32_16x16x32_bf16 v[232:235], v[124:127], v[60:63], v[232:235]
    s_add_u32 m0, m0, s96
    ds_read_b64_tr_b16 v[122:123], v11 offset:25664
    v_mfma_f32_16x16x32_bf16 v[236:239], v[124:127], v[64:67], v[236:239]
    v_mfma_f32_16x16x32_bf16 v[240:243], v[124:127], v[68:71], v[240:243]
    v_mfma_f32_16x16x32_bf16 v[244:247], v[124:127], v[72:75], v[244:247]
    v_mfma_f32_16x16x32_bf16 v[248:251], v[124:127], v[76:79], v[248:251]
    v_mfma_f32_16x16x32_bf16 v[252:255], v[124:127], v[80:83], v[252:255]
    buffer_load_dwordx4 v7, s[4:7], s49 offen offset:768 nt lds
    v_mfma_f32_16x16x32_bf16 a[112:115], v[128:131], v[56:59], a[112:115]
    s_add_u32 m0, m0, s97
    ds_read_b64_tr_b16 v[124:125], v11 offset:25440
    v_mfma_f32_16x16x32_bf16 a[116:119], v[128:131], v[60:63], a[116:119]
    ds_read_b64_tr_b16 v[126:127], v11 offset:25696
    v_mfma_f32_16x16x32_bf16 a[120:123], v[128:131], v[64:67], a[120:123]
    v_mfma_f32_16x16x32_bf16 a[124:127], v[128:131], v[68:71], a[124:127]
    v_mfma_f32_16x16x32_bf16 a[128:131], v[128:131], v[72:75], a[128:131]
    v_mfma_f32_16x16x32_bf16 a[132:135], v[128:131], v[76:79], a[132:135]
    buffer_load_dwordx4 v7, s[4:7], s49 offen offset:1024 nt lds
    v_mfma_f32_16x16x32_bf16 a[136:139], v[128:131], v[80:83], a[136:139]
    s_add_u32 m0, m0, s96
    ds_read_b64_tr_b16 v[128:129], v11 offset:25472
    v_mfma_f32_16x16x32_bf16 a[140:143], v[132:135], v[56:59], a[140:143]
    ds_read_b64_tr_b16 v[130:131], v11 offset:25728
    v_mfma_f32_16x16x32_bf16 a[144:147], v[132:135], v[60:63], a[144:147]
    v_mfma_f32_16x16x32_bf16 a[148:151], v[132:135], v[64:67], a[148:151]
    v_mfma_f32_16x16x32_bf16 a[152:155], v[132:135], v[68:71], a[152:155]
    v_mfma_f32_16x16x32_bf16 a[156:159], v[132:135], v[72:75], a[156:159]
    buffer_load_dwordx4 v7, s[4:7], s49 offen offset:1280 nt lds
    v_mfma_f32_16x16x32_bf16 a[160:163], v[132:135], v[76:79], a[160:163]
    s_add_u32 m0, m0, s97
    v_mfma_f32_16x16x32_bf16 a[164:167], v[132:135], v[80:83], a[164:167]
    ds_read_b64_tr_b16 v[132:133], v11 offset:25504
    v_mfma_f32_16x16x32_bf16 a[168:171], v[136:139], v[56:59], a[168:171]
    ds_read_b64_tr_b16 v[134:135], v11 offset:25760
    v_mfma_f32_16x16x32_bf16 a[172:175], v[136:139], v[60:63], a[172:175]
    v_mfma_f32_16x16x32_bf16 a[176:179], v[136:139], v[64:67], a[176:179]
    v_mfma_f32_16x16x32_bf16 a[180:183], v[136:139], v[68:71], a[180:183]
    buffer_load_dwordx4 v7, s[4:7], s49 offen offset:1536 nt lds
    v_mfma_f32_16x16x32_bf16 a[184:187], v[136:139], v[72:75], a[184:187]
    s_add_u32 m0, m0, s96
    v_mfma_f32_16x16x32_bf16 a[188:191], v[136:139], v[76:79], a[188:191]
    v_mfma_f32_16x16x32_bf16 a[192:195], v[136:139], v[80:83], a[192:195]
    ds_read_b64_tr_b16 v[136:137], v11 offset:25536
    v_mfma_f32_16x16x32_bf16 a[196:199], v[140:143], v[56:59], a[196:199]
    ds_read_b64_tr_b16 v[138:139], v11 offset:25792
    v_mfma_f32_16x16x32_bf16 a[200:203], v[140:143], v[60:63], a[200:203]
    v_mfma_f32_16x16x32_bf16 a[204:207], v[140:143], v[64:67], a[204:207]
    buffer_load_dwordx4 v7, s[4:7], s49 offen offset:1792 nt lds
    v_mfma_f32_16x16x32_bf16 a[208:211], v[140:143], v[68:71], a[208:211]
    v_mfma_f32_16x16x32_bf16 a[212:215], v[140:143], v[72:75], a[212:215]
    v_mfma_f32_16x16x32_bf16 a[216:219], v[140:143], v[76:79], a[216:219]
    v_mfma_f32_16x16x32_bf16 a[220:223], v[140:143], v[80:83], a[220:223]
    ds_read_b64_tr_b16 v[140:141], v11 offset:25568
    ds_read_b64_tr_b16 v[142:143], v11 offset:25824
    s_waitcnt lgkmcnt(14)
    v_mfma_f32_16x16x32_bf16 v[144:147], v[112:115], v[28:31], v[144:147]
    s_add_u32 s29, s34, s100
    v_mfma_f32_16x16x32_bf16 v[148:151], v[112:115], v[32:35], v[148:151]
    s_bfe_u32 s28, s29, 0x20003
    v_mfma_f32_16x16x32_bf16 v[152:155], v[112:115], v[36:39], v[152:155]
    s_lshl_b32 s28, s28, 16
    v_mfma_f32_16x16x32_bf16 v[156:159], v[112:115], v[40:43], v[156:159]
    s_and_b32 s29, s29, 7
    v_mfma_f32_16x16x32_bf16 v[160:163], v[112:115], v[44:47], v[160:163]
    s_lshl_b32 s29, s29, 11
    v_mfma_f32_16x16x32_bf16 v[164:167], v[112:115], v[48:51], v[164:167]
    s_add_u32 s29, s28, s29
    v_mfma_f32_16x16x32_bf16 v[168:171], v[112:115], v[52:55], v[168:171]
    s_lshr_b32 s28, s34, 5
    s_waitcnt vmcnt(16) lgkmcnt(0)
    s_barrier
    ds_read_b128 v[56:59], v8 offset:0
    v_mfma_f32_16x16x32_bf16 v[172:175], v[116:119], v[28:31], v[172:175]
    s_lshl_b32 s28, s28, 19
    ds_read_b128 v[60:63], v8 offset:64
    v_mfma_f32_16x16x32_bf16 v[176:179], v[116:119], v[32:35], v[176:179]
    s_add_u32 s49, s28, s29
    ds_read_b128 v[64:67], v8 offset:128
    v_mfma_f32_16x16x32_bf16 v[180:183], v[116:119], v[36:39], v[180:183]
    s_add_u32 m0, s33, 25344
    ds_read_b128 v[68:71], v8 offset:192
    v_mfma_f32_16x16x32_bf16 v[184:187], v[116:119], v[40:43], v[184:187]
    s_add_u32 s34, s34, 1
    ds_read_b128 v[72:75], v8 offset:512
    v_mfma_f32_16x16x32_bf16 v[188:191], v[116:119], v[44:47], v[188:191]
    buffer_load_dwordx4 v7, s[4:7], s49 offen offset:0 nt lds
    v_mfma_f32_16x16x32_bf16 v[192:195], v[116:119], v[48:51], v[192:195]
    s_add_u32 m0, m0, s96
    ds_read_b128 v[76:79], v8 offset:576
    v_mfma_f32_16x16x32_bf16 v[196:199], v[116:119], v[52:55], v[196:199]
    ds_read_b128 v[80:83], v8 offset:640
    v_mfma_f32_16x16x32_bf16 v[200:203], v[120:123], v[28:31], v[200:203]
    ds_read_b128 v[84:87], v8 offset:704
    v_mfma_f32_16x16x32_bf16 v[204:207], v[120:123], v[32:35], v[204:207]
    buffer_load_dwordx4 v7, s[4:7], s49 offen offset:256 nt lds
    v_mfma_f32_16x16x32_bf16 v[208:211], v[120:123], v[36:39], v[208:211]
    s_add_u32 m0, m0, s97
    v_mfma_f32_16x16x32_bf16 v[212:215], v[120:123], v[40:43], v[212:215]
    v_mfma_f32_16x16x32_bf16 v[216:219], v[120:123], v[44:47], v[216:219]
    v_mfma_f32_16x16x32_bf16 v[220:223], v[120:123], v[48:51], v[220:223]
    v_mfma_f32_16x16x32_bf16 v[224:227], v[120:123], v[52:55], v[224:227]
    v_mfma_f32_16x16x32_bf16 v[228:231], v[124:127], v[28:31], v[228:231]
    buffer_load_dwordx4 v7, s[4:7], s49 offen offset:512 nt lds
    v_mfma_f32_16x16x32_bf16 v[232:235], v[124:127], v[32:35], v[232:235]
    s_add_u32 m0, m0, s96
    v_mfma_f32_16x16x32_bf16 v[236:239], v[124:127], v[36:39], v[236:239]
    v_mfma_f32_16x16x32_bf16 v[240:243], v[124:127], v[40:43], v[240:243]
    v_mfma_f32_16x16x32_bf16 v[244:247], v[124:127], v[44:47], v[244:247]
    v_mfma_f32_16x16x32_bf16 v[248:251], v[124:127], v[48:51], v[248:251]
    v_mfma_f32_16x16x32_bf16 v[252:255], v[124:127], v[52:55], v[252:255]
    buffer_load_dwordx4 v7, s[4:7], s49 offen offset:768 nt lds
    v_mfma_f32_16x16x32_bf16 a[112:115], v[128:131], v[28:31], a[112:115]
    s_add_u32 m0, m0, s97
    v_mfma_f32_16x16x32_bf16 a[116:119], v[128:131], v[32:35], a[116:119]
    v_mfma_f32_16x16x32_bf16 a[120:123], v[128:131], v[36:39], a[120:123]
    v_mfma_f32_16x16x32_bf16 a[124:127], v[128:131], v[40:43], a[124:127]
    v_mfma_f32_16x16x32_bf16 a[128:131], v[128:131], v[44:47], a[128:131]
    v_mfma_f32_16x16x32_bf16 a[132:135], v[128:131], v[48:51], a[132:135]
    buffer_load_dwordx4 v7, s[4:7], s49 offen offset:1024 nt lds
    v_mfma_f32_16x16x32_bf16 a[136:139], v[128:131], v[52:55], a[136:139]
    s_add_u32 m0, m0, s96
    v_mfma_f32_16x16x32_bf16 a[140:143], v[132:135], v[28:31], a[140:143]
    v_mfma_f32_16x16x32_bf16 a[144:147], v[132:135], v[32:35], a[144:147]
    v_mfma_f32_16x16x32_bf16 a[148:151], v[132:135], v[36:39], a[148:151]
    v_mfma_f32_16x16x32_bf16 a[152:155], v[132:135], v[40:43], a[152:155]
    v_mfma_f32_16x16x32_bf16 a[156:159], v[132:135], v[44:47], a[156:159]
    buffer_load_dwordx4 v7, s[4:7], s49 offen offset:1280 nt lds
    v_mfma_f32_16x16x32_bf16 a[160:163], v[132:135], v[48:51], a[160:163]
    s_add_u32 m0, m0, s97
    v_mfma_f32_16x16x32_bf16 a[164:167], v[132:135], v[52:55], a[164:167]
    v_mfma_f32_16x16x32_bf16 a[168:171], v[136:139], v[28:31], a[168:171]
    v_mfma_f32_16x16x32_bf16 a[172:175], v[136:139], v[32:35], a[172:175]
    v_mfma_f32_16x16x32_bf16 a[176:179], v[136:139], v[36:39], a[176:179]
    v_mfma_f32_16x16x32_bf16 a[180:183], v[136:139], v[40:43], a[180:183]
    buffer_load_dwordx4 v7, s[4:7], s49 offen offset:1536 nt lds
    v_mfma_f32_16x16x32_bf16 a[184:187], v[136:139], v[44:47], a[184:187]
    s_add_u32 m0, m0, s96
    v_mfma_f32_16x16x32_bf16 a[188:191], v[136:139], v[48:51], a[188:191]
    v_mfma_f32_16x16x32_bf16 a[192:195], v[136:139], v[52:55], a[192:195]
    v_mfma_f32_16x16x32_bf16 a[196:199], v[140:143], v[28:31], a[196:199]
    v_mfma_f32_16x16x32_bf16 a[200:203], v[140:143], v[32:35], a[200:203]
    v_mfma_f32_16x16x32_bf16 a[204:207], v[140:143], v[36:39], a[204:207]
    buffer_load_dwordx4 v7, s[4:7], s49 offen offset:1792 nt lds
    v_mfma_f32_16x16x32_bf16 a[208:211], v[140:143], v[40:43], a[208:211]
    v_mfma_f32_16x16x32_bf16 a[212:215], v[140:143], v[44:47], a[212:215]
    v_mfma_f32_16x16x32_bf16 a[216:219], v[140:143], v[48:51], a[216:219]
    v_mfma_f32_16x16x32_bf16 a[220:223], v[140:143], v[52:55], a[220:223]
    s_branch L_at_qpepi
L_at_qptailB:
    s_mul_i32 s50, s21, s52
    s_mov_b32 s101, s21
    s_add_u32 s50, s50, s55
    s_cmp_ge_u32 s21, 2
    s_cselect_b32 s28, 0x40000000, 0
    s_add_u32 s50, s50, s28
    s_mov_b32 s82, s26
    s_mul_i32 s28, s26, s51
    s_add_u32 s50, s50, s28
    s_waitcnt lgkmcnt(14)
    v_mfma_f32_16x16x32_bf16 v[144:147], v[112:115], v[56:59], v[144:147]
    s_add_u32 m0, s33, 0
    v_mfma_f32_16x16x32_bf16 v[148:151], v[112:115], v[60:63], v[148:151]
    s_mov_b32 s49, s50
    v_mfma_f32_16x16x32_bf16 v[152:155], v[112:115], v[64:67], v[152:155]
    s_add_u32 s50, s50, s51
    v_mfma_f32_16x16x32_bf16 v[156:159], v[112:115], v[68:71], v[156:159]
    s_add_u32 s82, s82, 1
    v_mfma_f32_16x16x32_bf16 v[160:163], v[112:115], v[72:75], v[160:163]
    s_cmp_eq_u32 s82, 20
    v_mfma_f32_16x16x32_bf16 v[164:167], v[112:115], v[76:79], v[164:167]
    s_cselect_b32 s29, s83, 0
    v_mfma_f32_16x16x32_bf16 v[168:171], v[112:115], v[80:83], v[168:171]
    s_sub_u32 s50, s50, s29
    s_waitcnt vmcnt(16) lgkmcnt(0)
    s_barrier
    ds_read_b64_tr_b16 v[112:113], v11 offset:8448
    v_mfma_f32_16x16x32_bf16 v[172:175], v[116:119], v[56:59], v[172:175]
    ds_read_b64_tr_b16 v[114:115], v11 offset:8704
    v_mfma_f32_16x16x32_bf16 v[176:179], v[116:119], v[60:63], v[176:179]
    ds_read_b128 v[28:31], v27 offset:8448
    v_mfma_f32_16x16x32_bf16 v[180:183], v[116:119], v[64:67], v[180:183]
    s_add_u32 s28, s49, s88
    buffer_load_dwordx4 v26, s[16:19], s28 offen lds
    v_mfma_f32_16x16x32_bf16 v[184:187], v[116:119], v[68:71], v[184:187]
    s_add_u32 m0, m0, s53
    ds_read_b128 v[32:35], v27 offset:9472
    v_mfma_f32_16x16x32_bf16 v[188:191], v[116:119], v[72:75], v[188:191]
    ds_read_b128 v[36:39], v27 offset:10496
    v_mfma_f32_16x16x32_bf16 v[192:195], v[116:119], v[76:79], v[192:195]
    ds_read_b128 v[40:43], v27 offset:11520
    v_mfma_f32_16x16x32_bf16 v[196:199], v[116:119], v[80:83], v[196:199]
    ds_read_b128 v[44:47], v27 offset:12544
    v_mfma_f32_16x16x32_bf16 v[200:203], v[120:123], v[56:59], v[200:203]
    ds_read_b128 v[48:51], v27 offset:13568
    v_mfma_f32_16x16x32_bf16 v[204:207], v[120:123], v[60:63], v[204:207]
    s_add_u32 s28, s49, s89
    buffer_load_dwordx4 v26, s[16:19], s28 offen lds
    v_mfma_f32_16x16x32_bf16 v[208:211], v[120:123], v[64:67], v[208:211]
    s_add_u32 m0, m0, s53
    ds_read_b128 v[52:55], v27 offset:14592
    v_mfma_f32_16x16x32_bf16 v[212:215], v[120:123], v[68:71], v[212:215]
    ds_read_b64_tr_b16 v[116:117], v11 offset:8480
    v_mfma_f32_16x16x32_bf16 v[216:219], v[120:123], v[72:75], v[216:219]
    ds_read_b64_tr_b16 v[118:119], v11 offset:8736
    v_mfma_f32_16x16x32_bf16 v[220:223], v[120:123], v[76:79], v[220:223]
    v_mfma_f32_16x16x32_bf16 v[224:227], v[120:123], v[80:83], v[224:227]
    ds_read_b64_tr_b16 v[120:121], v11 offset:8512
    v_mfma_f32_16x16x32_bf16 v[228:231], v[124:127], v[56:59], v[228:231]
    s_add_u32 s28, s49, s90
    buffer_load_dwordx4 v26, s[16:19], s28 offen lds
    v_mfma_f32_16x16x32_bf16 v[232:235], v[124:127], v[60:63], v[232:235]
    s_add_u32 m0, m0, s53
    ds_read_b64_tr_b16 v[122:123], v11 offset:8768
    v_mfma_f32_16x16x32_bf16 v[236:239], v[124:127], v[64:67], v[236:239]
    v_mfma_f32_16x16x32_bf16 v[240:243], v[124:127], v[68:71], v[240:243]
    v_mfma_f32_16x16x32_bf16 v[244:247], v[124:127], v[72:75], v[244:247]
    v_mfma_f32_16x16x32_bf16 v[248:251], v[124:127], v[76:79], v[248:251]
    v_mfma_f32_16x16x32_bf16 v[252:255], v[124:127], v[80:83], v[252:255]
    s_add_u32 s28, s49, s91
    buffer_load_dwordx4 v26, s[16:19], s28 offen lds
    v_mfma_f32_16x16x32_bf16 a[112:115], v[128:131], v[56:59], a[112:115]
    s_add_u32 m0, m0, s53
    ds_read_b64_tr_b16 v[124:125], v11 offset:8544
    v_mfma_f32_16x16x32_bf16 a[116:119], v[128:131], v[60:63], a[116:119]
    ds_read_b64_tr_b16 v[126:127], v11 offset:8800
    v_mfma_f32_16x16x32_bf16 a[120:123], v[128:131], v[64:67], a[120:123]
    v_mfma_f32_16x16x32_bf16 a[124:127], v[128:131], v[68:71], a[124:127]
    v_mfma_f32_16x16x32_bf16 a[128:131], v[128:131], v[72:75], a[128:131]
    v_mfma_f32_16x16x32_bf16 a[132:135], v[128:131], v[76:79], a[132:135]
    s_add_u32 s28, s49, s92
    buffer_load_dwordx4 v26, s[16:19], s28 offen lds
    v_mfma_f32_16x16x32_bf16 a[136:139], v[128:131], v[80:83], a[136:139]
    s_add_u32 m0, m0, s53
    ds_read_b64_tr_b16 v[128:129], v11 offset:8576
    v_mfma_f32_16x16x32_bf16 a[140:143], v[132:135], v[56:59], a[140:143]
    ds_read_b64_tr_b16 v[130:131], v11 offset:8832
    v_mfma_f32_16x16x32_bf16 a[144:147], v[132:135], v[60:63], a[144:147]
    v_mfma_f32_16x16x32_bf16 a[148:151], v[132:135], v[64:67], a[148:151]
    v_mfma_f32_16x16x32_bf16 a[152:155], v[132:135], v[68:71], a[152:155]
    v_mfma_f32_16x16x32_bf16 a[156:159], v[132:135], v[72:75], a[156:159]
    s_add_u32 s28, s49, s93
    buffer_load_dwordx4 v26, s[16:19], s28 offen lds
    v_mfma_f32_16x16x32_bf16 a[160:163], v[132:135], v[76:79], a[160:163]
    s_add_u32 m0, m0, s53
    v_mfma_f32_16x16x32_bf16 a[164:167], v[132:135], v[80:83], a[164:167]
    ds_read_b64_tr_b16 v[132:133], v11 offset:8608
    v_mfma_f32_16x16x32_bf16 a[168:171], v[136:139], v[56:59], a[168:171]
    ds_read_b64_tr_b16 v[134:135], v11 offset:8864
    v_mfma_f32_16x16x32_bf16 a[172:175], v[136:139], v[60:63], a[172:175]
    v_mfma_f32_16x16x32_bf16 a[176:179], v[136:139], v[64:67], a[176:179]
    v_mfma_f32_16x16x32_bf16 a[180:183], v[136:139], v[68:71], a[180:183]
    s_add_u32 s28, s49, s94
    buffer_load_dwordx4 v26, s[16:19], s28 offen lds
    v_mfma_f32_16x16x32_bf16 a[184:187], v[136:139], v[72:75], a[184:187]
    s_add_u32 m0, m0, s53
    v_mfma_f32_16x16x32_bf16 a[188:191], v[136:139], v[76:79], a[188:191]
    v_mfma_f32_16x16x32_bf16 a[192:195], v[136:139], v[80:83], a[192:195]
    ds_read_b64_tr_b16 v[136:137], v11 offset:8640
    v_mfma_f32_16x16x32_bf16 a[196:199], v[140:143], v[56:59], a[196:199]
    ds_read_b64_tr_b16 v[138:139], v11 offset:8896
    v_mfma_f32_16x16x32_bf16 a[200:203], v[140:143], v[60:63], a[200:203]
    v_mfma_f32_16x16x32_bf16 a[204:207], v[140:143], v[64:67], a[204:207]
    s_add_u32 s28, s49, s95
    buffer_load_dwordx4 v26, s[16:19], s28 offen lds
    v_mfma_f32_16x16x32_bf16 a[208:211], v[140:143], v[68:71], a[208:211]
    v_mfma_f32_16x16x32_bf16 a[212:215], v[140:143], v[72:75], a[212:215]
    v_mfma_f32_16x16x32_bf16 a[216:219], v[140:143], v[76:79], a[216:219]
    v_mfma_f32_16x16x32_bf16 a[220:223], v[140:143], v[80:83], a[220:223]
    ds_read_b64_tr_b16 v[140:141], v11 offset:8672
    ds_read_b64_tr_b16 v[142:143], v11 offset:8928
    s_waitcnt lgkmcnt(14)
    v_mfma_f32_16x16x32_bf16 v[144:147], v[112:115], v[28:31], v[144:147]
    s_add_u32 m0, s33, 8448
    v_mfma_f32_16x16x32_bf16 v[148:151], v[112:115], v[32:35], v[148:151]
    s_mov_b32 s49, s50
    v_mfma_f32_16x16x32_bf16 v[152:155], v[112:115], v[36:39], v[152:155]
    s_add_u32 s50, s50, s51
    v_mfma_f32_16x16x32_bf16 v[156:159], v[112:115], v[40:43], v[156:159]
    s_add_u32 s82, s82, 1
    v_mfma_f32_16x16x32_bf16 v[160:163], v[112:115], v[44:47], v[160:163]
    s_cmp_eq_u32 s82, 20
    v_mfma_f32_16x16x32_bf16 v[164:167], v[112:115], v[48:51], v[164:167]
    s_cselect_b32 s29, s83, 0
    v_mfma_f32_16x16x32_bf16 v[168:171], v[112:115], v[52:55], v[168:171]
    s_sub_u32 s50, s50, s29
    s_waitcnt vmcnt(16) lgkmcnt(0)
    s_barrier
    ds_read_b64_tr_b16 v[112:113], v11 offset:16896
    v_mfma_f32_16x16x32_bf16 v[172:175], v[116:119], v[28:31], v[172:175]
    ds_read_b64_tr_b16 v[114:115], v11 offset:17152
    v_mfma_f32_16x16x32_bf16 v[176:179], v[116:119], v[32:35], v[176:179]
    ds_read_b128 v[56:59], v27 offset:16896
    v_mfma_f32_16x16x32_bf16 v[180:183], v[116:119], v[36:39], v[180:183]
    s_add_u32 s28, s49, s88
    buffer_load_dwordx4 v26, s[16:19], s28 offen lds
    v_mfma_f32_16x16x32_bf16 v[184:187], v[116:119], v[40:43], v[184:187]
    s_add_u32 m0, m0, s53
    ds_read_b128 v[60:63], v27 offset:17920
    v_mfma_f32_16x16x32_bf16 v[188:191], v[116:119], v[44:47], v[188:191]
    ds_read_b128 v[64:67], v27 offset:18944
    v_mfma_f32_16x16x32_bf16 v[192:195], v[116:119], v[48:51], v[192:195]
    ds_read_b128 v[68:71], v27 offset:19968
    v_mfma_f32_16x16x32_bf16 v[196:199], v[116:119], v[52:55], v[196:199]
    ds_read_b128 v[72:75], v27 offset:20992
    v_mfma_f32_16x16x32_bf16 v[200:203], v[120:123], v[28:31], v[200:203]
    ds_read_b128 v[76:79], v27 offset:22016
    v_mfma_f32_16x16x32_bf16 v[204:207], v[120:123], v[32:35], v[204:207]
    s_add_u32 s28, s49, s89
    buffer_load_dwordx4 v26, s[16:19], s28 offen lds
    v_mfma_f32_16x16x32_bf16 v[208:211], v[120:123], v[36:39], v[208:211]
    s_add_u32 m0, m0, s53
    ds_read_b128 v[80:83], v27 offset:23040
    v_mfma_f32_16x16x32_bf16 v[212:215], v[120:123], v[40:43], v[212:215]
    ds_read_b64_tr_b16 v[116:117], v11 offset:16928
    v_mfma_f32_16x16x32_bf16 v[216:219], v[120:123], v[44:47], v[216:219]
    ds_read_b64_tr_b16 v[118:119], v11 offset:17184
    v_mfma_f32_16x16x32_bf16 v[220:223], v[120:123], v[48:51], v[220:223]
    v_mfma_f32_16x16x32_bf16 v[224:227], v[120:123], v[52:55], v[224:227]
    ds_read_b64_tr_b16 v[120:121], v11 offset:16960
    v_mfma_f32_16x16x32_bf16 v[228:231], v[124:127], v[28:31], v[228:231]
    s_add_u32 s28, s49, s90
    buffer_load_dwordx4 v26, s[16:19], s28 offen lds
    v_mfma_f32_16x16x32_bf16 v[232:235], v[124:127], v[32:35], v[232:235]
    s_add_u32 m0, m0, s53
    ds_read_b64_tr_b16 v[122:123], v11 offset:17216
    v_mfma_f32_16x16x32_bf16 v[236:239], v[124:127], v[36:39], v[236:239]
    v_mfma_f32_16x16x32_bf16 v[240:243], v[124:127], v[40:43], v[240:243]
    v_mfma_f32_16x16x32_bf16 v[244:247], v[124:127], v[44:47], v[244:247]
    v_mfma_f32_16x16x32_bf16 v[248:251], v[124:127], v[48:51], v[248:251]
    v_mfma_f32_16x16x32_bf16 v[252:255], v[124:127], v[52:55], v[252:255]
    s_add_u32 s28, s49, s91
    buffer_load_dwordx4 v26, s[16:19], s28 offen lds
    v_mfma_f32_16x16x32_bf16 a[112:115], v[128:131], v[28:31], a[112:115]
    s_add_u32 m0, m0, s53
    ds_read_b64_tr_b16 v[124:125], v11 offset:16992
    v_mfma_f32_16x16x32_bf16 a[116:119], v[128:131], v[32:35], a[116:119]
    ds_read_b64_tr_b16 v[126:127], v11 offset:17248
    v_mfma_f32_16x16x32_bf16 a[120:123], v[128:131], v[36:39], a[120:123]
    v_mfma_f32_16x16x32_bf16 a[124:127], v[128:131], v[40:43], a[124:127]
    v_mfma_f32_16x16x32_bf16 a[128:131], v[128:131], v[44:47], a[128:131]
    v_mfma_f32_16x16x32_bf16 a[132:135], v[128:131], v[48:51], a[132:135]
    s_add_u32 s28, s49, s92
    buffer_load_dwordx4 v26, s[16:19], s28 offen lds
    v_mfma_f32_16x16x32_bf16 a[136:139], v[128:131], v[52:55], a[136:139]
    s_add_u32 m0, m0, s53
    ds_read_b64_tr_b16 v[128:129], v11 offset:17024
    v_mfma_f32_16x16x32_bf16 a[140:143], v[132:135], v[28:31], a[140:143]
    ds_read_b64_tr_b16 v[130:131], v11 offset:17280
    v_mfma_f32_16x16x32_bf16 a[144:147], v[132:135], v[32:35], a[144:147]
    v_mfma_f32_16x16x32_bf16 a[148:151], v[132:135], v[36:39], a[148:151]
    v_mfma_f32_16x16x32_bf16 a[152:155], v[132:135], v[40:43], a[152:155]
    v_mfma_f32_16x16x32_bf16 a[156:159], v[132:135], v[44:47], a[156:159]
    s_add_u32 s28, s49, s93
    buffer_load_dwordx4 v26, s[16:19], s28 offen lds
    v_mfma_f32_16x16x32_bf16 a[160:163], v[132:135], v[48:51], a[160:163]
    s_add_u32 m0, m0, s53
    v_mfma_f32_16x16x32_bf16 a[164:167], v[132:135], v[52:55], a[164:167]
    ds_read_b64_tr_b16 v[132:133], v11 offset:17056
    v_mfma_f32_16x16x32_bf16 a[168:171], v[136:139], v[28:31], a[168:171]
    ds_read_b64_tr_b16 v[134:135], v11 offset:17312
    v_mfma_f32_16x16x32_bf16 a[172:175], v[136:139], v[32:35], a[172:175]
    v_mfma_f32_16x16x32_bf16 a[176:179], v[136:139], v[36:39], a[176:179]
    v_mfma_f32_16x16x32_bf16 a[180:183], v[136:139], v[40:43], a[180:183]
    s_add_u32 s28, s49, s94
    buffer_load_dwordx4 v26, s[16:19], s28 offen lds
    v_mfma_f32_16x16x32_bf16 a[184:187], v[136:139], v[44:47], a[184:187]
    s_add_u32 m0, m0, s53
    v_mfma_f32_16x16x32_bf16 a[188:191], v[136:139], v[48:51], a[188:191]
    v_mfma_f32_16x16x32_bf16 a[192:195], v[136:139], v[52:55], a[192:195]
    ds_read_b64_tr_b16 v[136:137], v11 offset:17088
    v_mfma_f32_16x16x32_bf16 a[196:199], v[140:143], v[28:31], a[196:199]
    ds_read_b64_tr_b16 v[138:139], v11 offset:17344
    v_mfma_f32_16x16x32_bf16 a[200:203], v[140:143], v[32:35], a[200:203]
    v_mfma_f32_16x16x32_bf16 a[204:207], v[140:143], v[36:39], a[204:207]
    s_add_u32 s28, s49, s95
    buffer_load_dwordx4 v26, s[16:19], s28 offen lds
    v_mfma_f32_16x16x32_bf16 a[208:211], v[140:143], v[40:43], a[208:211]
    v_mfma_f32_16x16x32_bf16 a[212:215], v[140:143], v[44:47], a[212:215]
    v_mfma_f32_16x16x32_bf16 a[216:219], v[140:143], v[48:51], a[216:219]
    v_mfma_f32_16x16x32_bf16 a[220:223], v[140:143], v[52:55], a[220:223]
    ds_read_b64_tr_b16 v[140:141], v11 offset:17120
    ds_read_b64_tr_b16 v[142:143], v11 offset:17376
    s_waitcnt lgkmcnt(14)
    v_mfma_f32_16x16x32_bf16 v[144:147], v[112:115], v[56:59], v[144:147]
    s_add_u32 m0, s33, 16896
    v_mfma_f32_16x16x32_bf16 v[148:151], v[112:115], v[60:63], v[148:151]
    s_mov_b32 s49, s50
    v_mfma_f32_16x16x32_bf16 v[152:155], v[112:115], v[64:67], v[152:155]
    s_add_u32 s50, s50, s51
    v_mfma_f32_16x16x32_bf16 v[156:159], v[112:115], v[68:71], v[156:159]
    s_add_u32 s82, s82, 1
    v_mfma_f32_16x16x32_bf16 v[160:163], v[112:115], v[72:75], v[160:163]
    s_cmp_eq_u32 s82, 20
    v_mfma_f32_16x16x32_bf16 v[164:167], v[112:115], v[76:79], v[164:167]
    s_cselect_b32 s29, s83, 0
    v_mfma_f32_16x16x32_bf16 v[168:171], v[112:115], v[80:83], v[168:171]
    s_sub_u32 s50, s50, s29
    s_waitcnt vmcnt(16) lgkmcnt(0)
    s_barrier
    ds_read_b64_tr_b16 v[112:113], v11 offset:25344
    v_mfma_f32_16x16x32_bf16 v[172:175], v[116:119], v[56:59], v[172:175]
    ds_read_b64_tr_b16 v[114:115], v11 offset:25600
    v_mfma_f32_16x16x32_bf16 v[176:179], v[116:119], v[60:63], v[176:179]
    ds_read_b128 v[28:31], v27 offset:25344
    v_mfma_f32_16x16x32_bf16 v[180:183], v[116:119], v[64:67], v[180:183]
    s_add_u32 s28, s49, s88
    buffer_load_dwordx4 v26, s[16:19], s28 offen lds
    v_mfma_f32_16x16x32_bf16 v[184:187], v[116:119], v[68:71], v[184:187]
    s_add_u32 m0, m0, s53
    ds_read_b128 v[32:35], v27 offset:26368
    v_mfma_f32_16x16x32_bf16 v[188:191], v[116:119], v[72:75], v[188:191]
    ds_read_b128 v[36:39], v27 offset:27392
    v_mfma_f32_16x16x32_bf16 v[192:195], v[116:119], v[76:79], v[192:195]
    ds_read_b128 v[40:43], v27 offset:28416
    v_mfma_f32_16x16x32_bf16 v[196:199], v[116:119], v[80:83], v[196:199]
    ds_read_b128 v[44:47], v27 offset:29440
    v_mfma_f32_16x16x32_bf16 v[200:203], v[120:123], v[56:59], v[200:203]
    ds_read_b128 v[48:51], v27 offset:30464
    v_mfma_f32_16x16x32_bf16 v[204:207], v[120:123], v[60:63], v[204:207]
    s_add_u32 s28, s49, s89
    buffer_load_dwordx4 v26, s[16:19], s28 offen lds
    v_mfma_f32_16x16x32_bf16 v[208:211], v[120:123], v[64:67], v[208:211]
    s_add_u32 m0, m0, s53
    ds_read_b128 v[52:55], v27 offset:31488
    v_mfma_f32_16x16x32_bf16 v[212:215], v[120:123], v[68:71], v[212:215]
    ds_read_b64_tr_b16 v[116:117], v11 offset:25376
    v_mfma_f32_16x16x32_bf16 v[216:219], v[120:123], v[72:75], v[216:219]
    ds_read_b64_tr_b16 v[118:119], v11 offset:25632
    v_mfma_f32_16x16x32_bf16 v[220:223], v[120:123], v[76:79], v[220:223]
    v_mfma_f32_16x16x32_bf16 v[224:227], v[120:123], v[80:83], v[224:227]
    ds_read_b64_tr_b16 v[120:121], v11 offset:25408
    v_mfma_f32_16x16x32_bf16 v[228:231], v[124:127], v[56:59], v[228:231]
    s_add_u32 s28, s49, s90
    buffer_load_dwordx4 v26, s[16:19], s28 offen lds
    v_mfma_f32_16x16x32_bf16 v[232:235], v[124:127], v[60:63], v[232:235]
    s_add_u32 m0, m0, s53
    ds_read_b64_tr_b16 v[122:123], v11 offset:25664
    v_mfma_f32_16x16x32_bf16 v[236:239], v[124:127], v[64:67], v[236:239]
    v_mfma_f32_16x16x32_bf16 v[240:243], v[124:127], v[68:71], v[240:243]
    v_mfma_f32_16x16x32_bf16 v[244:247], v[124:127], v[72:75], v[244:247]
    v_mfma_f32_16x16x32_bf16 v[248:251], v[124:127], v[76:79], v[248:251]
    v_mfma_f32_16x16x32_bf16 v[252:255], v[124:127], v[80:83], v[252:255]
    s_add_u32 s28, s49, s91
    buffer_load_dwordx4 v26, s[16:19], s28 offen lds
    v_mfma_f32_16x16x32_bf16 a[112:115], v[128:131], v[56:59], a[112:115]
    s_add_u32 m0, m0, s53
    ds_read_b64_tr_b16 v[124:125], v11 offset:25440
    v_mfma_f32_16x16x32_bf16 a[116:119], v[128:131], v[60:63], a[116:119]
    ds_read_b64_tr_b16 v[126:127], v11 offset:25696
    v_mfma_f32_16x16x32_bf16 a[120:123], v[128:131], v[64:67], a[120:123]
    v_mfma_f32_16x16x32_bf16 a[124:127], v[128:131], v[68:71], a[124:127]
    v_mfma_f32_16x16x32_bf16 a[128:131], v[128:131], v[72:75], a[128:131]
    v_mfma_f32_16x16x32_bf16 a[132:135], v[128:131], v[76:79], a[132:135]
    s_add_u32 s28, s49, s92
    buffer_load_dwordx4 v26, s[16:19], s28 offen lds
    v_mfma_f32_16x16x32_bf16 a[136:139], v[128:131], v[80:83], a[136:139]
    s_add_u32 m0, m0, s53
    ds_read_b64_tr_b16 v[128:129], v11 offset:25472
    v_mfma_f32_16x16x32_bf16 a[140:143], v[132:135], v[56:59], a[140:143]
    ds_read_b64_tr_b16 v[130:131], v11 offset:25728
    v_mfma_f32_16x16x32_bf16 a[144:147], v[132:135], v[60:63], a[144:147]
    v_mfma_f32_16x16x32_bf16 a[148:151], v[132:135], v[64:67], a[148:151]
    v_mfma_f32_16x16x32_bf16 a[152:155], v[132:135], v[68:71], a[152:155]
    v_mfma_f32_16x16x32_bf16 a[156:159], v[132:135], v[72:75], a[156:159]
    s_add_u32 s28, s49, s93
    buffer_load_dwordx4 v26, s[16:19], s28 offen lds
    v_mfma_f32_16x16x32_bf16 a[160:163], v[132:135], v[76:79], a[160:163]
    s_add_u32 m0, m0, s53
    v_mfma_f32_16x16x32_bf16 a[164:167], v[132:135], v[80:83], a[164:167]
    ds_read_b64_tr_b16 v[132:133], v11 offset:25504
    v_mfma_f32_16x16x32_bf16 a[168:171], v[136:139], v[56:59], a[168:171]
    ds_read_b64_tr_b16 v[134:135], v11 offset:25760
    v_mfma_f32_16x16x32_bf16 a[172:175], v[136:139], v[60:63], a[172:175]
    v_mfma_f32_16x16x32_bf16 a[176:179], v[136:139], v[64:67], a[176:179]
    v_mfma_f32_16x16x32_bf16 a[180:183], v[136:139], v[68:71], a[180:183]
    s_add_u32 s28, s49, s94
    buffer_load_dwordx4 v26, s[16:19], s28 offen lds
    v_mfma_f32_16x16x32_bf16 a[184:187], v[136:139], v[72:75], a[184:187]
    s_add_u32 m0, m0, s53
    v_mfma_f32_16x16x32_bf16 a[188:191], v[136:139], v[76:79], a[188:191]
    v_mfma_f32_16x16x32_bf16 a[192:195], v[136:139], v[80:83], a[192:195]
    ds_read_b64_tr_b16 v[136:137], v11 offset:25536
    v_mfma_f32_16x16x32_bf16 a[196:199], v[140:143], v[56:59], a[196:199]
    ds_read_b64_tr_b16 v[138:139], v11 offset:25792
    v_mfma_f32_16x16x32_bf16 a[200:203], v[140:143], v[60:63], a[200:203]
    v_mfma_f32_16x16x32_bf16 a[204:207], v[140:143], v[64:67], a[204:207]
    s_add_u32 s28, s49, s95
    buffer_load_dwordx4 v26, s[16:19], s28 offen lds
    v_mfma_f32_16x16x32_bf16 a[208:211], v[140:143], v[68:71], a[208:211]
    v_mfma_f32_16x16x32_bf16 a[212:215], v[140:143], v[72:75], a[212:215]
    v_mfma_f32_16x16x32_bf16 a[216:219], v[140:143], v[76:79], a[216:219]
    v_mfma_f32_16x16x32_bf16 a[220:223], v[140:143], v[80:83], a[220:223]
    ds_read_b64_tr_b16 v[140:141], v11 offset:25568
    ds_read_b64_tr_b16 v[142:143], v11 offset:25824
    s_waitcnt lgkmcnt(14)
    v_mfma_f32_16x16x32_bf16 v[144:147], v[112:115], v[28:31], v[144:147]
    s_add_u32 m0, s33, 25344
    v_mfma_f32_16x16x32_bf16 v[148:151], v[112:115], v[32:35], v[148:151]
    s_mov_b32 s49, s50
    v_mfma_f32_16x16x32_bf16 v[152:155], v[112:115], v[36:39], v[152:155]
    s_add_u32 s50, s50, s51
    v_mfma_f32_16x16x32_bf16 v[156:159], v[112:115], v[40:43], v[156:159]
    s_add_u32 s82, s82, 1
    v_mfma_f32_16x16x32_bf16 v[160:163], v[112:115], v[44:47], v[160:163]
    s_cmp_eq_u32 s82, 20
    v_mfma_f32_16x16x32_bf16 v[164:167], v[112:115], v[48:51], v[164:167]
    s_cselect_b32 s29, s83, 0
    v_mfma_f32_16x16x32_bf16 v[168:171], v[112:115], v[52:55], v[168:171]
    s_sub_u32 s50, s50, s29
    s_waitcnt vmcnt(16) lgkmcnt(0)
    s_barrier
    v_mfma_f32_16x16x32_bf16 v[172:175], v[116:119], v[28:31], v[172:175]
    v_mfma_f32_16x16x32_bf16 v[176:179], v[116:119], v[32:35], v[176:179]
    v_mfma_f32_16x16x32_bf16 v[180:183], v[116:119], v[36:39], v[180:183]
    s_add_u32 s28, s49, s88
    buffer_load_dwordx4 v26, s[16:19], s28 offen lds
    v_mfma_f32_16x16x32_bf16 v[184:187], v[116:119], v[40:43], v[184:187]
    s_add_u32 m0, m0, s53
    v_mfma_f32_16x16x32_bf16 v[188:191], v[116:119], v[44:47], v[188:191]
    v_mfma_f32_16x16x32_bf16 v[192:195], v[116:119], v[48:51], v[192:195]
    v_mfma_f32_16x16x32_bf16 v[196:199], v[116:119], v[52:55], v[196:199]
    v_mfma_f32_16x16x32_bf16 v[200:203], v[120:123], v[28:31], v[200:203]
    v_mfma_f32_16x16x32_bf16 v[204:207], v[120:123], v[32:35], v[204:207]
    s_add_u32 s28, s49, s89
    buffer_load_dwordx4 v26, s[16:19], s28 offen lds
    v_mfma_f32_16x16x32_bf16 v[208:211], v[120:123], v[36:39], v[208:211]
    s_add_u32 m0, m0, s53
    v_mfma_f32_16x16x32_bf16 v[212:215], v[120:123], v[40:43], v[212:215]
    v_mfma_f32_16x16x32_bf16 v[216:219], v[120:123], v[44:47], v[216:219]
    v_mfma_f32_16x16x32_bf16 v[220:223], v[120:123], v[48:51], v[220:223]
    v_mfma_f32_16x16x32_bf16 v[224:227], v[120:123], v[52:55], v[224:227]
    v_mfma_f32_16x16x32_bf16 v[228:231], v[124:127], v[28:31], v[228:231]
    s_add_u32 s28, s49, s90
    buffer_load_dwordx4 v26, s[16:19], s28 offen lds
    v_mfma_f32_16x16x32_bf16 v[232:235], v[124:127], v[32:35], v[232:235]
    s_add_u32 m0, m0, s53
    v_mfma_f32_16x16x32_bf16 v[236:239], v[124:127], v[36:39], v[236:239]
    v_mfma_f32_16x16x32_bf16 v[240:243], v[124:127], v[40:43], v[240:243]
    v_mfma_f32_16x16x32_bf16 v[244:247], v[124:127], v[44:47], v[244:247]
    v_mfma_f32_16x16x32_bf16 v[248:251], v[124:127], v[48:51], v[248:251]
    v_mfma_f32_16x16x32_bf16 v[252:255], v[124:127], v[52:55], v[252:255]
    s_add_u32 s28, s49, s91
    buffer_load_dwordx4 v26, s[16:19], s28 offen lds
    v_mfma_f32_16x16x32_bf16 a[112:115], v[128:131], v[28:31], a[112:115]
    s_add_u32 m0, m0, s53
    v_mfma_f32_16x16x32_bf16 a[116:119], v[128:131], v[32:35], a[116:119]
    v_mfma_f32_16x16x32_bf16 a[120:123], v[128:131], v[36:39], a[120:123]
    v_mfma_f32_16x16x32_bf16 a[124:127], v[128:131], v[40:43], a[124:127]
    v_mfma_f32_16x16x32_bf16 a[128:131], v[128:131], v[44:47], a[128:131]
    v_mfma_f32_16x16x32_bf16 a[132:135], v[128:131], v[48:51], a[132:135]
    s_add_u32 s28, s49, s92
    buffer_load_dwordx4 v26, s[16:19], s28 offen lds
    v_mfma_f32_16x16x32_bf16 a[136:139], v[128:131], v[52:55], a[136:139]
    s_add_u32 m0, m0, s53
    v_mfma_f32_16x16x32_bf16 a[140:143], v[132:135], v[28:31], a[140:143]
    v_mfma_f32_16x16x32_bf16 a[144:147], v[132:135], v[32:35], a[144:147]
    v_mfma_f32_16x16x32_bf16 a[148:151], v[132:135], v[36:39], a[148:151]
    v_mfma_f32_16x16x32_bf16 a[152:155], v[132:135], v[40:43], a[152:155]
    v_mfma_f32_16x16x32_bf16 a[156:159], v[132:135], v[44:47], a[156:159]
    s_add_u32 s28, s49, s93
    buffer_load_dwordx4 v26, s[16:19], s28 offen lds
    v_mfma_f32_16x16x32_bf16 a[160:163], v[132:135], v[48:51], a[160:163]
    s_add_u32 m0, m0, s53
    v_mfma_f32_16x16x32_bf16 a[164:167], v[132:135], v[52:55], a[164:167]
    v_mfma_f32_16x16x32_bf16 a[168:171], v[136:139], v[28:31], a[168:171]
    v_mfma_f32_16x16x32_bf16 a[172:175], v[136:139], v[32:35], a[172:175]
    v_mfma_f32_16x16x32_bf16 a[176:179], v[136:139], v[36:39], a[176:179]
    v_mfma_f32_16x16x32_bf16 a[180:183], v[136:139], v[40:43], a[180:183]
    s_add_u32 s28, s49, s94
    buffer_load_dwordx4 v26, s[16:19], s28 offen lds
    v_mfma_f32_16x16x32_bf16 a[184:187], v[136:139], v[44:47], a[184:187]
    s_add_u32 m0, m0, s53
    v_mfma_f32_16x16x32_bf16 a[188:191], v[136:139], v[48:51], a[188:191]
    v_mfma_f32_16x16x32_bf16 a[192:195], v[136:139], v[52:55], a[192:195]
    v_mfma_f32_16x16x32_bf16 a[196:199], v[140:143], v[28:31], a[196:199]
    v_mfma_f32_16x16x32_bf16 a[200:203], v[140:143], v[32:35], a[200:203]
    v_mfma_f32_16x16x32_bf16 a[204:207], v[140:143], v[36:39], a[204:207]
    s_add_u32 s28, s49, s95
    buffer_load_dwordx4 v26, s[16:19], s28 offen lds
    v_mfma_f32_16x16x32_bf16 a[208:211], v[140:143], v[40:43], a[208:211]
    v_mfma_f32_16x16x32_bf16 a[212:215], v[140:143], v[44:47], a[212:215]
    v_mfma_f32_16x16x32_bf16 a[216:219], v[140:143], v[48:51], a[216:219]
    v_mfma_f32_16x16x32_bf16 a[220:223], v[140:143], v[52:55], a[220:223]
L_at_qpepi:
    v_mov_b32 v4, s54
    v_mov_b32 v5, s54
    s_nop 6
    v_pk_mul_f32 v[144:145], v[144:145], v[4:5]
    v_pk_mul_f32 v[146:147], v[146:147], v[4:5]
    v_pk_mul_f32 v[148:149], v[148:149], v[4:5]
    v_pk_mul_f32 v[150:151], v[150:151], v[4:5]
    v_pk_mul_f32 v[152:153], v[152:153], v[4:5]
    v_pk_mul_f32 v[154:155], v[154:155], v[4:5]
    v_pk_mul_f32 v[156:157], v[156:157], v[4:5]
    v_pk_mul_f32 v[158:159], v[158:159], v[4:5]
    v_pk_mul_f32 v[160:161], v[160:161], v[4:5]
    v_pk_mul_f32 v[162:163], v[162:163], v[4:5]
    v_pk_mul_f32 v[164:165], v[164:165], v[4:5]
    v_pk_mul_f32 v[166:167], v[166:167], v[4:5]
    v_pk_mul_f32 v[168:169], v[168:169], v[4:5]
    v_pk_mul_f32 v[170:171], v[170:171], v[4:5]
    v_pk_mul_f32 v[172:173], v[172:173], v[4:5]
    v_pk_mul_f32 v[174:175], v[174:175], v[4:5]
    v_pk_mul_f32 v[176:177], v[176:177], v[4:5]
    v_pk_mul_f32 v[178:179], v[178:179], v[4:5]
    v_pk_mul_f32 v[180:181], v[180:181], v[4:5]
    v_pk_mul_f32 v[182:183], v[182:183], v[4:5]
    v_pk_mul_f32 v[184:185], v[184:185], v[4:5]
    v_pk_mul_f32 v[186:187], v[186:187], v[4:5]
    v_pk_mul_f32 v[188:189], v[188:189], v[4:5]
    v_pk_mul_f32 v[190:191], v[190:191], v[4:5]
    v_pk_mul_f32 v[192:193], v[192:193], v[4:5]
    v_pk_mul_f32 v[194:195], v[194:195], v[4:5]
    v_pk_mul_f32 v[196:197], v[196:197], v[4:5]
    v_pk_mul_f32 v[198:199], v[198:199], v[4:5]
    v_cvt_pk_bf16_f32 v88, v144, v145
    v_cvt_pk_bf16_f32 v89, v146, v147
    v_cvt_pk_bf16_f32 v90, v172, v173
    v_cvt_pk_bf16_f32 v91, v174, v175
    v_cvt_pk_bf16_f32 v92, v148, v149
    v_cvt_pk_bf16_f32 v93, v150, v151
    v_cvt_pk_bf16_f32 v94, v176, v177
    v_cvt_pk_bf16_f32 v95, v178, v179
    v_cvt_pk_bf16_f32 v96, v152, v153
    v_cvt_pk_bf16_f32 v97, v154, v155
    v_cvt_pk_bf16_f32 v98, v180, v181
    v_cvt_pk_bf16_f32 v99, v182, v183
    v_cvt_pk_bf16_f32 v100, v156, v157
    v_cvt_pk_bf16_f32 v101, v158, v159
    v_cvt_pk_bf16_f32 v102, v184, v185
    v_cvt_pk_bf16_f32 v103, v186, v187
    v_cvt_pk_bf16_f32 v104, v160, v161
    v_cvt_pk_bf16_f32 v105, v162, v163
    v_cvt_pk_bf16_f32 v106, v188, v189
    v_cvt_pk_bf16_f32 v107, v190, v191
    v_cvt_pk_bf16_f32 v108, v164, v165
    v_cvt_pk_bf16_f32 v109, v166, v167
    v_cvt_pk_bf16_f32 v110, v192, v193
    v_cvt_pk_bf16_f32 v111, v194, v195
    v_cvt_pk_bf16_f32 v112, v168, v169
    v_cvt_pk_bf16_f32 v113, v170, v171
    v_cvt_pk_bf16_f32 v114, v196, v197
    v_cvt_pk_bf16_f32 v115, v198, v199
    s_nop 1
    v_permlane16_swap_b32 v88, v90
    v_permlane16_swap_b32 v89, v91
    v_permlane16_swap_b32 v92, v94
    v_permlane16_swap_b32 v93, v95
    v_permlane16_swap_b32 v96, v98
    v_permlane16_swap_b32 v97, v99
    v_permlane16_swap_b32 v100, v102
    v_permlane16_swap_b32 v101, v103
    v_permlane16_swap_b32 v104, v106
    v_permlane16_swap_b32 v105, v107
    v_permlane16_swap_b32 v108, v110
    v_permlane16_swap_b32 v109, v111
    v_permlane16_swap_b32 v112, v114
    v_permlane16_swap_b32 v113, v115
    v_accvgpr_write_b32 a0, v88
    v_accvgpr_write_b32 a1, v89
    v_accvgpr_write_b32 a2, v90
    v_accvgpr_write_b32 a3, v91
    v_accvgpr_write_b32 a16, v92
    v_accvgpr_write_b32 a17, v93
    v_accvgpr_write_b32 a18, v94
    v_accvgpr_write_b32 a19, v95
    v_accvgpr_write_b32 a32, v96
    v_accvgpr_write_b32 a33, v97
    v_accvgpr_write_b32 a34, v98
    v_accvgpr_write_b32 a35, v99
    v_accvgpr_write_b32 a48, v100
    v_accvgpr_write_b32 a49, v101
    v_accvgpr_write_b32 a50, v102
    v_accvgpr_write_b32 a51, v103
    v_accvgpr_write_b32 a64, v104
    v_accvgpr_write_b32 a65, v105
    v_accvgpr_write_b32 a66, v106
    v_accvgpr_write_b32 a67, v107
    v_accvgpr_write_b32 a80, v108
    v_accvgpr_write_b32 a81, v109
    v_accvgpr_write_b32 a82, v110
    v_accvgpr_write_b32 a83, v111
    v_accvgpr_write_b32 a96, v112
    v_accvgpr_write_b32 a97, v113
    v_accvgpr_write_b32 a98, v114
    v_accvgpr_write_b32 a99, v115
    v_pk_mul_f32 v[200:201], v[200:201], v[4:5]
    v_pk_mul_f32 v[202:203], v[202:203], v[4:5]
    v_pk_mul_f32 v[204:205], v[204:205], v[4:5]
    v_pk_mul_f32 v[206:207], v[206:207], v[4:5]
    v_pk_mul_f32 v[208:209], v[208:209], v[4:5]
    v_pk_mul_f32 v[210:211], v[210:211], v[4:5]
    v_pk_mul_f32 v[212:213], v[212:213], v[4:5]
    v_pk_mul_f32 v[214:215], v[214:215], v[4:5]
    v_pk_mul_f32 v[216:217], v[216:217], v[4:5]
    v_pk_mul_f32 v[218:219], v[218:219], v[4:5]
    v_pk_mul_f32 v[220:221], v[220:221], v[4:5]
    v_pk_mul_f32 v[222:223], v[222:223], v[4:5]
    v_pk_mul_f32 v[224:225], v[224:225], v[4:5]
    v_pk_mul_f32 v[226:227], v[226:227], v[4:5]
    v_pk_mul_f32 v[228:229], v[228:229], v[4:5]
    v_pk_mul_f32 v[230:231], v[230:231], v[4:5]
    v_pk_mul_f32 v[232:233], v[232:233], v[4:5]
    v_pk_mul_f32 v[234:235], v[234:235], v[4:5]
    v_pk_mul_f32 v[236:237], v[236:237], v[4:5]
    v_pk_mul_f32 v[238:239], v[238:239], v[4:5]
    v_pk_mul_f32 v[240:241], v[240:241], v[4:5]
    v_pk_mul_f32 v[242:243], v[242:243], v[4:5]
    v_pk_mul_f32 v[244:245], v[244:245], v[4:5]
    v_pk_mul_f32 v[246:247], v[246:247], v[4:5]
    v_pk_mul_f32 v[248:249], v[248:249], v[4:5]
    v_pk_mul_f32 v[250:251], v[250:251], v[4:5]
    v_pk_mul_f32 v[252:253], v[252:253], v[4:5]
    v_pk_mul_f32 v[254:255], v[254:255], v[4:5]
    v_cvt_pk_bf16_f32 v116, v200, v201
    v_cvt_pk_bf16_f32 v117, v202, v203
    v_cvt_pk_bf16_f32 v118, v228, v229
    v_cvt_pk_bf16_f32 v119, v230, v231
    v_cvt_pk_bf16_f32 v120, v204, v205
    v_cvt_pk_bf16_f32 v121, v206, v207
    v_cvt_pk_bf16_f32 v122, v232, v233
    v_cvt_pk_bf16_f32 v123, v234, v235
    v_cvt_pk_bf16_f32 v124, v208, v209
    v_cvt_pk_bf16_f32 v125, v210, v211
    v_cvt_pk_bf16_f32 v126, v236, v237
    v_cvt_pk_bf16_f32 v127, v238, v239
    v_cvt_pk_bf16_f32 v128, v212, v213
    v_cvt_pk_bf16_f32 v129, v214, v215
    v_cvt_pk_bf16_f32 v130, v240, v241
    v_cvt_pk_bf16_f32 v131, v242, v243
    v_cvt_pk_bf16_f32 v132, v216, v217
    v_cvt_pk_bf16_f32 v133, v218, v219
    v_cvt_pk_bf16_f32 v134, v244, v245
    v_cvt_pk_bf16_f32 v135, v246, v247
    v_cvt_pk_bf16_f32 v136, v220, v221
    v_cvt_pk_bf16_f32 v137, v222, v223
    v_cvt_pk_bf16_f32 v138, v248, v249
    v_cvt_pk_bf16_f32 v139, v250, v251
    v_cvt_pk_bf16_f32 v140, v224, v225
    v_cvt_pk_bf16_f32 v141, v226, v227
    v_cvt_pk_bf16_f32 v142, v252, v253
    v_cvt_pk_bf16_f32 v143, v254, v255
    s_nop 1
    v_permlane16_swap_b32 v116, v118
    v_permlane16_swap_b32 v117, v119
    v_permlane16_swap_b32 v120, v122
    v_permlane16_swap_b32 v121, v123
    v_permlane16_swap_b32 v124, v126
    v_permlane16_swap_b32 v125, v127
    v_permlane16_swap_b32 v128, v130
    v_permlane16_swap_b32 v129, v131
    v_permlane16_swap_b32 v132, v134
    v_permlane16_swap_b32 v133, v135
    v_permlane16_swap_b32 v136, v138
    v_permlane16_swap_b32 v137, v139
    v_permlane16_swap_b32 v140, v142
    v_permlane16_swap_b32 v141, v143
    v_accvgpr_write_b32 a4, v116
    v_accvgpr_write_b32 a5, v117
    v_accvgpr_write_b32 a6, v118
    v_accvgpr_write_b32 a7, v119
    v_accvgpr_write_b32 a20, v120
    v_accvgpr_write_b32 a21, v121
    v_accvgpr_write_b32 a22, v122
    v_accvgpr_write_b32 a23, v123
    v_accvgpr_write_b32 a36, v124
    v_accvgpr_write_b32 a37, v125
    v_accvgpr_write_b32 a38, v126
    v_accvgpr_write_b32 a39, v127
    v_accvgpr_write_b32 a52, v128
    v_accvgpr_write_b32 a53, v129
    v_accvgpr_write_b32 a54, v130
    v_accvgpr_write_b32 a55, v131
    v_accvgpr_write_b32 a68, v132
    v_accvgpr_write_b32 a69, v133
    v_accvgpr_write_b32 a70, v134
    v_accvgpr_write_b32 a71, v135
    v_accvgpr_write_b32 a84, v136
    v_accvgpr_write_b32 a85, v137
    v_accvgpr_write_b32 a86, v138
    v_accvgpr_write_b32 a87, v139
    v_accvgpr_write_b32 a100, v140
    v_accvgpr_write_b32 a101, v141
    v_accvgpr_write_b32 a102, v142
    v_accvgpr_write_b32 a103, v143
    v_accvgpr_read_b32 v144, a112
    v_accvgpr_read_b32 v145, a113
    v_accvgpr_read_b32 v146, a114
    v_accvgpr_read_b32 v147, a115
    v_accvgpr_read_b32 v148, a116
    v_accvgpr_read_b32 v149, a117
    v_accvgpr_read_b32 v150, a118
    v_accvgpr_read_b32 v151, a119
    v_accvgpr_read_b32 v152, a120
    v_accvgpr_read_b32 v153, a121
    v_accvgpr_read_b32 v154, a122
    v_accvgpr_read_b32 v155, a123
    v_accvgpr_read_b32 v156, a124
    v_accvgpr_read_b32 v157, a125
    v_accvgpr_read_b32 v158, a126
    v_accvgpr_read_b32 v159, a127
    v_accvgpr_read_b32 v160, a128
    v_accvgpr_read_b32 v161, a129
    v_accvgpr_read_b32 v162, a130
    v_accvgpr_read_b32 v163, a131
    v_accvgpr_read_b32 v164, a132
    v_accvgpr_read_b32 v165, a133
    v_accvgpr_read_b32 v166, a134
    v_accvgpr_read_b32 v167, a135
    v_accvgpr_read_b32 v168, a136
    v_accvgpr_read_b32 v169, a137
    v_accvgpr_read_b32 v170, a138
    v_accvgpr_read_b32 v171, a139
    v_accvgpr_read_b32 v172, a140
    v_accvgpr_read_b32 v173, a141
    v_accvgpr_read_b32 v174, a142
    v_accvgpr_read_b32 v175, a143
    v_accvgpr_read_b32 v176, a144
    v_accvgpr_read_b32 v177, a145
    v_accvgpr_read_b32 v178, a146
    v_accvgpr_read_b32 v179, a147
    v_accvgpr_read_b32 v180, a148
    v_accvgpr_read_b32 v181, a149
    v_accvgpr_read_b32 v182, a150
    v_accvgpr_read_b32 v183, a151
    v_accvgpr_read_b32 v184, a152
    v_accvgpr_read_b32 v185, a153
    v_accvgpr_read_b32 v186, a154
    v_accvgpr_read_b32 v187, a155
    v_accvgpr_read_b32 v188, a156
    v_accvgpr_read_b32 v189, a157
    v_accvgpr_read_b32 v190, a158
    v_accvgpr_read_b32 v191, a159
    v_accvgpr_read_b32 v192, a160
    v_accvgpr_read_b32 v193, a161
    v_accvgpr_read_b32 v194, a162
    v_accvgpr_read_b32 v195, a163
    v_accvgpr_read_b32 v196, a164
    v_accvgpr_read_b32 v197, a165
    v_accvgpr_read_b32 v198, a166
    v_accvgpr_read_b32 v199, a167
    v_pk_mul_f32 v[144:145], v[144:145], v[4:5]
    v_pk_mul_f32 v[146:147], v[146:147], v[4:5]
    v_pk_mul_f32 v[148:149], v[148:149], v[4:5]
    v_pk_mul_f32 v[150:151], v[150:151], v[4:5]
    v_pk_mul_f32 v[152:153], v[152:153], v[4:5]
    v_pk_mul_f32 v[154:155], v[154:155], v[4:5]
    v_pk_mul_f32 v[156:157], v[156:157], v[4:5]
    v_pk_mul_f32 v[158:159], v[158:159], v[4:5]
    v_pk_mul_f32 v[160:161], v[160:161], v[4:5]
    v_pk_mul_f32 v[162:163], v[162:163], v[4:5]
    v_pk_mul_f32 v[164:165], v[164:165], v[4:5]
    v_pk_mul_f32 v[166:167], v[166:167], v[4:5]
    v_pk_mul_f32 v[168:169], v[168:169], v[4:5]
    v_pk_mul_f32 v[170:171], v[170:171], v[4:5]
    v_pk_mul_f32 v[172:173], v[172:173], v[4:5]
    v_pk_mul_f32 v[174:175], v[174:175], v[4:5]
    v_pk_mul_f32 v[176:177], v[176:177], v[4:5]
    v_pk_mul_f32 v[178:179], v[178:179], v[4:5]
    v_pk_mul_f32 v[180:181], v[180:181], v[4:5]
    v_pk_mul_f32 v[182:183], v[182:183], v[4:5]
    v_pk_mul_f32 v[184:185], v[184:185], v[4:5]
    v_pk_mul_f32 v[186:187], v[186:187], v[4:5]
    v_pk_mul_f32 v[188:189], v[188:189], v[4:5]
    v_pk_mul_f32 v[190:191], v[190:191], v[4:5]
    v_pk_mul_f32 v[192:193], v[192:193], v[4:5]
    v_pk_mul_f32 v[194:195], v[194:195], v[4:5]
    v_pk_mul_f32 v[196:197], v[196:197], v[4:5]
    v_pk_mul_f32 v[198:199], v[198:199], v[4:5]
    v_cvt_pk_bf16_f32 v88, v144, v145
    v_cvt_pk_bf16_f32 v89, v146, v147
    v_cvt_pk_bf16_f32 v90, v172, v173
    v_cvt_pk_bf16_f32 v91, v174, v175
    v_cvt_pk_bf16_f32 v92, v148, v149
    v_cvt_pk_bf16_f32 v93, v150, v151
    v_cvt_pk_bf16_f32 v94, v176, v177
    v_cvt_pk_bf16_f32 v95, v178, v179
    v_cvt_pk_bf16_f32 v96, v152, v153
    v_cvt_pk_bf16_f32 v97, v154, v155
    v_cvt_pk_bf16_f32 v98, v180, v181
    v_cvt_pk_bf16_f32 v99, v182, v183
    v_cvt_pk_bf16_f32 v100, v156, v157
    v_cvt_pk_bf16_f32 v101, v158, v159
    v_cvt_pk_bf16_f32 v102, v184, v185
    v_cvt_pk_bf16_f32 v103, v186, v187
    v_cvt_pk_bf16_f32 v104, v160, v161
    v_cvt_pk_bf16_f32 v105, v162, v163
    v_cvt_pk_bf16_f32 v106, v188, v189
    v_cvt_pk_bf16_f32 v107, v190, v191
    v_cvt_pk_bf16_f32 v108, v164, v165
    v_cvt_pk_bf16_f32 v109, v166, v167
    v_cvt_pk_bf16_f32 v110, v192, v193
    v_cvt_pk_bf16_f32 v111, v194, v195
    v_cvt_pk_bf16_f32 v112, v168, v169
    v_cvt_pk_bf16_f32 v113, v170, v171
    v_cvt_pk_bf16_f32 v114, v196, v197
    v_cvt_pk_bf16_f32 v115, v198, v199
    s_nop 1
    v_permlane16_swap_b32 v88, v90
    v_permlane16_swap_b32 v89, v91
    v_permlane16_swap_b32 v92, v94
    v_permlane16_swap_b32 v93, v95
    v_permlane16_swap_b32 v96, v98
    v_permlane16_swap_b32 v97, v99
    v_permlane16_swap_b32 v100, v102
    v_permlane16_swap_b32 v101, v103
    v_permlane16_swap_b32 v104, v106
    v_permlane16_swap_b32 v105, v107
    v_permlane16_swap_b32 v108, v110
    v_permlane16_swap_b32 v109, v111
    v_permlane16_swap_b32 v112, v114
    v_permlane16_swap_b32 v113, v115
    v_accvgpr_write_b32 a8, v88
    v_accvgpr_write_b32 a9, v89
    v_accvgpr_write_b32 a10, v90
    v_accvgpr_write_b32 a11, v91
    v_accvgpr_write_b32 a24, v92
    v_accvgpr_write_b32 a25, v93
    v_accvgpr_write_b32 a26, v94
    v_accvgpr_write_b32 a27, v95
    v_accvgpr_write_b32 a40, v96
    v_accvgpr_write_b32 a41, v97
    v_accvgpr_write_b32 a42, v98
    v_accvgpr_write_b32 a43, v99
    v_accvgpr_write_b32 a56, v100
    v_accvgpr_write_b32 a57, v101
    v_accvgpr_write_b32 a58, v102
    v_accvgpr_write_b32 a59, v103
    v_accvgpr_write_b32 a72, v104
    v_accvgpr_write_b32 a73, v105
    v_accvgpr_write_b32 a74, v106
    v_accvgpr_write_b32 a75, v107
    v_accvgpr_write_b32 a88, v108
    v_accvgpr_write_b32 a89, v109
    v_accvgpr_write_b32 a90, v110
    v_accvgpr_write_b32 a91, v111
    v_accvgpr_write_b32 a104, v112
    v_accvgpr_write_b32 a105, v113
    v_accvgpr_write_b32 a106, v114
    v_accvgpr_write_b32 a107, v115
    v_accvgpr_read_b32 v200, a168
    v_accvgpr_read_b32 v201, a169
    v_accvgpr_read_b32 v202, a170
    v_accvgpr_read_b32 v203, a171
    v_accvgpr_read_b32 v204, a172
    v_accvgpr_read_b32 v205, a173
    v_accvgpr_read_b32 v206, a174
    v_accvgpr_read_b32 v207, a175
    v_accvgpr_read_b32 v208, a176
    v_accvgpr_read_b32 v209, a177
    v_accvgpr_read_b32 v210, a178
    v_accvgpr_read_b32 v211, a179
    v_accvgpr_read_b32 v212, a180
    v_accvgpr_read_b32 v213, a181
    v_accvgpr_read_b32 v214, a182
    v_accvgpr_read_b32 v215, a183
    v_accvgpr_read_b32 v216, a184
    v_accvgpr_read_b32 v217, a185
    v_accvgpr_read_b32 v218, a186
    v_accvgpr_read_b32 v219, a187
    v_accvgpr_read_b32 v220, a188
    v_accvgpr_read_b32 v221, a189
    v_accvgpr_read_b32 v222, a190
    v_accvgpr_read_b32 v223, a191
    v_accvgpr_read_b32 v224, a192
    v_accvgpr_read_b32 v225, a193
    v_accvgpr_read_b32 v226, a194
    v_accvgpr_read_b32 v227, a195
    v_accvgpr_read_b32 v228, a196
    v_accvgpr_read_b32 v229, a197
    v_accvgpr_read_b32 v230, a198
    v_accvgpr_read_b32 v231, a199
    v_accvgpr_read_b32 v232, a200
    v_accvgpr_read_b32 v233, a201
    v_accvgpr_read_b32 v234, a202
    v_accvgpr_read_b32 v235, a203
    v_accvgpr_read_b32 v236, a204
    v_accvgpr_read_b32 v237, a205
    v_accvgpr_read_b32 v238, a206
    v_accvgpr_read_b32 v239, a207
    v_accvgpr_read_b32 v240, a208
    v_accvgpr_read_b32 v241, a209
    v_accvgpr_read_b32 v242, a210
    v_accvgpr_read_b32 v243, a211
    v_accvgpr_read_b32 v244, a212
    v_accvgpr_read_b32 v245, a213
    v_accvgpr_read_b32 v246, a214
    v_accvgpr_read_b32 v247, a215
    v_accvgpr_read_b32 v248, a216
    v_accvgpr_read_b32 v249, a217
    v_accvgpr_read_b32 v250, a218
    v_accvgpr_read_b32 v251, a219
    v_accvgpr_read_b32 v252, a220
    v_accvgpr_read_b32 v253, a221
    v_accvgpr_read_b32 v254, a222
    v_accvgpr_read_b32 v255, a223
    v_pk_mul_f32 v[200:201], v[200:201], v[4:5]
    v_pk_mul_f32 v[202:203], v[202:203], v[4:5]
    v_pk_mul_f32 v[204:205], v[204:205], v[4:5]
    v_pk_mul_f32 v[206:207], v[206:207], v[4:5]
    v_pk_mul_f32 v[208:209], v[208:209], v[4:5]
    v_pk_mul_f32 v[210:211], v[210:211], v[4:5]
    v_pk_mul_f32 v[212:213], v[212:213], v[4:5]
    v_pk_mul_f32 v[214:215], v[214:215], v[4:5]
    v_pk_mul_f32 v[216:217], v[216:217], v[4:5]
    v_pk_mul_f32 v[218:219], v[218:219], v[4:5]
    v_pk_mul_f32 v[220:221], v[220:221], v[4:5]
    v_pk_mul_f32 v[222:223], v[222:223], v[4:5]
    v_pk_mul_f32 v[224:225], v[224:225], v[4:5]
    v_pk_mul_f32 v[226:227], v[226:227], v[4:5]
    v_pk_mul_f32 v[228:229], v[228:229], v[4:5]
    v_pk_mul_f32 v[230:231], v[230:231], v[4:5]
    v_pk_mul_f32 v[232:233], v[232:233], v[4:5]
    v_pk_mul_f32 v[234:235], v[234:235], v[4:5]
    v_pk_mul_f32 v[236:237], v[236:237], v[4:5]
    v_pk_mul_f32 v[238:239], v[238:239], v[4:5]
    v_pk_mul_f32 v[240:241], v[240:241], v[4:5]
    v_pk_mul_f32 v[242:243], v[242:243], v[4:5]
    v_pk_mul_f32 v[244:245], v[244:245], v[4:5]
    v_pk_mul_f32 v[246:247], v[246:247], v[4:5]
    v_pk_mul_f32 v[248:249], v[248:249], v[4:5]
    v_pk_mul_f32 v[250:251], v[250:251], v[4:5]
    v_pk_mul_f32 v[252:253], v[252:253], v[4:5]
    v_pk_mul_f32 v[254:255], v[254:255], v[4:5]
    v_cvt_pk_bf16_f32 v116, v200, v201
    v_cvt_pk_bf16_f32 v117, v202, v203
    v_cvt_pk_bf16_f32 v118, v228, v229
    v_cvt_pk_bf16_f32 v119, v230, v231
    v_cvt_pk_bf16_f32 v120, v204, v205
    v_cvt_pk_bf16_f32 v121, v206, v207
    v_cvt_pk_bf16_f32 v122, v232, v233
    v_cvt_pk_bf16_f32 v123, v234, v235
    v_cvt_pk_bf16_f32 v124, v208, v209
    v_cvt_pk_bf16_f32 v125, v210, v211
    v_cvt_pk_bf16_f32 v126, v236, v237
    v_cvt_pk_bf16_f32 v127, v238, v239
    v_cvt_pk_bf16_f32 v128, v212, v213
    v_cvt_pk_bf16_f32 v129, v214, v215
    v_cvt_pk_bf16_f32 v130, v240, v241
    v_cvt_pk_bf16_f32 v131, v242, v243
    v_cvt_pk_bf16_f32 v132, v216, v217
    v_cvt_pk_bf16_f32 v133, v218, v219
    v_cvt_pk_bf16_f32 v134, v244, v245
    v_cvt_pk_bf16_f32 v135, v246, v247
    v_cvt_pk_bf16_f32 v136, v220, v221
    v_cvt_pk_bf16_f32 v137, v222, v223
    v_cvt_pk_bf16_f32 v138, v248, v249
    v_cvt_pk_bf16_f32 v139, v250, v251
    v_cvt_pk_bf16_f32 v140, v224, v225
    v_cvt_pk_bf16_f32 v141, v226, v227
    v_cvt_pk_bf16_f32 v142, v252, v253
    v_cvt_pk_bf16_f32 v143, v254, v255
    s_nop 1
    v_permlane16_swap_b32 v116, v118
    v_permlane16_swap_b32 v117, v119
    v_permlane16_swap_b32 v120, v122
    v_permlane16_swap_b32 v121, v123
    v_permlane16_swap_b32 v124, v126
    v_permlane16_swap_b32 v125, v127
    v_permlane16_swap_b32 v128, v130
    v_permlane16_swap_b32 v129, v131
    v_permlane16_swap_b32 v132, v134
    v_permlane16_swap_b32 v133, v135
    v_permlane16_swap_b32 v136, v138
    v_permlane16_swap_b32 v137, v139
    v_permlane16_swap_b32 v140, v142
    v_permlane16_swap_b32 v141, v143
    v_accvgpr_write_b32 a12, v116
    v_accvgpr_write_b32 a13, v117
    v_accvgpr_write_b32 a14, v118
    v_accvgpr_write_b32 a15, v119
    v_accvgpr_write_b32 a28, v120
    v_accvgpr_write_b32 a29, v121
    v_accvgpr_write_b32 a30, v122
    v_accvgpr_write_b32 a31, v123
    v_accvgpr_write_b32 a44, v124
    v_accvgpr_write_b32 a45, v125
    v_accvgpr_write_b32 a46, v126
    v_accvgpr_write_b32 a47, v127
    v_accvgpr_write_b32 a60, v128
    v_accvgpr_write_b32 a61, v129
    v_accvgpr_write_b32 a62, v130
    v_accvgpr_write_b32 a63, v131
    v_accvgpr_write_b32 a76, v132
    v_accvgpr_write_b32 a77, v133
    v_accvgpr_write_b32 a78, v134
    v_accvgpr_write_b32 a79, v135
    v_accvgpr_write_b32 a92, v136
    v_accvgpr_write_b32 a93, v137
    v_accvgpr_write_b32 a94, v138
    v_accvgpr_write_b32 a95, v139
    v_accvgpr_write_b32 a108, v140
    v_accvgpr_write_b32 a109, v141
    v_accvgpr_write_b32 a110, v142
    v_accvgpr_write_b32 a111, v143
    s_cmp_eq_u32 s70, 0
    s_cbranch_scc1 L_at_nostash
    s_mov_b32 s70, 0
    s_lshl_b32 s30, s2, 2
    s_add_u32 s30, s30, s20
    s_mul_i32 s30, s30, 28672
    v_lshlrev_b32 v4, 4, v1
    buffer_store_dwordx4 a[0:3], v4, s[12:15], s30 offen offset:0
    buffer_store_dwordx4 a[4:7], v4, s[12:15], s30 offen offset:1024
    buffer_store_dwordx4 a[8:11], v4, s[12:15], s30 offen offset:2048
    buffer_store_dwordx4 a[12:15], v4, s[12:15], s30 offen offset:3072
    s_add_u32 s30, s30, 4096
    buffer_store_dwordx4 a[16:19], v4, s[12:15], s30 offen offset:0
    buffer_store_dwordx4 a[20:23], v4, s[12:15], s30 offen offset:1024
    buffer_store_dwordx4 a[24:27], v4, s[12:15], s30 offen offset:2048
    buffer_store_dwordx4 a[28:31], v4, s[12:15], s30 offen offset:3072
    s_add_u32 s30, s30, 4096
    buffer_store_dwordx4 a[32:35], v4, s[12:15], s30 offen offset:0
    buffer_store_dwordx4 a[36:39], v4, s[12:15], s30 offen offset:1024
    buffer_store_dwordx4 a[40:43], v4, s[12:15], s30 offen offset:2048
    buffer_store_dwordx4 a[44:47], v4, s[12:15], s30 offen offset:3072
    s_add_u32 s30, s30, 4096
    buffer_store_dwordx4 a[48:51], v4, s[12:15], s30 offen offset:0
    buffer_store_dwordx4 a[52:55], v4, s[12:15], s30 offen offset:1024
    buffer_store_dwordx4 a[56:59], v4, s[12:15], s30 offen offset:2048
    buffer_store_dwordx4 a[60:63], v4, s[12:15], s30 offen offset:3072
    s_add_u32 s30, s30, 4096
    buffer_store_dwordx4 a[64:67], v4, s[12:15], s30 offen offset:0
    buffer_store_dwordx4 a[68:71], v4, s[12:15], s30 offen offset:1024
    buffer_store_dwordx4 a[72:75], v4, s[12:15], s30 offen offset:2048
    buffer_store_dwordx4 a[76:79], v4, s[12:15], s30 offen offset:3072
    s_add_u32 s30, s30, 4096
    buffer_store_dwordx4 a[80:83], v4, s[12:15], s30 offen offset:0
    buffer_store_dwordx4 a[84:87], v4, s[12:15], s30 offen offset:1024
    buffer_store_dwordx4 a[88:91], v4, s[12:15], s30 offen offset:2048
    buffer_store_dwordx4 a[92:95], v4, s[12:15], s30 offen offset:3072
    s_add_u32 s30, s30, 4096
    buffer_store_dwordx4 a[96:99], v4, s[12:15], s30 offen offset:0
    buffer_store_dwordx4 a[100:103], v4, s[12:15], s30 offen offset:1024
    buffer_store_dwordx4 a[104:107], v4, s[12:15], s30 offen offset:2048
    buffer_store_dwordx4 a[108:111], v4, s[12:15], s30 offen offset:3072
    s_mov_b32 s68, 3
    s_branch L_at_round
L_at_nostash:
    s_cmp_lg_u32 s25, 0
    s_cbranch_scc1 L_at_maxpass
L_at_pre:
    s_cmp_lg_u32 s71, 1
    s_cbranch_scc1 L_at_nowo1
    s_mov_b32 s71, 2
    v_lshrrev_b32 v2, 4, v1
    v_bfe_u32 v3, v1, 2, 2
    v_lshl_add_u32 v3, v2, 3, v3
    v_mul_u32_u24 v3, 160, v3
    v_and_b32 v4, 3, v1
    v_lshl_add_u32 v3, v4, 3, v3
    s_mul_i32 s31, s20, 7168
    s_add_u32 s31, s31, 135168
    v_add_u32 v3, s31, v3
    v_lshlrev_b32 v4, 4, v1
    s_mul_i32 s28, s2, 40960
    s_mul_i32 s29, s20, 10240
    s_add_u32 s28, s28, s29
    s_add_u32 s28, s28, 117440512
    ds_read_b64_tr_b16 v[112:113], v3 offset:0
    ds_read_b64_tr_b16 v[114:115], v3 offset:640
    ds_read_b64_tr_b16 v[116:117], v3 offset:32
    ds_read_b64_tr_b16 v[118:119], v3 offset:672
    ds_read_b64_tr_b16 v[120:121], v3 offset:64
    ds_read_b64_tr_b16 v[122:123], v3 offset:704
    ds_read_b64_tr_b16 v[124:125], v3 offset:96
    ds_read_b64_tr_b16 v[126:127], v3 offset:736
    ds_read_b64_tr_b16 v[128:129], v3 offset:128
    ds_read_b64_tr_b16 v[130:131], v3 offset:768
    s_waitcnt lgkmcnt(0)
    buffer_store_dwordx4 v[112:115], v4, s[12:15], s28 offen offset:0 sc0 sc1
    buffer_store_dwordx4 v[116:119], v4, s[12:15], s28 offen offset:1024 sc0 sc1
    buffer_store_dwordx4 v[120:123], v4, s[12:15], s28 offen offset:2048 sc0 sc1
    buffer_store_dwordx4 v[124:127], v4, s[12:15], s28 offen offset:3072 sc0 sc1
    s_add_u32 s28, s28, 4096
    buffer_store_dwordx4 v[128:131], v4, s[12:15], s28 offen offset:0 sc0 sc1
    s_nop 1
    s_mov_b32 s28, 6554
    v_add_u32 v2, 0, v1
    v_mul_u32_u24 v3, s28, v2
    v_lshrrev_b32 v3, 16, v3
    v_mul_u32_u24 v4, 10, v3
    v_sub_u32 v4, v2, v4
    v_mul_u32_u24 v3, 1280, v3
    v_lshl_add_u32 v88, v4, 4, v3
    v_add_u32 v2, 64, v1
    v_mul_u32_u24 v3, s28, v2
    v_lshrrev_b32 v3, 16, v3
    v_mul_u32_u24 v4, 10, v3
    v_sub_u32 v4, v2, v4
    v_mul_u32_u24 v3, 1280, v3
    v_lshl_add_u32 v89, v4, 4, v3
    v_add_u32 v2, 128, v1
    v_mul_u32_u24 v3, s28, v2
    v_lshrrev_b32 v3, 16, v3
    v_mul_u32_u24 v4, 10, v3
    v_sub_u32 v4, v2, v4
    v_mul_u32_u24 v3, 1280, v3
    v_lshl_add_u32 v90, v4, 4, v3
    v_add_u32 v2, 192, v1
    v_mul_u32_u24 v3, s28, v2
    v_lshrrev_b32 v3, 16, v3
    v_mul_u32_u24 v4, 10, v3
    v_sub_u32 v4, v2, v4
    v_mul_u32_u24 v3, 1280, v3
    v_lshl_add_u32 v91, v4, 4, v3
    v_add_u32 v2, 256, v1
    v_mul_u32_u24 v3, s28, v2
    v_lshrrev_b32 v3, 16, v3
    v_mul_u32_u24 v4, 10, v3
    v_sub_u32 v4, v2, v4
    v_mul_u32_u24 v3, 1280, v3
    v_lshl_add_u32 v92, v4, 4, v3
    s_and_b32 s28, s2, 127
    s_mul_i32 s28, s28, 40960
    s_mul_i32 s29, s20, 320
    s_add_u32 s28, s28, s29
    s_add_u32 s28, s28, 160
    s_mul_i32 s31, s20, 7168
    s_add_u32 s31, s31, 135168
    s_add_u32 m0, s31, 0
    s_nop 0
    buffer_load_dwordx4 v88, s[84:87], s28 offen lds
    s_add_u32 m0, s31, 1024
    s_nop 0
    buffer_load_dwordx4 v89, s[84:87], s28 offen lds
    s_add_u32 m0, s31, 2048
    s_nop 0
    buffer_load_dwordx4 v90, s[84:87], s28 offen lds
    s_add_u32 m0, s31, 3072
    s_nop 0
    buffer_load_dwordx4 v91, s[84:87], s28 offen lds
    s_add_u32 m0, s31, 4096
    s_nop 0
    buffer_load_dwordx4 v92, s[84:87], s28 offen lds
L_at_nowo1:
    s_waitcnt lgkmcnt(0)
    v_mfma_f32_16x16x32_bf16 v[88:91], v[56:59], a[0:3], 0
    v_mov_b32 v168, 0
    v_mov_b32 v169, 0
    v_mfma_f32_16x16x32_bf16 v[88:91], v[60:63], a[4:7], v[88:91]
    v_mov_b32 v170, 0
    v_mov_b32 v171, 0
    v_mfma_f32_16x16x32_bf16 v[88:91], v[64:67], a[8:11], v[88:91]
    v_mov_b32 v196, 0
    v_mov_b32 v197, 0
    v_mfma_f32_16x16x32_bf16 v[88:91], v[68:71], a[12:15], v[88:91]
    v_mov_b32 v198, 0
    v_mov_b32 v199, 0
    v_mfma_f32_16x16x32_bf16 v[92:95], v[72:75], a[0:3], 0
    v_mov_b32 v224, 0
    v_mov_b32 v225, 0
    v_mfma_f32_16x16x32_bf16 v[92:95], v[76:79], a[4:7], v[92:95]
    v_mov_b32 v226, 0
    v_mov_b32 v227, 0
    v_mfma_f32_16x16x32_bf16 v[92:95], v[80:83], a[8:11], v[92:95]
    v_mov_b32 v252, 0
    v_mov_b32 v253, 0
    v_mfma_f32_16x16x32_bf16 v[92:95], v[84:87], a[12:15], v[92:95]
    v_mov_b32 v254, 0
    v_mov_b32 v255, 0
    v_accvgpr_write_b32 a136, 0
    v_accvgpr_write_b32 a137, 0
    v_accvgpr_write_b32 a138, 0
    v_accvgpr_write_b32 a139, 0
    v_accvgpr_write_b32 a164, 0
    v_accvgpr_write_b32 a165, 0
    v_accvgpr_write_b32 a166, 0
    v_accvgpr_write_b32 a167, 0
    v_accvgpr_write_b32 a192, 0
    v_accvgpr_write_b32 a193, 0
    v_accvgpr_write_b32 a194, 0
    v_accvgpr_write_b32 a195, 0
    v_accvgpr_write_b32 a220, 0
    v_accvgpr_write_b32 a221, 0
    v_accvgpr_write_b32 a222, 0
    v_accvgpr_write_b32 a223, 0
    v_mfma_f32_16x16x32_bf16 v[96:99], v[56:59], a[16:19], 0
    v_max3_f32 v2, v88, v89, v12
    v_max3_f32 v3, v90, v91, v92
    v_max3_f32 v2, v93, v94, v2
    v_mfma_f32_16x16x32_bf16 v[96:99], v[60:63], a[20:23], v[96:99]
    v_max3_f32 v2, v95, v2, v3
    v_mov_b32 v3, v2
    s_nop 1
    v_permlane16_swap_b32 v2, v3
    v_mfma_f32_16x16x32_bf16 v[96:99], v[64:67], a[24:27], v[96:99]
    s_nop 1
    v_max_f32 v2, v2, v3
    v_mov_b32 v3, v2
    v_mfma_f32_16x16x32_bf16 v[96:99], v[68:71], a[28:31], v[96:99]
    s_nop 1
    v_permlane32_swap_b32 v2, v3
    s_nop 1
    v_max_f32 v2, v2, v3
    v_mfma_f32_16x16x32_bf16 v[100:103], v[72:75], a[16:19], 0
    v_mov_b32 v12, 0
    v_mov_b32 v13, 0
    v_sub_f32 v88, v88, v2
    v_mfma_f32_16x16x32_bf16 v[100:103], v[76:79], a[20:23], v[100:103]
    v_sub_f32 v89, v89, v2
    v_sub_f32 v90, v90, v2
    v_sub_f32 v91, v91, v2
    v_sub_f32 v92, v92, v2
    v_mfma_f32_16x16x32_bf16 v[100:103], v[80:83], a[24:27], v[100:103]
    v_sub_f32 v93, v93, v2
    v_sub_f32 v94, v94, v2
    v_sub_f32 v95, v95, v2
    v_mfma_f32_16x16x32_bf16 v[100:103], v[84:87], a[28:31], v[100:103]
    v_sub_f32 v28, 0, v2
    v_sub_f32 v29, 0, v2
    v_sub_f32 v30, 0, v2
    v_sub_f32 v31, 0, v2
    ds_read_b64_tr_b16 v[112:113], v9 offset:0
    ds_read_b64_tr_b16 v[114:115], v9 offset:512
    v_exp_f32 v88, v88
    ds_read_b64_tr_b16 v[116:117], v9 offset:32
    ds_read_b64_tr_b16 v[118:119], v9 offset:544
    v_exp_f32 v89, v89
    v_exp_f32 v90, v90
    ds_read_b64_tr_b16 v[120:121], v9 offset:64
    ds_read_b64_tr_b16 v[122:123], v9 offset:576
    v_exp_f32 v91, v91
    v_add_f32 v12, v12, v88
    v_add_f32 v13, v13, v89
    ds_read_b64_tr_b16 v[124:125], v9 offset:96
    ds_read_b64_tr_b16 v[126:127], v9 offset:608
    v_cvt_pk_bf16_f32 v104, v88, v89
    v_exp_f32 v92, v92
    ds_read_b64_tr_b16 v[128:129], v9 offset:128
    ds_read_b64_tr_b16 v[130:131], v9 offset:640
    v_exp_f32 v93, v93
    v_add_f32 v12, v12, v90
    v_add_f32 v13, v13, v91
    ds_read_b64_tr_b16 v[132:133], v9 offset:160
    ds_read_b64_tr_b16 v[134:135], v9 offset:672
    v_cvt_pk_bf16_f32 v105, v90, v91
    v_exp_f32 v94, v94
    ds_read_b64_tr_b16 v[136:137], v9 offset:192
    ds_read_b64_tr_b16 v[138:139], v9 offset:704
    v_exp_f32 v95, v95
    v_add_f32 v12, v12, v92
    v_add_f32 v13, v13, v93
    ds_read_b64_tr_b16 v[140:141], v9 offset:224
    ds_read_b64_tr_b16 v[142:143], v9 offset:736
    v_cvt_pk_bf16_f32 v106, v92, v93
    v_add_f32 v12, v12, v94
    v_add_f32 v13, v13, v95
    v_cvt_pk_bf16_f32 v107, v94, v95
    v_mfma_f32_16x16x32_bf16 v[88:91], v[56:59], a[32:35], 0
    v_max3_f32 v2, v96, v97, v14
    v_max3_f32 v3, v98, v99, v100
    v_max3_f32 v2, v101, v102, v2
    v_mfma_f32_16x16x32_bf16 v[88:91], v[60:63], a[36:39], v[88:91]
    v_max3_f32 v2, v103, v2, v3
    v_mov_b32 v3, v2
    s_nop 1
    v_permlane16_swap_b32 v2, v3
    v_mfma_f32_16x16x32_bf16 v[88:91], v[64:67], a[40:43], v[88:91]
    s_nop 1
    v_max_f32 v2, v2, v3
    v_mov_b32 v3, v2
    v_mfma_f32_16x16x32_bf16 v[88:91], v[68:71], a[44:47], v[88:91]
    s_nop 1
    v_permlane32_swap_b32 v2, v3
    s_nop 1
    v_max_f32 v2, v2, v3
    v_mfma_f32_16x16x32_bf16 v[92:95], v[72:75], a[32:35], 0
    v_mov_b32 v14, 0
    v_mov_b32 v15, 0
    v_sub_f32 v96, v96, v2
    v_mfma_f32_16x16x32_bf16 v[92:95], v[76:79], a[36:39], v[92:95]
    v_sub_f32 v97, v97, v2
    v_sub_f32 v98, v98, v2
    v_sub_f32 v99, v99, v2
    v_sub_f32 v100, v100, v2
    v_mfma_f32_16x16x32_bf16 v[92:95], v[80:83], a[40:43], v[92:95]
    v_sub_f32 v101, v101, v2
    v_sub_f32 v102, v102, v2
    v_sub_f32 v103, v103, v2
    v_mfma_f32_16x16x32_bf16 v[92:95], v[84:87], a[44:47], v[92:95]
    v_sub_f32 v32, 0, v2
    v_sub_f32 v33, 0, v2
    v_sub_f32 v34, 0, v2
    v_sub_f32 v35, 0, v2
    s_waitcnt lgkmcnt(0)
    v_mfma_f32_16x16x32_bf16 v[144:147], v[112:115], v[104:107], 0
    v_exp_f32 v96, v96
    v_mfma_f32_16x16x32_bf16 v[172:175], v[116:119], v[104:107], 0
    v_exp_f32 v97, v97
    v_exp_f32 v98, v98
    v_mfma_f32_16x16x32_bf16 v[200:203], v[120:123], v[104:107], 0
    v_exp_f32 v99, v99
    v_add_f32 v14, v14, v96
    v_add_f32 v15, v15, v97
    v_mfma_f32_16x16x32_bf16 v[228:231], v[124:127], v[104:107], 0
    v_cvt_pk_bf16_f32 v108, v96, v97
    v_exp_f32 v100, v100
    v_mfma_f32_16x16x32_bf16 a[112:115], v[128:131], v[104:107], 0
    v_exp_f32 v101, v101
    v_add_f32 v14, v14, v98
    v_add_f32 v15, v15, v99
    v_mfma_f32_16x16x32_bf16 a[140:143], v[132:135], v[104:107], 0
    v_cvt_pk_bf16_f32 v109, v98, v99
    v_exp_f32 v102, v102
    v_mfma_f32_16x16x32_bf16 a[168:171], v[136:139], v[104:107], 0
    v_exp_f32 v103, v103
    v_add_f32 v14, v14, v100
    v_add_f32 v15, v15, v101
    v_mfma_f32_16x16x32_bf16 a[196:199], v[140:143], v[104:107], 0
    v_cvt_pk_bf16_f32 v110, v100, v101
    v_add_f32 v14, v14, v102
    v_add_f32 v15, v15, v103
    v_cvt_pk_bf16_f32 v111, v102, v103
    v_mfma_f32_16x16x32_bf16 v[96:99], v[56:59], a[48:51], 0
    v_max3_f32 v2, v88, v89, v16
    v_max3_f32 v3, v90, v91, v92
    v_max3_f32 v2, v93, v94, v2
    v_mfma_f32_16x16x32_bf16 v[96:99], v[60:63], a[52:55], v[96:99]
    v_max3_f32 v2, v95, v2, v3
    v_mov_b32 v3, v2
    s_nop 1
    v_permlane16_swap_b32 v2, v3
    v_mfma_f32_16x16x32_bf16 v[96:99], v[64:67], a[56:59], v[96:99]
    s_nop 1
    v_max_f32 v2, v2, v3
    v_mov_b32 v3, v2
    v_mfma_f32_16x16x32_bf16 v[96:99], v[68:71], a[60:63], v[96:99]
    s_nop 1
    v_permlane32_swap_b32 v2, v3
    s_nop 1
    v_max_f32 v2, v2, v3
    v_mfma_f32_16x16x32_bf16 v[100:103], v[72:75], a[48:51], 0
    v_mov_b32 v16, 0
    v_mov_b32 v17, 0
    v_sub_f32 v88, v88, v2
    v_mfma_f32_16x16x32_bf16 v[100:103], v[76:79], a[52:55], v[100:103]
    v_sub_f32 v89, v89, v2
    v_sub_f32 v90, v90, v2
    v_sub_f32 v91, v91, v2
    v_sub_f32 v92, v92, v2
    v_mfma_f32_16x16x32_bf16 v[100:103], v[80:83], a[56:59], v[100:103]
    v_sub_f32 v93, v93, v2
    v_sub_f32 v94, v94, v2
    v_sub_f32 v95, v95, v2
    v_mfma_f32_16x16x32_bf16 v[100:103], v[84:87], a[60:63], v[100:103]
    v_sub_f32 v36, 0, v2
    v_sub_f32 v37, 0, v2
    v_sub_f32 v38, 0, v2
    v_sub_f32 v39, 0, v2
    v_mfma_f32_16x16x32_bf16 v[148:151], v[112:115], v[108:111], 0
    v_exp_f32 v88, v88
    v_mfma_f32_16x16x32_bf16 v[176:179], v[116:119], v[108:111], 0
    v_exp_f32 v89, v89
    v_exp_f32 v90, v90
    v_mfma_f32_16x16x32_bf16 v[204:207], v[120:123], v[108:111], 0
    v_exp_f32 v91, v91
    v_add_f32 v16, v16, v88
    v_add_f32 v17, v17, v89
    v_mfma_f32_16x16x32_bf16 v[232:235], v[124:127], v[108:111], 0
    v_cvt_pk_bf16_f32 v104, v88, v89
    v_exp_f32 v92, v92
    v_mfma_f32_16x16x32_bf16 a[116:119], v[128:131], v[108:111], 0
    v_exp_f32 v93, v93
    v_add_f32 v16, v16, v90
    v_add_f32 v17, v17, v91
    v_mfma_f32_16x16x32_bf16 a[144:147], v[132:135], v[108:111], 0
    v_cvt_pk_bf16_f32 v105, v90, v91
    v_exp_f32 v94, v94
    v_mfma_f32_16x16x32_bf16 a[172:175], v[136:139], v[108:111], 0
    v_exp_f32 v95, v95
    v_add_f32 v16, v16, v92
    v_add_f32 v17, v17, v93
    v_mfma_f32_16x16x32_bf16 a[200:203], v[140:143], v[108:111], 0
    v_cvt_pk_bf16_f32 v106, v92, v93
    v_add_f32 v16, v16, v94
    v_add_f32 v17, v17, v95
    v_cvt_pk_bf16_f32 v107, v94, v95
    v_mfma_f32_16x16x32_bf16 v[88:91], v[56:59], a[64:67], 0
    v_max3_f32 v2, v96, v97, v18
    v_max3_f32 v3, v98, v99, v100
    v_max3_f32 v2, v101, v102, v2
    v_mfma_f32_16x16x32_bf16 v[88:91], v[60:63], a[68:71], v[88:91]
    v_max3_f32 v2, v103, v2, v3
    v_mov_b32 v3, v2
    s_nop 1
    v_permlane16_swap_b32 v2, v3
    v_mfma_f32_16x16x32_bf16 v[88:91], v[64:67], a[72:75], v[88:91]
    s_nop 1
    v_max_f32 v2, v2, v3
    v_mov_b32 v3, v2
    v_mfma_f32_16x16x32_bf16 v[88:91], v[68:71], a[76:79], v[88:91]
    s_nop 1
    v_permlane32_swap_b32 v2, v3
    s_nop 1
    v_max_f32 v2, v2, v3
    v_mfma_f32_16x16x32_bf16 v[92:95], v[72:75], a[64:67], 0
    v_mov_b32 v18, 0
    v_mov_b32 v19, 0
    v_sub_f32 v96, v96, v2
    v_mfma_f32_16x16x32_bf16 v[92:95], v[76:79], a[68:71], v[92:95]
    v_sub_f32 v97, v97, v2
    v_sub_f32 v98, v98, v2
    v_sub_f32 v99, v99, v2
    v_sub_f32 v100, v100, v2
    v_mfma_f32_16x16x32_bf16 v[92:95], v[80:83], a[72:75], v[92:95]
    v_sub_f32 v101, v101, v2
    v_sub_f32 v102, v102, v2
    v_sub_f32 v103, v103, v2
    v_mfma_f32_16x16x32_bf16 v[92:95], v[84:87], a[76:79], v[92:95]
    v_sub_f32 v40, 0, v2
    v_sub_f32 v41, 0, v2
    v_sub_f32 v42, 0, v2
    v_sub_f32 v43, 0, v2
    v_mfma_f32_16x16x32_bf16 v[152:155], v[112:115], v[104:107], 0
    v_exp_f32 v96, v96
    v_mfma_f32_16x16x32_bf16 v[180:183], v[116:119], v[104:107], 0
    v_exp_f32 v97, v97
    v_exp_f32 v98, v98
    v_mfma_f32_16x16x32_bf16 v[208:211], v[120:123], v[104:107], 0
    v_exp_f32 v99, v99
    v_add_f32 v18, v18, v96
    v_add_f32 v19, v19, v97
    v_mfma_f32_16x16x32_bf16 v[236:239], v[124:127], v[104:107], 0
    v_cvt_pk_bf16_f32 v108, v96, v97
    v_exp_f32 v100, v100
    v_mfma_f32_16x16x32_bf16 a[120:123], v[128:131], v[104:107], 0
    v_exp_f32 v101, v101
    v_add_f32 v18, v18, v98
    v_add_f32 v19, v19, v99
    v_mfma_f32_16x16x32_bf16 a[148:151], v[132:135], v[104:107], 0
    v_cvt_pk_bf16_f32 v109, v98, v99
    v_exp_f32 v102, v102
    v_mfma_f32_16x16x32_bf16 a[176:179], v[136:139], v[104:107], 0
    v_exp_f32 v103, v103
    v_add_f32 v18, v18, v100
    v_add_f32 v19, v19, v101
    v_mfma_f32_16x16x32_bf16 a[204:207], v[140:143], v[104:107], 0
    v_cvt_pk_bf16_f32 v110, v100, v101
    v_add_f32 v18, v18, v102
    v_add_f32 v19, v19, v103
    v_cvt_pk_bf16_f32 v111, v102, v103
    v_mfma_f32_16x16x32_bf16 v[96:99], v[56:59], a[80:83], 0
    v_max3_f32 v2, v88, v89, v20
    v_max3_f32 v3, v90, v91, v92
    v_max3_f32 v2, v93, v94, v2
    v_mfma_f32_16x16x32_bf16 v[96:99], v[60:63], a[84:87], v[96:99]
    v_max3_f32 v2, v95, v2, v3
    v_mov_b32 v3, v2
    s_nop 1
    v_permlane16_swap_b32 v2, v3
    v_mfma_f32_16x16x32_bf16 v[96:99], v[64:67], a[88:91], v[96:99]
    s_nop 1
    v_max_f32 v2, v2, v3
    v_mov_b32 v3, v2
    v_mfma_f32_16x16x32_bf16 v[96:99], v[68:71], a[92:95], v[96:99]
    s_nop 1
    v_permlane32_swap_b32 v2, v3
    s_nop 1
    v_max_f32 v2, v2, v3
    v_mfma_f32_16x16x32_bf16 v[100:103], v[72:75], a[80:83], 0
    v_mov_b32 v20, 0
    v_mov_b32 v21, 0
    v_sub_f32 v88, v88, v2
    v_mfma_f32_16x16x32_bf16 v[100:103], v[76:79], a[84:87], v[100:103]
    v_sub_f32 v89, v89, v2
    v_sub_f32 v90, v90, v2
    v_sub_f32 v91, v91, v2
    v_sub_f32 v92, v92, v2
    v_mfma_f32_16x16x32_bf16 v[100:103], v[80:83], a[88:91], v[100:103]
    v_sub_f32 v93, v93, v2
    v_sub_f32 v94, v94, v2
    v_sub_f32 v95, v95, v2
    v_mfma_f32_16x16x32_bf16 v[100:103], v[84:87], a[92:95], v[100:103]
    v_sub_f32 v44, 0, v2
    v_sub_f32 v45, 0, v2
    v_sub_f32 v46, 0, v2
    v_sub_f32 v47, 0, v2
    v_mfma_f32_16x16x32_bf16 v[156:159], v[112:115], v[108:111], 0
    v_exp_f32 v88, v88
    v_mfma_f32_16x16x32_bf16 v[184:187], v[116:119], v[108:111], 0
    v_exp_f32 v89, v89
    v_exp_f32 v90, v90
    v_mfma_f32_16x16x32_bf16 v[212:215], v[120:123], v[108:111], 0
    v_exp_f32 v91, v91
    v_add_f32 v20, v20, v88
    v_add_f32 v21, v21, v89
    v_mfma_f32_16x16x32_bf16 v[240:243], v[124:127], v[108:111], 0
    v_cvt_pk_bf16_f32 v104, v88, v89
    v_exp_f32 v92, v92
    v_mfma_f32_16x16x32_bf16 a[124:127], v[128:131], v[108:111], 0
    v_exp_f32 v93, v93
    v_add_f32 v20, v20, v90
    v_add_f32 v21, v21, v91
    v_mfma_f32_16x16x32_bf16 a[152:155], v[132:135], v[108:111], 0
    v_cvt_pk_bf16_f32 v105, v90, v91
    v_exp_f32 v94, v94
    v_mfma_f32_16x16x32_bf16 a[180:183], v[136:139], v[108:111], 0
    v_exp_f32 v95, v95
    v_add_f32 v20, v20, v92
    v_add_f32 v21, v21, v93
    v_mfma_f32_16x16x32_bf16 a[208:211], v[140:143], v[108:111], 0
    v_cvt_pk_bf16_f32 v106, v92, v93
    v_add_f32 v20, v20, v94
    v_add_f32 v21, v21, v95
    v_cvt_pk_bf16_f32 v107, v94, v95
    s_cmp_eq_u32 s68, 0
    s_cbranch_scc1 L_bw1_3296
    s_sub_u32 s68, s68, 1
    s_waitcnt vmcnt(44) lgkmcnt(0)
    s_branch L_bw2_3296
L_bw1_3296:
    s_waitcnt vmcnt(16) lgkmcnt(0)
L_bw2_3296:
    s_barrier
    s_cmp_le_u32 s21, s27
    s_cbranch_scc1 L_at_nofb_3305
    s_sub_u32 s28, s21, 1
    s_cmp_eq_u32 s28, s23
    s_cbranch_scc1 L_at_nofb_3305
    s_lshl_b32 s29, s28, 2
    s_add_u32 s29, s29, 76000
    v_mov_b32 v4, s29
    ds_read_b32 v4, v4
    s_waitcnt lgkmcnt(0)
    v_readfirstlane_b32 s29, v4
    s_nop 3
    s_cmp_lg_u32 s29, 0
    s_cbranch_scc1 L_at_fallback
L_at_nofb_3305:
    v_mfma_f32_16x16x32_bf16 v[88:91], v[56:59], a[96:99], 0
    ds_read_b128 v[56:59], v8 offset:8448
    v_max3_f32 v2, v96, v97, v22
    v_max3_f32 v3, v98, v99, v100
    v_max3_f32 v2, v101, v102, v2
    v_mfma_f32_16x16x32_bf16 v[88:91], v[60:63], a[100:103], v[88:91]
    ds_read_b128 v[60:63], v8 offset:8512
    v_max3_f32 v2, v103, v2, v3
    v_mov_b32 v3, v2
    s_nop 1
    v_permlane16_swap_b32 v2, v3
    v_mfma_f32_16x16x32_bf16 v[88:91], v[64:67], a[104:107], v[88:91]
    ds_read_b128 v[64:67], v8 offset:8576
    s_nop 1
    v_max_f32 v2, v2, v3
    v_mov_b32 v3, v2
    v_mfma_f32_16x16x32_bf16 v[88:91], v[68:71], a[108:111], v[88:91]
    ds_read_b128 v[68:71], v8 offset:8640
    s_nop 1
    v_permlane32_swap_b32 v2, v3
    s_nop 1
    v_max_f32 v2, v2, v3
    v_mfma_f32_16x16x32_bf16 v[92:95], v[72:75], a[96:99], 0
    ds_read_b128 v[72:75], v8 offset:8960
    v_mov_b32 v22, 0
    v_mov_b32 v23, 0
    v_sub_f32 v96, v96, v2
    v_mfma_f32_16x16x32_bf16 v[92:95], v[76:79], a[100:103], v[92:95]
    ds_read_b128 v[76:79], v8 offset:9024
    v_sub_f32 v97, v97, v2
    v_sub_f32 v98, v98, v2
    v_sub_f32 v99, v99, v2
    v_sub_f32 v100, v100, v2
    v_mfma_f32_16x16x32_bf16 v[92:95], v[80:83], a[104:107], v[92:95]
    ds_read_b128 v[80:83], v8 offset:9088
    v_sub_f32 v101, v101, v2
    v_sub_f32 v102, v102, v2
    v_sub_f32 v103, v103, v2
    v_mfma_f32_16x16x32_bf16 v[92:95], v[84:87], a[108:111], v[92:95]
    ds_read_b128 v[84:87], v8 offset:9152
    v_sub_f32 v48, 0, v2
    v_sub_f32 v49, 0, v2
    v_sub_f32 v50, 0, v2
    v_sub_f32 v51, 0, v2
    v_mfma_f32_16x16x32_bf16 v[160:163], v[112:115], v[104:107], 0
    v_exp_f32 v96, v96
    v_mfma_f32_16x16x32_bf16 v[188:191], v[116:119], v[104:107], 0
    v_exp_f32 v97, v97
    v_exp_f32 v98, v98
    v_mfma_f32_16x16x32_bf16 v[216:219], v[120:123], v[104:107], 0
    v_exp_f32 v99, v99
    v_add_f32 v22, v22, v96
    v_add_f32 v23, v23, v97
    v_mfma_f32_16x16x32_bf16 v[244:247], v[124:127], v[104:107], 0
    v_cvt_pk_bf16_f32 v108, v96, v97
    v_exp_f32 v100, v100
    v_mfma_f32_16x16x32_bf16 a[128:131], v[128:131], v[104:107], 0
    v_exp_f32 v101, v101
    v_add_f32 v22, v22, v98
    v_add_f32 v23, v23, v99
    v_mfma_f32_16x16x32_bf16 a[156:159], v[132:135], v[104:107], 0
    v_cvt_pk_bf16_f32 v109, v98, v99
    v_exp_f32 v102, v102
    v_mfma_f32_16x16x32_bf16 a[184:187], v[136:139], v[104:107], 0
    v_exp_f32 v103, v103
    v_add_f32 v22, v22, v100
    v_add_f32 v23, v23, v101
    v_mfma_f32_16x16x32_bf16 a[212:215], v[140:143], v[104:107], 0
    v_cvt_pk_bf16_f32 v110, v100, v101
    v_add_f32 v22, v22, v102
    v_add_f32 v23, v23, v103
    v_cvt_pk_bf16_f32 v111, v102, v103
    s_waitcnt lgkmcnt(0)
    v_mfma_f32_16x16x32_bf16 v[96:99], v[56:59], a[0:3], v[28:31]
    v_max3_f32 v2, v88, v89, v24
    v_max3_f32 v3, v90, v91, v92
    v_max3_f32 v2, v93, v94, v2
    v_mfma_f32_16x16x32_bf16 v[96:99], v[60:63], a[4:7], v[96:99]
    v_max3_f32 v2, v95, v2, v3
    v_mov_b32 v3, v2
    s_nop 1
    v_permlane16_swap_b32 v2, v3
    v_mfma_f32_16x16x32_bf16 v[96:99], v[64:67], a[8:11], v[96:99]
    s_nop 1
    v_max_f32 v2, v2, v3
    v_mov_b32 v3, v2
    v_mfma_f32_16x16x32_bf16 v[96:99], v[68:71], a[12:15], v[96:99]
    s_nop 1
    v_permlane32_swap_b32 v2, v3
    s_nop 1
    v_max_f32 v2, v2, v3
    v_mfma_f32_16x16x32_bf16 v[100:103], v[72:75], a[0:3], v[28:31]
    v_mov_b32 v24, 0
    v_mov_b32 v25, 0
    v_sub_f32 v88, v88, v2
    v_mfma_f32_16x16x32_bf16 v[100:103], v[76:79], a[4:7], v[100:103]
    v_sub_f32 v89, v89, v2
    v_sub_f32 v90, v90, v2
    v_sub_f32 v91, v91, v2
    v_sub_f32 v92, v92, v2
    v_mfma_f32_16x16x32_bf16 v[100:103], v[80:83], a[8:11], v[100:103]
    v_sub_f32 v93, v93, v2
    v_sub_f32 v94, v94, v2
    v_sub_f32 v95, v95, v2
    v_mfma_f32_16x16x32_bf16 v[100:103], v[84:87], a[12:15], v[100:103]
    v_sub_f32 v52, 0, v2
    v_sub_f32 v53, 0, v2
    v_sub_f32 v54, 0, v2
    v_sub_f32 v55, 0, v2
    v_mfma_f32_16x16x32_bf16 v[164:167], v[112:115], v[108:111], 0
    v_exp_f32 v88, v88
    v_mfma_f32_16x16x32_bf16 v[192:195], v[116:119], v[108:111], 0
    v_exp_f32 v89, v89
    v_exp_f32 v90, v90
    v_mfma_f32_16x16x32_bf16 v[220:223], v[120:123], v[108:111], 0
    v_exp_f32 v91, v91
    v_add_f32 v24, v24, v88
    v_add_f32 v25, v25, v89
    v_mfma_f32_16x16x32_bf16 v[248:251], v[124:127], v[108:111], 0
    v_cvt_pk_bf16_f32 v104, v88, v89
    v_exp_f32 v92, v92
    v_mfma_f32_16x16x32_bf16 a[132:135], v[128:131], v[108:111], 0
    v_exp_f32 v93, v93
    v_add_f32 v24, v24, v90
    v_add_f32 v25, v25, v91
    v_mfma_f32_16x16x32_bf16 a[160:163], v[132:135], v[108:111], 0
    v_cvt_pk_bf16_f32 v105, v90, v91
    v_exp_f32 v94, v94
    v_mfma_f32_16x16x32_bf16 a[188:191], v[136:139], v[108:111], 0
    v_exp_f32 v95, v95
    v_add_f32 v24, v24, v92
    v_add_f32 v25, v25, v93
    v_mfma_f32_16x16x32_bf16 a[216:219], v[140:143], v[108:111], 0
    v_cvt_pk_bf16_f32 v106, v92, v93
    v_add_f32 v24, v24, v94
    v_add_f32 v25, v25, v95
    v_cvt_pk_bf16_f32 v107, v94, v95
    s_mov_b32 s22, 0
L_at_loop:
    v_mfma_f32_16x16x32_bf16 v[88:91], v[56:59], a[16:19], v[32:35]
    v_mfma_f32_16x16x32_bf16 v[88:91], v[60:63], a[20:23], v[88:91]
    v_exp_f32 v96, v96
    v_mfma_f32_16x16x32_bf16 v[88:91], v[64:67], a[24:27], v[88:91]
    v_exp_f32 v97, v97
    v_mfma_f32_16x16x32_bf16 v[88:91], v[68:71], a[28:31], v[88:91]
    v_exp_f32 v98, v98
    v_mfma_f32_16x16x32_bf16 v[92:95], v[72:75], a[16:19], v[32:35]
    v_exp_f32 v99, v99
    v_mfma_f32_16x16x32_bf16 v[92:95], v[76:79], a[20:23], v[92:95]
    v_add_f32 v12, v12, v96
    v_add_f32 v13, v13, v97
    v_mfma_f32_16x16x32_bf16 v[92:95], v[80:83], a[24:27], v[92:95]
    v_cvt_pk_bf16_f32 v108, v96, v97
    v_mfma_f32_16x16x32_bf16 v[92:95], v[84:87], a[28:31], v[92:95]
    v_exp_f32 v100, v100
    v_mfma_f32_16x16x32_bf16 v[168:171], v[112:115], v[104:107], v[168:171]
    ds_read_b64_tr_b16 v[112:113], v9 offset:8448
    ds_read_b64_tr_b16 v[114:115], v9 offset:8960
    v_exp_f32 v101, v101
    v_mfma_f32_16x16x32_bf16 v[196:199], v[116:119], v[104:107], v[196:199]
    ds_read_b64_tr_b16 v[116:117], v9 offset:8480
    ds_read_b64_tr_b16 v[118:119], v9 offset:8992
    v_add_f32 v12, v12, v98
    v_add_f32 v13, v13, v99
    v_mfma_f32_16x16x32_bf16 v[224:227], v[120:123], v[104:107], v[224:227]
    ds_read_b64_tr_b16 v[120:121], v9 offset:8512
    ds_read_b64_tr_b16 v[122:123], v9 offset:9024
    v_cvt_pk_bf16_f32 v109, v98, v99
    v_mfma_f32_16x16x32_bf16 v[252:255], v[124:127], v[104:107], v[252:255]
    ds_read_b64_tr_b16 v[124:125], v9 offset:8544
    ds_read_b64_tr_b16 v[126:127], v9 offset:9056
    v_exp_f32 v102, v102
    v_mfma_f32_16x16x32_bf16 a[136:139], v[128:131], v[104:107], a[136:139]
    ds_read_b64_tr_b16 v[128:129], v9 offset:8576
    ds_read_b64_tr_b16 v[130:131], v9 offset:9088
    v_exp_f32 v103, v103
    v_mfma_f32_16x16x32_bf16 a[164:167], v[132:135], v[104:107], a[164:167]
    ds_read_b64_tr_b16 v[132:133], v9 offset:8608
    ds_read_b64_tr_b16 v[134:135], v9 offset:9120
    v_add_f32 v12, v12, v100
    v_add_f32 v13, v13, v101
    v_mfma_f32_16x16x32_bf16 a[192:195], v[136:139], v[104:107], a[192:195]
    ds_read_b64_tr_b16 v[136:137], v9 offset:8640
    ds_read_b64_tr_b16 v[138:139], v9 offset:9152
    v_cvt_pk_bf16_f32 v110, v100, v101
    v_add_f32 v12, v12, v102
    v_mfma_f32_16x16x32_bf16 a[220:223], v[140:143], v[104:107], a[220:223]
    ds_read_b64_tr_b16 v[140:141], v9 offset:8672
    ds_read_b64_tr_b16 v[142:143], v9 offset:9184
    v_add_f32 v13, v13, v103
    v_cvt_pk_bf16_f32 v111, v102, v103
    v_mfma_f32_16x16x32_bf16 v[96:99], v[56:59], a[32:35], v[36:39]
    v_mfma_f32_16x16x32_bf16 v[96:99], v[60:63], a[36:39], v[96:99]
    s_add_u32 s29, s34, s100
    v_exp_f32 v88, v88
    v_mfma_f32_16x16x32_bf16 v[96:99], v[64:67], a[40:43], v[96:99]
    v_exp_f32 v89, v89
    v_mfma_f32_16x16x32_bf16 v[96:99], v[68:71], a[44:47], v[96:99]
    s_bfe_u32 s28, s29, 0x20003
    v_exp_f32 v90, v90
    v_mfma_f32_16x16x32_bf16 v[100:103], v[72:75], a[32:35], v[36:39]
    v_exp_f32 v91, v91
    v_mfma_f32_16x16x32_bf16 v[100:103], v[76:79], a[36:39], v[100:103]
    s_lshl_b32 s28, s28, 16
    v_add_f32 v14, v14, v88
    v_add_f32 v15, v15, v89
    v_mfma_f32_16x16x32_bf16 v[100:103], v[80:83], a[40:43], v[100:103]
    v_cvt_pk_bf16_f32 v104, v88, v89
    v_mfma_f32_16x16x32_bf16 v[100:103], v[84:87], a[44:47], v[100:103]
    v_exp_f32 v92, v92
    s_waitcnt lgkmcnt(0)
    v_mfma_f32_16x16x32_bf16 v[144:147], v[112:115], v[108:111], v[144:147]
    s_and_b32 s29, s29, 7
    v_exp_f32 v93, v93
    v_mfma_f32_16x16x32_bf16 v[172:175], v[116:119], v[108:111], v[172:175]
    v_add_f32 v14, v14, v90
    v_add_f32 v15, v15, v91
    v_mfma_f32_16x16x32_bf16 v[200:203], v[120:123], v[108:111], v[200:203]
    s_lshl_b32 s29, s29, 11
    v_cvt_pk_bf16_f32 v105, v90, v91
    v_mfma_f32_16x16x32_bf16 v[228:231], v[124:127], v[108:111], v[228:231]
    v_exp_f32 v94, v94
    v_mfma_f32_16x16x32_bf16 a[112:115], v[128:131], v[108:111], a[112:115]
    s_add_u32 s29, s28, s29
    v_exp_f32 v95, v95
    v_mfma_f32_16x16x32_bf16 a[140:143], v[132:135], v[108:111], a[140:143]
    v_add_f32 v14, v14, v92
    v_add_f32 v15, v15, v93
    v_mfma_f32_16x16x32_bf16 a[168:171], v[136:139], v[108:111], a[168:171]
    s_lshr_b32 s28, s34, 5
    v_cvt_pk_bf16_f32 v106, v92, v93
    v_add_f32 v14, v14, v94
    v_mfma_f32_16x16x32_bf16 a[196:199], v[140:143], v[108:111], a[196:199]
    v_add_f32 v15, v15, v95
    v_cvt_pk_bf16_f32 v107, v94, v95
    v_mfma_f32_16x16x32_bf16 v[88:91], v[56:59], a[48:51], v[40:43]
    v_mfma_f32_16x16x32_bf16 v[88:91], v[60:63], a[52:55], v[88:91]
    s_lshl_b32 s28, s28, 19
    v_exp_f32 v96, v96
    v_mfma_f32_16x16x32_bf16 v[88:91], v[64:67], a[56:59], v[88:91]
    v_exp_f32 v97, v97
    v_mfma_f32_16x16x32_bf16 v[88:91], v[68:71], a[60:63], v[88:91]
    s_add_u32 s49, s28, s29
    v_exp_f32 v98, v98
    v_mfma_f32_16x16x32_bf16 v[92:95], v[72:75], a[48:51], v[40:43]
    v_exp_f32 v99, v99
    v_mfma_f32_16x16x32_bf16 v[92:95], v[76:79], a[52:55], v[92:95]
    s_add_u32 m0, s33, 0
    v_add_f32 v16, v16, v96
    v_add_f32 v17, v17, v97
    v_mfma_f32_16x16x32_bf16 v[92:95], v[80:83], a[56:59], v[92:95]
    v_cvt_pk_bf16_f32 v108, v96, v97
    v_mfma_f32_16x16x32_bf16 v[92:95], v[84:87], a[60:63], v[92:95]
    v_exp_f32 v100, v100
    v_mfma_f32_16x16x32_bf16 v[148:151], v[112:115], v[104:107], v[148:151]
    s_add_u32 s34, s34, 1
    v_exp_f32 v101, v101
    v_mfma_f32_16x16x32_bf16 v[176:179], v[116:119], v[104:107], v[176:179]
    v_add_f32 v16, v16, v98
    v_add_f32 v17, v17, v99
    v_mfma_f32_16x16x32_bf16 v[204:207], v[120:123], v[104:107], v[204:207]
    buffer_load_dwordx4 v7, s[4:7], s49 offen offset:0 nt lds
    v_cvt_pk_bf16_f32 v109, v98, v99
    v_mfma_f32_16x16x32_bf16 v[232:235], v[124:127], v[104:107], v[232:235]
    v_exp_f32 v102, v102
    v_mfma_f32_16x16x32_bf16 a[116:119], v[128:131], v[104:107], a[116:119]
    s_add_u32 m0, m0, s96
    v_exp_f32 v103, v103
    v_mfma_f32_16x16x32_bf16 a[144:147], v[132:135], v[104:107], a[144:147]
    v_add_f32 v16, v16, v100
    v_add_f32 v17, v17, v101
    v_mfma_f32_16x16x32_bf16 a[172:175], v[136:139], v[104:107], a[172:175]
    buffer_load_dwordx4 v7, s[4:7], s49 offen offset:256 nt lds
    v_cvt_pk_bf16_f32 v110, v100, v101
    v_add_f32 v16, v16, v102
    v_mfma_f32_16x16x32_bf16 a[200:203], v[140:143], v[104:107], a[200:203]
    v_add_f32 v17, v17, v103
    v_cvt_pk_bf16_f32 v111, v102, v103
    v_mfma_f32_16x16x32_bf16 v[96:99], v[56:59], a[64:67], v[44:47]
    v_mfma_f32_16x16x32_bf16 v[96:99], v[60:63], a[68:71], v[96:99]
    s_add_u32 m0, m0, s97
    v_exp_f32 v88, v88
    v_mfma_f32_16x16x32_bf16 v[96:99], v[64:67], a[72:75], v[96:99]
    v_exp_f32 v89, v89
    v_mfma_f32_16x16x32_bf16 v[96:99], v[68:71], a[76:79], v[96:99]
    buffer_load_dwordx4 v7, s[4:7], s49 offen offset:512 nt lds
    v_exp_f32 v90, v90
    v_mfma_f32_16x16x32_bf16 v[100:103], v[72:75], a[64:67], v[44:47]
    v_exp_f32 v91, v91
    v_mfma_f32_16x16x32_bf16 v[100:103], v[76:79], a[68:71], v[100:103]
    s_add_u32 m0, m0, s96
    v_add_f32 v18, v18, v88
    v_add_f32 v19, v19, v89
    v_mfma_f32_16x16x32_bf16 v[100:103], v[80:83], a[72:75], v[100:103]
    v_cvt_pk_bf16_f32 v104, v88, v89
    v_mfma_f32_16x16x32_bf16 v[100:103], v[84:87], a[76:79], v[100:103]
    v_exp_f32 v92, v92
    v_mfma_f32_16x16x32_bf16 v[152:155], v[112:115], v[108:111], v[152:155]
    buffer_load_dwordx4 v7, s[4:7], s49 offen offset:768 nt lds
    v_exp_f32 v93, v93
    v_mfma_f32_16x16x32_bf16 v[180:183], v[116:119], v[108:111], v[180:183]
    v_add_f32 v18, v18, v90
    v_add_f32 v19, v19, v91
    v_mfma_f32_16x16x32_bf16 v[208:211], v[120:123], v[108:111], v[208:211]
    s_add_u32 m0, m0, s97
    v_cvt_pk_bf16_f32 v105, v90, v91
    v_mfma_f32_16x16x32_bf16 v[236:239], v[124:127], v[108:111], v[236:239]
    v_exp_f32 v94, v94
    v_mfma_f32_16x16x32_bf16 a[120:123], v[128:131], v[108:111], a[120:123]
    buffer_load_dwordx4 v7, s[4:7], s49 offen offset:1024 nt lds
    v_exp_f32 v95, v95
    v_mfma_f32_16x16x32_bf16 a[148:151], v[132:135], v[108:111], a[148:151]
    v_add_f32 v18, v18, v92
    v_add_f32 v19, v19, v93
    v_mfma_f32_16x16x32_bf16 a[176:179], v[136:139], v[108:111], a[176:179]
    s_add_u32 m0, m0, s96
    v_cvt_pk_bf16_f32 v106, v92, v93
    v_add_f32 v18, v18, v94
    v_mfma_f32_16x16x32_bf16 a[204:207], v[140:143], v[108:111], a[204:207]
    v_add_f32 v19, v19, v95
    v_cvt_pk_bf16_f32 v107, v94, v95
    v_mfma_f32_16x16x32_bf16 v[88:91], v[56:59], a[80:83], v[48:51]
    v_mfma_f32_16x16x32_bf16 v[88:91], v[60:63], a[84:87], v[88:91]
    buffer_load_dwordx4 v7, s[4:7], s49 offen offset:1280 nt lds
    v_exp_f32 v96, v96
    v_mfma_f32_16x16x32_bf16 v[88:91], v[64:67], a[88:91], v[88:91]
    v_exp_f32 v97, v97
    v_mfma_f32_16x16x32_bf16 v[88:91], v[68:71], a[92:95], v[88:91]
    s_add_u32 m0, m0, s97
    v_exp_f32 v98, v98
    v_mfma_f32_16x16x32_bf16 v[92:95], v[72:75], a[80:83], v[48:51]
    v_exp_f32 v99, v99
    v_mfma_f32_16x16x32_bf16 v[92:95], v[76:79], a[84:87], v[92:95]
    buffer_load_dwordx4 v7, s[4:7], s49 offen offset:1536 nt lds
    v_add_f32 v20, v20, v96
    v_add_f32 v21, v21, v97
    v_mfma_f32_16x16x32_bf16 v[92:95], v[80:83], a[88:91], v[92:95]
    v_cvt_pk_bf16_f32 v108, v96, v97
    v_mfma_f32_16x16x32_bf16 v[92:95], v[84:87], a[92:95], v[92:95]
    v_exp_f32 v100, v100
    v_mfma_f32_16x16x32_bf16 v[156:159], v[112:115], v[104:107], v[156:159]
    s_add_u32 m0, m0, s96
    v_exp_f32 v101, v101
    v_mfma_f32_16x16x32_bf16 v[184:187], v[116:119], v[104:107], v[184:187]
    v_add_f32 v20, v20, v98
    v_add_f32 v21, v21, v99
    v_mfma_f32_16x16x32_bf16 v[212:215], v[120:123], v[104:107], v[212:215]
    buffer_load_dwordx4 v7, s[4:7], s49 offen offset:1792 nt lds
    v_cvt_pk_bf16_f32 v109, v98, v99
    v_mfma_f32_16x16x32_bf16 v[240:243], v[124:127], v[104:107], v[240:243]
    v_exp_f32 v102, v102
    v_mfma_f32_16x16x32_bf16 a[124:127], v[128:131], v[104:107], a[124:127]
    v_exp_f32 v103, v103
    v_mfma_f32_16x16x32_bf16 a[152:155], v[132:135], v[104:107], a[152:155]
    v_add_f32 v20, v20, v100
    v_add_f32 v21, v21, v101
    v_mfma_f32_16x16x32_bf16 a[180:183], v[136:139], v[104:107], a[180:183]
    v_cvt_pk_bf16_f32 v110, v100, v101
    v_add_f32 v20, v20, v102
    v_mfma_f32_16x16x32_bf16 a[208:211], v[140:143], v[104:107], a[208:211]
    v_add_f32 v21, v21, v103
    v_cvt_pk_bf16_f32 v111, v102, v103
    s_cmp_eq_u32 s68, 0
    s_cbranch_scc1 L_bw1_3682
    s_sub_u32 s68, s68, 1
    s_waitcnt vmcnt(44) lgkmcnt(0)
    s_branch L_bw2_3682
L_bw1_3682:
    s_waitcnt vmcnt(16) lgkmcnt(0)
L_bw2_3682:
    s_barrier
    v_mfma_f32_16x16x32_bf16 v[96:99], v[56:59], a[96:99], v[52:55]
    ds_read_b128 v[56:59], v8 offset:16896
    v_mfma_f32_16x16x32_bf16 v[96:99], v[60:63], a[100:103], v[96:99]
    ds_read_b128 v[60:63], v8 offset:16960
    v_exp_f32 v88, v88
    v_mfma_f32_16x16x32_bf16 v[96:99], v[64:67], a[104:107], v[96:99]
    ds_read_b128 v[64:67], v8 offset:17024
    v_exp_f32 v89, v89
    v_mfma_f32_16x16x32_bf16 v[96:99], v[68:71], a[108:111], v[96:99]
    ds_read_b128 v[68:71], v8 offset:17088
    v_exp_f32 v90, v90
    v_mfma_f32_16x16x32_bf16 v[100:103], v[72:75], a[96:99], v[52:55]
    ds_read_b128 v[72:75], v8 offset:17408
    v_exp_f32 v91, v91
    v_mfma_f32_16x16x32_bf16 v[100:103], v[76:79], a[100:103], v[100:103]
    ds_read_b128 v[76:79], v8 offset:17472
    v_add_f32 v22, v22, v88
    v_add_f32 v23, v23, v89
    v_mfma_f32_16x16x32_bf16 v[100:103], v[80:83], a[104:107], v[100:103]
    ds_read_b128 v[80:83], v8 offset:17536
    v_cvt_pk_bf16_f32 v104, v88, v89
    v_mfma_f32_16x16x32_bf16 v[100:103], v[84:87], a[108:111], v[100:103]
    ds_read_b128 v[84:87], v8 offset:17600
    v_exp_f32 v92, v92
    v_mfma_f32_16x16x32_bf16 v[160:163], v[112:115], v[108:111], v[160:163]
    v_exp_f32 v93, v93
    v_mfma_f32_16x16x32_bf16 v[188:191], v[116:119], v[108:111], v[188:191]
    v_add_f32 v22, v22, v90
    v_add_f32 v23, v23, v91
    v_mfma_f32_16x16x32_bf16 v[216:219], v[120:123], v[108:111], v[216:219]
    v_cvt_pk_bf16_f32 v105, v90, v91
    v_mfma_f32_16x16x32_bf16 v[244:247], v[124:127], v[108:111], v[244:247]
    v_exp_f32 v94, v94
    v_mfma_f32_16x16x32_bf16 a[128:131], v[128:131], v[108:111], a[128:131]
    v_exp_f32 v95, v95
    v_mfma_f32_16x16x32_bf16 a[156:159], v[132:135], v[108:111], a[156:159]
    v_add_f32 v22, v22, v92
    v_add_f32 v23, v23, v93
    v_mfma_f32_16x16x32_bf16 a[184:187], v[136:139], v[108:111], a[184:187]
    v_cvt_pk_bf16_f32 v106, v92, v93
    v_add_f32 v22, v22, v94
    v_mfma_f32_16x16x32_bf16 a[212:215], v[140:143], v[108:111], a[212:215]
    v_add_f32 v23, v23, v95
    v_cvt_pk_bf16_f32 v107, v94, v95
    s_waitcnt lgkmcnt(0)
    v_mfma_f32_16x16x32_bf16 v[88:91], v[56:59], a[0:3], v[28:31]
    v_mfma_f32_16x16x32_bf16 v[88:91], v[60:63], a[4:7], v[88:91]
    v_exp_f32 v96, v96
    v_mfma_f32_16x16x32_bf16 v[88:91], v[64:67], a[8:11], v[88:91]
    v_exp_f32 v97, v97
    v_mfma_f32_16x16x32_bf16 v[88:91], v[68:71], a[12:15], v[88:91]
    v_exp_f32 v98, v98
    v_mfma_f32_16x16x32_bf16 v[92:95], v[72:75], a[0:3], v[28:31]
    v_exp_f32 v99, v99
    v_mfma_f32_16x16x32_bf16 v[92:95], v[76:79], a[4:7], v[92:95]
    v_add_f32 v24, v24, v96
    v_add_f32 v25, v25, v97
    v_mfma_f32_16x16x32_bf16 v[92:95], v[80:83], a[8:11], v[92:95]
    v_cvt_pk_bf16_f32 v108, v96, v97
    v_mfma_f32_16x16x32_bf16 v[92:95], v[84:87], a[12:15], v[92:95]
    v_exp_f32 v100, v100
    v_mfma_f32_16x16x32_bf16 v[164:167], v[112:115], v[104:107], v[164:167]
    v_exp_f32 v101, v101
    v_mfma_f32_16x16x32_bf16 v[192:195], v[116:119], v[104:107], v[192:195]
    v_add_f32 v24, v24, v98
    v_add_f32 v25, v25, v99
    v_mfma_f32_16x16x32_bf16 v[220:223], v[120:123], v[104:107], v[220:223]
    v_cvt_pk_bf16_f32 v109, v98, v99
    v_mfma_f32_16x16x32_bf16 v[248:251], v[124:127], v[104:107], v[248:251]
    v_exp_f32 v102, v102
    v_mfma_f32_16x16x32_bf16 a[132:135], v[128:131], v[104:107], a[132:135]
    v_exp_f32 v103, v103
    v_mfma_f32_16x16x32_bf16 a[160:163], v[132:135], v[104:107], a[160:163]
    v_add_f32 v24, v24, v100
    v_add_f32 v25, v25, v101
    v_mfma_f32_16x16x32_bf16 a[188:191], v[136:139], v[104:107], a[188:191]
    v_cvt_pk_bf16_f32 v110, v100, v101
    v_add_f32 v24, v24, v102
    v_mfma_f32_16x16x32_bf16 a[216:219], v[140:143], v[104:107], a[216:219]
    v_add_f32 v25, v25, v103
    v_cvt_pk_bf16_f32 v111, v102, v103
    v_mfma_f32_16x16x32_bf16 v[96:99], v[56:59], a[16:19], v[32:35]
    v_mfma_f32_16x16x32_bf16 v[96:99], v[60:63], a[20:23], v[96:99]
    v_exp_f32 v88, v88
    v_mfma_f32_16x16x32_bf16 v[96:99], v[64:67], a[24:27], v[96:99]
    v_exp_f32 v89, v89
    v_mfma_f32_16x16x32_bf16 v[96:99], v[68:71], a[28:31], v[96:99]
    v_exp_f32 v90, v90
    v_mfma_f32_16x16x32_bf16 v[100:103], v[72:75], a[16:19], v[32:35]
    v_exp_f32 v91, v91
    v_mfma_f32_16x16x32_bf16 v[100:103], v[76:79], a[20:23], v[100:103]
    v_add_f32 v12, v12, v88
    v_add_f32 v13, v13, v89
    v_mfma_f32_16x16x32_bf16 v[100:103], v[80:83], a[24:27], v[100:103]
    v_cvt_pk_bf16_f32 v104, v88, v89
    v_mfma_f32_16x16x32_bf16 v[100:103], v[84:87], a[28:31], v[100:103]
    v_exp_f32 v92, v92
    v_mfma_f32_16x16x32_bf16 v[168:171], v[112:115], v[108:111], v[168:171]
    ds_read_b64_tr_b16 v[112:113], v9 offset:16896
    ds_read_b64_tr_b16 v[114:115], v9 offset:17408
    v_exp_f32 v93, v93
    v_mfma_f32_16x16x32_bf16 v[196:199], v[116:119], v[108:111], v[196:199]
    ds_read_b64_tr_b16 v[116:117], v9 offset:16928
    ds_read_b64_tr_b16 v[118:119], v9 offset:17440
    v_add_f32 v12, v12, v90
    v_add_f32 v13, v13, v91
    v_mfma_f32_16x16x32_bf16 v[224:227], v[120:123], v[108:111], v[224:227]
    ds_read_b64_tr_b16 v[120:121], v9 offset:16960
    ds_read_b64_tr_b16 v[122:123], v9 offset:17472
    v_cvt_pk_bf16_f32 v105, v90, v91
    v_mfma_f32_16x16x32_bf16 v[252:255], v[124:127], v[108:111], v[252:255]
    ds_read_b64_tr_b16 v[124:125], v9 offset:16992
    ds_read_b64_tr_b16 v[126:127], v9 offset:17504
    v_exp_f32 v94, v94
    v_mfma_f32_16x16x32_bf16 a[136:139], v[128:131], v[108:111], a[136:139]
    ds_read_b64_tr_b16 v[128:129], v9 offset:17024
    ds_read_b64_tr_b16 v[130:131], v9 offset:17536
    v_exp_f32 v95, v95
    v_mfma_f32_16x16x32_bf16 a[164:167], v[132:135], v[108:111], a[164:167]
    ds_read_b64_tr_b16 v[132:133], v9 offset:17056
    ds_read_b64_tr_b16 v[134:135], v9 offset:17568
    v_add_f32 v12, v12, v92
    v_add_f32 v13, v13, v93
    v_mfma_f32_16x16x32_bf16 a[192:195], v[136:139], v[108:111], a[192:195]
    ds_read_b64_tr_b16 v[136:137], v9 offset:17088
    ds_read_b64_tr_b16 v[138:139], v9 offset:17600
    v_cvt_pk_bf16_f32 v106, v92, v93
    v_add_f32 v12, v12, v94
    v_mfma_f32_16x16x32_bf16 a[220:223], v[140:143], v[108:111], a[220:223]
    ds_read_b64_tr_b16 v[140:141], v9 offset:17120
    ds_read_b64_tr_b16 v[142:143], v9 offset:17632
    v_add_f32 v13, v13, v95
    v_cvt_pk_bf16_f32 v107, v94, v95
    v_mfma_f32_16x16x32_bf16 v[88:91], v[56:59], a[32:35], v[36:39]
    v_mfma_f32_16x16x32_bf16 v[88:91], v[60:63], a[36:39], v[88:91]
    s_add_u32 s29, s34, s100
    v_exp_f32 v96, v96
    v_mfma_f32_16x16x32_bf16 v[88:91], v[64:67], a[40:43], v[88:91]
    v_exp_f32 v97, v97
    v_mfma_f32_16x16x32_bf16 v[88:91], v[68:71], a[44:47], v[88:91]
    s_bfe_u32 s28, s29, 0x20003
    v_exp_f32 v98, v98
    v_mfma_f32_16x16x32_bf16 v[92:95], v[72:75], a[32:35], v[36:39]
    v_exp_f32 v99, v99
    v_mfma_f32_16x16x32_bf16 v[92:95], v[76:79], a[36:39], v[92:95]
    s_lshl_b32 s28, s28, 16
    v_add_f32 v14, v14, v96
    v_add_f32 v15, v15, v97
    v_mfma_f32_16x16x32_bf16 v[92:95], v[80:83], a[40:43], v[92:95]
    v_cvt_pk_bf16_f32 v108, v96, v97
    v_mfma_f32_16x16x32_bf16 v[92:95], v[84:87], a[44:47], v[92:95]
    v_exp_f32 v100, v100
    s_waitcnt lgkmcnt(0)
    v_mfma_f32_16x16x32_bf16 v[144:147], v[112:115], v[104:107], v[144:147]
    s_and_b32 s29, s29, 7
    v_exp_f32 v101, v101
    v_mfma_f32_16x16x32_bf16 v[172:175], v[116:119], v[104:107], v[172:175]
    v_add_f32 v14, v14, v98
    v_add_f32 v15, v15, v99
    v_mfma_f32_16x16x32_bf16 v[200:203], v[120:123], v[104:107], v[200:203]
    s_lshl_b32 s29, s29, 11
    v_cvt_pk_bf16_f32 v109, v98, v99
    v_mfma_f32_16x16x32_bf16 v[228:231], v[124:127], v[104:107], v[228:231]
    v_exp_f32 v102, v102
    v_mfma_f32_16x16x32_bf16 a[112:115], v[128:131], v[104:107], a[112:115]
    s_add_u32 s29, s28, s29
    v_exp_f32 v103, v103
    v_mfma_f32_16x16x32_bf16 a[140:143], v[132:135], v[104:107], a[140:143]
    v_add_f32 v14, v14, v100
    v_add_f32 v15, v15, v101
    v_mfma_f32_16x16x32_bf16 a[168:171], v[136:139], v[104:107], a[168:171]
    s_lshr_b32 s28, s34, 5
    v_cvt_pk_bf16_f32 v110, v100, v101
    v_add_f32 v14, v14, v102
    v_mfma_f32_16x16x32_bf16 a[196:199], v[140:143], v[104:107], a[196:199]
    v_add_f32 v15, v15, v103
    v_cvt_pk_bf16_f32 v111, v102, v103
    v_mfma_f32_16x16x32_bf16 v[96:99], v[56:59], a[48:51], v[40:43]
    v_mfma_f32_16x16x32_bf16 v[96:99], v[60:63], a[52:55], v[96:99]
    s_lshl_b32 s28, s28, 19
    v_exp_f32 v88, v88
    v_mfma_f32_16x16x32_bf16 v[96:99], v[64:67], a[56:59], v[96:99]
    v_exp_f32 v89, v89
    v_mfma_f32_16x16x32_bf16 v[96:99], v[68:71], a[60:63], v[96:99]
    s_add_u32 s49, s28, s29
    v_exp_f32 v90, v90
    v_mfma_f32_16x16x32_bf16 v[100:103], v[72:75], a[48:51], v[40:43]
    v_exp_f32 v91, v91
    v_mfma_f32_16x16x32_bf16 v[100:103], v[76:79], a[52:55], v[100:103]
    s_add_u32 m0, s33, 8448
    v_add_f32 v16, v16, v88
    v_add_f32 v17, v17, v89
    v_mfma_f32_16x16x32_bf16 v[100:103], v[80:83], a[56:59], v[100:103]
    v_cvt_pk_bf16_f32 v104, v88, v89
    v_mfma_f32_16x16x32_bf16 v[100:103], v[84:87], a[60:63], v[100:103]
    v_exp_f32 v92, v92
    v_mfma_f32_16x16x32_bf16 v[148:151], v[112:115], v[108:111], v[148:151]
    s_add_u32 s34, s34, 1
    v_exp_f32 v93, v93
    v_mfma_f32_16x16x32_bf16 v[176:179], v[116:119], v[108:111], v[176:179]
    v_add_f32 v16, v16, v90
    v_add_f32 v17, v17, v91
    v_mfma_f32_16x16x32_bf16 v[204:207], v[120:123], v[108:111], v[204:207]
    buffer_load_dwordx4 v7, s[4:7], s49 offen offset:0 nt lds
    v_cvt_pk_bf16_f32 v105, v90, v91
    v_mfma_f32_16x16x32_bf16 v[232:235], v[124:127], v[108:111], v[232:235]
    v_exp_f32 v94, v94
    v_mfma_f32_16x16x32_bf16 a[116:119], v[128:131], v[108:111], a[116:119]
    s_add_u32 m0, m0, s96
    v_exp_f32 v95, v95
    v_mfma_f32_16x16x32_bf16 a[144:147], v[132:135], v[108:111], a[144:147]
    v_add_f32 v16, v16, v92
    v_add_f32 v17, v17, v93
    v_mfma_f32_16x16x32_bf16 a[172:175], v[136:139], v[108:111], a[172:175]
    buffer_load_dwordx4 v7, s[4:7], s49 offen offset:256 nt lds
    v_cvt_pk_bf16_f32 v106, v92, v93
    v_add_f32 v16, v16, v94
    v_mfma_f32_16x16x32_bf16 a[200:203], v[140:143], v[108:111], a[200:203]
    v_add_f32 v17, v17, v95
    v_cvt_pk_bf16_f32 v107, v94, v95
    v_mfma_f32_16x16x32_bf16 v[88:91], v[56:59], a[64:67], v[44:47]
    v_mfma_f32_16x16x32_bf16 v[88:91], v[60:63], a[68:71], v[88:91]
    s_add_u32 m0, m0, s97
    v_exp_f32 v96, v96
    v_mfma_f32_16x16x32_bf16 v[88:91], v[64:67], a[72:75], v[88:91]
    v_exp_f32 v97, v97
    v_mfma_f32_16x16x32_bf16 v[88:91], v[68:71], a[76:79], v[88:91]
    buffer_load_dwordx4 v7, s[4:7], s49 offen offset:512 nt lds
    v_exp_f32 v98, v98
    v_mfma_f32_16x16x32_bf16 v[92:95], v[72:75], a[64:67], v[44:47]
    v_exp_f32 v99, v99
    v_mfma_f32_16x16x32_bf16 v[92:95], v[76:79], a[68:71], v[92:95]
    s_add_u32 m0, m0, s96
    v_add_f32 v18, v18, v96
    v_add_f32 v19, v19, v97
    v_mfma_f32_16x16x32_bf16 v[92:95], v[80:83], a[72:75], v[92:95]
    v_cvt_pk_bf16_f32 v108, v96, v97
    v_mfma_f32_16x16x32_bf16 v[92:95], v[84:87], a[76:79], v[92:95]
    v_exp_f32 v100, v100
    v_mfma_f32_16x16x32_bf16 v[152:155], v[112:115], v[104:107], v[152:155]
    buffer_load_dwordx4 v7, s[4:7], s49 offen offset:768 nt lds
    v_exp_f32 v101, v101
    v_mfma_f32_16x16x32_bf16 v[180:183], v[116:119], v[104:107], v[180:183]
    v_add_f32 v18, v18, v98
    v_add_f32 v19, v19, v99
    v_mfma_f32_16x16x32_bf16 v[208:211], v[120:123], v[104:107], v[208:211]
    s_add_u32 m0, m0, s97
    v_cvt_pk_bf16_f32 v109, v98, v99
    v_mfma_f32_16x16x32_bf16 v[236:239], v[124:127], v[104:107], v[236:239]
    v_exp_f32 v102, v102
    v_mfma_f32_16x16x32_bf16 a[120:123], v[128:131], v[104:107], a[120:123]
    buffer_load_dwordx4 v7, s[4:7], s49 offen offset:1024 nt lds
    v_exp_f32 v103, v103
    v_mfma_f32_16x16x32_bf16 a[148:151], v[132:135], v[104:107], a[148:151]
    v_add_f32 v18, v18, v100
    v_add_f32 v19, v19, v101
    v_mfma_f32_16x16x32_bf16 a[176:179], v[136:139], v[104:107], a[176:179]
    s_add_u32 m0, m0, s96
    v_cvt_pk_bf16_f32 v110, v100, v101
    v_add_f32 v18, v18, v102
    v_mfma_f32_16x16x32_bf16 a[204:207], v[140:143], v[104:107], a[204:207]
    v_add_f32 v19, v19, v103
    v_cvt_pk_bf16_f32 v111, v102, v103
    v_mfma_f32_16x16x32_bf16 v[96:99], v[56:59], a[80:83], v[48:51]
    v_mfma_f32_16x16x32_bf16 v[96:99], v[60:63], a[84:87], v[96:99]
    buffer_load_dwordx4 v7, s[4:7], s49 offen offset:1280 nt lds
    v_exp_f32 v88, v88
    v_mfma_f32_16x16x32_bf16 v[96:99], v[64:67], a[88:91], v[96:99]
    v_exp_f32 v89, v89
    v_mfma_f32_16x16x32_bf16 v[96:99], v[68:71], a[92:95], v[96:99]
    s_add_u32 m0, m0, s97
    v_exp_f32 v90, v90
    v_mfma_f32_16x16x32_bf16 v[100:103], v[72:75], a[80:83], v[48:51]
    v_exp_f32 v91, v91
    v_mfma_f32_16x16x32_bf16 v[100:103], v[76:79], a[84:87], v[100:103]
    buffer_load_dwordx4 v7, s[4:7], s49 offen offset:1536 nt lds
    v_add_f32 v20, v20, v88
    v_add_f32 v21, v21, v89
    v_mfma_f32_16x16x32_bf16 v[100:103], v[80:83], a[88:91], v[100:103]
    v_cvt_pk_bf16_f32 v104, v88, v89
    v_mfma_f32_16x16x32_bf16 v[100:103], v[84:87], a[92:95], v[100:103]
    v_exp_f32 v92, v92
    v_mfma_f32_16x16x32_bf16 v[156:159], v[112:115], v[108:111], v[156:159]
    s_add_u32 m0, m0, s96
    v_exp_f32 v93, v93
    v_mfma_f32_16x16x32_bf16 v[184:187], v[116:119], v[108:111], v[184:187]
    v_add_f32 v20, v20, v90
    v_add_f32 v21, v21, v91
    v_mfma_f32_16x16x32_bf16 v[212:215], v[120:123], v[108:111], v[212:215]
    buffer_load_dwordx4 v7, s[4:7], s49 offen offset:1792 nt lds
    v_cvt_pk_bf16_f32 v105, v90, v91
    v_mfma_f32_16x16x32_bf16 v[240:243], v[124:127], v[108:111], v[240:243]
    v_exp_f32 v94, v94
    v_mfma_f32_16x16x32_bf16 a[124:127], v[128:131], v[108:111], a[124:127]
    v_exp_f32 v95, v95
    v_mfma_f32_16x16x32_bf16 a[152:155], v[132:135], v[108:111], a[152:155]
    v_add_f32 v20, v20, v92
    v_add_f32 v21, v21, v93
    v_mfma_f32_16x16x32_bf16 a[180:183], v[136:139], v[108:111], a[180:183]
    v_cvt_pk_bf16_f32 v106, v92, v93
    v_add_f32 v20, v20, v94
    v_mfma_f32_16x16x32_bf16 a[208:211], v[140:143], v[108:111], a[208:211]
    v_add_f32 v21, v21, v95
    v_cvt_pk_bf16_f32 v107, v94, v95
    s_cmp_eq_u32 s68, 0
    s_cbranch_scc1 L_bw1_3995
    s_sub_u32 s68, s68, 1
    s_waitcnt vmcnt(44) lgkmcnt(0)
    s_branch L_bw2_3995
L_bw1_3995:
    s_waitcnt vmcnt(16) lgkmcnt(0)
L_bw2_3995:
    s_barrier
    v_mfma_f32_16x16x32_bf16 v[88:91], v[56:59], a[96:99], v[52:55]
    ds_read_b128 v[56:59], v8 offset:25344
    v_mfma_f32_16x16x32_bf16 v[88:91], v[60:63], a[100:103], v[88:91]
    ds_read_b128 v[60:63], v8 offset:25408
    v_exp_f32 v96, v96
    v_mfma_f32_16x16x32_bf16 v[88:91], v[64:67], a[104:107], v[88:91]
    ds_read_b128 v[64:67], v8 offset:25472
    v_exp_f32 v97, v97
    v_mfma_f32_16x16x32_bf16 v[88:91], v[68:71], a[108:111], v[88:91]
    ds_read_b128 v[68:71], v8 offset:25536
    v_exp_f32 v98, v98
    v_mfma_f32_16x16x32_bf16 v[92:95], v[72:75], a[96:99], v[52:55]
    ds_read_b128 v[72:75], v8 offset:25856
    v_exp_f32 v99, v99
    v_mfma_f32_16x16x32_bf16 v[92:95], v[76:79], a[100:103], v[92:95]
    ds_read_b128 v[76:79], v8 offset:25920
    v_add_f32 v22, v22, v96
    v_add_f32 v23, v23, v97
    v_mfma_f32_16x16x32_bf16 v[92:95], v[80:83], a[104:107], v[92:95]
    ds_read_b128 v[80:83], v8 offset:25984
    v_cvt_pk_bf16_f32 v108, v96, v97
    v_mfma_f32_16x16x32_bf16 v[92:95], v[84:87], a[108:111], v[92:95]
    ds_read_b128 v[84:87], v8 offset:26048
    v_exp_f32 v100, v100
    v_mfma_f32_16x16x32_bf16 v[160:163], v[112:115], v[104:107], v[160:163]
    v_exp_f32 v101, v101
    v_mfma_f32_16x16x32_bf16 v[188:191], v[116:119], v[104:107], v[188:191]
    v_add_f32 v22, v22, v98
    v_add_f32 v23, v23, v99
    v_mfma_f32_16x16x32_bf16 v[216:219], v[120:123], v[104:107], v[216:219]
    v_cvt_pk_bf16_f32 v109, v98, v99
    v_mfma_f32_16x16x32_bf16 v[244:247], v[124:127], v[104:107], v[244:247]
    v_exp_f32 v102, v102
    v_mfma_f32_16x16x32_bf16 a[128:131], v[128:131], v[104:107], a[128:131]
    v_exp_f32 v103, v103
    v_mfma_f32_16x16x32_bf16 a[156:159], v[132:135], v[104:107], a[156:159]
    v_add_f32 v22, v22, v100
    v_add_f32 v23, v23, v101
    v_mfma_f32_16x16x32_bf16 a[184:187], v[136:139], v[104:107], a[184:187]
    v_cvt_pk_bf16_f32 v110, v100, v101
    v_add_f32 v22, v22, v102
    v_mfma_f32_16x16x32_bf16 a[212:215], v[140:143], v[104:107], a[212:215]
    v_add_f32 v23, v23, v103
    v_cvt_pk_bf16_f32 v111, v102, v103
    s_waitcnt lgkmcnt(0)
    v_mfma_f32_16x16x32_bf16 v[96:99], v[56:59], a[0:3], v[28:31]
    v_mfma_f32_16x16x32_bf16 v[96:99], v[60:63], a[4:7], v[96:99]
    v_exp_f32 v88, v88
    v_mfma_f32_16x16x32_bf16 v[96:99], v[64:67], a[8:11], v[96:99]
    v_exp_f32 v89, v89
    v_mfma_f32_16x16x32_bf16 v[96:99], v[68:71], a[12:15], v[96:99]
    v_exp_f32 v90, v90
    v_mfma_f32_16x16x32_bf16 v[100:103], v[72:75], a[0:3], v[28:31]
    v_exp_f32 v91, v91
    v_mfma_f32_16x16x32_bf16 v[100:103], v[76:79], a[4:7], v[100:103]
    v_add_f32 v24, v24, v88
    v_add_f32 v25, v25, v89
    v_mfma_f32_16x16x32_bf16 v[100:103], v[80:83], a[8:11], v[100:103]
    v_cvt_pk_bf16_f32 v104, v88, v89
    v_mfma_f32_16x16x32_bf16 v[100:103], v[84:87], a[12:15], v[100:103]
    v_exp_f32 v92, v92
    v_mfma_f32_16x16x32_bf16 v[164:167], v[112:115], v[108:111], v[164:167]
    v_exp_f32 v93, v93
    v_mfma_f32_16x16x32_bf16 v[192:195], v[116:119], v[108:111], v[192:195]
    v_add_f32 v24, v24, v90
    v_add_f32 v25, v25, v91
    v_mfma_f32_16x16x32_bf16 v[220:223], v[120:123], v[108:111], v[220:223]
    v_cvt_pk_bf16_f32 v105, v90, v91
    v_mfma_f32_16x16x32_bf16 v[248:251], v[124:127], v[108:111], v[248:251]
    v_exp_f32 v94, v94
    v_mfma_f32_16x16x32_bf16 a[132:135], v[128:131], v[108:111], a[132:135]
    v_exp_f32 v95, v95
    v_mfma_f32_16x16x32_bf16 a[160:163], v[132:135], v[108:111], a[160:163]
    v_add_f32 v24, v24, v92
    v_add_f32 v25, v25, v93
    v_mfma_f32_16x16x32_bf16 a[188:191], v[136:139], v[108:111], a[188:191]
    v_cvt_pk_bf16_f32 v106, v92, v93
    v_add_f32 v24, v24, v94
    v_mfma_f32_16x16x32_bf16 a[216:219], v[140:143], v[108:111], a[216:219]
    v_add_f32 v25, v25, v95
    v_cvt_pk_bf16_f32 v107, v94, v95
    v_mfma_f32_16x16x32_bf16 v[88:91], v[56:59], a[16:19], v[32:35]
    v_mfma_f32_16x16x32_bf16 v[88:91], v[60:63], a[20:23], v[88:91]
    v_exp_f32 v96, v96
    v_mfma_f32_16x16x32_bf16 v[88:91], v[64:67], a[24:27], v[88:91]
    v_exp_f32 v97, v97
    v_mfma_f32_16x16x32_bf16 v[88:91], v[68:71], a[28:31], v[88:91]
    v_exp_f32 v98, v98
    v_mfma_f32_16x16x32_bf16 v[92:95], v[72:75], a[16:19], v[32:35]
    v_exp_f32 v99, v99
    v_mfma_f32_16x16x32_bf16 v[92:95], v[76:79], a[20:23], v[92:95]
    v_add_f32 v12, v12, v96
    v_add_f32 v13, v13, v97
    v_mfma_f32_16x16x32_bf16 v[92:95], v[80:83], a[24:27], v[92:95]
    v_cvt_pk_bf16_f32 v108, v96, v97
    v_mfma_f32_16x16x32_bf16 v[92:95], v[84:87], a[28:31], v[92:95]
    v_exp_f32 v100, v100
    v_mfma_f32_16x16x32_bf16 v[168:171], v[112:115], v[104:107], v[168:171]
    ds_read_b64_tr_b16 v[112:113], v9 offset:25344
    ds_read_b64_tr_b16 v[114:115], v9 offset:25856
    v_exp_f32 v101, v101
    v_mfma_f32_16x16x32_bf16 v[196:199], v[116:119], v[104:107], v[196:199]
    ds_read_b64_tr_b16 v[116:117], v9 offset:25376
    ds_read_b64_tr_b16 v[118:119], v9 offset:25888
    v_add_f32 v12, v12, v98
    v_add_f32 v13, v13, v99
    v_mfma_f32_16x16x32_bf16 v[224:227], v[120:123], v[104:107], v[224:227]
    ds_read_b64_tr_b16 v[120:121], v9 offset:25408
    ds_read_b64_tr_b16 v[122:123], v9 offset:25920
    v_cvt_pk_bf16_f32 v109, v98, v99
    v_mfma_f32_16x16x32_bf16 v[252:255], v[124:127], v[104:107], v[252:255]
    ds_read_b64_tr_b16 v[124:125], v9 offset:25440
    ds_read_b64_tr_b16 v[126:127], v9 offset:25952
    v_exp_f32 v102, v102
    v_mfma_f32_16x16x32_bf16 a[136:139], v[128:131], v[104:107], a[136:139]
    ds_read_b64_tr_b16 v[128:129], v9 offset:25472
    ds_read_b64_tr_b16 v[130:131], v9 offset:25984
    v_exp_f32 v103, v103
    v_mfma_f32_16x16x32_bf16 a[164:167], v[132:135], v[104:107], a[164:167]
    ds_read_b64_tr_b16 v[132:133], v9 offset:25504
    ds_read_b64_tr_b16 v[134:135], v9 offset:26016
    v_add_f32 v12, v12, v100
    v_add_f32 v13, v13, v101
    v_mfma_f32_16x16x32_bf16 a[192:195], v[136:139], v[104:107], a[192:195]
    ds_read_b64_tr_b16 v[136:137], v9 offset:25536
    ds_read_b64_tr_b16 v[138:139], v9 offset:26048
    v_cvt_pk_bf16_f32 v110, v100, v101
    v_add_f32 v12, v12, v102
    v_mfma_f32_16x16x32_bf16 a[220:223], v[140:143], v[104:107], a[220:223]
    ds_read_b64_tr_b16 v[140:141], v9 offset:25568
    ds_read_b64_tr_b16 v[142:143], v9 offset:26080
    v_add_f32 v13, v13, v103
    v_cvt_pk_bf16_f32 v111, v102, v103
    v_mfma_f32_16x16x32_bf16 v[96:99], v[56:59], a[32:35], v[36:39]
    v_mfma_f32_16x16x32_bf16 v[96:99], v[60:63], a[36:39], v[96:99]
    s_add_u32 s29, s34, s100
    v_exp_f32 v88, v88
    v_mfma_f32_16x16x32_bf16 v[96:99], v[64:67], a[40:43], v[96:99]
    v_exp_f32 v89, v89
    v_mfma_f32_16x16x32_bf16 v[96:99], v[68:71], a[44:47], v[96:99]
    s_bfe_u32 s28, s29, 0x20003
    v_exp_f32 v90, v90
    v_mfma_f32_16x16x32_bf16 v[100:103], v[72:75], a[32:35], v[36:39]
    v_exp_f32 v91, v91
    v_mfma_f32_16x16x32_bf16 v[100:103], v[76:79], a[36:39], v[100:103]
    s_lshl_b32 s28, s28, 16
    v_add_f32 v14, v14, v88
    v_add_f32 v15, v15, v89
    v_mfma_f32_16x16x32_bf16 v[100:103], v[80:83], a[40:43], v[100:103]
    v_cvt_pk_bf16_f32 v104, v88, v89
    v_mfma_f32_16x16x32_bf16 v[100:103], v[84:87], a[44:47], v[100:103]
    v_exp_f32 v92, v92
    s_waitcnt lgkmcnt(0)
    v_mfma_f32_16x16x32_bf16 v[144:147], v[112:115], v[108:111], v[144:147]
    s_and_b32 s29, s29, 7
    v_exp_f32 v93, v93
    v_mfma_f32_16x16x32_bf16 v[172:175], v[116:119], v[108:111], v[172:175]
    v_add_f32 v14, v14, v90
    v_add_f32 v15, v15, v91
    v_mfma_f32_16x16x32_bf16 v[200:203], v[120:123], v[108:111], v[200:203]
    s_lshl_b32 s29, s29, 11
    v_cvt_pk_bf16_f32 v105, v90, v91
    v_mfma_f32_16x16x32_bf16 v[228:231], v[124:127], v[108:111], v[228:231]
    v_exp_f32 v94, v94
    v_mfma_f32_16x16x32_bf16 a[112:115], v[128:131], v[108:111], a[112:115]
    s_add_u32 s29, s28, s29
    v_exp_f32 v95, v95
    v_mfma_f32_16x16x32_bf16 a[140:143], v[132:135], v[108:111], a[140:143]
    v_add_f32 v14, v14, v92
    v_add_f32 v15, v15, v93
    v_mfma_f32_16x16x32_bf16 a[168:171], v[136:139], v[108:111], a[168:171]
    s_lshr_b32 s28, s34, 5
    v_cvt_pk_bf16_f32 v106, v92, v93
    v_add_f32 v14, v14, v94
    v_mfma_f32_16x16x32_bf16 a[196:199], v[140:143], v[108:111], a[196:199]
    v_add_f32 v15, v15, v95
    v_cvt_pk_bf16_f32 v107, v94, v95
    v_mfma_f32_16x16x32_bf16 v[88:91], v[56:59], a[48:51], v[40:43]
    v_mfma_f32_16x16x32_bf16 v[88:91], v[60:63], a[52:55], v[88:91]
    s_lshl_b32 s28, s28, 19
    v_exp_f32 v96, v96
    v_mfma_f32_16x16x32_bf16 v[88:91], v[64:67], a[56:59], v[88:91]
    v_exp_f32 v97, v97
    v_mfma_f32_16x16x32_bf16 v[88:91], v[68:71], a[60:63], v[88:91]
    s_add_u32 s49, s28, s29
    v_exp_f32 v98, v98
    v_mfma_f32_16x16x32_bf16 v[92:95], v[72:75], a[48:51], v[40:43]
    v_exp_f32 v99, v99
    v_mfma_f32_16x16x32_bf16 v[92:95], v[76:79], a[52:55], v[92:95]
    s_add_u32 m0, s33, 16896
    v_add_f32 v16, v16, v96
    v_add_f32 v17, v17, v97
    v_mfma_f32_16x16x32_bf16 v[92:95], v[80:83], a[56:59], v[92:95]
    v_cvt_pk_bf16_f32 v108, v96, v97
    v_mfma_f32_16x16x32_bf16 v[92:95], v[84:87], a[60:63], v[92:95]
    v_exp_f32 v100, v100
    v_mfma_f32_16x16x32_bf16 v[148:151], v[112:115], v[104:107], v[148:151]
    s_add_u32 s34, s34, 1
    v_exp_f32 v101, v101
    v_mfma_f32_16x16x32_bf16 v[176:179], v[116:119], v[104:107], v[176:179]
    v_add_f32 v16, v16, v98
    v_add_f32 v17, v17, v99
    v_mfma_f32_16x16x32_bf16 v[204:207], v[120:123], v[104:107], v[204:207]
    buffer_load_dwordx4 v7, s[4:7], s49 offen offset:0 nt lds
    v_cvt_pk_bf16_f32 v109, v98, v99
    v_mfma_f32_16x16x32_bf16 v[232:235], v[124:127], v[104:107], v[232:235]
    v_exp_f32 v102, v102
    v_mfma_f32_16x16x32_bf16 a[116:119], v[128:131], v[104:107], a[116:119]
    s_add_u32 m0, m0, s96
    v_exp_f32 v103, v103
    v_mfma_f32_16x16x32_bf16 a[144:147], v[132:135], v[104:107], a[144:147]
    v_add_f32 v16, v16, v100
    v_add_f32 v17, v17, v101
    v_mfma_f32_16x16x32_bf16 a[172:175], v[136:139], v[104:107], a[172:175]
    buffer_load_dwordx4 v7, s[4:7], s49 offen offset:256 nt lds
    v_cvt_pk_bf16_f32 v110, v100, v101
    v_add_f32 v16, v16, v102
    v_mfma_f32_16x16x32_bf16 a[200:203], v[140:143], v[104:107], a[200:203]
    v_add_f32 v17, v17, v103
    v_cvt_pk_bf16_f32 v111, v102, v103
    v_mfma_f32_16x16x32_bf16 v[96:99], v[56:59], a[64:67], v[44:47]
    v_mfma_f32_16x16x32_bf16 v[96:99], v[60:63], a[68:71], v[96:99]
    s_add_u32 m0, m0, s97
    v_exp_f32 v88, v88
    v_mfma_f32_16x16x32_bf16 v[96:99], v[64:67], a[72:75], v[96:99]
    v_exp_f32 v89, v89
    v_mfma_f32_16x16x32_bf16 v[96:99], v[68:71], a[76:79], v[96:99]
    buffer_load_dwordx4 v7, s[4:7], s49 offen offset:512 nt lds
    v_exp_f32 v90, v90
    v_mfma_f32_16x16x32_bf16 v[100:103], v[72:75], a[64:67], v[44:47]
    v_exp_f32 v91, v91
    v_mfma_f32_16x16x32_bf16 v[100:103], v[76:79], a[68:71], v[100:103]
    s_add_u32 m0, m0, s96
    v_add_f32 v18, v18, v88
    v_add_f32 v19, v19, v89
    v_mfma_f32_16x16x32_bf16 v[100:103], v[80:83], a[72:75], v[100:103]
    v_cvt_pk_bf16_f32 v104, v88, v89
    v_mfma_f32_16x16x32_bf16 v[100:103], v[84:87], a[76:79], v[100:103]
    v_exp_f32 v92, v92
    v_mfma_f32_16x16x32_bf16 v[152:155], v[112:115], v[108:111], v[152:155]
    buffer_load_dwordx4 v7, s[4:7], s49 offen offset:768 nt lds
    v_exp_f32 v93, v93
    v_mfma_f32_16x16x32_bf16 v[180:183], v[116:119], v[108:111], v[180:183]
    v_add_f32 v18, v18, v90
    v_add_f32 v19, v19, v91
    v_mfma_f32_16x16x32_bf16 v[208:211], v[120:123], v[108:111], v[208:211]
    s_add_u32 m0, m0, s97
    v_cvt_pk_bf16_f32 v105, v90, v91
    v_mfma_f32_16x16x32_bf16 v[236:239], v[124:127], v[108:111], v[236:239]
    v_exp_f32 v94, v94
    v_mfma_f32_16x16x32_bf16 a[120:123], v[128:131], v[108:111], a[120:123]
    buffer_load_dwordx4 v7, s[4:7], s49 offen offset:1024 nt lds
    v_exp_f32 v95, v95
    v_mfma_f32_16x16x32_bf16 a[148:151], v[132:135], v[108:111], a[148:151]
    v_add_f32 v18, v18, v92
    v_add_f32 v19, v19, v93
    v_mfma_f32_16x16x32_bf16 a[176:179], v[136:139], v[108:111], a[176:179]
    s_add_u32 m0, m0, s96
    v_cvt_pk_bf16_f32 v106, v92, v93
    v_add_f32 v18, v18, v94
    v_mfma_f32_16x16x32_bf16 a[204:207], v[140:143], v[108:111], a[204:207]
    v_add_f32 v19, v19, v95
    v_cvt_pk_bf16_f32 v107, v94, v95
    v_mfma_f32_16x16x32_bf16 v[88:91], v[56:59], a[80:83], v[48:51]
    v_mfma_f32_16x16x32_bf16 v[88:91], v[60:63], a[84:87], v[88:91]
    buffer_load_dwordx4 v7, s[4:7], s49 offen offset:1280 nt lds
    v_exp_f32 v96, v96
    v_mfma_f32_16x16x32_bf16 v[88:91], v[64:67], a[88:91], v[88:91]
    v_exp_f32 v97, v97
    v_mfma_f32_16x16x32_bf16 v[88:91], v[68:71], a[92:95], v[88:91]
    s_add_u32 m0, m0, s97
    v_exp_f32 v98, v98
    v_mfma_f32_16x16x32_bf16 v[92:95], v[72:75], a[80:83], v[48:51]
    v_exp_f32 v99, v99
    v_mfma_f32_16x16x32_bf16 v[92:95], v[76:79], a[84:87], v[92:95]
    buffer_load_dwordx4 v7, s[4:7], s49 offen offset:1536 nt lds
    v_add_f32 v20, v20, v96
    v_add_f32 v21, v21, v97
    v_mfma_f32_16x16x32_bf16 v[92:95], v[80:83], a[88:91], v[92:95]
    v_cvt_pk_bf16_f32 v108, v96, v97
    v_mfma_f32_16x16x32_bf16 v[92:95], v[84:87], a[92:95], v[92:95]
    v_exp_f32 v100, v100
    v_mfma_f32_16x16x32_bf16 v[156:159], v[112:115], v[104:107], v[156:159]
    s_add_u32 m0, m0, s96
    v_exp_f32 v101, v101
    v_mfma_f32_16x16x32_bf16 v[184:187], v[116:119], v[104:107], v[184:187]
    v_add_f32 v20, v20, v98
    v_add_f32 v21, v21, v99
    v_mfma_f32_16x16x32_bf16 v[212:215], v[120:123], v[104:107], v[212:215]
    buffer_load_dwordx4 v7, s[4:7], s49 offen offset:1792 nt lds
    v_cvt_pk_bf16_f32 v109, v98, v99
    v_mfma_f32_16x16x32_bf16 v[240:243], v[124:127], v[104:107], v[240:243]
    v_exp_f32 v102, v102
    v_mfma_f32_16x16x32_bf16 a[124:127], v[128:131], v[104:107], a[124:127]
    v_exp_f32 v103, v103
    v_mfma_f32_16x16x32_bf16 a[152:155], v[132:135], v[104:107], a[152:155]
    v_add_f32 v20, v20, v100
    v_add_f32 v21, v21, v101
    v_mfma_f32_16x16x32_bf16 a[180:183], v[136:139], v[104:107], a[180:183]
    v_cvt_pk_bf16_f32 v110, v100, v101
    v_add_f32 v20, v20, v102
    v_mfma_f32_16x16x32_bf16 a[208:211], v[140:143], v[104:107], a[208:211]
    v_add_f32 v21, v21, v103
    v_cvt_pk_bf16_f32 v111, v102, v103
    s_waitcnt vmcnt(16) lgkmcnt(0)
    s_barrier
    v_mfma_f32_16x16x32_bf16 v[96:99], v[56:59], a[96:99], v[52:55]
    ds_read_b128 v[56:59], v8 offset:0
    v_mfma_f32_16x16x32_bf16 v[96:99], v[60:63], a[100:103], v[96:99]
    ds_read_b128 v[60:63], v8 offset:64
    v_exp_f32 v88, v88
    v_mfma_f32_16x16x32_bf16 v[96:99], v[64:67], a[104:107], v[96:99]
    ds_read_b128 v[64:67], v8 offset:128
    v_exp_f32 v89, v89
    v_mfma_f32_16x16x32_bf16 v[96:99], v[68:71], a[108:111], v[96:99]
    ds_read_b128 v[68:71], v8 offset:192
    v_exp_f32 v90, v90
    v_mfma_f32_16x16x32_bf16 v[100:103], v[72:75], a[96:99], v[52:55]
    ds_read_b128 v[72:75], v8 offset:512
    v_exp_f32 v91, v91
    v_mfma_f32_16x16x32_bf16 v[100:103], v[76:79], a[100:103], v[100:103]
    ds_read_b128 v[76:79], v8 offset:576
    v_add_f32 v22, v22, v88
    v_add_f32 v23, v23, v89
    v_mfma_f32_16x16x32_bf16 v[100:103], v[80:83], a[104:107], v[100:103]
    ds_read_b128 v[80:83], v8 offset:640
    v_cvt_pk_bf16_f32 v104, v88, v89
    v_mfma_f32_16x16x32_bf16 v[100:103], v[84:87], a[108:111], v[100:103]
    ds_read_b128 v[84:87], v8 offset:704
    v_exp_f32 v92, v92
    v_mfma_f32_16x16x32_bf16 v[160:163], v[112:115], v[108:111], v[160:163]
    v_exp_f32 v93, v93
    v_mfma_f32_16x16x32_bf16 v[188:191], v[116:119], v[108:111], v[188:191]
    v_add_f32 v22, v22, v90
    v_add_f32 v23, v23, v91
    v_mfma_f32_16x16x32_bf16 v[216:219], v[120:123], v[108:111], v[216:219]
    v_cvt_pk_bf16_f32 v105, v90, v91
    v_mfma_f32_16x16x32_bf16 v[244:247], v[124:127], v[108:111], v[244:247]
    v_exp_f32 v94, v94
    v_mfma_f32_16x16x32_bf16 a[128:131], v[128:131], v[108:111], a[128:131]
    v_exp_f32 v95, v95
    v_mfma_f32_16x16x32_bf16 a[156:159], v[132:135], v[108:111], a[156:159]
    v_add_f32 v22, v22, v92
    v_add_f32 v23, v23, v93
    v_mfma_f32_16x16x32_bf16 a[184:187], v[136:139], v[108:111], a[184:187]
    v_cvt_pk_bf16_f32 v106, v92, v93
    v_add_f32 v22, v22, v94
    v_mfma_f32_16x16x32_bf16 a[212:215], v[140:143], v[108:111], a[212:215]
    v_add_f32 v23, v23, v95
    v_cvt_pk_bf16_f32 v107, v94, v95
    s_waitcnt lgkmcnt(0)
    v_mfma_f32_16x16x32_bf16 v[88:91], v[56:59], a[0:3], v[28:31]
    v_mfma_f32_16x16x32_bf16 v[88:91], v[60:63], a[4:7], v[88:91]
    v_exp_f32 v96, v96
    v_mfma_f32_16x16x32_bf16 v[88:91], v[64:67], a[8:11], v[88:91]
    v_exp_f32 v97, v97
    v_mfma_f32_16x16x32_bf16 v[88:91], v[68:71], a[12:15], v[88:91]
    v_exp_f32 v98, v98
    v_mfma_f32_16x16x32_bf16 v[92:95], v[72:75], a[0:3], v[28:31]
    v_exp_f32 v99, v99
    v_mfma_f32_16x16x32_bf16 v[92:95], v[76:79], a[4:7], v[92:95]
    v_add_f32 v24, v24, v96
    v_add_f32 v25, v25, v97
    v_mfma_f32_16x16x32_bf16 v[92:95], v[80:83], a[8:11], v[92:95]
    v_cvt_pk_bf16_f32 v108, v96, v97
    v_mfma_f32_16x16x32_bf16 v[92:95], v[84:87], a[12:15], v[92:95]
    v_exp_f32 v100, v100
    v_mfma_f32_16x16x32_bf16 v[164:167], v[112:115], v[104:107], v[164:167]
    v_exp_f32 v101, v101
    v_mfma_f32_16x16x32_bf16 v[192:195], v[116:119], v[104:107], v[192:195]
    v_add_f32 v24, v24, v98
    v_add_f32 v25, v25, v99
    v_mfma_f32_16x16x32_bf16 v[220:223], v[120:123], v[104:107], v[220:223]
    v_cvt_pk_bf16_f32 v109, v98, v99
    v_mfma_f32_16x16x32_bf16 v[248:251], v[124:127], v[104:107], v[248:251]
    v_exp_f32 v102, v102
    v_mfma_f32_16x16x32_bf16 a[132:135], v[128:131], v[104:107], a[132:135]
    v_exp_f32 v103, v103
    v_mfma_f32_16x16x32_bf16 a[160:163], v[132:135], v[104:107], a[160:163]
    v_add_f32 v24, v24, v100
    v_add_f32 v25, v25, v101
    v_mfma_f32_16x16x32_bf16 a[188:191], v[136:139], v[104:107], a[188:191]
    v_cvt_pk_bf16_f32 v110, v100, v101
    v_add_f32 v24, v24, v102
    v_mfma_f32_16x16x32_bf16 a[216:219], v[140:143], v[104:107], a[216:219]
    v_add_f32 v25, v25, v103
    v_cvt_pk_bf16_f32 v111, v102, v103
    v_mfma_f32_16x16x32_bf16 v[96:99], v[56:59], a[16:19], v[32:35]
    v_mfma_f32_16x16x32_bf16 v[96:99], v[60:63], a[20:23], v[96:99]
    v_exp_f32 v88, v88
    v_mfma_f32_16x16x32_bf16 v[96:99], v[64:67], a[24:27], v[96:99]
    v_exp_f32 v89, v89
    v_mfma_f32_16x16x32_bf16 v[96:99], v[68:71], a[28:31], v[96:99]
    v_exp_f32 v90, v90
    v_mfma_f32_16x16x32_bf16 v[100:103], v[72:75], a[16:19], v[32:35]
    v_exp_f32 v91, v91
    v_mfma_f32_16x16x32_bf16 v[100:103], v[76:79], a[20:23], v[100:103]
    v_add_f32 v12, v12, v88
    v_add_f32 v13, v13, v89
    v_mfma_f32_16x16x32_bf16 v[100:103], v[80:83], a[24:27], v[100:103]
    v_cvt_pk_bf16_f32 v104, v88, v89
    v_mfma_f32_16x16x32_bf16 v[100:103], v[84:87], a[28:31], v[100:103]
    v_exp_f32 v92, v92
    v_mfma_f32_16x16x32_bf16 v[168:171], v[112:115], v[108:111], v[168:171]
    ds_read_b64_tr_b16 v[112:113], v9 offset:0
    ds_read_b64_tr_b16 v[114:115], v9 offset:512
    v_exp_f32 v93, v93
    v_mfma_f32_16x16x32_bf16 v[196:199], v[116:119], v[108:111], v[196:199]
    ds_read_b64_tr_b16 v[116:117], v9 offset:32
    ds_read_b64_tr_b16 v[118:119], v9 offset:544
    v_add_f32 v12, v12, v90
    v_add_f32 v13, v13, v91
    v_mfma_f32_16x16x32_bf16 v[224:227], v[120:123], v[108:111], v[224:227]
    ds_read_b64_tr_b16 v[120:121], v9 offset:64
    ds_read_b64_tr_b16 v[122:123], v9 offset:576
    v_cvt_pk_bf16_f32 v105, v90, v91
    v_mfma_f32_16x16x32_bf16 v[252:255], v[124:127], v[108:111], v[252:255]
    ds_read_b64_tr_b16 v[124:125], v9 offset:96
    ds_read_b64_tr_b16 v[126:127], v9 offset:608
    v_exp_f32 v94, v94
    v_mfma_f32_16x16x32_bf16 a[136:139], v[128:131], v[108:111], a[136:139]
    ds_read_b64_tr_b16 v[128:129], v9 offset:128
    ds_read_b64_tr_b16 v[130:131], v9 offset:640
    v_exp_f32 v95, v95
    v_mfma_f32_16x16x32_bf16 a[164:167], v[132:135], v[108:111], a[164:167]
    ds_read_b64_tr_b16 v[132:133], v9 offset:160
    ds_read_b64_tr_b16 v[134:135], v9 offset:672
    v_add_f32 v12, v12, v92
    v_add_f32 v13, v13, v93
    v_mfma_f32_16x16x32_bf16 a[192:195], v[136:139], v[108:111], a[192:195]
    ds_read_b64_tr_b16 v[136:137], v9 offset:192
    ds_read_b64_tr_b16 v[138:139], v9 offset:704
    v_cvt_pk_bf16_f32 v106, v92, v93
    v_add_f32 v12, v12, v94
    v_mfma_f32_16x16x32_bf16 a[220:223], v[140:143], v[108:111], a[220:223]
    ds_read_b64_tr_b16 v[140:141], v9 offset:224
    ds_read_b64_tr_b16 v[142:143], v9 offset:736
    v_add_f32 v13, v13, v95
    v_cvt_pk_bf16_f32 v107, v94, v95
    v_mfma_f32_16x16x32_bf16 v[88:91], v[56:59], a[32:35], v[36:39]
    v_mfma_f32_16x16x32_bf16 v[88:91], v[60:63], a[36:39], v[88:91]
    s_add_u32 s29, s34, s100
    v_exp_f32 v96, v96
    v_mfma_f32_16x16x32_bf16 v[88:91], v[64:67], a[40:43], v[88:91]
    v_exp_f32 v97, v97
    v_mfma_f32_16x16x32_bf16 v[88:91], v[68:71], a[44:47], v[88:91]
    s_bfe_u32 s28, s29, 0x20003
    v_exp_f32 v98, v98
    v_mfma_f32_16x16x32_bf16 v[92:95], v[72:75], a[32:35], v[36:39]
    v_exp_f32 v99, v99
    v_mfma_f32_16x16x32_bf16 v[92:95], v[76:79], a[36:39], v[92:95]
    s_lshl_b32 s28, s28, 16
    v_add_f32 v14, v14, v96
    v_add_f32 v15, v15, v97
    v_mfma_f32_16x16x32_bf16 v[92:95], v[80:83], a[40:43], v[92:95]
    v_cvt_pk_bf16_f32 v108, v96, v97
    v_mfma_f32_16x16x32_bf16 v[92:95], v[84:87], a[44:47], v[92:95]
    v_exp_f32 v100, v100
    s_waitcnt lgkmcnt(0)
    v_mfma_f32_16x16x32_bf16 v[144:147], v[112:115], v[104:107], v[144:147]
    s_and_b32 s29, s29, 7
    v_exp_f32 v101, v101
    v_mfma_f32_16x16x32_bf16 v[172:175], v[116:119], v[104:107], v[172:175]
    v_add_f32 v14, v14, v98
    v_add_f32 v15, v15, v99
    v_mfma_f32_16x16x32_bf16 v[200:203], v[120:123], v[104:107], v[200:203]
    s_lshl_b32 s29, s29, 11
    v_cvt_pk_bf16_f32 v109, v98, v99
    v_mfma_f32_16x16x32_bf16 v[228:231], v[124:127], v[104:107], v[228:231]
    v_exp_f32 v102, v102
    v_mfma_f32_16x16x32_bf16 a[112:115], v[128:131], v[104:107], a[112:115]
    s_add_u32 s29, s28, s29
    v_exp_f32 v103, v103
    v_mfma_f32_16x16x32_bf16 a[140:143], v[132:135], v[104:107], a[140:143]
    v_add_f32 v14, v14, v100
    v_add_f32 v15, v15, v101
    v_mfma_f32_16x16x32_bf16 a[168:171], v[136:139], v[104:107], a[168:171]
    s_lshr_b32 s28, s34, 5
    v_cvt_pk_bf16_f32 v110, v100, v101
    v_add_f32 v14, v14, v102
    v_mfma_f32_16x16x32_bf16 a[196:199], v[140:143], v[104:107], a[196:199]
    v_add_f32 v15, v15, v103
    v_cvt_pk_bf16_f32 v111, v102, v103
    v_mfma_f32_16x16x32_bf16 v[96:99], v[56:59], a[48:51], v[40:43]
    v_mfma_f32_16x16x32_bf16 v[96:99], v[60:63], a[52:55], v[96:99]
    s_lshl_b32 s28, s28, 19
    v_exp_f32 v88, v88
    v_mfma_f32_16x16x32_bf16 v[96:99], v[64:67], a[56:59], v[96:99]
    v_exp_f32 v89, v89
    v_mfma_f32_16x16x32_bf16 v[96:99], v[68:71], a[60:63], v[96:99]
    s_add_u32 s49, s28, s29
    v_exp_f32 v90, v90
    v_mfma_f32_16x16x32_bf16 v[100:103], v[72:75], a[48:51], v[40:43]
    v_exp_f32 v91, v91
    v_mfma_f32_16x16x32_bf16 v[100:103], v[76:79], a[52:55], v[100:103]
    s_add_u32 m0, s33, 25344
    v_add_f32 v16, v16, v88
    v_add_f32 v17, v17, v89
    v_mfma_f32_16x16x32_bf16 v[100:103], v[80:83], a[56:59], v[100:103]
    v_cvt_pk_bf16_f32 v104, v88, v89
    v_mfma_f32_16x16x32_bf16 v[100:103], v[84:87], a[60:63], v[100:103]
    v_exp_f32 v92, v92
    v_mfma_f32_16x16x32_bf16 v[148:151], v[112:115], v[108:111], v[148:151]
    s_add_u32 s34, s34, 1
    v_exp_f32 v93, v93
    v_mfma_f32_16x16x32_bf16 v[176:179], v[116:119], v[108:111], v[176:179]
    v_add_f32 v16, v16, v90
    v_add_f32 v17, v17, v91
    v_mfma_f32_16x16x32_bf16 v[204:207], v[120:123], v[108:111], v[204:207]
    buffer_load_dwordx4 v7, s[4:7], s49 offen offset:0 nt lds
    v_cvt_pk_bf16_f32 v105, v90, v91
    v_mfma_f32_16x16x32_bf16 v[232:235], v[124:127], v[108:111], v[232:235]
    v_exp_f32 v94, v94
    v_mfma_f32_16x16x32_bf16 a[116:119], v[128:131], v[108:111], a[116:119]
    s_add_u32 m0, m0, s96
    v_exp_f32 v95, v95
    v_mfma_f32_16x16x32_bf16 a[144:147], v[132:135], v[108:111], a[144:147]
    v_add_f32 v16, v16, v92
    v_add_f32 v17, v17, v93
    v_mfma_f32_16x16x32_bf16 a[172:175], v[136:139], v[108:111], a[172:175]
    buffer_load_dwordx4 v7, s[4:7], s49 offen offset:256 nt lds
    v_cvt_pk_bf16_f32 v106, v92, v93
    v_add_f32 v16, v16, v94
    v_mfma_f32_16x16x32_bf16 a[200:203], v[140:143], v[108:111], a[200:203]
    v_add_f32 v17, v17, v95
    v_cvt_pk_bf16_f32 v107, v94, v95
    v_mfma_f32_16x16x32_bf16 v[88:91], v[56:59], a[64:67], v[44:47]
    v_mfma_f32_16x16x32_bf16 v[88:91], v[60:63], a[68:71], v[88:91]
    s_add_u32 m0, m0, s97
    v_exp_f32 v96, v96
    v_mfma_f32_16x16x32_bf16 v[88:91], v[64:67], a[72:75], v[88:91]
    v_exp_f32 v97, v97
    v_mfma_f32_16x16x32_bf16 v[88:91], v[68:71], a[76:79], v[88:91]
    buffer_load_dwordx4 v7, s[4:7], s49 offen offset:512 nt lds
    v_exp_f32 v98, v98
    v_mfma_f32_16x16x32_bf16 v[92:95], v[72:75], a[64:67], v[44:47]
    v_exp_f32 v99, v99
    v_mfma_f32_16x16x32_bf16 v[92:95], v[76:79], a[68:71], v[92:95]
    s_add_u32 m0, m0, s96
    v_add_f32 v18, v18, v96
    v_add_f32 v19, v19, v97
    v_mfma_f32_16x16x32_bf16 v[92:95], v[80:83], a[72:75], v[92:95]
    v_cvt_pk_bf16_f32 v108, v96, v97
    v_mfma_f32_16x16x32_bf16 v[92:95], v[84:87], a[76:79], v[92:95]
    v_exp_f32 v100, v100
    v_mfma_f32_16x16x32_bf16 v[152:155], v[112:115], v[104:107], v[152:155]
    buffer_load_dwordx4 v7, s[4:7], s49 offen offset:768 nt lds
    v_exp_f32 v101, v101
    v_mfma_f32_16x16x32_bf16 v[180:183], v[116:119], v[104:107], v[180:183]
    v_add_f32 v18, v18, v98
    v_add_f32 v19, v19, v99
    v_mfma_f32_16x16x32_bf16 v[208:211], v[120:123], v[104:107], v[208:211]
    s_add_u32 m0, m0, s97
    v_cvt_pk_bf16_f32 v109, v98, v99
    v_mfma_f32_16x16x32_bf16 v[236:239], v[124:127], v[104:107], v[236:239]
    v_exp_f32 v102, v102
    v_mfma_f32_16x16x32_bf16 a[120:123], v[128:131], v[104:107], a[120:123]
    buffer_load_dwordx4 v7, s[4:7], s49 offen offset:1024 nt lds
    v_exp_f32 v103, v103
    v_mfma_f32_16x16x32_bf16 a[148:151], v[132:135], v[104:107], a[148:151]
    v_add_f32 v18, v18, v100
    v_add_f32 v19, v19, v101
    v_mfma_f32_16x16x32_bf16 a[176:179], v[136:139], v[104:107], a[176:179]
    s_add_u32 m0, m0, s96
    v_cvt_pk_bf16_f32 v110, v100, v101
    v_add_f32 v18, v18, v102
    v_mfma_f32_16x16x32_bf16 a[204:207], v[140:143], v[104:107], a[204:207]
    v_add_f32 v19, v19, v103
    v_cvt_pk_bf16_f32 v111, v102, v103
    v_mfma_f32_16x16x32_bf16 v[96:99], v[56:59], a[80:83], v[48:51]
    v_mfma_f32_16x16x32_bf16 v[96:99], v[60:63], a[84:87], v[96:99]
    buffer_load_dwordx4 v7, s[4:7], s49 offen offset:1280 nt lds
    v_exp_f32 v88, v88
    v_mfma_f32_16x16x32_bf16 v[96:99], v[64:67], a[88:91], v[96:99]
    v_exp_f32 v89, v89
    v_mfma_f32_16x16x32_bf16 v[96:99], v[68:71], a[92:95], v[96:99]
    s_add_u32 m0, m0, s97
    v_exp_f32 v90, v90
    v_mfma_f32_16x16x32_bf16 v[100:103], v[72:75], a[80:83], v[48:51]
    v_exp_f32 v91, v91
    v_mfma_f32_16x16x32_bf16 v[100:103], v[76:79], a[84:87], v[100:103]
    buffer_load_dwordx4 v7, s[4:7], s49 offen offset:1536 nt lds
    v_add_f32 v20, v20, v88
    v_add_f32 v21, v21, v89
    v_mfma_f32_16x16x32_bf16 v[100:103], v[80:83], a[88:91], v[100:103]
    v_cvt_pk_bf16_f32 v104, v88, v89
    v_mfma_f32_16x16x32_bf16 v[100:103], v[84:87], a[92:95], v[100:103]
    v_exp_f32 v92, v92
    v_mfma_f32_16x16x32_bf16 v[156:159], v[112:115], v[108:111], v[156:159]
    s_add_u32 m0, m0, s96
    v_exp_f32 v93, v93
    v_mfma_f32_16x16x32_bf16 v[184:187], v[116:119], v[108:111], v[184:187]
    v_add_f32 v20, v20, v90
    v_add_f32 v21, v21, v91
    v_mfma_f32_16x16x32_bf16 v[212:215], v[120:123], v[108:111], v[212:215]
    buffer_load_dwordx4 v7, s[4:7], s49 offen offset:1792 nt lds
    v_cvt_pk_bf16_f32 v105, v90, v91
    v_mfma_f32_16x16x32_bf16 v[240:243], v[124:127], v[108:111], v[240:243]
    v_exp_f32 v94, v94
    v_mfma_f32_16x16x32_bf16 a[124:127], v[128:131], v[108:111], a[124:127]
    v_exp_f32 v95, v95
    v_mfma_f32_16x16x32_bf16 a[152:155], v[132:135], v[108:111], a[152:155]
    v_add_f32 v20, v20, v92
    v_add_f32 v21, v21, v93
    v_mfma_f32_16x16x32_bf16 a[180:183], v[136:139], v[108:111], a[180:183]
    v_cvt_pk_bf16_f32 v106, v92, v93
    v_add_f32 v20, v20, v94
    v_mfma_f32_16x16x32_bf16 a[208:211], v[140:143], v[108:111], a[208:211]
    v_add_f32 v21, v21, v95
    v_cvt_pk_bf16_f32 v107, v94, v95
    s_waitcnt vmcnt(16) lgkmcnt(0)
    s_barrier
    v_mfma_f32_16x16x32_bf16 v[88:91], v[56:59], a[96:99], v[52:55]
    ds_read_b128 v[56:59], v8 offset:8448
    v_mfma_f32_16x16x32_bf16 v[88:91], v[60:63], a[100:103], v[88:91]
    ds_read_b128 v[60:63], v8 offset:8512
    v_exp_f32 v96, v96
    v_mfma_f32_16x16x32_bf16 v[88:91], v[64:67], a[104:107], v[88:91]
    ds_read_b128 v[64:67], v8 offset:8576
    v_exp_f32 v97, v97
    v_mfma_f32_16x16x32_bf16 v[88:91], v[68:71], a[108:111], v[88:91]
    ds_read_b128 v[68:71], v8 offset:8640
    v_exp_f32 v98, v98
    v_mfma_f32_16x16x32_bf16 v[92:95], v[72:75], a[96:99], v[52:55]
    ds_read_b128 v[72:75], v8 offset:8960
    v_exp_f32 v99, v99
    v_mfma_f32_16x16x32_bf16 v[92:95], v[76:79], a[100:103], v[92:95]
    ds_read_b128 v[76:79], v8 offset:9024
    v_add_f32 v22, v22, v96
    v_add_f32 v23, v23, v97
    v_mfma_f32_16x16x32_bf16 v[92:95], v[80:83], a[104:107], v[92:95]
    ds_read_b128 v[80:83], v8 offset:9088
    v_cvt_pk_bf16_f32 v108, v96, v97
    v_mfma_f32_16x16x32_bf16 v[92:95], v[84:87], a[108:111], v[92:95]
    ds_read_b128 v[84:87], v8 offset:9152
    v_exp_f32 v100, v100
    v_mfma_f32_16x16x32_bf16 v[160:163], v[112:115], v[104:107], v[160:163]
    v_exp_f32 v101, v101
    v_mfma_f32_16x16x32_bf16 v[188:191], v[116:119], v[104:107], v[188:191]
    v_add_f32 v22, v22, v98
    v_add_f32 v23, v23, v99
    v_mfma_f32_16x16x32_bf16 v[216:219], v[120:123], v[104:107], v[216:219]
    v_cvt_pk_bf16_f32 v109, v98, v99
    v_mfma_f32_16x16x32_bf16 v[244:247], v[124:127], v[104:107], v[244:247]
    v_exp_f32 v102, v102
    v_mfma_f32_16x16x32_bf16 a[128:131], v[128:131], v[104:107], a[128:131]
    v_exp_f32 v103, v103
    v_mfma_f32_16x16x32_bf16 a[156:159], v[132:135], v[104:107], a[156:159]
    v_add_f32 v22, v22, v100
    v_add_f32 v23, v23, v101
    v_mfma_f32_16x16x32_bf16 a[184:187], v[136:139], v[104:107], a[184:187]
    v_cvt_pk_bf16_f32 v110, v100, v101
    v_add_f32 v22, v22, v102
    v_mfma_f32_16x16x32_bf16 a[212:215], v[140:143], v[104:107], a[212:215]
    v_add_f32 v23, v23, v103
    v_cvt_pk_bf16_f32 v111, v102, v103
    s_waitcnt lgkmcnt(0)
    v_mfma_f32_16x16x32_bf16 v[96:99], v[56:59], a[0:3], v[28:31]
    v_mfma_f32_16x16x32_bf16 v[96:99], v[60:63], a[4:7], v[96:99]
    v_exp_f32 v88, v88
    v_mfma_f32_16x16x32_bf16 v[96:99], v[64:67], a[8:11], v[96:99]
    v_exp_f32 v89, v89
    v_mfma_f32_16x16x32_bf16 v[96:99], v[68:71], a[12:15], v[96:99]
    v_exp_f32 v90, v90
    v_mfma_f32_16x16x32_bf16 v[100:103], v[72:75], a[0:3], v[28:31]
    v_exp_f32 v91, v91
    v_mfma_f32_16x16x32_bf16 v[100:103], v[76:79], a[4:7], v[100:103]
    v_add_f32 v24, v24, v88
    v_add_f32 v25, v25, v89
    v_mfma_f32_16x16x32_bf16 v[100:103], v[80:83], a[8:11], v[100:103]
    v_cvt_pk_bf16_f32 v104, v88, v89
    v_mfma_f32_16x16x32_bf16 v[100:103], v[84:87], a[12:15], v[100:103]
    v_exp_f32 v92, v92
    v_mfma_f32_16x16x32_bf16 v[164:167], v[112:115], v[108:111], v[164:167]
    v_exp_f32 v93, v93
    v_mfma_f32_16x16x32_bf16 v[192:195], v[116:119], v[108:111], v[192:195]
    v_add_f32 v24, v24, v90
    v_add_f32 v25, v25, v91
    v_mfma_f32_16x16x32_bf16 v[220:223], v[120:123], v[108:111], v[220:223]
    v_cvt_pk_bf16_f32 v105, v90, v91
    v_mfma_f32_16x16x32_bf16 v[248:251], v[124:127], v[108:111], v[248:251]
    v_exp_f32 v94, v94
    v_mfma_f32_16x16x32_bf16 a[132:135], v[128:131], v[108:111], a[132:135]
    v_exp_f32 v95, v95
    v_mfma_f32_16x16x32_bf16 a[160:163], v[132:135], v[108:111], a[160:163]
    v_add_f32 v24, v24, v92
    v_add_f32 v25, v25, v93
    v_mfma_f32_16x16x32_bf16 a[188:191], v[136:139], v[108:111], a[188:191]
    v_cvt_pk_bf16_f32 v106, v92, v93
    v_add_f32 v24, v24, v94
    v_mfma_f32_16x16x32_bf16 a[216:219], v[140:143], v[108:111], a[216:219]
    v_add_f32 v25, v25, v95
    v_cvt_pk_bf16_f32 v107, v94, v95
    s_add_u32 s22, s22, 1
    s_cmp_lt_u32 s22, 6
    s_cbranch_scc1 L_at_loop
    s_add_u32 s21, s21, 1
    v_mfma_f32_16x16x32_bf16 v[88:91], v[56:59], a[16:19], v[32:35]
    v_mfma_f32_16x16x32_bf16 v[88:91], v[60:63], a[20:23], v[88:91]
    v_exp_f32 v96, v96
    v_mfma_f32_16x16x32_bf16 v[88:91], v[64:67], a[24:27], v[88:91]
    v_exp_f32 v97, v97
    v_mfma_f32_16x16x32_bf16 v[88:91], v[68:71], a[28:31], v[88:91]
    v_exp_f32 v98, v98
    v_mfma_f32_16x16x32_bf16 v[92:95], v[72:75], a[16:19], v[32:35]
    v_exp_f32 v99, v99
    v_mfma_f32_16x16x32_bf16 v[92:95], v[76:79], a[20:23], v[92:95]
    v_add_f32 v12, v12, v96
    v_add_f32 v13, v13, v97
    v_mfma_f32_16x16x32_bf16 v[92:95], v[80:83], a[24:27], v[92:95]
    v_cvt_pk_bf16_f32 v108, v96, v97
    v_mfma_f32_16x16x32_bf16 v[92:95], v[84:87], a[28:31], v[92:95]
    v_exp_f32 v100, v100
    v_mfma_f32_16x16x32_bf16 v[168:171], v[112:115], v[104:107], v[168:171]
    ds_read_b64_tr_b16 v[112:113], v9 offset:8448
    ds_read_b64_tr_b16 v[114:115], v9 offset:8960
    v_exp_f32 v101, v101
    v_mfma_f32_16x16x32_bf16 v[196:199], v[116:119], v[104:107], v[196:199]
    ds_read_b64_tr_b16 v[116:117], v9 offset:8480
    ds_read_b64_tr_b16 v[118:119], v9 offset:8992
    v_add_f32 v12, v12, v98
    v_add_f32 v13, v13, v99
    v_mfma_f32_16x16x32_bf16 v[224:227], v[120:123], v[104:107], v[224:227]
    ds_read_b64_tr_b16 v[120:121], v9 offset:8512
    ds_read_b64_tr_b16 v[122:123], v9 offset:9024
    v_cvt_pk_bf16_f32 v109, v98, v99
    v_mfma_f32_16x16x32_bf16 v[252:255], v[124:127], v[104:107], v[252:255]
    ds_read_b64_tr_b16 v[124:125], v9 offset:8544
    ds_read_b64_tr_b16 v[126:127], v9 offset:9056
    v_exp_f32 v102, v102
    v_mfma_f32_16x16x32_bf16 a[136:139], v[128:131], v[104:107], a[136:139]
    ds_read_b64_tr_b16 v[128:129], v9 offset:8576
    ds_read_b64_tr_b16 v[130:131], v9 offset:9088
    v_exp_f32 v103, v103
    v_mfma_f32_16x16x32_bf16 a[164:167], v[132:135], v[104:107], a[164:167]
    ds_read_b64_tr_b16 v[132:133], v9 offset:8608
    ds_read_b64_tr_b16 v[134:135], v9 offset:9120
    v_add_f32 v12, v12, v100
    v_add_f32 v13, v13, v101
    v_mfma_f32_16x16x32_bf16 a[192:195], v[136:139], v[104:107], a[192:195]
    ds_read_b64_tr_b16 v[136:137], v9 offset:8640
    ds_read_b64_tr_b16 v[138:139], v9 offset:9152
    v_cvt_pk_bf16_f32 v110, v100, v101
    v_add_f32 v12, v12, v102
    v_mfma_f32_16x16x32_bf16 a[220:223], v[140:143], v[104:107], a[220:223]
    ds_read_b64_tr_b16 v[140:141], v9 offset:8672
    ds_read_b64_tr_b16 v[142:143], v9 offset:9184
    v_add_f32 v13, v13, v103
    v_cvt_pk_bf16_f32 v111, v102, v103
    v_mfma_f32_16x16x32_bf16 v[96:99], v[56:59], a[32:35], v[36:39]
    v_mfma_f32_16x16x32_bf16 v[96:99], v[60:63], a[36:39], v[96:99]
    s_add_u32 s29, s34, s100
    v_exp_f32 v88, v88
    v_mfma_f32_16x16x32_bf16 v[96:99], v[64:67], a[40:43], v[96:99]
    v_exp_f32 v89, v89
    v_mfma_f32_16x16x32_bf16 v[96:99], v[68:71], a[44:47], v[96:99]
    s_bfe_u32 s28, s29, 0x20003
    v_exp_f32 v90, v90
    v_mfma_f32_16x16x32_bf16 v[100:103], v[72:75], a[32:35], v[36:39]
    v_exp_f32 v91, v91
    v_mfma_f32_16x16x32_bf16 v[100:103], v[76:79], a[36:39], v[100:103]
    s_lshl_b32 s28, s28, 16
    v_add_f32 v14, v14, v88
    v_add_f32 v15, v15, v89
    v_mfma_f32_16x16x32_bf16 v[100:103], v[80:83], a[40:43], v[100:103]
    v_cvt_pk_bf16_f32 v104, v88, v89
    v_mfma_f32_16x16x32_bf16 v[100:103], v[84:87], a[44:47], v[100:103]
    v_exp_f32 v92, v92
    s_waitcnt lgkmcnt(0)
    v_mfma_f32_16x16x32_bf16 v[144:147], v[112:115], v[108:111], v[144:147]
    s_and_b32 s29, s29, 7
    v_exp_f32 v93, v93
    v_mfma_f32_16x16x32_bf16 v[172:175], v[116:119], v[108:111], v[172:175]
    v_add_f32 v14, v14, v90
    v_add_f32 v15, v15, v91
    v_mfma_f32_16x16x32_bf16 v[200:203], v[120:123], v[108:111], v[200:203]
    s_lshl_b32 s29, s29, 11
    v_cvt_pk_bf16_f32 v105, v90, v91
    v_mfma_f32_16x16x32_bf16 v[228:231], v[124:127], v[108:111], v[228:231]
    v_exp_f32 v94, v94
    v_mfma_f32_16x16x32_bf16 a[112:115], v[128:131], v[108:111], a[112:115]
    s_add_u32 s29, s28, s29
    v_exp_f32 v95, v95
    v_mfma_f32_16x16x32_bf16 a[140:143], v[132:135], v[108:111], a[140:143]
    v_add_f32 v14, v14, v92
    v_add_f32 v15, v15, v93
    v_mfma_f32_16x16x32_bf16 a[168:171], v[136:139], v[108:111], a[168:171]
    s_lshr_b32 s28, s34, 5
    v_cvt_pk_bf16_f32 v106, v92, v93
    v_add_f32 v14, v14, v94
    v_mfma_f32_16x16x32_bf16 a[196:199], v[140:143], v[108:111], a[196:199]
    v_add_f32 v15, v15, v95
    v_cvt_pk_bf16_f32 v107, v94, v95
    v_mfma_f32_16x16x32_bf16 v[88:91], v[56:59], a[48:51], v[40:43]
    v_mfma_f32_16x16x32_bf16 v[88:91], v[60:63], a[52:55], v[88:91]
    s_lshl_b32 s28, s28, 19
    v_exp_f32 v96, v96
    v_mfma_f32_16x16x32_bf16 v[88:91], v[64:67], a[56:59], v[88:91]
    v_exp_f32 v97, v97
    v_mfma_f32_16x16x32_bf16 v[88:91], v[68:71], a[60:63], v[88:91]
    s_add_u32 s49, s28, s29
    v_exp_f32 v98, v98
    v_mfma_f32_16x16x32_bf16 v[92:95], v[72:75], a[48:51], v[40:43]
    v_exp_f32 v99, v99
    v_mfma_f32_16x16x32_bf16 v[92:95], v[76:79], a[52:55], v[92:95]
    s_add_u32 m0, s33, 0
    v_add_f32 v16, v16, v96
    v_add_f32 v17, v17, v97
    v_mfma_f32_16x16x32_bf16 v[92:95], v[80:83], a[56:59], v[92:95]
    v_cvt_pk_bf16_f32 v108, v96, v97
    v_mfma_f32_16x16x32_bf16 v[92:95], v[84:87], a[60:63], v[92:95]
    v_exp_f32 v100, v100
    v_mfma_f32_16x16x32_bf16 v[148:151], v[112:115], v[104:107], v[148:151]
    s_add_u32 s34, s34, 1
    v_exp_f32 v101, v101
    v_mfma_f32_16x16x32_bf16 v[176:179], v[116:119], v[104:107], v[176:179]
    v_add_f32 v16, v16, v98
    v_add_f32 v17, v17, v99
    v_mfma_f32_16x16x32_bf16 v[204:207], v[120:123], v[104:107], v[204:207]
    buffer_load_dwordx4 v7, s[4:7], s49 offen offset:0 nt lds
    v_cvt_pk_bf16_f32 v109, v98, v99
    v_mfma_f32_16x16x32_bf16 v[232:235], v[124:127], v[104:107], v[232:235]
    v_exp_f32 v102, v102
    v_mfma_f32_16x16x32_bf16 a[116:119], v[128:131], v[104:107], a[116:119]
    s_add_u32 m0, m0, s96
    v_exp_f32 v103, v103
    v_mfma_f32_16x16x32_bf16 a[144:147], v[132:135], v[104:107], a[144:147]
    v_add_f32 v16, v16, v100
    v_add_f32 v17, v17, v101
    v_mfma_f32_16x16x32_bf16 a[172:175], v[136:139], v[104:107], a[172:175]
    buffer_load_dwordx4 v7, s[4:7], s49 offen offset:256 nt lds
    v_cvt_pk_bf16_f32 v110, v100, v101
    v_add_f32 v16, v16, v102
    v_mfma_f32_16x16x32_bf16 a[200:203], v[140:143], v[104:107], a[200:203]
    v_add_f32 v17, v17, v103
    v_cvt_pk_bf16_f32 v111, v102, v103
    v_mfma_f32_16x16x32_bf16 v[96:99], v[56:59], a[64:67], v[44:47]
    v_mfma_f32_16x16x32_bf16 v[96:99], v[60:63], a[68:71], v[96:99]
    s_add_u32 m0, m0, s97
    v_exp_f32 v88, v88
    v_mfma_f32_16x16x32_bf16 v[96:99], v[64:67], a[72:75], v[96:99]
    v_exp_f32 v89, v89
    v_mfma_f32_16x16x32_bf16 v[96:99], v[68:71], a[76:79], v[96:99]
    buffer_load_dwordx4 v7, s[4:7], s49 offen offset:512 nt lds
    v_exp_f32 v90, v90
    v_mfma_f32_16x16x32_bf16 v[100:103], v[72:75], a[64:67], v[44:47]
    v_exp_f32 v91, v91
    v_mfma_f32_16x16x32_bf16 v[100:103], v[76:79], a[68:71], v[100:103]
    s_add_u32 m0, m0, s96
    v_add_f32 v18, v18, v88
    v_add_f32 v19, v19, v89
    v_mfma_f32_16x16x32_bf16 v[100:103], v[80:83], a[72:75], v[100:103]
    v_cvt_pk_bf16_f32 v104, v88, v89
    v_mfma_f32_16x16x32_bf16 v[100:103], v[84:87], a[76:79], v[100:103]
    v_exp_f32 v92, v92
    v_mfma_f32_16x16x32_bf16 v[152:155], v[112:115], v[108:111], v[152:155]
    buffer_load_dwordx4 v7, s[4:7], s49 offen offset:768 nt lds
    v_exp_f32 v93, v93
    v_mfma_f32_16x16x32_bf16 v[180:183], v[116:119], v[108:111], v[180:183]
    v_add_f32 v18, v18, v90
    v_add_f32 v19, v19, v91
    v_mfma_f32_16x16x32_bf16 v[208:211], v[120:123], v[108:111], v[208:211]
    s_add_u32 m0, m0, s97
    v_cvt_pk_bf16_f32 v105, v90, v91
    v_mfma_f32_16x16x32_bf16 v[236:239], v[124:127], v[108:111], v[236:239]
    v_exp_f32 v94, v94
    v_mfma_f32_16x16x32_bf16 a[120:123], v[128:131], v[108:111], a[120:123]
    buffer_load_dwordx4 v7, s[4:7], s49 offen offset:1024 nt lds
    v_exp_f32 v95, v95
    v_mfma_f32_16x16x32_bf16 a[148:151], v[132:135], v[108:111], a[148:151]
    v_add_f32 v18, v18, v92
    v_add_f32 v19, v19, v93
    v_mfma_f32_16x16x32_bf16 a[176:179], v[136:139], v[108:111], a[176:179]
    s_add_u32 m0, m0, s96
    v_cvt_pk_bf16_f32 v106, v92, v93
    v_add_f32 v18, v18, v94
    v_mfma_f32_16x16x32_bf16 a[204:207], v[140:143], v[108:111], a[204:207]
    v_add_f32 v19, v19, v95
    v_cvt_pk_bf16_f32 v107, v94, v95
    v_mfma_f32_16x16x32_bf16 v[88:91], v[56:59], a[80:83], v[48:51]
    v_mfma_f32_16x16x32_bf16 v[88:91], v[60:63], a[84:87], v[88:91]
    buffer_load_dwordx4 v7, s[4:7], s49 offen offset:1280 nt lds
    v_exp_f32 v96, v96
    v_mfma_f32_16x16x32_bf16 v[88:91], v[64:67], a[88:91], v[88:91]
    v_exp_f32 v97, v97
    v_mfma_f32_16x16x32_bf16 v[88:91], v[68:71], a[92:95], v[88:91]
    s_add_u32 m0, m0, s97
    v_exp_f32 v98, v98
    v_mfma_f32_16x16x32_bf16 v[92:95], v[72:75], a[80:83], v[48:51]
    v_exp_f32 v99, v99
    v_mfma_f32_16x16x32_bf16 v[92:95], v[76:79], a[84:87], v[92:95]
    buffer_load_dwordx4 v7, s[4:7], s49 offen offset:1536 nt lds
    v_add_f32 v20, v20, v96
    v_add_f32 v21, v21, v97
    v_mfma_f32_16x16x32_bf16 v[92:95], v[80:83], a[88:91], v[92:95]
    v_cvt_pk_bf16_f32 v108, v96, v97
    v_mfma_f32_16x16x32_bf16 v[92:95], v[84:87], a[92:95], v[92:95]
    v_exp_f32 v100, v100
    v_mfma_f32_16x16x32_bf16 v[156:159], v[112:115], v[104:107], v[156:159]
    s_add_u32 m0, m0, s96
    v_exp_f32 v101, v101
    v_mfma_f32_16x16x32_bf16 v[184:187], v[116:119], v[104:107], v[184:187]
    v_add_f32 v20, v20, v98
    v_add_f32 v21, v21, v99
    v_mfma_f32_16x16x32_bf16 v[212:215], v[120:123], v[104:107], v[212:215]
    buffer_load_dwordx4 v7, s[4:7], s49 offen offset:1792 nt lds
    v_cvt_pk_bf16_f32 v109, v98, v99
    v_mfma_f32_16x16x32_bf16 v[240:243], v[124:127], v[104:107], v[240:243]
    v_exp_f32 v102, v102
    v_mfma_f32_16x16x32_bf16 a[124:127], v[128:131], v[104:107], a[124:127]
    v_exp_f32 v103, v103
    v_mfma_f32_16x16x32_bf16 a[152:155], v[132:135], v[104:107], a[152:155]
    v_add_f32 v20, v20, v100
    v_add_f32 v21, v21, v101
    v_mfma_f32_16x16x32_bf16 a[180:183], v[136:139], v[104:107], a[180:183]
    v_cvt_pk_bf16_f32 v110, v100, v101
    v_add_f32 v20, v20, v102
    v_mfma_f32_16x16x32_bf16 a[208:211], v[140:143], v[104:107], a[208:211]
    v_add_f32 v21, v21, v103
    v_cvt_pk_bf16_f32 v111, v102, v103
    s_waitcnt vmcnt(16) lgkmcnt(0)
    s_barrier
    v_mfma_f32_16x16x32_bf16 v[96:99], v[56:59], a[96:99], v[52:55]
    ds_read_b128 v[56:59], v8 offset:16896
    v_mfma_f32_16x16x32_bf16 v[96:99], v[60:63], a[100:103], v[96:99]
    ds_read_b128 v[60:63], v8 offset:16960
    v_exp_f32 v88, v88
    v_mfma_f32_16x16x32_bf16 v[96:99], v[64:67], a[104:107], v[96:99]
    ds_read_b128 v[64:67], v8 offset:17024
    v_exp_f32 v89, v89
    v_mfma_f32_16x16x32_bf16 v[96:99], v[68:71], a[108:111], v[96:99]
    ds_read_b128 v[68:71], v8 offset:17088
    v_exp_f32 v90, v90
    v_mfma_f32_16x16x32_bf16 v[100:103], v[72:75], a[96:99], v[52:55]
    ds_read_b128 v[72:75], v8 offset:17408
    v_exp_f32 v91, v91
    v_mfma_f32_16x16x32_bf16 v[100:103], v[76:79], a[100:103], v[100:103]
    ds_read_b128 v[76:79], v8 offset:17472
    v_add_f32 v22, v22, v88
    v_add_f32 v23, v23, v89
    v_mfma_f32_16x16x32_bf16 v[100:103], v[80:83], a[104:107], v[100:103]
    ds_read_b128 v[80:83], v8 offset:17536
    v_cvt_pk_bf16_f32 v104, v88, v89
    v_mfma_f32_16x16x32_bf16 v[100:103], v[84:87], a[108:111], v[100:103]
    ds_read_b128 v[84:87], v8 offset:17600
    v_exp_f32 v92, v92
    v_mfma_f32_16x16x32_bf16 v[160:163], v[112:115], v[108:111], v[160:163]
    v_exp_f32 v93, v93
    v_mfma_f32_16x16x32_bf16 v[188:191], v[116:119], v[108:111], v[188:191]
    v_add_f32 v22, v22, v90
    v_add_f32 v23, v23, v91
    v_mfma_f32_16x16x32_bf16 v[216:219], v[120:123], v[108:111], v[216:219]
    v_cvt_pk_bf16_f32 v105, v90, v91
    v_mfma_f32_16x16x32_bf16 v[244:247], v[124:127], v[108:111], v[244:247]
    v_exp_f32 v94, v94
    v_mfma_f32_16x16x32_bf16 a[128:131], v[128:131], v[108:111], a[128:131]
    v_exp_f32 v95, v95
    v_mfma_f32_16x16x32_bf16 a[156:159], v[132:135], v[108:111], a[156:159]
    v_add_f32 v22, v22, v92
    v_add_f32 v23, v23, v93
    v_mfma_f32_16x16x32_bf16 a[184:187], v[136:139], v[108:111], a[184:187]
    v_cvt_pk_bf16_f32 v106, v92, v93
    v_add_f32 v22, v22, v94
    v_mfma_f32_16x16x32_bf16 a[212:215], v[140:143], v[108:111], a[212:215]
    v_add_f32 v23, v23, v95
    v_cvt_pk_bf16_f32 v107, v94, v95
    s_waitcnt lgkmcnt(0)
    v_mfma_f32_16x16x32_bf16 v[88:91], v[56:59], a[0:3], v[28:31]
    v_mfma_f32_16x16x32_bf16 v[88:91], v[60:63], a[4:7], v[88:91]
    v_exp_f32 v96, v96
    v_mfma_f32_16x16x32_bf16 v[88:91], v[64:67], a[8:11], v[88:91]
    v_exp_f32 v97, v97
    v_mfma_f32_16x16x32_bf16 v[88:91], v[68:71], a[12:15], v[88:91]
    v_exp_f32 v98, v98
    v_mfma_f32_16x16x32_bf16 v[92:95], v[72:75], a[0:3], v[28:31]
    v_exp_f32 v99, v99
    v_mfma_f32_16x16x32_bf16 v[92:95], v[76:79], a[4:7], v[92:95]
    v_add_f32 v24, v24, v96
    v_add_f32 v25, v25, v97
    v_mfma_f32_16x16x32_bf16 v[92:95], v[80:83], a[8:11], v[92:95]
    v_cvt_pk_bf16_f32 v108, v96, v97
    v_mfma_f32_16x16x32_bf16 v[92:95], v[84:87], a[12:15], v[92:95]
    v_exp_f32 v100, v100
    v_mfma_f32_16x16x32_bf16 v[164:167], v[112:115], v[104:107], v[164:167]
    v_exp_f32 v101, v101
    v_mfma_f32_16x16x32_bf16 v[192:195], v[116:119], v[104:107], v[192:195]
    v_add_f32 v24, v24, v98
    v_add_f32 v25, v25, v99
    v_mfma_f32_16x16x32_bf16 v[220:223], v[120:123], v[104:107], v[220:223]
    v_cvt_pk_bf16_f32 v109, v98, v99
    v_mfma_f32_16x16x32_bf16 v[248:251], v[124:127], v[104:107], v[248:251]
    v_exp_f32 v102, v102
    v_mfma_f32_16x16x32_bf16 a[132:135], v[128:131], v[104:107], a[132:135]
    v_exp_f32 v103, v103
    v_mfma_f32_16x16x32_bf16 a[160:163], v[132:135], v[104:107], a[160:163]
    v_add_f32 v24, v24, v100
    v_add_f32 v25, v25, v101
    v_mfma_f32_16x16x32_bf16 a[188:191], v[136:139], v[104:107], a[188:191]
    v_cvt_pk_bf16_f32 v110, v100, v101
    v_add_f32 v24, v24, v102
    v_mfma_f32_16x16x32_bf16 a[216:219], v[140:143], v[104:107], a[216:219]
    v_add_f32 v25, v25, v103
    v_cvt_pk_bf16_f32 v111, v102, v103
    v_mfma_f32_16x16x32_bf16 v[96:99], v[56:59], a[16:19], v[32:35]
    v_mfma_f32_16x16x32_bf16 v[96:99], v[60:63], a[20:23], v[96:99]
    v_exp_f32 v88, v88
    v_mfma_f32_16x16x32_bf16 v[96:99], v[64:67], a[24:27], v[96:99]
    v_exp_f32 v89, v89
    v_mfma_f32_16x16x32_bf16 v[96:99], v[68:71], a[28:31], v[96:99]
    v_exp_f32 v90, v90
    v_mfma_f32_16x16x32_bf16 v[100:103], v[72:75], a[16:19], v[32:35]
    v_exp_f32 v91, v91
    v_mfma_f32_16x16x32_bf16 v[100:103], v[76:79], a[20:23], v[100:103]
    v_add_f32 v12, v12, v88
    v_add_f32 v13, v13, v89
    v_mfma_f32_16x16x32_bf16 v[100:103], v[80:83], a[24:27], v[100:103]
    v_cvt_pk_bf16_f32 v104, v88, v89
    v_mfma_f32_16x16x32_bf16 v[100:103], v[84:87], a[28:31], v[100:103]
    v_exp_f32 v92, v92
    v_mfma_f32_16x16x32_bf16 v[168:171], v[112:115], v[108:111], v[168:171]
    ds_read_b64_tr_b16 v[112:113], v9 offset:16896
    ds_read_b64_tr_b16 v[114:115], v9 offset:17408
    v_exp_f32 v93, v93
    v_mfma_f32_16x16x32_bf16 v[196:199], v[116:119], v[108:111], v[196:199]
    ds_read_b64_tr_b16 v[116:117], v9 offset:16928
    ds_read_b64_tr_b16 v[118:119], v9 offset:17440
    v_add_f32 v12, v12, v90
    v_add_f32 v13, v13, v91
    v_mfma_f32_16x16x32_bf16 v[224:227], v[120:123], v[108:111], v[224:227]
    ds_read_b64_tr_b16 v[120:121], v9 offset:16960
    ds_read_b64_tr_b16 v[122:123], v9 offset:17472
    v_cvt_pk_bf16_f32 v105, v90, v91
    v_mfma_f32_16x16x32_bf16 v[252:255], v[124:127], v[108:111], v[252:255]
    ds_read_b64_tr_b16 v[124:125], v9 offset:16992
    ds_read_b64_tr_b16 v[126:127], v9 offset:17504
    v_exp_f32 v94, v94
    v_mfma_f32_16x16x32_bf16 a[136:139], v[128:131], v[108:111], a[136:139]
    ds_read_b64_tr_b16 v[128:129], v9 offset:17024
    ds_read_b64_tr_b16 v[130:131], v9 offset:17536
    v_exp_f32 v95, v95
    v_mfma_f32_16x16x32_bf16 a[164:167], v[132:135], v[108:111], a[164:167]
    ds_read_b64_tr_b16 v[132:133], v9 offset:17056
    ds_read_b64_tr_b16 v[134:135], v9 offset:17568
    v_add_f32 v12, v12, v92
    v_add_f32 v13, v13, v93
    v_mfma_f32_16x16x32_bf16 a[192:195], v[136:139], v[108:111], a[192:195]
    ds_read_b64_tr_b16 v[136:137], v9 offset:17088
    ds_read_b64_tr_b16 v[138:139], v9 offset:17600
    v_cvt_pk_bf16_f32 v106, v92, v93
    v_add_f32 v12, v12, v94
    v_mfma_f32_16x16x32_bf16 a[220:223], v[140:143], v[108:111], a[220:223]
    ds_read_b64_tr_b16 v[140:141], v9 offset:17120
    ds_read_b64_tr_b16 v[142:143], v9 offset:17632
    v_add_f32 v13, v13, v95
    v_cvt_pk_bf16_f32 v107, v94, v95
    v_mfma_f32_16x16x32_bf16 v[88:91], v[56:59], a[32:35], v[36:39]
    v_mfma_f32_16x16x32_bf16 v[88:91], v[60:63], a[36:39], v[88:91]
    s_add_u32 s29, s34, s100
    v_exp_f32 v96, v96
    v_mfma_f32_16x16x32_bf16 v[88:91], v[64:67], a[40:43], v[88:91]
    v_exp_f32 v97, v97
    v_mfma_f32_16x16x32_bf16 v[88:91], v[68:71], a[44:47], v[88:91]
    s_bfe_u32 s28, s29, 0x20003
    v_exp_f32 v98, v98
    v_mfma_f32_16x16x32_bf16 v[92:95], v[72:75], a[32:35], v[36:39]
    v_exp_f32 v99, v99
    v_mfma_f32_16x16x32_bf16 v[92:95], v[76:79], a[36:39], v[92:95]
    s_lshl_b32 s28, s28, 16
    v_add_f32 v14, v14, v96
    v_add_f32 v15, v15, v97
    v_mfma_f32_16x16x32_bf16 v[92:95], v[80:83], a[40:43], v[92:95]
    v_cvt_pk_bf16_f32 v108, v96, v97
    v_mfma_f32_16x16x32_bf16 v[92:95], v[84:87], a[44:47], v[92:95]
    v_exp_f32 v100, v100
    s_waitcnt lgkmcnt(0)
    v_mfma_f32_16x16x32_bf16 v[144:147], v[112:115], v[104:107], v[144:147]
    s_and_b32 s29, s29, 7
    v_exp_f32 v101, v101
    v_mfma_f32_16x16x32_bf16 v[172:175], v[116:119], v[104:107], v[172:175]
    v_add_f32 v14, v14, v98
    v_add_f32 v15, v15, v99
    v_mfma_f32_16x16x32_bf16 v[200:203], v[120:123], v[104:107], v[200:203]
    s_lshl_b32 s29, s29, 11
    v_cvt_pk_bf16_f32 v109, v98, v99
    v_mfma_f32_16x16x32_bf16 v[228:231], v[124:127], v[104:107], v[228:231]
    v_exp_f32 v102, v102
    v_mfma_f32_16x16x32_bf16 a[112:115], v[128:131], v[104:107], a[112:115]
    s_add_u32 s29, s28, s29
    v_exp_f32 v103, v103
    v_mfma_f32_16x16x32_bf16 a[140:143], v[132:135], v[104:107], a[140:143]
    v_add_f32 v14, v14, v100
    v_add_f32 v15, v15, v101
    v_mfma_f32_16x16x32_bf16 a[168:171], v[136:139], v[104:107], a[168:171]
    s_lshr_b32 s28, s34, 5
    v_cvt_pk_bf16_f32 v110, v100, v101
    v_add_f32 v14, v14, v102
    v_mfma_f32_16x16x32_bf16 a[196:199], v[140:143], v[104:107], a[196:199]
    v_add_f32 v15, v15, v103
    v_cvt_pk_bf16_f32 v111, v102, v103
    v_mfma_f32_16x16x32_bf16 v[96:99], v[56:59], a[48:51], v[40:43]
    v_mfma_f32_16x16x32_bf16 v[96:99], v[60:63], a[52:55], v[96:99]
    s_lshl_b32 s28, s28, 19
    v_exp_f32 v88, v88
    v_mfma_f32_16x16x32_bf16 v[96:99], v[64:67], a[56:59], v[96:99]
    v_exp_f32 v89, v89
    v_mfma_f32_16x16x32_bf16 v[96:99], v[68:71], a[60:63], v[96:99]
    s_add_u32 s49, s28, s29
    v_exp_f32 v90, v90
    v_mfma_f32_16x16x32_bf16 v[100:103], v[72:75], a[48:51], v[40:43]
    v_exp_f32 v91, v91
    v_mfma_f32_16x16x32_bf16 v[100:103], v[76:79], a[52:55], v[100:103]
    s_add_u32 m0, s33, 8448
    v_add_f32 v16, v16, v88
    v_add_f32 v17, v17, v89
    v_mfma_f32_16x16x32_bf16 v[100:103], v[80:83], a[56:59], v[100:103]
    v_cvt_pk_bf16_f32 v104, v88, v89
    v_mfma_f32_16x16x32_bf16 v[100:103], v[84:87], a[60:63], v[100:103]
    v_exp_f32 v92, v92
    v_mfma_f32_16x16x32_bf16 v[148:151], v[112:115], v[108:111], v[148:151]
    s_add_u32 s34, s34, 1
    v_exp_f32 v93, v93
    v_mfma_f32_16x16x32_bf16 v[176:179], v[116:119], v[108:111], v[176:179]
    v_add_f32 v16, v16, v90
    v_add_f32 v17, v17, v91
    v_mfma_f32_16x16x32_bf16 v[204:207], v[120:123], v[108:111], v[204:207]
    buffer_load_dwordx4 v7, s[4:7], s49 offen offset:0 nt lds
    v_cvt_pk_bf16_f32 v105, v90, v91
    v_mfma_f32_16x16x32_bf16 v[232:235], v[124:127], v[108:111], v[232:235]
    v_exp_f32 v94, v94
    v_mfma_f32_16x16x32_bf16 a[116:119], v[128:131], v[108:111], a[116:119]
    s_add_u32 m0, m0, s96
    v_exp_f32 v95, v95
    v_mfma_f32_16x16x32_bf16 a[144:147], v[132:135], v[108:111], a[144:147]
    v_add_f32 v16, v16, v92
    v_add_f32 v17, v17, v93
    v_mfma_f32_16x16x32_bf16 a[172:175], v[136:139], v[108:111], a[172:175]
    buffer_load_dwordx4 v7, s[4:7], s49 offen offset:256 nt lds
    v_cvt_pk_bf16_f32 v106, v92, v93
    v_add_f32 v16, v16, v94
    v_mfma_f32_16x16x32_bf16 a[200:203], v[140:143], v[108:111], a[200:203]
    v_add_f32 v17, v17, v95
    v_cvt_pk_bf16_f32 v107, v94, v95
    v_mfma_f32_16x16x32_bf16 v[88:91], v[56:59], a[64:67], v[44:47]
    v_mfma_f32_16x16x32_bf16 v[88:91], v[60:63], a[68:71], v[88:91]
    s_add_u32 m0, m0, s97
    v_exp_f32 v96, v96
    v_mfma_f32_16x16x32_bf16 v[88:91], v[64:67], a[72:75], v[88:91]
    v_exp_f32 v97, v97
    v_mfma_f32_16x16x32_bf16 v[88:91], v[68:71], a[76:79], v[88:91]
    buffer_load_dwordx4 v7, s[4:7], s49 offen offset:512 nt lds
    v_exp_f32 v98, v98
    v_mfma_f32_16x16x32_bf16 v[92:95], v[72:75], a[64:67], v[44:47]
    v_exp_f32 v99, v99
    v_mfma_f32_16x16x32_bf16 v[92:95], v[76:79], a[68:71], v[92:95]
    s_add_u32 m0, m0, s96
    v_add_f32 v18, v18, v96
    v_add_f32 v19, v19, v97
    v_mfma_f32_16x16x32_bf16 v[92:95], v[80:83], a[72:75], v[92:95]
    v_cvt_pk_bf16_f32 v108, v96, v97
    v_mfma_f32_16x16x32_bf16 v[92:95], v[84:87], a[76:79], v[92:95]
    v_exp_f32 v100, v100
    v_mfma_f32_16x16x32_bf16 v[152:155], v[112:115], v[104:107], v[152:155]
    buffer_load_dwordx4 v7, s[4:7], s49 offen offset:768 nt lds
    v_exp_f32 v101, v101
    v_mfma_f32_16x16x32_bf16 v[180:183], v[116:119], v[104:107], v[180:183]
    v_add_f32 v18, v18, v98
    v_add_f32 v19, v19, v99
    v_mfma_f32_16x16x32_bf16 v[208:211], v[120:123], v[104:107], v[208:211]
    s_add_u32 m0, m0, s97
    v_cvt_pk_bf16_f32 v109, v98, v99
    v_mfma_f32_16x16x32_bf16 v[236:239], v[124:127], v[104:107], v[236:239]
    v_exp_f32 v102, v102
    v_mfma_f32_16x16x32_bf16 a[120:123], v[128:131], v[104:107], a[120:123]
    buffer_load_dwordx4 v7, s[4:7], s49 offen offset:1024 nt lds
    v_exp_f32 v103, v103
    v_mfma_f32_16x16x32_bf16 a[148:151], v[132:135], v[104:107], a[148:151]
    v_add_f32 v18, v18, v100
    v_add_f32 v19, v19, v101
    v_mfma_f32_16x16x32_bf16 a[176:179], v[136:139], v[104:107], a[176:179]
    s_add_u32 m0, m0, s96
    v_cvt_pk_bf16_f32 v110, v100, v101
    v_add_f32 v18, v18, v102
    v_mfma_f32_16x16x32_bf16 a[204:207], v[140:143], v[104:107], a[204:207]
    v_add_f32 v19, v19, v103
    v_cvt_pk_bf16_f32 v111, v102, v103
    v_mfma_f32_16x16x32_bf16 v[96:99], v[56:59], a[80:83], v[48:51]
    v_mfma_f32_16x16x32_bf16 v[96:99], v[60:63], a[84:87], v[96:99]
    buffer_load_dwordx4 v7, s[4:7], s49 offen offset:1280 nt lds
    v_exp_f32 v88, v88
    v_mfma_f32_16x16x32_bf16 v[96:99], v[64:67], a[88:91], v[96:99]
    v_exp_f32 v89, v89
    v_mfma_f32_16x16x32_bf16 v[96:99], v[68:71], a[92:95], v[96:99]
    s_add_u32 m0, m0, s97
    v_exp_f32 v90, v90
    v_mfma_f32_16x16x32_bf16 v[100:103], v[72:75], a[80:83], v[48:51]
    v_exp_f32 v91, v91
    v_mfma_f32_16x16x32_bf16 v[100:103], v[76:79], a[84:87], v[100:103]
    buffer_load_dwordx4 v7, s[4:7], s49 offen offset:1536 nt lds
    v_add_f32 v20, v20, v88
    v_add_f32 v21, v21, v89
    v_mfma_f32_16x16x32_bf16 v[100:103], v[80:83], a[88:91], v[100:103]
    v_cvt_pk_bf16_f32 v104, v88, v89
    v_mfma_f32_16x16x32_bf16 v[100:103], v[84:87], a[92:95], v[100:103]
    v_exp_f32 v92, v92
    v_mfma_f32_16x16x32_bf16 v[156:159], v[112:115], v[108:111], v[156:159]
    s_add_u32 m0, m0, s96
    v_exp_f32 v93, v93
    v_mfma_f32_16x16x32_bf16 v[184:187], v[116:119], v[108:111], v[184:187]
    v_add_f32 v20, v20, v90
    v_add_f32 v21, v21, v91
    v_mfma_f32_16x16x32_bf16 v[212:215], v[120:123], v[108:111], v[212:215]
    buffer_load_dwordx4 v7, s[4:7], s49 offen offset:1792 nt lds
    v_cvt_pk_bf16_f32 v105, v90, v91
    v_mfma_f32_16x16x32_bf16 v[240:243], v[124:127], v[108:111], v[240:243]
    v_exp_f32 v94, v94
    v_mfma_f32_16x16x32_bf16 a[124:127], v[128:131], v[108:111], a[124:127]
    v_exp_f32 v95, v95
    v_mfma_f32_16x16x32_bf16 a[152:155], v[132:135], v[108:111], a[152:155]
    v_add_f32 v20, v20, v92
    v_add_f32 v21, v21, v93
    v_mfma_f32_16x16x32_bf16 a[180:183], v[136:139], v[108:111], a[180:183]
    v_cvt_pk_bf16_f32 v106, v92, v93
    v_add_f32 v20, v20, v94
    v_mfma_f32_16x16x32_bf16 a[208:211], v[140:143], v[108:111], a[208:211]
    v_add_f32 v21, v21, v95
    v_cvt_pk_bf16_f32 v107, v94, v95
    s_waitcnt vmcnt(16) lgkmcnt(0)
    s_barrier
    v_mfma_f32_16x16x32_bf16 v[88:91], v[56:59], a[96:99], v[52:55]
    ds_read_b128 v[56:59], v8 offset:25344
    v_mfma_f32_16x16x32_bf16 v[88:91], v[60:63], a[100:103], v[88:91]
    ds_read_b128 v[60:63], v8 offset:25408
    v_exp_f32 v96, v96
    v_mfma_f32_16x16x32_bf16 v[88:91], v[64:67], a[104:107], v[88:91]
    ds_read_b128 v[64:67], v8 offset:25472
    v_exp_f32 v97, v97
    v_mfma_f32_16x16x32_bf16 v[88:91], v[68:71], a[108:111], v[88:91]
    ds_read_b128 v[68:71], v8 offset:25536
    v_exp_f32 v98, v98
    v_mfma_f32_16x16x32_bf16 v[92:95], v[72:75], a[96:99], v[52:55]
    ds_read_b128 v[72:75], v8 offset:25856
    v_exp_f32 v99, v99
    v_mfma_f32_16x16x32_bf16 v[92:95], v[76:79], a[100:103], v[92:95]
    ds_read_b128 v[76:79], v8 offset:25920
    v_add_f32 v22, v22, v96
    v_add_f32 v23, v23, v97
    v_mfma_f32_16x16x32_bf16 v[92:95], v[80:83], a[104:107], v[92:95]
    ds_read_b128 v[80:83], v8 offset:25984
    v_cvt_pk_bf16_f32 v108, v96, v97
    v_mfma_f32_16x16x32_bf16 v[92:95], v[84:87], a[108:111], v[92:95]
    ds_read_b128 v[84:87], v8 offset:26048
    v_exp_f32 v100, v100
    v_mfma_f32_16x16x32_bf16 v[160:163], v[112:115], v[104:107], v[160:163]
    v_exp_f32 v101, v101
    v_mfma_f32_16x16x32_bf16 v[188:191], v[116:119], v[104:107], v[188:191]
    v_add_f32 v22, v22, v98
    v_add_f32 v23, v23, v99
    v_mfma_f32_16x16x32_bf16 v[216:219], v[120:123], v[104:107], v[216:219]
    v_cvt_pk_bf16_f32 v109, v98, v99
    v_mfma_f32_16x16x32_bf16 v[244:247], v[124:127], v[104:107], v[244:247]
    v_exp_f32 v102, v102
    v_mfma_f32_16x16x32_bf16 a[128:131], v[128:131], v[104:107], a[128:131]
    v_exp_f32 v103, v103
    v_mfma_f32_16x16x32_bf16 a[156:159], v[132:135], v[104:107], a[156:159]
    v_add_f32 v22, v22, v100
    v_add_f32 v23, v23, v101
    v_mfma_f32_16x16x32_bf16 a[184:187], v[136:139], v[104:107], a[184:187]
    v_cvt_pk_bf16_f32 v110, v100, v101
    v_add_f32 v22, v22, v102
    v_mfma_f32_16x16x32_bf16 a[212:215], v[140:143], v[104:107], a[212:215]
    v_add_f32 v23, v23, v103
    v_cvt_pk_bf16_f32 v111, v102, v103
    s_waitcnt lgkmcnt(0)
    v_mfma_f32_16x16x32_bf16 v[96:99], v[56:59], a[0:3], v[28:31]
    v_mfma_f32_16x16x32_bf16 v[96:99], v[60:63], a[4:7], v[96:99]
    v_exp_f32 v88, v88
    v_mfma_f32_16x16x32_bf16 v[96:99], v[64:67], a[8:11], v[96:99]
    v_exp_f32 v89, v89
    v_mfma_f32_16x16x32_bf16 v[96:99], v[68:71], a[12:15], v[96:99]
    v_exp_f32 v90, v90
    v_mfma_f32_16x16x32_bf16 v[100:103], v[72:75], a[0:3], v[28:31]
    v_exp_f32 v91, v91
    v_mfma_f32_16x16x32_bf16 v[100:103], v[76:79], a[4:7], v[100:103]
    v_add_f32 v24, v24, v88
    v_add_f32 v25, v25, v89
    v_mfma_f32_16x16x32_bf16 v[100:103], v[80:83], a[8:11], v[100:103]
    v_cvt_pk_bf16_f32 v104, v88, v89
    v_mfma_f32_16x16x32_bf16 v[100:103], v[84:87], a[12:15], v[100:103]
    v_exp_f32 v92, v92
    v_mfma_f32_16x16x32_bf16 v[164:167], v[112:115], v[108:111], v[164:167]
    v_exp_f32 v93, v93
    v_mfma_f32_16x16x32_bf16 v[192:195], v[116:119], v[108:111], v[192:195]
    v_add_f32 v24, v24, v90
    v_add_f32 v25, v25, v91
    v_mfma_f32_16x16x32_bf16 v[220:223], v[120:123], v[108:111], v[220:223]
    v_cvt_pk_bf16_f32 v105, v90, v91
    v_mfma_f32_16x16x32_bf16 v[248:251], v[124:127], v[108:111], v[248:251]
    v_exp_f32 v94, v94
    v_mfma_f32_16x16x32_bf16 a[132:135], v[128:131], v[108:111], a[132:135]
    v_exp_f32 v95, v95
    v_mfma_f32_16x16x32_bf16 a[160:163], v[132:135], v[108:111], a[160:163]
    v_add_f32 v24, v24, v92
    v_add_f32 v25, v25, v93
    v_mfma_f32_16x16x32_bf16 a[188:191], v[136:139], v[108:111], a[188:191]
    v_cvt_pk_bf16_f32 v106, v92, v93
    v_add_f32 v24, v24, v94
    v_mfma_f32_16x16x32_bf16 a[216:219], v[140:143], v[108:111], a[216:219]
    v_add_f32 v25, v25, v95
    v_cvt_pk_bf16_f32 v107, v94, v95
    v_mfma_f32_16x16x32_bf16 v[88:91], v[56:59], a[16:19], v[32:35]
    v_mfma_f32_16x16x32_bf16 v[88:91], v[60:63], a[20:23], v[88:91]
    v_exp_f32 v96, v96
    v_mfma_f32_16x16x32_bf16 v[88:91], v[64:67], a[24:27], v[88:91]
    v_exp_f32 v97, v97
    v_mfma_f32_16x16x32_bf16 v[88:91], v[68:71], a[28:31], v[88:91]
    v_exp_f32 v98, v98
    v_mfma_f32_16x16x32_bf16 v[92:95], v[72:75], a[16:19], v[32:35]
    v_exp_f32 v99, v99
    v_mfma_f32_16x16x32_bf16 v[92:95], v[76:79], a[20:23], v[92:95]
    v_add_f32 v12, v12, v96
    v_add_f32 v13, v13, v97
    v_mfma_f32_16x16x32_bf16 v[92:95], v[80:83], a[24:27], v[92:95]
    v_cvt_pk_bf16_f32 v108, v96, v97
    v_mfma_f32_16x16x32_bf16 v[92:95], v[84:87], a[28:31], v[92:95]
    v_exp_f32 v100, v100
    v_mfma_f32_16x16x32_bf16 v[168:171], v[112:115], v[104:107], v[168:171]
    ds_read_b64_tr_b16 v[112:113], v9 offset:25344
    ds_read_b64_tr_b16 v[114:115], v9 offset:25856
    v_exp_f32 v101, v101
    v_mfma_f32_16x16x32_bf16 v[196:199], v[116:119], v[104:107], v[196:199]
    ds_read_b64_tr_b16 v[116:117], v9 offset:25376
    ds_read_b64_tr_b16 v[118:119], v9 offset:25888
    v_add_f32 v12, v12, v98
    v_add_f32 v13, v13, v99
    v_mfma_f32_16x16x32_bf16 v[224:227], v[120:123], v[104:107], v[224:227]
    ds_read_b64_tr_b16 v[120:121], v9 offset:25408
    ds_read_b64_tr_b16 v[122:123], v9 offset:25920
    v_cvt_pk_bf16_f32 v109, v98, v99
    v_mfma_f32_16x16x32_bf16 v[252:255], v[124:127], v[104:107], v[252:255]
    ds_read_b64_tr_b16 v[124:125], v9 offset:25440
    ds_read_b64_tr_b16 v[126:127], v9 offset:25952
    v_exp_f32 v102, v102
    v_mfma_f32_16x16x32_bf16 a[136:139], v[128:131], v[104:107], a[136:139]
    ds_read_b64_tr_b16 v[128:129], v9 offset:25472
    ds_read_b64_tr_b16 v[130:131], v9 offset:25984
    v_exp_f32 v103, v103
    v_mfma_f32_16x16x32_bf16 a[164:167], v[132:135], v[104:107], a[164:167]
    ds_read_b64_tr_b16 v[132:133], v9 offset:25504
    ds_read_b64_tr_b16 v[134:135], v9 offset:26016
    v_add_f32 v12, v12, v100
    v_add_f32 v13, v13, v101
    v_mfma_f32_16x16x32_bf16 a[192:195], v[136:139], v[104:107], a[192:195]
    ds_read_b64_tr_b16 v[136:137], v9 offset:25536
    ds_read_b64_tr_b16 v[138:139], v9 offset:26048
    v_cvt_pk_bf16_f32 v110, v100, v101
    v_add_f32 v12, v12, v102
    v_mfma_f32_16x16x32_bf16 a[220:223], v[140:143], v[104:107], a[220:223]
    ds_read_b64_tr_b16 v[140:141], v9 offset:25568
    ds_read_b64_tr_b16 v[142:143], v9 offset:26080
    v_add_f32 v13, v13, v103
    v_cvt_pk_bf16_f32 v111, v102, v103
    v_mfma_f32_16x16x32_bf16 v[96:99], v[56:59], a[32:35], v[36:39]
    v_mfma_f32_16x16x32_bf16 v[96:99], v[60:63], a[36:39], v[96:99]
    s_add_u32 s29, s34, s100
    v_exp_f32 v88, v88
    v_mfma_f32_16x16x32_bf16 v[96:99], v[64:67], a[40:43], v[96:99]
    v_exp_f32 v89, v89
    v_mfma_f32_16x16x32_bf16 v[96:99], v[68:71], a[44:47], v[96:99]
    s_bfe_u32 s28, s29, 0x20003
    v_exp_f32 v90, v90
    v_mfma_f32_16x16x32_bf16 v[100:103], v[72:75], a[32:35], v[36:39]
    v_exp_f32 v91, v91
    v_mfma_f32_16x16x32_bf16 v[100:103], v[76:79], a[36:39], v[100:103]
    s_lshl_b32 s28, s28, 16
    v_add_f32 v14, v14, v88
    v_add_f32 v15, v15, v89
    v_mfma_f32_16x16x32_bf16 v[100:103], v[80:83], a[40:43], v[100:103]
    v_cvt_pk_bf16_f32 v104, v88, v89
    v_mfma_f32_16x16x32_bf16 v[100:103], v[84:87], a[44:47], v[100:103]
    v_exp_f32 v92, v92
    s_waitcnt lgkmcnt(0)
    v_mfma_f32_16x16x32_bf16 v[144:147], v[112:115], v[108:111], v[144:147]
    s_and_b32 s29, s29, 7
    v_exp_f32 v93, v93
    v_mfma_f32_16x16x32_bf16 v[172:175], v[116:119], v[108:111], v[172:175]
    v_add_f32 v14, v14, v90
    v_add_f32 v15, v15, v91
    v_mfma_f32_16x16x32_bf16 v[200:203], v[120:123], v[108:111], v[200:203]
    s_lshl_b32 s29, s29, 11
    v_cvt_pk_bf16_f32 v105, v90, v91
    v_mfma_f32_16x16x32_bf16 v[228:231], v[124:127], v[108:111], v[228:231]
    v_exp_f32 v94, v94
    v_mfma_f32_16x16x32_bf16 a[112:115], v[128:131], v[108:111], a[112:115]
    s_add_u32 s29, s28, s29
    v_exp_f32 v95, v95
    v_mfma_f32_16x16x32_bf16 a[140:143], v[132:135], v[108:111], a[140:143]
    v_add_f32 v14, v14, v92
    v_add_f32 v15, v15, v93
    v_mfma_f32_16x16x32_bf16 a[168:171], v[136:139], v[108:111], a[168:171]
    s_lshr_b32 s28, s34, 5
    v_cvt_pk_bf16_f32 v106, v92, v93
    v_add_f32 v14, v14, v94
    v_mfma_f32_16x16x32_bf16 a[196:199], v[140:143], v[108:111], a[196:199]
    v_add_f32 v15, v15, v95
    v_cvt_pk_bf16_f32 v107, v94, v95
    v_mfma_f32_16x16x32_bf16 v[88:91], v[56:59], a[48:51], v[40:43]
    v_mfma_f32_16x16x32_bf16 v[88:91], v[60:63], a[52:55], v[88:91]
    s_lshl_b32 s28, s28, 19
    v_exp_f32 v96, v96
    v_mfma_f32_16x16x32_bf16 v[88:91], v[64:67], a[56:59], v[88:91]
    v_exp_f32 v97, v97
    v_mfma_f32_16x16x32_bf16 v[88:91], v[68:71], a[60:63], v[88:91]
    s_add_u32 s49, s28, s29
    v_exp_f32 v98, v98
    v_mfma_f32_16x16x32_bf16 v[92:95], v[72:75], a[48:51], v[40:43]
    v_exp_f32 v99, v99
    v_mfma_f32_16x16x32_bf16 v[92:95], v[76:79], a[52:55], v[92:95]
    s_add_u32 m0, s33, 16896
    v_add_f32 v16, v16, v96
    v_add_f32 v17, v17, v97
    v_mfma_f32_16x16x32_bf16 v[92:95], v[80:83], a[56:59], v[92:95]
    v_cvt_pk_bf16_f32 v108, v96, v97
    v_mfma_f32_16x16x32_bf16 v[92:95], v[84:87], a[60:63], v[92:95]
    v_exp_f32 v100, v100
    v_mfma_f32_16x16x32_bf16 v[148:151], v[112:115], v[104:107], v[148:151]
    s_add_u32 s34, s34, 1
    v_exp_f32 v101, v101
    v_mfma_f32_16x16x32_bf16 v[176:179], v[116:119], v[104:107], v[176:179]
    v_add_f32 v16, v16, v98
    v_add_f32 v17, v17, v99
    v_mfma_f32_16x16x32_bf16 v[204:207], v[120:123], v[104:107], v[204:207]
    buffer_load_dwordx4 v7, s[4:7], s49 offen offset:0 nt lds
    v_cvt_pk_bf16_f32 v109, v98, v99
    v_mfma_f32_16x16x32_bf16 v[232:235], v[124:127], v[104:107], v[232:235]
    v_exp_f32 v102, v102
    v_mfma_f32_16x16x32_bf16 a[116:119], v[128:131], v[104:107], a[116:119]
    s_add_u32 m0, m0, s96
    v_exp_f32 v103, v103
    v_mfma_f32_16x16x32_bf16 a[144:147], v[132:135], v[104:107], a[144:147]
    v_add_f32 v16, v16, v100
    v_add_f32 v17, v17, v101
    v_mfma_f32_16x16x32_bf16 a[172:175], v[136:139], v[104:107], a[172:175]
    buffer_load_dwordx4 v7, s[4:7], s49 offen offset:256 nt lds
    v_cvt_pk_bf16_f32 v110, v100, v101
    v_add_f32 v16, v16, v102
    v_mfma_f32_16x16x32_bf16 a[200:203], v[140:143], v[104:107], a[200:203]
    v_add_f32 v17, v17, v103
    v_cvt_pk_bf16_f32 v111, v102, v103
    v_mfma_f32_16x16x32_bf16 v[96:99], v[56:59], a[64:67], v[44:47]
    v_mfma_f32_16x16x32_bf16 v[96:99], v[60:63], a[68:71], v[96:99]
    s_add_u32 m0, m0, s97
    v_exp_f32 v88, v88
    v_mfma_f32_16x16x32_bf16 v[96:99], v[64:67], a[72:75], v[96:99]
    v_exp_f32 v89, v89
    v_mfma_f32_16x16x32_bf16 v[96:99], v[68:71], a[76:79], v[96:99]
    buffer_load_dwordx4 v7, s[4:7], s49 offen offset:512 nt lds
    v_exp_f32 v90, v90
    v_mfma_f32_16x16x32_bf16 v[100:103], v[72:75], a[64:67], v[44:47]
    v_exp_f32 v91, v91
    v_mfma_f32_16x16x32_bf16 v[100:103], v[76:79], a[68:71], v[100:103]
    s_add_u32 m0, m0, s96
    v_add_f32 v18, v18, v88
    v_add_f32 v19, v19, v89
    v_mfma_f32_16x16x32_bf16 v[100:103], v[80:83], a[72:75], v[100:103]
    v_cvt_pk_bf16_f32 v104, v88, v89
    v_mfma_f32_16x16x32_bf16 v[100:103], v[84:87], a[76:79], v[100:103]
    v_exp_f32 v92, v92
    v_mfma_f32_16x16x32_bf16 v[152:155], v[112:115], v[108:111], v[152:155]
    buffer_load_dwordx4 v7, s[4:7], s49 offen offset:768 nt lds
    v_exp_f32 v93, v93
    v_mfma_f32_16x16x32_bf16 v[180:183], v[116:119], v[108:111], v[180:183]
    v_add_f32 v18, v18, v90
    v_add_f32 v19, v19, v91
    v_mfma_f32_16x16x32_bf16 v[208:211], v[120:123], v[108:111], v[208:211]
    s_add_u32 m0, m0, s97
    v_cvt_pk_bf16_f32 v105, v90, v91
    v_mfma_f32_16x16x32_bf16 v[236:239], v[124:127], v[108:111], v[236:239]
    v_exp_f32 v94, v94
    v_mfma_f32_16x16x32_bf16 a[120:123], v[128:131], v[108:111], a[120:123]
    buffer_load_dwordx4 v7, s[4:7], s49 offen offset:1024 nt lds
    v_exp_f32 v95, v95
    v_mfma_f32_16x16x32_bf16 a[148:151], v[132:135], v[108:111], a[148:151]
    v_add_f32 v18, v18, v92
    v_add_f32 v19, v19, v93
    v_mfma_f32_16x16x32_bf16 a[176:179], v[136:139], v[108:111], a[176:179]
    s_add_u32 m0, m0, s96
    v_cvt_pk_bf16_f32 v106, v92, v93
    v_add_f32 v18, v18, v94
    v_mfma_f32_16x16x32_bf16 a[204:207], v[140:143], v[108:111], a[204:207]
    v_add_f32 v19, v19, v95
    v_cvt_pk_bf16_f32 v107, v94, v95
    v_mfma_f32_16x16x32_bf16 v[88:91], v[56:59], a[80:83], v[48:51]
    v_mfma_f32_16x16x32_bf16 v[88:91], v[60:63], a[84:87], v[88:91]
    buffer_load_dwordx4 v7, s[4:7], s49 offen offset:1280 nt lds
    v_exp_f32 v96, v96
    v_mfma_f32_16x16x32_bf16 v[88:91], v[64:67], a[88:91], v[88:91]
    v_exp_f32 v97, v97
    v_mfma_f32_16x16x32_bf16 v[88:91], v[68:71], a[92:95], v[88:91]
    s_add_u32 m0, m0, s97
    v_exp_f32 v98, v98
    v_mfma_f32_16x16x32_bf16 v[92:95], v[72:75], a[80:83], v[48:51]
    v_exp_f32 v99, v99
    v_mfma_f32_16x16x32_bf16 v[92:95], v[76:79], a[84:87], v[92:95]
    buffer_load_dwordx4 v7, s[4:7], s49 offen offset:1536 nt lds
    v_add_f32 v20, v20, v96
    v_add_f32 v21, v21, v97
    v_mfma_f32_16x16x32_bf16 v[92:95], v[80:83], a[88:91], v[92:95]
    v_cvt_pk_bf16_f32 v108, v96, v97
    v_mfma_f32_16x16x32_bf16 v[92:95], v[84:87], a[92:95], v[92:95]
    v_exp_f32 v100, v100
    v_mfma_f32_16x16x32_bf16 v[156:159], v[112:115], v[104:107], v[156:159]
    s_add_u32 m0, m0, s96
    v_exp_f32 v101, v101
    v_mfma_f32_16x16x32_bf16 v[184:187], v[116:119], v[104:107], v[184:187]
    v_add_f32 v20, v20, v98
    v_add_f32 v21, v21, v99
    v_mfma_f32_16x16x32_bf16 v[212:215], v[120:123], v[104:107], v[212:215]
    buffer_load_dwordx4 v7, s[4:7], s49 offen offset:1792 nt lds
    v_cvt_pk_bf16_f32 v109, v98, v99
    v_mfma_f32_16x16x32_bf16 v[240:243], v[124:127], v[104:107], v[240:243]
    v_exp_f32 v102, v102
    v_mfma_f32_16x16x32_bf16 a[124:127], v[128:131], v[104:107], a[124:127]
    v_exp_f32 v103, v103
    v_mfma_f32_16x16x32_bf16 a[152:155], v[132:135], v[104:107], a[152:155]
    v_add_f32 v20, v20, v100
    v_add_f32 v21, v21, v101
    v_mfma_f32_16x16x32_bf16 a[180:183], v[136:139], v[104:107], a[180:183]
    v_cvt_pk_bf16_f32 v110, v100, v101
    v_add_f32 v20, v20, v102
    v_mfma_f32_16x16x32_bf16 a[208:211], v[140:143], v[104:107], a[208:211]
    v_add_f32 v21, v21, v103
    v_cvt_pk_bf16_f32 v111, v102, v103
    s_waitcnt vmcnt(16) lgkmcnt(0)
    s_barrier
    v_mfma_f32_16x16x32_bf16 v[96:99], v[56:59], a[96:99], v[52:55]
    ds_read_b128 v[56:59], v8 offset:0
    v_mfma_f32_16x16x32_bf16 v[96:99], v[60:63], a[100:103], v[96:99]
    ds_read_b128 v[60:63], v8 offset:64
    v_exp_f32 v88, v88
    v_mfma_f32_16x16x32_bf16 v[96:99], v[64:67], a[104:107], v[96:99]
    ds_read_b128 v[64:67], v8 offset:128
    v_exp_f32 v89, v89
    v_mfma_f32_16x16x32_bf16 v[96:99], v[68:71], a[108:111], v[96:99]
    ds_read_b128 v[68:71], v8 offset:192
    v_exp_f32 v90, v90
    v_mfma_f32_16x16x32_bf16 v[100:103], v[72:75], a[96:99], v[52:55]
    ds_read_b128 v[72:75], v8 offset:512
    v_exp_f32 v91, v91
    v_mfma_f32_16x16x32_bf16 v[100:103], v[76:79], a[100:103], v[100:103]
    ds_read_b128 v[76:79], v8 offset:576
    v_add_f32 v22, v22, v88
    v_add_f32 v23, v23, v89
    v_mfma_f32_16x16x32_bf16 v[100:103], v[80:83], a[104:107], v[100:103]
    ds_read_b128 v[80:83], v8 offset:640
    v_cvt_pk_bf16_f32 v104, v88, v89
    v_mfma_f32_16x16x32_bf16 v[100:103], v[84:87], a[108:111], v[100:103]
    ds_read_b128 v[84:87], v8 offset:704
    v_exp_f32 v92, v92
    v_mfma_f32_16x16x32_bf16 v[160:163], v[112:115], v[108:111], v[160:163]
    v_exp_f32 v93, v93
    v_mfma_f32_16x16x32_bf16 v[188:191], v[116:119], v[108:111], v[188:191]
    v_add_f32 v22, v22, v90
    v_add_f32 v23, v23, v91
    v_mfma_f32_16x16x32_bf16 v[216:219], v[120:123], v[108:111], v[216:219]
    v_cvt_pk_bf16_f32 v105, v90, v91
    v_mfma_f32_16x16x32_bf16 v[244:247], v[124:127], v[108:111], v[244:247]
    v_exp_f32 v94, v94
    v_mfma_f32_16x16x32_bf16 a[128:131], v[128:131], v[108:111], a[128:131]
    v_exp_f32 v95, v95
    v_mfma_f32_16x16x32_bf16 a[156:159], v[132:135], v[108:111], a[156:159]
    v_add_f32 v22, v22, v92
    v_add_f32 v23, v23, v93
    v_mfma_f32_16x16x32_bf16 a[184:187], v[136:139], v[108:111], a[184:187]
    v_cvt_pk_bf16_f32 v106, v92, v93
    v_add_f32 v22, v22, v94
    v_mfma_f32_16x16x32_bf16 a[212:215], v[140:143], v[108:111], a[212:215]
    v_add_f32 v23, v23, v95
    v_cvt_pk_bf16_f32 v107, v94, v95
    s_waitcnt lgkmcnt(0)
    v_mfma_f32_16x16x32_bf16 v[88:91], v[56:59], a[0:3], v[28:31]
    v_mfma_f32_16x16x32_bf16 v[88:91], v[60:63], a[4:7], v[88:91]
    v_exp_f32 v96, v96
    v_mfma_f32_16x16x32_bf16 v[88:91], v[64:67], a[8:11], v[88:91]
    v_exp_f32 v97, v97
    v_mfma_f32_16x16x32_bf16 v[88:91], v[68:71], a[12:15], v[88:91]
    v_exp_f32 v98, v98
    v_mfma_f32_16x16x32_bf16 v[92:95], v[72:75], a[0:3], v[28:31]
    v_exp_f32 v99, v99
    v_mfma_f32_16x16x32_bf16 v[92:95], v[76:79], a[4:7], v[92:95]
    v_add_f32 v24, v24, v96
    v_add_f32 v25, v25, v97
    v_mfma_f32_16x16x32_bf16 v[92:95], v[80:83], a[8:11], v[92:95]
    v_cvt_pk_bf16_f32 v108, v96, v97
    v_mfma_f32_16x16x32_bf16 v[92:95], v[84:87], a[12:15], v[92:95]
    v_exp_f32 v100, v100
    v_mfma_f32_16x16x32_bf16 v[164:167], v[112:115], v[104:107], v[164:167]
    v_exp_f32 v101, v101
    v_mfma_f32_16x16x32_bf16 v[192:195], v[116:119], v[104:107], v[192:195]
    v_add_f32 v24, v24, v98
    v_add_f32 v25, v25, v99
    v_mfma_f32_16x16x32_bf16 v[220:223], v[120:123], v[104:107], v[220:223]
    v_cvt_pk_bf16_f32 v109, v98, v99
    v_mfma_f32_16x16x32_bf16 v[248:251], v[124:127], v[104:107], v[248:251]
    v_exp_f32 v102, v102
    v_mfma_f32_16x16x32_bf16 a[132:135], v[128:131], v[104:107], a[132:135]
    v_exp_f32 v103, v103
    v_mfma_f32_16x16x32_bf16 a[160:163], v[132:135], v[104:107], a[160:163]
    v_add_f32 v24, v24, v100
    v_add_f32 v25, v25, v101
    v_mfma_f32_16x16x32_bf16 a[188:191], v[136:139], v[104:107], a[188:191]
    v_cvt_pk_bf16_f32 v110, v100, v101
    v_add_f32 v24, v24, v102
    v_mfma_f32_16x16x32_bf16 a[216:219], v[140:143], v[104:107], a[216:219]
    v_add_f32 v25, v25, v103
    v_cvt_pk_bf16_f32 v111, v102, v103
    s_mul_i32 s50, s21, s52
    s_mov_b32 s101, s21
    s_add_u32 s50, s50, s55
    s_cmp_ge_u32 s21, 2
    s_cselect_b32 s28, 0x40000000, 0
    s_add_u32 s50, s50, s28
    s_mov_b32 s82, s26
    s_mul_i32 s28, s26, s51
    s_add_u32 s50, s50, s28
    v_mfma_f32_16x16x32_bf16 v[96:99], v[56:59], a[16:19], v[32:35]
    v_mfma_f32_16x16x32_bf16 v[96:99], v[60:63], a[20:23], v[96:99]
    v_exp_f32 v88, v88
    v_mfma_f32_16x16x32_bf16 v[96:99], v[64:67], a[24:27], v[96:99]
    v_exp_f32 v89, v89
    v_mfma_f32_16x16x32_bf16 v[96:99], v[68:71], a[28:31], v[96:99]
    v_exp_f32 v90, v90
    v_mfma_f32_16x16x32_bf16 v[100:103], v[72:75], a[16:19], v[32:35]
    v_exp_f32 v91, v91
    v_mfma_f32_16x16x32_bf16 v[100:103], v[76:79], a[20:23], v[100:103]
    v_add_f32 v12, v12, v88
    v_add_f32 v13, v13, v89
    v_mfma_f32_16x16x32_bf16 v[100:103], v[80:83], a[24:27], v[100:103]
    v_cvt_pk_bf16_f32 v104, v88, v89
    v_mfma_f32_16x16x32_bf16 v[100:103], v[84:87], a[28:31], v[100:103]
    v_exp_f32 v92, v92
    v_mfma_f32_16x16x32_bf16 v[168:171], v[112:115], v[108:111], v[168:171]
    ds_read_b64_tr_b16 v[112:113], v9 offset:0
    ds_read_b64_tr_b16 v[114:115], v9 offset:512
    v_exp_f32 v93, v93
    v_mfma_f32_16x16x32_bf16 v[196:199], v[116:119], v[108:111], v[196:199]
    ds_read_b64_tr_b16 v[116:117], v9 offset:32
    ds_read_b64_tr_b16 v[118:119], v9 offset:544
    v_add_f32 v12, v12, v90
    v_add_f32 v13, v13, v91
    v_mfma_f32_16x16x32_bf16 v[224:227], v[120:123], v[108:111], v[224:227]
    ds_read_b64_tr_b16 v[120:121], v9 offset:64
    ds_read_b64_tr_b16 v[122:123], v9 offset:576
    v_cvt_pk_bf16_f32 v105, v90, v91
    v_mfma_f32_16x16x32_bf16 v[252:255], v[124:127], v[108:111], v[252:255]
    ds_read_b64_tr_b16 v[124:125], v9 offset:96
    ds_read_b64_tr_b16 v[126:127], v9 offset:608
    v_exp_f32 v94, v94
    v_mfma_f32_16x16x32_bf16 a[136:139], v[128:131], v[108:111], a[136:139]
    ds_read_b64_tr_b16 v[128:129], v9 offset:128
    ds_read_b64_tr_b16 v[130:131], v9 offset:640
    v_exp_f32 v95, v95
    v_mfma_f32_16x16x32_bf16 a[164:167], v[132:135], v[108:111], a[164:167]
    ds_read_b64_tr_b16 v[132:133], v9 offset:160
    ds_read_b64_tr_b16 v[134:135], v9 offset:672
    v_add_f32 v12, v12, v92
    v_add_f32 v13, v13, v93
    v_mfma_f32_16x16x32_bf16 a[192:195], v[136:139], v[108:111], a[192:195]
    ds_read_b64_tr_b16 v[136:137], v9 offset:192
    ds_read_b64_tr_b16 v[138:139], v9 offset:704
    v_cvt_pk_bf16_f32 v106, v92, v93
    v_add_f32 v12, v12, v94
    v_mfma_f32_16x16x32_bf16 a[220:223], v[140:143], v[108:111], a[220:223]
    ds_read_b64_tr_b16 v[140:141], v9 offset:224
    ds_read_b64_tr_b16 v[142:143], v9 offset:736
    v_add_f32 v13, v13, v95
    v_cvt_pk_bf16_f32 v107, v94, v95
    v_mfma_f32_16x16x32_bf16 v[88:91], v[56:59], a[32:35], v[36:39]
    v_mfma_f32_16x16x32_bf16 v[88:91], v[60:63], a[36:39], v[88:91]
    s_add_u32 s29, s34, s100
    v_exp_f32 v96, v96
    v_mfma_f32_16x16x32_bf16 v[88:91], v[64:67], a[40:43], v[88:91]
    v_exp_f32 v97, v97
    v_mfma_f32_16x16x32_bf16 v[88:91], v[68:71], a[44:47], v[88:91]
    s_bfe_u32 s28, s29, 0x20003
    v_exp_f32 v98, v98
    v_mfma_f32_16x16x32_bf16 v[92:95], v[72:75], a[32:35], v[36:39]
    v_exp_f32 v99, v99
    v_mfma_f32_16x16x32_bf16 v[92:95], v[76:79], a[36:39], v[92:95]
    s_lshl_b32 s28, s28, 16
    v_add_f32 v14, v14, v96
    v_add_f32 v15, v15, v97
    v_mfma_f32_16x16x32_bf16 v[92:95], v[80:83], a[40:43], v[92:95]
    v_cvt_pk_bf16_f32 v108, v96, v97
    v_mfma_f32_16x16x32_bf16 v[92:95], v[84:87], a[44:47], v[92:95]
    v_exp_f32 v100, v100
    s_waitcnt lgkmcnt(0)
    v_mfma_f32_16x16x32_bf16 v[144:147], v[112:115], v[104:107], v[144:147]
    s_and_b32 s29, s29, 7
    v_exp_f32 v101, v101
    v_mfma_f32_16x16x32_bf16 v[172:175], v[116:119], v[104:107], v[172:175]
    v_add_f32 v14, v14, v98
    v_add_f32 v15, v15, v99
    v_mfma_f32_16x16x32_bf16 v[200:203], v[120:123], v[104:107], v[200:203]
    s_lshl_b32 s29, s29, 11
    v_cvt_pk_bf16_f32 v109, v98, v99
    v_mfma_f32_16x16x32_bf16 v[228:231], v[124:127], v[104:107], v[228:231]
    v_exp_f32 v102, v102
    v_mfma_f32_16x16x32_bf16 a[112:115], v[128:131], v[104:107], a[112:115]
    s_add_u32 s29, s28, s29
    v_exp_f32 v103, v103
    v_mfma_f32_16x16x32_bf16 a[140:143], v[132:135], v[104:107], a[140:143]
    v_add_f32 v14, v14, v100
    v_add_f32 v15, v15, v101
    v_mfma_f32_16x16x32_bf16 a[168:171], v[136:139], v[104:107], a[168:171]
    s_lshr_b32 s28, s34, 5
    v_cvt_pk_bf16_f32 v110, v100, v101
    v_add_f32 v14, v14, v102
    v_mfma_f32_16x16x32_bf16 a[196:199], v[140:143], v[104:107], a[196:199]
    v_add_f32 v15, v15, v103
    v_cvt_pk_bf16_f32 v111, v102, v103
    v_mfma_f32_16x16x32_bf16 v[96:99], v[56:59], a[48:51], v[40:43]
    v_mfma_f32_16x16x32_bf16 v[96:99], v[60:63], a[52:55], v[96:99]
    s_lshl_b32 s28, s28, 19
    v_exp_f32 v88, v88
    v_mfma_f32_16x16x32_bf16 v[96:99], v[64:67], a[56:59], v[96:99]
    v_exp_f32 v89, v89
    v_mfma_f32_16x16x32_bf16 v[96:99], v[68:71], a[60:63], v[96:99]
    s_add_u32 s49, s28, s29
    v_exp_f32 v90, v90
    v_mfma_f32_16x16x32_bf16 v[100:103], v[72:75], a[48:51], v[40:43]
    v_exp_f32 v91, v91
    v_mfma_f32_16x16x32_bf16 v[100:103], v[76:79], a[52:55], v[100:103]
    s_add_u32 m0, s33, 25344
    v_add_f32 v16, v16, v88
    v_add_f32 v17, v17, v89
    v_mfma_f32_16x16x32_bf16 v[100:103], v[80:83], a[56:59], v[100:103]
    v_cvt_pk_bf16_f32 v104, v88, v89
    v_mfma_f32_16x16x32_bf16 v[100:103], v[84:87], a[60:63], v[100:103]
    v_exp_f32 v92, v92
    v_mfma_f32_16x16x32_bf16 v[148:151], v[112:115], v[108:111], v[148:151]
    s_add_u32 s34, s34, 1
    v_exp_f32 v93, v93
    v_mfma_f32_16x16x32_bf16 v[176:179], v[116:119], v[108:111], v[176:179]
    v_add_f32 v16, v16, v90
    v_add_f32 v17, v17, v91
    v_mfma_f32_16x16x32_bf16 v[204:207], v[120:123], v[108:111], v[204:207]
    buffer_load_dwordx4 v7, s[4:7], s49 offen offset:0 nt lds
    v_cvt_pk_bf16_f32 v105, v90, v91
    v_mfma_f32_16x16x32_bf16 v[232:235], v[124:127], v[108:111], v[232:235]
    v_exp_f32 v94, v94
    v_mfma_f32_16x16x32_bf16 a[116:119], v[128:131], v[108:111], a[116:119]
    s_add_u32 m0, m0, s96
    v_exp_f32 v95, v95
    v_mfma_f32_16x16x32_bf16 a[144:147], v[132:135], v[108:111], a[144:147]
    v_add_f32 v16, v16, v92
    v_add_f32 v17, v17, v93
    v_mfma_f32_16x16x32_bf16 a[172:175], v[136:139], v[108:111], a[172:175]
    buffer_load_dwordx4 v7, s[4:7], s49 offen offset:256 nt lds
    v_cvt_pk_bf16_f32 v106, v92, v93
    v_add_f32 v16, v16, v94
    v_mfma_f32_16x16x32_bf16 a[200:203], v[140:143], v[108:111], a[200:203]
    v_add_f32 v17, v17, v95
    v_cvt_pk_bf16_f32 v107, v94, v95
    v_mfma_f32_16x16x32_bf16 v[88:91], v[56:59], a[64:67], v[44:47]
    v_mfma_f32_16x16x32_bf16 v[88:91], v[60:63], a[68:71], v[88:91]
    s_add_u32 m0, m0, s97
    v_exp_f32 v96, v96
    v_mfma_f32_16x16x32_bf16 v[88:91], v[64:67], a[72:75], v[88:91]
    v_exp_f32 v97, v97
    v_mfma_f32_16x16x32_bf16 v[88:91], v[68:71], a[76:79], v[88:91]
    buffer_load_dwordx4 v7, s[4:7], s49 offen offset:512 nt lds
    v_exp_f32 v98, v98
    v_mfma_f32_16x16x32_bf16 v[92:95], v[72:75], a[64:67], v[44:47]
    v_exp_f32 v99, v99
    v_mfma_f32_16x16x32_bf16 v[92:95], v[76:79], a[68:71], v[92:95]
    s_add_u32 m0, m0, s96
    v_add_f32 v18, v18, v96
    v_add_f32 v19, v19, v97
    v_mfma_f32_16x16x32_bf16 v[92:95], v[80:83], a[72:75], v[92:95]
    v_cvt_pk_bf16_f32 v108, v96, v97
    v_mfma_f32_16x16x32_bf16 v[92:95], v[84:87], a[76:79], v[92:95]
    v_exp_f32 v100, v100
    v_mfma_f32_16x16x32_bf16 v[152:155], v[112:115], v[104:107], v[152:155]
    buffer_load_dwordx4 v7, s[4:7], s49 offen offset:768 nt lds
    v_exp_f32 v101, v101
    v_mfma_f32_16x16x32_bf16 v[180:183], v[116:119], v[104:107], v[180:183]
    v_add_f32 v18, v18, v98
    v_add_f32 v19, v19, v99
    v_mfma_f32_16x16x32_bf16 v[208:211], v[120:123], v[104:107], v[208:211]
    s_add_u32 m0, m0, s97
    v_cvt_pk_bf16_f32 v109, v98, v99
    v_mfma_f32_16x16x32_bf16 v[236:239], v[124:127], v[104:107], v[236:239]
    v_exp_f32 v102, v102
    v_mfma_f32_16x16x32_bf16 a[120:123], v[128:131], v[104:107], a[120:123]
    buffer_load_dwordx4 v7, s[4:7], s49 offen offset:1024 nt lds
    v_exp_f32 v103, v103
    v_mfma_f32_16x16x32_bf16 a[148:151], v[132:135], v[104:107], a[148:151]
    v_add_f32 v18, v18, v100
    v_add_f32 v19, v19, v101
    v_mfma_f32_16x16x32_bf16 a[176:179], v[136:139], v[104:107], a[176:179]
    s_add_u32 m0, m0, s96
    v_cvt_pk_bf16_f32 v110, v100, v101
    v_add_f32 v18, v18, v102
    v_mfma_f32_16x16x32_bf16 a[204:207], v[140:143], v[104:107], a[204:207]
    v_add_f32 v19, v19, v103
    v_cvt_pk_bf16_f32 v111, v102, v103
    v_mfma_f32_16x16x32_bf16 v[96:99], v[56:59], a[80:83], v[48:51]
    v_mfma_f32_16x16x32_bf16 v[96:99], v[60:63], a[84:87], v[96:99]
    buffer_load_dwordx4 v7, s[4:7], s49 offen offset:1280 nt lds
    v_exp_f32 v88, v88
    v_mfma_f32_16x16x32_bf16 v[96:99], v[64:67], a[88:91], v[96:99]
    v_exp_f32 v89, v89
    v_mfma_f32_16x16x32_bf16 v[96:99], v[68:71], a[92:95], v[96:99]
    s_add_u32 m0, m0, s97
    v_exp_f32 v90, v90
    v_mfma_f32_16x16x32_bf16 v[100:103], v[72:75], a[80:83], v[48:51]
    v_exp_f32 v91, v91
    v_mfma_f32_16x16x32_bf16 v[100:103], v[76:79], a[84:87], v[100:103]
    buffer_load_dwordx4 v7, s[4:7], s49 offen offset:1536 nt lds
    v_add_f32 v20, v20, v88
    v_add_f32 v21, v21, v89
    v_mfma_f32_16x16x32_bf16 v[100:103], v[80:83], a[88:91], v[100:103]
    v_cvt_pk_bf16_f32 v104, v88, v89
    v_mfma_f32_16x16x32_bf16 v[100:103], v[84:87], a[92:95], v[100:103]
    v_exp_f32 v92, v92
    v_mfma_f32_16x16x32_bf16 v[156:159], v[112:115], v[108:111], v[156:159]
    s_add_u32 m0, m0, s96
    v_exp_f32 v93, v93
    v_mfma_f32_16x16x32_bf16 v[184:187], v[116:119], v[108:111], v[184:187]
    v_add_f32 v20, v20, v90
    v_add_f32 v21, v21, v91
    v_mfma_f32_16x16x32_bf16 v[212:215], v[120:123], v[108:111], v[212:215]
    buffer_load_dwordx4 v7, s[4:7], s49 offen offset:1792 nt lds
    v_cvt_pk_bf16_f32 v105, v90, v91
    v_mfma_f32_16x16x32_bf16 v[240:243], v[124:127], v[108:111], v[240:243]
    v_exp_f32 v94, v94
    v_mfma_f32_16x16x32_bf16 a[124:127], v[128:131], v[108:111], a[124:127]
    v_exp_f32 v95, v95
    v_mfma_f32_16x16x32_bf16 a[152:155], v[132:135], v[108:111], a[152:155]
    v_add_f32 v20, v20, v92
    v_add_f32 v21, v21, v93
    v_mfma_f32_16x16x32_bf16 a[180:183], v[136:139], v[108:111], a[180:183]
    v_cvt_pk_bf16_f32 v106, v92, v93
    v_add_f32 v20, v20, v94
    v_mfma_f32_16x16x32_bf16 a[208:211], v[140:143], v[108:111], a[208:211]
    v_add_f32 v21, v21, v95
    v_cvt_pk_bf16_f32 v107, v94, v95
    s_waitcnt vmcnt(16) lgkmcnt(0)
    s_barrier
    v_mfma_f32_16x16x32_bf16 v[88:91], v[56:59], a[96:99], v[52:55]
    ds_read_b128 v[56:59], v8 offset:8448
    v_mfma_f32_16x16x32_bf16 v[88:91], v[60:63], a[100:103], v[88:91]
    ds_read_b128 v[60:63], v8 offset:8512
    v_exp_f32 v96, v96
    v_mfma_f32_16x16x32_bf16 v[88:91], v[64:67], a[104:107], v[88:91]
    ds_read_b128 v[64:67], v8 offset:8576
    v_exp_f32 v97, v97
    v_mfma_f32_16x16x32_bf16 v[88:91], v[68:71], a[108:111], v[88:91]
    ds_read_b128 v[68:71], v8 offset:8640
    v_exp_f32 v98, v98
    v_mfma_f32_16x16x32_bf16 v[92:95], v[72:75], a[96:99], v[52:55]
    ds_read_b128 v[72:75], v8 offset:8960
    v_exp_f32 v99, v99
    v_mfma_f32_16x16x32_bf16 v[92:95], v[76:79], a[100:103], v[92:95]
    ds_read_b128 v[76:79], v8 offset:9024
    v_add_f32 v22, v22, v96
    v_add_f32 v23, v23, v97
    v_mfma_f32_16x16x32_bf16 v[92:95], v[80:83], a[104:107], v[92:95]
    ds_read_b128 v[80:83], v8 offset:9088
    v_cvt_pk_bf16_f32 v108, v96, v97
    v_mfma_f32_16x16x32_bf16 v[92:95], v[84:87], a[108:111], v[92:95]
    ds_read_b128 v[84:87], v8 offset:9152
    v_exp_f32 v100, v100
    v_mfma_f32_16x16x32_bf16 v[160:163], v[112:115], v[104:107], v[160:163]
    v_exp_f32 v101, v101
    v_mfma_f32_16x16x32_bf16 v[188:191], v[116:119], v[104:107], v[188:191]
    v_add_f32 v22, v22, v98
    v_add_f32 v23, v23, v99
    v_mfma_f32_16x16x32_bf16 v[216:219], v[120:123], v[104:107], v[216:219]
    v_cvt_pk_bf16_f32 v109, v98, v99
    v_mfma_f32_16x16x32_bf16 v[244:247], v[124:127], v[104:107], v[244:247]
    v_exp_f32 v102, v102
    v_mfma_f32_16x16x32_bf16 a[128:131], v[128:131], v[104:107], a[128:131]
    v_exp_f32 v103, v103
    v_mfma_f32_16x16x32_bf16 a[156:159], v[132:135], v[104:107], a[156:159]
    v_add_f32 v22, v22, v100
    v_add_f32 v23, v23, v101
    v_mfma_f32_16x16x32_bf16 a[184:187], v[136:139], v[104:107], a[184:187]
    v_cvt_pk_bf16_f32 v110, v100, v101
    v_add_f32 v22, v22, v102
    v_mfma_f32_16x16x32_bf16 a[212:215], v[140:143], v[104:107], a[212:215]
    v_add_f32 v23, v23, v103
    v_cvt_pk_bf16_f32 v111, v102, v103
    s_waitcnt lgkmcnt(0)
    v_mfma_f32_16x16x32_bf16 v[96:99], v[56:59], a[0:3], v[28:31]
    v_mfma_f32_16x16x32_bf16 v[96:99], v[60:63], a[4:7], v[96:99]
    v_exp_f32 v88, v88
    v_mfma_f32_16x16x32_bf16 v[96:99], v[64:67], a[8:11], v[96:99]
    v_exp_f32 v89, v89
    v_mfma_f32_16x16x32_bf16 v[96:99], v[68:71], a[12:15], v[96:99]
    v_exp_f32 v90, v90
    v_mfma_f32_16x16x32_bf16 v[100:103], v[72:75], a[0:3], v[28:31]
    v_exp_f32 v91, v91
    v_mfma_f32_16x16x32_bf16 v[100:103], v[76:79], a[4:7], v[100:103]
    v_add_f32 v24, v24, v88
    v_add_f32 v25, v25, v89
    v_mfma_f32_16x16x32_bf16 v[100:103], v[80:83], a[8:11], v[100:103]
    v_cvt_pk_bf16_f32 v104, v88, v89
    v_mfma_f32_16x16x32_bf16 v[100:103], v[84:87], a[12:15], v[100:103]
    v_exp_f32 v92, v92
    v_mfma_f32_16x16x32_bf16 v[164:167], v[112:115], v[108:111], v[164:167]
    v_exp_f32 v93, v93
    v_mfma_f32_16x16x32_bf16 v[192:195], v[116:119], v[108:111], v[192:195]
    v_add_f32 v24, v24, v90
    v_add_f32 v25, v25, v91
    v_mfma_f32_16x16x32_bf16 v[220:223], v[120:123], v[108:111], v[220:223]
    v_cvt_pk_bf16_f32 v105, v90, v91
    v_mfma_f32_16x16x32_bf16 v[248:251], v[124:127], v[108:111], v[248:251]
    v_exp_f32 v94, v94
    v_mfma_f32_16x16x32_bf16 a[132:135], v[128:131], v[108:111], a[132:135]
    v_exp_f32 v95, v95
    v_mfma_f32_16x16x32_bf16 a[160:163], v[132:135], v[108:111], a[160:163]
    v_add_f32 v24, v24, v92
    v_add_f32 v25, v25, v93
    v_mfma_f32_16x16x32_bf16 a[188:191], v[136:139], v[108:111], a[188:191]
    v_cvt_pk_bf16_f32 v106, v92, v93
    v_add_f32 v24, v24, v94
    v_mfma_f32_16x16x32_bf16 a[216:219], v[140:143], v[108:111], a[216:219]
    v_add_f32 v25, v25, v95
    v_cvt_pk_bf16_f32 v107, v94, v95
    s_cmp_lg_u32 s69, 0
    s_cbranch_scc1 L_at_atailB
    v_mfma_f32_16x16x32_bf16 v[88:91], v[56:59], a[16:19], v[32:35]
    v_mfma_f32_16x16x32_bf16 v[88:91], v[60:63], a[20:23], v[88:91]
    v_exp_f32 v96, v96
    v_mfma_f32_16x16x32_bf16 v[88:91], v[64:67], a[24:27], v[88:91]
    v_exp_f32 v97, v97
    v_mfma_f32_16x16x32_bf16 v[88:91], v[68:71], a[28:31], v[88:91]
    v_exp_f32 v98, v98
    v_mfma_f32_16x16x32_bf16 v[92:95], v[72:75], a[16:19], v[32:35]
    v_exp_f32 v99, v99
    v_mfma_f32_16x16x32_bf16 v[92:95], v[76:79], a[20:23], v[92:95]
    v_add_f32 v12, v12, v96
    v_add_f32 v13, v13, v97
    v_mfma_f32_16x16x32_bf16 v[92:95], v[80:83], a[24:27], v[92:95]
    v_cvt_pk_bf16_f32 v108, v96, v97
    v_mfma_f32_16x16x32_bf16 v[92:95], v[84:87], a[28:31], v[92:95]
    v_exp_f32 v100, v100
    v_mfma_f32_16x16x32_bf16 v[168:171], v[112:115], v[104:107], v[168:171]
    ds_read_b64_tr_b16 v[112:113], v9 offset:8448
    ds_read_b64_tr_b16 v[114:115], v9 offset:8960
    v_exp_f32 v101, v101
    v_mfma_f32_16x16x32_bf16 v[196:199], v[116:119], v[104:107], v[196:199]
    ds_read_b64_tr_b16 v[116:117], v9 offset:8480
    ds_read_b64_tr_b16 v[118:119], v9 offset:8992
    v_add_f32 v12, v12, v98
    v_add_f32 v13, v13, v99
    v_mfma_f32_16x16x32_bf16 v[224:227], v[120:123], v[104:107], v[224:227]
    ds_read_b64_tr_b16 v[120:121], v9 offset:8512
    ds_read_b64_tr_b16 v[122:123], v9 offset:9024
    v_cvt_pk_bf16_f32 v109, v98, v99
    v_mfma_f32_16x16x32_bf16 v[252:255], v[124:127], v[104:107], v[252:255]
    ds_read_b64_tr_b16 v[124:125], v9 offset:8544
    ds_read_b64_tr_b16 v[126:127], v9 offset:9056
    v_exp_f32 v102, v102
    v_mfma_f32_16x16x32_bf16 a[136:139], v[128:131], v[104:107], a[136:139]
    ds_read_b64_tr_b16 v[128:129], v9 offset:8576
    ds_read_b64_tr_b16 v[130:131], v9 offset:9088
    v_exp_f32 v103, v103
    v_mfma_f32_16x16x32_bf16 a[164:167], v[132:135], v[104:107], a[164:167]
    ds_read_b64_tr_b16 v[132:133], v9 offset:8608
    ds_read_b64_tr_b16 v[134:135], v9 offset:9120
    v_add_f32 v12, v12, v100
    v_add_f32 v13, v13, v101
    v_mfma_f32_16x16x32_bf16 a[192:195], v[136:139], v[104:107], a[192:195]
    ds_read_b64_tr_b16 v[136:137], v9 offset:8640
    ds_read_b64_tr_b16 v[138:139], v9 offset:9152
    v_cvt_pk_bf16_f32 v110, v100, v101
    v_add_f32 v12, v12, v102
    v_mfma_f32_16x16x32_bf16 a[220:223], v[140:143], v[104:107], a[220:223]
    ds_read_b64_tr_b16 v[140:141], v9 offset:8672
    ds_read_b64_tr_b16 v[142:143], v9 offset:9184
    v_add_f32 v13, v13, v103
    v_cvt_pk_bf16_f32 v111, v102, v103
    v_mfma_f32_16x16x32_bf16 v[96:99], v[56:59], a[32:35], v[36:39]
    v_mfma_f32_16x16x32_bf16 v[96:99], v[60:63], a[36:39], v[96:99]
    s_add_u32 m0, s33, 0
    v_exp_f32 v88, v88
    v_mfma_f32_16x16x32_bf16 v[96:99], v[64:67], a[40:43], v[96:99]
    v_exp_f32 v89, v89
    v_mfma_f32_16x16x32_bf16 v[96:99], v[68:71], a[44:47], v[96:99]
    s_mov_b32 s49, s50
    v_exp_f32 v90, v90
    v_mfma_f32_16x16x32_bf16 v[100:103], v[72:75], a[32:35], v[36:39]
    v_exp_f32 v91, v91
    v_mfma_f32_16x16x32_bf16 v[100:103], v[76:79], a[36:39], v[100:103]
    s_add_u32 s50, s50, s51
    v_add_f32 v14, v14, v88
    v_add_f32 v15, v15, v89
    v_mfma_f32_16x16x32_bf16 v[100:103], v[80:83], a[40:43], v[100:103]
    v_cvt_pk_bf16_f32 v104, v88, v89
    v_mfma_f32_16x16x32_bf16 v[100:103], v[84:87], a[44:47], v[100:103]
    s_add_u32 s82, s82, 1
    v_exp_f32 v92, v92
    s_waitcnt lgkmcnt(0)
    v_mfma_f32_16x16x32_bf16 v[144:147], v[112:115], v[108:111], v[144:147]
    v_exp_f32 v93, v93
    v_mfma_f32_16x16x32_bf16 v[172:175], v[116:119], v[108:111], v[172:175]
    s_cmp_eq_u32 s82, 20
    v_add_f32 v14, v14, v90
    v_add_f32 v15, v15, v91
    v_mfma_f32_16x16x32_bf16 v[200:203], v[120:123], v[108:111], v[200:203]
    v_cvt_pk_bf16_f32 v105, v90, v91
    v_mfma_f32_16x16x32_bf16 v[228:231], v[124:127], v[108:111], v[228:231]
    s_cselect_b32 s29, s83, 0
    v_exp_f32 v94, v94
    v_mfma_f32_16x16x32_bf16 a[112:115], v[128:131], v[108:111], a[112:115]
    v_exp_f32 v95, v95
    v_mfma_f32_16x16x32_bf16 a[140:143], v[132:135], v[108:111], a[140:143]
    s_sub_u32 s50, s50, s29
    v_add_f32 v14, v14, v92
    v_add_f32 v15, v15, v93
    v_mfma_f32_16x16x32_bf16 a[168:171], v[136:139], v[108:111], a[168:171]
    v_cvt_pk_bf16_f32 v106, v92, v93
    v_add_f32 v14, v14, v94
    v_mfma_f32_16x16x32_bf16 a[196:199], v[140:143], v[108:111], a[196:199]
    s_add_u32 s28, s49, s88
    v_add_f32 v15, v15, v95
    v_cvt_pk_bf16_f32 v107, v94, v95
    v_mfma_f32_16x16x32_bf16 v[88:91], v[56:59], a[48:51], v[40:43]
    v_mfma_f32_16x16x32_bf16 v[88:91], v[60:63], a[52:55], v[88:91]
    buffer_load_dwordx4 v26, s[16:19], s28 offen lds
    v_exp_f32 v96, v96
    v_mfma_f32_16x16x32_bf16 v[88:91], v[64:67], a[56:59], v[88:91]
    v_exp_f32 v97, v97
    v_mfma_f32_16x16x32_bf16 v[88:91], v[68:71], a[60:63], v[88:91]
    s_add_u32 m0, m0, s53
    v_exp_f32 v98, v98
    v_mfma_f32_16x16x32_bf16 v[92:95], v[72:75], a[48:51], v[40:43]
    v_exp_f32 v99, v99
    v_mfma_f32_16x16x32_bf16 v[92:95], v[76:79], a[52:55], v[92:95]
    s_add_u32 s28, s49, s89
    v_add_f32 v16, v16, v96
    v_add_f32 v17, v17, v97
    v_mfma_f32_16x16x32_bf16 v[92:95], v[80:83], a[56:59], v[92:95]
    v_cvt_pk_bf16_f32 v108, v96, v97
    v_mfma_f32_16x16x32_bf16 v[92:95], v[84:87], a[60:63], v[92:95]
    buffer_load_dwordx4 v26, s[16:19], s28 offen lds
    v_exp_f32 v100, v100
    v_mfma_f32_16x16x32_bf16 v[148:151], v[112:115], v[104:107], v[148:151]
    v_exp_f32 v101, v101
    v_mfma_f32_16x16x32_bf16 v[176:179], v[116:119], v[104:107], v[176:179]
    s_add_u32 m0, m0, s53
    v_add_f32 v16, v16, v98
    v_add_f32 v17, v17, v99
    v_mfma_f32_16x16x32_bf16 v[204:207], v[120:123], v[104:107], v[204:207]
    v_cvt_pk_bf16_f32 v109, v98, v99
    v_mfma_f32_16x16x32_bf16 v[232:235], v[124:127], v[104:107], v[232:235]
    s_add_u32 s28, s49, s90
    v_exp_f32 v102, v102
    v_mfma_f32_16x16x32_bf16 a[116:119], v[128:131], v[104:107], a[116:119]
    v_exp_f32 v103, v103
    v_mfma_f32_16x16x32_bf16 a[144:147], v[132:135], v[104:107], a[144:147]
    buffer_load_dwordx4 v26, s[16:19], s28 offen lds
    v_add_f32 v16, v16, v100
    v_add_f32 v17, v17, v101
    v_mfma_f32_16x16x32_bf16 a[172:175], v[136:139], v[104:107], a[172:175]
    v_cvt_pk_bf16_f32 v110, v100, v101
    v_add_f32 v16, v16, v102
    v_mfma_f32_16x16x32_bf16 a[200:203], v[140:143], v[104:107], a[200:203]
    s_add_u32 m0, m0, s53
    v_add_f32 v17, v17, v103
    v_cvt_pk_bf16_f32 v111, v102, v103
    v_mfma_f32_16x16x32_bf16 v[96:99], v[56:59], a[64:67], v[44:47]
    v_mfma_f32_16x16x32_bf16 v[96:99], v[60:63], a[68:71], v[96:99]
    s_add_u32 s28, s49, s91
    v_exp_f32 v88, v88
    v_mfma_f32_16x16x32_bf16 v[96:99], v[64:67], a[72:75], v[96:99]
    v_exp_f32 v89, v89
    v_mfma_f32_16x16x32_bf16 v[96:99], v[68:71], a[76:79], v[96:99]
    buffer_load_dwordx4 v26, s[16:19], s28 offen lds
    v_exp_f32 v90, v90
    v_mfma_f32_16x16x32_bf16 v[100:103], v[72:75], a[64:67], v[44:47]
    v_exp_f32 v91, v91
    v_mfma_f32_16x16x32_bf16 v[100:103], v[76:79], a[68:71], v[100:103]
    s_add_u32 m0, m0, s53
    v_add_f32 v18, v18, v88
    v_add_f32 v19, v19, v89
    v_mfma_f32_16x16x32_bf16 v[100:103], v[80:83], a[72:75], v[100:103]
    v_cvt_pk_bf16_f32 v104, v88, v89
    v_mfma_f32_16x16x32_bf16 v[100:103], v[84:87], a[76:79], v[100:103]
    s_add_u32 s28, s49, s92
    v_exp_f32 v92, v92
    v_mfma_f32_16x16x32_bf16 v[152:155], v[112:115], v[108:111], v[152:155]
    v_exp_f32 v93, v93
    v_mfma_f32_16x16x32_bf16 v[180:183], v[116:119], v[108:111], v[180:183]
    buffer_load_dwordx4 v26, s[16:19], s28 offen lds
    v_add_f32 v18, v18, v90
    v_add_f32 v19, v19, v91
    v_mfma_f32_16x16x32_bf16 v[208:211], v[120:123], v[108:111], v[208:211]
    v_cvt_pk_bf16_f32 v105, v90, v91
    v_mfma_f32_16x16x32_bf16 v[236:239], v[124:127], v[108:111], v[236:239]
    s_add_u32 m0, m0, s53
    v_exp_f32 v94, v94
    v_mfma_f32_16x16x32_bf16 a[120:123], v[128:131], v[108:111], a[120:123]
    v_exp_f32 v95, v95
    v_mfma_f32_16x16x32_bf16 a[148:151], v[132:135], v[108:111], a[148:151]
    s_add_u32 s28, s49, s93
    v_add_f32 v18, v18, v92
    v_add_f32 v19, v19, v93
    v_mfma_f32_16x16x32_bf16 a[176:179], v[136:139], v[108:111], a[176:179]
    v_cvt_pk_bf16_f32 v106, v92, v93
    v_add_f32 v18, v18, v94
    v_mfma_f32_16x16x32_bf16 a[204:207], v[140:143], v[108:111], a[204:207]
    buffer_load_dwordx4 v26, s[16:19], s28 offen lds
    v_add_f32 v19, v19, v95
    v_cvt_pk_bf16_f32 v107, v94, v95
    v_mfma_f32_16x16x32_bf16 v[88:91], v[56:59], a[80:83], v[48:51]
    v_mfma_f32_16x16x32_bf16 v[88:91], v[60:63], a[84:87], v[88:91]
    s_add_u32 m0, m0, s53
    v_exp_f32 v96, v96
    v_mfma_f32_16x16x32_bf16 v[88:91], v[64:67], a[88:91], v[88:91]
    v_exp_f32 v97, v97
    v_mfma_f32_16x16x32_bf16 v[88:91], v[68:71], a[92:95], v[88:91]
    s_add_u32 s28, s49, s94
    v_exp_f32 v98, v98
    v_mfma_f32_16x16x32_bf16 v[92:95], v[72:75], a[80:83], v[48:51]
    v_exp_f32 v99, v99
    v_mfma_f32_16x16x32_bf16 v[92:95], v[76:79], a[84:87], v[92:95]
    buffer_load_dwordx4 v26, s[16:19], s28 offen lds
    v_add_f32 v20, v20, v96
    v_add_f32 v21, v21, v97
    v_mfma_f32_16x16x32_bf16 v[92:95], v[80:83], a[88:91], v[92:95]
    v_cvt_pk_bf16_f32 v108, v96, v97
    v_mfma_f32_16x16x32_bf16 v[92:95], v[84:87], a[92:95], v[92:95]
    s_add_u32 m0, m0, s53
    v_exp_f32 v100, v100
    v_mfma_f32_16x16x32_bf16 v[156:159], v[112:115], v[104:107], v[156:159]
    v_exp_f32 v101, v101
    v_mfma_f32_16x16x32_bf16 v[184:187], v[116:119], v[104:107], v[184:187]
    s_add_u32 s28, s49, s95
    v_add_f32 v20, v20, v98
    v_add_f32 v21, v21, v99
    v_mfma_f32_16x16x32_bf16 v[212:215], v[120:123], v[104:107], v[212:215]
    v_cvt_pk_bf16_f32 v109, v98, v99
    v_mfma_f32_16x16x32_bf16 v[240:243], v[124:127], v[104:107], v[240:243]
    buffer_load_dwordx4 v26, s[16:19], s28 offen lds
    v_exp_f32 v102, v102
    v_mfma_f32_16x16x32_bf16 a[124:127], v[128:131], v[104:107], a[124:127]
    v_exp_f32 v103, v103
    v_mfma_f32_16x16x32_bf16 a[152:155], v[132:135], v[104:107], a[152:155]
    v_add_f32 v20, v20, v100
    v_add_f32 v21, v21, v101
    v_mfma_f32_16x16x32_bf16 a[180:183], v[136:139], v[104:107], a[180:183]
    v_cvt_pk_bf16_f32 v110, v100, v101
    v_add_f32 v20, v20, v102
    v_mfma_f32_16x16x32_bf16 a[208:211], v[140:143], v[104:107], a[208:211]
    v_add_f32 v21, v21, v103
    v_cvt_pk_bf16_f32 v111, v102, v103
    s_waitcnt vmcnt(16) lgkmcnt(0)
    s_barrier
    v_mfma_f32_16x16x32_bf16 v[96:99], v[56:59], a[96:99], v[52:55]
    ds_read_b128 v[56:59], v8 offset:16896
    v_mfma_f32_16x16x32_bf16 v[96:99], v[60:63], a[100:103], v[96:99]
    ds_read_b128 v[60:63], v8 offset:16960
    v_exp_f32 v88, v88
    v_mfma_f32_16x16x32_bf16 v[96:99], v[64:67], a[104:107], v[96:99]
    ds_read_b128 v[64:67], v8 offset:17024
    v_exp_f32 v89, v89
    v_mfma_f32_16x16x32_bf16 v[96:99], v[68:71], a[108:111], v[96:99]
    ds_read_b128 v[68:71], v8 offset:17088
    v_exp_f32 v90, v90
    v_mfma_f32_16x16x32_bf16 v[100:103], v[72:75], a[96:99], v[52:55]
    ds_read_b128 v[72:75], v8 offset:17408
    v_exp_f32 v91, v91
    v_mfma_f32_16x16x32_bf16 v[100:103], v[76:79], a[100:103], v[100:103]
    ds_read_b128 v[76:79], v8 offset:17472
    v_add_f32 v22, v22, v88
    v_add_f32 v23, v23, v89
    v_mfma_f32_16x16x32_bf16 v[100:103], v[80:83], a[104:107], v[100:103]
    ds_read_b128 v[80:83], v8 offset:17536
    v_cvt_pk_bf16_f32 v104, v88, v89
    v_mfma_f32_16x16x32_bf16 v[100:103], v[84:87], a[108:111], v[100:103]
    ds_read_b128 v[84:87], v8 offset:17600
    v_exp_f32 v92, v92
    v_mfma_f32_16x16x32_bf16 v[160:163], v[112:115], v[108:111], v[160:163]
    v_exp_f32 v93, v93
    v_mfma_f32_16x16x32_bf16 v[188:191], v[116:119], v[108:111], v[188:191]
    v_add_f32 v22, v22, v90
    v_add_f32 v23, v23, v91
    v_mfma_f32_16x16x32_bf16 v[216:219], v[120:123], v[108:111], v[216:219]
    v_cvt_pk_bf16_f32 v105, v90, v91
    v_mfma_f32_16x16x32_bf16 v[244:247], v[124:127], v[108:111], v[244:247]
    v_exp_f32 v94, v94
    v_mfma_f32_16x16x32_bf16 a[128:131], v[128:131], v[108:111], a[128:131]
    v_exp_f32 v95, v95
    v_mfma_f32_16x16x32_bf16 a[156:159], v[132:135], v[108:111], a[156:159]
    v_add_f32 v22, v22, v92
    v_add_f32 v23, v23, v93
    v_mfma_f32_16x16x32_bf16 a[184:187], v[136:139], v[108:111], a[184:187]
    v_cvt_pk_bf16_f32 v106, v92, v93
    v_add_f32 v22, v22, v94
    v_mfma_f32_16x16x32_bf16 a[212:215], v[140:143], v[108:111], a[212:215]
    v_add_f32 v23, v23, v95
    v_cvt_pk_bf16_f32 v107, v94, v95
    s_waitcnt lgkmcnt(0)
    v_mfma_f32_16x16x32_bf16 v[88:91], v[56:59], a[0:3], v[28:31]
    v_mfma_f32_16x16x32_bf16 v[88:91], v[60:63], a[4:7], v[88:91]
    v_exp_f32 v96, v96
    v_mfma_f32_16x16x32_bf16 v[88:91], v[64:67], a[8:11], v[88:91]
    v_exp_f32 v97, v97
    v_mfma_f32_16x16x32_bf16 v[88:91], v[68:71], a[12:15], v[88:91]
    v_exp_f32 v98, v98
    v_mfma_f32_16x16x32_bf16 v[92:95], v[72:75], a[0:3], v[28:31]
    v_exp_f32 v99, v99
    v_mfma_f32_16x16x32_bf16 v[92:95], v[76:79], a[4:7], v[92:95]
    v_add_f32 v24, v24, v96
    v_add_f32 v25, v25, v97
    v_mfma_f32_16x16x32_bf16 v[92:95], v[80:83], a[8:11], v[92:95]
    v_cvt_pk_bf16_f32 v108, v96, v97
    v_mfma_f32_16x16x32_bf16 v[92:95], v[84:87], a[12:15], v[92:95]
    v_exp_f32 v100, v100
    v_mfma_f32_16x16x32_bf16 v[164:167], v[112:115], v[104:107], v[164:167]
    v_exp_f32 v101, v101
    v_mfma_f32_16x16x32_bf16 v[192:195], v[116:119], v[104:107], v[192:195]
    v_add_f32 v24, v24, v98
    v_add_f32 v25, v25, v99
    v_mfma_f32_16x16x32_bf16 v[220:223], v[120:123], v[104:107], v[220:223]
    v_cvt_pk_bf16_f32 v109, v98, v99
    v_mfma_f32_16x16x32_bf16 v[248:251], v[124:127], v[104:107], v[248:251]
    v_exp_f32 v102, v102
    v_mfma_f32_16x16x32_bf16 a[132:135], v[128:131], v[104:107], a[132:135]
    v_exp_f32 v103, v103
    v_mfma_f32_16x16x32_bf16 a[160:163], v[132:135], v[104:107], a[160:163]
    v_add_f32 v24, v24, v100
    v_add_f32 v25, v25, v101
    v_mfma_f32_16x16x32_bf16 a[188:191], v[136:139], v[104:107], a[188:191]
    v_cvt_pk_bf16_f32 v110, v100, v101
    v_add_f32 v24, v24, v102
    v_mfma_f32_16x16x32_bf16 a[216:219], v[140:143], v[104:107], a[216:219]
    v_add_f32 v25, v25, v103
    v_cvt_pk_bf16_f32 v111, v102, v103
    v_mfma_f32_16x16x32_bf16 v[96:99], v[56:59], a[16:19], v[32:35]
    v_mfma_f32_16x16x32_bf16 v[96:99], v[60:63], a[20:23], v[96:99]
    v_exp_f32 v88, v88
    v_mfma_f32_16x16x32_bf16 v[96:99], v[64:67], a[24:27], v[96:99]
    v_exp_f32 v89, v89
    v_mfma_f32_16x16x32_bf16 v[96:99], v[68:71], a[28:31], v[96:99]
    v_exp_f32 v90, v90
    v_mfma_f32_16x16x32_bf16 v[100:103], v[72:75], a[16:19], v[32:35]
    v_exp_f32 v91, v91
    v_mfma_f32_16x16x32_bf16 v[100:103], v[76:79], a[20:23], v[100:103]
    v_add_f32 v12, v12, v88
    v_add_f32 v13, v13, v89
    v_mfma_f32_16x16x32_bf16 v[100:103], v[80:83], a[24:27], v[100:103]
    v_cvt_pk_bf16_f32 v104, v88, v89
    v_mfma_f32_16x16x32_bf16 v[100:103], v[84:87], a[28:31], v[100:103]
    v_exp_f32 v92, v92
    v_mfma_f32_16x16x32_bf16 v[168:171], v[112:115], v[108:111], v[168:171]
    ds_read_b64_tr_b16 v[112:113], v9 offset:16896
    ds_read_b64_tr_b16 v[114:115], v9 offset:17408
    v_exp_f32 v93, v93
    v_mfma_f32_16x16x32_bf16 v[196:199], v[116:119], v[108:111], v[196:199]
    ds_read_b64_tr_b16 v[116:117], v9 offset:16928
    ds_read_b64_tr_b16 v[118:119], v9 offset:17440
    v_add_f32 v12, v12, v90
    v_add_f32 v13, v13, v91
    v_mfma_f32_16x16x32_bf16 v[224:227], v[120:123], v[108:111], v[224:227]
    ds_read_b64_tr_b16 v[120:121], v9 offset:16960
    ds_read_b64_tr_b16 v[122:123], v9 offset:17472
    v_cvt_pk_bf16_f32 v105, v90, v91
    v_mfma_f32_16x16x32_bf16 v[252:255], v[124:127], v[108:111], v[252:255]
    ds_read_b64_tr_b16 v[124:125], v9 offset:16992
    ds_read_b64_tr_b16 v[126:127], v9 offset:17504
    v_exp_f32 v94, v94
    v_mfma_f32_16x16x32_bf16 a[136:139], v[128:131], v[108:111], a[136:139]
    ds_read_b64_tr_b16 v[128:129], v9 offset:17024
    ds_read_b64_tr_b16 v[130:131], v9 offset:17536
    v_exp_f32 v95, v95
    v_mfma_f32_16x16x32_bf16 a[164:167], v[132:135], v[108:111], a[164:167]
    ds_read_b64_tr_b16 v[132:133], v9 offset:17056
    ds_read_b64_tr_b16 v[134:135], v9 offset:17568
    v_add_f32 v12, v12, v92
    v_add_f32 v13, v13, v93
    v_mfma_f32_16x16x32_bf16 a[192:195], v[136:139], v[108:111], a[192:195]
    ds_read_b64_tr_b16 v[136:137], v9 offset:17088
    ds_read_b64_tr_b16 v[138:139], v9 offset:17600
    v_cvt_pk_bf16_f32 v106, v92, v93
    v_add_f32 v12, v12, v94
    v_mfma_f32_16x16x32_bf16 a[220:223], v[140:143], v[108:111], a[220:223]
    ds_read_b64_tr_b16 v[140:141], v9 offset:17120
    ds_read_b64_tr_b16 v[142:143], v9 offset:17632
    v_add_f32 v13, v13, v95
    v_cvt_pk_bf16_f32 v107, v94, v95
    v_mfma_f32_16x16x32_bf16 v[88:91], v[56:59], a[32:35], v[36:39]
    v_mfma_f32_16x16x32_bf16 v[88:91], v[60:63], a[36:39], v[88:91]
    s_add_u32 m0, s33, 8448
    v_exp_f32 v96, v96
    v_mfma_f32_16x16x32_bf16 v[88:91], v[64:67], a[40:43], v[88:91]
    v_exp_f32 v97, v97
    v_mfma_f32_16x16x32_bf16 v[88:91], v[68:71], a[44:47], v[88:91]
    s_mov_b32 s49, s50
    v_exp_f32 v98, v98
    v_mfma_f32_16x16x32_bf16 v[92:95], v[72:75], a[32:35], v[36:39]
    v_exp_f32 v99, v99
    v_mfma_f32_16x16x32_bf16 v[92:95], v[76:79], a[36:39], v[92:95]
    s_add_u32 s50, s50, s51
    v_add_f32 v14, v14, v96
    v_add_f32 v15, v15, v97
    v_mfma_f32_16x16x32_bf16 v[92:95], v[80:83], a[40:43], v[92:95]
    v_cvt_pk_bf16_f32 v108, v96, v97
    v_mfma_f32_16x16x32_bf16 v[92:95], v[84:87], a[44:47], v[92:95]
    s_add_u32 s82, s82, 1
    v_exp_f32 v100, v100
    s_waitcnt lgkmcnt(0)
    v_mfma_f32_16x16x32_bf16 v[144:147], v[112:115], v[104:107], v[144:147]
    v_exp_f32 v101, v101
    v_mfma_f32_16x16x32_bf16 v[172:175], v[116:119], v[104:107], v[172:175]
    s_cmp_eq_u32 s82, 20
    v_add_f32 v14, v14, v98
    v_add_f32 v15, v15, v99
    v_mfma_f32_16x16x32_bf16 v[200:203], v[120:123], v[104:107], v[200:203]
    v_cvt_pk_bf16_f32 v109, v98, v99
    v_mfma_f32_16x16x32_bf16 v[228:231], v[124:127], v[104:107], v[228:231]
    s_cselect_b32 s29, s83, 0
    v_exp_f32 v102, v102
    v_mfma_f32_16x16x32_bf16 a[112:115], v[128:131], v[104:107], a[112:115]
    v_exp_f32 v103, v103
    v_mfma_f32_16x16x32_bf16 a[140:143], v[132:135], v[104:107], a[140:143]
    s_sub_u32 s50, s50, s29
    v_add_f32 v14, v14, v100
    v_add_f32 v15, v15, v101
    v_mfma_f32_16x16x32_bf16 a[168:171], v[136:139], v[104:107], a[168:171]
    v_cvt_pk_bf16_f32 v110, v100, v101
    v_add_f32 v14, v14, v102
    v_mfma_f32_16x16x32_bf16 a[196:199], v[140:143], v[104:107], a[196:199]
    s_add_u32 s28, s49, s88
    v_add_f32 v15, v15, v103
    v_cvt_pk_bf16_f32 v111, v102, v103
    v_mfma_f32_16x16x32_bf16 v[96:99], v[56:59], a[48:51], v[40:43]
    v_mfma_f32_16x16x32_bf16 v[96:99], v[60:63], a[52:55], v[96:99]
    buffer_load_dwordx4 v26, s[16:19], s28 offen lds
    v_exp_f32 v88, v88
    v_mfma_f32_16x16x32_bf16 v[96:99], v[64:67], a[56:59], v[96:99]
    v_exp_f32 v89, v89
    v_mfma_f32_16x16x32_bf16 v[96:99], v[68:71], a[60:63], v[96:99]
    s_add_u32 m0, m0, s53
    v_exp_f32 v90, v90
    v_mfma_f32_16x16x32_bf16 v[100:103], v[72:75], a[48:51], v[40:43]
    v_exp_f32 v91, v91
    v_mfma_f32_16x16x32_bf16 v[100:103], v[76:79], a[52:55], v[100:103]
    s_add_u32 s28, s49, s89
    v_add_f32 v16, v16, v88
    v_add_f32 v17, v17, v89
    v_mfma_f32_16x16x32_bf16 v[100:103], v[80:83], a[56:59], v[100:103]
    v_cvt_pk_bf16_f32 v104, v88, v89
    v_mfma_f32_16x16x32_bf16 v[100:103], v[84:87], a[60:63], v[100:103]
    buffer_load_dwordx4 v26, s[16:19], s28 offen lds
    v_exp_f32 v92, v92
    v_mfma_f32_16x16x32_bf16 v[148:151], v[112:115], v[108:111], v[148:151]
    v_exp_f32 v93, v93
    v_mfma_f32_16x16x32_bf16 v[176:179], v[116:119], v[108:111], v[176:179]
    s_add_u32 m0, m0, s53
    v_add_f32 v16, v16, v90
    v_add_f32 v17, v17, v91
    v_mfma_f32_16x16x32_bf16 v[204:207], v[120:123], v[108:111], v[204:207]
    v_cvt_pk_bf16_f32 v105, v90, v91
    v_mfma_f32_16x16x32_bf16 v[232:235], v[124:127], v[108:111], v[232:235]
    s_add_u32 s28, s49, s90
    v_exp_f32 v94, v94
    v_mfma_f32_16x16x32_bf16 a[116:119], v[128:131], v[108:111], a[116:119]
    v_exp_f32 v95, v95
    v_mfma_f32_16x16x32_bf16 a[144:147], v[132:135], v[108:111], a[144:147]
    buffer_load_dwordx4 v26, s[16:19], s28 offen lds
    v_add_f32 v16, v16, v92
    v_add_f32 v17, v17, v93
    v_mfma_f32_16x16x32_bf16 a[172:175], v[136:139], v[108:111], a[172:175]
    v_cvt_pk_bf16_f32 v106, v92, v93
    v_add_f32 v16, v16, v94
    v_mfma_f32_16x16x32_bf16 a[200:203], v[140:143], v[108:111], a[200:203]
    s_add_u32 m0, m0, s53
    v_add_f32 v17, v17, v95
    v_cvt_pk_bf16_f32 v107, v94, v95
    v_mfma_f32_16x16x32_bf16 v[88:91], v[56:59], a[64:67], v[44:47]
    v_mfma_f32_16x16x32_bf16 v[88:91], v[60:63], a[68:71], v[88:91]
    s_add_u32 s28, s49, s91
    v_exp_f32 v96, v96
    v_mfma_f32_16x16x32_bf16 v[88:91], v[64:67], a[72:75], v[88:91]
    v_exp_f32 v97, v97
    v_mfma_f32_16x16x32_bf16 v[88:91], v[68:71], a[76:79], v[88:91]
    buffer_load_dwordx4 v26, s[16:19], s28 offen lds
    v_exp_f32 v98, v98
    v_mfma_f32_16x16x32_bf16 v[92:95], v[72:75], a[64:67], v[44:47]
    v_exp_f32 v99, v99
    v_mfma_f32_16x16x32_bf16 v[92:95], v[76:79], a[68:71], v[92:95]
    s_add_u32 m0, m0, s53
    v_add_f32 v18, v18, v96
    v_add_f32 v19, v19, v97
    v_mfma_f32_16x16x32_bf16 v[92:95], v[80:83], a[72:75], v[92:95]
    v_cvt_pk_bf16_f32 v108, v96, v97
    v_mfma_f32_16x16x32_bf16 v[92:95], v[84:87], a[76:79], v[92:95]
    s_add_u32 s28, s49, s92
    v_exp_f32 v100, v100
    v_mfma_f32_16x16x32_bf16 v[152:155], v[112:115], v[104:107], v[152:155]
    v_exp_f32 v101, v101
    v_mfma_f32_16x16x32_bf16 v[180:183], v[116:119], v[104:107], v[180:183]
    buffer_load_dwordx4 v26, s[16:19], s28 offen lds
    v_add_f32 v18, v18, v98
    v_add_f32 v19, v19, v99
    v_mfma_f32_16x16x32_bf16 v[208:211], v[120:123], v[104:107], v[208:211]
    v_cvt_pk_bf16_f32 v109, v98, v99
    v_mfma_f32_16x16x32_bf16 v[236:239], v[124:127], v[104:107], v[236:239]
    s_add_u32 m0, m0, s53
    v_exp_f32 v102, v102
    v_mfma_f32_16x16x32_bf16 a[120:123], v[128:131], v[104:107], a[120:123]
    v_exp_f32 v103, v103
    v_mfma_f32_16x16x32_bf16 a[148:151], v[132:135], v[104:107], a[148:151]
    s_add_u32 s28, s49, s93
    v_add_f32 v18, v18, v100
    v_add_f32 v19, v19, v101
    v_mfma_f32_16x16x32_bf16 a[176:179], v[136:139], v[104:107], a[176:179]
    v_cvt_pk_bf16_f32 v110, v100, v101
    v_add_f32 v18, v18, v102
    v_mfma_f32_16x16x32_bf16 a[204:207], v[140:143], v[104:107], a[204:207]
    buffer_load_dwordx4 v26, s[16:19], s28 offen lds
    v_add_f32 v19, v19, v103
    v_cvt_pk_bf16_f32 v111, v102, v103
    v_mfma_f32_16x16x32_bf16 v[96:99], v[56:59], a[80:83], v[48:51]
    v_mfma_f32_16x16x32_bf16 v[96:99], v[60:63], a[84:87], v[96:99]
    s_add_u32 m0, m0, s53
    v_exp_f32 v88, v88
    v_mfma_f32_16x16x32_bf16 v[96:99], v[64:67], a[88:91], v[96:99]
    v_exp_f32 v89, v89
    v_mfma_f32_16x16x32_bf16 v[96:99], v[68:71], a[92:95], v[96:99]
    s_add_u32 s28, s49, s94
    v_exp_f32 v90, v90
    v_mfma_f32_16x16x32_bf16 v[100:103], v[72:75], a[80:83], v[48:51]
    v_exp_f32 v91, v91
    v_mfma_f32_16x16x32_bf16 v[100:103], v[76:79], a[84:87], v[100:103]
    buffer_load_dwordx4 v26, s[16:19], s28 offen lds
    v_add_f32 v20, v20, v88
    v_add_f32 v21, v21, v89
    v_mfma_f32_16x16x32_bf16 v[100:103], v[80:83], a[88:91], v[100:103]
    v_cvt_pk_bf16_f32 v104, v88, v89
    v_mfma_f32_16x16x32_bf16 v[100:103], v[84:87], a[92:95], v[100:103]
    s_add_u32 m0, m0, s53
    v_exp_f32 v92, v92
    v_mfma_f32_16x16x32_bf16 v[156:159], v[112:115], v[108:111], v[156:159]
    v_exp_f32 v93, v93
    v_mfma_f32_16x16x32_bf16 v[184:187], v[116:119], v[108:111], v[184:187]
    s_add_u32 s28, s49, s95
    v_add_f32 v20, v20, v90
    v_add_f32 v21, v21, v91
    v_mfma_f32_16x16x32_bf16 v[212:215], v[120:123], v[108:111], v[212:215]
    v_cvt_pk_bf16_f32 v105, v90, v91
    v_mfma_f32_16x16x32_bf16 v[240:243], v[124:127], v[108:111], v[240:243]
    buffer_load_dwordx4 v26, s[16:19], s28 offen lds
    v_exp_f32 v94, v94
    v_mfma_f32_16x16x32_bf16 a[124:127], v[128:131], v[108:111], a[124:127]
    v_exp_f32 v95, v95
    v_mfma_f32_16x16x32_bf16 a[152:155], v[132:135], v[108:111], a[152:155]
    v_add_f32 v20, v20, v92
    v_add_f32 v21, v21, v93
    v_mfma_f32_16x16x32_bf16 a[180:183], v[136:139], v[108:111], a[180:183]
    v_cvt_pk_bf16_f32 v106, v92, v93
    v_add_f32 v20, v20, v94
    v_mfma_f32_16x16x32_bf16 a[208:211], v[140:143], v[108:111], a[208:211]
    v_add_f32 v21, v21, v95
    v_cvt_pk_bf16_f32 v107, v94, v95
    s_waitcnt vmcnt(16) lgkmcnt(0)
    s_barrier
    v_mfma_f32_16x16x32_bf16 v[88:91], v[56:59], a[96:99], v[52:55]
    ds_read_b128 v[56:59], v8 offset:25344
    v_mfma_f32_16x16x32_bf16 v[88:91], v[60:63], a[100:103], v[88:91]
    ds_read_b128 v[60:63], v8 offset:25408
    v_exp_f32 v96, v96
    v_mfma_f32_16x16x32_bf16 v[88:91], v[64:67], a[104:107], v[88:91]
    ds_read_b128 v[64:67], v8 offset:25472
    v_exp_f32 v97, v97
    v_mfma_f32_16x16x32_bf16 v[88:91], v[68:71], a[108:111], v[88:91]
    ds_read_b128 v[68:71], v8 offset:25536
    v_exp_f32 v98, v98
    v_mfma_f32_16x16x32_bf16 v[92:95], v[72:75], a[96:99], v[52:55]
    ds_read_b128 v[72:75], v8 offset:25856
    v_exp_f32 v99, v99
    v_mfma_f32_16x16x32_bf16 v[92:95], v[76:79], a[100:103], v[92:95]
    ds_read_b128 v[76:79], v8 offset:25920
    v_add_f32 v22, v22, v96
    v_add_f32 v23, v23, v97
    v_mfma_f32_16x16x32_bf16 v[92:95], v[80:83], a[104:107], v[92:95]
    ds_read_b128 v[80:83], v8 offset:25984
    v_cvt_pk_bf16_f32 v108, v96, v97
    v_mfma_f32_16x16x32_bf16 v[92:95], v[84:87], a[108:111], v[92:95]
    ds_read_b128 v[84:87], v8 offset:26048
    v_exp_f32 v100, v100
    v_mfma_f32_16x16x32_bf16 v[160:163], v[112:115], v[104:107], v[160:163]
    v_exp_f32 v101, v101
    v_mfma_f32_16x16x32_bf16 v[188:191], v[116:119], v[104:107], v[188:191]
    v_add_f32 v22, v22, v98
    v_add_f32 v23, v23, v99
    v_mfma_f32_16x16x32_bf16 v[216:219], v[120:123], v[104:107], v[216:219]
    v_cvt_pk_bf16_f32 v109, v98, v99
    v_mfma_f32_16x16x32_bf16 v[244:247], v[124:127], v[104:107], v[244:247]
    v_exp_f32 v102, v102
    v_mfma_f32_16x16x32_bf16 a[128:131], v[128:131], v[104:107], a[128:131]
    v_exp_f32 v103, v103
    v_mfma_f32_16x16x32_bf16 a[156:159], v[132:135], v[104:107], a[156:159]
    v_add_f32 v22, v22, v100
    v_add_f32 v23, v23, v101
    v_mfma_f32_16x16x32_bf16 a[184:187], v[136:139], v[104:107], a[184:187]
    v_cvt_pk_bf16_f32 v110, v100, v101
    v_add_f32 v22, v22, v102
    v_mfma_f32_16x16x32_bf16 a[212:215], v[140:143], v[104:107], a[212:215]
    v_add_f32 v23, v23, v103
    v_cvt_pk_bf16_f32 v111, v102, v103
    s_waitcnt lgkmcnt(0)
    v_mfma_f32_16x16x32_bf16 v[96:99], v[56:59], a[0:3], v[28:31]
    v_mfma_f32_16x16x32_bf16 v[96:99], v[60:63], a[4:7], v[96:99]
    v_exp_f32 v88, v88
    v_mfma_f32_16x16x32_bf16 v[96:99], v[64:67], a[8:11], v[96:99]
    v_exp_f32 v89, v89
    v_mfma_f32_16x16x32_bf16 v[96:99], v[68:71], a[12:15], v[96:99]
    v_exp_f32 v90, v90
    v_mfma_f32_16x16x32_bf16 v[100:103], v[72:75], a[0:3], v[28:31]
    v_exp_f32 v91, v91
    v_mfma_f32_16x16x32_bf16 v[100:103], v[76:79], a[4:7], v[100:103]
    v_add_f32 v24, v24, v88
    v_add_f32 v25, v25, v89
    v_mfma_f32_16x16x32_bf16 v[100:103], v[80:83], a[8:11], v[100:103]
    v_cvt_pk_bf16_f32 v104, v88, v89
    v_mfma_f32_16x16x32_bf16 v[100:103], v[84:87], a[12:15], v[100:103]
    v_exp_f32 v92, v92
    v_mfma_f32_16x16x32_bf16 v[164:167], v[112:115], v[108:111], v[164:167]
    v_exp_f32 v93, v93
    v_mfma_f32_16x16x32_bf16 v[192:195], v[116:119], v[108:111], v[192:195]
    v_add_f32 v24, v24, v90
    v_add_f32 v25, v25, v91
    v_mfma_f32_16x16x32_bf16 v[220:223], v[120:123], v[108:111], v[220:223]
    v_cvt_pk_bf16_f32 v105, v90, v91
    v_mfma_f32_16x16x32_bf16 v[248:251], v[124:127], v[108:111], v[248:251]
    v_exp_f32 v94, v94
    v_mfma_f32_16x16x32_bf16 a[132:135], v[128:131], v[108:111], a[132:135]
    v_exp_f32 v95, v95
    v_mfma_f32_16x16x32_bf16 a[160:163], v[132:135], v[108:111], a[160:163]
    v_add_f32 v24, v24, v92
    v_add_f32 v25, v25, v93
    v_mfma_f32_16x16x32_bf16 a[188:191], v[136:139], v[108:111], a[188:191]
    v_cvt_pk_bf16_f32 v106, v92, v93
    v_add_f32 v24, v24, v94
    v_mfma_f32_16x16x32_bf16 a[216:219], v[140:143], v[108:111], a[216:219]
    v_add_f32 v25, v25, v95
    v_cvt_pk_bf16_f32 v107, v94, v95
    v_mfma_f32_16x16x32_bf16 v[88:91], v[56:59], a[16:19], v[32:35]
    v_mfma_f32_16x16x32_bf16 v[88:91], v[60:63], a[20:23], v[88:91]
    v_exp_f32 v96, v96
    v_mfma_f32_16x16x32_bf16 v[88:91], v[64:67], a[24:27], v[88:91]
    v_exp_f32 v97, v97
    v_mfma_f32_16x16x32_bf16 v[88:91], v[68:71], a[28:31], v[88:91]
    v_exp_f32 v98, v98
    v_mfma_f32_16x16x32_bf16 v[92:95], v[72:75], a[16:19], v[32:35]
    v_exp_f32 v99, v99
    v_mfma_f32_16x16x32_bf16 v[92:95], v[76:79], a[20:23], v[92:95]
    v_add_f32 v12, v12, v96
    v_add_f32 v13, v13, v97
    v_mfma_f32_16x16x32_bf16 v[92:95], v[80:83], a[24:27], v[92:95]
    v_cvt_pk_bf16_f32 v108, v96, v97
    v_mfma_f32_16x16x32_bf16 v[92:95], v[84:87], a[28:31], v[92:95]
    v_exp_f32 v100, v100
    v_mfma_f32_16x16x32_bf16 v[168:171], v[112:115], v[104:107], v[168:171]
    ds_read_b64_tr_b16 v[112:113], v9 offset:25344
    ds_read_b64_tr_b16 v[114:115], v9 offset:25856
    v_exp_f32 v101, v101
    v_mfma_f32_16x16x32_bf16 v[196:199], v[116:119], v[104:107], v[196:199]
    ds_read_b64_tr_b16 v[116:117], v9 offset:25376
    ds_read_b64_tr_b16 v[118:119], v9 offset:25888
    v_add_f32 v12, v12, v98
    v_add_f32 v13, v13, v99
    v_mfma_f32_16x16x32_bf16 v[224:227], v[120:123], v[104:107], v[224:227]
    ds_read_b64_tr_b16 v[120:121], v9 offset:25408
    ds_read_b64_tr_b16 v[122:123], v9 offset:25920
    v_cvt_pk_bf16_f32 v109, v98, v99
    v_mfma_f32_16x16x32_bf16 v[252:255], v[124:127], v[104:107], v[252:255]
    ds_read_b64_tr_b16 v[124:125], v9 offset:25440
    ds_read_b64_tr_b16 v[126:127], v9 offset:25952
    v_exp_f32 v102, v102
    v_mfma_f32_16x16x32_bf16 a[136:139], v[128:131], v[104:107], a[136:139]
    ds_read_b64_tr_b16 v[128:129], v9 offset:25472
    ds_read_b64_tr_b16 v[130:131], v9 offset:25984
    v_exp_f32 v103, v103
    v_mfma_f32_16x16x32_bf16 a[164:167], v[132:135], v[104:107], a[164:167]
    ds_read_b64_tr_b16 v[132:133], v9 offset:25504
    ds_read_b64_tr_b16 v[134:135], v9 offset:26016
    v_add_f32 v12, v12, v100
    v_add_f32 v13, v13, v101
    v_mfma_f32_16x16x32_bf16 a[192:195], v[136:139], v[104:107], a[192:195]
    ds_read_b64_tr_b16 v[136:137], v9 offset:25536
    ds_read_b64_tr_b16 v[138:139], v9 offset:26048
    v_cvt_pk_bf16_f32 v110, v100, v101
    v_add_f32 v12, v12, v102
    v_mfma_f32_16x16x32_bf16 a[220:223], v[140:143], v[104:107], a[220:223]
    ds_read_b64_tr_b16 v[140:141], v9 offset:25568
    ds_read_b64_tr_b16 v[142:143], v9 offset:26080
    v_add_f32 v13, v13, v103
    v_cvt_pk_bf16_f32 v111, v102, v103
    v_mfma_f32_16x16x32_bf16 v[96:99], v[56:59], a[32:35], v[36:39]
    v_mfma_f32_16x16x32_bf16 v[96:99], v[60:63], a[36:39], v[96:99]
    s_add_u32 m0, s33, 16896
    v_exp_f32 v88, v88
    v_mfma_f32_16x16x32_bf16 v[96:99], v[64:67], a[40:43], v[96:99]
    v_exp_f32 v89, v89
    v_mfma_f32_16x16x32_bf16 v[96:99], v[68:71], a[44:47], v[96:99]
    s_mov_b32 s49, s50
    v_exp_f32 v90, v90
    v_mfma_f32_16x16x32_bf16 v[100:103], v[72:75], a[32:35], v[36:39]
    v_exp_f32 v91, v91
    v_mfma_f32_16x16x32_bf16 v[100:103], v[76:79], a[36:39], v[100:103]
    s_add_u32 s50, s50, s51
    v_add_f32 v14, v14, v88
    v_add_f32 v15, v15, v89
    v_mfma_f32_16x16x32_bf16 v[100:103], v[80:83], a[40:43], v[100:103]
    v_cvt_pk_bf16_f32 v104, v88, v89
    v_mfma_f32_16x16x32_bf16 v[100:103], v[84:87], a[44:47], v[100:103]
    s_add_u32 s82, s82, 1
    v_exp_f32 v92, v92
    s_waitcnt lgkmcnt(0)
    v_mfma_f32_16x16x32_bf16 v[144:147], v[112:115], v[108:111], v[144:147]
    v_exp_f32 v93, v93
    v_mfma_f32_16x16x32_bf16 v[172:175], v[116:119], v[108:111], v[172:175]
    s_cmp_eq_u32 s82, 20
    v_add_f32 v14, v14, v90
    v_add_f32 v15, v15, v91
    v_mfma_f32_16x16x32_bf16 v[200:203], v[120:123], v[108:111], v[200:203]
    v_cvt_pk_bf16_f32 v105, v90, v91
    v_mfma_f32_16x16x32_bf16 v[228:231], v[124:127], v[108:111], v[228:231]
    s_cselect_b32 s29, s83, 0
    v_exp_f32 v94, v94
    v_mfma_f32_16x16x32_bf16 a[112:115], v[128:131], v[108:111], a[112:115]
    v_exp_f32 v95, v95
    v_mfma_f32_16x16x32_bf16 a[140:143], v[132:135], v[108:111], a[140:143]
    s_sub_u32 s50, s50, s29
    v_add_f32 v14, v14, v92
    v_add_f32 v15, v15, v93
    v_mfma_f32_16x16x32_bf16 a[168:171], v[136:139], v[108:111], a[168:171]
    v_cvt_pk_bf16_f32 v106, v92, v93
    v_add_f32 v14, v14, v94
    v_mfma_f32_16x16x32_bf16 a[196:199], v[140:143], v[108:111], a[196:199]
    s_add_u32 s28, s49, s88
    v_add_f32 v15, v15, v95
    v_cvt_pk_bf16_f32 v107, v94, v95
    v_mfma_f32_16x16x32_bf16 v[88:91], v[56:59], a[48:51], v[40:43]
    v_mfma_f32_16x16x32_bf16 v[88:91], v[60:63], a[52:55], v[88:91]
    buffer_load_dwordx4 v26, s[16:19], s28 offen lds
    v_exp_f32 v96, v96
    v_mfma_f32_16x16x32_bf16 v[88:91], v[64:67], a[56:59], v[88:91]
    v_exp_f32 v97, v97
    v_mfma_f32_16x16x32_bf16 v[88:91], v[68:71], a[60:63], v[88:91]
    s_add_u32 m0, m0, s53
    v_exp_f32 v98, v98
    v_mfma_f32_16x16x32_bf16 v[92:95], v[72:75], a[48:51], v[40:43]
    v_exp_f32 v99, v99
    v_mfma_f32_16x16x32_bf16 v[92:95], v[76:79], a[52:55], v[92:95]
    s_add_u32 s28, s49, s89
    v_add_f32 v16, v16, v96
    v_add_f32 v17, v17, v97
    v_mfma_f32_16x16x32_bf16 v[92:95], v[80:83], a[56:59], v[92:95]
    v_cvt_pk_bf16_f32 v108, v96, v97
    v_mfma_f32_16x16x32_bf16 v[92:95], v[84:87], a[60:63], v[92:95]
    buffer_load_dwordx4 v26, s[16:19], s28 offen lds
    v_exp_f32 v100, v100
    v_mfma_f32_16x16x32_bf16 v[148:151], v[112:115], v[104:107], v[148:151]
    v_exp_f32 v101, v101
    v_mfma_f32_16x16x32_bf16 v[176:179], v[116:119], v[104:107], v[176:179]
    s_add_u32 m0, m0, s53
    v_add_f32 v16, v16, v98
    v_add_f32 v17, v17, v99
    v_mfma_f32_16x16x32_bf16 v[204:207], v[120:123], v[104:107], v[204:207]
    v_cvt_pk_bf16_f32 v109, v98, v99
    v_mfma_f32_16x16x32_bf16 v[232:235], v[124:127], v[104:107], v[232:235]
    s_add_u32 s28, s49, s90
    v_exp_f32 v102, v102
    v_mfma_f32_16x16x32_bf16 a[116:119], v[128:131], v[104:107], a[116:119]
    v_exp_f32 v103, v103
    v_mfma_f32_16x16x32_bf16 a[144:147], v[132:135], v[104:107], a[144:147]
    buffer_load_dwordx4 v26, s[16:19], s28 offen lds
    v_add_f32 v16, v16, v100
    v_add_f32 v17, v17, v101
    v_mfma_f32_16x16x32_bf16 a[172:175], v[136:139], v[104:107], a[172:175]
    v_cvt_pk_bf16_f32 v110, v100, v101
    v_add_f32 v16, v16, v102
    v_mfma_f32_16x16x32_bf16 a[200:203], v[140:143], v[104:107], a[200:203]
    s_add_u32 m0, m0, s53
    v_add_f32 v17, v17, v103
    v_cvt_pk_bf16_f32 v111, v102, v103
    v_mfma_f32_16x16x32_bf16 v[96:99], v[56:59], a[64:67], v[44:47]
    v_mfma_f32_16x16x32_bf16 v[96:99], v[60:63], a[68:71], v[96:99]
    s_add_u32 s28, s49, s91
    v_exp_f32 v88, v88
    v_mfma_f32_16x16x32_bf16 v[96:99], v[64:67], a[72:75], v[96:99]
    v_exp_f32 v89, v89
    v_mfma_f32_16x16x32_bf16 v[96:99], v[68:71], a[76:79], v[96:99]
    buffer_load_dwordx4 v26, s[16:19], s28 offen lds
    v_exp_f32 v90, v90
    v_mfma_f32_16x16x32_bf16 v[100:103], v[72:75], a[64:67], v[44:47]
    v_exp_f32 v91, v91
    v_mfma_f32_16x16x32_bf16 v[100:103], v[76:79], a[68:71], v[100:103]
    s_add_u32 m0, m0, s53
    v_add_f32 v18, v18, v88
    v_add_f32 v19, v19, v89
    v_mfma_f32_16x16x32_bf16 v[100:103], v[80:83], a[72:75], v[100:103]
    v_cvt_pk_bf16_f32 v104, v88, v89
    v_mfma_f32_16x16x32_bf16 v[100:103], v[84:87], a[76:79], v[100:103]
    s_add_u32 s28, s49, s92
    v_exp_f32 v92, v92
    v_mfma_f32_16x16x32_bf16 v[152:155], v[112:115], v[108:111], v[152:155]
    v_exp_f32 v93, v93
    v_mfma_f32_16x16x32_bf16 v[180:183], v[116:119], v[108:111], v[180:183]
    buffer_load_dwordx4 v26, s[16:19], s28 offen lds
    v_add_f32 v18, v18, v90
    v_add_f32 v19, v19, v91
    v_mfma_f32_16x16x32_bf16 v[208:211], v[120:123], v[108:111], v[208:211]
    v_cvt_pk_bf16_f32 v105, v90, v91
    v_mfma_f32_16x16x32_bf16 v[236:239], v[124:127], v[108:111], v[236:239]
    s_add_u32 m0, m0, s53
    v_exp_f32 v94, v94
    v_mfma_f32_16x16x32_bf16 a[120:123], v[128:131], v[108:111], a[120:123]
    v_exp_f32 v95, v95
    v_mfma_f32_16x16x32_bf16 a[148:151], v[132:135], v[108:111], a[148:151]
    s_add_u32 s28, s49, s93
    v_add_f32 v18, v18, v92
    v_add_f32 v19, v19, v93
    v_mfma_f32_16x16x32_bf16 a[176:179], v[136:139], v[108:111], a[176:179]
    v_cvt_pk_bf16_f32 v106, v92, v93
    v_add_f32 v18, v18, v94
    v_mfma_f32_16x16x32_bf16 a[204:207], v[140:143], v[108:111], a[204:207]
    buffer_load_dwordx4 v26, s[16:19], s28 offen lds
    v_add_f32 v19, v19, v95
    v_cvt_pk_bf16_f32 v107, v94, v95
    v_mfma_f32_16x16x32_bf16 v[88:91], v[56:59], a[80:83], v[48:51]
    v_mfma_f32_16x16x32_bf16 v[88:91], v[60:63], a[84:87], v[88:91]
    s_add_u32 m0, m0, s53
    v_exp_f32 v96, v96
    v_mfma_f32_16x16x32_bf16 v[88:91], v[64:67], a[88:91], v[88:91]
    v_exp_f32 v97, v97
    v_mfma_f32_16x16x32_bf16 v[88:91], v[68:71], a[92:95], v[88:91]
    s_add_u32 s28, s49, s94
    v_exp_f32 v98, v98
    v_mfma_f32_16x16x32_bf16 v[92:95], v[72:75], a[80:83], v[48:51]
    v_exp_f32 v99, v99
    v_mfma_f32_16x16x32_bf16 v[92:95], v[76:79], a[84:87], v[92:95]
    buffer_load_dwordx4 v26, s[16:19], s28 offen lds
    v_add_f32 v20, v20, v96
    v_add_f32 v21, v21, v97
    v_mfma_f32_16x16x32_bf16 v[92:95], v[80:83], a[88:91], v[92:95]
    v_cvt_pk_bf16_f32 v108, v96, v97
    v_mfma_f32_16x16x32_bf16 v[92:95], v[84:87], a[92:95], v[92:95]
    s_add_u32 m0, m0, s53
    v_exp_f32 v100, v100
    v_mfma_f32_16x16x32_bf16 v[156:159], v[112:115], v[104:107], v[156:159]
    v_exp_f32 v101, v101
    v_mfma_f32_16x16x32_bf16 v[184:187], v[116:119], v[104:107], v[184:187]
    s_add_u32 s28, s49, s95
    v_add_f32 v20, v20, v98
    v_add_f32 v21, v21, v99
    v_mfma_f32_16x16x32_bf16 v[212:215], v[120:123], v[104:107], v[212:215]
    v_cvt_pk_bf16_f32 v109, v98, v99
    v_mfma_f32_16x16x32_bf16 v[240:243], v[124:127], v[104:107], v[240:243]
    buffer_load_dwordx4 v26, s[16:19], s28 offen lds
    v_exp_f32 v102, v102
    v_mfma_f32_16x16x32_bf16 a[124:127], v[128:131], v[104:107], a[124:127]
    v_exp_f32 v103, v103
    v_mfma_f32_16x16x32_bf16 a[152:155], v[132:135], v[104:107], a[152:155]
    v_add_f32 v20, v20, v100
    v_add_f32 v21, v21, v101
    v_mfma_f32_16x16x32_bf16 a[180:183], v[136:139], v[104:107], a[180:183]
    v_cvt_pk_bf16_f32 v110, v100, v101
    v_add_f32 v20, v20, v102
    v_mfma_f32_16x16x32_bf16 a[208:211], v[140:143], v[104:107], a[208:211]
    v_add_f32 v21, v21, v103
    v_cvt_pk_bf16_f32 v111, v102, v103
    s_waitcnt vmcnt(16) lgkmcnt(0)
    s_barrier
    v_mfma_f32_16x16x32_bf16 v[96:99], v[56:59], a[96:99], v[52:55]
    s_add_u32 m0, s33, 25344
    v_mfma_f32_16x16x32_bf16 v[96:99], v[60:63], a[100:103], v[96:99]
    s_mov_b32 s49, s50
    v_exp_f32 v88, v88
    v_mfma_f32_16x16x32_bf16 v[96:99], v[64:67], a[104:107], v[96:99]
    s_add_u32 s50, s50, s51
    v_exp_f32 v89, v89
    v_mfma_f32_16x16x32_bf16 v[96:99], v[68:71], a[108:111], v[96:99]
    s_add_u32 s82, s82, 1
    v_exp_f32 v90, v90
    v_mfma_f32_16x16x32_bf16 v[100:103], v[72:75], a[96:99], v[52:55]
    s_cmp_eq_u32 s82, 20
    v_exp_f32 v91, v91
    v_mfma_f32_16x16x32_bf16 v[100:103], v[76:79], a[100:103], v[100:103]
    s_cselect_b32 s29, s83, 0
    v_add_f32 v22, v22, v88
    v_add_f32 v23, v23, v89
    v_mfma_f32_16x16x32_bf16 v[100:103], v[80:83], a[104:107], v[100:103]
    s_sub_u32 s50, s50, s29
    v_cvt_pk_bf16_f32 v104, v88, v89
    v_mfma_f32_16x16x32_bf16 v[100:103], v[84:87], a[108:111], v[100:103]
    v_exp_f32 v92, v92
    v_mfma_f32_16x16x32_bf16 v[160:163], v[112:115], v[108:111], v[160:163]
    s_add_u32 s28, s49, s88
    v_exp_f32 v93, v93
    v_mfma_f32_16x16x32_bf16 v[188:191], v[116:119], v[108:111], v[188:191]
    buffer_load_dwordx4 v26, s[16:19], s28 offen lds
    v_add_f32 v22, v22, v90
    v_add_f32 v23, v23, v91
    v_mfma_f32_16x16x32_bf16 v[216:219], v[120:123], v[108:111], v[216:219]
    s_add_u32 m0, m0, s53
    v_cvt_pk_bf16_f32 v105, v90, v91
    v_mfma_f32_16x16x32_bf16 v[244:247], v[124:127], v[108:111], v[244:247]
    s_add_u32 s28, s49, s89
    v_exp_f32 v94, v94
    v_mfma_f32_16x16x32_bf16 a[128:131], v[128:131], v[108:111], a[128:131]
    buffer_load_dwordx4 v26, s[16:19], s28 offen lds
    v_exp_f32 v95, v95
    v_mfma_f32_16x16x32_bf16 a[156:159], v[132:135], v[108:111], a[156:159]
    s_add_u32 m0, m0, s53
    v_add_f32 v22, v22, v92
    v_add_f32 v23, v23, v93
    v_mfma_f32_16x16x32_bf16 a[184:187], v[136:139], v[108:111], a[184:187]
    s_add_u32 s28, s49, s90
    v_cvt_pk_bf16_f32 v106, v92, v93
    v_add_f32 v22, v22, v94
    v_mfma_f32_16x16x32_bf16 a[212:215], v[140:143], v[108:111], a[212:215]
    buffer_load_dwordx4 v26, s[16:19], s28 offen lds
    v_add_f32 v23, v23, v95
    v_cvt_pk_bf16_f32 v107, v94, v95
    s_nop 1
    v_mfma_f32_16x16x32_bf16 v[164:167], v[112:115], v[104:107], v[164:167]
    s_add_u32 m0, m0, s53
    s_add_u32 s28, s49, s91
    v_exp_f32 v96, v96
    v_mfma_f32_16x16x32_bf16 v[192:195], v[116:119], v[104:107], v[192:195]
    buffer_load_dwordx4 v26, s[16:19], s28 offen lds
    s_add_u32 m0, m0, s53
    v_exp_f32 v97, v97
    v_exp_f32 v98, v98
    v_mfma_f32_16x16x32_bf16 v[220:223], v[120:123], v[104:107], v[220:223]
    s_add_u32 s28, s49, s92
    buffer_load_dwordx4 v26, s[16:19], s28 offen lds
    v_exp_f32 v99, v99
    v_add_f32 v24, v24, v96
    v_add_f32 v25, v25, v97
    v_mfma_f32_16x16x32_bf16 v[248:251], v[124:127], v[104:107], v[248:251]
    s_add_u32 m0, m0, s53
    v_cvt_pk_bf16_f32 v108, v96, v97
    v_exp_f32 v100, v100
    v_mfma_f32_16x16x32_bf16 a[132:135], v[128:131], v[104:107], a[132:135]
    s_add_u32 s28, s49, s93
    buffer_load_dwordx4 v26, s[16:19], s28 offen lds
    v_exp_f32 v101, v101
    v_add_f32 v24, v24, v98
    v_add_f32 v25, v25, v99
    v_mfma_f32_16x16x32_bf16 a[160:163], v[132:135], v[104:107], a[160:163]
    s_add_u32 m0, m0, s53
    s_add_u32 s28, s49, s94
    v_cvt_pk_bf16_f32 v109, v98, v99
    v_exp_f32 v102, v102
    v_mfma_f32_16x16x32_bf16 a[188:191], v[136:139], v[104:107], a[188:191]
    buffer_load_dwordx4 v26, s[16:19], s28 offen lds
    s_add_u32 m0, m0, s53
    v_exp_f32 v103, v103
    v_add_f32 v24, v24, v100
    v_add_f32 v25, v25, v101
    v_mfma_f32_16x16x32_bf16 a[216:219], v[140:143], v[104:107], a[216:219]
    s_add_u32 s28, s49, s95
    buffer_load_dwordx4 v26, s[16:19], s28 offen lds
    v_cvt_pk_bf16_f32 v110, v100, v101
    v_add_f32 v24, v24, v102
    v_add_f32 v25, v25, v103
    v_cvt_pk_bf16_f32 v111, v102, v103
    s_branch L_at_aepi
L_at_atailB:
    v_mfma_f32_16x16x32_bf16 v[88:91], v[56:59], a[16:19], v[32:35]
    v_mfma_f32_16x16x32_bf16 v[88:91], v[60:63], a[20:23], v[88:91]
    v_exp_f32 v96, v96
    v_mfma_f32_16x16x32_bf16 v[88:91], v[64:67], a[24:27], v[88:91]
    v_exp_f32 v97, v97
    v_mfma_f32_16x16x32_bf16 v[88:91], v[68:71], a[28:31], v[88:91]
    v_exp_f32 v98, v98
    v_mfma_f32_16x16x32_bf16 v[92:95], v[72:75], a[16:19], v[32:35]
    v_exp_f32 v99, v99
    v_mfma_f32_16x16x32_bf16 v[92:95], v[76:79], a[20:23], v[92:95]
    v_add_f32 v12, v12, v96
    v_add_f32 v13, v13, v97
    v_mfma_f32_16x16x32_bf16 v[92:95], v[80:83], a[24:27], v[92:95]
    v_cvt_pk_bf16_f32 v108, v96, v97
    v_mfma_f32_16x16x32_bf16 v[92:95], v[84:87], a[28:31], v[92:95]
    v_exp_f32 v100, v100
    v_mfma_f32_16x16x32_bf16 v[168:171], v[112:115], v[104:107], v[168:171]
    ds_read_b64_tr_b16 v[112:113], v9 offset:8448
    ds_read_b64_tr_b16 v[114:115], v9 offset:8960
    v_exp_f32 v101, v101
    v_mfma_f32_16x16x32_bf16 v[196:199], v[116:119], v[104:107], v[196:199]
    ds_read_b64_tr_b16 v[116:117], v9 offset:8480
    ds_read_b64_tr_b16 v[118:119], v9 offset:8992
    v_add_f32 v12, v12, v98
    v_add_f32 v13, v13, v99
    v_mfma_f32_16x16x32_bf16 v[224:227], v[120:123], v[104:107], v[224:227]
    ds_read_b64_tr_b16 v[120:121], v9 offset:8512
    ds_read_b64_tr_b16 v[122:123], v9 offset:9024
    v_cvt_pk_bf16_f32 v109, v98, v99
    v_mfma_f32_16x16x32_bf16 v[252:255], v[124:127], v[104:107], v[252:255]
    ds_read_b64_tr_b16 v[124:125], v9 offset:8544
    ds_read_b64_tr_b16 v[126:127], v9 offset:9056
    v_exp_f32 v102, v102
    v_mfma_f32_16x16x32_bf16 a[136:139], v[128:131], v[104:107], a[136:139]
    ds_read_b64_tr_b16 v[128:129], v9 offset:8576
    ds_read_b64_tr_b16 v[130:131], v9 offset:9088
    v_exp_f32 v103, v103
    v_mfma_f32_16x16x32_bf16 a[164:167], v[132:135], v[104:107], a[164:167]
    ds_read_b64_tr_b16 v[132:133], v9 offset:8608
    ds_read_b64_tr_b16 v[134:135], v9 offset:9120
    v_add_f32 v12, v12, v100
    v_add_f32 v13, v13, v101
    v_mfma_f32_16x16x32_bf16 a[192:195], v[136:139], v[104:107], a[192:195]
    ds_read_b64_tr_b16 v[136:137], v9 offset:8640
    ds_read_b64_tr_b16 v[138:139], v9 offset:9152
    v_cvt_pk_bf16_f32 v110, v100, v101
    v_add_f32 v12, v12, v102
    v_mfma_f32_16x16x32_bf16 a[220:223], v[140:143], v[104:107], a[220:223]
    ds_read_b64_tr_b16 v[140:141], v9 offset:8672
    ds_read_b64_tr_b16 v[142:143], v9 offset:9184
    v_add_f32 v13, v13, v103
    v_cvt_pk_bf16_f32 v111, v102, v103
    v_mfma_f32_16x16x32_bf16 v[96:99], v[56:59], a[32:35], v[36:39]
    v_mfma_f32_16x16x32_bf16 v[96:99], v[60:63], a[36:39], v[96:99]
    s_add_u32 s29, s34, s100
    v_exp_f32 v88, v88
    v_mfma_f32_16x16x32_bf16 v[96:99], v[64:67], a[40:43], v[96:99]
    v_exp_f32 v89, v89
    v_mfma_f32_16x16x32_bf16 v[96:99], v[68:71], a[44:47], v[96:99]
    s_bfe_u32 s28, s29, 0x20003
    v_exp_f32 v90, v90
    v_mfma_f32_16x16x32_bf16 v[100:103], v[72:75], a[32:35], v[36:39]
    v_exp_f32 v91, v91
    v_mfma_f32_16x16x32_bf16 v[100:103], v[76:79], a[36:39], v[100:103]
    s_lshl_b32 s28, s28, 16
    v_add_f32 v14, v14, v88
    v_add_f32 v15, v15, v89
    v_mfma_f32_16x16x32_bf16 v[100:103], v[80:83], a[40:43], v[100:103]
    v_cvt_pk_bf16_f32 v104, v88, v89
    v_mfma_f32_16x16x32_bf16 v[100:103], v[84:87], a[44:47], v[100:103]
    v_exp_f32 v92, v92
    s_waitcnt lgkmcnt(0)
    v_mfma_f32_16x16x32_bf16 v[144:147], v[112:115], v[108:111], v[144:147]
    s_and_b32 s29, s29, 7
    v_exp_f32 v93, v93
    v_mfma_f32_16x16x32_bf16 v[172:175], v[116:119], v[108:111], v[172:175]
    v_add_f32 v14, v14, v90
    v_add_f32 v15, v15, v91
    v_mfma_f32_16x16x32_bf16 v[200:203], v[120:123], v[108:111], v[200:203]
    s_lshl_b32 s29, s29, 11
    v_cvt_pk_bf16_f32 v105, v90, v91
    v_mfma_f32_16x16x32_bf16 v[228:231], v[124:127], v[108:111], v[228:231]
    v_exp_f32 v94, v94
    v_mfma_f32_16x16x32_bf16 a[112:115], v[128:131], v[108:111], a[112:115]
    s_add_u32 s29, s28, s29
    v_exp_f32 v95, v95
    v_mfma_f32_16x16x32_bf16 a[140:143], v[132:135], v[108:111], a[140:143]
    v_add_f32 v14, v14, v92
    v_add_f32 v15, v15, v93
    v_mfma_f32_16x16x32_bf16 a[168:171], v[136:139], v[108:111], a[168:171]
    s_lshr_b32 s28, s34, 5
    v_cvt_pk_bf16_f32 v106, v92, v93
    v_add_f32 v14, v14, v94
    v_mfma_f32_16x16x32_bf16 a[196:199], v[140:143], v[108:111], a[196:199]
    v_add_f32 v15, v15, v95
    v_cvt_pk_bf16_f32 v107, v94, v95
    v_mfma_f32_16x16x32_bf16 v[88:91], v[56:59], a[48:51], v[40:43]
    v_mfma_f32_16x16x32_bf16 v[88:91], v[60:63], a[52:55], v[88:91]
    s_lshl_b32 s28, s28, 19
    v_exp_f32 v96, v96
    v_mfma_f32_16x16x32_bf16 v[88:91], v[64:67], a[56:59], v[88:91]
    v_exp_f32 v97, v97
    v_mfma_f32_16x16x32_bf16 v[88:91], v[68:71], a[60:63], v[88:91]
    s_add_u32 s49, s28, s29
    v_exp_f32 v98, v98
    v_mfma_f32_16x16x32_bf16 v[92:95], v[72:75], a[48:51], v[40:43]
    v_exp_f32 v99, v99
    v_mfma_f32_16x16x32_bf16 v[92:95], v[76:79], a[52:55], v[92:95]
    s_add_u32 m0, s33, 0
    v_add_f32 v16, v16, v96
    v_add_f32 v17, v17, v97
    v_mfma_f32_16x16x32_bf16 v[92:95], v[80:83], a[56:59], v[92:95]
    v_cvt_pk_bf16_f32 v108, v96, v97
    v_mfma_f32_16x16x32_bf16 v[92:95], v[84:87], a[60:63], v[92:95]
    v_exp_f32 v100, v100
    v_mfma_f32_16x16x32_bf16 v[148:151], v[112:115], v[104:107], v[148:151]
    s_add_u32 s34, s34, 1
    v_exp_f32 v101, v101
    v_mfma_f32_16x16x32_bf16 v[176:179], v[116:119], v[104:107], v[176:179]
    v_add_f32 v16, v16, v98
    v_add_f32 v17, v17, v99
    v_mfma_f32_16x16x32_bf16 v[204:207], v[120:123], v[104:107], v[204:207]
    buffer_load_dwordx4 v7, s[4:7], s49 offen offset:0 nt lds
    v_cvt_pk_bf16_f32 v109, v98, v99
    v_mfma_f32_16x16x32_bf16 v[232:235], v[124:127], v[104:107], v[232:235]
    v_exp_f32 v102, v102
    v_mfma_f32_16x16x32_bf16 a[116:119], v[128:131], v[104:107], a[116:119]
    s_add_u32 m0, m0, s96
    v_exp_f32 v103, v103
    v_mfma_f32_16x16x32_bf16 a[144:147], v[132:135], v[104:107], a[144:147]
    v_add_f32 v16, v16, v100
    v_add_f32 v17, v17, v101
    v_mfma_f32_16x16x32_bf16 a[172:175], v[136:139], v[104:107], a[172:175]
    buffer_load_dwordx4 v7, s[4:7], s49 offen offset:256 nt lds
    v_cvt_pk_bf16_f32 v110, v100, v101
    v_add_f32 v16, v16, v102
    v_mfma_f32_16x16x32_bf16 a[200:203], v[140:143], v[104:107], a[200:203]
    v_add_f32 v17, v17, v103
    v_cvt_pk_bf16_f32 v111, v102, v103
    v_mfma_f32_16x16x32_bf16 v[96:99], v[56:59], a[64:67], v[44:47]
    v_mfma_f32_16x16x32_bf16 v[96:99], v[60:63], a[68:71], v[96:99]
    s_add_u32 m0, m0, s97
    v_exp_f32 v88, v88
    v_mfma_f32_16x16x32_bf16 v[96:99], v[64:67], a[72:75], v[96:99]
    v_exp_f32 v89, v89
    v_mfma_f32_16x16x32_bf16 v[96:99], v[68:71], a[76:79], v[96:99]
    buffer_load_dwordx4 v7, s[4:7], s49 offen offset:512 nt lds
    v_exp_f32 v90, v90
    v_mfma_f32_16x16x32_bf16 v[100:103], v[72:75], a[64:67], v[44:47]
    v_exp_f32 v91, v91
    v_mfma_f32_16x16x32_bf16 v[100:103], v[76:79], a[68:71], v[100:103]
    s_add_u32 m0, m0, s96
    v_add_f32 v18, v18, v88
    v_add_f32 v19, v19, v89
    v_mfma_f32_16x16x32_bf16 v[100:103], v[80:83], a[72:75], v[100:103]
    v_cvt_pk_bf16_f32 v104, v88, v89
    v_mfma_f32_16x16x32_bf16 v[100:103], v[84:87], a[76:79], v[100:103]
    v_exp_f32 v92, v92
    v_mfma_f32_16x16x32_bf16 v[152:155], v[112:115], v[108:111], v[152:155]
    buffer_load_dwordx4 v7, s[4:7], s49 offen offset:768 nt lds
    v_exp_f32 v93, v93
    v_mfma_f32_16x16x32_bf16 v[180:183], v[116:119], v[108:111], v[180:183]
    v_add_f32 v18, v18, v90
    v_add_f32 v19, v19, v91
    v_mfma_f32_16x16x32_bf16 v[208:211], v[120:123], v[108:111], v[208:211]
    s_add_u32 m0, m0, s97
    v_cvt_pk_bf16_f32 v105, v90, v91
    v_mfma_f32_16x16x32_bf16 v[236:239], v[124:127], v[108:111], v[236:239]
    v_exp_f32 v94, v94
    v_mfma_f32_16x16x32_bf16 a[120:123], v[128:131], v[108:111], a[120:123]
    buffer_load_dwordx4 v7, s[4:7], s49 offen offset:1024 nt lds
    v_exp_f32 v95, v95
    v_mfma_f32_16x16x32_bf16 a[148:151], v[132:135], v[108:111], a[148:151]
    v_add_f32 v18, v18, v92
    v_add_f32 v19, v19, v93
    v_mfma_f32_16x16x32_bf16 a[176:179], v[136:139], v[108:111], a[176:179]
    s_add_u32 m0, m0, s96
    v_cvt_pk_bf16_f32 v106, v92, v93
    v_add_f32 v18, v18, v94
    v_mfma_f32_16x16x32_bf16 a[204:207], v[140:143], v[108:111], a[204:207]
    v_add_f32 v19, v19, v95
    v_cvt_pk_bf16_f32 v107, v94, v95
    v_mfma_f32_16x16x32_bf16 v[88:91], v[56:59], a[80:83], v[48:51]
    v_mfma_f32_16x16x32_bf16 v[88:91], v[60:63], a[84:87], v[88:91]
    buffer_load_dwordx4 v7, s[4:7], s49 offen offset:1280 nt lds
    v_exp_f32 v96, v96
    v_mfma_f32_16x16x32_bf16 v[88:91], v[64:67], a[88:91], v[88:91]
    v_exp_f32 v97, v97
    v_mfma_f32_16x16x32_bf16 v[88:91], v[68:71], a[92:95], v[88:91]
    s_add_u32 m0, m0, s97
    v_exp_f32 v98, v98
    v_mfma_f32_16x16x32_bf16 v[92:95], v[72:75], a[80:83], v[48:51]
    v_exp_f32 v99, v99
    v_mfma_f32_16x16x32_bf16 v[92:95], v[76:79], a[84:87], v[92:95]
    buffer_load_dwordx4 v7, s[4:7], s49 offen offset:1536 nt lds
    v_add_f32 v20, v20, v96
    v_add_f32 v21, v21, v97
    v_mfma_f32_16x16x32_bf16 v[92:95], v[80:83], a[88:91], v[92:95]
    v_cvt_pk_bf16_f32 v108, v96, v97
    v_mfma_f32_16x16x32_bf16 v[92:95], v[84:87], a[92:95], v[92:95]
    v_exp_f32 v100, v100
    v_mfma_f32_16x16x32_bf16 v[156:159], v[112:115], v[104:107], v[156:159]
    s_add_u32 m0, m0, s96
    v_exp_f32 v101, v101
    v_mfma_f32_16x16x32_bf16 v[184:187], v[116:119], v[104:107], v[184:187]
    v_add_f32 v20, v20, v98
    v_add_f32 v21, v21, v99
    v_mfma_f32_16x16x32_bf16 v[212:215], v[120:123], v[104:107], v[212:215]
    buffer_load_dwordx4 v7, s[4:7], s49 offen offset:1792 nt lds
    v_cvt_pk_bf16_f32 v109, v98, v99
    v_mfma_f32_16x16x32_bf16 v[240:243], v[124:127], v[104:107], v[240:243]
    v_exp_f32 v102, v102
    v_mfma_f32_16x16x32_bf16 a[124:127], v[128:131], v[104:107], a[124:127]
    v_exp_f32 v103, v103
    v_mfma_f32_16x16x32_bf16 a[152:155], v[132:135], v[104:107], a[152:155]
    v_add_f32 v20, v20, v100
    v_add_f32 v21, v21, v101
    v_mfma_f32_16x16x32_bf16 a[180:183], v[136:139], v[104:107], a[180:183]
    v_cvt_pk_bf16_f32 v110, v100, v101
    v_add_f32 v20, v20, v102
    v_mfma_f32_16x16x32_bf16 a[208:211], v[140:143], v[104:107], a[208:211]
    v_add_f32 v21, v21, v103
    v_cvt_pk_bf16_f32 v111, v102, v103
    s_waitcnt vmcnt(16) lgkmcnt(0)
    s_barrier
    v_mfma_f32_16x16x32_bf16 v[96:99], v[56:59], a[96:99], v[52:55]
    ds_read_b128 v[56:59], v8 offset:16896
    v_mfma_f32_16x16x32_bf16 v[96:99], v[60:63], a[100:103], v[96:99]
    ds_read_b128 v[60:63], v8 offset:16960
    v_exp_f32 v88, v88
    v_mfma_f32_16x16x32_bf16 v[96:99], v[64:67], a[104:107], v[96:99]
    ds_read_b128 v[64:67], v8 offset:17024
    v_exp_f32 v89, v89
    v_mfma_f32_16x16x32_bf16 v[96:99], v[68:71], a[108:111], v[96:99]
    ds_read_b128 v[68:71], v8 offset:17088
    v_exp_f32 v90, v90
    v_mfma_f32_16x16x32_bf16 v[100:103], v[72:75], a[96:99], v[52:55]
    ds_read_b128 v[72:75], v8 offset:17408
    v_exp_f32 v91, v91
    v_mfma_f32_16x16x32_bf16 v[100:103], v[76:79], a[100:103], v[100:103]
    ds_read_b128 v[76:79], v8 offset:17472
    v_add_f32 v22, v22, v88
    v_add_f32 v23, v23, v89
    v_mfma_f32_16x16x32_bf16 v[100:103], v[80:83], a[104:107], v[100:103]
    ds_read_b128 v[80:83], v8 offset:17536
    v_cvt_pk_bf16_f32 v104, v88, v89
    v_mfma_f32_16x16x32_bf16 v[100:103], v[84:87], a[108:111], v[100:103]
    ds_read_b128 v[84:87], v8 offset:17600
    v_exp_f32 v92, v92
    v_mfma_f32_16x16x32_bf16 v[160:163], v[112:115], v[108:111], v[160:163]
    v_exp_f32 v93, v93
    v_mfma_f32_16x16x32_bf16 v[188:191], v[116:119], v[108:111], v[188:191]
    v_add_f32 v22, v22, v90
    v_add_f32 v23, v23, v91
    v_mfma_f32_16x16x32_bf16 v[216:219], v[120:123], v[108:111], v[216:219]
    v_cvt_pk_bf16_f32 v105, v90, v91
    v_mfma_f32_16x16x32_bf16 v[244:247], v[124:127], v[108:111], v[244:247]
    v_exp_f32 v94, v94
    v_mfma_f32_16x16x32_bf16 a[128:131], v[128:131], v[108:111], a[128:131]
    v_exp_f32 v95, v95
    v_mfma_f32_16x16x32_bf16 a[156:159], v[132:135], v[108:111], a[156:159]
    v_add_f32 v22, v22, v92
    v_add_f32 v23, v23, v93
    v_mfma_f32_16x16x32_bf16 a[184:187], v[136:139], v[108:111], a[184:187]
    v_cvt_pk_bf16_f32 v106, v92, v93
    v_add_f32 v22, v22, v94
    v_mfma_f32_16x16x32_bf16 a[212:215], v[140:143], v[108:111], a[212:215]
    v_add_f32 v23, v23, v95
    v_cvt_pk_bf16_f32 v107, v94, v95
    s_waitcnt lgkmcnt(0)
    v_mfma_f32_16x16x32_bf16 v[88:91], v[56:59], a[0:3], v[28:31]
    v_mfma_f32_16x16x32_bf16 v[88:91], v[60:63], a[4:7], v[88:91]
    v_exp_f32 v96, v96
    v_mfma_f32_16x16x32_bf16 v[88:91], v[64:67], a[8:11], v[88:91]
    v_exp_f32 v97, v97
    v_mfma_f32_16x16x32_bf16 v[88:91], v[68:71], a[12:15], v[88:91]
    v_exp_f32 v98, v98
    v_mfma_f32_16x16x32_bf16 v[92:95], v[72:75], a[0:3], v[28:31]
    v_exp_f32 v99, v99
    v_mfma_f32_16x16x32_bf16 v[92:95], v[76:79], a[4:7], v[92:95]
    v_add_f32 v24, v24, v96
    v_add_f32 v25, v25, v97
    v_mfma_f32_16x16x32_bf16 v[92:95], v[80:83], a[8:11], v[92:95]
    v_cvt_pk_bf16_f32 v108, v96, v97
    v_mfma_f32_16x16x32_bf16 v[92:95], v[84:87], a[12:15], v[92:95]
    v_exp_f32 v100, v100
    v_mfma_f32_16x16x32_bf16 v[164:167], v[112:115], v[104:107], v[164:167]
    v_exp_f32 v101, v101
    v_mfma_f32_16x16x32_bf16 v[192:195], v[116:119], v[104:107], v[192:195]
    v_add_f32 v24, v24, v98
    v_add_f32 v25, v25, v99
    v_mfma_f32_16x16x32_bf16 v[220:223], v[120:123], v[104:107], v[220:223]
    v_cvt_pk_bf16_f32 v109, v98, v99
    v_mfma_f32_16x16x32_bf16 v[248:251], v[124:127], v[104:107], v[248:251]
    v_exp_f32 v102, v102
    v_mfma_f32_16x16x32_bf16 a[132:135], v[128:131], v[104:107], a[132:135]
    v_exp_f32 v103, v103
    v_mfma_f32_16x16x32_bf16 a[160:163], v[132:135], v[104:107], a[160:163]
    v_add_f32 v24, v24, v100
    v_add_f32 v25, v25, v101
    v_mfma_f32_16x16x32_bf16 a[188:191], v[136:139], v[104:107], a[188:191]
    v_cvt_pk_bf16_f32 v110, v100, v101
    v_add_f32 v24, v24, v102
    v_mfma_f32_16x16x32_bf16 a[216:219], v[140:143], v[104:107], a[216:219]
    v_add_f32 v25, v25, v103
    v_cvt_pk_bf16_f32 v111, v102, v103
    v_mfma_f32_16x16x32_bf16 v[96:99], v[56:59], a[16:19], v[32:35]
    v_mfma_f32_16x16x32_bf16 v[96:99], v[60:63], a[20:23], v[96:99]
    v_exp_f32 v88, v88
    v_mfma_f32_16x16x32_bf16 v[96:99], v[64:67], a[24:27], v[96:99]
    v_exp_f32 v89, v89
    v_mfma_f32_16x16x32_bf16 v[96:99], v[68:71], a[28:31], v[96:99]
    v_exp_f32 v90, v90
    v_mfma_f32_16x16x32_bf16 v[100:103], v[72:75], a[16:19], v[32:35]
    v_exp_f32 v91, v91
    v_mfma_f32_16x16x32_bf16 v[100:103], v[76:79], a[20:23], v[100:103]
    v_add_f32 v12, v12, v88
    v_add_f32 v13, v13, v89
    v_mfma_f32_16x16x32_bf16 v[100:103], v[80:83], a[24:27], v[100:103]
    v_cvt_pk_bf16_f32 v104, v88, v89
    v_mfma_f32_16x16x32_bf16 v[100:103], v[84:87], a[28:31], v[100:103]
    v_exp_f32 v92, v92
    v_mfma_f32_16x16x32_bf16 v[168:171], v[112:115], v[108:111], v[168:171]
    ds_read_b64_tr_b16 v[112:113], v9 offset:16896
    ds_read_b64_tr_b16 v[114:115], v9 offset:17408
    v_exp_f32 v93, v93
    v_mfma_f32_16x16x32_bf16 v[196:199], v[116:119], v[108:111], v[196:199]
    ds_read_b64_tr_b16 v[116:117], v9 offset:16928
    ds_read_b64_tr_b16 v[118:119], v9 offset:17440
    v_add_f32 v12, v12, v90
    v_add_f32 v13, v13, v91
    v_mfma_f32_16x16x32_bf16 v[224:227], v[120:123], v[108:111], v[224:227]
    ds_read_b64_tr_b16 v[120:121], v9 offset:16960
    ds_read_b64_tr_b16 v[122:123], v9 offset:17472
    v_cvt_pk_bf16_f32 v105, v90, v91
    v_mfma_f32_16x16x32_bf16 v[252:255], v[124:127], v[108:111], v[252:255]
    ds_read_b64_tr_b16 v[124:125], v9 offset:16992
    ds_read_b64_tr_b16 v[126:127], v9 offset:17504
    v_exp_f32 v94, v94
    v_mfma_f32_16x16x32_bf16 a[136:139], v[128:131], v[108:111], a[136:139]
    ds_read_b64_tr_b16 v[128:129], v9 offset:17024
    ds_read_b64_tr_b16 v[130:131], v9 offset:17536
    v_exp_f32 v95, v95
    v_mfma_f32_16x16x32_bf16 a[164:167], v[132:135], v[108:111], a[164:167]
    ds_read_b64_tr_b16 v[132:133], v9 offset:17056
    ds_read_b64_tr_b16 v[134:135], v9 offset:17568
    v_add_f32 v12, v12, v92
    v_add_f32 v13, v13, v93
    v_mfma_f32_16x16x32_bf16 a[192:195], v[136:139], v[108:111], a[192:195]
    ds_read_b64_tr_b16 v[136:137], v9 offset:17088
    ds_read_b64_tr_b16 v[138:139], v9 offset:17600
    v_cvt_pk_bf16_f32 v106, v92, v93
    v_add_f32 v12, v12, v94
    v_mfma_f32_16x16x32_bf16 a[220:223], v[140:143], v[108:111], a[220:223]
    ds_read_b64_tr_b16 v[140:141], v9 offset:17120
    ds_read_b64_tr_b16 v[142:143], v9 offset:17632
    v_add_f32 v13, v13, v95
    v_cvt_pk_bf16_f32 v107, v94, v95
    v_mfma_f32_16x16x32_bf16 v[88:91], v[56:59], a[32:35], v[36:39]
    v_mfma_f32_16x16x32_bf16 v[88:91], v[60:63], a[36:39], v[88:91]
    s_add_u32 s29, s34, s100
    v_exp_f32 v96, v96
    v_mfma_f32_16x16x32_bf16 v[88:91], v[64:67], a[40:43], v[88:91]
    v_exp_f32 v97, v97
    v_mfma_f32_16x16x32_bf16 v[88:91], v[68:71], a[44:47], v[88:91]
    s_bfe_u32 s28, s29, 0x20003
    v_exp_f32 v98, v98
    v_mfma_f32_16x16x32_bf16 v[92:95], v[72:75], a[32:35], v[36:39]
    v_exp_f32 v99, v99
    v_mfma_f32_16x16x32_bf16 v[92:95], v[76:79], a[36:39], v[92:95]
    s_lshl_b32 s28, s28, 16
    v_add_f32 v14, v14, v96
    v_add_f32 v15, v15, v97
    v_mfma_f32_16x16x32_bf16 v[92:95], v[80:83], a[40:43], v[92:95]
    v_cvt_pk_bf16_f32 v108, v96, v97
    v_mfma_f32_16x16x32_bf16 v[92:95], v[84:87], a[44:47], v[92:95]
    v_exp_f32 v100, v100
    s_waitcnt lgkmcnt(0)
    v_mfma_f32_16x16x32_bf16 v[144:147], v[112:115], v[104:107], v[144:147]
    s_and_b32 s29, s29, 7
    v_exp_f32 v101, v101
    v_mfma_f32_16x16x32_bf16 v[172:175], v[116:119], v[104:107], v[172:175]
    v_add_f32 v14, v14, v98
    v_add_f32 v15, v15, v99
    v_mfma_f32_16x16x32_bf16 v[200:203], v[120:123], v[104:107], v[200:203]
    s_lshl_b32 s29, s29, 11
    v_cvt_pk_bf16_f32 v109, v98, v99
    v_mfma_f32_16x16x32_bf16 v[228:231], v[124:127], v[104:107], v[228:231]
    v_exp_f32 v102, v102
    v_mfma_f32_16x16x32_bf16 a[112:115], v[128:131], v[104:107], a[112:115]
    s_add_u32 s29, s28, s29
    v_exp_f32 v103, v103
    v_mfma_f32_16x16x32_bf16 a[140:143], v[132:135], v[104:107], a[140:143]
    v_add_f32 v14, v14, v100
    v_add_f32 v15, v15, v101
    v_mfma_f32_16x16x32_bf16 a[168:171], v[136:139], v[104:107], a[168:171]
    s_lshr_b32 s28, s34, 5
    v_cvt_pk_bf16_f32 v110, v100, v101
    v_add_f32 v14, v14, v102
    v_mfma_f32_16x16x32_bf16 a[196:199], v[140:143], v[104:107], a[196:199]
    v_add_f32 v15, v15, v103
    v_cvt_pk_bf16_f32 v111, v102, v103
    v_mfma_f32_16x16x32_bf16 v[96:99], v[56:59], a[48:51], v[40:43]
    v_mfma_f32_16x16x32_bf16 v[96:99], v[60:63], a[52:55], v[96:99]
    s_lshl_b32 s28, s28, 19
    v_exp_f32 v88, v88
    v_mfma_f32_16x16x32_bf16 v[96:99], v[64:67], a[56:59], v[96:99]
    v_exp_f32 v89, v89
    v_mfma_f32_16x16x32_bf16 v[96:99], v[68:71], a[60:63], v[96:99]
    s_add_u32 s49, s28, s29
    v_exp_f32 v90, v90
    v_mfma_f32_16x16x32_bf16 v[100:103], v[72:75], a[48:51], v[40:43]
    v_exp_f32 v91, v91
    v_mfma_f32_16x16x32_bf16 v[100:103], v[76:79], a[52:55], v[100:103]
    s_add_u32 m0, s33, 8448
    v_add_f32 v16, v16, v88
    v_add_f32 v17, v17, v89
    v_mfma_f32_16x16x32_bf16 v[100:103], v[80:83], a[56:59], v[100:103]
    v_cvt_pk_bf16_f32 v104, v88, v89
    v_mfma_f32_16x16x32_bf16 v[100:103], v[84:87], a[60:63], v[100:103]
    v_exp_f32 v92, v92
    v_mfma_f32_16x16x32_bf16 v[148:151], v[112:115], v[108:111], v[148:151]
    s_add_u32 s34, s34, 1
    v_exp_f32 v93, v93
    v_mfma_f32_16x16x32_bf16 v[176:179], v[116:119], v[108:111], v[176:179]
    v_add_f32 v16, v16, v90
    v_add_f32 v17, v17, v91
    v_mfma_f32_16x16x32_bf16 v[204:207], v[120:123], v[108:111], v[204:207]
    buffer_load_dwordx4 v7, s[4:7], s49 offen offset:0 nt lds
    v_cvt_pk_bf16_f32 v105, v90, v91
    v_mfma_f32_16x16x32_bf16 v[232:235], v[124:127], v[108:111], v[232:235]
    v_exp_f32 v94, v94
    v_mfma_f32_16x16x32_bf16 a[116:119], v[128:131], v[108:111], a[116:119]
    s_add_u32 m0, m0, s96
    v_exp_f32 v95, v95
    v_mfma_f32_16x16x32_bf16 a[144:147], v[132:135], v[108:111], a[144:147]
    v_add_f32 v16, v16, v92
    v_add_f32 v17, v17, v93
    v_mfma_f32_16x16x32_bf16 a[172:175], v[136:139], v[108:111], a[172:175]
    buffer_load_dwordx4 v7, s[4:7], s49 offen offset:256 nt lds
    v_cvt_pk_bf16_f32 v106, v92, v93
    v_add_f32 v16, v16, v94
    v_mfma_f32_16x16x32_bf16 a[200:203], v[140:143], v[108:111], a[200:203]
    v_add_f32 v17, v17, v95
    v_cvt_pk_bf16_f32 v107, v94, v95
    v_mfma_f32_16x16x32_bf16 v[88:91], v[56:59], a[64:67], v[44:47]
    v_mfma_f32_16x16x32_bf16 v[88:91], v[60:63], a[68:71], v[88:91]
    s_add_u32 m0, m0, s97
    v_exp_f32 v96, v96
    v_mfma_f32_16x16x32_bf16 v[88:91], v[64:67], a[72:75], v[88:91]
    v_exp_f32 v97, v97
    v_mfma_f32_16x16x32_bf16 v[88:91], v[68:71], a[76:79], v[88:91]
    buffer_load_dwordx4 v7, s[4:7], s49 offen offset:512 nt lds
    v_exp_f32 v98, v98
    v_mfma_f32_16x16x32_bf16 v[92:95], v[72:75], a[64:67], v[44:47]
    v_exp_f32 v99, v99
    v_mfma_f32_16x16x32_bf16 v[92:95], v[76:79], a[68:71], v[92:95]
    s_add_u32 m0, m0, s96
    v_add_f32 v18, v18, v96
    v_add_f32 v19, v19, v97
    v_mfma_f32_16x16x32_bf16 v[92:95], v[80:83], a[72:75], v[92:95]
    v_cvt_pk_bf16_f32 v108, v96, v97
    v_mfma_f32_16x16x32_bf16 v[92:95], v[84:87], a[76:79], v[92:95]
    v_exp_f32 v100, v100
    v_mfma_f32_16x16x32_bf16 v[152:155], v[112:115], v[104:107], v[152:155]
    buffer_load_dwordx4 v7, s[4:7], s49 offen offset:768 nt lds
    v_exp_f32 v101, v101
    v_mfma_f32_16x16x32_bf16 v[180:183], v[116:119], v[104:107], v[180:183]
    v_add_f32 v18, v18, v98
    v_add_f32 v19, v19, v99
    v_mfma_f32_16x16x32_bf16 v[208:211], v[120:123], v[104:107], v[208:211]
    s_add_u32 m0, m0, s97
    v_cvt_pk_bf16_f32 v109, v98, v99
    v_mfma_f32_16x16x32_bf16 v[236:239], v[124:127], v[104:107], v[236:239]
    v_exp_f32 v102, v102
    v_mfma_f32_16x16x32_bf16 a[120:123], v[128:131], v[104:107], a[120:123]
    buffer_load_dwordx4 v7, s[4:7], s49 offen offset:1024 nt lds
    v_exp_f32 v103, v103
    v_mfma_f32_16x16x32_bf16 a[148:151], v[132:135], v[104:107], a[148:151]
    v_add_f32 v18, v18, v100
    v_add_f32 v19, v19, v101
    v_mfma_f32_16x16x32_bf16 a[176:179], v[136:139], v[104:107], a[176:179]
    s_add_u32 m0, m0, s96
    v_cvt_pk_bf16_f32 v110, v100, v101
    v_add_f32 v18, v18, v102
    v_mfma_f32_16x16x32_bf16 a[204:207], v[140:143], v[104:107], a[204:207]
    v_add_f32 v19, v19, v103
    v_cvt_pk_bf16_f32 v111, v102, v103
    v_mfma_f32_16x16x32_bf16 v[96:99], v[56:59], a[80:83], v[48:51]
    v_mfma_f32_16x16x32_bf16 v[96:99], v[60:63], a[84:87], v[96:99]
    buffer_load_dwordx4 v7, s[4:7], s49 offen offset:1280 nt lds
    v_exp_f32 v88, v88
    v_mfma_f32_16x16x32_bf16 v[96:99], v[64:67], a[88:91], v[96:99]
    v_exp_f32 v89, v89
    v_mfma_f32_16x16x32_bf16 v[96:99], v[68:71], a[92:95], v[96:99]
    s_add_u32 m0, m0, s97
    v_exp_f32 v90, v90
    v_mfma_f32_16x16x32_bf16 v[100:103], v[72:75], a[80:83], v[48:51]
    v_exp_f32 v91, v91
    v_mfma_f32_16x16x32_bf16 v[100:103], v[76:79], a[84:87], v[100:103]
    buffer_load_dwordx4 v7, s[4:7], s49 offen offset:1536 nt lds
    v_add_f32 v20, v20, v88
    v_add_f32 v21, v21, v89
    v_mfma_f32_16x16x32_bf16 v[100:103], v[80:83], a[88:91], v[100:103]
    v_cvt_pk_bf16_f32 v104, v88, v89
    v_mfma_f32_16x16x32_bf16 v[100:103], v[84:87], a[92:95], v[100:103]
    v_exp_f32 v92, v92
    v_mfma_f32_16x16x32_bf16 v[156:159], v[112:115], v[108:111], v[156:159]
    s_add_u32 m0, m0, s96
    v_exp_f32 v93, v93
    v_mfma_f32_16x16x32_bf16 v[184:187], v[116:119], v[108:111], v[184:187]
    v_add_f32 v20, v20, v90
    v_add_f32 v21, v21, v91
    v_mfma_f32_16x16x32_bf16 v[212:215], v[120:123], v[108:111], v[212:215]
    buffer_load_dwordx4 v7, s[4:7], s49 offen offset:1792 nt lds
    v_cvt_pk_bf16_f32 v105, v90, v91
    v_mfma_f32_16x16x32_bf16 v[240:243], v[124:127], v[108:111], v[240:243]
    v_exp_f32 v94, v94
    v_mfma_f32_16x16x32_bf16 a[124:127], v[128:131], v[108:111], a[124:127]
    v_exp_f32 v95, v95
    v_mfma_f32_16x16x32_bf16 a[152:155], v[132:135], v[108:111], a[152:155]
    v_add_f32 v20, v20, v92
    v_add_f32 v21, v21, v93
    v_mfma_f32_16x16x32_bf16 a[180:183], v[136:139], v[108:111], a[180:183]
    v_cvt_pk_bf16_f32 v106, v92, v93
    v_add_f32 v20, v20, v94
    v_mfma_f32_16x16x32_bf16 a[208:211], v[140:143], v[108:111], a[208:211]
    v_add_f32 v21, v21, v95
    v_cvt_pk_bf16_f32 v107, v94, v95
    s_waitcnt vmcnt(16) lgkmcnt(0)
    s_barrier
    v_mfma_f32_16x16x32_bf16 v[88:91], v[56:59], a[96:99], v[52:55]
    ds_read_b128 v[56:59], v8 offset:25344
    v_mfma_f32_16x16x32_bf16 v[88:91], v[60:63], a[100:103], v[88:91]
    ds_read_b128 v[60:63], v8 offset:25408
    v_exp_f32 v96, v96
    v_mfma_f32_16x16x32_bf16 v[88:91], v[64:67], a[104:107], v[88:91]
    ds_read_b128 v[64:67], v8 offset:25472
    v_exp_f32 v97, v97
    v_mfma_f32_16x16x32_bf16 v[88:91], v[68:71], a[108:111], v[88:91]
    ds_read_b128 v[68:71], v8 offset:25536
    v_exp_f32 v98, v98
    v_mfma_f32_16x16x32_bf16 v[92:95], v[72:75], a[96:99], v[52:55]
    ds_read_b128 v[72:75], v8 offset:25856
    v_exp_f32 v99, v99
    v_mfma_f32_16x16x32_bf16 v[92:95], v[76:79], a[100:103], v[92:95]
    ds_read_b128 v[76:79], v8 offset:25920
    v_add_f32 v22, v22, v96
    v_add_f32 v23, v23, v97
    v_mfma_f32_16x16x32_bf16 v[92:95], v[80:83], a[104:107], v[92:95]
    ds_read_b128 v[80:83], v8 offset:25984
    v_cvt_pk_bf16_f32 v108, v96, v97
    v_mfma_f32_16x16x32_bf16 v[92:95], v[84:87], a[108:111], v[92:95]
    ds_read_b128 v[84:87], v8 offset:26048
    v_exp_f32 v100, v100
    v_mfma_f32_16x16x32_bf16 v[160:163], v[112:115], v[104:107], v[160:163]
    v_exp_f32 v101, v101
    v_mfma_f32_16x16x32_bf16 v[188:191], v[116:119], v[104:107], v[188:191]
    v_add_f32 v22, v22, v98
    v_add_f32 v23, v23, v99
    v_mfma_f32_16x16x32_bf16 v[216:219], v[120:123], v[104:107], v[216:219]
    v_cvt_pk_bf16_f32 v109, v98, v99
    v_mfma_f32_16x16x32_bf16 v[244:247], v[124:127], v[104:107], v[244:247]
    v_exp_f32 v102, v102
    v_mfma_f32_16x16x32_bf16 a[128:131], v[128:131], v[104:107], a[128:131]
    v_exp_f32 v103, v103
    v_mfma_f32_16x16x32_bf16 a[156:159], v[132:135], v[104:107], a[156:159]
    v_add_f32 v22, v22, v100
    v_add_f32 v23, v23, v101
    v_mfma_f32_16x16x32_bf16 a[184:187], v[136:139], v[104:107], a[184:187]
    v_cvt_pk_bf16_f32 v110, v100, v101
    v_add_f32 v22, v22, v102
    v_mfma_f32_16x16x32_bf16 a[212:215], v[140:143], v[104:107], a[212:215]
    v_add_f32 v23, v23, v103
    v_cvt_pk_bf16_f32 v111, v102, v103
    s_waitcnt lgkmcnt(0)
    v_mfma_f32_16x16x32_bf16 v[96:99], v[56:59], a[0:3], v[28:31]
    v_mfma_f32_16x16x32_bf16 v[96:99], v[60:63], a[4:7], v[96:99]
    v_exp_f32 v88, v88
    v_mfma_f32_16x16x32_bf16 v[96:99], v[64:67], a[8:11], v[96:99]
    v_exp_f32 v89, v89
    v_mfma_f32_16x16x32_bf16 v[96:99], v[68:71], a[12:15], v[96:99]
    v_exp_f32 v90, v90
    v_mfma_f32_16x16x32_bf16 v[100:103], v[72:75], a[0:3], v[28:31]
    v_exp_f32 v91, v91
    v_mfma_f32_16x16x32_bf16 v[100:103], v[76:79], a[4:7], v[100:103]
    v_add_f32 v24, v24, v88
    v_add_f32 v25, v25, v89
    v_mfma_f32_16x16x32_bf16 v[100:103], v[80:83], a[8:11], v[100:103]
    v_cvt_pk_bf16_f32 v104, v88, v89
    v_mfma_f32_16x16x32_bf16 v[100:103], v[84:87], a[12:15], v[100:103]
    v_exp_f32 v92, v92
    v_mfma_f32_16x16x32_bf16 v[164:167], v[112:115], v[108:111], v[164:167]
    v_exp_f32 v93, v93
    v_mfma_f32_16x16x32_bf16 v[192:195], v[116:119], v[108:111], v[192:195]
    v_add_f32 v24, v24, v90
    v_add_f32 v25, v25, v91
    v_mfma_f32_16x16x32_bf16 v[220:223], v[120:123], v[108:111], v[220:223]
    v_cvt_pk_bf16_f32 v105, v90, v91
    v_mfma_f32_16x16x32_bf16 v[248:251], v[124:127], v[108:111], v[248:251]
    v_exp_f32 v94, v94
    v_mfma_f32_16x16x32_bf16 a[132:135], v[128:131], v[108:111], a[132:135]
    v_exp_f32 v95, v95
    v_mfma_f32_16x16x32_bf16 a[160:163], v[132:135], v[108:111], a[160:163]
    v_add_f32 v24, v24, v92
    v_add_f32 v25, v25, v93
    v_mfma_f32_16x16x32_bf16 a[188:191], v[136:139], v[108:111], a[188:191]
    v_cvt_pk_bf16_f32 v106, v92, v93
    v_add_f32 v24, v24, v94
    v_mfma_f32_16x16x32_bf16 a[216:219], v[140:143], v[108:111], a[216:219]
    v_add_f32 v25, v25, v95
    v_cvt_pk_bf16_f32 v107, v94, v95
    v_mfma_f32_16x16x32_bf16 v[88:91], v[56:59], a[16:19], v[32:35]
    v_mfma_f32_16x16x32_bf16 v[88:91], v[60:63], a[20:23], v[88:91]
    v_exp_f32 v96, v96
    v_mfma_f32_16x16x32_bf16 v[88:91], v[64:67], a[24:27], v[88:91]
    v_exp_f32 v97, v97
    v_mfma_f32_16x16x32_bf16 v[88:91], v[68:71], a[28:31], v[88:91]
    v_exp_f32 v98, v98
    v_mfma_f32_16x16x32_bf16 v[92:95], v[72:75], a[16:19], v[32:35]
    v_exp_f32 v99, v99
    v_mfma_f32_16x16x32_bf16 v[92:95], v[76:79], a[20:23], v[92:95]
    v_add_f32 v12, v12, v96
    v_add_f32 v13, v13, v97
    v_mfma_f32_16x16x32_bf16 v[92:95], v[80:83], a[24:27], v[92:95]
    v_cvt_pk_bf16_f32 v108, v96, v97
    v_mfma_f32_16x16x32_bf16 v[92:95], v[84:87], a[28:31], v[92:95]
    v_exp_f32 v100, v100
    v_mfma_f32_16x16x32_bf16 v[168:171], v[112:115], v[104:107], v[168:171]
    ds_read_b64_tr_b16 v[112:113], v9 offset:25344
    ds_read_b64_tr_b16 v[114:115], v9 offset:25856
    v_exp_f32 v101, v101
    v_mfma_f32_16x16x32_bf16 v[196:199], v[116:119], v[104:107], v[196:199]
    ds_read_b64_tr_b16 v[116:117], v9 offset:25376
    ds_read_b64_tr_b16 v[118:119], v9 offset:25888
    v_add_f32 v12, v12, v98
    v_add_f32 v13, v13, v99
    v_mfma_f32_16x16x32_bf16 v[224:227], v[120:123], v[104:107], v[224:227]
    ds_read_b64_tr_b16 v[120:121], v9 offset:25408
    ds_read_b64_tr_b16 v[122:123], v9 offset:25920
    v_cvt_pk_bf16_f32 v109, v98, v99
    v_mfma_f32_16x16x32_bf16 v[252:255], v[124:127], v[104:107], v[252:255]
    ds_read_b64_tr_b16 v[124:125], v9 offset:25440
    ds_read_b64_tr_b16 v[126:127], v9 offset:25952
    v_exp_f32 v102, v102
    v_mfma_f32_16x16x32_bf16 a[136:139], v[128:131], v[104:107], a[136:139]
    ds_read_b64_tr_b16 v[128:129], v9 offset:25472
    ds_read_b64_tr_b16 v[130:131], v9 offset:25984
    v_exp_f32 v103, v103
    v_mfma_f32_16x16x32_bf16 a[164:167], v[132:135], v[104:107], a[164:167]
    ds_read_b64_tr_b16 v[132:133], v9 offset:25504
    ds_read_b64_tr_b16 v[134:135], v9 offset:26016
    v_add_f32 v12, v12, v100
    v_add_f32 v13, v13, v101
    v_mfma_f32_16x16x32_bf16 a[192:195], v[136:139], v[104:107], a[192:195]
    ds_read_b64_tr_b16 v[136:137], v9 offset:25536
    ds_read_b64_tr_b16 v[138:139], v9 offset:26048
    v_cvt_pk_bf16_f32 v110, v100, v101
    v_add_f32 v12, v12, v102
    v_mfma_f32_16x16x32_bf16 a[220:223], v[140:143], v[104:107], a[220:223]
    ds_read_b64_tr_b16 v[140:141], v9 offset:25568
    ds_read_b64_tr_b16 v[142:143], v9 offset:26080
    v_add_f32 v13, v13, v103
    v_cvt_pk_bf16_f32 v111, v102, v103
    v_mfma_f32_16x16x32_bf16 v[96:99], v[56:59], a[32:35], v[36:39]
    v_mfma_f32_16x16x32_bf16 v[96:99], v[60:63], a[36:39], v[96:99]
    s_add_u32 s29, s34, s100
    v_exp_f32 v88, v88
    v_mfma_f32_16x16x32_bf16 v[96:99], v[64:67], a[40:43], v[96:99]
    v_exp_f32 v89, v89
    v_mfma_f32_16x16x32_bf16 v[96:99], v[68:71], a[44:47], v[96:99]
    s_bfe_u32 s28, s29, 0x20003
    v_exp_f32 v90, v90
    v_mfma_f32_16x16x32_bf16 v[100:103], v[72:75], a[32:35], v[36:39]
    v_exp_f32 v91, v91
    v_mfma_f32_16x16x32_bf16 v[100:103], v[76:79], a[36:39], v[100:103]
    s_lshl_b32 s28, s28, 16
    v_add_f32 v14, v14, v88
    v_add_f32 v15, v15, v89
    v_mfma_f32_16x16x32_bf16 v[100:103], v[80:83], a[40:43], v[100:103]
    v_cvt_pk_bf16_f32 v104, v88, v89
    v_mfma_f32_16x16x32_bf16 v[100:103], v[84:87], a[44:47], v[100:103]
    v_exp_f32 v92, v92
    s_waitcnt lgkmcnt(0)
    v_mfma_f32_16x16x32_bf16 v[144:147], v[112:115], v[108:111], v[144:147]
    s_and_b32 s29, s29, 7
    v_exp_f32 v93, v93
    v_mfma_f32_16x16x32_bf16 v[172:175], v[116:119], v[108:111], v[172:175]
    v_add_f32 v14, v14, v90
    v_add_f32 v15, v15, v91
    v_mfma_f32_16x16x32_bf16 v[200:203], v[120:123], v[108:111], v[200:203]
    s_lshl_b32 s29, s29, 11
    v_cvt_pk_bf16_f32 v105, v90, v91
    v_mfma_f32_16x16x32_bf16 v[228:231], v[124:127], v[108:111], v[228:231]
    v_exp_f32 v94, v94
    v_mfma_f32_16x16x32_bf16 a[112:115], v[128:131], v[108:111], a[112:115]
    s_add_u32 s29, s28, s29
    v_exp_f32 v95, v95
    v_mfma_f32_16x16x32_bf16 a[140:143], v[132:135], v[108:111], a[140:143]
    v_add_f32 v14, v14, v92
    v_add_f32 v15, v15, v93
    v_mfma_f32_16x16x32_bf16 a[168:171], v[136:139], v[108:111], a[168:171]
    s_lshr_b32 s28, s34, 5
    v_cvt_pk_bf16_f32 v106, v92, v93
    v_add_f32 v14, v14, v94
    v_mfma_f32_16x16x32_bf16 a[196:199], v[140:143], v[108:111], a[196:199]
    v_add_f32 v15, v15, v95
    v_cvt_pk_bf16_f32 v107, v94, v95
    v_mfma_f32_16x16x32_bf16 v[88:91], v[56:59], a[48:51], v[40:43]
    v_mfma_f32_16x16x32_bf16 v[88:91], v[60:63], a[52:55], v[88:91]
    s_lshl_b32 s28, s28, 19
    v_exp_f32 v96, v96
    v_mfma_f32_16x16x32_bf16 v[88:91], v[64:67], a[56:59], v[88:91]
    v_exp_f32 v97, v97
    v_mfma_f32_16x16x32_bf16 v[88:91], v[68:71], a[60:63], v[88:91]
    s_add_u32 s49, s28, s29
    v_exp_f32 v98, v98
    v_mfma_f32_16x16x32_bf16 v[92:95], v[72:75], a[48:51], v[40:43]
    v_exp_f32 v99, v99
    v_mfma_f32_16x16x32_bf16 v[92:95], v[76:79], a[52:55], v[92:95]
    s_add_u32 m0, s33, 16896
    v_add_f32 v16, v16, v96
    v_add_f32 v17, v17, v97
    v_mfma_f32_16x16x32_bf16 v[92:95], v[80:83], a[56:59], v[92:95]
    v_cvt_pk_bf16_f32 v108, v96, v97
    v_mfma_f32_16x16x32_bf16 v[92:95], v[84:87], a[60:63], v[92:95]
    v_exp_f32 v100, v100
    v_mfma_f32_16x16x32_bf16 v[148:151], v[112:115], v[104:107], v[148:151]
    s_add_u32 s34, s34, 1
    v_exp_f32 v101, v101
    v_mfma_f32_16x16x32_bf16 v[176:179], v[116:119], v[104:107], v[176:179]
    v_add_f32 v16, v16, v98
    v_add_f32 v17, v17, v99
    v_mfma_f32_16x16x32_bf16 v[204:207], v[120:123], v[104:107], v[204:207]
    buffer_load_dwordx4 v7, s[4:7], s49 offen offset:0 nt lds
    v_cvt_pk_bf16_f32 v109, v98, v99
    v_mfma_f32_16x16x32_bf16 v[232:235], v[124:127], v[104:107], v[232:235]
    v_exp_f32 v102, v102
    v_mfma_f32_16x16x32_bf16 a[116:119], v[128:131], v[104:107], a[116:119]
    s_add_u32 m0, m0, s96
    v_exp_f32 v103, v103
    v_mfma_f32_16x16x32_bf16 a[144:147], v[132:135], v[104:107], a[144:147]
    v_add_f32 v16, v16, v100
    v_add_f32 v17, v17, v101
    v_mfma_f32_16x16x32_bf16 a[172:175], v[136:139], v[104:107], a[172:175]
    buffer_load_dwordx4 v7, s[4:7], s49 offen offset:256 nt lds
    v_cvt_pk_bf16_f32 v110, v100, v101
    v_add_f32 v16, v16, v102
    v_mfma_f32_16x16x32_bf16 a[200:203], v[140:143], v[104:107], a[200:203]
    v_add_f32 v17, v17, v103
    v_cvt_pk_bf16_f32 v111, v102, v103
    v_mfma_f32_16x16x32_bf16 v[96:99], v[56:59], a[64:67], v[44:47]
    v_mfma_f32_16x16x32_bf16 v[96:99], v[60:63], a[68:71], v[96:99]
    s_add_u32 m0, m0, s97
    v_exp_f32 v88, v88
    v_mfma_f32_16x16x32_bf16 v[96:99], v[64:67], a[72:75], v[96:99]
    v_exp_f32 v89, v89
    v_mfma_f32_16x16x32_bf16 v[96:99], v[68:71], a[76:79], v[96:99]
    buffer_load_dwordx4 v7, s[4:7], s49 offen offset:512 nt lds
    v_exp_f32 v90, v90
    v_mfma_f32_16x16x32_bf16 v[100:103], v[72:75], a[64:67], v[44:47]
    v_exp_f32 v91, v91
    v_mfma_f32_16x16x32_bf16 v[100:103], v[76:79], a[68:71], v[100:103]
    s_add_u32 m0, m0, s96
    v_add_f32 v18, v18, v88
    v_add_f32 v19, v19, v89
    v_mfma_f32_16x16x32_bf16 v[100:103], v[80:83], a[72:75], v[100:103]
    v_cvt_pk_bf16_f32 v104, v88, v89
    v_mfma_f32_16x16x32_bf16 v[100:103], v[84:87], a[76:79], v[100:103]
    v_exp_f32 v92, v92
    v_mfma_f32_16x16x32_bf16 v[152:155], v[112:115], v[108:111], v[152:155]
    buffer_load_dwordx4 v7, s[4:7], s49 offen offset:768 nt lds
    v_exp_f32 v93, v93
    v_mfma_f32_16x16x32_bf16 v[180:183], v[116:119], v[108:111], v[180:183]
    v_add_f32 v18, v18, v90
    v_add_f32 v19, v19, v91
    v_mfma_f32_16x16x32_bf16 v[208:211], v[120:123], v[108:111], v[208:211]
    s_add_u32 m0, m0, s97
    v_cvt_pk_bf16_f32 v105, v90, v91
    v_mfma_f32_16x16x32_bf16 v[236:239], v[124:127], v[108:111], v[236:239]
    v_exp_f32 v94, v94
    v_mfma_f32_16x16x32_bf16 a[120:123], v[128:131], v[108:111], a[120:123]
    buffer_load_dwordx4 v7, s[4:7], s49 offen offset:1024 nt lds
    v_exp_f32 v95, v95
    v_mfma_f32_16x16x32_bf16 a[148:151], v[132:135], v[108:111], a[148:151]
    v_add_f32 v18, v18, v92
    v_add_f32 v19, v19, v93
    v_mfma_f32_16x16x32_bf16 a[176:179], v[136:139], v[108:111], a[176:179]
    s_add_u32 m0, m0, s96
    v_cvt_pk_bf16_f32 v106, v92, v93
    v_add_f32 v18, v18, v94
    v_mfma_f32_16x16x32_bf16 a[204:207], v[140:143], v[108:111], a[204:207]
    v_add_f32 v19, v19, v95
    v_cvt_pk_bf16_f32 v107, v94, v95
    v_mfma_f32_16x16x32_bf16 v[88:91], v[56:59], a[80:83], v[48:51]
    v_mfma_f32_16x16x32_bf16 v[88:91], v[60:63], a[84:87], v[88:91]
    buffer_load_dwordx4 v7, s[4:7], s49 offen offset:1280 nt lds
    v_exp_f32 v96, v96
    v_mfma_f32_16x16x32_bf16 v[88:91], v[64:67], a[88:91], v[88:91]
    v_exp_f32 v97, v97
    v_mfma_f32_16x16x32_bf16 v[88:91], v[68:71], a[92:95], v[88:91]
    s_add_u32 m0, m0, s97
    v_exp_f32 v98, v98
    v_mfma_f32_16x16x32_bf16 v[92:95], v[72:75], a[80:83], v[48:51]
    v_exp_f32 v99, v99
    v_mfma_f32_16x16x32_bf16 v[92:95], v[76:79], a[84:87], v[92:95]
    buffer_load_dwordx4 v7, s[4:7], s49 offen offset:1536 nt lds
    v_add_f32 v20, v20, v96
    v_add_f32 v21, v21, v97
    v_mfma_f32_16x16x32_bf16 v[92:95], v[80:83], a[88:91], v[92:95]
    v_cvt_pk_bf16_f32 v108, v96, v97
    v_mfma_f32_16x16x32_bf16 v[92:95], v[84:87], a[92:95], v[92:95]
    v_exp_f32 v100, v100
    v_mfma_f32_16x16x32_bf16 v[156:159], v[112:115], v[104:107], v[156:159]
    s_add_u32 m0, m0, s96
    v_exp_f32 v101, v101
    v_mfma_f32_16x16x32_bf16 v[184:187], v[116:119], v[104:107], v[184:187]
    v_add_f32 v20, v20, v98
    v_add_f32 v21, v21, v99
    v_mfma_f32_16x16x32_bf16 v[212:215], v[120:123], v[104:107], v[212:215]
    buffer_load_dwordx4 v7, s[4:7], s49 offen offset:1792 nt lds
    v_cvt_pk_bf16_f32 v109, v98, v99
    v_mfma_f32_16x16x32_bf16 v[240:243], v[124:127], v[104:107], v[240:243]
    v_exp_f32 v102, v102
    v_mfma_f32_16x16x32_bf16 a[124:127], v[128:131], v[104:107], a[124:127]
    v_exp_f32 v103, v103
    v_mfma_f32_16x16x32_bf16 a[152:155], v[132:135], v[104:107], a[152:155]
    v_add_f32 v20, v20, v100
    v_add_f32 v21, v21, v101
    v_mfma_f32_16x16x32_bf16 a[180:183], v[136:139], v[104:107], a[180:183]
    v_cvt_pk_bf16_f32 v110, v100, v101
    v_add_f32 v20, v20, v102
    v_mfma_f32_16x16x32_bf16 a[208:211], v[140:143], v[104:107], a[208:211]
    v_add_f32 v21, v21, v103
    v_cvt_pk_bf16_f32 v111, v102, v103
    s_waitcnt vmcnt(16) lgkmcnt(0)
    s_barrier
    v_mfma_f32_16x16x32_bf16 v[96:99], v[56:59], a[96:99], v[52:55]
    ds_read_b128 v[56:59], v8 offset:0
    s_add_u32 s29, s34, s100
    v_mfma_f32_16x16x32_bf16 v[96:99], v[60:63], a[100:103], v[96:99]
    ds_read_b128 v[60:63], v8 offset:64
    s_bfe_u32 s28, s29, 0x20003
    v_exp_f32 v88, v88
    v_mfma_f32_16x16x32_bf16 v[96:99], v[64:67], a[104:107], v[96:99]
    ds_read_b128 v[64:67], v8 offset:128
    s_lshl_b32 s28, s28, 16
    v_exp_f32 v89, v89
    v_mfma_f32_16x16x32_bf16 v[96:99], v[68:71], a[108:111], v[96:99]
    ds_read_b128 v[68:71], v8 offset:192
    s_and_b32 s29, s29, 7
    v_exp_f32 v90, v90
    v_mfma_f32_16x16x32_bf16 v[100:103], v[72:75], a[96:99], v[52:55]
    ds_read_b128 v[72:75], v8 offset:512
    s_lshl_b32 s29, s29, 11
    v_exp_f32 v91, v91
    v_mfma_f32_16x16x32_bf16 v[100:103], v[76:79], a[100:103], v[100:103]
    ds_read_b128 v[76:79], v8 offset:576
    s_add_u32 s29, s28, s29
    v_add_f32 v22, v22, v88
    v_add_f32 v23, v23, v89
    v_mfma_f32_16x16x32_bf16 v[100:103], v[80:83], a[104:107], v[100:103]
    ds_read_b128 v[80:83], v8 offset:640
    s_lshr_b32 s28, s34, 5
    v_cvt_pk_bf16_f32 v104, v88, v89
    v_mfma_f32_16x16x32_bf16 v[100:103], v[84:87], a[108:111], v[100:103]
    ds_read_b128 v[84:87], v8 offset:704
    s_lshl_b32 s28, s28, 19
    v_exp_f32 v92, v92
    v_mfma_f32_16x16x32_bf16 v[160:163], v[112:115], v[108:111], v[160:163]
    s_add_u32 s49, s28, s29
    s_add_u32 m0, s33, 25344
    v_exp_f32 v93, v93
    v_mfma_f32_16x16x32_bf16 v[188:191], v[116:119], v[108:111], v[188:191]
    s_add_u32 s34, s34, 1
    v_add_f32 v22, v22, v90
    v_add_f32 v23, v23, v91
    v_mfma_f32_16x16x32_bf16 v[216:219], v[120:123], v[108:111], v[216:219]
    s_nop 0
    v_cvt_pk_bf16_f32 v105, v90, v91
    v_mfma_f32_16x16x32_bf16 v[244:247], v[124:127], v[108:111], v[244:247]
    buffer_load_dwordx4 v7, s[4:7], s49 offen offset:0 nt lds
    v_exp_f32 v94, v94
    v_mfma_f32_16x16x32_bf16 a[128:131], v[128:131], v[108:111], a[128:131]
    s_add_u32 m0, m0, s96
    v_exp_f32 v95, v95
    v_mfma_f32_16x16x32_bf16 a[156:159], v[132:135], v[108:111], a[156:159]
    s_nop 0
    v_add_f32 v22, v22, v92
    v_add_f32 v23, v23, v93
    v_mfma_f32_16x16x32_bf16 a[184:187], v[136:139], v[108:111], a[184:187]
    buffer_load_dwordx4 v7, s[4:7], s49 offen offset:256 nt lds
    v_cvt_pk_bf16_f32 v106, v92, v93
    v_add_f32 v22, v22, v94
    v_mfma_f32_16x16x32_bf16 a[212:215], v[140:143], v[108:111], a[212:215]
    s_add_u32 m0, m0, s97
    v_add_f32 v23, v23, v95
    v_cvt_pk_bf16_f32 v107, v94, v95
    s_lshl_b32 s30, s2, 2
    s_add_u32 s30, s30, s20
    s_mul_i32 s30, s30, 28672
    v_lshlrev_b32 v4, 4, v1
    buffer_load_dwordx4 a[0:3], v4, s[12:15], s30 offen offset:0
    buffer_load_dwordx4 a[4:7], v4, s[12:15], s30 offen offset:1024
    buffer_load_dwordx4 a[8:11], v4, s[12:15], s30 offen offset:2048
    buffer_load_dwordx4 a[12:15], v4, s[12:15], s30 offen offset:3072
    s_add_u32 s30, s30, 4096
    buffer_load_dwordx4 a[16:19], v4, s[12:15], s30 offen offset:0
    buffer_load_dwordx4 a[20:23], v4, s[12:15], s30 offen offset:1024
    buffer_load_dwordx4 a[24:27], v4, s[12:15], s30 offen offset:2048
    buffer_load_dwordx4 a[28:31], v4, s[12:15], s30 offen offset:3072
    s_add_u32 s30, s30, 4096
    buffer_load_dwordx4 a[32:35], v4, s[12:15], s30 offen offset:0
    buffer_load_dwordx4 a[36:39], v4, s[12:15], s30 offen offset:1024
    buffer_load_dwordx4 a[40:43], v4, s[12:15], s30 offen offset:2048
    buffer_load_dwordx4 a[44:47], v4, s[12:15], s30 offen offset:3072
    s_add_u32 s30, s30, 4096
    buffer_load_dwordx4 a[48:51], v4, s[12:15], s30 offen offset:0
    buffer_load_dwordx4 a[52:55], v4, s[12:15], s30 offen offset:1024
    buffer_load_dwordx4 a[56:59], v4, s[12:15], s30 offen offset:2048
    buffer_load_dwordx4 a[60:63], v4, s[12:15], s30 offen offset:3072
    s_add_u32 s30, s30, 4096
    buffer_load_dwordx4 a[64:67], v4, s[12:15], s30 offen offset:0
    buffer_load_dwordx4 a[68:71], v4, s[12:15], s30 offen offset:1024
    buffer_load_dwordx4 a[72:75], v4, s[12:15], s30 offen offset:2048
    buffer_load_dwordx4 a[76:79], v4, s[12:15], s30 offen offset:3072
    s_add_u32 s30, s30, 4096
    buffer_load_dwordx4 a[80:83], v4, s[12:15], s30 offen offset:0
    buffer_load_dwordx4 a[84:87], v4, s[12:15], s30 offen offset:1024
    buffer_load_dwordx4 a[88:91], v4, s[12:15], s30 offen offset:2048
    buffer_load_dwordx4 a[92:95], v4, s[12:15], s30 offen offset:3072
    s_add_u32 s30, s30, 4096
    buffer_load_dwordx4 a[96:99], v4, s[12:15], s30 offen offset:0
    buffer_load_dwordx4 a[100:103], v4, s[12:15], s30 offen offset:1024
    buffer_load_dwordx4 a[104:107], v4, s[12:15], s30 offen offset:2048
    buffer_load_dwordx4 a[108:111], v4, s[12:15], s30 offen offset:3072
    s_nop 1
    v_mfma_f32_16x16x32_bf16 v[164:167], v[112:115], v[104:107], v[164:167]
    s_nop 0
    buffer_load_dwordx4 v7, s[4:7], s49 offen offset:512 nt lds
    v_exp_f32 v96, v96
    v_mfma_f32_16x16x32_bf16 v[192:195], v[116:119], v[104:107], v[192:195]
    s_add_u32 m0, m0, s96
    s_nop 0
    v_exp_f32 v97, v97
    v_exp_f32 v98, v98
    v_mfma_f32_16x16x32_bf16 v[220:223], v[120:123], v[104:107], v[220:223]
    buffer_load_dwordx4 v7, s[4:7], s49 offen offset:768 nt lds
    s_add_u32 m0, m0, s97
    v_exp_f32 v99, v99
    v_add_f32 v24, v24, v96
    v_add_f32 v25, v25, v97
    v_mfma_f32_16x16x32_bf16 v[248:251], v[124:127], v[104:107], v[248:251]
    s_nop 0
    buffer_load_dwordx4 v7, s[4:7], s49 offen offset:1024 nt lds
    v_cvt_pk_bf16_f32 v108, v96, v97
    v_exp_f32 v100, v100
    v_mfma_f32_16x16x32_bf16 a[132:135], v[128:131], v[104:107], a[132:135]
    s_add_u32 m0, m0, s96
    s_nop 0
    buffer_load_dwordx4 v7, s[4:7], s49 offen offset:1280 nt lds
    v_exp_f32 v101, v101
    v_add_f32 v24, v24, v98
    v_add_f32 v25, v25, v99
    v_mfma_f32_16x16x32_bf16 a[160:163], v[132:135], v[104:107], a[160:163]
    s_add_u32 m0, m0, s97
    s_nop 0
    v_cvt_pk_bf16_f32 v109, v98, v99
    v_exp_f32 v102, v102
    v_mfma_f32_16x16x32_bf16 a[188:191], v[136:139], v[104:107], a[188:191]
    buffer_load_dwordx4 v7, s[4:7], s49 offen offset:1536 nt lds
    s_add_u32 m0, m0, s96
    v_exp_f32 v103, v103
    v_add_f32 v24, v24, v100
    v_add_f32 v25, v25, v101
    v_mfma_f32_16x16x32_bf16 a[216:219], v[140:143], v[104:107], a[216:219]
    s_nop 0
    buffer_load_dwordx4 v7, s[4:7], s49 offen offset:1792 nt lds
    v_cvt_pk_bf16_f32 v110, v100, v101
    v_add_f32 v24, v24, v102
    v_add_f32 v25, v25, v103
    v_cvt_pk_bf16_f32 v111, v102, v103
L_at_aepi:
    s_nop 1
    s_waitcnt lgkmcnt(0)
    v_mfma_f32_16x16x32_bf16 v[168:171], v[112:115], v[108:111], v[168:171]
    v_add_f32 v12, v12, v13
    v_add_f32 v14, v14, v15
    v_add_f32 v16, v16, v17
    v_add_f32 v18, v18, v19
    v_add_f32 v20, v20, v21
    v_add_f32 v22, v22, v23
    v_mfma_f32_16x16x32_bf16 v[196:199], v[116:119], v[108:111], v[196:199]
    v_add_f32 v24, v24, v25
    v_mov_b32 v88, v12
    v_mov_b32 v89, v14
    v_mov_b32 v90, v16
    v_mov_b32 v91, v18
    v_mov_b32 v92, v20
    v_mfma_f32_16x16x32_bf16 v[224:227], v[120:123], v[108:111], v[224:227]
    v_mov_b32 v93, v22
    v_mov_b32 v94, v24
    v_permlane16_swap_b32 v12, v88
    v_permlane16_swap_b32 v14, v89
    v_permlane16_swap_b32 v16, v90
    v_permlane16_swap_b32 v18, v91
    v_mfma_f32_16x16x32_bf16 v[252:255], v[124:127], v[108:111], v[252:255]
    v_permlane16_swap_b32 v20, v92
    v_permlane16_swap_b32 v22, v93
    v_permlane16_swap_b32 v24, v94
    v_add_f32 v12, v12, v88
    v_add_f32 v14, v14, v89
    v_add_f32 v16, v16, v90
    v_mfma_f32_16x16x32_bf16 a[136:139], v[128:131], v[108:111], a[136:139]
    v_add_f32 v18, v18, v91
    v_add_f32 v20, v20, v92
    v_add_f32 v22, v22, v93
    v_add_f32 v24, v24, v94
    v_mov_b32 v88, v12
    v_mov_b32 v89, v14
    v_mfma_f32_16x16x32_bf16 a[164:167], v[132:135], v[108:111], a[164:167]
    v_mov_b32 v90, v16
    v_mov_b32 v91, v18
    v_mov_b32 v92, v20
    v_mov_b32 v93, v22
    v_mov_b32 v94, v24
    v_permlane32_swap_b32 v12, v88
    v_mfma_f32_16x16x32_bf16 a[192:195], v[136:139], v[108:111], a[192:195]
    v_permlane32_swap_b32 v14, v89
    v_permlane32_swap_b32 v16, v90
    v_permlane32_swap_b32 v18, v91
    v_permlane32_swap_b32 v20, v92
    v_permlane32_swap_b32 v22, v93
    v_permlane32_swap_b32 v24, v94
    v_mfma_f32_16x16x32_bf16 a[220:223], v[140:143], v[108:111], a[220:223]
    v_add_f32 v12, v12, v88
    v_add_f32 v14, v14, v89
    v_add_f32 v16, v16, v90
    v_add_f32 v18, v18, v91
    v_add_f32 v20, v20, v92
    v_add_f32 v22, v22, v93
    v_add_f32 v24, v24, v94
    v_rcp_f32 v28, v12
    v_rcp_f32 v32, v14
    v_rcp_f32 v36, v16
    v_rcp_f32 v40, v18
    v_rcp_f32 v44, v20
    v_rcp_f32 v48, v22
    v_rcp_f32 v52, v24
    v_add_f32 v90, v12, v14
    v_add_f32 v91, v16, v18
    v_add_f32 v92, v20, v22
    v_add_f32 v90, v90, v24
    v_add_f32 v91, v91, v92
    v_add_f32 v90, v90, v91
    v_cmp_nge_f32 vcc, s32, v90
    v_mov_b32 v12, 0xff800000
    v_mov_b32 v14, 0xff800000
    v_mov_b32 v16, 0xff800000
    v_mov_b32 v18, 0xff800000
    v_mov_b32 v20, 0xff800000
    v_mov_b32 v22, 0xff800000
    v_mov_b32 v24, 0xff800000
    s_cmp_eq_u64 vcc, 0
    s_cbranch_scc1 L_at_noflag
    s_lshl_b32 s29, s21, 2
    s_add_u32 s29, s29, 75996
    v_mov_b32 v90, s29
    v_mov_b32 v91, 1
    ds_write_b32 v90, v91
L_at_noflag:
    s_mul_i32 s31, s21, 114688
    s_add_u32 s31, s31, s24
    s_sub_u32 s31, s31, 114688
    v_pk_mul_f32 v[144:145], v[144:145], v[28:29] op_sel_hi:[1,0]
    v_pk_mul_f32 v[146:147], v[146:147], v[28:29] op_sel_hi:[1,0]
    v_pk_mul_f32 v[148:149], v[148:149], v[32:33] op_sel_hi:[1,0]
    v_pk_mul_f32 v[150:151], v[150:151], v[32:33] op_sel_hi:[1,0]
    v_pk_mul_f32 v[152:153], v[152:153], v[36:37] op_sel_hi:[1,0]
    v_pk_mul_f32 v[154:155], v[154:155], v[36:37] op_sel_hi:[1,0]
    v_pk_mul_f32 v[156:157], v[156:157], v[40:41] op_sel_hi:[1,0]
    v_pk_mul_f32 v[158:159], v[158:159], v[40:41] op_sel_hi:[1,0]
    v_pk_mul_f32 v[160:161], v[160:161], v[44:45] op_sel_hi:[1,0]
    v_pk_mul_f32 v[162:163], v[162:163], v[44:45] op_sel_hi:[1,0]
    v_pk_mul_f32 v[164:165], v[164:165], v[48:49] op_sel_hi:[1,0]
    v_pk_mul_f32 v[166:167], v[166:167], v[48:49] op_sel_hi:[1,0]
    v_pk_mul_f32 v[168:169], v[168:169], v[52:53] op_sel_hi:[1,0]
    v_pk_mul_f32 v[170:171], v[170:171], v[52:53] op_sel_hi:[1,0]
    v_pk_mul_f32 v[172:173], v[172:173], v[28:29] op_sel_hi:[1,0]
    v_pk_mul_f32 v[174:175], v[174:175], v[28:29] op_sel_hi:[1,0]
    v_pk_mul_f32 v[176:177], v[176:177], v[32:33] op_sel_hi:[1,0]
    v_pk_mul_f32 v[178:179], v[178:179], v[32:33] op_sel_hi:[1,0]
    v_pk_mul_f32 v[180:181], v[180:181], v[36:37] op_sel_hi:[1,0]
    v_pk_mul_f32 v[182:183], v[182:183], v[36:37] op_sel_hi:[1,0]
    v_pk_mul_f32 v[184:185], v[184:185], v[40:41] op_sel_hi:[1,0]
    v_pk_mul_f32 v[186:187], v[186:187], v[40:41] op_sel_hi:[1,0]
    v_pk_mul_f32 v[188:189], v[188:189], v[44:45] op_sel_hi:[1,0]
    v_pk_mul_f32 v[190:191], v[190:191], v[44:45] op_sel_hi:[1,0]
    v_pk_mul_f32 v[192:193], v[192:193], v[48:49] op_sel_hi:[1,0]
    v_pk_mul_f32 v[194:195], v[194:195], v[48:49] op_sel_hi:[1,0]
    v_pk_mul_f32 v[196:197], v[196:197], v[52:53] op_sel_hi:[1,0]
    v_pk_mul_f32 v[198:199], v[198:199], v[52:53] op_sel_hi:[1,0]
    v_cvt_pk_bf16_f32 v88, v144, v145
    v_cvt_pk_bf16_f32 v89, v146, v147
    v_cvt_pk_bf16_f32 v90, v172, v173
    v_cvt_pk_bf16_f32 v91, v174, v175
    v_cvt_pk_bf16_f32 v92, v148, v149
    v_cvt_pk_bf16_f32 v93, v150, v151
    v_cvt_pk_bf16_f32 v94, v176, v177
    v_cvt_pk_bf16_f32 v95, v178, v179
    v_cvt_pk_bf16_f32 v96, v152, v153
    v_cvt_pk_bf16_f32 v97, v154, v155
    v_cvt_pk_bf16_f32 v98, v180, v181
    v_cvt_pk_bf16_f32 v99, v182, v183
    v_cvt_pk_bf16_f32 v100, v156, v157
    v_cvt_pk_bf16_f32 v101, v158, v159
    v_cvt_pk_bf16_f32 v102, v184, v185
    v_cvt_pk_bf16_f32 v103, v186, v187
    v_cvt_pk_bf16_f32 v104, v160, v161
    v_cvt_pk_bf16_f32 v105, v162, v163
    v_cvt_pk_bf16_f32 v106, v188, v189
    v_cvt_pk_bf16_f32 v107, v190, v191
    v_cvt_pk_bf16_f32 v108, v164, v165
    v_cvt_pk_bf16_f32 v109, v166, v167
    v_cvt_pk_bf16_f32 v110, v192, v193
    v_cvt_pk_bf16_f32 v111, v194, v195
    v_cvt_pk_bf16_f32 v112, v168, v169
    v_cvt_pk_bf16_f32 v113, v170, v171
    v_cvt_pk_bf16_f32 v114, v196, v197
    v_cvt_pk_bf16_f32 v115, v198, v199
    s_nop 1
    v_permlane16_swap_b32 v88, v90
    v_permlane16_swap_b32 v89, v91
    v_permlane16_swap_b32 v92, v94
    v_permlane16_swap_b32 v93, v95
    v_permlane16_swap_b32 v96, v98
    v_permlane16_swap_b32 v97, v99
    v_permlane16_swap_b32 v100, v102
    v_permlane16_swap_b32 v101, v103
    v_permlane16_swap_b32 v104, v106
    v_permlane16_swap_b32 v105, v107
    v_permlane16_swap_b32 v108, v110
    v_permlane16_swap_b32 v109, v111
    v_permlane16_swap_b32 v112, v114
    v_permlane16_swap_b32 v113, v115
    s_mov_b32 s28, s31
    buffer_store_dwordx4 v[88:91], v10, s[12:15], s28 offen offset:0 sc0 sc1
    s_add_u32 s28, s28, 4096
    buffer_store_dwordx4 v[92:95], v10, s[12:15], s28 offen offset:0 sc0 sc1
    s_add_u32 s28, s28, 4096
    buffer_store_dwordx4 v[96:99], v10, s[12:15], s28 offen offset:0 sc0 sc1
    s_add_u32 s28, s28, 4096
    buffer_store_dwordx4 v[100:103], v10, s[12:15], s28 offen offset:0 sc0 sc1
    s_add_u32 s28, s28, 4096
    buffer_store_dwordx4 v[104:107], v10, s[12:15], s28 offen offset:0 sc0 sc1
    s_add_u32 s28, s28, 4096
    buffer_store_dwordx4 v[108:111], v10, s[12:15], s28 offen offset:0 sc0 sc1
    s_add_u32 s28, s28, 4096
    buffer_store_dwordx4 v[112:115], v10, s[12:15], s28 offen offset:0 sc0 sc1
    v_pk_mul_f32 v[200:201], v[200:201], v[28:29] op_sel_hi:[1,0]
    v_pk_mul_f32 v[202:203], v[202:203], v[28:29] op_sel_hi:[1,0]
    v_pk_mul_f32 v[204:205], v[204:205], v[32:33] op_sel_hi:[1,0]
    v_pk_mul_f32 v[206:207], v[206:207], v[32:33] op_sel_hi:[1,0]
    v_pk_mul_f32 v[208:209], v[208:209], v[36:37] op_sel_hi:[1,0]
    v_pk_mul_f32 v[210:211], v[210:211], v[36:37] op_sel_hi:[1,0]
    v_pk_mul_f32 v[212:213], v[212:213], v[40:41] op_sel_hi:[1,0]
    v_pk_mul_f32 v[214:215], v[214:215], v[40:41] op_sel_hi:[1,0]
    v_pk_mul_f32 v[216:217], v[216:217], v[44:45] op_sel_hi:[1,0]
    v_pk_mul_f32 v[218:219], v[218:219], v[44:45] op_sel_hi:[1,0]
    v_pk_mul_f32 v[220:221], v[220:221], v[48:49] op_sel_hi:[1,0]
    v_pk_mul_f32 v[222:223], v[222:223], v[48:49] op_sel_hi:[1,0]
    v_pk_mul_f32 v[224:225], v[224:225], v[52:53] op_sel_hi:[1,0]
    v_pk_mul_f32 v[226:227], v[226:227], v[52:53] op_sel_hi:[1,0]
    v_pk_mul_f32 v[228:229], v[228:229], v[28:29] op_sel_hi:[1,0]
    v_pk_mul_f32 v[230:231], v[230:231], v[28:29] op_sel_hi:[1,0]
    v_pk_mul_f32 v[232:233], v[232:233], v[32:33] op_sel_hi:[1,0]
    v_pk_mul_f32 v[234:235], v[234:235], v[32:33] op_sel_hi:[1,0]
    v_pk_mul_f32 v[236:237], v[236:237], v[36:37] op_sel_hi:[1,0]
    v_pk_mul_f32 v[238:239], v[238:239], v[36:37] op_sel_hi:[1,0]
    v_pk_mul_f32 v[240:241], v[240:241], v[40:41] op_sel_hi:[1,0]
    v_pk_mul_f32 v[242:243], v[242:243], v[40:41] op_sel_hi:[1,0]
    v_pk_mul_f32 v[244:245], v[244:245], v[44:45] op_sel_hi:[1,0]
    v_pk_mul_f32 v[246:247], v[246:247], v[44:45] op_sel_hi:[1,0]
    v_pk_mul_f32 v[248:249], v[248:249], v[48:49] op_sel_hi:[1,0]
    v_pk_mul_f32 v[250:251], v[250:251], v[48:49] op_sel_hi:[1,0]
    v_pk_mul_f32 v[252:253], v[252:253], v[52:53] op_sel_hi:[1,0]
    v_pk_mul_f32 v[254:255], v[254:255], v[52:53] op_sel_hi:[1,0]
    v_cvt_pk_bf16_f32 v116, v200, v201
    v_cvt_pk_bf16_f32 v117, v202, v203
    v_cvt_pk_bf16_f32 v118, v228, v229
    v_cvt_pk_bf16_f32 v119, v230, v231
    v_cvt_pk_bf16_f32 v120, v204, v205
    v_cvt_pk_bf16_f32 v121, v206, v207
    v_cvt_pk_bf16_f32 v122, v232, v233
    v_cvt_pk_bf16_f32 v123, v234, v235
    v_cvt_pk_bf16_f32 v124, v208, v209
    v_cvt_pk_bf16_f32 v125, v210, v211
    v_cvt_pk_bf16_f32 v126, v236, v237
    v_cvt_pk_bf16_f32 v127, v238, v239
    v_cvt_pk_bf16_f32 v128, v212, v213
    v_cvt_pk_bf16_f32 v129, v214, v215
    v_cvt_pk_bf16_f32 v130, v240, v241
    v_cvt_pk_bf16_f32 v131, v242, v243
    v_cvt_pk_bf16_f32 v132, v216, v217
    v_cvt_pk_bf16_f32 v133, v218, v219
    v_cvt_pk_bf16_f32 v134, v244, v245
    v_cvt_pk_bf16_f32 v135, v246, v247
    v_cvt_pk_bf16_f32 v136, v220, v221
    v_cvt_pk_bf16_f32 v137, v222, v223
    v_cvt_pk_bf16_f32 v138, v248, v249
    v_cvt_pk_bf16_f32 v139, v250, v251
    v_cvt_pk_bf16_f32 v140, v224, v225
    v_cvt_pk_bf16_f32 v141, v226, v227
    v_cvt_pk_bf16_f32 v142, v252, v253
    v_cvt_pk_bf16_f32 v143, v254, v255
    s_nop 1
    v_permlane16_swap_b32 v116, v118
    v_permlane16_swap_b32 v117, v119
    v_permlane16_swap_b32 v120, v122
    v_permlane16_swap_b32 v121, v123
    v_permlane16_swap_b32 v124, v126
    v_permlane16_swap_b32 v125, v127
    v_permlane16_swap_b32 v128, v130
    v_permlane16_swap_b32 v129, v131
    v_permlane16_swap_b32 v132, v134
    v_permlane16_swap_b32 v133, v135
    v_permlane16_swap_b32 v136, v138
    v_permlane16_swap_b32 v137, v139
    v_permlane16_swap_b32 v140, v142
    v_permlane16_swap_b32 v141, v143
    s_mov_b32 s28, s31
    buffer_store_dwordx4 v[116:119], v10, s[12:15], s28 offen offset:1024 sc0 sc1
    s_add_u32 s28, s28, 4096
    buffer_store_dwordx4 v[120:123], v10, s[12:15], s28 offen offset:1024 sc0 sc1
    s_add_u32 s28, s28, 4096
    buffer_store_dwordx4 v[124:127], v10, s[12:15], s28 offen offset:1024 sc0 sc1
    s_add_u32 s28, s28, 4096
    buffer_store_dwordx4 v[128:131], v10, s[12:15], s28 offen offset:1024 sc0 sc1
    s_add_u32 s28, s28, 4096
    buffer_store_dwordx4 v[132:135], v10, s[12:15], s28 offen offset:1024 sc0 sc1
    s_add_u32 s28, s28, 4096
    buffer_store_dwordx4 v[136:139], v10, s[12:15], s28 offen offset:1024 sc0 sc1
    s_add_u32 s28, s28, 4096
    buffer_store_dwordx4 v[140:143], v10, s[12:15], s28 offen offset:1024 sc0 sc1
    v_accvgpr_read_b32 v144, a112
    v_accvgpr_read_b32 v145, a113
    v_accvgpr_read_b32 v146, a114
    v_accvgpr_read_b32 v147, a115
    v_accvgpr_read_b32 v148, a116
    v_accvgpr_read_b32 v149, a117
    v_accvgpr_read_b32 v150, a118
    v_accvgpr_read_b32 v151, a119
    v_accvgpr_read_b32 v152, a120
    v_accvgpr_read_b32 v153, a121
    v_accvgpr_read_b32 v154, a122
    v_accvgpr_read_b32 v155, a123
    v_accvgpr_read_b32 v156, a124
    v_accvgpr_read_b32 v157, a125
    v_accvgpr_read_b32 v158, a126
    v_accvgpr_read_b32 v159, a127
    v_accvgpr_read_b32 v160, a128
    v_accvgpr_read_b32 v161, a129
    v_accvgpr_read_b32 v162, a130
    v_accvgpr_read_b32 v163, a131
    v_accvgpr_read_b32 v164, a132
    v_accvgpr_read_b32 v165, a133
    v_accvgpr_read_b32 v166, a134
    v_accvgpr_read_b32 v167, a135
    v_accvgpr_read_b32 v168, a136
    v_accvgpr_read_b32 v169, a137
    v_accvgpr_read_b32 v170, a138
    v_accvgpr_read_b32 v171, a139
    v_accvgpr_read_b32 v172, a140
    v_accvgpr_read_b32 v173, a141
    v_accvgpr_read_b32 v174, a142
    v_accvgpr_read_b32 v175, a143
    v_accvgpr_read_b32 v176, a144
    v_accvgpr_read_b32 v177, a145
    v_accvgpr_read_b32 v178, a146
    v_accvgpr_read_b32 v179, a147
    v_accvgpr_read_b32 v180, a148
    v_accvgpr_read_b32 v181, a149
    v_accvgpr_read_b32 v182, a150
    v_accvgpr_read_b32 v183, a151
    v_accvgpr_read_b32 v184, a152
    v_accvgpr_read_b32 v185, a153
    v_accvgpr_read_b32 v186, a154
    v_accvgpr_read_b32 v187, a155
    v_accvgpr_read_b32 v188, a156
    v_accvgpr_read_b32 v189, a157
    v_accvgpr_read_b32 v190, a158
    v_accvgpr_read_b32 v191, a159
    v_accvgpr_read_b32 v192, a160
    v_accvgpr_read_b32 v193, a161
    v_accvgpr_read_b32 v194, a162
    v_accvgpr_read_b32 v195, a163
    v_accvgpr_read_b32 v196, a164
    v_accvgpr_read_b32 v197, a165
    v_accvgpr_read_b32 v198, a166
    v_accvgpr_read_b32 v199, a167
    v_pk_mul_f32 v[144:145], v[144:145], v[28:29] op_sel_hi:[1,0]
    v_pk_mul_f32 v[146:147], v[146:147], v[28:29] op_sel_hi:[1,0]
    v_pk_mul_f32 v[148:149], v[148:149], v[32:33] op_sel_hi:[1,0]
    v_pk_mul_f32 v[150:151], v[150:151], v[32:33] op_sel_hi:[1,0]
    v_pk_mul_f32 v[152:153], v[152:153], v[36:37] op_sel_hi:[1,0]
    v_pk_mul_f32 v[154:155], v[154:155], v[36:37] op_sel_hi:[1,0]
    v_pk_mul_f32 v[156:157], v[156:157], v[40:41] op_sel_hi:[1,0]
    v_pk_mul_f32 v[158:159], v[158:159], v[40:41] op_sel_hi:[1,0]
    v_pk_mul_f32 v[160:161], v[160:161], v[44:45] op_sel_hi:[1,0]
    v_pk_mul_f32 v[162:163], v[162:163], v[44:45] op_sel_hi:[1,0]
    v_pk_mul_f32 v[164:165], v[164:165], v[48:49] op_sel_hi:[1,0]
    v_pk_mul_f32 v[166:167], v[166:167], v[48:49] op_sel_hi:[1,0]
    v_pk_mul_f32 v[168:169], v[168:169], v[52:53] op_sel_hi:[1,0]
    v_pk_mul_f32 v[170:171], v[170:171], v[52:53] op_sel_hi:[1,0]
    v_pk_mul_f32 v[172:173], v[172:173], v[28:29] op_sel_hi:[1,0]
    v_pk_mul_f32 v[174:175], v[174:175], v[28:29] op_sel_hi:[1,0]
    v_pk_mul_f32 v[176:177], v[176:177], v[32:33] op_sel_hi:[1,0]
    v_pk_mul_f32 v[178:179], v[178:179], v[32:33] op_sel_hi:[1,0]
    v_pk_mul_f32 v[180:181], v[180:181], v[36:37] op_sel_hi:[1,0]
    v_pk_mul_f32 v[182:183], v[182:183], v[36:37] op_sel_hi:[1,0]
    v_pk_mul_f32 v[184:185], v[184:185], v[40:41] op_sel_hi:[1,0]
    v_pk_mul_f32 v[186:187], v[186:187], v[40:41] op_sel_hi:[1,0]
    v_pk_mul_f32 v[188:189], v[188:189], v[44:45] op_sel_hi:[1,0]
    v_pk_mul_f32 v[190:191], v[190:191], v[44:45] op_sel_hi:[1,0]
    v_pk_mul_f32 v[192:193], v[192:193], v[48:49] op_sel_hi:[1,0]
    v_pk_mul_f32 v[194:195], v[194:195], v[48:49] op_sel_hi:[1,0]
    v_pk_mul_f32 v[196:197], v[196:197], v[52:53] op_sel_hi:[1,0]
    v_pk_mul_f32 v[198:199], v[198:199], v[52:53] op_sel_hi:[1,0]
    v_cvt_pk_bf16_f32 v88, v144, v145
    v_cvt_pk_bf16_f32 v89, v146, v147
    v_cvt_pk_bf16_f32 v90, v172, v173
    v_cvt_pk_bf16_f32 v91, v174, v175
    v_cvt_pk_bf16_f32 v92, v148, v149
    v_cvt_pk_bf16_f32 v93, v150, v151
    v_cvt_pk_bf16_f32 v94, v176, v177
    v_cvt_pk_bf16_f32 v95, v178, v179
    v_cvt_pk_bf16_f32 v96, v152, v153
    v_cvt_pk_bf16_f32 v97, v154, v155
    v_cvt_pk_bf16_f32 v98, v180, v181
    v_cvt_pk_bf16_f32 v99, v182, v183
    v_cvt_pk_bf16_f32 v100, v156, v157
    v_cvt_pk_bf16_f32 v101, v158, v159
    v_cvt_pk_bf16_f32 v102, v184, v185
    v_cvt_pk_bf16_f32 v103, v186, v187
    v_cvt_pk_bf16_f32 v104, v160, v161
    v_cvt_pk_bf16_f32 v105, v162, v163
    v_cvt_pk_bf16_f32 v106, v188, v189
    v_cvt_pk_bf16_f32 v107, v190, v191
    v_cvt_pk_bf16_f32 v108, v164, v165
    v_cvt_pk_bf16_f32 v109, v166, v167
    v_cvt_pk_bf16_f32 v110, v192, v193
    v_cvt_pk_bf16_f32 v111, v194, v195
    v_cvt_pk_bf16_f32 v112, v168, v169
    v_cvt_pk_bf16_f32 v113, v170, v171
    v_cvt_pk_bf16_f32 v114, v196, v197
    v_cvt_pk_bf16_f32 v115, v198, v199
    s_nop 1
    v_permlane16_swap_b32 v88, v90
    v_permlane16_swap_b32 v89, v91
    v_permlane16_swap_b32 v92, v94
    v_permlane16_swap_b32 v93, v95
    v_permlane16_swap_b32 v96, v98
    v_permlane16_swap_b32 v97, v99
    v_permlane16_swap_b32 v100, v102
    v_permlane16_swap_b32 v101, v103
    v_permlane16_swap_b32 v104, v106
    v_permlane16_swap_b32 v105, v107
    v_permlane16_swap_b32 v108, v110
    v_permlane16_swap_b32 v109, v111
    v_permlane16_swap_b32 v112, v114
    v_permlane16_swap_b32 v113, v115
    s_mov_b32 s28, s31
    buffer_store_dwordx4 v[88:91], v10, s[12:15], s28 offen offset:2048 sc0 sc1
    s_add_u32 s28, s28, 4096
    buffer_store_dwordx4 v[92:95], v10, s[12:15], s28 offen offset:2048 sc0 sc1
    s_add_u32 s28, s28, 4096
    buffer_store_dwordx4 v[96:99], v10, s[12:15], s28 offen offset:2048 sc0 sc1
    s_add_u32 s28, s28, 4096
    buffer_store_dwordx4 v[100:103], v10, s[12:15], s28 offen offset:2048 sc0 sc1
    s_add_u32 s28, s28, 4096
    buffer_store_dwordx4 v[104:107], v10, s[12:15], s28 offen offset:2048 sc0 sc1
    s_add_u32 s28, s28, 4096
    buffer_store_dwordx4 v[108:111], v10, s[12:15], s28 offen offset:2048 sc0 sc1
    s_add_u32 s28, s28, 4096
    buffer_store_dwordx4 v[112:115], v10, s[12:15], s28 offen offset:2048 sc0 sc1
    v_accvgpr_read_b32 v200, a168
    v_accvgpr_read_b32 v201, a169
    v_accvgpr_read_b32 v202, a170
    v_accvgpr_read_b32 v203, a171
    v_accvgpr_read_b32 v204, a172
    v_accvgpr_read_b32 v205, a173
    v_accvgpr_read_b32 v206, a174
    v_accvgpr_read_b32 v207, a175
    v_accvgpr_read_b32 v208, a176
    v_accvgpr_read_b32 v209, a177
    v_accvgpr_read_b32 v210, a178
    v_accvgpr_read_b32 v211, a179
    v_accvgpr_read_b32 v212, a180
    v_accvgpr_read_b32 v213, a181
    v_accvgpr_read_b32 v214, a182
    v_accvgpr_read_b32 v215, a183
    v_accvgpr_read_b32 v216, a184
    v_accvgpr_read_b32 v217, a185
    v_accvgpr_read_b32 v218, a186
    v_accvgpr_read_b32 v219, a187
    v_accvgpr_read_b32 v220, a188
    v_accvgpr_read_b32 v221, a189
    v_accvgpr_read_b32 v222, a190
    v_accvgpr_read_b32 v223, a191
    v_accvgpr_read_b32 v224, a192
    v_accvgpr_read_b32 v225, a193
    v_accvgpr_read_b32 v226, a194
    v_accvgpr_read_b32 v227, a195
    v_accvgpr_read_b32 v228, a196
    v_accvgpr_read_b32 v229, a197
    v_accvgpr_read_b32 v230, a198
    v_accvgpr_read_b32 v231, a199
    v_accvgpr_read_b32 v232, a200
    v_accvgpr_read_b32 v233, a201
    v_accvgpr_read_b32 v234, a202
    v_accvgpr_read_b32 v235, a203
    v_accvgpr_read_b32 v236, a204
    v_accvgpr_read_b32 v237, a205
    v_accvgpr_read_b32 v238, a206
    v_accvgpr_read_b32 v239, a207
    v_accvgpr_read_b32 v240, a208
    v_accvgpr_read_b32 v241, a209
    v_accvgpr_read_b32 v242, a210
    v_accvgpr_read_b32 v243, a211
    v_accvgpr_read_b32 v244, a212
    v_accvgpr_read_b32 v245, a213
    v_accvgpr_read_b32 v246, a214
    v_accvgpr_read_b32 v247, a215
    v_accvgpr_read_b32 v248, a216
    v_accvgpr_read_b32 v249, a217
    v_accvgpr_read_b32 v250, a218
    v_accvgpr_read_b32 v251, a219
    v_accvgpr_read_b32 v252, a220
    v_accvgpr_read_b32 v253, a221
    v_accvgpr_read_b32 v254, a222
    v_accvgpr_read_b32 v255, a223
    v_pk_mul_f32 v[200:201], v[200:201], v[28:29] op_sel_hi:[1,0]
    v_pk_mul_f32 v[202:203], v[202:203], v[28:29] op_sel_hi:[1,0]
    v_pk_mul_f32 v[204:205], v[204:205], v[32:33] op_sel_hi:[1,0]
    v_pk_mul_f32 v[206:207], v[206:207], v[32:33] op_sel_hi:[1,0]
    v_pk_mul_f32 v[208:209], v[208:209], v[36:37] op_sel_hi:[1,0]
    v_pk_mul_f32 v[210:211], v[210:211], v[36:37] op_sel_hi:[1,0]
    v_pk_mul_f32 v[212:213], v[212:213], v[40:41] op_sel_hi:[1,0]
    v_pk_mul_f32 v[214:215], v[214:215], v[40:41] op_sel_hi:[1,0]
    v_pk_mul_f32 v[216:217], v[216:217], v[44:45] op_sel_hi:[1,0]
    v_pk_mul_f32 v[218:219], v[218:219], v[44:45] op_sel_hi:[1,0]
    v_pk_mul_f32 v[220:221], v[220:221], v[48:49] op_sel_hi:[1,0]
    v_pk_mul_f32 v[222:223], v[222:223], v[48:49] op_sel_hi:[1,0]
    v_pk_mul_f32 v[224:225], v[224:225], v[52:53] op_sel_hi:[1,0]
    v_pk_mul_f32 v[226:227], v[226:227], v[52:53] op_sel_hi:[1,0]
    v_pk_mul_f32 v[228:229], v[228:229], v[28:29] op_sel_hi:[1,0]
    v_pk_mul_f32 v[230:231], v[230:231], v[28:29] op_sel_hi:[1,0]
    v_pk_mul_f32 v[232:233], v[232:233], v[32:33] op_sel_hi:[1,0]
    v_pk_mul_f32 v[234:235], v[234:235], v[32:33] op_sel_hi:[1,0]
    v_pk_mul_f32 v[236:237], v[236:237], v[36:37] op_sel_hi:[1,0]
    v_pk_mul_f32 v[238:239], v[238:239], v[36:37] op_sel_hi:[1,0]
    v_pk_mul_f32 v[240:241], v[240:241], v[40:41] op_sel_hi:[1,0]
    v_pk_mul_f32 v[242:243], v[242:243], v[40:41] op_sel_hi:[1,0]
    v_pk_mul_f32 v[244:245], v[244:245], v[44:45] op_sel_hi:[1,0]
    v_pk_mul_f32 v[246:247], v[246:247], v[44:45] op_sel_hi:[1,0]
    v_pk_mul_f32 v[248:249], v[248:249], v[48:49] op_sel_hi:[1,0]
    v_pk_mul_f32 v[250:251], v[250:251], v[48:49] op_sel_hi:[1,0]
    v_pk_mul_f32 v[252:253], v[252:253], v[52:53] op_sel_hi:[1,0]
    v_pk_mul_f32 v[254:255], v[254:255], v[52:53] op_sel_hi:[1,0]
    v_cvt_pk_bf16_f32 v116, v200, v201
    v_cvt_pk_bf16_f32 v117, v202, v203
    v_cvt_pk_bf16_f32 v118, v228, v229
    v_cvt_pk_bf16_f32 v119, v230, v231
    v_cvt_pk_bf16_f32 v120, v204, v205
    v_cvt_pk_bf16_f32 v121, v206, v207
    v_cvt_pk_bf16_f32 v122, v232, v233
    v_cvt_pk_bf16_f32 v123, v234, v235
    v_cvt_pk_bf16_f32 v124, v208, v209
    v_cvt_pk_bf16_f32 v125, v210, v211
    v_cvt_pk_bf16_f32 v126, v236, v237
    v_cvt_pk_bf16_f32 v127, v238, v239
    v_cvt_pk_bf16_f32 v128, v212, v213
    v_cvt_pk_bf16_f32 v129, v214, v215
    v_cvt_pk_bf16_f32 v130, v240, v241
    v_cvt_pk_bf16_f32 v131, v242, v243
    v_cvt_pk_bf16_f32 v132, v216, v217
    v_cvt_pk_bf16_f32 v133, v218, v219
    v_cvt_pk_bf16_f32 v134, v244, v245
    v_cvt_pk_bf16_f32 v135, v246, v247
    v_cvt_pk_bf16_f32 v136, v220, v221
    v_cvt_pk_bf16_f32 v137, v222, v223
    v_cvt_pk_bf16_f32 v138, v248, v249
    v_cvt_pk_bf16_f32 v139, v250, v251
    v_cvt_pk_bf16_f32 v140, v224, v225
    v_cvt_pk_bf16_f32 v141, v226, v227
    v_cvt_pk_bf16_f32 v142, v252, v253
    v_cvt_pk_bf16_f32 v143, v254, v255
    s_nop 1
    v_permlane16_swap_b32 v116, v118
    v_permlane16_swap_b32 v117, v119
    v_permlane16_swap_b32 v120, v122
    v_permlane16_swap_b32 v121, v123
    v_permlane16_swap_b32 v124, v126
    v_permlane16_swap_b32 v125, v127
    v_permlane16_swap_b32 v128, v130
    v_permlane16_swap_b32 v129, v131
    v_permlane16_swap_b32 v132, v134
    v_permlane16_swap_b32 v133, v135
    v_permlane16_swap_b32 v136, v138
    v_permlane16_swap_b32 v137, v139
    v_permlane16_swap_b32 v140, v142
    v_permlane16_swap_b32 v141, v143
    s_mov_b32 s28, s31
    buffer_store_dwordx4 v[116:119], v10, s[12:15], s28 offen offset:3072 sc0 sc1
    s_add_u32 s28, s28, 4096
    buffer_store_dwordx4 v[120:123], v10, s[12:15], s28 offen offset:3072 sc0 sc1
    s_add_u32 s28, s28, 4096
    buffer_store_dwordx4 v[124:127], v10, s[12:15], s28 offen offset:3072 sc0 sc1
    s_add_u32 s28, s28, 4096
    buffer_store_dwordx4 v[128:131], v10, s[12:15], s28 offen offset:3072 sc0 sc1
    s_add_u32 s28, s28, 4096
    buffer_store_dwordx4 v[132:135], v10, s[12:15], s28 offen offset:3072 sc0 sc1
    s_add_u32 s28, s28, 4096
    buffer_store_dwordx4 v[136:139], v10, s[12:15], s28 offen offset:3072 sc0 sc1
    s_add_u32 s28, s28, 4096
    buffer_store_dwordx4 v[140:143], v10, s[12:15], s28 offen offset:3072 sc0 sc1
    s_nop 1
    s_cmp_lg_u32 s71, 2
    s_cbranch_scc1 L_at_nowo2
    s_mov_b32 s71, 3
    v_lshrrev_b32 v2, 4, v1
    v_bfe_u32 v3, v1, 2, 2
    v_lshl_add_u32 v3, v2, 3, v3
    v_mul_u32_u24 v3, 160, v3
    v_and_b32 v4, 3, v1
    v_lshl_add_u32 v3, v4, 3, v3
    s_mul_i32 s31, s20, 7168
    s_add_u32 s31, s31, 135168
    v_add_u32 v3, s31, v3
    v_lshlrev_b32 v4, 4, v1
    s_mul_i32 s28, s2, 40960
    s_mul_i32 s29, s20, 10240
    s_add_u32 s28, s28, s29
    s_add_u32 s28, s28, 117445632
    ds_read_b64_tr_b16 v[112:113], v3 offset:0
    ds_read_b64_tr_b16 v[114:115], v3 offset:640
    ds_read_b64_tr_b16 v[116:117], v3 offset:32
    ds_read_b64_tr_b16 v[118:119], v3 offset:672
    ds_read_b64_tr_b16 v[120:121], v3 offset:64
    ds_read_b64_tr_b16 v[122:123], v3 offset:704
    ds_read_b64_tr_b16 v[124:125], v3 offset:96
    ds_read_b64_tr_b16 v[126:127], v3 offset:736
    ds_read_b64_tr_b16 v[128:129], v3 offset:128
    ds_read_b64_tr_b16 v[130:131], v3 offset:768
    s_waitcnt lgkmcnt(0)
    buffer_store_dwordx4 v[112:115], v4, s[12:15], s28 offen offset:0 sc0 sc1
    buffer_store_dwordx4 v[116:119], v4, s[12:15], s28 offen offset:1024 sc0 sc1
    buffer_store_dwordx4 v[120:123], v4, s[12:15], s28 offen offset:2048 sc0 sc1
    buffer_store_dwordx4 v[124:127], v4, s[12:15], s28 offen offset:3072 sc0 sc1
    s_add_u32 s28, s28, 4096
    buffer_store_dwordx4 v[128:131], v4, s[12:15], s28 offen offset:0 sc0 sc1
    s_nop 1
L_at_nowo2:
    s_mov_b32 s68, 3
    s_cmp_ge_u32 s21, 2
    s_cbranch_scc1 L_at_fin
    s_cmp_eq_u32 s69, 0
    s_cbranch_scc1 L_at_round
    s_waitcnt vmcnt(28)
    s_branch L_at_pre
L_at_fin:
    s_waitcnt lgkmcnt(0)
    s_barrier
    s_cmp_le_u32 s21, s27
    s_cbranch_scc1 L_at_nofb_8455
    s_sub_u32 s28, s21, 1
    s_cmp_eq_u32 s28, s23
    s_cbranch_scc1 L_at_nofb_8455
    s_lshl_b32 s29, s28, 2
    s_add_u32 s29, s29, 76000
    v_mov_b32 v4, s29
    ds_read_b32 v4, v4
    s_waitcnt lgkmcnt(0)
    v_readfirstlane_b32 s29, v4
    s_nop 3
    s_cmp_lg_u32 s29, 0
    s_cbranch_scc1 L_at_fallback
L_at_nofb_8455:
    s_branch L_at_end
L_at_fallback:
    s_sub_u32 s27, s21, 1
    s_mov_b32 s23, s27
    s_mov_b32 s25, 1
    s_mov_b32 s69, 0
    s_mov_b32 s70, 0
    s_mov_b32 s68, 0
    v_mov_b32 v12, 0xff800000
    v_mov_b32 v14, 0xff800000
    v_mov_b32 v16, 0xff800000
    v_mov_b32 v18, 0xff800000
    v_mov_b32 v20, 0xff800000
    v_mov_b32 v22, 0xff800000
    v_mov_b32 v24, 0xff800000
    s_waitcnt vmcnt(0) lgkmcnt(0)
    s_barrier
    s_branch L_at_start
L_at_maxpass:
    s_mov_b32 s25, 0
    s_waitcnt lgkmcnt(0)
    v_and_b32 v2, 15, v1
    v_lshlrev_b32 v2, 8, v2
    v_bfe_u32 v3, v1, 4, 1
    v_lshl_add_u32 v2, v3, 5, v2
    v_bfe_u32 v3, v1, 5, 1
    v_lshl_add_u32 v4, v3, 4, v2
    v_add_u32 v5, 4096, v4
    s_lshl_b32 s29, s21, 19
    s_mov_b32 s22, 0
L_at_mp:
    buffer_load_dwordx4 v[112:115], v4, s[8:11], s29 offen offset:0
    buffer_load_dwordx4 v[116:119], v4, s[8:11], s29 offen offset:64
    buffer_load_dwordx4 v[120:123], v4, s[8:11], s29 offen offset:128
    buffer_load_dwordx4 v[124:127], v4, s[8:11], s29 offen offset:192
    buffer_load_dwordx4 v[128:131], v5, s[8:11], s29 offen offset:0
    buffer_load_dwordx4 v[132:135], v5, s[8:11], s29 offen offset:64
    buffer_load_dwordx4 v[136:139], v5, s[8:11], s29 offen offset:128
    buffer_load_dwordx4 v[140:143], v5, s[8:11], s29 offen offset:192
    s_waitcnt vmcnt(0)
    v_mfma_f32_16x16x32_bf16 v[88:91], v[112:115], a[0:3], 0
    v_mfma_f32_16x16x32_bf16 v[88:91], v[116:119], a[4:7], v[88:91]
    v_mfma_f32_16x16x32_bf16 v[88:91], v[120:123], a[8:11], v[88:91]
    v_mfma_f32_16x16x32_bf16 v[88:91], v[124:127], a[12:15], v[88:91]
    v_mfma_f32_16x16x32_bf16 v[92:95], v[128:131], a[0:3], 0
    v_mfma_f32_16x16x32_bf16 v[92:95], v[132:135], a[4:7], v[92:95]
    v_mfma_f32_16x16x32_bf16 v[92:95], v[136:139], a[8:11], v[92:95]
    v_mfma_f32_16x16x32_bf16 v[92:95], v[140:143], a[12:15], v[92:95]
    s_nop 9
    v_max3_f32 v12, v88, v89, v12
    v_max3_f32 v12, v90, v91, v12
    v_max3_f32 v12, v92, v93, v12
    v_max3_f32 v12, v94, v95, v12
    s_nop 3
    v_mfma_f32_16x16x32_bf16 v[88:91], v[112:115], a[16:19], 0
    v_mfma_f32_16x16x32_bf16 v[88:91], v[116:119], a[20:23], v[88:91]
    v_mfma_f32_16x16x32_bf16 v[88:91], v[120:123], a[24:27], v[88:91]
    v_mfma_f32_16x16x32_bf16 v[88:91], v[124:127], a[28:31], v[88:91]
    v_mfma_f32_16x16x32_bf16 v[92:95], v[128:131], a[16:19], 0
    v_mfma_f32_16x16x32_bf16 v[92:95], v[132:135], a[20:23], v[92:95]
    v_mfma_f32_16x16x32_bf16 v[92:95], v[136:139], a[24:27], v[92:95]
    v_mfma_f32_16x16x32_bf16 v[92:95], v[140:143], a[28:31], v[92:95]
    s_nop 9
    v_max3_f32 v14, v88, v89, v14
    v_max3_f32 v14, v90, v91, v14
    v_max3_f32 v14, v92, v93, v14
    v_max3_f32 v14, v94, v95, v14
    s_nop 3
    v_mfma_f32_16x16x32_bf16 v[88:91], v[112:115], a[32:35], 0
    v_mfma_f32_16x16x32_bf16 v[88:91], v[116:119], a[36:39], v[88:91]
    v_mfma_f32_16x16x32_bf16 v[88:91], v[120:123], a[40:43], v[88:91]
    v_mfma_f32_16x16x32_bf16 v[88:91], v[124:127], a[44:47], v[88:91]
    v_mfma_f32_16x16x32_bf16 v[92:95], v[128:131], a[32:35], 0
    v_mfma_f32_16x16x32_bf16 v[92:95], v[132:135], a[36:39], v[92:95]
    v_mfma_f32_16x16x32_bf16 v[92:95], v[136:139], a[40:43], v[92:95]
    v_mfma_f32_16x16x32_bf16 v[92:95], v[140:143], a[44:47], v[92:95]
    s_nop 9
    v_max3_f32 v16, v88, v89, v16
    v_max3_f32 v16, v90, v91, v16
    v_max3_f32 v16, v92, v93, v16
    v_max3_f32 v16, v94, v95, v16
    s_nop 3
    v_mfma_f32_16x16x32_bf16 v[88:91], v[112:115], a[48:51], 0
    v_mfma_f32_16x16x32_bf16 v[88:91], v[116:119], a[52:55], v[88:91]
    v_mfma_f32_16x16x32_bf16 v[88:91], v[120:123], a[56:59], v[88:91]
    v_mfma_f32_16x16x32_bf16 v[88:91], v[124:127], a[60:63], v[88:91]
    v_mfma_f32_16x16x32_bf16 v[92:95], v[128:131], a[48:51], 0
    v_mfma_f32_16x16x32_bf16 v[92:95], v[132:135], a[52:55], v[92:95]
    v_mfma_f32_16x16x32_bf16 v[92:95], v[136:139], a[56:59], v[92:95]
    v_mfma_f32_16x16x32_bf16 v[92:95], v[140:143], a[60:63], v[92:95]
    s_nop 9
    v_max3_f32 v18, v88, v89, v18
    v_max3_f32 v18, v90, v91, v18
    v_max3_f32 v18, v92, v93, v18
    v_max3_f32 v18, v94, v95, v18
    s_nop 3
    v_mfma_f32_16x16x32_bf16 v[88:91], v[112:115], a[64:67], 0
    v_mfma_f32_16x16x32_bf16 v[88:91], v[116:119], a[68:71], v[88:91]
    v_mfma_f32_16x16x32_bf16 v[88:91], v[120:123], a[72:75], v[88:91]
    v_mfma_f32_16x16x32_bf16 v[88:91], v[124:127], a[76:79], v[88:91]
    v_mfma_f32_16x16x32_bf16 v[92:95], v[128:131], a[64:67], 0
    v_mfma_f32_16x16x32_bf16 v[92:95], v[132:135], a[68:71], v[92:95]
    v_mfma_f32_16x16x32_bf16 v[92:95], v[136:139], a[72:75], v[92:95]
    v_mfma_f32_16x16x32_bf16 v[92:95], v[140:143], a[76:79], v[92:95]
    s_nop 9
    v_max3_f32 v20, v88, v89, v20
    v_max3_f32 v20, v90, v91, v20
    v_max3_f32 v20, v92, v93, v20
    v_max3_f32 v20, v94, v95, v20
    s_nop 3
    v_mfma_f32_16x16x32_bf16 v[88:91], v[112:115], a[80:83], 0
    v_mfma_f32_16x16x32_bf16 v[88:91], v[116:119], a[84:87], v[88:91]
    v_mfma_f32_16x16x32_bf16 v[88:91], v[120:123], a[88:91], v[88:91]
    v_mfma_f32_16x16x32_bf16 v[88:91], v[124:127], a[92:95], v[88:91]
    v_mfma_f32_16x16x32_bf16 v[92:95], v[128:131], a[80:83], 0
    v_mfma_f32_16x16x32_bf16 v[92:95], v[132:135], a[84:87], v[92:95]
    v_mfma_f32_16x16x32_bf16 v[92:95], v[136:139], a[88:91], v[92:95]
    v_mfma_f32_16x16x32_bf16 v[92:95], v[140:143], a[92:95], v[92:95]
    s_nop 9
    v_max3_f32 v22, v88, v89, v22
    v_max3_f32 v22, v90, v91, v22
    v_max3_f32 v22, v92, v93, v22
    v_max3_f32 v22, v94, v95, v22
    s_nop 3
    v_mfma_f32_16x16x32_bf16 v[88:91], v[112:115], a[96:99], 0
    v_mfma_f32_16x16x32_bf16 v[88:91], v[116:119], a[100:103], v[88:91]
    v_mfma_f32_16x16x32_bf16 v[88:91], v[120:123], a[104:107], v[88:91]
    v_mfma_f32_16x16x32_bf16 v[88:91], v[124:127], a[108:111], v[88:91]
    v_mfma_f32_16x16x32_bf16 v[92:95], v[128:131], a[96:99], 0
    v_mfma_f32_16x16x32_bf16 v[92:95], v[132:135], a[100:103], v[92:95]
    v_mfma_f32_16x16x32_bf16 v[92:95], v[136:139], a[104:107], v[92:95]
    v_mfma_f32_16x16x32_bf16 v[92:95], v[140:143], a[108:111], v[92:95]
    s_nop 9
    v_max3_f32 v24, v88, v89, v24
    v_max3_f32 v24, v90, v91, v24
    v_max3_f32 v24, v92, v93, v24
    v_max3_f32 v24, v94, v95, v24
    s_nop 3
    s_add_u32 s29, s29, 8192
    s_add_u32 s22, s22, 1
    s_cmp_lt_u32 s22, 32
    s_cbranch_scc1 L_at_mp
    s_branch L_at_pre
L_at_end:
    s_endpgm
.globl op_kernel
.p2align 8
.type op_kernel,@function
op_kernel:
    s_cmp_ge_u32 s2, 256
    s_cbranch_scc1 L_op_end
    s_load_dwordx2 s[36:37], s[0:1], 32
    s_load_dwordx2 s[38:39], s[0:1], 72
    s_load_dwordx2 s[40:41], s[0:1], 80
    s_load_dwordx2 s[44:45], s[0:1], 96
    v_and_b32 v1, 63, v0
    v_lshrrev_b32 v2, 6, v0
    s_nop 0
    v_readfirstlane_b32 s20, v2
    s_and_b32 s3, s2, 7
    s_lshl_b32 s3, s3, 3
    s_lshr_b32 s30, s2, 5
    s_add_u32 s3, s3, s30
    s_bfe_u32 s31, s2, 0x20003
    s_waitcnt lgkmcnt(0)
    s_cmp_ge_u32 s3, 32
    s_add_u32 s44, s44, 0
    s_addc_u32 s45, s45, 0
    s_mov_b32 s8, s44
    s_mov_b32 s9, s45
    s_mov_b32 s10, 127926272
    s_mov_b32 s11, 0x20000
    s_mov_b32 s4, s44
    s_mov_b32 s5, s45
    s_mov_b32 s6, 127926272
    s_mov_b32 s7, 0x20000
    s_mov_b32 s12, s40
    s_mov_b32 s13, s41
    s_mov_b32 s14, 9175040
    s_mov_b32 s15, 0x20000
    s_lshr_b32 s22, s3, 1
    s_mul_i32 s22, s22, 1835008
    s_and_b32 s23, s3, 1
    s_mul_i32 s23, s23, 28672
    s_add_u32 s22, s22, s23
    s_lshl_b32 s23, s20, 10
    s_add_u32 s22, s22, s23
    s_add_u32 s25, s22, 58720256
    s_lshr_b32 s22, s3, 5
    s_lshl_b32 s22, s22, 7
    s_add_u32 s22, s22, s20
    s_mul_i32 s22, s22, 40960
    s_mul_i32 s23, s31, 10240
    s_add_u32 s22, s22, s23
    s_add_u32 s26, s22, 117440512
    s_mul_i32 s27, s20, 40960
    v_lshlrev_b32 v6, 4, v1
    v_add_u32 v7, s27, v6
    v_bfe_u32 v4, v1, 4, 1
    v_lshlrev_b32 v4, 5, v4
    v_and_b32 v2, 15, v1
    v_mul_u32_u24 v2, 2560, v2
    v_add_u32 v2, v2, v4
    v_bfe_u32 v4, v1, 5, 1
    v_lshl_add_u32 v9, v4, 4, v2
    s_add_u32 m0, s27, 0
    s_mov_b32 s23, s26
    buffer_load_dwordx4 v6, s[8:11], s23 offen offset:0 lds
    buffer_load_dwordx4 v6, s[8:11], s23 offen offset:1024 lds
    buffer_load_dwordx4 v6, s[8:11], s23 offen offset:2048 lds
    buffer_load_dwordx4 v6, s[8:11], s23 offen offset:3072 lds
    s_add_u32 m0, s27, 4096
    s_add_u32 s23, s23, 4096
    buffer_load_dwordx4 v6, s[8:11], s23 offen offset:0 lds
    buffer_load_dwordx4 v6, s[8:11], s23 offen offset:1024 lds
    buffer_load_dwordx4 v6, s[8:11], s23 offen offset:2048 lds
    buffer_load_dwordx4 v6, s[8:11], s23 offen offset:3072 lds
    s_add_u32 m0, s27, 8192
    s_add_u32 s23, s23, 4096
    buffer_load_dwordx4 v6, s[8:11], s23 offen offset:0 lds
    buffer_load_dwordx4 v6, s[8:11], s23 offen offset:1024 lds
    s_add_u32 s26, s26, 163840
    s_mov_b32 s22, s25
    buffer_load_dwordx4 v[84:87], v6, s[4:7], s22 offen
    s_add_u32 s22, s22, 4096
    buffer_load_dwordx4 v[88:91], v6, s[4:7], s22 offen
    s_add_u32 s22, s22, 4096
    buffer_load_dwordx4 v[92:95], v6, s[4:7], s22 offen
    s_add_u32 s22, s22, 4096
    buffer_load_dwordx4 v[96:99], v6, s[4:7], s22 offen
    s_add_u32 s22, s22, 4096
    buffer_load_dwordx4 v[100:103], v6, s[4:7], s22 offen
    s_add_u32 s22, s22, 4096
    buffer_load_dwordx4 v[104:107], v6, s[4:7], s22 offen
    s_add_u32 s22, s22, 4096
    buffer_load_dwordx4 v[108:111], v6, s[4:7], s22 offen
    s_add_u32 s25, s25, 57344
    s_add_u32 m0, s27, 10240
    s_mov_b32 s23, s26
    buffer_load_dwordx4 v6, s[8:11], s23 offen offset:0 lds
    buffer_load_dwordx4 v6, s[8:11], s23 offen offset:1024 lds
    buffer_load_dwordx4 v6, s[8:11], s23 offen offset:2048 lds
    buffer_load_dwordx4 v6, s[8:11], s23 offen offset:3072 lds
    s_add_u32 m0, s27, 14336
    s_add_u32 s23, s23, 4096
    buffer_load_dwordx4 v6, s[8:11], s23 offen offset:0 lds
    buffer_load_dwordx4 v6, s[8:11], s23 offen offset:1024 lds
    buffer_load_dwordx4 v6, s[8:11], s23 offen offset:2048 lds
    buffer_load_dwordx4 v6, s[8:11], s23 offen offset:3072 lds
    s_add_u32 m0, s27, 18432
    s_add_u32 s23, s23, 4096
    buffer_load_dwordx4 v6, s[8:11], s23 offen offset:0 lds
    buffer_load_dwordx4 v6, s[8:11], s23 offen offset:1024 lds
    s_add_u32 s26, s26, 163840
    s_lshl_b32 s22, s20, 11
    v_add_u32 v2, s22, v6
    v_add_u32 v3, 40960, v2
    v_add_u32 v4, 81920, v2
    v_add_u32 v5, 122880, v2
    s_and_b32 s22, s3, 31
    s_mul_i32 s22, s22, 286720
    s_lshr_b32 s32, s3, 5
    s_mul_i32 s32, s32, 1280
    s_add_u32 s22, s22, s32
    s_mul_i32 s32, s31, 320
    s_add_u32 s24, s22, s32
    s_waitcnt vmcnt(17)
    ds_read_b128 v[44:47], v7 offset:0
    ds_read_b128 v[48:51], v7 offset:1024
    ds_read_b128 v[52:55], v7 offset:2048
    ds_read_b128 v[56:59], v7 offset:3072
    ds_read_b128 v[60:63], v7 offset:4096
    ds_read_b128 v[64:67], v7 offset:5120
    ds_read_b128 v[68:71], v7 offset:6144
    ds_read_b128 v[72:75], v7 offset:7168
    ds_read_b128 v[76:79], v7 offset:8192
    ds_read_b128 v[80:83], v7 offset:9216
    s_waitcnt vmcnt(0) lgkmcnt(7)
    v_mfma_f32_16x16x32_bf16 a[0:3], v[44:47], v[84:87], 0
    s_mov_b32 s22, s25
    v_mfma_f32_16x16x32_bf16 a[4:7], v[44:47], v[88:91], 0
    buffer_load_dwordx4 v[112:115], v6, s[4:7], s22 offen
    v_mfma_f32_16x16x32_bf16 a[8:11], v[44:47], v[92:95], 0
    s_add_u32 s22, s22, 4096
    v_mfma_f32_16x16x32_bf16 a[12:15], v[44:47], v[96:99], 0
    buffer_load_dwordx4 v[116:119], v6, s[4:7], s22 offen
    v_mfma_f32_16x16x32_bf16 a[16:19], v[44:47], v[100:103], 0
    s_add_u32 s22, s22, 4096
    v_mfma_f32_16x16x32_bf16 a[20:23], v[44:47], v[104:107], 0
    buffer_load_dwordx4 v[120:123], v6, s[4:7], s22 offen
    v_mfma_f32_16x16x32_bf16 a[24:27], v[44:47], v[108:111], 0
    ds_read_b128 v[44:47], v7 offset:10240
    v_mfma_f32_16x16x32_bf16 a[28:31], v[48:51], v[84:87], 0
    s_add_u32 s22, s22, 4096
    v_mfma_f32_16x16x32_bf16 a[32:35], v[48:51], v[88:91], 0
    buffer_load_dwordx4 v[124:127], v6, s[4:7], s22 offen
    v_mfma_f32_16x16x32_bf16 a[36:39], v[48:51], v[92:95], 0
    s_add_u32 s22, s22, 4096
    v_mfma_f32_16x16x32_bf16 a[40:43], v[48:51], v[96:99], 0
    buffer_load_dwordx4 v[128:131], v6, s[4:7], s22 offen
    v_mfma_f32_16x16x32_bf16 a[44:47], v[48:51], v[100:103], 0
    s_add_u32 s22, s22, 4096
    v_mfma_f32_16x16x32_bf16 a[48:51], v[48:51], v[104:107], 0
    buffer_load_dwordx4 v[132:135], v6, s[4:7], s22 offen
    v_mfma_f32_16x16x32_bf16 a[52:55], v[48:51], v[108:111], 0
    ds_read_b128 v[48:51], v7 offset:11264
    s_waitcnt lgkmcnt(2)
    v_mfma_f32_16x16x32_bf16 a[56:59], v[52:55], v[84:87], 0
    s_add_u32 s22, s22, 4096
    v_mfma_f32_16x16x32_bf16 a[60:63], v[52:55], v[88:91], 0
    buffer_load_dwordx4 v[136:139], v6, s[4:7], s22 offen
    v_mfma_f32_16x16x32_bf16 a[64:67], v[52:55], v[92:95], 0
    s_add_u32 s25, s25, 57344
    v_mfma_f32_16x16x32_bf16 a[68:71], v[52:55], v[96:99], 0
    s_add_u32 m0, s27, 20480
    v_mfma_f32_16x16x32_bf16 a[72:75], v[52:55], v[100:103], 0
    s_mov_b32 s23, s26
    v_mfma_f32_16x16x32_bf16 a[76:79], v[52:55], v[104:107], 0
    buffer_load_dwordx4 v6, s[8:11], s23 offen offset:0 lds
    v_mfma_f32_16x16x32_bf16 a[80:83], v[52:55], v[108:111], 0
    ds_read_b128 v[52:55], v7 offset:12288
    v_mfma_f32_16x16x32_bf16 a[84:87], v[56:59], v[84:87], 0
    buffer_load_dwordx4 v6, s[8:11], s23 offen offset:1024 lds
    v_mfma_f32_16x16x32_bf16 a[88:91], v[56:59], v[88:91], 0
    buffer_load_dwordx4 v6, s[8:11], s23 offen offset:2048 lds
    v_mfma_f32_16x16x32_bf16 a[92:95], v[56:59], v[92:95], 0
    buffer_load_dwordx4 v6, s[8:11], s23 offen offset:3072 lds
    v_mfma_f32_16x16x32_bf16 a[96:99], v[56:59], v[96:99], 0
    s_add_u32 m0, s27, 24576
    v_mfma_f32_16x16x32_bf16 a[100:103], v[56:59], v[100:103], 0
    s_add_u32 s23, s23, 4096
    v_mfma_f32_16x16x32_bf16 a[104:107], v[56:59], v[104:107], 0
    buffer_load_dwordx4 v6, s[8:11], s23 offen offset:0 lds
    v_mfma_f32_16x16x32_bf16 a[108:111], v[56:59], v[108:111], 0
    ds_read_b128 v[56:59], v7 offset:13312
    v_mfma_f32_16x16x32_bf16 a[112:115], v[60:63], v[84:87], 0
    buffer_load_dwordx4 v6, s[8:11], s23 offen offset:1024 lds
    v_mfma_f32_16x16x32_bf16 a[116:119], v[60:63], v[88:91], 0
    buffer_load_dwordx4 v6, s[8:11], s23 offen offset:2048 lds
    v_mfma_f32_16x16x32_bf16 a[120:123], v[60:63], v[92:95], 0
    buffer_load_dwordx4 v6, s[8:11], s23 offen offset:3072 lds
    v_mfma_f32_16x16x32_bf16 a[124:127], v[60:63], v[96:99], 0
    s_add_u32 m0, s27, 28672
    v_mfma_f32_16x16x32_bf16 a[128:131], v[60:63], v[100:103], 0
    s_add_u32 s23, s23, 4096
    v_mfma_f32_16x16x32_bf16 a[132:135], v[60:63], v[104:107], 0
    buffer_load_dwordx4 v6, s[8:11], s23 offen offset:0 lds
    v_mfma_f32_16x16x32_bf16 a[136:139], v[60:63], v[108:111], 0
    ds_read_b128 v[60:63], v7 offset:14336
    v_mfma_f32_16x16x32_bf16 a[140:143], v[64:67], v[84:87], 0
    buffer_load_dwordx4 v6, s[8:11], s23 offen offset:1024 lds
    v_mfma_f32_16x16x32_bf16 a[144:147], v[64:67], v[88:91], 0
    s_add_u32 s26, s26, 163840
    v_mfma_f32_16x16x32_bf16 a[148:151], v[64:67], v[92:95], 0
    s_mov_b32 s22, s25
    v_mfma_f32_16x16x32_bf16 a[152:155], v[64:67], v[96:99], 0
    buffer_load_dwordx4 v[140:143], v6, s[4:7], s22 offen
    v_mfma_f32_16x16x32_bf16 a[156:159], v[64:67], v[100:103], 0
    s_add_u32 s22, s22, 4096
    v_mfma_f32_16x16x32_bf16 a[160:163], v[64:67], v[104:107], 0
    buffer_load_dwordx4 v[144:147], v6, s[4:7], s22 offen
    v_mfma_f32_16x16x32_bf16 a[164:167], v[64:67], v[108:111], 0
    ds_read_b128 v[64:67], v7 offset:15360
    v_mfma_f32_16x16x32_bf16 a[168:171], v[68:71], v[84:87], 0
    s_add_u32 s22, s22, 4096
    v_mfma_f32_16x16x32_bf16 a[172:175], v[68:71], v[88:91], 0
    buffer_load_dwordx4 v[148:151], v6, s[4:7], s22 offen
    v_mfma_f32_16x16x32_bf16 a[176:179], v[68:71], v[92:95], 0
    s_add_u32 s22, s22, 4096
    v_mfma_f32_16x16x32_bf16 a[180:183], v[68:71], v[96:99], 0
    buffer_load_dwordx4 v[152:155], v6, s[4:7], s22 offen
    v_mfma_f32_16x16x32_bf16 a[184:187], v[68:71], v[100:103], 0
    s_add_u32 s22, s22, 4096
    v_mfma_f32_16x16x32_bf16 a[188:191], v[68:71], v[104:107], 0
    buffer_load_dwordx4 v[156:159], v6, s[4:7], s22 offen
    v_mfma_f32_16x16x32_bf16 a[192:195], v[68:71], v[108:111], 0
    ds_read_b128 v[68:71], v7 offset:16384
    v_mfma_f32_16x16x32_bf16 a[196:199], v[72:75], v[84:87], 0
    s_add_u32 s22, s22, 4096
    v_mfma_f32_16x16x32_bf16 a[200:203], v[72:75], v[88:91], 0
    buffer_load_dwordx4 v[160:163], v6, s[4:7], s22 offen
    v_mfma_f32_16x16x32_bf16 a[204:207], v[72:75], v[92:95], 0
    s_add_u32 s22, s22, 4096
    v_mfma_f32_16x16x32_bf16 a[208:211], v[72:75], v[96:99], 0
    buffer_load_dwordx4 v[164:167], v6, s[4:7], s22 offen
    v_mfma_f32_16x16x32_bf16 a[212:215], v[72:75], v[100:103], 0
    s_add_u32 s25, s25, 57344
    v_mfma_f32_16x16x32_bf16 a[216:219], v[72:75], v[104:107], 0
    v_mfma_f32_16x16x32_bf16 a[220:223], v[72:75], v[108:111], 0
    ds_read_b128 v[72:75], v7 offset:17408
    v_mfma_f32_16x16x32_bf16 a[224:227], v[76:79], v[84:87], 0
    v_mfma_f32_16x16x32_bf16 a[228:231], v[76:79], v[88:91], 0
    v_mfma_f32_16x16x32_bf16 a[232:235], v[76:79], v[92:95], 0
    v_mfma_f32_16x16x32_bf16 a[236:239], v[76:79], v[96:99], 0
    v_mfma_f32_16x16x32_bf16 a[240:243], v[76:79], v[100:103], 0
    v_mfma_f32_16x16x32_bf16 a[244:247], v[76:79], v[104:107], 0
    v_mfma_f32_16x16x32_bf16 a[248:251], v[76:79], v[108:111], 0
    ds_read_b128 v[76:79], v7 offset:18432
    v_mfma_f32_16x16x32_bf16 a[252:255], v[80:83], v[84:87], 0
    v_mfma_f32_16x16x32_bf16 v[20:23], v[80:83], v[88:91], 0
    v_mfma_f32_16x16x32_bf16 v[24:27], v[80:83], v[92:95], 0
    v_mfma_f32_16x16x32_bf16 v[28:31], v[80:83], v[96:99], 0
    v_mfma_f32_16x16x32_bf16 v[32:35], v[80:83], v[100:103], 0
    v_mfma_f32_16x16x32_bf16 v[36:39], v[80:83], v[104:107], 0
    v_mfma_f32_16x16x32_bf16 v[40:43], v[80:83], v[108:111], 0
    ds_read_b128 v[80:83], v7 offset:19456
    s_waitcnt vmcnt(7) lgkmcnt(7)
    v_mfma_f32_16x16x32_bf16 a[0:3], v[44:47], v[112:115], a[0:3]
    v_mfma_f32_16x16x32_bf16 a[4:7], v[44:47], v[116:119], a[4:7]
    v_mfma_f32_16x16x32_bf16 a[8:11], v[44:47], v[120:123], a[8:11]
    v_mfma_f32_16x16x32_bf16 a[12:15], v[44:47], v[124:127], a[12:15]
    v_mfma_f32_16x16x32_bf16 a[16:19], v[44:47], v[128:131], a[16:19]
    v_mfma_f32_16x16x32_bf16 a[20:23], v[44:47], v[132:135], a[20:23]
    v_mfma_f32_16x16x32_bf16 a[24:27], v[44:47], v[136:139], a[24:27]
    ds_read_b128 v[44:47], v7 offset:20480
    v_mfma_f32_16x16x32_bf16 a[28:31], v[48:51], v[112:115], a[28:31]
    v_mfma_f32_16x16x32_bf16 a[32:35], v[48:51], v[116:119], a[32:35]
    v_mfma_f32_16x16x32_bf16 a[36:39], v[48:51], v[120:123], a[36:39]
    v_mfma_f32_16x16x32_bf16 a[40:43], v[48:51], v[124:127], a[40:43]
    v_mfma_f32_16x16x32_bf16 a[44:47], v[48:51], v[128:131], a[44:47]
    v_mfma_f32_16x16x32_bf16 a[48:51], v[48:51], v[132:135], a[48:51]
    v_mfma_f32_16x16x32_bf16 a[52:55], v[48:51], v[136:139], a[52:55]
    ds_read_b128 v[48:51], v7 offset:21504
    s_waitcnt lgkmcnt(2)
    v_mfma_f32_16x16x32_bf16 a[56:59], v[52:55], v[112:115], a[56:59]
    s_add_u32 m0, s27, 30720
    v_mfma_f32_16x16x32_bf16 a[60:63], v[52:55], v[116:119], a[60:63]
    s_mov_b32 s23, s26
    v_mfma_f32_16x16x32_bf16 a[64:67], v[52:55], v[120:123], a[64:67]
    buffer_load_dwordx4 v6, s[8:11], s23 offen offset:0 lds
    v_mfma_f32_16x16x32_bf16 a[68:71], v[52:55], v[124:127], a[68:71]
    buffer_load_dwordx4 v6, s[8:11], s23 offen offset:1024 lds
    v_mfma_f32_16x16x32_bf16 a[72:75], v[52:55], v[128:131], a[72:75]
    buffer_load_dwordx4 v6, s[8:11], s23 offen offset:2048 lds
    v_mfma_f32_16x16x32_bf16 a[76:79], v[52:55], v[132:135], a[76:79]
    buffer_load_dwordx4 v6, s[8:11], s23 offen offset:3072 lds
    v_mfma_f32_16x16x32_bf16 a[80:83], v[52:55], v[136:139], a[80:83]
    ds_read_b128 v[52:55], v7 offset:22528
    v_mfma_f32_16x16x32_bf16 a[84:87], v[56:59], v[112:115], a[84:87]
    s_add_u32 m0, s27, 34816
    v_mfma_f32_16x16x32_bf16 a[88:91], v[56:59], v[116:119], a[88:91]
    s_add_u32 s23, s23, 4096
    v_mfma_f32_16x16x32_bf16 a[92:95], v[56:59], v[120:123], a[92:95]
    buffer_load_dwordx4 v6, s[8:11], s23 offen offset:0 lds
    v_mfma_f32_16x16x32_bf16 a[96:99], v[56:59], v[124:127], a[96:99]
    buffer_load_dwordx4 v6, s[8:11], s23 offen offset:1024 lds
    v_mfma_f32_16x16x32_bf16 a[100:103], v[56:59], v[128:131], a[100:103]
    buffer_load_dwordx4 v6, s[8:11], s23 offen offset:2048 lds
    v_mfma_f32_16x16x32_bf16 a[104:107], v[56:59], v[132:135], a[104:107]
    buffer_load_dwordx4 v6, s[8:11], s23 offen offset:3072 lds
    v_mfma_f32_16x16x32_bf16 a[108:111], v[56:59], v[136:139], a[108:111]
    ds_read_b128 v[56:59], v7 offset:23552
    v_mfma_f32_16x16x32_bf16 a[112:115], v[60:63], v[112:115], a[112:115]
    s_add_u32 m0, s27, 38912
    v_mfma_f32_16x16x32_bf16 a[116:119], v[60:63], v[116:119], a[116:119]
    s_add_u32 s23, s23, 4096
    v_mfma_f32_16x16x32_bf16 a[120:123], v[60:63], v[120:123], a[120:123]
    buffer_load_dwordx4 v6, s[8:11], s23 offen offset:0 lds
    v_mfma_f32_16x16x32_bf16 a[124:127], v[60:63], v[124:127], a[124:127]
    buffer_load_dwordx4 v6, s[8:11], s23 offen offset:1024 lds
    v_mfma_f32_16x16x32_bf16 a[128:131], v[60:63], v[128:131], a[128:131]
    s_add_u32 s26, s26, 163840
    v_mfma_f32_16x16x32_bf16 a[132:135], v[60:63], v[132:135], a[132:135]
    s_mov_b32 s22, s25
    v_mfma_f32_16x16x32_bf16 a[136:139], v[60:63], v[136:139], a[136:139]
    ds_read_b128 v[60:63], v7 offset:24576
    v_mfma_f32_16x16x32_bf16 a[140:143], v[64:67], v[112:115], a[140:143]
    buffer_load_dwordx4 v[168:171], v6, s[4:7], s22 offen
    v_mfma_f32_16x16x32_bf16 a[144:147], v[64:67], v[116:119], a[144:147]
    s_add_u32 s22, s22, 4096
    v_mfma_f32_16x16x32_bf16 a[148:151], v[64:67], v[120:123], a[148:151]
    buffer_load_dwordx4 v[172:175], v6, s[4:7], s22 offen
    v_mfma_f32_16x16x32_bf16 a[152:155], v[64:67], v[124:127], a[152:155]
    s_add_u32 s22, s22, 4096
    v_mfma_f32_16x16x32_bf16 a[156:159], v[64:67], v[128:131], a[156:159]
    buffer_load_dwordx4 v[176:179], v6, s[4:7], s22 offen
    v_mfma_f32_16x16x32_bf16 a[160:163], v[64:67], v[132:135], a[160:163]
    s_add_u32 s22, s22, 4096
    v_mfma_f32_16x16x32_bf16 a[164:167], v[64:67], v[136:139], a[164:167]
    ds_read_b128 v[64:67], v7 offset:25600
    v_mfma_f32_16x16x32_bf16 a[168:171], v[68:71], v[112:115], a[168:171]
    buffer_load_dwordx4 v[180:183], v6, s[4:7], s22 offen
    v_mfma_f32_16x16x32_bf16 a[172:175], v[68:71], v[116:119], a[172:175]
    s_add_u32 s22, s22, 4096
    v_mfma_f32_16x16x32_bf16 a[176:179], v[68:71], v[120:123], a[176:179]
    buffer_load_dwordx4 v[184:187], v6, s[4:7], s22 offen
    v_mfma_f32_16x16x32_bf16 a[180:183], v[68:71], v[124:127], a[180:183]
    s_add_u32 s22, s22, 4096
    v_mfma_f32_16x16x32_bf16 a[184:187], v[68:71], v[128:131], a[184:187]
    buffer_load_dwordx4 v[188:191], v6, s[4:7], s22 offen
    v_mfma_f32_16x16x32_bf16 a[188:191], v[68:71], v[132:135], a[188:191]
    s_add_u32 s22, s22, 4096
    v_mfma_f32_16x16x32_bf16 a[192:195], v[68:71], v[136:139], a[192:195]
    ds_read_b128 v[68:71], v7 offset:26624
    v_mfma_f32_16x16x32_bf16 a[196:199], v[72:75], v[112:115], a[196:199]
    buffer_load_dwordx4 v[192:195], v6, s[4:7], s22 offen
    v_mfma_f32_16x16x32_bf16 a[200:203], v[72:75], v[116:119], a[200:203]
    s_add_u32 s25, s25, 57344
    v_mfma_f32_16x16x32_bf16 a[204:207], v[72:75], v[120:123], a[204:207]
    s_add_u32 m0, s27, 0
    v_mfma_f32_16x16x32_bf16 a[208:211], v[72:75], v[124:127], a[208:211]
    s_mov_b32 s23, s26
    v_mfma_f32_16x16x32_bf16 a[212:215], v[72:75], v[128:131], a[212:215]
    buffer_load_dwordx4 v6, s[8:11], s23 offen offset:0 lds
    v_mfma_f32_16x16x32_bf16 a[216:219], v[72:75], v[132:135], a[216:219]
    buffer_load_dwordx4 v6, s[8:11], s23 offen offset:1024 lds
    v_mfma_f32_16x16x32_bf16 a[220:223], v[72:75], v[136:139], a[220:223]
    ds_read_b128 v[72:75], v7 offset:27648
    v_mfma_f32_16x16x32_bf16 a[224:227], v[76:79], v[112:115], a[224:227]
    buffer_load_dwordx4 v6, s[8:11], s23 offen offset:2048 lds
    v_mfma_f32_16x16x32_bf16 a[228:231], v[76:79], v[116:119], a[228:231]
    buffer_load_dwordx4 v6, s[8:11], s23 offen offset:3072 lds
    v_mfma_f32_16x16x32_bf16 a[232:235], v[76:79], v[120:123], a[232:235]
    s_add_u32 m0, s27, 4096
    v_mfma_f32_16x16x32_bf16 a[236:239], v[76:79], v[124:127], a[236:239]
    s_add_u32 s23, s23, 4096
    v_mfma_f32_16x16x32_bf16 a[240:243], v[76:79], v[128:131], a[240:243]
    buffer_load_dwordx4 v6, s[8:11], s23 offen offset:0 lds
    v_mfma_f32_16x16x32_bf16 a[244:247], v[76:79], v[132:135], a[244:247]
    buffer_load_dwordx4 v6, s[8:11], s23 offen offset:1024 lds
    v_mfma_f32_16x16x32_bf16 a[248:251], v[76:79], v[136:139], a[248:251]
    ds_read_b128 v[76:79], v7 offset:28672
    v_mfma_f32_16x16x32_bf16 a[252:255], v[80:83], v[112:115], a[252:255]
    buffer_load_dwordx4 v6, s[8:11], s23 offen offset:2048 lds
    v_mfma_f32_16x16x32_bf16 v[20:23], v[80:83], v[116:119], v[20:23]
    buffer_load_dwordx4 v6, s[8:11], s23 offen offset:3072 lds
    v_mfma_f32_16x16x32_bf16 v[24:27], v[80:83], v[120:123], v[24:27]
    s_add_u32 m0, s27, 8192
    v_mfma_f32_16x16x32_bf16 v[28:31], v[80:83], v[124:127], v[28:31]
    s_add_u32 s23, s23, 4096
    v_mfma_f32_16x16x32_bf16 v[32:35], v[80:83], v[128:131], v[32:35]
    buffer_load_dwordx4 v6, s[8:11], s23 offen offset:0 lds
    v_mfma_f32_16x16x32_bf16 v[36:39], v[80:83], v[132:135], v[36:39]
    buffer_load_dwordx4 v6, s[8:11], s23 offen offset:1024 lds
    v_mfma_f32_16x16x32_bf16 v[40:43], v[80:83], v[136:139], v[40:43]
    ds_read_b128 v[80:83], v7 offset:29696
    s_add_u32 s26, s26, 163840
    s_waitcnt vmcnt(17) lgkmcnt(7)
    v_mfma_f32_16x16x32_bf16 a[0:3], v[44:47], v[140:143], a[0:3]
    s_mov_b32 s22, s25
    v_mfma_f32_16x16x32_bf16 a[4:7], v[44:47], v[144:147], a[4:7]
    buffer_load_dwordx4 v[84:87], v6, s[4:7], s22 offen
    v_mfma_f32_16x16x32_bf16 a[8:11], v[44:47], v[148:151], a[8:11]
    s_add_u32 s22, s22, 4096
    v_mfma_f32_16x16x32_bf16 a[12:15], v[44:47], v[152:155], a[12:15]
    buffer_load_dwordx4 v[88:91], v6, s[4:7], s22 offen
    v_mfma_f32_16x16x32_bf16 a[16:19], v[44:47], v[156:159], a[16:19]
    s_add_u32 s22, s22, 4096
    v_mfma_f32_16x16x32_bf16 a[20:23], v[44:47], v[160:163], a[20:23]
    buffer_load_dwordx4 v[92:95], v6, s[4:7], s22 offen
    v_mfma_f32_16x16x32_bf16 a[24:27], v[44:47], v[164:167], a[24:27]
    ds_read_b128 v[44:47], v7 offset:30720
    v_mfma_f32_16x16x32_bf16 a[28:31], v[48:51], v[140:143], a[28:31]
    s_add_u32 s22, s22, 4096
    v_mfma_f32_16x16x32_bf16 a[32:35], v[48:51], v[144:147], a[32:35]
    buffer_load_dwordx4 v[96:99], v6, s[4:7], s22 offen
    v_mfma_f32_16x16x32_bf16 a[36:39], v[48:51], v[148:151], a[36:39]
    s_add_u32 s22, s22, 4096
    v_mfma_f32_16x16x32_bf16 a[40:43], v[48:51], v[152:155], a[40:43]
    buffer_load_dwordx4 v[100:103], v6, s[4:7], s22 offen
    v_mfma_f32_16x16x32_bf16 a[44:47], v[48:51], v[156:159], a[44:47]
    s_add_u32 s22, s22, 4096
    v_mfma_f32_16x16x32_bf16 a[48:51], v[48:51], v[160:163], a[48:51]
    buffer_load_dwordx4 v[104:107], v6, s[4:7], s22 offen
    v_mfma_f32_16x16x32_bf16 a[52:55], v[48:51], v[164:167], a[52:55]
    ds_read_b128 v[48:51], v7 offset:31744
    s_waitcnt lgkmcnt(2)
    v_mfma_f32_16x16x32_bf16 a[56:59], v[52:55], v[140:143], a[56:59]
    s_add_u32 s22, s22, 4096
    v_mfma_f32_16x16x32_bf16 a[60:63], v[52:55], v[144:147], a[60:63]
    buffer_load_dwordx4 v[108:111], v6, s[4:7], s22 offen
    v_mfma_f32_16x16x32_bf16 a[64:67], v[52:55], v[148:151], a[64:67]
    s_add_u32 s25, s25, 57344
    v_mfma_f32_16x16x32_bf16 a[68:71], v[52:55], v[152:155], a[68:71]
    s_add_u32 m0, s27, 10240
    v_mfma_f32_16x16x32_bf16 a[72:75], v[52:55], v[156:159], a[72:75]
    s_mov_b32 s23, s26
    v_mfma_f32_16x16x32_bf16 a[76:79], v[52:55], v[160:163], a[76:79]
    buffer_load_dwordx4 v6, s[8:11], s23 offen offset:0 lds
    v_mfma_f32_16x16x32_bf16 a[80:83], v[52:55], v[164:167], a[80:83]
    ds_read_b128 v[52:55], v7 offset:32768
    v_mfma_f32_16x16x32_bf16 a[84:87], v[56:59], v[140:143], a[84:87]
    buffer_load_dwordx4 v6, s[8:11], s23 offen offset:1024 lds
    v_mfma_f32_16x16x32_bf16 a[88:91], v[56:59], v[144:147], a[88:91]
    buffer_load_dwordx4 v6, s[8:11], s23 offen offset:2048 lds
    v_mfma_f32_16x16x32_bf16 a[92:95], v[56:59], v[148:151], a[92:95]
    buffer_load_dwordx4 v6, s[8:11], s23 offen offset:3072 lds
    v_mfma_f32_16x16x32_bf16 a[96:99], v[56:59], v[152:155], a[96:99]
    s_add_u32 m0, s27, 14336
    v_mfma_f32_16x16x32_bf16 a[100:103], v[56:59], v[156:159], a[100:103]
    s_add_u32 s23, s23, 4096
    v_mfma_f32_16x16x32_bf16 a[104:107], v[56:59], v[160:163], a[104:107]
    buffer_load_dwordx4 v6, s[8:11], s23 offen offset:0 lds
    v_mfma_f32_16x16x32_bf16 a[108:111], v[56:59], v[164:167], a[108:111]
    ds_read_b128 v[56:59], v7 offset:33792
    v_mfma_f32_16x16x32_bf16 a[112:115], v[60:63], v[140:143], a[112:115]
    buffer_load_dwordx4 v6, s[8:11], s23 offen offset:1024 lds
    v_mfma_f32_16x16x32_bf16 a[116:119], v[60:63], v[144:147], a[116:119]
    buffer_load_dwordx4 v6, s[8:11], s23 offen offset:2048 lds
    v_mfma_f32_16x16x32_bf16 a[120:123], v[60:63], v[148:151], a[120:123]
    buffer_load_dwordx4 v6, s[8:11], s23 offen offset:3072 lds
    v_mfma_f32_16x16x32_bf16 a[124:127], v[60:63], v[152:155], a[124:127]
    s_add_u32 m0, s27, 18432
    v_mfma_f32_16x16x32_bf16 a[128:131], v[60:63], v[156:159], a[128:131]
    s_add_u32 s23, s23, 4096
    v_mfma_f32_16x16x32_bf16 a[132:135], v[60:63], v[160:163], a[132:135]
    buffer_load_dwordx4 v6, s[8:11], s23 offen offset:0 lds
    v_mfma_f32_16x16x32_bf16 a[136:139], v[60:63], v[164:167], a[136:139]
    ds_read_b128 v[60:63], v7 offset:34816
    v_mfma_f32_16x16x32_bf16 a[140:143], v[64:67], v[140:143], a[140:143]
    buffer_load_dwordx4 v6, s[8:11], s23 offen offset:1024 lds
    v_mfma_f32_16x16x32_bf16 a[144:147], v[64:67], v[144:147], a[144:147]
    s_add_u32 s26, s26, 163840
    v_mfma_f32_16x16x32_bf16 a[148:151], v[64:67], v[148:151], a[148:151]
    s_mov_b32 s22, s25
    v_mfma_f32_16x16x32_bf16 a[152:155], v[64:67], v[152:155], a[152:155]
    buffer_load_dwordx4 v[112:115], v6, s[4:7], s22 offen
    v_mfma_f32_16x16x32_bf16 a[156:159], v[64:67], v[156:159], a[156:159]
    s_add_u32 s22, s22, 4096
    v_mfma_f32_16x16x32_bf16 a[160:163], v[64:67], v[160:163], a[160:163]
    buffer_load_dwordx4 v[116:119], v6, s[4:7], s22 offen
    v_mfma_f32_16x16x32_bf16 a[164:167], v[64:67], v[164:167], a[164:167]
    ds_read_b128 v[64:67], v7 offset:35840
    v_mfma_f32_16x16x32_bf16 a[168:171], v[68:71], v[140:143], a[168:171]
    s_add_u32 s22, s22, 4096
    v_mfma_f32_16x16x32_bf16 a[172:175], v[68:71], v[144:147], a[172:175]
    buffer_load_dwordx4 v[120:123], v6, s[4:7], s22 offen
    v_mfma_f32_16x16x32_bf16 a[176:179], v[68:71], v[148:151], a[176:179]
    s_add_u32 s22, s22, 4096
    v_mfma_f32_16x16x32_bf16 a[180:183], v[68:71], v[152:155], a[180:183]
    buffer_load_dwordx4 v[124:127], v6, s[4:7], s22 offen
    v_mfma_f32_16x16x32_bf16 a[184:187], v[68:71], v[156:159], a[184:187]
    s_add_u32 s22, s22, 4096
    v_mfma_f32_16x16x32_bf16 a[188:191], v[68:71], v[160:163], a[188:191]
    buffer_load_dwordx4 v[128:131], v6, s[4:7], s22 offen
    v_mfma_f32_16x16x32_bf16 a[192:195], v[68:71], v[164:167], a[192:195]
    ds_read_b128 v[68:71], v7 offset:36864
    v_mfma_f32_16x16x32_bf16 a[196:199], v[72:75], v[140:143], a[196:199]
    s_add_u32 s22, s22, 4096
    v_mfma_f32_16x16x32_bf16 a[200:203], v[72:75], v[144:147], a[200:203]
    buffer_load_dwordx4 v[132:135], v6, s[4:7], s22 offen
    v_mfma_f32_16x16x32_bf16 a[204:207], v[72:75], v[148:151], a[204:207]
    s_add_u32 s22, s22, 4096
    v_mfma_f32_16x16x32_bf16 a[208:211], v[72:75], v[152:155], a[208:211]
    buffer_load_dwordx4 v[136:139], v6, s[4:7], s22 offen
    v_mfma_f32_16x16x32_bf16 a[212:215], v[72:75], v[156:159], a[212:215]
    s_add_u32 s25, s25, 57344
    v_mfma_f32_16x16x32_bf16 a[216:219], v[72:75], v[160:163], a[216:219]
    v_mfma_f32_16x16x32_bf16 a[220:223], v[72:75], v[164:167], a[220:223]
    ds_read_b128 v[72:75], v7 offset:37888
    v_mfma_f32_16x16x32_bf16 a[224:227], v[76:79], v[140:143], a[224:227]
    v_mfma_f32_16x16x32_bf16 a[228:231], v[76:79], v[144:147], a[228:231]
    v_mfma_f32_16x16x32_bf16 a[232:235], v[76:79], v[148:151], a[232:235]
    v_mfma_f32_16x16x32_bf16 a[236:239], v[76:79], v[152:155], a[236:239]
    v_mfma_f32_16x16x32_bf16 a[240:243], v[76:79], v[156:159], a[240:243]
    v_mfma_f32_16x16x32_bf16 a[244:247], v[76:79], v[160:163], a[244:247]
    v_mfma_f32_16x16x32_bf16 a[248:251], v[76:79], v[164:167], a[248:251]
    ds_read_b128 v[76:79], v7 offset:38912
    v_mfma_f32_16x16x32_bf16 a[252:255], v[80:83], v[140:143], a[252:255]
    v_mfma_f32_16x16x32_bf16 v[20:23], v[80:83], v[144:147], v[20:23]
    v_mfma_f32_16x16x32_bf16 v[24:27], v[80:83], v[148:151], v[24:27]
    v_mfma_f32_16x16x32_bf16 v[28:31], v[80:83], v[152:155], v[28:31]
    v_mfma_f32_16x16x32_bf16 v[32:35], v[80:83], v[156:159], v[32:35]
    v_mfma_f32_16x16x32_bf16 v[36:39], v[80:83], v[160:163], v[36:39]
    v_mfma_f32_16x16x32_bf16 v[40:43], v[80:83], v[164:167], v[40:43]
    ds_read_b128 v[80:83], v7 offset:39936
    s_waitcnt vmcnt(24) lgkmcnt(7)
    v_mfma_f32_16x16x32_bf16 a[0:3], v[44:47], v[168:171], a[0:3]
    v_mfma_f32_16x16x32_bf16 a[4:7], v[44:47], v[172:175], a[4:7]
    v_mfma_f32_16x16x32_bf16 a[8:11], v[44:47], v[176:179], a[8:11]
    v_mfma_f32_16x16x32_bf16 a[12:15], v[44:47], v[180:183], a[12:15]
    v_mfma_f32_16x16x32_bf16 a[16:19], v[44:47], v[184:187], a[16:19]
    v_mfma_f32_16x16x32_bf16 a[20:23], v[44:47], v[188:191], a[20:23]
    v_mfma_f32_16x16x32_bf16 a[24:27], v[44:47], v[192:195], a[24:27]
    ds_read_b128 v[44:47], v7 offset:0
    v_mfma_f32_16x16x32_bf16 a[28:31], v[48:51], v[168:171], a[28:31]
    v_mfma_f32_16x16x32_bf16 a[32:35], v[48:51], v[172:175], a[32:35]
    v_mfma_f32_16x16x32_bf16 a[36:39], v[48:51], v[176:179], a[36:39]
    v_mfma_f32_16x16x32_bf16 a[40:43], v[48:51], v[180:183], a[40:43]
    v_mfma_f32_16x16x32_bf16 a[44:47], v[48:51], v[184:187], a[44:47]
    v_mfma_f32_16x16x32_bf16 a[48:51], v[48:51], v[188:191], a[48:51]
    v_mfma_f32_16x16x32_bf16 a[52:55], v[48:51], v[192:195], a[52:55]
    ds_read_b128 v[48:51], v7 offset:1024
    s_waitcnt lgkmcnt(2)
    v_mfma_f32_16x16x32_bf16 a[56:59], v[52:55], v[168:171], a[56:59]
    s_add_u32 m0, s27, 20480
    v_mfma_f32_16x16x32_bf16 a[60:63], v[52:55], v[172:175], a[60:63]
    s_mov_b32 s23, s26
    v_mfma_f32_16x16x32_bf16 a[64:67], v[52:55], v[176:179], a[64:67]
    buffer_load_dwordx4 v6, s[8:11], s23 offen offset:0 lds
    v_mfma_f32_16x16x32_bf16 a[68:71], v[52:55], v[180:183], a[68:71]
    buffer_load_dwordx4 v6, s[8:11], s23 offen offset:1024 lds
    v_mfma_f32_16x16x32_bf16 a[72:75], v[52:55], v[184:187], a[72:75]
    buffer_load_dwordx4 v6, s[8:11], s23 offen offset:2048 lds
    v_mfma_f32_16x16x32_bf16 a[76:79], v[52:55], v[188:191], a[76:79]
    buffer_load_dwordx4 v6, s[8:11], s23 offen offset:3072 lds
    v_mfma_f32_16x16x32_bf16 a[80:83], v[52:55], v[192:195], a[80:83]
    ds_read_b128 v[52:55], v7 offset:2048
    v_mfma_f32_16x16x32_bf16 a[84:87], v[56:59], v[168:171], a[84:87]
    s_add_u32 m0, s27, 24576
    v_mfma_f32_16x16x32_bf16 a[88:91], v[56:59], v[172:175], a[88:91]
    s_add_u32 s23, s23, 4096
    v_mfma_f32_16x16x32_bf16 a[92:95], v[56:59], v[176:179], a[92:95]
    buffer_load_dwordx4 v6, s[8:11], s23 offen offset:0 lds
    v_mfma_f32_16x16x32_bf16 a[96:99], v[56:59], v[180:183], a[96:99]
    buffer_load_dwordx4 v6, s[8:11], s23 offen offset:1024 lds
    v_mfma_f32_16x16x32_bf16 a[100:103], v[56:59], v[184:187], a[100:103]
    buffer_load_dwordx4 v6, s[8:11], s23 offen offset:2048 lds
    v_mfma_f32_16x16x32_bf16 a[104:107], v[56:59], v[188:191], a[104:107]
    buffer_load_dwordx4 v6, s[8:11], s23 offen offset:3072 lds
    v_mfma_f32_16x16x32_bf16 a[108:111], v[56:59], v[192:195], a[108:111]
    ds_read_b128 v[56:59], v7 offset:3072
    v_mfma_f32_16x16x32_bf16 a[112:115], v[60:63], v[168:171], a[112:115]
    s_add_u32 m0, s27, 28672
    v_mfma_f32_16x16x32_bf16 a[116:119], v[60:63], v[172:175], a[116:119]
    s_add_u32 s23, s23, 4096
    v_mfma_f32_16x16x32_bf16 a[120:123], v[60:63], v[176:179], a[120:123]
    buffer_load_dwordx4 v6, s[8:11], s23 offen offset:0 lds
    v_mfma_f32_16x16x32_bf16 a[124:127], v[60:63], v[180:183], a[124:127]
    buffer_load_dwordx4 v6, s[8:11], s23 offen offset:1024 lds
    v_mfma_f32_16x16x32_bf16 a[128:131], v[60:63], v[184:187], a[128:131]
    s_add_u32 s26, s26, 163840
    v_mfma_f32_16x16x32_bf16 a[132:135], v[60:63], v[188:191], a[132:135]
    s_mov_b32 s22, s25
    v_mfma_f32_16x16x32_bf16 a[136:139], v[60:63], v[192:195], a[136:139]
    ds_read_b128 v[60:63], v7 offset:4096
    v_mfma_f32_16x16x32_bf16 a[140:143], v[64:67], v[168:171], a[140:143]
    buffer_load_dwordx4 v[140:143], v6, s[4:7], s22 offen
    v_mfma_f32_16x16x32_bf16 a[144:147], v[64:67], v[172:175], a[144:147]
    s_add_u32 s22, s22, 4096
    v_mfma_f32_16x16x32_bf16 a[148:151], v[64:67], v[176:179], a[148:151]
    buffer_load_dwordx4 v[144:147], v6, s[4:7], s22 offen
    v_mfma_f32_16x16x32_bf16 a[152:155], v[64:67], v[180:183], a[152:155]
    s_add_u32 s22, s22, 4096
    v_mfma_f32_16x16x32_bf16 a[156:159], v[64:67], v[184:187], a[156:159]
    buffer_load_dwordx4 v[148:151], v6, s[4:7], s22 offen
    v_mfma_f32_16x16x32_bf16 a[160:163], v[64:67], v[188:191], a[160:163]
    s_add_u32 s22, s22, 4096
    v_mfma_f32_16x16x32_bf16 a[164:167], v[64:67], v[192:195], a[164:167]
    ds_read_b128 v[64:67], v7 offset:5120
    v_mfma_f32_16x16x32_bf16 a[168:171], v[68:71], v[168:171], a[168:171]
    buffer_load_dwordx4 v[152:155], v6, s[4:7], s22 offen
    v_mfma_f32_16x16x32_bf16 a[172:175], v[68:71], v[172:175], a[172:175]
    s_add_u32 s22, s22, 4096
    v_mfma_f32_16x16x32_bf16 a[176:179], v[68:71], v[176:179], a[176:179]
    buffer_load_dwordx4 v[156:159], v6, s[4:7], s22 offen
    v_mfma_f32_16x16x32_bf16 a[180:183], v[68:71], v[180:183], a[180:183]
    s_add_u32 s22, s22, 4096
    v_mfma_f32_16x16x32_bf16 a[184:187], v[68:71], v[184:187], a[184:187]
    buffer_load_dwordx4 v[160:163], v6, s[4:7], s22 offen
    v_mfma_f32_16x16x32_bf16 a[188:191], v[68:71], v[188:191], a[188:191]
    s_add_u32 s22, s22, 4096
    v_mfma_f32_16x16x32_bf16 a[192:195], v[68:71], v[192:195], a[192:195]
    ds_read_b128 v[68:71], v7 offset:6144
    v_mfma_f32_16x16x32_bf16 a[196:199], v[72:75], v[168:171], a[196:199]
    buffer_load_dwordx4 v[164:167], v6, s[4:7], s22 offen
    v_mfma_f32_16x16x32_bf16 a[200:203], v[72:75], v[172:175], a[200:203]
    s_add_u32 s25, s25, 57344
    v_mfma_f32_16x16x32_bf16 a[204:207], v[72:75], v[176:179], a[204:207]
    s_add_u32 m0, s27, 30720
    v_mfma_f32_16x16x32_bf16 a[208:211], v[72:75], v[180:183], a[208:211]
    s_mov_b32 s23, s26
    v_mfma_f32_16x16x32_bf16 a[212:215], v[72:75], v[184:187], a[212:215]
    buffer_load_dwordx4 v6, s[8:11], s23 offen offset:0 lds
    v_mfma_f32_16x16x32_bf16 a[216:219], v[72:75], v[188:191], a[216:219]
    buffer_load_dwordx4 v6, s[8:11], s23 offen offset:1024 lds
    v_mfma_f32_16x16x32_bf16 a[220:223], v[72:75], v[192:195], a[220:223]
    ds_read_b128 v[72:75], v7 offset:7168
    v_mfma_f32_16x16x32_bf16 a[224:227], v[76:79], v[168:171], a[224:227]
    buffer_load_dwordx4 v6, s[8:11], s23 offen offset:2048 lds
    v_mfma_f32_16x16x32_bf16 a[228:231], v[76:79], v[172:175], a[228:231]
    buffer_load_dwordx4 v6, s[8:11], s23 offen offset:3072 lds
    v_mfma_f32_16x16x32_bf16 a[232:235], v[76:79], v[176:179], a[232:235]
    s_add_u32 m0, s27, 34816
    v_mfma_f32_16x16x32_bf16 a[236:239], v[76:79], v[180:183], a[236:239]
    s_add_u32 s23, s23, 4096
    v_mfma_f32_16x16x32_bf16 a[240:243], v[76:79], v[184:187], a[240:243]
    buffer_load_dwordx4 v6, s[8:11], s23 offen offset:0 lds
    v_mfma_f32_16x16x32_bf16 a[244:247], v[76:79], v[188:191], a[244:247]
    buffer_load_dwordx4 v6, s[8:11], s23 offen offset:1024 lds
    v_mfma_f32_16x16x32_bf16 a[248:251], v[76:79], v[192:195], a[248:251]
    ds_read_b128 v[76:79], v7 offset:8192
    v_mfma_f32_16x16x32_bf16 a[252:255], v[80:83], v[168:171], a[252:255]
    buffer_load_dwordx4 v6, s[8:11], s23 offen offset:2048 lds
    v_mfma_f32_16x16x32_bf16 v[20:23], v[80:83], v[172:175], v[20:23]
    buffer_load_dwordx4 v6, s[8:11], s23 offen offset:3072 lds
    v_mfma_f32_16x16x32_bf16 v[24:27], v[80:83], v[176:179], v[24:27]
    s_add_u32 m0, s27, 38912
    v_mfma_f32_16x16x32_bf16 v[28:31], v[80:83], v[180:183], v[28:31]
    s_add_u32 s23, s23, 4096
    v_mfma_f32_16x16x32_bf16 v[32:35], v[80:83], v[184:187], v[32:35]
    buffer_load_dwordx4 v6, s[8:11], s23 offen offset:0 lds
    v_mfma_f32_16x16x32_bf16 v[36:39], v[80:83], v[188:191], v[36:39]
    buffer_load_dwordx4 v6, s[8:11], s23 offen offset:1024 lds
    v_mfma_f32_16x16x32_bf16 v[40:43], v[80:83], v[192:195], v[40:43]
    ds_read_b128 v[80:83], v7 offset:9216
    s_add_u32 s26, s26, 163840
    s_mov_b32 s21, 0
L_op_loop:
    s_waitcnt vmcnt(34) lgkmcnt(7)
    v_mfma_f32_16x16x32_bf16 a[0:3], v[44:47], v[84:87], a[0:3]
    s_mov_b32 s22, s25
    v_mfma_f32_16x16x32_bf16 a[4:7], v[44:47], v[88:91], a[4:7]
    buffer_load_dwordx4 v[168:171], v6, s[4:7], s22 offen
    v_mfma_f32_16x16x32_bf16 a[8:11], v[44:47], v[92:95], a[8:11]
    s_add_u32 s22, s22, 4096
    v_mfma_f32_16x16x32_bf16 a[12:15], v[44:47], v[96:99], a[12:15]
    buffer_load_dwordx4 v[172:175], v6, s[4:7], s22 offen
    v_mfma_f32_16x16x32_bf16 a[16:19], v[44:47], v[100:103], a[16:19]
    s_add_u32 s22, s22, 4096
    v_mfma_f32_16x16x32_bf16 a[20:23], v[44:47], v[104:107], a[20:23]
    buffer_load_dwordx4 v[176:179], v6, s[4:7], s22 offen
    v_mfma_f32_16x16x32_bf16 a[24:27], v[44:47], v[108:111], a[24:27]
    ds_read_b128 v[44:47], v7 offset:10240
    v_mfma_f32_16x16x32_bf16 a[28:31], v[48:51], v[84:87], a[28:31]
    s_add_u32 s22, s22, 4096
    v_mfma_f32_16x16x32_bf16 a[32:35], v[48:51], v[88:91], a[32:35]
    buffer_load_dwordx4 v[180:183], v6, s[4:7], s22 offen
    v_mfma_f32_16x16x32_bf16 a[36:39], v[48:51], v[92:95], a[36:39]
    s_add_u32 s22, s22, 4096
    v_mfma_f32_16x16x32_bf16 a[40:43], v[48:51], v[96:99], a[40:43]
    buffer_load_dwordx4 v[184:187], v6, s[4:7], s22 offen
    v_mfma_f32_16x16x32_bf16 a[44:47], v[48:51], v[100:103], a[44:47]
    s_add_u32 s22, s22, 4096
    v_mfma_f32_16x16x32_bf16 a[48:51], v[48:51], v[104:107], a[48:51]
    buffer_load_dwordx4 v[188:191], v6, s[4:7], s22 offen
    v_mfma_f32_16x16x32_bf16 a[52:55], v[48:51], v[108:111], a[52:55]
    ds_read_b128 v[48:51], v7 offset:11264
    s_waitcnt lgkmcnt(2)
    v_mfma_f32_16x16x32_bf16 a[56:59], v[52:55], v[84:87], a[56:59]
    s_add_u32 s22, s22, 4096
    v_mfma_f32_16x16x32_bf16 a[60:63], v[52:55], v[88:91], a[60:63]
    buffer_load_dwordx4 v[192:195], v6, s[4:7], s22 offen
    v_mfma_f32_16x16x32_bf16 a[64:67], v[52:55], v[92:95], a[64:67]
    s_add_u32 s25, s25, 57344
    v_mfma_f32_16x16x32_bf16 a[68:71], v[52:55], v[96:99], a[68:71]
    s_add_u32 m0, s27, 0
    v_mfma_f32_16x16x32_bf16 a[72:75], v[52:55], v[100:103], a[72:75]
    s_mov_b32 s23, s26
    v_mfma_f32_16x16x32_bf16 a[76:79], v[52:55], v[104:107], a[76:79]
    buffer_load_dwordx4 v6, s[8:11], s23 offen offset:0 lds
    v_mfma_f32_16x16x32_bf16 a[80:83], v[52:55], v[108:111], a[80:83]
    ds_read_b128 v[52:55], v7 offset:12288
    v_mfma_f32_16x16x32_bf16 a[84:87], v[56:59], v[84:87], a[84:87]
    buffer_load_dwordx4 v6, s[8:11], s23 offen offset:1024 lds
    v_mfma_f32_16x16x32_bf16 a[88:91], v[56:59], v[88:91], a[88:91]
    buffer_load_dwordx4 v6, s[8:11], s23 offen offset:2048 lds
    v_mfma_f32_16x16x32_bf16 a[92:95], v[56:59], v[92:95], a[92:95]
    buffer_load_dwordx4 v6, s[8:11], s23 offen offset:3072 lds
    v_mfma_f32_16x16x32_bf16 a[96:99], v[56:59], v[96:99], a[96:99]
    s_add_u32 m0, s27, 4096
    v_mfma_f32_16x16x32_bf16 a[100:103], v[56:59], v[100:103], a[100:103]
    s_add_u32 s23, s23, 4096
    v_mfma_f32_16x16x32_bf16 a[104:107], v[56:59], v[104:107], a[104:107]
    buffer_load_dwordx4 v6, s[8:11], s23 offen offset:0 lds
    v_mfma_f32_16x16x32_bf16 a[108:111], v[56:59], v[108:111], a[108:111]
    ds_read_b128 v[56:59], v7 offset:13312
    v_mfma_f32_16x16x32_bf16 a[112:115], v[60:63], v[84:87], a[112:115]
    buffer_load_dwordx4 v6, s[8:11], s23 offen offset:1024 lds
    v_mfma_f32_16x16x32_bf16 a[116:119], v[60:63], v[88:91], a[116:119]
    buffer_load_dwordx4 v6, s[8:11], s23 offen offset:2048 lds
    v_mfma_f32_16x16x32_bf16 a[120:123], v[60:63], v[92:95], a[120:123]
    buffer_load_dwordx4 v6, s[8:11], s23 offen offset:3072 lds
    v_mfma_f32_16x16x32_bf16 a[124:127], v[60:63], v[96:99], a[124:127]
    s_add_u32 m0, s27, 8192
    v_mfma_f32_16x16x32_bf16 a[128:131], v[60:63], v[100:103], a[128:131]
    s_add_u32 s23, s23, 4096
    v_mfma_f32_16x16x32_bf16 a[132:135], v[60:63], v[104:107], a[132:135]
    buffer_load_dwordx4 v6, s[8:11], s23 offen offset:0 lds
    v_mfma_f32_16x16x32_bf16 a[136:139], v[60:63], v[108:111], a[136:139]
    ds_read_b128 v[60:63], v7 offset:14336
    v_mfma_f32_16x16x32_bf16 a[140:143], v[64:67], v[84:87], a[140:143]
    buffer_load_dwordx4 v6, s[8:11], s23 offen offset:1024 lds
    v_mfma_f32_16x16x32_bf16 a[144:147], v[64:67], v[88:91], a[144:147]
    s_add_u32 s26, s26, 163840
    v_mfma_f32_16x16x32_bf16 a[148:151], v[64:67], v[92:95], a[148:151]
    v_mfma_f32_16x16x32_bf16 a[152:155], v[64:67], v[96:99], a[152:155]
    v_mfma_f32_16x16x32_bf16 a[156:159], v[64:67], v[100:103], a[156:159]
    v_mfma_f32_16x16x32_bf16 a[160:163], v[64:67], v[104:107], a[160:163]
    v_mfma_f32_16x16x32_bf16 a[164:167], v[64:67], v[108:111], a[164:167]
    ds_read_b128 v[64:67], v7 offset:15360
    v_mfma_f32_16x16x32_bf16 a[168:171], v[68:71], v[84:87], a[168:171]
    v_mfma_f32_16x16x32_bf16 a[172:175], v[68:71], v[88:91], a[172:175]
    v_mfma_f32_16x16x32_bf16 a[176:179], v[68:71], v[92:95], a[176:179]
    v_mfma_f32_16x16x32_bf16 a[180:183], v[68:71], v[96:99], a[180:183]
    v_mfma_f32_16x16x32_bf16 a[184:187], v[68:71], v[100:103], a[184:187]
    v_mfma_f32_16x16x32_bf16 a[188:191], v[68:71], v[104:107], a[188:191]
    v_mfma_f32_16x16x32_bf16 a[192:195], v[68:71], v[108:111], a[192:195]
    ds_read_b128 v[68:71], v7 offset:16384
    v_mfma_f32_16x16x32_bf16 a[196:199], v[72:75], v[84:87], a[196:199]
    v_mfma_f32_16x16x32_bf16 a[200:203], v[72:75], v[88:91], a[200:203]
    v_mfma_f32_16x16x32_bf16 a[204:207], v[72:75], v[92:95], a[204:207]
    v_mfma_f32_16x16x32_bf16 a[208:211], v[72:75], v[96:99], a[208:211]
    v_mfma_f32_16x16x32_bf16 a[212:215], v[72:75], v[100:103], a[212:215]
    v_mfma_f32_16x16x32_bf16 a[216:219], v[72:75], v[104:107], a[216:219]
    v_mfma_f32_16x16x32_bf16 a[220:223], v[72:75], v[108:111], a[220:223]
    ds_read_b128 v[72:75], v7 offset:17408
    v_mfma_f32_16x16x32_bf16 a[224:227], v[76:79], v[84:87], a[224:227]
    v_mfma_f32_16x16x32_bf16 a[228:231], v[76:79], v[88:91], a[228:231]
    v_mfma_f32_16x16x32_bf16 a[232:235], v[76:79], v[92:95], a[232:235]
    v_mfma_f32_16x16x32_bf16 a[236:239], v[76:79], v[96:99], a[236:239]
    v_mfma_f32_16x16x32_bf16 a[240:243], v[76:79], v[100:103], a[240:243]
    v_mfma_f32_16x16x32_bf16 a[244:247], v[76:79], v[104:107], a[244:247]
    v_mfma_f32_16x16x32_bf16 a[248:251], v[76:79], v[108:111], a[248:251]
    ds_read_b128 v[76:79], v7 offset:18432
    v_mfma_f32_16x16x32_bf16 a[252:255], v[80:83], v[84:87], a[252:255]
    v_mfma_f32_16x16x32_bf16 v[20:23], v[80:83], v[88:91], v[20:23]
    v_mfma_f32_16x16x32_bf16 v[24:27], v[80:83], v[92:95], v[24:27]
    v_mfma_f32_16x16x32_bf16 v[28:31], v[80:83], v[96:99], v[28:31]
    v_mfma_f32_16x16x32_bf16 v[32:35], v[80:83], v[100:103], v[32:35]
    v_mfma_f32_16x16x32_bf16 v[36:39], v[80:83], v[104:107], v[36:39]
    v_mfma_f32_16x16x32_bf16 v[40:43], v[80:83], v[108:111], v[40:43]
    ds_read_b128 v[80:83], v7 offset:19456
    s_waitcnt vmcnt(34) lgkmcnt(7)
    v_mfma_f32_16x16x32_bf16 a[0:3], v[44:47], v[112:115], a[0:3]
    s_mov_b32 s22, s25
    v_mfma_f32_16x16x32_bf16 a[4:7], v[44:47], v[116:119], a[4:7]
    buffer_load_dwordx4 v[84:87], v6, s[4:7], s22 offen
    v_mfma_f32_16x16x32_bf16 a[8:11], v[44:47], v[120:123], a[8:11]
    s_add_u32 s22, s22, 4096
    v_mfma_f32_16x16x32_bf16 a[12:15], v[44:47], v[124:127], a[12:15]
    buffer_load_dwordx4 v[88:91], v6, s[4:7], s22 offen
    v_mfma_f32_16x16x32_bf16 a[16:19], v[44:47], v[128:131], a[16:19]
    s_add_u32 s22, s22, 4096
    v_mfma_f32_16x16x32_bf16 a[20:23], v[44:47], v[132:135], a[20:23]
    buffer_load_dwordx4 v[92:95], v6, s[4:7], s22 offen
    v_mfma_f32_16x16x32_bf16 a[24:27], v[44:47], v[136:139], a[24:27]
    ds_read_b128 v[44:47], v7 offset:20480
    v_mfma_f32_16x16x32_bf16 a[28:31], v[48:51], v[112:115], a[28:31]
    s_add_u32 s22, s22, 4096
    v_mfma_f32_16x16x32_bf16 a[32:35], v[48:51], v[116:119], a[32:35]
    buffer_load_dwordx4 v[96:99], v6, s[4:7], s22 offen
    v_mfma_f32_16x16x32_bf16 a[36:39], v[48:51], v[120:123], a[36:39]
    s_add_u32 s22, s22, 4096
    v_mfma_f32_16x16x32_bf16 a[40:43], v[48:51], v[124:127], a[40:43]
    buffer_load_dwordx4 v[100:103], v6, s[4:7], s22 offen
    v_mfma_f32_16x16x32_bf16 a[44:47], v[48:51], v[128:131], a[44:47]
    s_add_u32 s22, s22, 4096
    v_mfma_f32_16x16x32_bf16 a[48:51], v[48:51], v[132:135], a[48:51]
    buffer_load_dwordx4 v[104:107], v6, s[4:7], s22 offen
    v_mfma_f32_16x16x32_bf16 a[52:55], v[48:51], v[136:139], a[52:55]
    ds_read_b128 v[48:51], v7 offset:21504
    s_waitcnt lgkmcnt(2)
    v_mfma_f32_16x16x32_bf16 a[56:59], v[52:55], v[112:115], a[56:59]
    s_add_u32 s22, s22, 4096
    v_mfma_f32_16x16x32_bf16 a[60:63], v[52:55], v[116:119], a[60:63]
    buffer_load_dwordx4 v[108:111], v6, s[4:7], s22 offen
    v_mfma_f32_16x16x32_bf16 a[64:67], v[52:55], v[120:123], a[64:67]
    s_add_u32 s25, s25, 57344
    v_mfma_f32_16x16x32_bf16 a[68:71], v[52:55], v[124:127], a[68:71]
    s_add_u32 m0, s27, 10240
    v_mfma_f32_16x16x32_bf16 a[72:75], v[52:55], v[128:131], a[72:75]
    s_mov_b32 s23, s26
    v_mfma_f32_16x16x32_bf16 a[76:79], v[52:55], v[132:135], a[76:79]
    buffer_load_dwordx4 v6, s[8:11], s23 offen offset:0 lds
    v_mfma_f32_16x16x32_bf16 a[80:83], v[52:55], v[136:139], a[80:83]
    ds_read_b128 v[52:55], v7 offset:22528
    v_mfma_f32_16x16x32_bf16 a[84:87], v[56:59], v[112:115], a[84:87]
    buffer_load_dwordx4 v6, s[8:11], s23 offen offset:1024 lds
    v_mfma_f32_16x16x32_bf16 a[88:91], v[56:59], v[116:119], a[88:91]
    buffer_load_dwordx4 v6, s[8:11], s23 offen offset:2048 lds
    v_mfma_f32_16x16x32_bf16 a[92:95], v[56:59], v[120:123], a[92:95]
    buffer_load_dwordx4 v6, s[8:11], s23 offen offset:3072 lds
    v_mfma_f32_16x16x32_bf16 a[96:99], v[56:59], v[124:127], a[96:99]
    s_add_u32 m0, s27, 14336
    v_mfma_f32_16x16x32_bf16 a[100:103], v[56:59], v[128:131], a[100:103]
    s_add_u32 s23, s23, 4096
    v_mfma_f32_16x16x32_bf16 a[104:107], v[56:59], v[132:135], a[104:107]
    buffer_load_dwordx4 v6, s[8:11], s23 offen offset:0 lds
    v_mfma_f32_16x16x32_bf16 a[108:111], v[56:59], v[136:139], a[108:111]
    ds_read_b128 v[56:59], v7 offset:23552
    v_mfma_f32_16x16x32_bf16 a[112:115], v[60:63], v[112:115], a[112:115]
    buffer_load_dwordx4 v6, s[8:11], s23 offen offset:1024 lds
    v_mfma_f32_16x16x32_bf16 a[116:119], v[60:63], v[116:119], a[116:119]
    buffer_load_dwordx4 v6, s[8:11], s23 offen offset:2048 lds
    v_mfma_f32_16x16x32_bf16 a[120:123], v[60:63], v[120:123], a[120:123]
    buffer_load_dwordx4 v6, s[8:11], s23 offen offset:3072 lds
    v_mfma_f32_16x16x32_bf16 a[124:127], v[60:63], v[124:127], a[124:127]
    s_add_u32 m0, s27, 18432
    v_mfma_f32_16x16x32_bf16 a[128:131], v[60:63], v[128:131], a[128:131]
    s_add_u32 s23, s23, 4096
    v_mfma_f32_16x16x32_bf16 a[132:135], v[60:63], v[132:135], a[132:135]
    buffer_load_dwordx4 v6, s[8:11], s23 offen offset:0 lds
    v_mfma_f32_16x16x32_bf16 a[136:139], v[60:63], v[136:139], a[136:139]
    ds_read_b128 v[60:63], v7 offset:24576
    v_mfma_f32_16x16x32_bf16 a[140:143], v[64:67], v[112:115], a[140:143]
    buffer_load_dwordx4 v6, s[8:11], s23 offen offset:1024 lds
    v_mfma_f32_16x16x32_bf16 a[144:147], v[64:67], v[116:119], a[144:147]
    s_add_u32 s26, s26, 163840
    v_mfma_f32_16x16x32_bf16 a[148:151], v[64:67], v[120:123], a[148:151]
    v_mfma_f32_16x16x32_bf16 a[152:155], v[64:67], v[124:127], a[152:155]
    v_mfma_f32_16x16x32_bf16 a[156:159], v[64:67], v[128:131], a[156:159]
    v_mfma_f32_16x16x32_bf16 a[160:163], v[64:67], v[132:135], a[160:163]
    v_mfma_f32_16x16x32_bf16 a[164:167], v[64:67], v[136:139], a[164:167]
    ds_read_b128 v[64:67], v7 offset:25600
    v_mfma_f32_16x16x32_bf16 a[168:171], v[68:71], v[112:115], a[168:171]
    v_mfma_f32_16x16x32_bf16 a[172:175], v[68:71], v[116:119], a[172:175]
    v_mfma_f32_16x16x32_bf16 a[176:179], v[68:71], v[120:123], a[176:179]
    v_mfma_f32_16x16x32_bf16 a[180:183], v[68:71], v[124:127], a[180:183]
    v_mfma_f32_16x16x32_bf16 a[184:187], v[68:71], v[128:131], a[184:187]
    v_mfma_f32_16x16x32_bf16 a[188:191], v[68:71], v[132:135], a[188:191]
    v_mfma_f32_16x16x32_bf16 a[192:195], v[68:71], v[136:139], a[192:195]
    ds_read_b128 v[68:71], v7 offset:26624
    v_mfma_f32_16x16x32_bf16 a[196:199], v[72:75], v[112:115], a[196:199]
    v_mfma_f32_16x16x32_bf16 a[200:203], v[72:75], v[116:119], a[200:203]
    v_mfma_f32_16x16x32_bf16 a[204:207], v[72:75], v[120:123], a[204:207]
    v_mfma_f32_16x16x32_bf16 a[208:211], v[72:75], v[124:127], a[208:211]
    v_mfma_f32_16x16x32_bf16 a[212:215], v[72:75], v[128:131], a[212:215]
    v_mfma_f32_16x16x32_bf16 a[216:219], v[72:75], v[132:135], a[216:219]
    v_mfma_f32_16x16x32_bf16 a[220:223], v[72:75], v[136:139], a[220:223]
    ds_read_b128 v[72:75], v7 offset:27648
    v_mfma_f32_16x16x32_bf16 a[224:227], v[76:79], v[112:115], a[224:227]
    v_mfma_f32_16x16x32_bf16 a[228:231], v[76:79], v[116:119], a[228:231]
    v_mfma_f32_16x16x32_bf16 a[232:235], v[76:79], v[120:123], a[232:235]
    v_mfma_f32_16x16x32_bf16 a[236:239], v[76:79], v[124:127], a[236:239]
    v_mfma_f32_16x16x32_bf16 a[240:243], v[76:79], v[128:131], a[240:243]
    v_mfma_f32_16x16x32_bf16 a[244:247], v[76:79], v[132:135], a[244:247]
    v_mfma_f32_16x16x32_bf16 a[248:251], v[76:79], v[136:139], a[248:251]
    ds_read_b128 v[76:79], v7 offset:28672
    v_mfma_f32_16x16x32_bf16 a[252:255], v[80:83], v[112:115], a[252:255]
    v_mfma_f32_16x16x32_bf16 v[20:23], v[80:83], v[116:119], v[20:23]
    v_mfma_f32_16x16x32_bf16 v[24:27], v[80:83], v[120:123], v[24:27]
    v_mfma_f32_16x16x32_bf16 v[28:31], v[80:83], v[124:127], v[28:31]
    v_mfma_f32_16x16x32_bf16 v[32:35], v[80:83], v[128:131], v[32:35]
    v_mfma_f32_16x16x32_bf16 v[36:39], v[80:83], v[132:135], v[36:39]
    v_mfma_f32_16x16x32_bf16 v[40:43], v[80:83], v[136:139], v[40:43]
    ds_read_b128 v[80:83], v7 offset:29696
    s_waitcnt vmcnt(34) lgkmcnt(7)
    v_mfma_f32_16x16x32_bf16 a[0:3], v[44:47], v[140:143], a[0:3]
    s_mov_b32 s22, s25
    v_mfma_f32_16x16x32_bf16 a[4:7], v[44:47], v[144:147], a[4:7]
    buffer_load_dwordx4 v[112:115], v6, s[4:7], s22 offen
    v_mfma_f32_16x16x32_bf16 a[8:11], v[44:47], v[148:151], a[8:11]
    s_add_u32 s22, s22, 4096
    v_mfma_f32_16x16x32_bf16 a[12:15], v[44:47], v[152:155], a[12:15]
    buffer_load_dwordx4 v[116:119], v6, s[4:7], s22 offen
    v_mfma_f32_16x16x32_bf16 a[16:19], v[44:47], v[156:159], a[16:19]
    s_add_u32 s22, s22, 4096
    v_mfma_f32_16x16x32_bf16 a[20:23], v[44:47], v[160:163], a[20:23]
    buffer_load_dwordx4 v[120:123], v6, s[4:7], s22 offen
    v_mfma_f32_16x16x32_bf16 a[24:27], v[44:47], v[164:167], a[24:27]
    ds_read_b128 v[44:47], v7 offset:30720
    v_mfma_f32_16x16x32_bf16 a[28:31], v[48:51], v[140:143], a[28:31]
    s_add_u32 s22, s22, 4096
    v_mfma_f32_16x16x32_bf16 a[32:35], v[48:51], v[144:147], a[32:35]
    buffer_load_dwordx4 v[124:127], v6, s[4:7], s22 offen
    v_mfma_f32_16x16x32_bf16 a[36:39], v[48:51], v[148:151], a[36:39]
    s_add_u32 s22, s22, 4096
    v_mfma_f32_16x16x32_bf16 a[40:43], v[48:51], v[152:155], a[40:43]
    buffer_load_dwordx4 v[128:131], v6, s[4:7], s22 offen
    v_mfma_f32_16x16x32_bf16 a[44:47], v[48:51], v[156:159], a[44:47]
    s_add_u32 s22, s22, 4096
    v_mfma_f32_16x16x32_bf16 a[48:51], v[48:51], v[160:163], a[48:51]
    buffer_load_dwordx4 v[132:135], v6, s[4:7], s22 offen
    v_mfma_f32_16x16x32_bf16 a[52:55], v[48:51], v[164:167], a[52:55]
    ds_read_b128 v[48:51], v7 offset:31744
    s_waitcnt lgkmcnt(2)
    v_mfma_f32_16x16x32_bf16 a[56:59], v[52:55], v[140:143], a[56:59]
    s_add_u32 s22, s22, 4096
    v_mfma_f32_16x16x32_bf16 a[60:63], v[52:55], v[144:147], a[60:63]
    buffer_load_dwordx4 v[136:139], v6, s[4:7], s22 offen
    v_mfma_f32_16x16x32_bf16 a[64:67], v[52:55], v[148:151], a[64:67]
    s_add_u32 s25, s25, 57344
    v_mfma_f32_16x16x32_bf16 a[68:71], v[52:55], v[152:155], a[68:71]
    s_add_u32 m0, s27, 20480
    v_mfma_f32_16x16x32_bf16 a[72:75], v[52:55], v[156:159], a[72:75]
    s_mov_b32 s23, s26
    v_mfma_f32_16x16x32_bf16 a[76:79], v[52:55], v[160:163], a[76:79]
    buffer_load_dwordx4 v6, s[8:11], s23 offen offset:0 lds
    v_mfma_f32_16x16x32_bf16 a[80:83], v[52:55], v[164:167], a[80:83]
    ds_read_b128 v[52:55], v7 offset:32768
    v_mfma_f32_16x16x32_bf16 a[84:87], v[56:59], v[140:143], a[84:87]
    buffer_load_dwordx4 v6, s[8:11], s23 offen offset:1024 lds
    v_mfma_f32_16x16x32_bf16 a[88:91], v[56:59], v[144:147], a[88:91]
    buffer_load_dwordx4 v6, s[8:11], s23 offen offset:2048 lds
    v_mfma_f32_16x16x32_bf16 a[92:95], v[56:59], v[148:151], a[92:95]
    buffer_load_dwordx4 v6, s[8:11], s23 offen offset:3072 lds
    v_mfma_f32_16x16x32_bf16 a[96:99], v[56:59], v[152:155], a[96:99]
    s_add_u32 m0, s27, 24576
    v_mfma_f32_16x16x32_bf16 a[100:103], v[56:59], v[156:159], a[100:103]
    s_add_u32 s23, s23, 4096
    v_mfma_f32_16x16x32_bf16 a[104:107], v[56:59], v[160:163], a[104:107]
    buffer_load_dwordx4 v6, s[8:11], s23 offen offset:0 lds
    v_mfma_f32_16x16x32_bf16 a[108:111], v[56:59], v[164:167], a[108:111]
    ds_read_b128 v[56:59], v7 offset:33792
    v_mfma_f32_16x16x32_bf16 a[112:115], v[60:63], v[140:143], a[112:115]
    buffer_load_dwordx4 v6, s[8:11], s23 offen offset:1024 lds
    v_mfma_f32_16x16x32_bf16 a[116:119], v[60:63], v[144:147], a[116:119]
    buffer_load_dwordx4 v6, s[8:11], s23 offen offset:2048 lds
    v_mfma_f32_16x16x32_bf16 a[120:123], v[60:63], v[148:151], a[120:123]
    buffer_load_dwordx4 v6, s[8:11], s23 offen offset:3072 lds
    v_mfma_f32_16x16x32_bf16 a[124:127], v[60:63], v[152:155], a[124:127]
    s_add_u32 m0, s27, 28672
    v_mfma_f32_16x16x32_bf16 a[128:131], v[60:63], v[156:159], a[128:131]
    s_add_u32 s23, s23, 4096
    v_mfma_f32_16x16x32_bf16 a[132:135], v[60:63], v[160:163], a[132:135]
    buffer_load_dwordx4 v6, s[8:11], s23 offen offset:0 lds
    v_mfma_f32_16x16x32_bf16 a[136:139], v[60:63], v[164:167], a[136:139]
    ds_read_b128 v[60:63], v7 offset:34816
    v_mfma_f32_16x16x32_bf16 a[140:143], v[64:67], v[140:143], a[140:143]
    buffer_load_dwordx4 v6, s[8:11], s23 offen offset:1024 lds
    v_mfma_f32_16x16x32_bf16 a[144:147], v[64:67], v[144:147], a[144:147]
    s_add_u32 s26, s26, 163840
    v_mfma_f32_16x16x32_bf16 a[148:151], v[64:67], v[148:151], a[148:151]
    v_mfma_f32_16x16x32_bf16 a[152:155], v[64:67], v[152:155], a[152:155]
    v_mfma_f32_16x16x32_bf16 a[156:159], v[64:67], v[156:159], a[156:159]
    v_mfma_f32_16x16x32_bf16 a[160:163], v[64:67], v[160:163], a[160:163]
    v_mfma_f32_16x16x32_bf16 a[164:167], v[64:67], v[164:167], a[164:167]
    ds_read_b128 v[64:67], v7 offset:35840
    v_mfma_f32_16x16x32_bf16 a[168:171], v[68:71], v[140:143], a[168:171]
    v_mfma_f32_16x16x32_bf16 a[172:175], v[68:71], v[144:147], a[172:175]
    v_mfma_f32_16x16x32_bf16 a[176:179], v[68:71], v[148:151], a[176:179]
    v_mfma_f32_16x16x32_bf16 a[180:183], v[68:71], v[152:155], a[180:183]
    v_mfma_f32_16x16x32_bf16 a[184:187], v[68:71], v[156:159], a[184:187]
    v_mfma_f32_16x16x32_bf16 a[188:191], v[68:71], v[160:163], a[188:191]
    v_mfma_f32_16x16x32_bf16 a[192:195], v[68:71], v[164:167], a[192:195]
    ds_read_b128 v[68:71], v7 offset:36864
    v_mfma_f32_16x16x32_bf16 a[196:199], v[72:75], v[140:143], a[196:199]
    v_mfma_f32_16x16x32_bf16 a[200:203], v[72:75], v[144:147], a[200:203]
    v_mfma_f32_16x16x32_bf16 a[204:207], v[72:75], v[148:151], a[204:207]
    v_mfma_f32_16x16x32_bf16 a[208:211], v[72:75], v[152:155], a[208:211]
    v_mfma_f32_16x16x32_bf16 a[212:215], v[72:75], v[156:159], a[212:215]
    v_mfma_f32_16x16x32_bf16 a[216:219], v[72:75], v[160:163], a[216:219]
    v_mfma_f32_16x16x32_bf16 a[220:223], v[72:75], v[164:167], a[220:223]
    ds_read_b128 v[72:75], v7 offset:37888
    v_mfma_f32_16x16x32_bf16 a[224:227], v[76:79], v[140:143], a[224:227]
    v_mfma_f32_16x16x32_bf16 a[228:231], v[76:79], v[144:147], a[228:231]
    v_mfma_f32_16x16x32_bf16 a[232:235], v[76:79], v[148:151], a[232:235]
    v_mfma_f32_16x16x32_bf16 a[236:239], v[76:79], v[152:155], a[236:239]
    v_mfma_f32_16x16x32_bf16 a[240:243], v[76:79], v[156:159], a[240:243]
    v_mfma_f32_16x16x32_bf16 a[244:247], v[76:79], v[160:163], a[244:247]
    v_mfma_f32_16x16x32_bf16 a[248:251], v[76:79], v[164:167], a[248:251]
    ds_read_b128 v[76:79], v7 offset:38912
    v_mfma_f32_16x16x32_bf16 a[252:255], v[80:83], v[140:143], a[252:255]
    v_mfma_f32_16x16x32_bf16 v[20:23], v[80:83], v[144:147], v[20:23]
    v_mfma_f32_16x16x32_bf16 v[24:27], v[80:83], v[148:151], v[24:27]
    v_mfma_f32_16x16x32_bf16 v[28:31], v[80:83], v[152:155], v[28:31]
    v_mfma_f32_16x16x32_bf16 v[32:35], v[80:83], v[156:159], v[32:35]
    v_mfma_f32_16x16x32_bf16 v[36:39], v[80:83], v[160:163], v[36:39]
    v_mfma_f32_16x16x32_bf16 v[40:43], v[80:83], v[164:167], v[40:43]
    ds_read_b128 v[80:83], v7 offset:39936
    s_waitcnt vmcnt(34) lgkmcnt(7)
    v_mfma_f32_16x16x32_bf16 a[0:3], v[44:47], v[168:171], a[0:3]
    s_mov_b32 s22, s25
    v_mfma_f32_16x16x32_bf16 a[4:7], v[44:47], v[172:175], a[4:7]
    buffer_load_dwordx4 v[140:143], v6, s[4:7], s22 offen
    v_mfma_f32_16x16x32_bf16 a[8:11], v[44:47], v[176:179], a[8:11]
    s_add_u32 s22, s22, 4096
    v_mfma_f32_16x16x32_bf16 a[12:15], v[44:47], v[180:183], a[12:15]
    buffer_load_dwordx4 v[144:147], v6, s[4:7], s22 offen
    v_mfma_f32_16x16x32_bf16 a[16:19], v[44:47], v[184:187], a[16:19]
    s_add_u32 s22, s22, 4096
    v_mfma_f32_16x16x32_bf16 a[20:23], v[44:47], v[188:191], a[20:23]
    buffer_load_dwordx4 v[148:151], v6, s[4:7], s22 offen
    v_mfma_f32_16x16x32_bf16 a[24:27], v[44:47], v[192:195], a[24:27]
    ds_read_b128 v[44:47], v7 offset:0
    v_mfma_f32_16x16x32_bf16 a[28:31], v[48:51], v[168:171], a[28:31]
    s_add_u32 s22, s22, 4096
    v_mfma_f32_16x16x32_bf16 a[32:35], v[48:51], v[172:175], a[32:35]
    buffer_load_dwordx4 v[152:155], v6, s[4:7], s22 offen
    v_mfma_f32_16x16x32_bf16 a[36:39], v[48:51], v[176:179], a[36:39]
    s_add_u32 s22, s22, 4096
    v_mfma_f32_16x16x32_bf16 a[40:43], v[48:51], v[180:183], a[40:43]
    buffer_load_dwordx4 v[156:159], v6, s[4:7], s22 offen
    v_mfma_f32_16x16x32_bf16 a[44:47], v[48:51], v[184:187], a[44:47]
    s_add_u32 s22, s22, 4096
    v_mfma_f32_16x16x32_bf16 a[48:51], v[48:51], v[188:191], a[48:51]
    buffer_load_dwordx4 v[160:163], v6, s[4:7], s22 offen
    v_mfma_f32_16x16x32_bf16 a[52:55], v[48:51], v[192:195], a[52:55]
    ds_read_b128 v[48:51], v7 offset:1024
    s_waitcnt lgkmcnt(2)
    v_mfma_f32_16x16x32_bf16 a[56:59], v[52:55], v[168:171], a[56:59]
    s_add_u32 s22, s22, 4096
    v_mfma_f32_16x16x32_bf16 a[60:63], v[52:55], v[172:175], a[60:63]
    buffer_load_dwordx4 v[164:167], v6, s[4:7], s22 offen
    v_mfma_f32_16x16x32_bf16 a[64:67], v[52:55], v[176:179], a[64:67]
    s_add_u32 s25, s25, 57344
    v_mfma_f32_16x16x32_bf16 a[68:71], v[52:55], v[180:183], a[68:71]
    s_add_u32 m0, s27, 30720
    v_mfma_f32_16x16x32_bf16 a[72:75], v[52:55], v[184:187], a[72:75]
    s_mov_b32 s23, s26
    v_mfma_f32_16x16x32_bf16 a[76:79], v[52:55], v[188:191], a[76:79]
    buffer_load_dwordx4 v6, s[8:11], s23 offen offset:0 lds
    v_mfma_f32_16x16x32_bf16 a[80:83], v[52:55], v[192:195], a[80:83]
    ds_read_b128 v[52:55], v7 offset:2048
    v_mfma_f32_16x16x32_bf16 a[84:87], v[56:59], v[168:171], a[84:87]
    buffer_load_dwordx4 v6, s[8:11], s23 offen offset:1024 lds
    v_mfma_f32_16x16x32_bf16 a[88:91], v[56:59], v[172:175], a[88:91]
    buffer_load_dwordx4 v6, s[8:11], s23 offen offset:2048 lds
    v_mfma_f32_16x16x32_bf16 a[92:95], v[56:59], v[176:179], a[92:95]
    buffer_load_dwordx4 v6, s[8:11], s23 offen offset:3072 lds
    v_mfma_f32_16x16x32_bf16 a[96:99], v[56:59], v[180:183], a[96:99]
    s_add_u32 m0, s27, 34816
    v_mfma_f32_16x16x32_bf16 a[100:103], v[56:59], v[184:187], a[100:103]
    s_add_u32 s23, s23, 4096
    v_mfma_f32_16x16x32_bf16 a[104:107], v[56:59], v[188:191], a[104:107]
    buffer_load_dwordx4 v6, s[8:11], s23 offen offset:0 lds
    v_mfma_f32_16x16x32_bf16 a[108:111], v[56:59], v[192:195], a[108:111]
    ds_read_b128 v[56:59], v7 offset:3072
    v_mfma_f32_16x16x32_bf16 a[112:115], v[60:63], v[168:171], a[112:115]
    buffer_load_dwordx4 v6, s[8:11], s23 offen offset:1024 lds
    v_mfma_f32_16x16x32_bf16 a[116:119], v[60:63], v[172:175], a[116:119]
    buffer_load_dwordx4 v6, s[8:11], s23 offen offset:2048 lds
    v_mfma_f32_16x16x32_bf16 a[120:123], v[60:63], v[176:179], a[120:123]
    buffer_load_dwordx4 v6, s[8:11], s23 offen offset:3072 lds
    v_mfma_f32_16x16x32_bf16 a[124:127], v[60:63], v[180:183], a[124:127]
    s_add_u32 m0, s27, 38912
    v_mfma_f32_16x16x32_bf16 a[128:131], v[60:63], v[184:187], a[128:131]
    s_add_u32 s23, s23, 4096
    v_mfma_f32_16x16x32_bf16 a[132:135], v[60:63], v[188:191], a[132:135]
    buffer_load_dwordx4 v6, s[8:11], s23 offen offset:0 lds
    v_mfma_f32_16x16x32_bf16 a[136:139], v[60:63], v[192:195], a[136:139]
    ds_read_b128 v[60:63], v7 offset:4096
    v_mfma_f32_16x16x32_bf16 a[140:143], v[64:67], v[168:171], a[140:143]
    buffer_load_dwordx4 v6, s[8:11], s23 offen offset:1024 lds
    v_mfma_f32_16x16x32_bf16 a[144:147], v[64:67], v[172:175], a[144:147]
    s_add_u32 s26, s26, 163840
    v_mfma_f32_16x16x32_bf16 a[148:151], v[64:67], v[176:179], a[148:151]
    v_mfma_f32_16x16x32_bf16 a[152:155], v[64:67], v[180:183], a[152:155]
    v_mfma_f32_16x16x32_bf16 a[156:159], v[64:67], v[184:187], a[156:159]
    v_mfma_f32_16x16x32_bf16 a[160:163], v[64:67], v[188:191], a[160:163]
    v_mfma_f32_16x16x32_bf16 a[164:167], v[64:67], v[192:195], a[164:167]
    ds_read_b128 v[64:67], v7 offset:5120
    v_mfma_f32_16x16x32_bf16 a[168:171], v[68:71], v[168:171], a[168:171]
    v_mfma_f32_16x16x32_bf16 a[172:175], v[68:71], v[172:175], a[172:175]
    v_mfma_f32_16x16x32_bf16 a[176:179], v[68:71], v[176:179], a[176:179]
    v_mfma_f32_16x16x32_bf16 a[180:183], v[68:71], v[180:183], a[180:183]
    v_mfma_f32_16x16x32_bf16 a[184:187], v[68:71], v[184:187], a[184:187]
    v_mfma_f32_16x16x32_bf16 a[188:191], v[68:71], v[188:191], a[188:191]
    v_mfma_f32_16x16x32_bf16 a[192:195], v[68:71], v[192:195], a[192:195]
    ds_read_b128 v[68:71], v7 offset:6144
    v_mfma_f32_16x16x32_bf16 a[196:199], v[72:75], v[168:171], a[196:199]
    v_mfma_f32_16x16x32_bf16 a[200:203], v[72:75], v[172:175], a[200:203]
    v_mfma_f32_16x16x32_bf16 a[204:207], v[72:75], v[176:179], a[204:207]
    v_mfma_f32_16x16x32_bf16 a[208:211], v[72:75], v[180:183], a[208:211]
    v_mfma_f32_16x16x32_bf16 a[212:215], v[72:75], v[184:187], a[212:215]
    v_mfma_f32_16x16x32_bf16 a[216:219], v[72:75], v[188:191], a[216:219]
    v_mfma_f32_16x16x32_bf16 a[220:223], v[72:75], v[192:195], a[220:223]
    ds_read_b128 v[72:75], v7 offset:7168
    v_mfma_f32_16x16x32_bf16 a[224:227], v[76:79], v[168:171], a[224:227]
    v_mfma_f32_16x16x32_bf16 a[228:231], v[76:79], v[172:175], a[228:231]
    v_mfma_f32_16x16x32_bf16 a[232:235], v[76:79], v[176:179], a[232:235]
    v_mfma_f32_16x16x32_bf16 a[236:239], v[76:79], v[180:183], a[236:239]
    v_mfma_f32_16x16x32_bf16 a[240:243], v[76:79], v[184:187], a[240:243]
    v_mfma_f32_16x16x32_bf16 a[244:247], v[76:79], v[188:191], a[244:247]
    v_mfma_f32_16x16x32_bf16 a[248:251], v[76:79], v[192:195], a[248:251]
    ds_read_b128 v[76:79], v7 offset:8192
    v_mfma_f32_16x16x32_bf16 a[252:255], v[80:83], v[168:171], a[252:255]
    v_mfma_f32_16x16x32_bf16 v[20:23], v[80:83], v[172:175], v[20:23]
    v_mfma_f32_16x16x32_bf16 v[24:27], v[80:83], v[176:179], v[24:27]
    v_mfma_f32_16x16x32_bf16 v[28:31], v[80:83], v[180:183], v[28:31]
    v_mfma_f32_16x16x32_bf16 v[32:35], v[80:83], v[184:187], v[32:35]
    v_mfma_f32_16x16x32_bf16 v[36:39], v[80:83], v[188:191], v[36:39]
    v_mfma_f32_16x16x32_bf16 v[40:43], v[80:83], v[192:195], v[40:43]
    ds_read_b128 v[80:83], v7 offset:9216
    s_add_u32 s21, s21, 1
    s_cmp_lt_u32 s21, 6
    s_cbranch_scc1 L_op_loop
    s_waitcnt vmcnt(34) lgkmcnt(7)
    v_mfma_f32_16x16x32_bf16 a[0:3], v[44:47], v[84:87], a[0:3]
    s_mov_b32 s22, s25
    v_mfma_f32_16x16x32_bf16 a[4:7], v[44:47], v[88:91], a[4:7]
    buffer_load_dwordx4 v[168:171], v6, s[4:7], s22 offen
    v_mfma_f32_16x16x32_bf16 a[8:11], v[44:47], v[92:95], a[8:11]
    s_add_u32 s22, s22, 4096
    v_mfma_f32_16x16x32_bf16 a[12:15], v[44:47], v[96:99], a[12:15]
    buffer_load_dwordx4 v[172:175], v6, s[4:7], s22 offen
    v_mfma_f32_16x16x32_bf16 a[16:19], v[44:47], v[100:103], a[16:19]
    s_add_u32 s22, s22, 4096
    v_mfma_f32_16x16x32_bf16 a[20:23], v[44:47], v[104:107], a[20:23]
    buffer_load_dwordx4 v[176:179], v6, s[4:7], s22 offen
    v_mfma_f32_16x16x32_bf16 a[24:27], v[44:47], v[108:111], a[24:27]
    ds_read_b128 v[44:47], v7 offset:10240
    v_mfma_f32_16x16x32_bf16 a[28:31], v[48:51], v[84:87], a[28:31]
    s_add_u32 s22, s22, 4096
    v_mfma_f32_16x16x32_bf16 a[32:35], v[48:51], v[88:91], a[32:35]
    buffer_load_dwordx4 v[180:183], v6, s[4:7], s22 offen
    v_mfma_f32_16x16x32_bf16 a[36:39], v[48:51], v[92:95], a[36:39]
    s_add_u32 s22, s22, 4096
    v_mfma_f32_16x16x32_bf16 a[40:43], v[48:51], v[96:99], a[40:43]
    buffer_load_dwordx4 v[184:187], v6, s[4:7], s22 offen
    v_mfma_f32_16x16x32_bf16 a[44:47], v[48:51], v[100:103], a[44:47]
    s_add_u32 s22, s22, 4096
    v_mfma_f32_16x16x32_bf16 a[48:51], v[48:51], v[104:107], a[48:51]
    buffer_load_dwordx4 v[188:191], v6, s[4:7], s22 offen
    v_mfma_f32_16x16x32_bf16 a[52:55], v[48:51], v[108:111], a[52:55]
    ds_read_b128 v[48:51], v7 offset:11264
    s_waitcnt lgkmcnt(2)
    v_mfma_f32_16x16x32_bf16 a[56:59], v[52:55], v[84:87], a[56:59]
    s_add_u32 s22, s22, 4096
    v_mfma_f32_16x16x32_bf16 a[60:63], v[52:55], v[88:91], a[60:63]
    buffer_load_dwordx4 v[192:195], v6, s[4:7], s22 offen
    v_mfma_f32_16x16x32_bf16 a[64:67], v[52:55], v[92:95], a[64:67]
    s_add_u32 s25, s25, 57344
    v_mfma_f32_16x16x32_bf16 a[68:71], v[52:55], v[96:99], a[68:71]
    v_mfma_f32_16x16x32_bf16 a[72:75], v[52:55], v[100:103], a[72:75]
    v_mfma_f32_16x16x32_bf16 a[76:79], v[52:55], v[104:107], a[76:79]
    v_mfma_f32_16x16x32_bf16 a[80:83], v[52:55], v[108:111], a[80:83]
    ds_read_b128 v[52:55], v7 offset:12288
    v_mfma_f32_16x16x32_bf16 a[84:87], v[56:59], v[84:87], a[84:87]
    v_mfma_f32_16x16x32_bf16 a[88:91], v[56:59], v[88:91], a[88:91]
    v_mfma_f32_16x16x32_bf16 a[92:95], v[56:59], v[92:95], a[92:95]
    v_mfma_f32_16x16x32_bf16 a[96:99], v[56:59], v[96:99], a[96:99]
    v_mfma_f32_16x16x32_bf16 a[100:103], v[56:59], v[100:103], a[100:103]
    v_mfma_f32_16x16x32_bf16 a[104:107], v[56:59], v[104:107], a[104:107]
    v_mfma_f32_16x16x32_bf16 a[108:111], v[56:59], v[108:111], a[108:111]
    ds_read_b128 v[56:59], v7 offset:13312
    v_mfma_f32_16x16x32_bf16 a[112:115], v[60:63], v[84:87], a[112:115]
    v_mfma_f32_16x16x32_bf16 a[116:119], v[60:63], v[88:91], a[116:119]
    v_mfma_f32_16x16x32_bf16 a[120:123], v[60:63], v[92:95], a[120:123]
    v_mfma_f32_16x16x32_bf16 a[124:127], v[60:63], v[96:99], a[124:127]
    v_mfma_f32_16x16x32_bf16 a[128:131], v[60:63], v[100:103], a[128:131]
    v_mfma_f32_16x16x32_bf16 a[132:135], v[60:63], v[104:107], a[132:135]
    v_mfma_f32_16x16x32_bf16 a[136:139], v[60:63], v[108:111], a[136:139]
    ds_read_b128 v[60:63], v7 offset:14336
    v_mfma_f32_16x16x32_bf16 a[140:143], v[64:67], v[84:87], a[140:143]
    v_mfma_f32_16x16x32_bf16 a[144:147], v[64:67], v[88:91], a[144:147]
    v_mfma_f32_16x16x32_bf16 a[148:151], v[64:67], v[92:95], a[148:151]
    v_mfma_f32_16x16x32_bf16 a[152:155], v[64:67], v[96:99], a[152:155]
    v_mfma_f32_16x16x32_bf16 a[156:159], v[64:67], v[100:103], a[156:159]
    v_mfma_f32_16x16x32_bf16 a[160:163], v[64:67], v[104:107], a[160:163]
    v_mfma_f32_16x16x32_bf16 a[164:167], v[64:67], v[108:111], a[164:167]
    ds_read_b128 v[64:67], v7 offset:15360
    v_mfma_f32_16x16x32_bf16 a[168:171], v[68:71], v[84:87], a[168:171]
    v_mfma_f32_16x16x32_bf16 a[172:175], v[68:71], v[88:91], a[172:175]
    v_mfma_f32_16x16x32_bf16 a[176:179], v[68:71], v[92:95], a[176:179]
    v_mfma_f32_16x16x32_bf16 a[180:183], v[68:71], v[96:99], a[180:183]
    v_mfma_f32_16x16x32_bf16 a[184:187], v[68:71], v[100:103], a[184:187]
    v_mfma_f32_16x16x32_bf16 a[188:191], v[68:71], v[104:107], a[188:191]
    v_mfma_f32_16x16x32_bf16 a[192:195], v[68:71], v[108:111], a[192:195]
    ds_read_b128 v[68:71], v7 offset:16384
    v_mfma_f32_16x16x32_bf16 a[196:199], v[72:75], v[84:87], a[196:199]
    v_mfma_f32_16x16x32_bf16 a[200:203], v[72:75], v[88:91], a[200:203]
    v_mfma_f32_16x16x32_bf16 a[204:207], v[72:75], v[92:95], a[204:207]
    v_mfma_f32_16x16x32_bf16 a[208:211], v[72:75], v[96:99], a[208:211]
    v_mfma_f32_16x16x32_bf16 a[212:215], v[72:75], v[100:103], a[212:215]
    v_mfma_f32_16x16x32_bf16 a[216:219], v[72:75], v[104:107], a[216:219]
    v_mfma_f32_16x16x32_bf16 a[220:223], v[72:75], v[108:111], a[220:223]
    ds_read_b128 v[72:75], v7 offset:17408
    v_mfma_f32_16x16x32_bf16 a[224:227], v[76:79], v[84:87], a[224:227]
    v_mfma_f32_16x16x32_bf16 a[228:231], v[76:79], v[88:91], a[228:231]
    v_mfma_f32_16x16x32_bf16 a[232:235], v[76:79], v[92:95], a[232:235]
    v_mfma_f32_16x16x32_bf16 a[236:239], v[76:79], v[96:99], a[236:239]
    v_mfma_f32_16x16x32_bf16 a[240:243], v[76:79], v[100:103], a[240:243]
    v_mfma_f32_16x16x32_bf16 a[244:247], v[76:79], v[104:107], a[244:247]
    v_mfma_f32_16x16x32_bf16 a[248:251], v[76:79], v[108:111], a[248:251]
    ds_read_b128 v[76:79], v7 offset:18432
    v_mfma_f32_16x16x32_bf16 a[252:255], v[80:83], v[84:87], a[252:255]
    v_mfma_f32_16x16x32_bf16 v[20:23], v[80:83], v[88:91], v[20:23]
    v_mfma_f32_16x16x32_bf16 v[24:27], v[80:83], v[92:95], v[24:27]
    v_mfma_f32_16x16x32_bf16 v[28:31], v[80:83], v[96:99], v[28:31]
    v_mfma_f32_16x16x32_bf16 v[32:35], v[80:83], v[100:103], v[32:35]
    v_mfma_f32_16x16x32_bf16 v[36:39], v[80:83], v[104:107], v[36:39]
    v_mfma_f32_16x16x32_bf16 v[40:43], v[80:83], v[108:111], v[40:43]
    ds_read_b128 v[80:83], v7 offset:19456
    s_waitcnt vmcnt(24) lgkmcnt(7)
    v_mfma_f32_16x16x32_bf16 a[0:3], v[44:47], v[112:115], a[0:3]
    v_mfma_f32_16x16x32_bf16 a[4:7], v[44:47], v[116:119], a[4:7]
    v_mfma_f32_16x16x32_bf16 a[8:11], v[44:47], v[120:123], a[8:11]
    v_mfma_f32_16x16x32_bf16 a[12:15], v[44:47], v[124:127], a[12:15]
    v_mfma_f32_16x16x32_bf16 a[16:19], v[44:47], v[128:131], a[16:19]
    v_mfma_f32_16x16x32_bf16 a[20:23], v[44:47], v[132:135], a[20:23]
    v_mfma_f32_16x16x32_bf16 a[24:27], v[44:47], v[136:139], a[24:27]
    ds_read_b128 v[44:47], v7 offset:20480
    v_mfma_f32_16x16x32_bf16 a[28:31], v[48:51], v[112:115], a[28:31]
    v_mfma_f32_16x16x32_bf16 a[32:35], v[48:51], v[116:119], a[32:35]
    v_mfma_f32_16x16x32_bf16 a[36:39], v[48:51], v[120:123], a[36:39]
    v_mfma_f32_16x16x32_bf16 a[40:43], v[48:51], v[124:127], a[40:43]
    v_mfma_f32_16x16x32_bf16 a[44:47], v[48:51], v[128:131], a[44:47]
    v_mfma_f32_16x16x32_bf16 a[48:51], v[48:51], v[132:135], a[48:51]
    v_mfma_f32_16x16x32_bf16 a[52:55], v[48:51], v[136:139], a[52:55]
    ds_read_b128 v[48:51], v7 offset:21504
    s_waitcnt lgkmcnt(2)
    v_mfma_f32_16x16x32_bf16 a[56:59], v[52:55], v[112:115], a[56:59]
    v_mfma_f32_16x16x32_bf16 a[60:63], v[52:55], v[116:119], a[60:63]
    v_mfma_f32_16x16x32_bf16 a[64:67], v[52:55], v[120:123], a[64:67]
    v_mfma_f32_16x16x32_bf16 a[68:71], v[52:55], v[124:127], a[68:71]
    v_mfma_f32_16x16x32_bf16 a[72:75], v[52:55], v[128:131], a[72:75]
    v_mfma_f32_16x16x32_bf16 a[76:79], v[52:55], v[132:135], a[76:79]
    v_mfma_f32_16x16x32_bf16 a[80:83], v[52:55], v[136:139], a[80:83]
    ds_read_b128 v[52:55], v7 offset:22528
    v_mfma_f32_16x16x32_bf16 a[84:87], v[56:59], v[112:115], a[84:87]
    v_mfma_f32_16x16x32_bf16 a[88:91], v[56:59], v[116:119], a[88:91]
    v_mfma_f32_16x16x32_bf16 a[92:95], v[56:59], v[120:123], a[92:95]
    v_mfma_f32_16x16x32_bf16 a[96:99], v[56:59], v[124:127], a[96:99]
    v_mfma_f32_16x16x32_bf16 a[100:103], v[56:59], v[128:131], a[100:103]
    v_mfma_f32_16x16x32_bf16 a[104:107], v[56:59], v[132:135], a[104:107]
    v_mfma_f32_16x16x32_bf16 a[108:111], v[56:59], v[136:139], a[108:111]
    ds_read_b128 v[56:59], v7 offset:23552
    v_mfma_f32_16x16x32_bf16 a[112:115], v[60:63], v[112:115], a[112:115]
    v_mfma_f32_16x16x32_bf16 a[116:119], v[60:63], v[116:119], a[116:119]
    v_mfma_f32_16x16x32_bf16 a[120:123], v[60:63], v[120:123], a[120:123]
    v_mfma_f32_16x16x32_bf16 a[124:127], v[60:63], v[124:127], a[124:127]
    v_mfma_f32_16x16x32_bf16 a[128:131], v[60:63], v[128:131], a[128:131]
    v_mfma_f32_16x16x32_bf16 a[132:135], v[60:63], v[132:135], a[132:135]
    v_mfma_f32_16x16x32_bf16 a[136:139], v[60:63], v[136:139], a[136:139]
    ds_read_b128 v[60:63], v7 offset:24576
    v_mfma_f32_16x16x32_bf16 a[140:143], v[64:67], v[112:115], a[140:143]
    v_mfma_f32_16x16x32_bf16 a[144:147], v[64:67], v[116:119], a[144:147]
    v_mfma_f32_16x16x32_bf16 a[148:151], v[64:67], v[120:123], a[148:151]
    v_mfma_f32_16x16x32_bf16 a[152:155], v[64:67], v[124:127], a[152:155]
    v_mfma_f32_16x16x32_bf16 a[156:159], v[64:67], v[128:131], a[156:159]
    v_mfma_f32_16x16x32_bf16 a[160:163], v[64:67], v[132:135], a[160:163]
    v_mfma_f32_16x16x32_bf16 a[164:167], v[64:67], v[136:139], a[164:167]
    ds_read_b128 v[64:67], v7 offset:25600
    v_mfma_f32_16x16x32_bf16 a[168:171], v[68:71], v[112:115], a[168:171]
    v_mfma_f32_16x16x32_bf16 a[172:175], v[68:71], v[116:119], a[172:175]
    v_mfma_f32_16x16x32_bf16 a[176:179], v[68:71], v[120:123], a[176:179]
    v_mfma_f32_16x16x32_bf16 a[180:183], v[68:71], v[124:127], a[180:183]
    v_mfma_f32_16x16x32_bf16 a[184:187], v[68:71], v[128:131], a[184:187]
    v_mfma_f32_16x16x32_bf16 a[188:191], v[68:71], v[132:135], a[188:191]
    v_mfma_f32_16x16x32_bf16 a[192:195], v[68:71], v[136:139], a[192:195]
    ds_read_b128 v[68:71], v7 offset:26624
    v_mfma_f32_16x16x32_bf16 a[196:199], v[72:75], v[112:115], a[196:199]
    v_mfma_f32_16x16x32_bf16 a[200:203], v[72:75], v[116:119], a[200:203]
    v_mfma_f32_16x16x32_bf16 a[204:207], v[72:75], v[120:123], a[204:207]
    v_mfma_f32_16x16x32_bf16 a[208:211], v[72:75], v[124:127], a[208:211]
    v_mfma_f32_16x16x32_bf16 a[212:215], v[72:75], v[128:131], a[212:215]
    v_mfma_f32_16x16x32_bf16 a[216:219], v[72:75], v[132:135], a[216:219]
    v_mfma_f32_16x16x32_bf16 a[220:223], v[72:75], v[136:139], a[220:223]
    ds_read_b128 v[72:75], v7 offset:27648
    v_mfma_f32_16x16x32_bf16 a[224:227], v[76:79], v[112:115], a[224:227]
    v_mfma_f32_16x16x32_bf16 a[228:231], v[76:79], v[116:119], a[228:231]
    v_mfma_f32_16x16x32_bf16 a[232:235], v[76:79], v[120:123], a[232:235]
    v_mfma_f32_16x16x32_bf16 a[236:239], v[76:79], v[124:127], a[236:239]
    v_mfma_f32_16x16x32_bf16 a[240:243], v[76:79], v[128:131], a[240:243]
    v_mfma_f32_16x16x32_bf16 a[244:247], v[76:79], v[132:135], a[244:247]
    v_mfma_f32_16x16x32_bf16 a[248:251], v[76:79], v[136:139], a[248:251]
    ds_read_b128 v[76:79], v7 offset:28672
    v_mfma_f32_16x16x32_bf16 a[252:255], v[80:83], v[112:115], a[252:255]
    v_mfma_f32_16x16x32_bf16 v[20:23], v[80:83], v[116:119], v[20:23]
    v_mfma_f32_16x16x32_bf16 v[24:27], v[80:83], v[120:123], v[24:27]
    v_mfma_f32_16x16x32_bf16 v[28:31], v[80:83], v[124:127], v[28:31]
    v_mfma_f32_16x16x32_bf16 v[32:35], v[80:83], v[128:131], v[32:35]
    v_mfma_f32_16x16x32_bf16 v[36:39], v[80:83], v[132:135], v[36:39]
    v_mfma_f32_16x16x32_bf16 v[40:43], v[80:83], v[136:139], v[40:43]
    ds_read_b128 v[80:83], v7 offset:29696
    s_waitcnt vmcnt(7) lgkmcnt(7)
    v_mfma_f32_16x16x32_bf16 a[0:3], v[44:47], v[140:143], a[0:3]
    v_mfma_f32_16x16x32_bf16 a[4:7], v[44:47], v[144:147], a[4:7]
    v_mfma_f32_16x16x32_bf16 a[8:11], v[44:47], v[148:151], a[8:11]
    v_mfma_f32_16x16x32_bf16 a[12:15], v[44:47], v[152:155], a[12:15]
    v_mfma_f32_16x16x32_bf16 a[16:19], v[44:47], v[156:159], a[16:19]
    v_mfma_f32_16x16x32_bf16 a[20:23], v[44:47], v[160:163], a[20:23]
    v_mfma_f32_16x16x32_bf16 a[24:27], v[44:47], v[164:167], a[24:27]
    ds_read_b128 v[44:47], v7 offset:30720
    v_mfma_f32_16x16x32_bf16 a[28:31], v[48:51], v[140:143], a[28:31]
    v_mfma_f32_16x16x32_bf16 a[32:35], v[48:51], v[144:147], a[32:35]
    v_mfma_f32_16x16x32_bf16 a[36:39], v[48:51], v[148:151], a[36:39]
    v_mfma_f32_16x16x32_bf16 a[40:43], v[48:51], v[152:155], a[40:43]
    v_mfma_f32_16x16x32_bf16 a[44:47], v[48:51], v[156:159], a[44:47]
    v_mfma_f32_16x16x32_bf16 a[48:51], v[48:51], v[160:163], a[48:51]
    v_mfma_f32_16x16x32_bf16 a[52:55], v[48:51], v[164:167], a[52:55]
    ds_read_b128 v[48:51], v7 offset:31744
    s_waitcnt lgkmcnt(2)
    v_mfma_f32_16x16x32_bf16 a[56:59], v[52:55], v[140:143], a[56:59]
    v_mfma_f32_16x16x32_bf16 a[60:63], v[52:55], v[144:147], a[60:63]
    v_mfma_f32_16x16x32_bf16 a[64:67], v[52:55], v[148:151], a[64:67]
    v_mfma_f32_16x16x32_bf16 a[68:71], v[52:55], v[152:155], a[68:71]
    v_mfma_f32_16x16x32_bf16 a[72:75], v[52:55], v[156:159], a[72:75]
    v_mfma_f32_16x16x32_bf16 a[76:79], v[52:55], v[160:163], a[76:79]
    v_mfma_f32_16x16x32_bf16 a[80:83], v[52:55], v[164:167], a[80:83]
    ds_read_b128 v[52:55], v7 offset:32768
    v_mfma_f32_16x16x32_bf16 a[84:87], v[56:59], v[140:143], a[84:87]
    v_mfma_f32_16x16x32_bf16 a[88:91], v[56:59], v[144:147], a[88:91]
    v_mfma_f32_16x16x32_bf16 a[92:95], v[56:59], v[148:151], a[92:95]
    v_mfma_f32_16x16x32_bf16 a[96:99], v[56:59], v[152:155], a[96:99]
    v_mfma_f32_16x16x32_bf16 a[100:103], v[56:59], v[156:159], a[100:103]
    v_mfma_f32_16x16x32_bf16 a[104:107], v[56:59], v[160:163], a[104:107]
    v_mfma_f32_16x16x32_bf16 a[108:111], v[56:59], v[164:167], a[108:111]
    ds_read_b128 v[56:59], v7 offset:33792
    v_mfma_f32_16x16x32_bf16 a[112:115], v[60:63], v[140:143], a[112:115]
    v_mfma_f32_16x16x32_bf16 a[116:119], v[60:63], v[144:147], a[116:119]
    v_mfma_f32_16x16x32_bf16 a[120:123], v[60:63], v[148:151], a[120:123]
    v_mfma_f32_16x16x32_bf16 a[124:127], v[60:63], v[152:155], a[124:127]
    v_mfma_f32_16x16x32_bf16 a[128:131], v[60:63], v[156:159], a[128:131]
    v_mfma_f32_16x16x32_bf16 a[132:135], v[60:63], v[160:163], a[132:135]
    v_mfma_f32_16x16x32_bf16 a[136:139], v[60:63], v[164:167], a[136:139]
    ds_read_b128 v[60:63], v7 offset:34816
    v_mfma_f32_16x16x32_bf16 a[140:143], v[64:67], v[140:143], a[140:143]
    v_mfma_f32_16x16x32_bf16 a[144:147], v[64:67], v[144:147], a[144:147]
    v_mfma_f32_16x16x32_bf16 a[148:151], v[64:67], v[148:151], a[148:151]
    v_mfma_f32_16x16x32_bf16 a[152:155], v[64:67], v[152:155], a[152:155]
    v_mfma_f32_16x16x32_bf16 a[156:159], v[64:67], v[156:159], a[156:159]
    v_mfma_f32_16x16x32_bf16 a[160:163], v[64:67], v[160:163], a[160:163]
    v_mfma_f32_16x16x32_bf16 a[164:167], v[64:67], v[164:167], a[164:167]
    ds_read_b128 v[64:67], v7 offset:35840
    v_mfma_f32_16x16x32_bf16 a[168:171], v[68:71], v[140:143], a[168:171]
    v_mfma_f32_16x16x32_bf16 a[172:175], v[68:71], v[144:147], a[172:175]
    v_mfma_f32_16x16x32_bf16 a[176:179], v[68:71], v[148:151], a[176:179]
    v_mfma_f32_16x16x32_bf16 a[180:183], v[68:71], v[152:155], a[180:183]
    v_mfma_f32_16x16x32_bf16 a[184:187], v[68:71], v[156:159], a[184:187]
    v_mfma_f32_16x16x32_bf16 a[188:191], v[68:71], v[160:163], a[188:191]
    v_mfma_f32_16x16x32_bf16 a[192:195], v[68:71], v[164:167], a[192:195]
    ds_read_b128 v[68:71], v7 offset:36864
    v_mfma_f32_16x16x32_bf16 a[196:199], v[72:75], v[140:143], a[196:199]
    v_mfma_f32_16x16x32_bf16 a[200:203], v[72:75], v[144:147], a[200:203]
    v_mfma_f32_16x16x32_bf16 a[204:207], v[72:75], v[148:151], a[204:207]
    v_mfma_f32_16x16x32_bf16 a[208:211], v[72:75], v[152:155], a[208:211]
    v_mfma_f32_16x16x32_bf16 a[212:215], v[72:75], v[156:159], a[212:215]
    v_mfma_f32_16x16x32_bf16 a[216:219], v[72:75], v[160:163], a[216:219]
    v_mfma_f32_16x16x32_bf16 a[220:223], v[72:75], v[164:167], a[220:223]
    ds_read_b128 v[72:75], v7 offset:37888
    v_mfma_f32_16x16x32_bf16 a[224:227], v[76:79], v[140:143], a[224:227]
    v_mfma_f32_16x16x32_bf16 a[228:231], v[76:79], v[144:147], a[228:231]
    v_mfma_f32_16x16x32_bf16 a[232:235], v[76:79], v[148:151], a[232:235]
    v_mfma_f32_16x16x32_bf16 a[236:239], v[76:79], v[152:155], a[236:239]
    v_mfma_f32_16x16x32_bf16 a[240:243], v[76:79], v[156:159], a[240:243]
    v_mfma_f32_16x16x32_bf16 a[244:247], v[76:79], v[160:163], a[244:247]
    v_mfma_f32_16x16x32_bf16 a[248:251], v[76:79], v[164:167], a[248:251]
    ds_read_b128 v[76:79], v7 offset:38912
    v_mfma_f32_16x16x32_bf16 a[252:255], v[80:83], v[140:143], a[252:255]
    v_mfma_f32_16x16x32_bf16 v[20:23], v[80:83], v[144:147], v[20:23]
    v_mfma_f32_16x16x32_bf16 v[24:27], v[80:83], v[148:151], v[24:27]
    v_mfma_f32_16x16x32_bf16 v[28:31], v[80:83], v[152:155], v[28:31]
    v_mfma_f32_16x16x32_bf16 v[32:35], v[80:83], v[156:159], v[32:35]
    v_mfma_f32_16x16x32_bf16 v[36:39], v[80:83], v[160:163], v[36:39]
    v_mfma_f32_16x16x32_bf16 v[40:43], v[80:83], v[164:167], v[40:43]
    ds_read_b128 v[80:83], v7 offset:39936
    s_waitcnt vmcnt(0) lgkmcnt(7)
    v_mfma_f32_16x16x32_bf16 a[0:3], v[44:47], v[168:171], a[0:3]
    v_mfma_f32_16x16x32_bf16 a[4:7], v[44:47], v[172:175], a[4:7]
    v_mfma_f32_16x16x32_bf16 a[8:11], v[44:47], v[176:179], a[8:11]
    v_mfma_f32_16x16x32_bf16 a[12:15], v[44:47], v[180:183], a[12:15]
    v_mfma_f32_16x16x32_bf16 a[16:19], v[44:47], v[184:187], a[16:19]
    v_mfma_f32_16x16x32_bf16 a[20:23], v[44:47], v[188:191], a[20:23]
    v_mfma_f32_16x16x32_bf16 a[24:27], v[44:47], v[192:195], a[24:27]
    v_mfma_f32_16x16x32_bf16 a[28:31], v[48:51], v[168:171], a[28:31]
    v_mfma_f32_16x16x32_bf16 a[32:35], v[48:51], v[172:175], a[32:35]
    v_mfma_f32_16x16x32_bf16 a[36:39], v[48:51], v[176:179], a[36:39]
    v_mfma_f32_16x16x32_bf16 a[40:43], v[48:51], v[180:183], a[40:43]
    v_mfma_f32_16x16x32_bf16 a[44:47], v[48:51], v[184:187], a[44:47]
    v_mfma_f32_16x16x32_bf16 a[48:51], v[48:51], v[188:191], a[48:51]
    v_mfma_f32_16x16x32_bf16 a[52:55], v[48:51], v[192:195], a[52:55]
    s_waitcnt lgkmcnt(0)
    v_mfma_f32_16x16x32_bf16 a[56:59], v[52:55], v[168:171], a[56:59]
    v_mfma_f32_16x16x32_bf16 a[60:63], v[52:55], v[172:175], a[60:63]
    ds_write_b128 v7, a[0:3] offset:0
    v_mfma_f32_16x16x32_bf16 a[64:67], v[52:55], v[176:179], a[64:67]
    ds_write_b128 v7, a[28:31] offset:1024
    v_mfma_f32_16x16x32_bf16 a[68:71], v[52:55], v[180:183], a[68:71]
    ds_write_b128 v7, a[4:7] offset:2048
    v_mfma_f32_16x16x32_bf16 a[72:75], v[52:55], v[184:187], a[72:75]
    ds_write_b128 v7, a[32:35] offset:3072
    v_mfma_f32_16x16x32_bf16 a[76:79], v[52:55], v[188:191], a[76:79]
    ds_write_b128 v7, a[8:11] offset:4096
    v_mfma_f32_16x16x32_bf16 a[80:83], v[52:55], v[192:195], a[80:83]
    ds_write_b128 v7, a[36:39] offset:5120
    v_mfma_f32_16x16x32_bf16 a[84:87], v[56:59], v[168:171], a[84:87]
    ds_write_b128 v7, a[12:15] offset:6144
    v_mfma_f32_16x16x32_bf16 a[88:91], v[56:59], v[172:175], a[88:91]
    ds_write_b128 v7, a[40:43] offset:7168
    v_mfma_f32_16x16x32_bf16 a[92:95], v[56:59], v[176:179], a[92:95]
    ds_write_b128 v7, a[16:19] offset:8192
    v_mfma_f32_16x16x32_bf16 a[96:99], v[56:59], v[180:183], a[96:99]
    ds_write_b128 v7, a[44:47] offset:9216
    v_mfma_f32_16x16x32_bf16 a[100:103], v[56:59], v[184:187], a[100:103]
    ds_write_b128 v7, a[20:23] offset:10240
    v_mfma_f32_16x16x32_bf16 a[104:107], v[56:59], v[188:191], a[104:107]
    ds_write_b128 v7, a[48:51] offset:11264
    v_mfma_f32_16x16x32_bf16 a[108:111], v[56:59], v[192:195], a[108:111]
    ds_write_b128 v7, a[24:27] offset:12288
    v_mfma_f32_16x16x32_bf16 a[112:115], v[60:63], v[168:171], a[112:115]
    ds_write_b128 v7, a[52:55] offset:13312
    v_mfma_f32_16x16x32_bf16 a[116:119], v[60:63], v[172:175], a[116:119]
    ds_write_b128 v7, a[56:59] offset:14336
    v_mfma_f32_16x16x32_bf16 a[120:123], v[60:63], v[176:179], a[120:123]
    ds_write_b128 v7, a[84:87] offset:15360
    v_mfma_f32_16x16x32_bf16 a[124:127], v[60:63], v[180:183], a[124:127]
    ds_write_b128 v7, a[60:63] offset:16384
    v_mfma_f32_16x16x32_bf16 a[128:131], v[60:63], v[184:187], a[128:131]
    ds_write_b128 v7, a[88:91] offset:17408
    v_mfma_f32_16x16x32_bf16 a[132:135], v[60:63], v[188:191], a[132:135]
    ds_write_b128 v7, a[64:67] offset:18432
    v_mfma_f32_16x16x32_bf16 a[136:139], v[60:63], v[192:195], a[136:139]
    ds_write_b128 v7, a[92:95] offset:19456
    v_mfma_f32_16x16x32_bf16 a[140:143], v[64:67], v[168:171], a[140:143]
    ds_write_b128 v7, a[68:71] offset:20480
    v_mfma_f32_16x16x32_bf16 a[144:147], v[64:67], v[172:175], a[144:147]
    ds_write_b128 v7, a[96:99] offset:21504
    v_mfma_f32_16x16x32_bf16 a[148:151], v[64:67], v[176:179], a[148:151]
    ds_write_b128 v7, a[72:75] offset:22528
    v_mfma_f32_16x16x32_bf16 a[152:155], v[64:67], v[180:183], a[152:155]
    ds_write_b128 v7, a[100:103] offset:23552
    v_mfma_f32_16x16x32_bf16 a[156:159], v[64:67], v[184:187], a[156:159]
    ds_write_b128 v7, a[76:79] offset:24576
    v_mfma_f32_16x16x32_bf16 a[160:163], v[64:67], v[188:191], a[160:163]
    ds_write_b128 v7, a[104:107] offset:25600
    v_mfma_f32_16x16x32_bf16 a[164:167], v[64:67], v[192:195], a[164:167]
    ds_write_b128 v7, a[80:83] offset:26624
    v_mfma_f32_16x16x32_bf16 a[168:171], v[68:71], v[168:171], a[168:171]
    ds_write_b128 v7, a[108:111] offset:27648
    v_mfma_f32_16x16x32_bf16 a[172:175], v[68:71], v[172:175], a[172:175]
    ds_write_b128 v7, a[112:115] offset:28672
    v_mfma_f32_16x16x32_bf16 a[176:179], v[68:71], v[176:179], a[176:179]
    ds_write_b128 v7, a[140:143] offset:29696
    v_mfma_f32_16x16x32_bf16 a[180:183], v[68:71], v[180:183], a[180:183]
    ds_write_b128 v7, a[116:119] offset:30720
    v_mfma_f32_16x16x32_bf16 a[184:187], v[68:71], v[184:187], a[184:187]
    ds_write_b128 v7, a[144:147] offset:31744
    v_mfma_f32_16x16x32_bf16 a[188:191], v[68:71], v[188:191], a[188:191]
    ds_write_b128 v7, a[120:123] offset:32768
    v_mfma_f32_16x16x32_bf16 a[192:195], v[68:71], v[192:195], a[192:195]
    ds_write_b128 v7, a[148:151] offset:33792
    v_mfma_f32_16x16x32_bf16 a[196:199], v[72:75], v[168:171], a[196:199]
    ds_write_b128 v7, a[124:127] offset:34816
    v_mfma_f32_16x16x32_bf16 a[200:203], v[72:75], v[172:175], a[200:203]
    ds_write_b128 v7, a[152:155] offset:35840
    v_mfma_f32_16x16x32_bf16 a[204:207], v[72:75], v[176:179], a[204:207]
    ds_write_b128 v7, a[128:131] offset:36864
    v_mfma_f32_16x16x32_bf16 a[208:211], v[72:75], v[180:183], a[208:211]
    ds_write_b128 v7, a[156:159] offset:37888
    v_mfma_f32_16x16x32_bf16 a[212:215], v[72:75], v[184:187], a[212:215]
    ds_write_b128 v7, a[132:135] offset:38912
    v_mfma_f32_16x16x32_bf16 a[216:219], v[72:75], v[188:191], a[216:219]
    ds_write_b128 v7, a[160:163] offset:39936
    v_mfma_f32_16x16x32_bf16 a[220:223], v[72:75], v[192:195], a[220:223]
    v_mfma_f32_16x16x32_bf16 a[224:227], v[76:79], v[168:171], a[224:227]
    v_mfma_f32_16x16x32_bf16 a[228:231], v[76:79], v[172:175], a[228:231]
    v_mfma_f32_16x16x32_bf16 a[232:235], v[76:79], v[176:179], a[232:235]
    v_mfma_f32_16x16x32_bf16 a[236:239], v[76:79], v[180:183], a[236:239]
    v_mfma_f32_16x16x32_bf16 a[240:243], v[76:79], v[184:187], a[240:243]
    v_mfma_f32_16x16x32_bf16 a[244:247], v[76:79], v[188:191], a[244:247]
    v_mfma_f32_16x16x32_bf16 a[248:251], v[76:79], v[192:195], a[248:251]
    v_mfma_f32_16x16x32_bf16 a[252:255], v[80:83], v[168:171], a[252:255]
    v_mfma_f32_16x16x32_bf16 v[20:23], v[80:83], v[172:175], v[20:23]
    v_mfma_f32_16x16x32_bf16 v[24:27], v[80:83], v[176:179], v[24:27]
    v_mfma_f32_16x16x32_bf16 v[28:31], v[80:83], v[180:183], v[28:31]
    v_mfma_f32_16x16x32_bf16 v[32:35], v[80:83], v[184:187], v[32:35]
    v_mfma_f32_16x16x32_bf16 v[36:39], v[80:83], v[188:191], v[36:39]
    v_mfma_f32_16x16x32_bf16 v[40:43], v[80:83], v[192:195], v[40:43]
    s_waitcnt lgkmcnt(0)
    s_barrier
    ds_read_b128 v[44:47], v2 offset:0
    ds_read_b128 v[48:51], v2 offset:1024
    ds_read_b128 v[52:55], v3 offset:0
    ds_read_b128 v[56:59], v3 offset:1024
    ds_read_b128 v[60:63], v4 offset:0
    ds_read_b128 v[64:67], v4 offset:1024
    ds_read_b128 v[68:71], v5 offset:0
    ds_read_b128 v[72:75], v5 offset:1024
    ds_read_b128 v[76:79], v2 offset:8192
    ds_read_b128 v[80:83], v2 offset:9216
    ds_read_b128 v[84:87], v3 offset:8192
    ds_read_b128 v[88:91], v3 offset:9216
    ds_read_b128 v[92:95], v4 offset:8192
    ds_read_b128 v[96:99], v4 offset:9216
    ds_read_b128 v[100:103], v5 offset:8192
    ds_read_b128 v[104:107], v5 offset:9216
    ds_read_b128 v[108:111], v2 offset:16384
    ds_read_b128 v[112:115], v2 offset:17408
    ds_read_b128 v[116:119], v3 offset:16384
    ds_read_b128 v[120:123], v3 offset:17408
    ds_read_b128 v[124:127], v4 offset:16384
    ds_read_b128 v[128:131], v4 offset:17408
    ds_read_b128 v[132:135], v5 offset:16384
    ds_read_b128 v[136:139], v5 offset:17408
    ds_read_b128 v[140:143], v2 offset:24576
    ds_read_b128 v[144:147], v2 offset:25600
    ds_read_b128 v[148:151], v3 offset:24576
    ds_read_b128 v[152:155], v3 offset:25600
    ds_read_b128 v[156:159], v4 offset:24576
    ds_read_b128 v[160:163], v4 offset:25600
    ds_read_b128 v[164:167], v5 offset:24576
    ds_read_b128 v[168:171], v5 offset:25600
    ds_read_b128 v[172:175], v2 offset:32768
    ds_read_b128 v[176:179], v2 offset:33792
    ds_read_b128 v[180:183], v3 offset:32768
    ds_read_b128 v[184:187], v3 offset:33792
    ds_read_b128 v[188:191], v4 offset:32768
    ds_read_b128 v[192:195], v4 offset:33792
    ds_read_b128 v[196:199], v5 offset:32768
    ds_read_b128 v[200:203], v5 offset:33792
    s_waitcnt lgkmcnt(0)
    s_barrier
    ds_write_b128 v7, a[136:139] offset:0
    v_pk_add_f32 v[44:45], v[44:45], v[52:53]
    v_pk_add_f32 v[60:61], v[60:61], v[68:69]
    v_pk_add_f32 v[46:47], v[46:47], v[54:55]
    v_pk_add_f32 v[62:63], v[62:63], v[70:71]
    ds_write_b128 v7, a[164:167] offset:1024
    v_pk_add_f32 v[48:49], v[48:49], v[56:57]
    v_pk_add_f32 v[64:65], v[64:65], v[72:73]
    v_pk_add_f32 v[50:51], v[50:51], v[58:59]
    v_pk_add_f32 v[66:67], v[66:67], v[74:75]
    ds_write_b128 v7, a[168:171] offset:2048
    v_pk_add_f32 v[44:45], v[44:45], v[60:61]
    v_pk_add_f32 v[46:47], v[46:47], v[62:63]
    v_pk_add_f32 v[48:49], v[48:49], v[64:65]
    v_pk_add_f32 v[50:51], v[50:51], v[66:67]
    ds_write_b128 v7, a[196:199] offset:3072
    v_cvt_pk_bf16_f32 v52, v44, v45
    v_cvt_pk_bf16_f32 v53, v46, v47
    v_cvt_pk_bf16_f32 v54, v48, v49
    v_cvt_pk_bf16_f32 v55, v50, v51
    ds_write_b128 v7, a[172:175] offset:4096
    s_add_u32 s22, s20, 0
    s_mul_i32 s23, s22, 9363
    s_lshr_b32 s23, s23, 16
    v_permlane16_swap_b32 v52, v54
    ds_write_b128 v7, a[200:203] offset:5120
    v_permlane16_swap_b32 v53, v55
    s_mul_i32 s30, s23, 7
    s_sub_u32 s30, s22, s30
    s_mul_i32 s30, s30, 40960
    ds_write_b128 v7, a[176:179] offset:6144
    s_lshl_b32 s23, s23, 6
    s_add_u32 s30, s30, s23
    s_add_u32 s30, s30, s24
    buffer_store_dwordx4 v[52:55], v9, s[12:15], s30 offen sc0 sc1
    ds_write_b128 v7, a[204:207] offset:7168
    v_pk_add_f32 v[76:77], v[76:77], v[84:85]
    v_pk_add_f32 v[92:93], v[92:93], v[100:101]
    v_pk_add_f32 v[78:79], v[78:79], v[86:87]
    v_pk_add_f32 v[94:95], v[94:95], v[102:103]
    ds_write_b128 v7, a[180:183] offset:8192
    v_pk_add_f32 v[80:81], v[80:81], v[88:89]
    v_pk_add_f32 v[96:97], v[96:97], v[104:105]
    v_pk_add_f32 v[82:83], v[82:83], v[90:91]
    v_pk_add_f32 v[98:99], v[98:99], v[106:107]
    ds_write_b128 v7, a[208:211] offset:9216
    v_pk_add_f32 v[76:77], v[76:77], v[92:93]
    v_pk_add_f32 v[78:79], v[78:79], v[94:95]
    v_pk_add_f32 v[80:81], v[80:81], v[96:97]
    v_pk_add_f32 v[82:83], v[82:83], v[98:99]
    ds_write_b128 v7, a[184:187] offset:10240
    v_cvt_pk_bf16_f32 v84, v76, v77
    v_cvt_pk_bf16_f32 v85, v78, v79
    v_cvt_pk_bf16_f32 v86, v80, v81
    v_cvt_pk_bf16_f32 v87, v82, v83
    ds_write_b128 v7, a[212:215] offset:11264
    s_add_u32 s22, s20, 4
    s_mul_i32 s23, s22, 9363
    s_lshr_b32 s23, s23, 16
    v_permlane16_swap_b32 v84, v86
    ds_write_b128 v7, a[188:191] offset:12288
    v_permlane16_swap_b32 v85, v87
    s_mul_i32 s30, s23, 7
    s_sub_u32 s30, s22, s30
    s_mul_i32 s30, s30, 40960
    ds_write_b128 v7, a[216:219] offset:13312
    s_lshl_b32 s23, s23, 6
    s_add_u32 s30, s30, s23
    s_add_u32 s30, s30, s24
    buffer_store_dwordx4 v[84:87], v9, s[12:15], s30 offen sc0 sc1
    ds_write_b128 v7, a[192:195] offset:14336
    v_pk_add_f32 v[108:109], v[108:109], v[116:117]
    v_pk_add_f32 v[124:125], v[124:125], v[132:133]
    v_pk_add_f32 v[110:111], v[110:111], v[118:119]
    v_pk_add_f32 v[126:127], v[126:127], v[134:135]
    ds_write_b128 v7, a[220:223] offset:15360
    v_pk_add_f32 v[112:113], v[112:113], v[120:121]
    v_pk_add_f32 v[128:129], v[128:129], v[136:137]
    v_pk_add_f32 v[114:115], v[114:115], v[122:123]
    v_pk_add_f32 v[130:131], v[130:131], v[138:139]
    ds_write_b128 v7, a[224:227] offset:16384
    v_pk_add_f32 v[108:109], v[108:109], v[124:125]
    v_pk_add_f32 v[110:111], v[110:111], v[126:127]
    v_pk_add_f32 v[112:113], v[112:113], v[128:129]
    v_pk_add_f32 v[114:115], v[114:115], v[130:131]
    ds_write_b128 v7, a[252:255] offset:17408
    v_cvt_pk_bf16_f32 v116, v108, v109
    v_cvt_pk_bf16_f32 v117, v110, v111
    v_cvt_pk_bf16_f32 v118, v112, v113
    v_cvt_pk_bf16_f32 v119, v114, v115
    ds_write_b128 v7, a[228:231] offset:18432
    s_add_u32 s22, s20, 8
    s_mul_i32 s23, s22, 9363
    s_lshr_b32 s23, s23, 16
    v_permlane16_swap_b32 v116, v118
    ds_write_b128 v7, v[20:23] offset:19456
    v_permlane16_swap_b32 v117, v119
    s_mul_i32 s30, s23, 7
    s_sub_u32 s30, s22, s30
    s_mul_i32 s30, s30, 40960
    ds_write_b128 v7, a[232:235] offset:20480
    s_lshl_b32 s23, s23, 6
    s_add_u32 s30, s30, s23
    s_add_u32 s30, s30, s24
    buffer_store_dwordx4 v[116:119], v9, s[12:15], s30 offen sc0 sc1
    ds_write_b128 v7, v[24:27] offset:21504
    v_pk_add_f32 v[140:141], v[140:141], v[148:149]
    v_pk_add_f32 v[156:157], v[156:157], v[164:165]
    v_pk_add_f32 v[142:143], v[142:143], v[150:151]
    v_pk_add_f32 v[158:159], v[158:159], v[166:167]
    ds_write_b128 v7, a[236:239] offset:22528
    v_pk_add_f32 v[144:145], v[144:145], v[152:153]
    v_pk_add_f32 v[160:161], v[160:161], v[168:169]
    v_pk_add_f32 v[146:147], v[146:147], v[154:155]
    v_pk_add_f32 v[162:163], v[162:163], v[170:171]
    ds_write_b128 v7, v[28:31] offset:23552
    v_pk_add_f32 v[140:141], v[140:141], v[156:157]
    v_pk_add_f32 v[142:143], v[142:143], v[158:159]
    v_pk_add_f32 v[144:145], v[144:145], v[160:161]
    v_pk_add_f32 v[146:147], v[146:147], v[162:163]
    ds_write_b128 v7, a[240:243] offset:24576
    v_cvt_pk_bf16_f32 v148, v140, v141
    v_cvt_pk_bf16_f32 v149, v142, v143
    v_cvt_pk_bf16_f32 v150, v144, v145
    v_cvt_pk_bf16_f32 v151, v146, v147
    ds_write_b128 v7, v[32:35] offset:25600
    s_add_u32 s22, s20, 12
    s_mul_i32 s23, s22, 9363
    s_lshr_b32 s23, s23, 16
    v_permlane16_swap_b32 v148, v150
    ds_write_b128 v7, a[244:247] offset:26624
    v_permlane16_swap_b32 v149, v151
    s_mul_i32 s30, s23, 7
    s_sub_u32 s30, s22, s30
    s_mul_i32 s30, s30, 40960
    ds_write_b128 v7, v[36:39] offset:27648
    s_lshl_b32 s23, s23, 6
    s_add_u32 s30, s30, s23
    s_add_u32 s30, s30, s24
    buffer_store_dwordx4 v[148:151], v9, s[12:15], s30 offen sc0 sc1
    ds_write_b128 v7, a[248:251] offset:28672
    v_pk_add_f32 v[172:173], v[172:173], v[180:181]
    v_pk_add_f32 v[188:189], v[188:189], v[196:197]
    v_pk_add_f32 v[174:175], v[174:175], v[182:183]
    v_pk_add_f32 v[190:191], v[190:191], v[198:199]
    ds_write_b128 v7, v[40:43] offset:29696
    v_pk_add_f32 v[176:177], v[176:177], v[184:185]
    v_pk_add_f32 v[192:193], v[192:193], v[200:201]
    v_pk_add_f32 v[178:179], v[178:179], v[186:187]
    v_pk_add_f32 v[194:195], v[194:195], v[202:203]
    v_pk_add_f32 v[172:173], v[172:173], v[188:189]
    v_pk_add_f32 v[174:175], v[174:175], v[190:191]
    v_pk_add_f32 v[176:177], v[176:177], v[192:193]
    v_pk_add_f32 v[178:179], v[178:179], v[194:195]
    v_cvt_pk_bf16_f32 v180, v172, v173
    v_cvt_pk_bf16_f32 v181, v174, v175
    v_cvt_pk_bf16_f32 v182, v176, v177
    v_cvt_pk_bf16_f32 v183, v178, v179
    s_add_u32 s22, s20, 16
    s_mul_i32 s23, s22, 9363
    s_lshr_b32 s23, s23, 16
    v_permlane16_swap_b32 v180, v182
    v_permlane16_swap_b32 v181, v183
    s_mul_i32 s30, s23, 7
    s_sub_u32 s30, s22, s30
    s_mul_i32 s30, s30, 40960
    s_lshl_b32 s23, s23, 6
    s_add_u32 s30, s30, s23
    s_add_u32 s30, s30, s24
    buffer_store_dwordx4 v[180:183], v9, s[12:15], s30 offen sc0 sc1
    s_waitcnt lgkmcnt(0)
    s_barrier
    ds_read_b128 v[44:47], v2 offset:0
    ds_read_b128 v[48:51], v2 offset:1024
    ds_read_b128 v[52:55], v3 offset:0
    ds_read_b128 v[56:59], v3 offset:1024
    ds_read_b128 v[60:63], v4 offset:0
    ds_read_b128 v[64:67], v4 offset:1024
    ds_read_b128 v[68:71], v5 offset:0
    ds_read_b128 v[72:75], v5 offset:1024
    ds_read_b128 v[76:79], v2 offset:8192
    ds_read_b128 v[80:83], v2 offset:9216
    ds_read_b128 v[84:87], v3 offset:8192
    ds_read_b128 v[88:91], v3 offset:9216
    ds_read_b128 v[92:95], v4 offset:8192
    ds_read_b128 v[96:99], v4 offset:9216
    ds_read_b128 v[100:103], v5 offset:8192
    ds_read_b128 v[104:107], v5 offset:9216
    ds_read_b128 v[108:111], v2 offset:16384
    ds_read_b128 v[112:115], v2 offset:17408
    ds_read_b128 v[116:119], v3 offset:16384
    ds_read_b128 v[120:123], v3 offset:17408
    ds_read_b128 v[124:127], v4 offset:16384
    ds_read_b128 v[128:131], v4 offset:17408
    ds_read_b128 v[132:135], v5 offset:16384
    ds_read_b128 v[136:139], v5 offset:17408
    ds_read_b128 v[140:143], v2 offset:24576
    ds_read_b128 v[144:147], v2 offset:25600
    ds_read_b128 v[148:151], v3 offset:24576
    ds_read_b128 v[152:155], v3 offset:25600
    ds_read_b128 v[156:159], v4 offset:24576
    ds_read_b128 v[160:163], v4 offset:25600
    ds_read_b128 v[164:167], v5 offset:24576
    ds_read_b128 v[168:171], v5 offset:25600
    s_waitcnt lgkmcnt(15)
    v_pk_add_f32 v[44:45], v[44:45], v[52:53]
    v_pk_add_f32 v[60:61], v[60:61], v[68:69]
    v_pk_add_f32 v[46:47], v[46:47], v[54:55]
    v_pk_add_f32 v[62:63], v[62:63], v[70:71]
    v_pk_add_f32 v[48:49], v[48:49], v[56:57]
    v_pk_add_f32 v[64:65], v[64:65], v[72:73]
    v_pk_add_f32 v[50:51], v[50:51], v[58:59]
    v_pk_add_f32 v[66:67], v[66:67], v[74:75]
    v_pk_add_f32 v[44:45], v[44:45], v[60:61]
    v_pk_add_f32 v[46:47], v[46:47], v[62:63]
    v_pk_add_f32 v[48:49], v[48:49], v[64:65]
    v_pk_add_f32 v[50:51], v[50:51], v[66:67]
    v_cvt_pk_bf16_f32 v52, v44, v45
    v_cvt_pk_bf16_f32 v53, v46, v47
    v_cvt_pk_bf16_f32 v54, v48, v49
    v_cvt_pk_bf16_f32 v55, v50, v51
    s_add_u32 s22, s20, 20
    s_mul_i32 s23, s22, 9363
    s_lshr_b32 s23, s23, 16
    v_permlane16_swap_b32 v52, v54
    v_permlane16_swap_b32 v53, v55
    s_mul_i32 s30, s23, 7
    s_sub_u32 s30, s22, s30
    s_mul_i32 s30, s30, 40960
    s_lshl_b32 s23, s23, 6
    s_add_u32 s30, s30, s23
    s_add_u32 s30, s30, s24
    buffer_store_dwordx4 v[52:55], v9, s[12:15], s30 offen sc0 sc1
    s_waitcnt lgkmcnt(15)
    v_pk_add_f32 v[76:77], v[76:77], v[84:85]
    v_pk_add_f32 v[92:93], v[92:93], v[100:101]
    v_pk_add_f32 v[78:79], v[78:79], v[86:87]
    v_pk_add_f32 v[94:95], v[94:95], v[102:103]
    v_pk_add_f32 v[80:81], v[80:81], v[88:89]
    v_pk_add_f32 v[96:97], v[96:97], v[104:105]
    v_pk_add_f32 v[82:83], v[82:83], v[90:91]
    v_pk_add_f32 v[98:99], v[98:99], v[106:107]
    v_pk_add_f32 v[76:77], v[76:77], v[92:93]
    v_pk_add_f32 v[78:79], v[78:79], v[94:95]
    v_pk_add_f32 v[80:81], v[80:81], v[96:97]
    v_pk_add_f32 v[82:83], v[82:83], v[98:99]
    v_cvt_pk_bf16_f32 v84, v76, v77
    v_cvt_pk_bf16_f32 v85, v78, v79
    v_cvt_pk_bf16_f32 v86, v80, v81
    v_cvt_pk_bf16_f32 v87, v82, v83
    s_add_u32 s22, s20, 24
    s_mul_i32 s23, s22, 9363
    s_lshr_b32 s23, s23, 16
    v_permlane16_swap_b32 v84, v86
    v_permlane16_swap_b32 v85, v87
    s_mul_i32 s30, s23, 7
    s_sub_u32 s30, s22, s30
    s_mul_i32 s30, s30, 40960
    s_lshl_b32 s23, s23, 6
    s_add_u32 s30, s30, s23
    s_add_u32 s30, s30, s24
    buffer_store_dwordx4 v[84:87], v9, s[12:15], s30 offen sc0 sc1
    s_waitcnt lgkmcnt(8)
    v_pk_add_f32 v[108:109], v[108:109], v[116:117]
    v_pk_add_f32 v[124:125], v[124:125], v[132:133]
    v_pk_add_f32 v[110:111], v[110:111], v[118:119]
    v_pk_add_f32 v[126:127], v[126:127], v[134:135]
    v_pk_add_f32 v[112:113], v[112:113], v[120:121]
    v_pk_add_f32 v[128:129], v[128:129], v[136:137]
    v_pk_add_f32 v[114:115], v[114:115], v[122:123]
    v_pk_add_f32 v[130:131], v[130:131], v[138:139]
    v_pk_add_f32 v[108:109], v[108:109], v[124:125]
    v_pk_add_f32 v[110:111], v[110:111], v[126:127]
    v_pk_add_f32 v[112:113], v[112:113], v[128:129]
    v_pk_add_f32 v[114:115], v[114:115], v[130:131]
    v_cvt_pk_bf16_f32 v116, v108, v109
    v_cvt_pk_bf16_f32 v117, v110, v111
    v_cvt_pk_bf16_f32 v118, v112, v113
    v_cvt_pk_bf16_f32 v119, v114, v115
    s_add_u32 s22, s20, 28
    s_mul_i32 s23, s22, 9363
    s_lshr_b32 s23, s23, 16
    v_permlane16_swap_b32 v116, v118
    v_permlane16_swap_b32 v117, v119
    s_mul_i32 s30, s23, 7
    s_sub_u32 s30, s22, s30
    s_mul_i32 s30, s30, 40960
    s_lshl_b32 s23, s23, 6
    s_add_u32 s30, s30, s23
    s_add_u32 s30, s30, s24
    buffer_store_dwordx4 v[116:119], v9, s[12:15], s30 offen sc0 sc1
    s_waitcnt lgkmcnt(0)
    v_pk_add_f32 v[140:141], v[140:141], v[148:149]
    v_pk_add_f32 v[156:157], v[156:157], v[164:165]
    v_pk_add_f32 v[142:143], v[142:143], v[150:151]
    v_pk_add_f32 v[158:159], v[158:159], v[166:167]
    v_pk_add_f32 v[144:145], v[144:145], v[152:153]
    v_pk_add_f32 v[160:161], v[160:161], v[168:169]
    v_pk_add_f32 v[146:147], v[146:147], v[154:155]
    v_pk_add_f32 v[162:163], v[162:163], v[170:171]
    v_pk_add_f32 v[140:141], v[140:141], v[156:157]
    v_pk_add_f32 v[142:143], v[142:143], v[158:159]
    v_pk_add_f32 v[144:145], v[144:145], v[160:161]
    v_pk_add_f32 v[146:147], v[146:147], v[162:163]
    v_cvt_pk_bf16_f32 v148, v140, v141
    v_cvt_pk_bf16_f32 v149, v142, v143
    v_cvt_pk_bf16_f32 v150, v144, v145
    v_cvt_pk_bf16_f32 v151, v146, v147
    s_add_u32 s22, s20, 32
    s_mul_i32 s23, s22, 9363
    s_lshr_b32 s23, s23, 16
    v_permlane16_swap_b32 v148, v150
    v_permlane16_swap_b32 v149, v151
    s_mul_i32 s30, s23, 7
    s_sub_u32 s30, s22, s30
    s_mul_i32 s30, s30, 40960
    s_lshl_b32 s23, s23, 6
    s_add_u32 s30, s30, s23
    s_add_u32 s30, s30, s24
    s_cmp_ge_u32 s22, 35
    s_cselect_b32 s23, 0x40000000, 0
    s_add_u32 s30, s30, s23
    buffer_store_dwordx4 v[148:151], v9, s[12:15], s30 offen sc0 sc1
L_op_end:
    s_endpgm
L_code_end:
.section .rodata,"a"
.p2align 6
.amdhsa_kernel fused_kernel
  .amdhsa_next_free_vgpr 512
  .amdhsa_next_free_sgpr 102
  .amdhsa_accum_offset 256
  .amdhsa_group_segment_fixed_size 0
  .amdhsa_kernarg_size 104
  .amdhsa_user_sgpr_count 2
  .amdhsa_user_sgpr_kernarg_segment_ptr 1
  .amdhsa_system_sgpr_workgroup_id_x 1
.end_amdhsa_kernel
.p2align 6
.amdhsa_kernel op_kernel
  .amdhsa_next_free_vgpr 512
  .amdhsa_next_free_sgpr 102
  .amdhsa_accum_offset 256
  .amdhsa_group_segment_fixed_size 0
  .amdhsa_kernarg_size 104
  .amdhsa_user_sgpr_count 2
  .amdhsa_user_sgpr_kernarg_segment_ptr 1
  .amdhsa_system_sgpr_workgroup_id_x 1
.end_amdhsa_kernel
```

```asm
; @launch kernel=fused_kernel grid=(256,1,1) block=(256,1,1) lds=163840
; @launch kernel=op_kernel grid=(256,1,1) block=(256,1,1) lds=163840
.amdgcn_target "amdgcn-amd-amdhsa--gfx950"
.text
.globl fused_kernel
.p2align 8
.type fused_kernel,@function
fused_kernel:
    s_cmp_ge_u32 s2, 256
    s_cbranch_scc1 L_at_end
    s_and_b32 s3, s2, 7
    s_lshl_b32 s3, s3, 5
    s_lshr_b32 s36, s2, 6
    s_lshl_b32 s36, s36, 3
    s_or_b32 s3, s3, s36
    s_bfe_u32 s36, s2, 0x30003
    s_or_b32 s2, s3, s36
    s_load_dwordx8 s[36:43], s[0:1], 0
    s_load_dwordx8 s[56:63], s[0:1], 40
    s_load_dwordx2 s[44:45], s[0:1], 96
    s_load_dwordx2 s[84:85], s[0:1], 32
    s_load_dwordx2 s[86:87], s[0:1], 72
    s_getpc_b64 s[72:73]
L_pc0:
    v_lshlrev_b32 v105, 7, v0
    v_add_u32 v104, 0, v105
    v_min_u32 v104, L_code_end - L_pc0 - 4, v104
    v_mov_b32 v107, s73
    v_add_co_u32 v106, vcc, s72, v104
    v_addc_co_u32 v107, vcc, 0, v107, vcc
    global_load_dword v108, v[106:107], off
    v_add_u32 v104, 32768, v105
    v_min_u32 v104, L_code_end - L_pc0 - 4, v104
    v_mov_b32 v107, s73
    v_add_co_u32 v106, vcc, s72, v104
    v_addc_co_u32 v107, vcc, 0, v107, vcc
    global_load_dword v108, v[106:107], off
    v_add_u32 v104, 65536, v105
    v_min_u32 v104, L_code_end - L_pc0 - 4, v104
    v_mov_b32 v107, s73
    v_add_co_u32 v106, vcc, s72, v104
    v_addc_co_u32 v107, vcc, 0, v107, vcc
    global_load_dword v108, v[106:107], off
    v_and_b32 v1, 63, v0
    v_lshrrev_b32 v2, 6, v0
    s_nop 0
    v_readfirstlane_b32 s20, v2
    s_waitcnt lgkmcnt(0)
    s_and_b32 s48, s20, 1
    s_lshr_b32 s35, s20, 1
    s_cmp_ge_u32 s2, 128
    s_cselect_b32 s36, s56, s36
    s_cselect_b32 s37, s57, s37
    s_cselect_b32 s38, s58, s38
    s_cselect_b32 s39, s59, s39
    s_cselect_b32 s40, s60, s40
    s_cselect_b32 s41, s61, s41
    s_cselect_b32 s42, s62, s42
    s_cselect_b32 s43, s63, s43
    s_cselect_b32 s84, s86, s84
    s_cselect_b32 s85, s87, s85
    s_mov_b32 s86, 5242880
    s_mov_b32 s87, 0x20000
    s_and_b32 s28, s2, 127
    s_lshl_b32 s29, s28, 20
    s_lshl_b32 s30, s35, 18
    s_add_u32 s29, s29, s30
    s_add_u32 s38, s38, s29
    s_addc_u32 s39, s39, 0
    s_add_u32 s40, s40, s29
    s_addc_u32 s41, s41, 0
    s_sub_u32 s30, 0x100000, s30
    s_mov_b32 s8, s38
    s_mov_b32 s9, s39
    s_mov_b32 s10, s30
    s_mov_b32 s11, 0x20000
    s_cmp_eq_u32 s48, 0
    s_cselect_b32 s4, s38, s40
    s_cselect_b32 s5, s39, s41
    s_mov_b32 s6, s30
    s_mov_b32 s7, 0x20000
    s_cselect_b32 s16, s42, s36
    s_cselect_b32 s17, s43, s37
    s_mov_b32 s28, 5242880
    s_mov_b32 s29, 4587520
    s_cselect_b32 s18, s28, s29
    s_mov_b32 s19, 0x20000
    s_mov_b32 s28, 262144
    s_mov_b32 s29, 64
    s_cselect_b32 s51, s28, s29
    s_cselect_b32 s52, 512, 0
    s_mov_b32 s28, 1056
    s_mov_b32 s29, 1024
    s_cselect_b32 s53, s28, s29
    s_mov_b32 s28, 0
    s_mov_b32 s29, 0
    s_cselect_b32 s88, s28, s29
    s_mov_b32 s28, 8192
    s_mov_b32 s29, 20480
    s_cselect_b32 s89, s28, s29
    s_mov_b32 s28, 16384
    s_mov_b32 s29, 40960
    s_cselect_b32 s90, s28, s29
    s_mov_b32 s28, 24576
    s_mov_b32 s29, 61440
    s_cselect_b32 s91, s28, s29
    s_mov_b32 s28, 65536
    s_mov_b32 s29, 81920
    s_cselect_b32 s92, s28, s29
    s_mov_b32 s28, 73728
    s_mov_b32 s29, 102400
    s_cselect_b32 s93, s28, s29
    s_mov_b32 s28, 81920
    s_mov_b32 s29, 122880
    s_cselect_b32 s94, s28, s29
    s_mov_b32 s28, 90112
    s_mov_b32 s29, 1073741824
    s_cselect_b32 s95, s28, s29
    s_and_b32 s28, s2, 7
    s_lshl_b32 s28, s28, 2
    s_add_u32 s28, s28, s35
    s_lshl_b32 s28, s28, 8
    s_bfe_u32 s29, s2, 262147
    s_lshl_b32 s29, s29, 1
    s_add_u32 s29, s29, s35
    s_mul_i32 s29, s29, 143360
    s_cmp_eq_u32 s48, 0
    s_cselect_b32 s55, s28, s29
    s_add_u32 s12, s44, 0
    s_addc_u32 s13, s45, 0
    s_mov_b32 s14, 127926272
    s_mov_b32 s15, 0x20000
    s_lshl_b32 s28, s2, 2
    s_add_u32 s28, s28, s35
    s_mul_i32 s24, s28, 57344
    s_mul_i32 s28, s48, 28672
    s_add_u32 s24, s24, s28
    s_add_u32 s24, s24, 58720256
    s_mov_b32 s23, -1
    s_mov_b32 s60, s42
    s_mov_b32 s61, s43
    s_mov_b32 s62, 5242880
    s_mov_b32 s63, 0x20000
    s_mov_b32 s27, 0
    s_mov_b32 s25, 0
    s_mov_b32 s68, 0
    s_mov_b32 s71, 0
    s_lshr_b32 s26, s2, 3
    s_lshr_b32 s28, s2, 1
    s_add_u32 s26, s26, s28
    s_and_b32 s26, s26, 3
    s_mul_i32 s26, s26, 5
    s_mul_i32 s83, s51, 20
    s_and_b32 s69, s2, 1
    s_min_u32 s69, s69, 1
    s_bfe_u32 s3, s2, 0x10005
    s_xor_b32 s3, s3, 1
    s_and_b32 s69, s2, s3
    s_nop 0
    s_mov_b32 s70, s69
    s_mov_b32 s32, 0x4e800000
    s_mov_b32 s54, 0x3e0293ee
    s_lshl_b32 s28, s48, 1
    s_add_u32 s28, s28, s35
    s_mul_i32 s33, s28, 33792
    v_lshlrev_b32 v6, 4, v1
    v_lshrrev_b32 v2, 4, v1
    v_and_b32 v3, 15, v1
    v_lshlrev_b32 v4, 4, v3
    v_lshl_add_u32 v7, v2, 14, v4
    v_bfe_u32 v5, v1, 4, 1
    v_lshl_add_u32 v26, v5, 15, v4
    v_bfe_u32 v5, v1, 5, 1
    v_lshl_add_u32 v26, v5, 17, v26
    v_mul_u32_u24 v27, 1280, v3
    v_lshl_add_u32 v27, v2, 4, v27
    v_lshrrev_b32 v5, 4, v1
    v_and_b32 v27, 1, v5
    v_lshlrev_b32 v27, 1, v27
    v_lshrrev_b32 v5, 1, v5
    v_mul_u32_u24 v5, 3, v5
    v_xor_b32 v27, v27, v5
    v_and_b32 v5, 3, v1
    v_xor_b32 v27, v27, v5
    v_lshlrev_b32 v27, 4, v27
    v_lshrrev_b32 v5, 2, v1
    v_mul_u32_u24 v5, 1280, v5
    v_add_u32 v27, v27, v5
    s_cmp_eq_u32 s48, 0
    s_cselect_b64 vcc, -1, 0
    s_nop 1
    v_cndmask_b32 v26, v27, v26, vcc
    s_add_u32 s28, s48, 2
    s_mul_i32 s28, s28, 33792
    v_bfe_u32 v5, v1, 2, 2
    v_and_b32 v27, 1, v5
    v_lshlrev_b32 v27, 1, v27
    v_lshrrev_b32 v5, 1, v5
    v_mul_u32_u24 v5, 3, v5
    v_xor_b32 v27, v27, v5
    v_xor_b32 v27, v27, v2
    v_lshlrev_b32 v27, 4, v27
    v_lshl_add_u32 v27, v3, 6, v27
    v_add_u32 v27, s28, v27
    v_bfe_u32 v5, v1, 4, 1
    v_lshl_add_u32 v4, v5, 9, v4
    v_bfe_u32 v5, v1, 5, 1
    v_lshl_add_u32 v10, v5, 8, v4
    v_and_b32 v4, 7, v3
    v_lshlrev_b32 v8, 10, v4
    v_and_b32 v5, 1, v3
    v_lshl_add_u32 v8, v5, 4, v8
    v_bfe_u32 v5, v3, 1, 2
    v_lshl_add_u32 v8, v5, 6, v8
    v_lshrrev_b32 v5, 3, v3
    v_lshl_add_u32 v8, v5, 8, v8
    v_bfe_u32 v5, v1, 4, 1
    v_lshl_add_u32 v8, v5, 5, v8
    v_bfe_u32 v5, v1, 5, 1
    v_lshl_add_u32 v8, v5, 4, v8
    s_mul_i32 s28, s35, 33792
    v_add_u32 v8, s28, v8
    v_bfe_u32 v3, v1, 2, 2
    v_bfe_u32 v5, v1, 4, 1
    v_lshl_add_u32 v4, v5, 2, v3
    v_mul_u32_u24 v4, 1056, v4
    v_bfe_u32 v5, v1, 5, 1
    v_lshl_add_u32 v4, v5, 9, v4
    v_and_b32 v5, 3, v1
    v_lshl_add_u32 v4, v5, 3, v4
    v_add_u32 v11, s28, v4
    v_lshl_add_u32 v3, v2, 2, v3
    v_and_b32 v4, 7, v3
    v_mul_u32_u24 v4, 1056, v4
    v_lshrrev_b32 v5, 3, v3
    v_lshl_add_u32 v4, v5, 8, v4
    v_and_b32 v5, 3, v1
    v_lshl_add_u32 v4, v5, 3, v4
    s_add_u32 s28, s28, 67584
    v_add_u32 v9, s28, v4
    v_mov_b32 v12, 0xff800000
    v_mov_b32 v14, 0xff800000
    v_mov_b32 v16, 0xff800000
    v_mov_b32 v18, 0xff800000
    v_mov_b32 v20, 0xff800000
    v_mov_b32 v22, 0xff800000
    v_mov_b32 v24, 0xff800000
    v_mov_b32 v2, 0x3f803f80
    v_accvgpr_write_b32 a252, v2
    v_accvgpr_write_b32 a253, v2
    v_accvgpr_write_b32 a254, v2
    v_accvgpr_write_b32 a255, v2
    v_and_b32 v2, 3, v1
    v_lshlrev_b32 v2, 2, v2
    v_add_u32 v2, 76000, v2
    v_mov_b32 v3, 0
    ds_write_b32 v2, v3
    s_cmp_eq_u32 s48, 0
    s_mov_b32 s28, 784
    s_mov_b32 s29, 800
    s_cselect_b32 s96, s28, s29
    s_mov_b32 s28, 816
    s_cselect_b32 s97, s28, s29
    v_lshrrev_b32 v2, 1, v1
    v_lshlrev_b32 v2, 13, v2
    v_and_b32 v3, 1, v1
    v_lshl_add_u32 v2, v3, 7, v2
    v_lshlrev_b32 v3, 7, v1
    s_bfe_u32 s28, s2, 0x20003
    s_lshl_b32 s28, s28, 18
    s_and_b32 s29, s2, 7
    s_mul_i32 s29, s29, 17920
    s_cmp_eq_u32 s48, 0
    s_cselect_b64 vcc, -1, 0
    s_cselect_b32 s100, s28, s29
    s_add_u32 s100, s100, s55
    s_cmp_eq_u32 s48, 0
    s_mov_b32 s28, 1048576
    s_mov_b32 s29, 8192
    s_cselect_b32 s99, s28, s29
    v_cndmask_b32 v6, v3, v2, vcc
    s_mul_i32 s100, s2, 11
    s_lshr_b32 s28, s2, 5
    s_mul_i32 s28, s28, 7
    s_add_u32 s100, s100, s28
    s_lshl_b32 s28, s35, 4
    s_add_u32 s100, s100, s28
    s_and_b32 s100, s100, 31
L_at_start:
    s_mov_b32 s21, s27
    s_lshl_b32 s34, s27, 5
    s_add_u32 s31, s21, s70
    s_mul_i32 s50, s31, s52
    s_mov_b32 s101, s31
    s_add_u32 s50, s50, s55
    s_cmp_ge_u32 s31, 2
    s_cselect_b32 s28, 0x40000000, 0
    s_add_u32 s50, s50, s28
    s_mov_b32 s82, s26
    s_mul_i32 s28, s26, s51
    s_add_u32 s50, s50, s28
    s_add_u32 m0, s33, 0
    s_mov_b32 s49, s50
    s_add_u32 s50, s50, s51
    s_add_u32 s82, s82, 1
    s_cmp_eq_u32 s82, 20
    s_cselect_b32 s29, s83, 0
    s_sub_u32 s50, s50, s29
    s_add_u32 s28, s49, s88
    buffer_load_dwordx4 v26, s[16:19], s28 offen lds
    s_add_u32 m0, m0, s53
    s_add_u32 s28, s49, s89
    buffer_load_dwordx4 v26, s[16:19], s28 offen lds
    s_add_u32 m0, m0, s53
    s_add_u32 s28, s49, s90
    buffer_load_dwordx4 v26, s[16:19], s28 offen lds
    s_add_u32 m0, m0, s53
    s_add_u32 s28, s49, s91
    buffer_load_dwordx4 v26, s[16:19], s28 offen lds
    s_add_u32 m0, m0, s53
    s_add_u32 s28, s49, s92
    buffer_load_dwordx4 v26, s[16:19], s28 offen lds
    s_add_u32 m0, m0, s53
    s_add_u32 s28, s49, s93
    buffer_load_dwordx4 v26, s[16:19], s28 offen lds
    s_add_u32 m0, m0, s53
    s_add_u32 s28, s49, s94
    buffer_load_dwordx4 v26, s[16:19], s28 offen lds
    s_add_u32 m0, m0, s53
    s_add_u32 s28, s49, s95
    buffer_load_dwordx4 v26, s[16:19], s28 offen lds
    s_add_u32 m0, s33, 8448
    s_mov_b32 s49, s50
    s_add_u32 s50, s50, s51
    s_add_u32 s82, s82, 1
    s_cmp_eq_u32 s82, 20
    s_cselect_b32 s29, s83, 0
    s_sub_u32 s50, s50, s29
    s_add_u32 s28, s49, s88
    buffer_load_dwordx4 v26, s[16:19], s28 offen lds
    s_add_u32 m0, m0, s53
    s_add_u32 s28, s49, s89
    buffer_load_dwordx4 v26, s[16:19], s28 offen lds
    s_add_u32 m0, m0, s53
    s_add_u32 s28, s49, s90
    buffer_load_dwordx4 v26, s[16:19], s28 offen lds
    s_add_u32 m0, m0, s53
    s_add_u32 s28, s49, s91
    buffer_load_dwordx4 v26, s[16:19], s28 offen lds
    s_add_u32 m0, m0, s53
    s_add_u32 s28, s49, s92
    buffer_load_dwordx4 v26, s[16:19], s28 offen lds
    s_add_u32 m0, m0, s53
    s_add_u32 s28, s49, s93
    buffer_load_dwordx4 v26, s[16:19], s28 offen lds
    s_add_u32 m0, m0, s53
    s_add_u32 s28, s49, s94
    buffer_load_dwordx4 v26, s[16:19], s28 offen lds
    s_add_u32 m0, m0, s53
    s_add_u32 s28, s49, s95
    buffer_load_dwordx4 v26, s[16:19], s28 offen lds
    s_add_u32 m0, s33, 16896
    s_mov_b32 s49, s50
    s_add_u32 s50, s50, s51
    s_add_u32 s82, s82, 1
    s_cmp_eq_u32 s82, 20
    s_cselect_b32 s29, s83, 0
    s_sub_u32 s50, s50, s29
    s_add_u32 s28, s49, s88
    buffer_load_dwordx4 v26, s[16:19], s28 offen lds
    s_add_u32 m0, m0, s53
    s_add_u32 s28, s49, s89
    buffer_load_dwordx4 v26, s[16:19], s28 offen lds
    s_add_u32 m0, m0, s53
    s_add_u32 s28, s49, s90
    buffer_load_dwordx4 v26, s[16:19], s28 offen lds
    s_add_u32 m0, m0, s53
    s_add_u32 s28, s49, s91
    buffer_load_dwordx4 v26, s[16:19], s28 offen lds
    s_add_u32 m0, m0, s53
    s_add_u32 s28, s49, s92
    buffer_load_dwordx4 v26, s[16:19], s28 offen lds
    s_add_u32 m0, m0, s53
    s_add_u32 s28, s49, s93
    buffer_load_dwordx4 v26, s[16:19], s28 offen lds
    s_add_u32 m0, m0, s53
    s_add_u32 s28, s49, s94
    buffer_load_dwordx4 v26, s[16:19], s28 offen lds
    s_add_u32 m0, m0, s53
    s_add_u32 s28, s49, s95
    buffer_load_dwordx4 v26, s[16:19], s28 offen lds
    s_add_u32 m0, s33, 25344
    s_mov_b32 s49, s50
    s_add_u32 s50, s50, s51
    s_add_u32 s82, s82, 1
    s_cmp_eq_u32 s82, 20
    s_cselect_b32 s29, s83, 0
    s_sub_u32 s50, s50, s29
    s_add_u32 s28, s49, s88
    buffer_load_dwordx4 v26, s[16:19], s28 offen lds
    s_add_u32 m0, m0, s53
    s_add_u32 s28, s49, s89
    buffer_load_dwordx4 v26, s[16:19], s28 offen lds
    s_add_u32 m0, m0, s53
    s_add_u32 s28, s49, s90
    buffer_load_dwordx4 v26, s[16:19], s28 offen lds
    s_add_u32 m0, m0, s53
    s_add_u32 s28, s49, s91
    buffer_load_dwordx4 v26, s[16:19], s28 offen lds
    s_add_u32 m0, m0, s53
    s_add_u32 s28, s49, s92
    buffer_load_dwordx4 v26, s[16:19], s28 offen lds
    s_add_u32 m0, m0, s53
    s_add_u32 s28, s49, s93
    buffer_load_dwordx4 v26, s[16:19], s28 offen lds
    s_add_u32 m0, m0, s53
    s_add_u32 s28, s49, s94
    buffer_load_dwordx4 v26, s[16:19], s28 offen lds
    s_add_u32 m0, m0, s53
    s_add_u32 s28, s49, s95
    buffer_load_dwordx4 v26, s[16:19], s28 offen lds
    s_and_b32 s56, s2, 127
    s_mul_i32 s56, s56, 40960
    s_mul_i32 s58, s20, 320
    s_add_u32 s56, s56, s58
    s_mul_i32 s58, s20, 7168
    s_add_u32 s58, s58, 135168
    s_mov_b32 s28, 6554
    v_add_u32 v2, 0, v1
    v_mul_u32_u24 v3, s28, v2
    v_lshrrev_b32 v3, 16, v3
    v_mul_u32_u24 v4, 10, v3
    v_sub_u32 v4, v2, v4
    v_mul_u32_u24 v3, 1280, v3
    v_lshl_add_u32 v5, v4, 4, v3
    v_accvgpr_write_b32 a244, v5
    v_add_u32 v2, 64, v1
    v_mul_u32_u24 v3, s28, v2
    v_lshrrev_b32 v3, 16, v3
    v_mul_u32_u24 v4, 10, v3
    v_sub_u32 v4, v2, v4
    v_mul_u32_u24 v3, 1280, v3
    v_lshl_add_u32 v5, v4, 4, v3
    v_accvgpr_write_b32 a245, v5
    v_add_u32 v2, 128, v1
    v_mul_u32_u24 v3, s28, v2
    v_lshrrev_b32 v3, 16, v3
    v_mul_u32_u24 v4, 10, v3
    v_sub_u32 v4, v2, v4
    v_mul_u32_u24 v3, 1280, v3
    v_lshl_add_u32 v5, v4, 4, v3
    v_accvgpr_write_b32 a246, v5
    v_add_u32 v2, 192, v1
    v_mul_u32_u24 v3, s28, v2
    v_lshrrev_b32 v3, 16, v3
    v_mul_u32_u24 v4, 10, v3
    v_sub_u32 v4, v2, v4
    v_mul_u32_u24 v3, 1280, v3
    v_lshl_add_u32 v5, v4, 4, v3
    v_accvgpr_write_b32 a247, v5
    v_add_u32 v2, 256, v1
    v_mul_u32_u24 v3, s28, v2
    v_lshrrev_b32 v3, 16, v3
    v_mul_u32_u24 v4, 10, v3
    v_sub_u32 v4, v2, v4
    v_mul_u32_u24 v3, 1280, v3
    v_lshl_add_u32 v5, v4, 4, v3
    v_accvgpr_write_b32 a248, v5
    v_lshrrev_b32 v2, 4, v1
    v_bfe_u32 v3, v1, 2, 2
    v_lshl_add_u32 v3, v2, 3, v3
    v_mul_u32_u24 v3, 160, v3
    v_and_b32 v4, 3, v1
    v_lshl_add_u32 v3, v4, 3, v3
    v_add_u32 v3, s58, v3
    v_accvgpr_write_b32 a249, v3
    s_waitcnt vmcnt(24) lgkmcnt(0)
    s_barrier
L_at_round:
    ds_read_b64_tr_b16 v[112:113], v11 offset:0
    ds_read_b64_tr_b16 v[114:115], v11 offset:256
    ds_read_b64_tr_b16 v[116:117], v11 offset:32
    ds_read_b64_tr_b16 v[118:119], v11 offset:288
    ds_read_b64_tr_b16 v[120:121], v11 offset:64
    ds_read_b64_tr_b16 v[122:123], v11 offset:320
    ds_read_b64_tr_b16 v[124:125], v11 offset:96
    ds_read_b64_tr_b16 v[126:127], v11 offset:352
    ds_read_b64_tr_b16 v[128:129], v11 offset:128
    ds_read_b64_tr_b16 v[130:131], v11 offset:384
    ds_read_b64_tr_b16 v[132:133], v11 offset:160
    ds_read_b64_tr_b16 v[134:135], v11 offset:416
    ds_read_b64_tr_b16 v[136:137], v11 offset:192
    ds_read_b64_tr_b16 v[138:139], v11 offset:448
    ds_read_b64_tr_b16 v[140:141], v11 offset:224
    ds_read_b64_tr_b16 v[142:143], v11 offset:480
    ds_read_b128 v[56:59], v27 offset:0
    ds_read_b128 v[60:63], v27 offset:1024
    ds_read_b128 v[64:67], v27 offset:2048
    ds_read_b128 v[68:71], v27 offset:3072
    ds_read_b128 v[72:75], v27 offset:4096
    ds_read_b128 v[76:79], v27 offset:5120
    ds_read_b128 v[80:83], v27 offset:6144
    s_waitcnt lgkmcnt(0)
    s_waitcnt lgkmcnt(14)
    v_mfma_f32_16x16x32_bf16 v[144:147], v[112:115], v[56:59], 0
    s_add_u32 m0, s33, 0
    v_mfma_f32_16x16x32_bf16 v[148:151], v[112:115], v[60:63], 0
    s_mov_b32 s49, s50
    v_mfma_f32_16x16x32_bf16 v[152:155], v[112:115], v[64:67], 0
    s_add_u32 s50, s50, s51
    v_mfma_f32_16x16x32_bf16 v[156:159], v[112:115], v[68:71], 0
    s_add_u32 s82, s82, 1
    v_mfma_f32_16x16x32_bf16 v[160:163], v[112:115], v[72:75], 0
    s_cmp_eq_u32 s82, 20
    v_mfma_f32_16x16x32_bf16 v[164:167], v[112:115], v[76:79], 0
    s_cselect_b32 s29, s83, 0
    v_mfma_f32_16x16x32_bf16 v[168:171], v[112:115], v[80:83], 0
    s_sub_u32 s50, s50, s29
    s_cmp_eq_u32 s68, 0
    s_cbranch_scc0 L_bw1_510
    s_waitcnt vmcnt(16) lgkmcnt(0)
L_bw2_510:
    s_barrier
    s_cmp_le_u32 s21, s27
    s_cbranch_scc1 L_at_nofb_515
    s_sub_u32 s28, s21, 1
    s_cmp_eq_u32 s28, s23
    s_cbranch_scc1 L_at_nofb_515
    s_lshl_b32 s29, s28, 2
    s_add_u32 s29, s29, 76000
    v_mov_b32 v4, s29
    ds_read_b32 v4, v4
    s_waitcnt lgkmcnt(0)
    v_readfirstlane_b32 s29, v4
    s_nop 3
    s_cmp_lg_u32 s29, 0
    s_cbranch_scc1 L_at_fallback
L_at_nofb_515:
    ds_read_b64_tr_b16 v[112:113], v11 offset:8448
    v_mfma_f32_16x16x32_bf16 v[172:175], v[116:119], v[56:59], 0
    ds_read_b64_tr_b16 v[114:115], v11 offset:8704
    v_mfma_f32_16x16x32_bf16 v[176:179], v[116:119], v[60:63], 0
    ds_read_b128 v[28:31], v27 offset:8448
    v_mfma_f32_16x16x32_bf16 v[180:183], v[116:119], v[64:67], 0
    s_add_u32 s28, s49, s88
    buffer_load_dwordx4 v26, s[16:19], s28 offen lds
    v_mfma_f32_16x16x32_bf16 v[184:187], v[116:119], v[68:71], 0
    s_add_u32 m0, m0, s53
    ds_read_b128 v[32:35], v27 offset:9472
    v_mfma_f32_16x16x32_bf16 v[188:191], v[116:119], v[72:75], 0
    ds_read_b128 v[36:39], v27 offset:10496
    v_mfma_f32_16x16x32_bf16 v[192:195], v[116:119], v[76:79], 0
    ds_read_b128 v[40:43], v27 offset:11520
    v_mfma_f32_16x16x32_bf16 v[196:199], v[116:119], v[80:83], 0
    ds_read_b128 v[44:47], v27 offset:12544
    v_mfma_f32_16x16x32_bf16 v[200:203], v[120:123], v[56:59], 0
    ds_read_b128 v[48:51], v27 offset:13568
    v_mfma_f32_16x16x32_bf16 v[204:207], v[120:123], v[60:63], 0
    s_add_u32 s28, s49, s89
    buffer_load_dwordx4 v26, s[16:19], s28 offen lds
    v_mfma_f32_16x16x32_bf16 v[208:211], v[120:123], v[64:67], 0
    s_add_u32 m0, m0, s53
    ds_read_b128 v[52:55], v27 offset:14592
    v_mfma_f32_16x16x32_bf16 v[212:215], v[120:123], v[68:71], 0
    ds_read_b64_tr_b16 v[116:117], v11 offset:8480
    v_mfma_f32_16x16x32_bf16 v[216:219], v[120:123], v[72:75], 0
    ds_read_b64_tr_b16 v[118:119], v11 offset:8736
    v_mfma_f32_16x16x32_bf16 v[220:223], v[120:123], v[76:79], 0
    v_mfma_f32_16x16x32_bf16 v[224:227], v[120:123], v[80:83], 0
    ds_read_b64_tr_b16 v[120:121], v11 offset:8512
    v_mfma_f32_16x16x32_bf16 v[228:231], v[124:127], v[56:59], 0
    s_add_u32 s28, s49, s90
    buffer_load_dwordx4 v26, s[16:19], s28 offen lds
    v_mfma_f32_16x16x32_bf16 v[232:235], v[124:127], v[60:63], 0
    s_add_u32 m0, m0, s53
    ds_read_b64_tr_b16 v[122:123], v11 offset:8768
    v_mfma_f32_16x16x32_bf16 v[236:239], v[124:127], v[64:67], 0
    v_mfma_f32_16x16x32_bf16 v[240:243], v[124:127], v[68:71], 0
    v_mfma_f32_16x16x32_bf16 v[244:247], v[124:127], v[72:75], 0
    v_mfma_f32_16x16x32_bf16 v[248:251], v[124:127], v[76:79], 0
    v_mfma_f32_16x16x32_bf16 v[252:255], v[124:127], v[80:83], 0
    s_add_u32 s28, s49, s91
    buffer_load_dwordx4 v26, s[16:19], s28 offen lds
    v_mfma_f32_16x16x32_bf16 a[112:115], v[128:131], v[56:59], 0
    s_add_u32 m0, m0, s53
    ds_read_b64_tr_b16 v[124:125], v11 offset:8544
    v_mfma_f32_16x16x32_bf16 a[116:119], v[128:131], v[60:63], 0
    ds_read_b64_tr_b16 v[126:127], v11 offset:8800
    v_mfma_f32_16x16x32_bf16 a[120:123], v[128:131], v[64:67], 0
    v_mfma_f32_16x16x32_bf16 a[124:127], v[128:131], v[68:71], 0
    v_mfma_f32_16x16x32_bf16 a[128:131], v[128:131], v[72:75], 0
    v_mfma_f32_16x16x32_bf16 a[132:135], v[128:131], v[76:79], 0
    s_add_u32 s28, s49, s92
    buffer_load_dwordx4 v26, s[16:19], s28 offen lds
    v_mfma_f32_16x16x32_bf16 a[136:139], v[128:131], v[80:83], 0
    s_add_u32 m0, m0, s53
    ds_read_b64_tr_b16 v[128:129], v11 offset:8576
    v_mfma_f32_16x16x32_bf16 a[140:143], v[132:135], v[56:59], 0
    ds_read_b64_tr_b16 v[130:131], v11 offset:8832
    v_mfma_f32_16x16x32_bf16 a[144:147], v[132:135], v[60:63], 0
    v_mfma_f32_16x16x32_bf16 a[148:151], v[132:135], v[64:67], 0
    v_mfma_f32_16x16x32_bf16 a[152:155], v[132:135], v[68:71], 0
    v_mfma_f32_16x16x32_bf16 a[156:159], v[132:135], v[72:75], 0
    s_add_u32 s28, s49, s93
    buffer_load_dwordx4 v26, s[16:19], s28 offen lds
    v_mfma_f32_16x16x32_bf16 a[160:163], v[132:135], v[76:79], 0
    s_add_u32 m0, m0, s53
    v_mfma_f32_16x16x32_bf16 a[164:167], v[132:135], v[80:83], 0
    ds_read_b64_tr_b16 v[132:133], v11 offset:8608
    v_mfma_f32_16x16x32_bf16 a[168:171], v[136:139], v[56:59], 0
    ds_read_b64_tr_b16 v[134:135], v11 offset:8864
    v_mfma_f32_16x16x32_bf16 a[172:175], v[136:139], v[60:63], 0
    v_mfma_f32_16x16x32_bf16 a[176:179], v[136:139], v[64:67], 0
    v_mfma_f32_16x16x32_bf16 a[180:183], v[136:139], v[68:71], 0
    s_add_u32 s28, s49, s94
    buffer_load_dwordx4 v26, s[16:19], s28 offen lds
    v_mfma_f32_16x16x32_bf16 a[184:187], v[136:139], v[72:75], 0
    s_add_u32 m0, m0, s53
    v_mfma_f32_16x16x32_bf16 a[188:191], v[136:139], v[76:79], 0
    v_mfma_f32_16x16x32_bf16 a[192:195], v[136:139], v[80:83], 0
    ds_read_b64_tr_b16 v[136:137], v11 offset:8640
    v_mfma_f32_16x16x32_bf16 a[196:199], v[140:143], v[56:59], 0
    ds_read_b64_tr_b16 v[138:139], v11 offset:8896
    v_mfma_f32_16x16x32_bf16 a[200:203], v[140:143], v[60:63], 0
    v_mfma_f32_16x16x32_bf16 a[204:207], v[140:143], v[64:67], 0
    s_add_u32 s28, s49, s95
    buffer_load_dwordx4 v26, s[16:19], s28 offen lds
    v_mfma_f32_16x16x32_bf16 a[208:211], v[140:143], v[68:71], 0
    v_mfma_f32_16x16x32_bf16 a[212:215], v[140:143], v[72:75], 0
    v_mfma_f32_16x16x32_bf16 a[216:219], v[140:143], v[76:79], 0
    v_mfma_f32_16x16x32_bf16 a[220:223], v[140:143], v[80:83], 0
    ds_read_b64_tr_b16 v[140:141], v11 offset:8672
    ds_read_b64_tr_b16 v[142:143], v11 offset:8928
    s_waitcnt lgkmcnt(14)
    v_mfma_f32_16x16x32_bf16 v[144:147], v[112:115], v[28:31], v[144:147]
    s_add_u32 m0, s33, 8448
    v_mfma_f32_16x16x32_bf16 v[148:151], v[112:115], v[32:35], v[148:151]
    s_mov_b32 s49, s50
    v_mfma_f32_16x16x32_bf16 v[152:155], v[112:115], v[36:39], v[152:155]
    s_add_u32 s50, s50, s51
    v_mfma_f32_16x16x32_bf16 v[156:159], v[112:115], v[40:43], v[156:159]
    s_add_u32 s82, s82, 1
    v_mfma_f32_16x16x32_bf16 v[160:163], v[112:115], v[44:47], v[160:163]
    s_cmp_eq_u32 s82, 20
    v_mfma_f32_16x16x32_bf16 v[164:167], v[112:115], v[48:51], v[164:167]
    s_cselect_b32 s29, s83, 0
    v_mfma_f32_16x16x32_bf16 v[168:171], v[112:115], v[52:55], v[168:171]
    s_sub_u32 s50, s50, s29
    s_cmp_eq_u32 s68, 0
    s_cbranch_scc0 L_bw1_640
    s_waitcnt vmcnt(16) lgkmcnt(0)
L_bw2_640:
    s_barrier
    ds_read_b64_tr_b16 v[112:113], v11 offset:16896
    v_mfma_f32_16x16x32_bf16 v[172:175], v[116:119], v[28:31], v[172:175]
    ds_read_b64_tr_b16 v[114:115], v11 offset:17152
    v_mfma_f32_16x16x32_bf16 v[176:179], v[116:119], v[32:35], v[176:179]
    ds_read_b128 v[56:59], v27 offset:16896
    v_mfma_f32_16x16x32_bf16 v[180:183], v[116:119], v[36:39], v[180:183]
    s_add_u32 s28, s49, s88
    buffer_load_dwordx4 v26, s[16:19], s28 offen lds
    v_mfma_f32_16x16x32_bf16 v[184:187], v[116:119], v[40:43], v[184:187]
    s_add_u32 m0, m0, s53
    ds_read_b128 v[60:63], v27 offset:17920
    v_mfma_f32_16x16x32_bf16 v[188:191], v[116:119], v[44:47], v[188:191]
    ds_read_b128 v[64:67], v27 offset:18944
    v_mfma_f32_16x16x32_bf16 v[192:195], v[116:119], v[48:51], v[192:195]
    ds_read_b128 v[68:71], v27 offset:19968
    v_mfma_f32_16x16x32_bf16 v[196:199], v[116:119], v[52:55], v[196:199]
    ds_read_b128 v[72:75], v27 offset:20992
    v_mfma_f32_16x16x32_bf16 v[200:203], v[120:123], v[28:31], v[200:203]
    ds_read_b128 v[76:79], v27 offset:22016
    v_mfma_f32_16x16x32_bf16 v[204:207], v[120:123], v[32:35], v[204:207]
    s_add_u32 s28, s49, s89
    buffer_load_dwordx4 v26, s[16:19], s28 offen lds
    v_mfma_f32_16x16x32_bf16 v[208:211], v[120:123], v[36:39], v[208:211]
    s_add_u32 m0, m0, s53
    ds_read_b128 v[80:83], v27 offset:23040
    v_mfma_f32_16x16x32_bf16 v[212:215], v[120:123], v[40:43], v[212:215]
    ds_read_b64_tr_b16 v[116:117], v11 offset:16928
    v_mfma_f32_16x16x32_bf16 v[216:219], v[120:123], v[44:47], v[216:219]
    ds_read_b64_tr_b16 v[118:119], v11 offset:17184
    v_mfma_f32_16x16x32_bf16 v[220:223], v[120:123], v[48:51], v[220:223]
    v_mfma_f32_16x16x32_bf16 v[224:227], v[120:123], v[52:55], v[224:227]
    ds_read_b64_tr_b16 v[120:121], v11 offset:16960
    v_mfma_f32_16x16x32_bf16 v[228:231], v[124:127], v[28:31], v[228:231]
    s_add_u32 s28, s49, s90
    buffer_load_dwordx4 v26, s[16:19], s28 offen lds
    v_mfma_f32_16x16x32_bf16 v[232:235], v[124:127], v[32:35], v[232:235]
    s_add_u32 m0, m0, s53
    ds_read_b64_tr_b16 v[122:123], v11 offset:17216
    v_mfma_f32_16x16x32_bf16 v[236:239], v[124:127], v[36:39], v[236:239]
    v_mfma_f32_16x16x32_bf16 v[240:243], v[124:127], v[40:43], v[240:243]
    v_mfma_f32_16x16x32_bf16 v[244:247], v[124:127], v[44:47], v[244:247]
    v_mfma_f32_16x16x32_bf16 v[248:251], v[124:127], v[48:51], v[248:251]
    v_mfma_f32_16x16x32_bf16 v[252:255], v[124:127], v[52:55], v[252:255]
    s_add_u32 s28, s49, s91
    buffer_load_dwordx4 v26, s[16:19], s28 offen lds
    v_mfma_f32_16x16x32_bf16 a[112:115], v[128:131], v[28:31], a[112:115]
    s_add_u32 m0, m0, s53
    ds_read_b64_tr_b16 v[124:125], v11 offset:16992
    v_mfma_f32_16x16x32_bf16 a[116:119], v[128:131], v[32:35], a[116:119]
    ds_read_b64_tr_b16 v[126:127], v11 offset:17248
    v_mfma_f32_16x16x32_bf16 a[120:123], v[128:131], v[36:39], a[120:123]
    v_mfma_f32_16x16x32_bf16 a[124:127], v[128:131], v[40:43], a[124:127]
    v_mfma_f32_16x16x32_bf16 a[128:131], v[128:131], v[44:47], a[128:131]
    v_mfma_f32_16x16x32_bf16 a[132:135], v[128:131], v[48:51], a[132:135]
    s_add_u32 s28, s49, s92
    buffer_load_dwordx4 v26, s[16:19], s28 offen lds
    v_mfma_f32_16x16x32_bf16 a[136:139], v[128:131], v[52:55], a[136:139]
    s_add_u32 m0, m0, s53
    ds_read_b64_tr_b16 v[128:129], v11 offset:17024
    v_mfma_f32_16x16x32_bf16 a[140:143], v[132:135], v[28:31], a[140:143]
    ds_read_b64_tr_b16 v[130:131], v11 offset:17280
    v_mfma_f32_16x16x32_bf16 a[144:147], v[132:135], v[32:35], a[144:147]
    v_mfma_f32_16x16x32_bf16 a[148:151], v[132:135], v[36:39], a[148:151]
    v_mfma_f32_16x16x32_bf16 a[152:155], v[132:135], v[40:43], a[152:155]
    v_mfma_f32_16x16x32_bf16 a[156:159], v[132:135], v[44:47], a[156:159]
    s_add_u32 s28, s49, s93
    buffer_load_dwordx4 v26, s[16:19], s28 offen lds
    v_mfma_f32_16x16x32_bf16 a[160:163], v[132:135], v[48:51], a[160:163]
    s_add_u32 m0, m0, s53
    v_mfma_f32_16x16x32_bf16 a[164:167], v[132:135], v[52:55], a[164:167]
    ds_read_b64_tr_b16 v[132:133], v11 offset:17056
    v_mfma_f32_16x16x32_bf16 a[168:171], v[136:139], v[28:31], a[168:171]
    ds_read_b64_tr_b16 v[134:135], v11 offset:17312
    v_mfma_f32_16x16x32_bf16 a[172:175], v[136:139], v[32:35], a[172:175]
    v_mfma_f32_16x16x32_bf16 a[176:179], v[136:139], v[36:39], a[176:179]
    v_mfma_f32_16x16x32_bf16 a[180:183], v[136:139], v[40:43], a[180:183]
    s_add_u32 s28, s49, s94
    buffer_load_dwordx4 v26, s[16:19], s28 offen lds
    v_mfma_f32_16x16x32_bf16 a[184:187], v[136:139], v[44:47], a[184:187]
    s_add_u32 m0, m0, s53
    v_mfma_f32_16x16x32_bf16 a[188:191], v[136:139], v[48:51], a[188:191]
    v_mfma_f32_16x16x32_bf16 a[192:195], v[136:139], v[52:55], a[192:195]
    ds_read_b64_tr_b16 v[136:137], v11 offset:17088
    v_mfma_f32_16x16x32_bf16 a[196:199], v[140:143], v[28:31], a[196:199]
    ds_read_b64_tr_b16 v[138:139], v11 offset:17344
    v_mfma_f32_16x16x32_bf16 a[200:203], v[140:143], v[32:35], a[200:203]
    v_mfma_f32_16x16x32_bf16 a[204:207], v[140:143], v[36:39], a[204:207]
    s_add_u32 s28, s49, s95
    buffer_load_dwordx4 v26, s[16:19], s28 offen lds
    v_mfma_f32_16x16x32_bf16 a[208:211], v[140:143], v[40:43], a[208:211]
    v_mfma_f32_16x16x32_bf16 a[212:215], v[140:143], v[44:47], a[212:215]
    v_mfma_f32_16x16x32_bf16 a[216:219], v[140:143], v[48:51], a[216:219]
    v_mfma_f32_16x16x32_bf16 a[220:223], v[140:143], v[52:55], a[220:223]
    ds_read_b64_tr_b16 v[140:141], v11 offset:17120
    ds_read_b64_tr_b16 v[142:143], v11 offset:17376
    s_waitcnt lgkmcnt(14)
    v_mfma_f32_16x16x32_bf16 v[144:147], v[112:115], v[56:59], v[144:147]
    s_add_u32 m0, s33, 16896
    v_mfma_f32_16x16x32_bf16 v[148:151], v[112:115], v[60:63], v[148:151]
    s_mov_b32 s49, s50
    v_mfma_f32_16x16x32_bf16 v[152:155], v[112:115], v[64:67], v[152:155]
    s_add_u32 s50, s50, s51
    v_mfma_f32_16x16x32_bf16 v[156:159], v[112:115], v[68:71], v[156:159]
    s_add_u32 s82, s82, 1
    v_mfma_f32_16x16x32_bf16 v[160:163], v[112:115], v[72:75], v[160:163]
    s_cmp_eq_u32 s82, 20
    v_mfma_f32_16x16x32_bf16 v[164:167], v[112:115], v[76:79], v[164:167]
    s_cselect_b32 s29, s83, 0
    v_mfma_f32_16x16x32_bf16 v[168:171], v[112:115], v[80:83], v[168:171]
    s_sub_u32 s50, s50, s29
    s_cmp_eq_u32 s68, 0
    s_cbranch_scc0 L_bw1_755
    s_waitcnt vmcnt(16) lgkmcnt(0)
L_bw2_755:
    s_barrier
    ds_read_b64_tr_b16 v[112:113], v11 offset:25344
    v_mfma_f32_16x16x32_bf16 v[172:175], v[116:119], v[56:59], v[172:175]
    ds_read_b64_tr_b16 v[114:115], v11 offset:25600
    v_mfma_f32_16x16x32_bf16 v[176:179], v[116:119], v[60:63], v[176:179]
    ds_read_b128 v[28:31], v27 offset:25344
    v_mfma_f32_16x16x32_bf16 v[180:183], v[116:119], v[64:67], v[180:183]
    s_add_u32 s28, s49, s88
    buffer_load_dwordx4 v26, s[16:19], s28 offen lds
    v_mfma_f32_16x16x32_bf16 v[184:187], v[116:119], v[68:71], v[184:187]
    s_add_u32 m0, m0, s53
    ds_read_b128 v[32:35], v27 offset:26368
    v_mfma_f32_16x16x32_bf16 v[188:191], v[116:119], v[72:75], v[188:191]
    ds_read_b128 v[36:39], v27 offset:27392
    v_mfma_f32_16x16x32_bf16 v[192:195], v[116:119], v[76:79], v[192:195]
    ds_read_b128 v[40:43], v27 offset:28416
    v_mfma_f32_16x16x32_bf16 v[196:199], v[116:119], v[80:83], v[196:199]
    ds_read_b128 v[44:47], v27 offset:29440
    v_mfma_f32_16x16x32_bf16 v[200:203], v[120:123], v[56:59], v[200:203]
    ds_read_b128 v[48:51], v27 offset:30464
    v_mfma_f32_16x16x32_bf16 v[204:207], v[120:123], v[60:63], v[204:207]
    s_add_u32 s28, s49, s89
    buffer_load_dwordx4 v26, s[16:19], s28 offen lds
    v_mfma_f32_16x16x32_bf16 v[208:211], v[120:123], v[64:67], v[208:211]
    s_add_u32 m0, m0, s53
    ds_read_b128 v[52:55], v27 offset:31488
    v_mfma_f32_16x16x32_bf16 v[212:215], v[120:123], v[68:71], v[212:215]
    ds_read_b64_tr_b16 v[116:117], v11 offset:25376
    v_mfma_f32_16x16x32_bf16 v[216:219], v[120:123], v[72:75], v[216:219]
    ds_read_b64_tr_b16 v[118:119], v11 offset:25632
    v_mfma_f32_16x16x32_bf16 v[220:223], v[120:123], v[76:79], v[220:223]
    v_mfma_f32_16x16x32_bf16 v[224:227], v[120:123], v[80:83], v[224:227]
    ds_read_b64_tr_b16 v[120:121], v11 offset:25408
    v_mfma_f32_16x16x32_bf16 v[228:231], v[124:127], v[56:59], v[228:231]
    s_add_u32 s28, s49, s90
    buffer_load_dwordx4 v26, s[16:19], s28 offen lds
    v_mfma_f32_16x16x32_bf16 v[232:235], v[124:127], v[60:63], v[232:235]
    s_add_u32 m0, m0, s53
    ds_read_b64_tr_b16 v[122:123], v11 offset:25664
    v_mfma_f32_16x16x32_bf16 v[236:239], v[124:127], v[64:67], v[236:239]
    v_mfma_f32_16x16x32_bf16 v[240:243], v[124:127], v[68:71], v[240:243]
    v_mfma_f32_16x16x32_bf16 v[244:247], v[124:127], v[72:75], v[244:247]
    v_mfma_f32_16x16x32_bf16 v[248:251], v[124:127], v[76:79], v[248:251]
    v_mfma_f32_16x16x32_bf16 v[252:255], v[124:127], v[80:83], v[252:255]
    s_add_u32 s28, s49, s91
    buffer_load_dwordx4 v26, s[16:19], s28 offen lds
    v_mfma_f32_16x16x32_bf16 a[112:115], v[128:131], v[56:59], a[112:115]
    s_add_u32 m0, m0, s53
    ds_read_b64_tr_b16 v[124:125], v11 offset:25440
    v_mfma_f32_16x16x32_bf16 a[116:119], v[128:131], v[60:63], a[116:119]
    ds_read_b64_tr_b16 v[126:127], v11 offset:25696
    v_mfma_f32_16x16x32_bf16 a[120:123], v[128:131], v[64:67], a[120:123]
    v_mfma_f32_16x16x32_bf16 a[124:127], v[128:131], v[68:71], a[124:127]
    v_mfma_f32_16x16x32_bf16 a[128:131], v[128:131], v[72:75], a[128:131]
    v_mfma_f32_16x16x32_bf16 a[132:135], v[128:131], v[76:79], a[132:135]
    s_add_u32 s28, s49, s92
    buffer_load_dwordx4 v26, s[16:19], s28 offen lds
    v_mfma_f32_16x16x32_bf16 a[136:139], v[128:131], v[80:83], a[136:139]
    s_add_u32 m0, m0, s53
    ds_read_b64_tr_b16 v[128:129], v11 offset:25472
    v_mfma_f32_16x16x32_bf16 a[140:143], v[132:135], v[56:59], a[140:143]
    ds_read_b64_tr_b16 v[130:131], v11 offset:25728
    v_mfma_f32_16x16x32_bf16 a[144:147], v[132:135], v[60:63], a[144:147]
    v_mfma_f32_16x16x32_bf16 a[148:151], v[132:135], v[64:67], a[148:151]
    v_mfma_f32_16x16x32_bf16 a[152:155], v[132:135], v[68:71], a[152:155]
    v_mfma_f32_16x16x32_bf16 a[156:159], v[132:135], v[72:75], a[156:159]
    s_add_u32 s28, s49, s93
    buffer_load_dwordx4 v26, s[16:19], s28 offen lds
    v_mfma_f32_16x16x32_bf16 a[160:163], v[132:135], v[76:79], a[160:163]
    s_add_u32 m0, m0, s53
    v_mfma_f32_16x16x32_bf16 a[164:167], v[132:135], v[80:83], a[164:167]
    ds_read_b64_tr_b16 v[132:133], v11 offset:25504
    v_mfma_f32_16x16x32_bf16 a[168:171], v[136:139], v[56:59], a[168:171]
    ds_read_b64_tr_b16 v[134:135], v11 offset:25760
    v_mfma_f32_16x16x32_bf16 a[172:175], v[136:139], v[60:63], a[172:175]
    v_mfma_f32_16x16x32_bf16 a[176:179], v[136:139], v[64:67], a[176:179]
    v_mfma_f32_16x16x32_bf16 a[180:183], v[136:139], v[68:71], a[180:183]
    s_add_u32 s28, s49, s94
    buffer_load_dwordx4 v26, s[16:19], s28 offen lds
    v_mfma_f32_16x16x32_bf16 a[184:187], v[136:139], v[72:75], a[184:187]
    s_add_u32 m0, m0, s53
    v_mfma_f32_16x16x32_bf16 a[188:191], v[136:139], v[76:79], a[188:191]
    v_mfma_f32_16x16x32_bf16 a[192:195], v[136:139], v[80:83], a[192:195]
    ds_read_b64_tr_b16 v[136:137], v11 offset:25536
    v_mfma_f32_16x16x32_bf16 a[196:199], v[140:143], v[56:59], a[196:199]
    ds_read_b64_tr_b16 v[138:139], v11 offset:25792
    v_mfma_f32_16x16x32_bf16 a[200:203], v[140:143], v[60:63], a[200:203]
    v_mfma_f32_16x16x32_bf16 a[204:207], v[140:143], v[64:67], a[204:207]
    s_add_u32 s28, s49, s95
    buffer_load_dwordx4 v26, s[16:19], s28 offen lds
    v_mfma_f32_16x16x32_bf16 a[208:211], v[140:143], v[68:71], a[208:211]
    v_mfma_f32_16x16x32_bf16 a[212:215], v[140:143], v[72:75], a[212:215]
    v_mfma_f32_16x16x32_bf16 a[216:219], v[140:143], v[76:79], a[216:219]
    v_mfma_f32_16x16x32_bf16 a[220:223], v[140:143], v[80:83], a[220:223]
    ds_read_b64_tr_b16 v[140:141], v11 offset:25568
    ds_read_b64_tr_b16 v[142:143], v11 offset:25824
    s_waitcnt lgkmcnt(14)
    v_mfma_f32_16x16x32_bf16 v[144:147], v[112:115], v[28:31], v[144:147]
    s_add_u32 m0, s33, 25344
    v_mfma_f32_16x16x32_bf16 v[148:151], v[112:115], v[32:35], v[148:151]
    s_mov_b32 s49, s50
    v_mfma_f32_16x16x32_bf16 v[152:155], v[112:115], v[36:39], v[152:155]
    s_add_u32 s50, s50, s51
    v_mfma_f32_16x16x32_bf16 v[156:159], v[112:115], v[40:43], v[156:159]
    s_add_u32 s82, s82, 1
    v_mfma_f32_16x16x32_bf16 v[160:163], v[112:115], v[44:47], v[160:163]
    s_cmp_eq_u32 s82, 20
    v_mfma_f32_16x16x32_bf16 v[164:167], v[112:115], v[48:51], v[164:167]
    s_cselect_b32 s29, s83, 0
    v_mfma_f32_16x16x32_bf16 v[168:171], v[112:115], v[52:55], v[168:171]
    s_sub_u32 s50, s50, s29
    s_waitcnt vmcnt(16) lgkmcnt(0)
    s_barrier
    ds_read_b64_tr_b16 v[112:113], v11 offset:0
    v_mfma_f32_16x16x32_bf16 v[172:175], v[116:119], v[28:31], v[172:175]
    ds_read_b64_tr_b16 v[114:115], v11 offset:256
    v_mfma_f32_16x16x32_bf16 v[176:179], v[116:119], v[32:35], v[176:179]
    ds_read_b128 v[56:59], v27 offset:0
    v_mfma_f32_16x16x32_bf16 v[180:183], v[116:119], v[36:39], v[180:183]
    s_add_u32 s28, s49, s88
    buffer_load_dwordx4 v26, s[16:19], s28 offen lds
    v_mfma_f32_16x16x32_bf16 v[184:187], v[116:119], v[40:43], v[184:187]
    s_add_u32 m0, m0, s53
    ds_read_b128 v[60:63], v27 offset:1024
    v_mfma_f32_16x16x32_bf16 v[188:191], v[116:119], v[44:47], v[188:191]
    ds_read_b128 v[64:67], v27 offset:2048
    v_mfma_f32_16x16x32_bf16 v[192:195], v[116:119], v[48:51], v[192:195]
    ds_read_b128 v[68:71], v27 offset:3072
    v_mfma_f32_16x16x32_bf16 v[196:199], v[116:119], v[52:55], v[196:199]
    ds_read_b128 v[72:75], v27 offset:4096
    v_mfma_f32_16x16x32_bf16 v[200:203], v[120:123], v[28:31], v[200:203]
    ds_read_b128 v[76:79], v27 offset:5120
    v_mfma_f32_16x16x32_bf16 v[204:207], v[120:123], v[32:35], v[204:207]
    s_add_u32 s28, s49, s89
    buffer_load_dwordx4 v26, s[16:19], s28 offen lds
    v_mfma_f32_16x16x32_bf16 v[208:211], v[120:123], v[36:39], v[208:211]
    s_add_u32 m0, m0, s53
    ds_read_b128 v[80:83], v27 offset:6144
    v_mfma_f32_16x16x32_bf16 v[212:215], v[120:123], v[40:43], v[212:215]
    ds_read_b64_tr_b16 v[116:117], v11 offset:32
    v_mfma_f32_16x16x32_bf16 v[216:219], v[120:123], v[44:47], v[216:219]
    ds_read_b64_tr_b16 v[118:119], v11 offset:288
    v_mfma_f32_16x16x32_bf16 v[220:223], v[120:123], v[48:51], v[220:223]
    v_mfma_f32_16x16x32_bf16 v[224:227], v[120:123], v[52:55], v[224:227]
    ds_read_b64_tr_b16 v[120:121], v11 offset:64
    v_mfma_f32_16x16x32_bf16 v[228:231], v[124:127], v[28:31], v[228:231]
    s_add_u32 s28, s49, s90
    buffer_load_dwordx4 v26, s[16:19], s28 offen lds
    v_mfma_f32_16x16x32_bf16 v[232:235], v[124:127], v[32:35], v[232:235]
    s_add_u32 m0, m0, s53
    ds_read_b64_tr_b16 v[122:123], v11 offset:320
    v_mfma_f32_16x16x32_bf16 v[236:239], v[124:127], v[36:39], v[236:239]
    v_mfma_f32_16x16x32_bf16 v[240:243], v[124:127], v[40:43], v[240:243]
    v_mfma_f32_16x16x32_bf16 v[244:247], v[124:127], v[44:47], v[244:247]
    v_mfma_f32_16x16x32_bf16 v[248:251], v[124:127], v[48:51], v[248:251]
    v_mfma_f32_16x16x32_bf16 v[252:255], v[124:127], v[52:55], v[252:255]
    s_add_u32 s28, s49, s91
    buffer_load_dwordx4 v26, s[16:19], s28 offen lds
    v_mfma_f32_16x16x32_bf16 a[112:115], v[128:131], v[28:31], a[112:115]
    s_add_u32 m0, m0, s53
    ds_read_b64_tr_b16 v[124:125], v11 offset:96
    v_mfma_f32_16x16x32_bf16 a[116:119], v[128:131], v[32:35], a[116:119]
    ds_read_b64_tr_b16 v[126:127], v11 offset:352
    v_mfma_f32_16x16x32_bf16 a[120:123], v[128:131], v[36:39], a[120:123]
    v_mfma_f32_16x16x32_bf16 a[124:127], v[128:131], v[40:43], a[124:127]
    v_mfma_f32_16x16x32_bf16 a[128:131], v[128:131], v[44:47], a[128:131]
    v_mfma_f32_16x16x32_bf16 a[132:135], v[128:131], v[48:51], a[132:135]
    s_add_u32 s28, s49, s92
    buffer_load_dwordx4 v26, s[16:19], s28 offen lds
    v_mfma_f32_16x16x32_bf16 a[136:139], v[128:131], v[52:55], a[136:139]
    s_add_u32 m0, m0, s53
    ds_read_b64_tr_b16 v[128:129], v11 offset:128
    v_mfma_f32_16x16x32_bf16 a[140:143], v[132:135], v[28:31], a[140:143]
    ds_read_b64_tr_b16 v[130:131], v11 offset:384
    v_mfma_f32_16x16x32_bf16 a[144:147], v[132:135], v[32:35], a[144:147]
    v_mfma_f32_16x16x32_bf16 a[148:151], v[132:135], v[36:39], a[148:151]
    v_mfma_f32_16x16x32_bf16 a[152:155], v[132:135], v[40:43], a[152:155]
    v_mfma_f32_16x16x32_bf16 a[156:159], v[132:135], v[44:47], a[156:159]
    s_add_u32 s28, s49, s93
    buffer_load_dwordx4 v26, s[16:19], s28 offen lds
    v_mfma_f32_16x16x32_bf16 a[160:163], v[132:135], v[48:51], a[160:163]
    s_add_u32 m0, m0, s53
    v_mfma_f32_16x16x32_bf16 a[164:167], v[132:135], v[52:55], a[164:167]
    ds_read_b64_tr_b16 v[132:133], v11 offset:160
    v_mfma_f32_16x16x32_bf16 a[168:171], v[136:139], v[28:31], a[168:171]
    ds_read_b64_tr_b16 v[134:135], v11 offset:416
    v_mfma_f32_16x16x32_bf16 a[172:175], v[136:139], v[32:35], a[172:175]
    v_mfma_f32_16x16x32_bf16 a[176:179], v[136:139], v[36:39], a[176:179]
    v_mfma_f32_16x16x32_bf16 a[180:183], v[136:139], v[40:43], a[180:183]
    s_add_u32 s28, s49, s94
    buffer_load_dwordx4 v26, s[16:19], s28 offen lds
    v_mfma_f32_16x16x32_bf16 a[184:187], v[136:139], v[44:47], a[184:187]
    s_add_u32 m0, m0, s53
    v_mfma_f32_16x16x32_bf16 a[188:191], v[136:139], v[48:51], a[188:191]
    v_mfma_f32_16x16x32_bf16 a[192:195], v[136:139], v[52:55], a[192:195]
    ds_read_b64_tr_b16 v[136:137], v11 offset:192
    v_mfma_f32_16x16x32_bf16 a[196:199], v[140:143], v[28:31], a[196:199]
    ds_read_b64_tr_b16 v[138:139], v11 offset:448
    v_mfma_f32_16x16x32_bf16 a[200:203], v[140:143], v[32:35], a[200:203]
    v_mfma_f32_16x16x32_bf16 a[204:207], v[140:143], v[36:39], a[204:207]
    s_add_u32 s28, s49, s95
    buffer_load_dwordx4 v26, s[16:19], s28 offen lds
    v_mfma_f32_16x16x32_bf16 a[208:211], v[140:143], v[40:43], a[208:211]
    v_mfma_f32_16x16x32_bf16 a[212:215], v[140:143], v[44:47], a[212:215]
    v_mfma_f32_16x16x32_bf16 a[216:219], v[140:143], v[48:51], a[216:219]
    v_mfma_f32_16x16x32_bf16 a[220:223], v[140:143], v[52:55], a[220:223]
    ds_read_b64_tr_b16 v[140:141], v11 offset:224
    ds_read_b64_tr_b16 v[142:143], v11 offset:480
    s_mov_b32 s22, 0
L_at_qploop:
    s_waitcnt lgkmcnt(14)
    v_mfma_f32_16x16x32_bf16 v[144:147], v[112:115], v[56:59], v[144:147]
    s_add_u32 m0, s33, 0
    v_mfma_f32_16x16x32_bf16 v[148:151], v[112:115], v[60:63], v[148:151]
    s_mov_b32 s49, s50
    v_mfma_f32_16x16x32_bf16 v[152:155], v[112:115], v[64:67], v[152:155]
    s_add_u32 s50, s50, s51
    v_mfma_f32_16x16x32_bf16 v[156:159], v[112:115], v[68:71], v[156:159]
    s_add_u32 s82, s82, 1
    v_mfma_f32_16x16x32_bf16 v[160:163], v[112:115], v[72:75], v[160:163]
    s_cmp_eq_u32 s82, 20
    v_mfma_f32_16x16x32_bf16 v[164:167], v[112:115], v[76:79], v[164:167]
    s_cselect_b32 s29, s83, 0
    v_mfma_f32_16x16x32_bf16 v[168:171], v[112:115], v[80:83], v[168:171]
    s_sub_u32 s50, s50, s29
    s_waitcnt vmcnt(16) lgkmcnt(0)
    s_barrier
    ds_read_b64_tr_b16 v[112:113], v11 offset:8448
    v_mfma_f32_16x16x32_bf16 v[172:175], v[116:119], v[56:59], v[172:175]
    ds_read_b64_tr_b16 v[114:115], v11 offset:8704
    v_mfma_f32_16x16x32_bf16 v[176:179], v[116:119], v[60:63], v[176:179]
    ds_read_b128 v[28:31], v27 offset:8448
    v_mfma_f32_16x16x32_bf16 v[180:183], v[116:119], v[64:67], v[180:183]
    s_add_u32 s28, s49, s88
    buffer_load_dwordx4 v26, s[16:19], s28 offen lds
    v_mfma_f32_16x16x32_bf16 v[184:187], v[116:119], v[68:71], v[184:187]
    s_add_u32 m0, m0, s53
    ds_read_b128 v[32:35], v27 offset:9472
    v_mfma_f32_16x16x32_bf16 v[188:191], v[116:119], v[72:75], v[188:191]
    ds_read_b128 v[36:39], v27 offset:10496
    v_mfma_f32_16x16x32_bf16 v[192:195], v[116:119], v[76:79], v[192:195]
    ds_read_b128 v[40:43], v27 offset:11520
    v_mfma_f32_16x16x32_bf16 v[196:199], v[116:119], v[80:83], v[196:199]
    ds_read_b128 v[44:47], v27 offset:12544
    v_mfma_f32_16x16x32_bf16 v[200:203], v[120:123], v[56:59], v[200:203]
    ds_read_b128 v[48:51], v27 offset:13568
    v_mfma_f32_16x16x32_bf16 v[204:207], v[120:123], v[60:63], v[204:207]
    s_add_u32 s28, s49, s89
    buffer_load_dwordx4 v26, s[16:19], s28 offen lds
    v_mfma_f32_16x16x32_bf16 v[208:211], v[120:123], v[64:67], v[208:211]
    s_add_u32 m0, m0, s53
    ds_read_b128 v[52:55], v27 offset:14592
    v_mfma_f32_16x16x32_bf16 v[212:215], v[120:123], v[68:71], v[212:215]
    ds_read_b64_tr_b16 v[116:117], v11 offset:8480
    v_mfma_f32_16x16x32_bf16 v[216:219], v[120:123], v[72:75], v[216:219]
    ds_read_b64_tr_b16 v[118:119], v11 offset:8736
    v_mfma_f32_16x16x32_bf16 v[220:223], v[120:123], v[76:79], v[220:223]
    v_mfma_f32_16x16x32_bf16 v[224:227], v[120:123], v[80:83], v[224:227]
    ds_read_b64_tr_b16 v[120:121], v11 offset:8512
    v_mfma_f32_16x16x32_bf16 v[228:231], v[124:127], v[56:59], v[228:231]
    s_add_u32 s28, s49, s90
    buffer_load_dwordx4 v26, s[16:19], s28 offen lds
    v_mfma_f32_16x16x32_bf16 v[232:235], v[124:127], v[60:63], v[232:235]
    s_add_u32 m0, m0, s53
    ds_read_b64_tr_b16 v[122:123], v11 offset:8768
    v_mfma_f32_16x16x32_bf16 v[236:239], v[124:127], v[64:67], v[236:239]
    v_mfma_f32_16x16x32_bf16 v[240:243], v[124:127], v[68:71], v[240:243]
    v_mfma_f32_16x16x32_bf16 v[244:247], v[124:127], v[72:75], v[244:247]
    v_mfma_f32_16x16x32_bf16 v[248:251], v[124:127], v[76:79], v[248:251]
    v_mfma_f32_16x16x32_bf16 v[252:255], v[124:127], v[80:83], v[252:255]
    s_add_u32 s28, s49, s91
    buffer_load_dwordx4 v26, s[16:19], s28 offen lds
    v_mfma_f32_16x16x32_bf16 a[112:115], v[128:131], v[56:59], a[112:115]
    s_add_u32 m0, m0, s53
    ds_read_b64_tr_b16 v[124:125], v11 offset:8544
    v_mfma_f32_16x16x32_bf16 a[116:119], v[128:131], v[60:63], a[116:119]
    ds_read_b64_tr_b16 v[126:127], v11 offset:8800
    v_mfma_f32_16x16x32_bf16 a[120:123], v[128:131], v[64:67], a[120:123]
    v_mfma_f32_16x16x32_bf16 a[124:127], v[128:131], v[68:71], a[124:127]
    v_mfma_f32_16x16x32_bf16 a[128:131], v[128:131], v[72:75], a[128:131]
    v_mfma_f32_16x16x32_bf16 a[132:135], v[128:131], v[76:79], a[132:135]
    s_add_u32 s28, s49, s92
    buffer_load_dwordx4 v26, s[16:19], s28 offen lds
    v_mfma_f32_16x16x32_bf16 a[136:139], v[128:131], v[80:83], a[136:139]
    s_add_u32 m0, m0, s53
    ds_read_b64_tr_b16 v[128:129], v11 offset:8576
    v_mfma_f32_16x16x32_bf16 a[140:143], v[132:135], v[56:59], a[140:143]
    ds_read_b64_tr_b16 v[130:131], v11 offset:8832
    v_mfma_f32_16x16x32_bf16 a[144:147], v[132:135], v[60:63], a[144:147]
    v_mfma_f32_16x16x32_bf16 a[148:151], v[132:135], v[64:67], a[148:151]
    v_mfma_f32_16x16x32_bf16 a[152:155], v[132:135], v[68:71], a[152:155]
    v_mfma_f32_16x16x32_bf16 a[156:159], v[132:135], v[72:75], a[156:159]
    s_add_u32 s28, s49, s93
    buffer_load_dwordx4 v26, s[16:19], s28 offen lds
    v_mfma_f32_16x16x32_bf16 a[160:163], v[132:135], v[76:79], a[160:163]
    s_add_u32 m0, m0, s53
    v_mfma_f32_16x16x32_bf16 a[164:167], v[132:135], v[80:83], a[164:167]
    ds_read_b64_tr_b16 v[132:133], v11 offset:8608
    v_mfma_f32_16x16x32_bf16 a[168:171], v[136:139], v[56:59], a[168:171]
    ds_read_b64_tr_b16 v[134:135], v11 offset:8864
    v_mfma_f32_16x16x32_bf16 a[172:175], v[136:139], v[60:63], a[172:175]
    v_mfma_f32_16x16x32_bf16 a[176:179], v[136:139], v[64:67], a[176:179]
    v_mfma_f32_16x16x32_bf16 a[180:183], v[136:139], v[68:71], a[180:183]
    s_add_u32 s28, s49, s94
    buffer_load_dwordx4 v26, s[16:19], s28 offen lds
    v_mfma_f32_16x16x32_bf16 a[184:187], v[136:139], v[72:75], a[184:187]
    s_add_u32 m0, m0, s53
    v_mfma_f32_16x16x32_bf16 a[188:191], v[136:139], v[76:79], a[188:191]
    v_mfma_f32_16x16x32_bf16 a[192:195], v[136:139], v[80:83], a[192:195]
    ds_read_b64_tr_b16 v[136:137], v11 offset:8640
    v_mfma_f32_16x16x32_bf16 a[196:199], v[140:143], v[56:59], a[196:199]
    ds_read_b64_tr_b16 v[138:139], v11 offset:8896
    v_mfma_f32_16x16x32_bf16 a[200:203], v[140:143], v[60:63], a[200:203]
    v_mfma_f32_16x16x32_bf16 a[204:207], v[140:143], v[64:67], a[204:207]
    s_add_u32 s28, s49, s95
    buffer_load_dwordx4 v26, s[16:19], s28 offen lds
    v_mfma_f32_16x16x32_bf16 a[208:211], v[140:143], v[68:71], a[208:211]
    v_mfma_f32_16x16x32_bf16 a[212:215], v[140:143], v[72:75], a[212:215]
    v_mfma_f32_16x16x32_bf16 a[216:219], v[140:143], v[76:79], a[216:219]
    v_mfma_f32_16x16x32_bf16 a[220:223], v[140:143], v[80:83], a[220:223]
    ds_read_b64_tr_b16 v[140:141], v11 offset:8672
    ds_read_b64_tr_b16 v[142:143], v11 offset:8928
    s_waitcnt lgkmcnt(14)
    v_mfma_f32_16x16x32_bf16 v[144:147], v[112:115], v[28:31], v[144:147]
    s_add_u32 m0, s33, 8448
    v_mfma_f32_16x16x32_bf16 v[148:151], v[112:115], v[32:35], v[148:151]
    s_mov_b32 s49, s50
    v_mfma_f32_16x16x32_bf16 v[152:155], v[112:115], v[36:39], v[152:155]
    s_add_u32 s50, s50, s51
    v_mfma_f32_16x16x32_bf16 v[156:159], v[112:115], v[40:43], v[156:159]
    s_add_u32 s82, s82, 1
    v_mfma_f32_16x16x32_bf16 v[160:163], v[112:115], v[44:47], v[160:163]
    s_cmp_eq_u32 s82, 20
    v_mfma_f32_16x16x32_bf16 v[164:167], v[112:115], v[48:51], v[164:167]
    s_cselect_b32 s29, s83, 0
    v_mfma_f32_16x16x32_bf16 v[168:171], v[112:115], v[52:55], v[168:171]
    s_sub_u32 s50, s50, s29
    s_waitcnt vmcnt(16) lgkmcnt(0)
    s_barrier
    ds_read_b64_tr_b16 v[112:113], v11 offset:16896
    v_mfma_f32_16x16x32_bf16 v[172:175], v[116:119], v[28:31], v[172:175]
    ds_read_b64_tr_b16 v[114:115], v11 offset:17152
    v_mfma_f32_16x16x32_bf16 v[176:179], v[116:119], v[32:35], v[176:179]
    ds_read_b128 v[56:59], v27 offset:16896
    v_mfma_f32_16x16x32_bf16 v[180:183], v[116:119], v[36:39], v[180:183]
    s_add_u32 s28, s49, s88
    buffer_load_dwordx4 v26, s[16:19], s28 offen lds
    v_mfma_f32_16x16x32_bf16 v[184:187], v[116:119], v[40:43], v[184:187]
    s_add_u32 m0, m0, s53
    ds_read_b128 v[60:63], v27 offset:17920
    v_mfma_f32_16x16x32_bf16 v[188:191], v[116:119], v[44:47], v[188:191]
    ds_read_b128 v[64:67], v27 offset:18944
    v_mfma_f32_16x16x32_bf16 v[192:195], v[116:119], v[48:51], v[192:195]
    ds_read_b128 v[68:71], v27 offset:19968
    v_mfma_f32_16x16x32_bf16 v[196:199], v[116:119], v[52:55], v[196:199]
    ds_read_b128 v[72:75], v27 offset:20992
    v_mfma_f32_16x16x32_bf16 v[200:203], v[120:123], v[28:31], v[200:203]
    ds_read_b128 v[76:79], v27 offset:22016
    v_mfma_f32_16x16x32_bf16 v[204:207], v[120:123], v[32:35], v[204:207]
    s_add_u32 s28, s49, s89
    buffer_load_dwordx4 v26, s[16:19], s28 offen lds
    v_mfma_f32_16x16x32_bf16 v[208:211], v[120:123], v[36:39], v[208:211]
    s_add_u32 m0, m0, s53
    ds_read_b128 v[80:83], v27 offset:23040
    v_mfma_f32_16x16x32_bf16 v[212:215], v[120:123], v[40:43], v[212:215]
    ds_read_b64_tr_b16 v[116:117], v11 offset:16928
    v_mfma_f32_16x16x32_bf16 v[216:219], v[120:123], v[44:47], v[216:219]
    ds_read_b64_tr_b16 v[118:119], v11 offset:17184
    v_mfma_f32_16x16x32_bf16 v[220:223], v[120:123], v[48:51], v[220:223]
    v_mfma_f32_16x16x32_bf16 v[224:227], v[120:123], v[52:55], v[224:227]
    ds_read_b64_tr_b16 v[120:121], v11 offset:16960
    v_mfma_f32_16x16x32_bf16 v[228:231], v[124:127], v[28:31], v[228:231]
    s_add_u32 s28, s49, s90
    buffer_load_dwordx4 v26, s[16:19], s28 offen lds
    v_mfma_f32_16x16x32_bf16 v[232:235], v[124:127], v[32:35], v[232:235]
    s_add_u32 m0, m0, s53
    ds_read_b64_tr_b16 v[122:123], v11 offset:17216
    v_mfma_f32_16x16x32_bf16 v[236:239], v[124:127], v[36:39], v[236:239]
    v_mfma_f32_16x16x32_bf16 v[240:243], v[124:127], v[40:43], v[240:243]
    v_mfma_f32_16x16x32_bf16 v[244:247], v[124:127], v[44:47], v[244:247]
    v_mfma_f32_16x16x32_bf16 v[248:251], v[124:127], v[48:51], v[248:251]
    v_mfma_f32_16x16x32_bf16 v[252:255], v[124:127], v[52:55], v[252:255]
    s_add_u32 s28, s49, s91
    buffer_load_dwordx4 v26, s[16:19], s28 offen lds
    v_mfma_f32_16x16x32_bf16 a[112:115], v[128:131], v[28:31], a[112:115]
    s_add_u32 m0, m0, s53
    ds_read_b64_tr_b16 v[124:125], v11 offset:16992
    v_mfma_f32_16x16x32_bf16 a[116:119], v[128:131], v[32:35], a[116:119]
    ds_read_b64_tr_b16 v[126:127], v11 offset:17248
    v_mfma_f32_16x16x32_bf16 a[120:123], v[128:131], v[36:39], a[120:123]
    v_mfma_f32_16x16x32_bf16 a[124:127], v[128:131], v[40:43], a[124:127]
    v_mfma_f32_16x16x32_bf16 a[128:131], v[128:131], v[44:47], a[128:131]
    v_mfma_f32_16x16x32_bf16 a[132:135], v[128:131], v[48:51], a[132:135]
    s_add_u32 s28, s49, s92
    buffer_load_dwordx4 v26, s[16:19], s28 offen lds
    v_mfma_f32_16x16x32_bf16 a[136:139], v[128:131], v[52:55], a[136:139]
    s_add_u32 m0, m0, s53
    ds_read_b64_tr_b16 v[128:129], v11 offset:17024
    v_mfma_f32_16x16x32_bf16 a[140:143], v[132:135], v[28:31], a[140:143]
    ds_read_b64_tr_b16 v[130:131], v11 offset:17280
    v_mfma_f32_16x16x32_bf16 a[144:147], v[132:135], v[32:35], a[144:147]
    v_mfma_f32_16x16x32_bf16 a[148:151], v[132:135], v[36:39], a[148:151]
    v_mfma_f32_16x16x32_bf16 a[152:155], v[132:135], v[40:43], a[152:155]
    v_mfma_f32_16x16x32_bf16 a[156:159], v[132:135], v[44:47], a[156:159]
    s_add_u32 s28, s49, s93
    buffer_load_dwordx4 v26, s[16:19], s28 offen lds
    v_mfma_f32_16x16x32_bf16 a[160:163], v[132:135], v[48:51], a[160:163]
    s_add_u32 m0, m0, s53
    v_mfma_f32_16x16x32_bf16 a[164:167], v[132:135], v[52:55], a[164:167]
    ds_read_b64_tr_b16 v[132:133], v11 offset:17056
    v_mfma_f32_16x16x32_bf16 a[168:171], v[136:139], v[28:31], a[168:171]
    ds_read_b64_tr_b16 v[134:135], v11 offset:17312
    v_mfma_f32_16x16x32_bf16 a[172:175], v[136:139], v[32:35], a[172:175]
    v_mfma_f32_16x16x32_bf16 a[176:179], v[136:139], v[36:39], a[176:179]
    v_mfma_f32_16x16x32_bf16 a[180:183], v[136:139], v[40:43], a[180:183]
    s_add_u32 s28, s49, s94
    buffer_load_dwordx4 v26, s[16:19], s28 offen lds
    v_mfma_f32_16x16x32_bf16 a[184:187], v[136:139], v[44:47], a[184:187]
    s_add_u32 m0, m0, s53
    v_mfma_f32_16x16x32_bf16 a[188:191], v[136:139], v[48:51], a[188:191]
    v_mfma_f32_16x16x32_bf16 a[192:195], v[136:139], v[52:55], a[192:195]
    ds_read_b64_tr_b16 v[136:137], v11 offset:17088
    v_mfma_f32_16x16x32_bf16 a[196:199], v[140:143], v[28:31], a[196:199]
    ds_read_b64_tr_b16 v[138:139], v11 offset:17344
    v_mfma_f32_16x16x32_bf16 a[200:203], v[140:143], v[32:35], a[200:203]
    v_mfma_f32_16x16x32_bf16 a[204:207], v[140:143], v[36:39], a[204:207]
    s_add_u32 s28, s49, s95
    buffer_load_dwordx4 v26, s[16:19], s28 offen lds
    v_mfma_f32_16x16x32_bf16 a[208:211], v[140:143], v[40:43], a[208:211]
    v_mfma_f32_16x16x32_bf16 a[212:215], v[140:143], v[44:47], a[212:215]
    v_mfma_f32_16x16x32_bf16 a[216:219], v[140:143], v[48:51], a[216:219]
    v_mfma_f32_16x16x32_bf16 a[220:223], v[140:143], v[52:55], a[220:223]
    ds_read_b64_tr_b16 v[140:141], v11 offset:17120
    ds_read_b64_tr_b16 v[142:143], v11 offset:17376
    s_waitcnt lgkmcnt(14)
    v_mfma_f32_16x16x32_bf16 v[144:147], v[112:115], v[56:59], v[144:147]
    s_add_u32 m0, s33, 16896
    v_mfma_f32_16x16x32_bf16 v[148:151], v[112:115], v[60:63], v[148:151]
    s_mov_b32 s49, s50
    v_mfma_f32_16x16x32_bf16 v[152:155], v[112:115], v[64:67], v[152:155]
    s_add_u32 s50, s50, s51
    v_mfma_f32_16x16x32_bf16 v[156:159], v[112:115], v[68:71], v[156:159]
    s_add_u32 s82, s82, 1
    v_mfma_f32_16x16x32_bf16 v[160:163], v[112:115], v[72:75], v[160:163]
    s_cmp_eq_u32 s82, 20
    v_mfma_f32_16x16x32_bf16 v[164:167], v[112:115], v[76:79], v[164:167]
    s_cselect_b32 s29, s83, 0
    v_mfma_f32_16x16x32_bf16 v[168:171], v[112:115], v[80:83], v[168:171]
    s_sub_u32 s50, s50, s29
    s_waitcnt vmcnt(16) lgkmcnt(0)
    s_barrier
    ds_read_b64_tr_b16 v[112:113], v11 offset:25344
    v_mfma_f32_16x16x32_bf16 v[172:175], v[116:119], v[56:59], v[172:175]
    ds_read_b64_tr_b16 v[114:115], v11 offset:25600
    v_mfma_f32_16x16x32_bf16 v[176:179], v[116:119], v[60:63], v[176:179]
    ds_read_b128 v[28:31], v27 offset:25344
    v_mfma_f32_16x16x32_bf16 v[180:183], v[116:119], v[64:67], v[180:183]
    s_add_u32 s28, s49, s88
    buffer_load_dwordx4 v26, s[16:19], s28 offen lds
    v_mfma_f32_16x16x32_bf16 v[184:187], v[116:119], v[68:71], v[184:187]
    s_add_u32 m0, m0, s53
    ds_read_b128 v[32:35], v27 offset:26368
    v_mfma_f32_16x16x32_bf16 v[188:191], v[116:119], v[72:75], v[188:191]
    ds_read_b128 v[36:39], v27 offset:27392
    v_mfma_f32_16x16x32_bf16 v[192:195], v[116:119], v[76:79], v[192:195]
    ds_read_b128 v[40:43], v27 offset:28416
    v_mfma_f32_16x16x32_bf16 v[196:199], v[116:119], v[80:83], v[196:199]
    ds_read_b128 v[44:47], v27 offset:29440
    v_mfma_f32_16x16x32_bf16 v[200:203], v[120:123], v[56:59], v[200:203]
    ds_read_b128 v[48:51], v27 offset:30464
    v_mfma_f32_16x16x32_bf16 v[204:207], v[120:123], v[60:63], v[204:207]
    s_add_u32 s28, s49, s89
    buffer_load_dwordx4 v26, s[16:19], s28 offen lds
    v_mfma_f32_16x16x32_bf16 v[208:211], v[120:123], v[64:67], v[208:211]
    s_add_u32 m0, m0, s53
    ds_read_b128 v[52:55], v27 offset:31488
    v_mfma_f32_16x16x32_bf16 v[212:215], v[120:123], v[68:71], v[212:215]
    ds_read_b64_tr_b16 v[116:117], v11 offset:25376
    v_mfma_f32_16x16x32_bf16 v[216:219], v[120:123], v[72:75], v[216:219]
    ds_read_b64_tr_b16 v[118:119], v11 offset:25632
    v_mfma_f32_16x16x32_bf16 v[220:223], v[120:123], v[76:79], v[220:223]
    v_mfma_f32_16x16x32_bf16 v[224:227], v[120:123], v[80:83], v[224:227]
    ds_read_b64_tr_b16 v[120:121], v11 offset:25408
    v_mfma_f32_16x16x32_bf16 v[228:231], v[124:127], v[56:59], v[228:231]
    s_add_u32 s28, s49, s90
    buffer_load_dwordx4 v26, s[16:19], s28 offen lds
    v_mfma_f32_16x16x32_bf16 v[232:235], v[124:127], v[60:63], v[232:235]
    s_add_u32 m0, m0, s53
    ds_read_b64_tr_b16 v[122:123], v11 offset:25664
    v_mfma_f32_16x16x32_bf16 v[236:239], v[124:127], v[64:67], v[236:239]
    v_mfma_f32_16x16x32_bf16 v[240:243], v[124:127], v[68:71], v[240:243]
    v_mfma_f32_16x16x32_bf16 v[244:247], v[124:127], v[72:75], v[244:247]
    v_mfma_f32_16x16x32_bf16 v[248:251], v[124:127], v[76:79], v[248:251]
    v_mfma_f32_16x16x32_bf16 v[252:255], v[124:127], v[80:83], v[252:255]
    s_add_u32 s28, s49, s91
    buffer_load_dwordx4 v26, s[16:19], s28 offen lds
    v_mfma_f32_16x16x32_bf16 a[112:115], v[128:131], v[56:59], a[112:115]
    s_add_u32 m0, m0, s53
    ds_read_b64_tr_b16 v[124:125], v11 offset:25440
    v_mfma_f32_16x16x32_bf16 a[116:119], v[128:131], v[60:63], a[116:119]
    ds_read_b64_tr_b16 v[126:127], v11 offset:25696
    v_mfma_f32_16x16x32_bf16 a[120:123], v[128:131], v[64:67], a[120:123]
    v_mfma_f32_16x16x32_bf16 a[124:127], v[128:131], v[68:71], a[124:127]
    v_mfma_f32_16x16x32_bf16 a[128:131], v[128:131], v[72:75], a[128:131]
    v_mfma_f32_16x16x32_bf16 a[132:135], v[128:131], v[76:79], a[132:135]
    s_add_u32 s28, s49, s92
    buffer_load_dwordx4 v26, s[16:19], s28 offen lds
    v_mfma_f32_16x16x32_bf16 a[136:139], v[128:131], v[80:83], a[136:139]
    s_add_u32 m0, m0, s53
    ds_read_b64_tr_b16 v[128:129], v11 offset:25472
    v_mfma_f32_16x16x32_bf16 a[140:143], v[132:135], v[56:59], a[140:143]
    ds_read_b64_tr_b16 v[130:131], v11 offset:25728
    v_mfma_f32_16x16x32_bf16 a[144:147], v[132:135], v[60:63], a[144:147]
    v_mfma_f32_16x16x32_bf16 a[148:151], v[132:135], v[64:67], a[148:151]
    v_mfma_f32_16x16x32_bf16 a[152:155], v[132:135], v[68:71], a[152:155]
    v_mfma_f32_16x16x32_bf16 a[156:159], v[132:135], v[72:75], a[156:159]
    s_add_u32 s28, s49, s93
    buffer_load_dwordx4 v26, s[16:19], s28 offen lds
    v_mfma_f32_16x16x32_bf16 a[160:163], v[132:135], v[76:79], a[160:163]
    s_add_u32 m0, m0, s53
    v_mfma_f32_16x16x32_bf16 a[164:167], v[132:135], v[80:83], a[164:167]
    ds_read_b64_tr_b16 v[132:133], v11 offset:25504
    v_mfma_f32_16x16x32_bf16 a[168:171], v[136:139], v[56:59], a[168:171]
    ds_read_b64_tr_b16 v[134:135], v11 offset:25760
    v_mfma_f32_16x16x32_bf16 a[172:175], v[136:139], v[60:63], a[172:175]
    v_mfma_f32_16x16x32_bf16 a[176:179], v[136:139], v[64:67], a[176:179]
    v_mfma_f32_16x16x32_bf16 a[180:183], v[136:139], v[68:71], a[180:183]
    s_add_u32 s28, s49, s94
    buffer_load_dwordx4 v26, s[16:19], s28 offen lds
    v_mfma_f32_16x16x32_bf16 a[184:187], v[136:139], v[72:75], a[184:187]
    s_add_u32 m0, m0, s53
    v_mfma_f32_16x16x32_bf16 a[188:191], v[136:139], v[76:79], a[188:191]
    v_mfma_f32_16x16x32_bf16 a[192:195], v[136:139], v[80:83], a[192:195]
    ds_read_b64_tr_b16 v[136:137], v11 offset:25536
    v_mfma_f32_16x16x32_bf16 a[196:199], v[140:143], v[56:59], a[196:199]
    ds_read_b64_tr_b16 v[138:139], v11 offset:25792
    v_mfma_f32_16x16x32_bf16 a[200:203], v[140:143], v[60:63], a[200:203]
    v_mfma_f32_16x16x32_bf16 a[204:207], v[140:143], v[64:67], a[204:207]
    s_add_u32 s28, s49, s95
    buffer_load_dwordx4 v26, s[16:19], s28 offen lds
    v_mfma_f32_16x16x32_bf16 a[208:211], v[140:143], v[68:71], a[208:211]
    v_mfma_f32_16x16x32_bf16 a[212:215], v[140:143], v[72:75], a[212:215]
    v_mfma_f32_16x16x32_bf16 a[216:219], v[140:143], v[76:79], a[216:219]
    v_mfma_f32_16x16x32_bf16 a[220:223], v[140:143], v[80:83], a[220:223]
    ds_read_b64_tr_b16 v[140:141], v11 offset:25568
    ds_read_b64_tr_b16 v[142:143], v11 offset:25824
    s_waitcnt lgkmcnt(14)
    v_mfma_f32_16x16x32_bf16 v[144:147], v[112:115], v[28:31], v[144:147]
    s_add_u32 m0, s33, 25344
    v_mfma_f32_16x16x32_bf16 v[148:151], v[112:115], v[32:35], v[148:151]
    s_mov_b32 s49, s50
    v_mfma_f32_16x16x32_bf16 v[152:155], v[112:115], v[36:39], v[152:155]
    s_add_u32 s50, s50, s51
    v_mfma_f32_16x16x32_bf16 v[156:159], v[112:115], v[40:43], v[156:159]
    s_add_u32 s82, s82, 1
    v_mfma_f32_16x16x32_bf16 v[160:163], v[112:115], v[44:47], v[160:163]
    s_cmp_eq_u32 s82, 20
    v_mfma_f32_16x16x32_bf16 v[164:167], v[112:115], v[48:51], v[164:167]
    s_cselect_b32 s29, s83, 0
    v_mfma_f32_16x16x32_bf16 v[168:171], v[112:115], v[52:55], v[168:171]
    s_sub_u32 s50, s50, s29
    s_waitcnt vmcnt(16) lgkmcnt(0)
    s_barrier
    ds_read_b64_tr_b16 v[112:113], v11 offset:0
    v_mfma_f32_16x16x32_bf16 v[172:175], v[116:119], v[28:31], v[172:175]
    ds_read_b64_tr_b16 v[114:115], v11 offset:256
    v_mfma_f32_16x16x32_bf16 v[176:179], v[116:119], v[32:35], v[176:179]
    ds_read_b128 v[56:59], v27 offset:0
    v_mfma_f32_16x16x32_bf16 v[180:183], v[116:119], v[36:39], v[180:183]
    s_add_u32 s28, s49, s88
    buffer_load_dwordx4 v26, s[16:19], s28 offen lds
    v_mfma_f32_16x16x32_bf16 v[184:187], v[116:119], v[40:43], v[184:187]
    s_add_u32 m0, m0, s53
    ds_read_b128 v[60:63], v27 offset:1024
    v_mfma_f32_16x16x32_bf16 v[188:191], v[116:119], v[44:47], v[188:191]
    ds_read_b128 v[64:67], v27 offset:2048
    v_mfma_f32_16x16x32_bf16 v[192:195], v[116:119], v[48:51], v[192:195]
    ds_read_b128 v[68:71], v27 offset:3072
    v_mfma_f32_16x16x32_bf16 v[196:199], v[116:119], v[52:55], v[196:199]
    ds_read_b128 v[72:75], v27 offset:4096
    v_mfma_f32_16x16x32_bf16 v[200:203], v[120:123], v[28:31], v[200:203]
    ds_read_b128 v[76:79], v27 offset:5120
    v_mfma_f32_16x16x32_bf16 v[204:207], v[120:123], v[32:35], v[204:207]
    s_add_u32 s28, s49, s89
    buffer_load_dwordx4 v26, s[16:19], s28 offen lds
    v_mfma_f32_16x16x32_bf16 v[208:211], v[120:123], v[36:39], v[208:211]
    s_add_u32 m0, m0, s53
    ds_read_b128 v[80:83], v27 offset:6144
    v_mfma_f32_16x16x32_bf16 v[212:215], v[120:123], v[40:43], v[212:215]
    ds_read_b64_tr_b16 v[116:117], v11 offset:32
    v_mfma_f32_16x16x32_bf16 v[216:219], v[120:123], v[44:47], v[216:219]
    ds_read_b64_tr_b16 v[118:119], v11 offset:288
    v_mfma_f32_16x16x32_bf16 v[220:223], v[120:123], v[48:51], v[220:223]
    v_mfma_f32_16x16x32_bf16 v[224:227], v[120:123], v[52:55], v[224:227]
    ds_read_b64_tr_b16 v[120:121], v11 offset:64
    v_mfma_f32_16x16x32_bf16 v[228:231], v[124:127], v[28:31], v[228:231]
    s_add_u32 s28, s49, s90
    buffer_load_dwordx4 v26, s[16:19], s28 offen lds
    v_mfma_f32_16x16x32_bf16 v[232:235], v[124:127], v[32:35], v[232:235]
    s_add_u32 m0, m0, s53
    ds_read_b64_tr_b16 v[122:123], v11 offset:320
    v_mfma_f32_16x16x32_bf16 v[236:239], v[124:127], v[36:39], v[236:239]
    v_mfma_f32_16x16x32_bf16 v[240:243], v[124:127], v[40:43], v[240:243]
    v_mfma_f32_16x16x32_bf16 v[244:247], v[124:127], v[44:47], v[244:247]
    v_mfma_f32_16x16x32_bf16 v[248:251], v[124:127], v[48:51], v[248:251]
    v_mfma_f32_16x16x32_bf16 v[252:255], v[124:127], v[52:55], v[252:255]
    s_add_u32 s28, s49, s91
    buffer_load_dwordx4 v26, s[16:19], s28 offen lds
    v_mfma_f32_16x16x32_bf16 a[112:115], v[128:131], v[28:31], a[112:115]
    s_add_u32 m0, m0, s53
    ds_read_b64_tr_b16 v[124:125], v11 offset:96
    v_mfma_f32_16x16x32_bf16 a[116:119], v[128:131], v[32:35], a[116:119]
    ds_read_b64_tr_b16 v[126:127], v11 offset:352
    v_mfma_f32_16x16x32_bf16 a[120:123], v[128:131], v[36:39], a[120:123]
    v_mfma_f32_16x16x32_bf16 a[124:127], v[128:131], v[40:43], a[124:127]
    v_mfma_f32_16x16x32_bf16 a[128:131], v[128:131], v[44:47], a[128:131]
    v_mfma_f32_16x16x32_bf16 a[132:135], v[128:131], v[48:51], a[132:135]
    s_add_u32 s28, s49, s92
    buffer_load_dwordx4 v26, s[16:19], s28 offen lds
    v_mfma_f32_16x16x32_bf16 a[136:139], v[128:131], v[52:55], a[136:139]
    s_add_u32 m0, m0, s53
    ds_read_b64_tr_b16 v[128:129], v11 offset:128
    v_mfma_f32_16x16x32_bf16 a[140:143], v[132:135], v[28:31], a[140:143]
    ds_read_b64_tr_b16 v[130:131], v11 offset:384
    v_mfma_f32_16x16x32_bf16 a[144:147], v[132:135], v[32:35], a[144:147]
    v_mfma_f32_16x16x32_bf16 a[148:151], v[132:135], v[36:39], a[148:151]
    v_mfma_f32_16x16x32_bf16 a[152:155], v[132:135], v[40:43], a[152:155]
    v_mfma_f32_16x16x32_bf16 a[156:159], v[132:135], v[44:47], a[156:159]
    s_add_u32 s28, s49, s93
    buffer_load_dwordx4 v26, s[16:19], s28 offen lds
    v_mfma_f32_16x16x32_bf16 a[160:163], v[132:135], v[48:51], a[160:163]
    s_add_u32 m0, m0, s53
    v_mfma_f32_16x16x32_bf16 a[164:167], v[132:135], v[52:55], a[164:167]
    ds_read_b64_tr_b16 v[132:133], v11 offset:160
    v_mfma_f32_16x16x32_bf16 a[168:171], v[136:139], v[28:31], a[168:171]
    ds_read_b64_tr_b16 v[134:135], v11 offset:416
    v_mfma_f32_16x16x32_bf16 a[172:175], v[136:139], v[32:35], a[172:175]
    v_mfma_f32_16x16x32_bf16 a[176:179], v[136:139], v[36:39], a[176:179]
    v_mfma_f32_16x16x32_bf16 a[180:183], v[136:139], v[40:43], a[180:183]
    s_add_u32 s28, s49, s94
    buffer_load_dwordx4 v26, s[16:19], s28 offen lds
    v_mfma_f32_16x16x32_bf16 a[184:187], v[136:139], v[44:47], a[184:187]
    s_add_u32 m0, m0, s53
    v_mfma_f32_16x16x32_bf16 a[188:191], v[136:139], v[48:51], a[188:191]
    v_mfma_f32_16x16x32_bf16 a[192:195], v[136:139], v[52:55], a[192:195]
    ds_read_b64_tr_b16 v[136:137], v11 offset:192
    v_mfma_f32_16x16x32_bf16 a[196:199], v[140:143], v[28:31], a[196:199]
    ds_read_b64_tr_b16 v[138:139], v11 offset:448
    v_mfma_f32_16x16x32_bf16 a[200:203], v[140:143], v[32:35], a[200:203]
    v_mfma_f32_16x16x32_bf16 a[204:207], v[140:143], v[36:39], a[204:207]
    s_add_u32 s28, s49, s95
    buffer_load_dwordx4 v26, s[16:19], s28 offen lds
    v_mfma_f32_16x16x32_bf16 a[208:211], v[140:143], v[40:43], a[208:211]
    v_mfma_f32_16x16x32_bf16 a[212:215], v[140:143], v[44:47], a[212:215]
    v_mfma_f32_16x16x32_bf16 a[216:219], v[140:143], v[48:51], a[216:219]
    v_mfma_f32_16x16x32_bf16 a[220:223], v[140:143], v[52:55], a[220:223]
    ds_read_b64_tr_b16 v[140:141], v11 offset:224
    ds_read_b64_tr_b16 v[142:143], v11 offset:480
    s_add_u32 s22, s22, 1
    s_cmp_lt_u32 s22, 3
    s_cbranch_scc1 L_at_qploop
    s_cmp_lg_u32 s70, 0
    s_cbranch_scc1 L_at_qptailB
    s_waitcnt lgkmcnt(14)
    v_mfma_f32_16x16x32_bf16 v[144:147], v[112:115], v[56:59], v[144:147]
    s_add_u32 s29, s34, s100
    v_accvgpr_read_b32 v88, a244
    v_mfma_f32_16x16x32_bf16 v[148:151], v[112:115], v[60:63], v[148:151]
    s_bfe_u32 s28, s29, 0x20003
    v_accvgpr_read_b32 v89, a245
    v_mfma_f32_16x16x32_bf16 v[152:155], v[112:115], v[64:67], v[152:155]
    s_lshl_b32 s28, s28, 16
    v_accvgpr_read_b32 v90, a246
    v_mfma_f32_16x16x32_bf16 v[156:159], v[112:115], v[68:71], v[156:159]
    s_and_b32 s29, s29, 7
    v_accvgpr_read_b32 v91, a247
    v_mfma_f32_16x16x32_bf16 v[160:163], v[112:115], v[72:75], v[160:163]
    s_lshl_b32 s29, s29, 11
    v_accvgpr_read_b32 v92, a248
    v_mfma_f32_16x16x32_bf16 v[164:167], v[112:115], v[76:79], v[164:167]
    s_add_u32 s29, s28, s29
    v_mfma_f32_16x16x32_bf16 v[168:171], v[112:115], v[80:83], v[168:171]
    s_lshr_b32 s28, s34, 5
    s_waitcnt vmcnt(16) lgkmcnt(0)
    s_barrier
    ds_read_b64_tr_b16 v[112:113], v11 offset:8448
    v_mfma_f32_16x16x32_bf16 v[172:175], v[116:119], v[56:59], v[172:175]
    s_lshl_b32 s28, s28, 19
    ds_read_b64_tr_b16 v[114:115], v11 offset:8704
    v_mfma_f32_16x16x32_bf16 v[176:179], v[116:119], v[60:63], v[176:179]
    s_add_u32 s49, s28, s29
    ds_read_b128 v[28:31], v27 offset:8448
    v_mfma_f32_16x16x32_bf16 v[180:183], v[116:119], v[64:67], v[180:183]
    s_add_u32 m0, s33, 0
    ds_read_b128 v[32:35], v27 offset:9472
    v_mfma_f32_16x16x32_bf16 v[184:187], v[116:119], v[68:71], v[184:187]
    s_add_u32 s34, s34, 1
    ds_read_b128 v[36:39], v27 offset:10496
    v_mfma_f32_16x16x32_bf16 v[188:191], v[116:119], v[72:75], v[188:191]
    buffer_load_dwordx4 v7, s[4:7], s49 offen offset:0 nt lds
    v_mfma_f32_16x16x32_bf16 v[192:195], v[116:119], v[76:79], v[192:195]
    s_add_u32 m0, m0, s96
    ds_read_b128 v[40:43], v27 offset:11520
    v_mfma_f32_16x16x32_bf16 v[196:199], v[116:119], v[80:83], v[196:199]
    buffer_load_dwordx4 v7, s[4:7], s49 offen offset:256 nt lds
    v_mfma_f32_16x16x32_bf16 v[200:203], v[120:123], v[56:59], v[200:203]
    s_add_u32 m0, m0, s97
    ds_read_b128 v[44:47], v27 offset:12544
    v_mfma_f32_16x16x32_bf16 v[204:207], v[120:123], v[60:63], v[204:207]
    ds_read_b128 v[48:51], v27 offset:13568
    v_mfma_f32_16x16x32_bf16 v[208:211], v[120:123], v[64:67], v[208:211]
    ds_read_b128 v[52:55], v27 offset:14592
    v_mfma_f32_16x16x32_bf16 v[212:215], v[120:123], v[68:71], v[212:215]
    buffer_load_dwordx4 v7, s[4:7], s49 offen offset:512 nt lds
    v_mfma_f32_16x16x32_bf16 v[216:219], v[120:123], v[72:75], v[216:219]
    s_add_u32 m0, m0, s96
    ds_read_b64_tr_b16 v[116:117], v11 offset:8480
    v_mfma_f32_16x16x32_bf16 v[220:223], v[120:123], v[76:79], v[220:223]
    ds_read_b64_tr_b16 v[118:119], v11 offset:8736
    v_mfma_f32_16x16x32_bf16 v[224:227], v[120:123], v[80:83], v[224:227]
    ds_read_b64_tr_b16 v[120:121], v11 offset:8512
    v_mfma_f32_16x16x32_bf16 v[228:231], v[124:127], v[56:59], v[228:231]
    buffer_load_dwordx4 v7, s[4:7], s49 offen offset:768 nt lds
    v_mfma_f32_16x16x32_bf16 v[232:235], v[124:127], v[60:63], v[232:235]
    s_add_u32 m0, m0, s97
    ds_read_b64_tr_b16 v[122:123], v11 offset:8768
    v_mfma_f32_16x16x32_bf16 v[236:239], v[124:127], v[64:67], v[236:239]
    v_mfma_f32_16x16x32_bf16 v[240:243], v[124:127], v[68:71], v[240:243]
    v_mfma_f32_16x16x32_bf16 v[244:247], v[124:127], v[72:75], v[244:247]
    buffer_load_dwordx4 v7, s[4:7], s49 offen offset:1024 nt lds
    v_mfma_f32_16x16x32_bf16 v[248:251], v[124:127], v[76:79], v[248:251]
    s_add_u32 m0, m0, s96
    v_mfma_f32_16x16x32_bf16 v[252:255], v[124:127], v[80:83], v[252:255]
    ds_read_b64_tr_b16 v[124:125], v11 offset:8544
    v_mfma_f32_16x16x32_bf16 a[112:115], v[128:131], v[56:59], a[112:115]
    ds_read_b64_tr_b16 v[126:127], v11 offset:8800
    v_mfma_f32_16x16x32_bf16 a[116:119], v[128:131], v[60:63], a[116:119]
    buffer_load_dwordx4 v7, s[4:7], s49 offen offset:1280 nt lds
    v_mfma_f32_16x16x32_bf16 a[120:123], v[128:131], v[64:67], a[120:123]
    s_add_u32 m0, m0, s97
    v_mfma_f32_16x16x32_bf16 a[124:127], v[128:131], v[68:71], a[124:127]
    v_mfma_f32_16x16x32_bf16 a[128:131], v[128:131], v[72:75], a[128:131]
    v_mfma_f32_16x16x32_bf16 a[132:135], v[128:131], v[76:79], a[132:135]
    buffer_load_dwordx4 v7, s[4:7], s49 offen offset:1536 nt lds
    v_mfma_f32_16x16x32_bf16 a[136:139], v[128:131], v[80:83], a[136:139]
    s_add_u32 m0, m0, s96
    ds_read_b64_tr_b16 v[128:129], v11 offset:8576
    v_mfma_f32_16x16x32_bf16 a[140:143], v[132:135], v[56:59], a[140:143]
    ds_read_b64_tr_b16 v[130:131], v11 offset:8832
    v_mfma_f32_16x16x32_bf16 a[144:147], v[132:135], v[60:63], a[144:147]
    v_mfma_f32_16x16x32_bf16 a[148:151], v[132:135], v[64:67], a[148:151]
    buffer_load_dwordx4 v7, s[4:7], s49 offen offset:1792 nt lds
    v_mfma_f32_16x16x32_bf16 a[152:155], v[132:135], v[68:71], a[152:155]
    v_mfma_f32_16x16x32_bf16 a[156:159], v[132:135], v[72:75], a[156:159]
    s_cmp_eq_u32 s71, 0
    s_cselect_b32 s57, s56, 0x40000000
    v_mfma_f32_16x16x32_bf16 a[160:163], v[132:135], v[76:79], a[160:163]
    s_add_u32 m0, s58, 0
    v_mfma_f32_16x16x32_bf16 a[164:167], v[132:135], v[80:83], a[164:167]
    buffer_load_dwordx4 v88, s[84:87], s57 offen lds
    v_mfma_f32_16x16x32_bf16 a[168:171], v[136:139], v[56:59], a[168:171]
    ds_read_b64_tr_b16 v[132:133], v11 offset:8608
    v_mfma_f32_16x16x32_bf16 a[172:175], v[136:139], v[60:63], a[172:175]
    s_add_u32 m0, s58, 1024
    ds_read_b64_tr_b16 v[134:135], v11 offset:8864
    v_mfma_f32_16x16x32_bf16 a[176:179], v[136:139], v[64:67], a[176:179]
    buffer_load_dwordx4 v89, s[84:87], s57 offen lds
    v_mfma_f32_16x16x32_bf16 a[180:183], v[136:139], v[68:71], a[180:183]
    v_mfma_f32_16x16x32_bf16 a[184:187], v[136:139], v[72:75], a[184:187]
    s_add_u32 m0, s58, 2048
    v_mfma_f32_16x16x32_bf16 a[188:191], v[136:139], v[76:79], a[188:191]
    buffer_load_dwordx4 v90, s[84:87], s57 offen lds
    v_mfma_f32_16x16x32_bf16 a[192:195], v[136:139], v[80:83], a[192:195]
    ds_read_b64_tr_b16 v[136:137], v11 offset:8640
    v_mfma_f32_16x16x32_bf16 a[196:199], v[140:143], v[56:59], a[196:199]
    s_add_u32 m0, s58, 3072
    ds_read_b64_tr_b16 v[138:139], v11 offset:8896
    v_mfma_f32_16x16x32_bf16 a[200:203], v[140:143], v[60:63], a[200:203]
    buffer_load_dwordx4 v91, s[84:87], s57 offen lds
    v_mfma_f32_16x16x32_bf16 a[204:207], v[140:143], v[64:67], a[204:207]
    v_mfma_f32_16x16x32_bf16 a[208:211], v[140:143], v[68:71], a[208:211]
    s_add_u32 m0, s58, 4096
    v_mfma_f32_16x16x32_bf16 a[212:215], v[140:143], v[72:75], a[212:215]
    buffer_load_dwordx4 v92, s[84:87], s57 offen lds
    v_mfma_f32_16x16x32_bf16 a[216:219], v[140:143], v[76:79], a[216:219]
    v_mfma_f32_16x16x32_bf16 a[220:223], v[140:143], v[80:83], a[220:223]
    ds_read_b64_tr_b16 v[140:141], v11 offset:8672
    ds_read_b64_tr_b16 v[142:143], v11 offset:8928
    s_waitcnt lgkmcnt(14)
    v_mfma_f32_16x16x32_bf16 v[144:147], v[112:115], v[28:31], v[144:147]
    s_add_u32 s29, s34, s100
    v_mfma_f32_16x16x32_bf16 v[148:151], v[112:115], v[32:35], v[148:151]
    s_bfe_u32 s28, s29, 0x20003
    v_mfma_f32_16x16x32_bf16 v[152:155], v[112:115], v[36:39], v[152:155]
    s_lshl_b32 s28, s28, 16
    v_mfma_f32_16x16x32_bf16 v[156:159], v[112:115], v[40:43], v[156:159]
    s_and_b32 s29, s29, 7
    v_mfma_f32_16x16x32_bf16 v[160:163], v[112:115], v[44:47], v[160:163]
    s_lshl_b32 s29, s29, 11
    v_mfma_f32_16x16x32_bf16 v[164:167], v[112:115], v[48:51], v[164:167]
    s_add_u32 s29, s28, s29
    v_mfma_f32_16x16x32_bf16 v[168:171], v[112:115], v[52:55], v[168:171]
    s_lshr_b32 s28, s34, 5
    s_waitcnt vmcnt(21) lgkmcnt(0)
    s_barrier
    ds_read_b64_tr_b16 v[112:113], v11 offset:16896
    v_mfma_f32_16x16x32_bf16 v[172:175], v[116:119], v[28:31], v[172:175]
    s_lshl_b32 s28, s28, 19
    ds_read_b64_tr_b16 v[114:115], v11 offset:17152
    v_mfma_f32_16x16x32_bf16 v[176:179], v[116:119], v[32:35], v[176:179]
    s_add_u32 s49, s28, s29
    ds_read_b128 v[56:59], v27 offset:16896
    v_mfma_f32_16x16x32_bf16 v[180:183], v[116:119], v[36:39], v[180:183]
    s_add_u32 m0, s33, 8448
    ds_read_b128 v[60:63], v27 offset:17920
    v_mfma_f32_16x16x32_bf16 v[184:187], v[116:119], v[40:43], v[184:187]
    s_add_u32 s34, s34, 1
    ds_read_b128 v[64:67], v27 offset:18944
    v_mfma_f32_16x16x32_bf16 v[188:191], v[116:119], v[44:47], v[188:191]
    buffer_load_dwordx4 v7, s[4:7], s49 offen offset:0 nt lds
    v_mfma_f32_16x16x32_bf16 v[192:195], v[116:119], v[48:51], v[192:195]
    s_add_u32 m0, m0, s96
    ds_read_b128 v[68:71], v27 offset:19968
    v_mfma_f32_16x16x32_bf16 v[196:199], v[116:119], v[52:55], v[196:199]
    ds_read_b128 v[72:75], v27 offset:20992
    v_mfma_f32_16x16x32_bf16 v[200:203], v[120:123], v[28:31], v[200:203]
    ds_read_b128 v[76:79], v27 offset:22016
    v_mfma_f32_16x16x32_bf16 v[204:207], v[120:123], v[32:35], v[204:207]
    buffer_load_dwordx4 v7, s[4:7], s49 offen offset:256 nt lds
    v_mfma_f32_16x16x32_bf16 v[208:211], v[120:123], v[36:39], v[208:211]
    s_add_u32 m0, m0, s97
    ds_read_b128 v[80:83], v27 offset:23040
    v_mfma_f32_16x16x32_bf16 v[212:215], v[120:123], v[40:43], v[212:215]
    ds_read_b64_tr_b16 v[116:117], v11 offset:16928
    v_mfma_f32_16x16x32_bf16 v[216:219], v[120:123], v[44:47], v[216:219]
    ds_read_b64_tr_b16 v[118:119], v11 offset:17184
    v_mfma_f32_16x16x32_bf16 v[220:223], v[120:123], v[48:51], v[220:223]
    v_mfma_f32_16x16x32_bf16 v[224:227], v[120:123], v[52:55], v[224:227]
    ds_read_b64_tr_b16 v[120:121], v11 offset:16960
    v_mfma_f32_16x16x32_bf16 v[228:231], v[124:127], v[28:31], v[228:231]
    buffer_load_dwordx4 v7, s[4:7], s49 offen offset:512 nt lds
    v_mfma_f32_16x16x32_bf16 v[232:235], v[124:127], v[32:35], v[232:235]
    s_add_u32 m0, m0, s96
    ds_read_b64_tr_b16 v[122:123], v11 offset:17216
    v_mfma_f32_16x16x32_bf16 v[236:239], v[124:127], v[36:39], v[236:239]
    v_mfma_f32_16x16x32_bf16 v[240:243], v[124:127], v[40:43], v[240:243]
    v_mfma_f32_16x16x32_bf16 v[244:247], v[124:127], v[44:47], v[244:247]
    v_mfma_f32_16x16x32_bf16 v[248:251], v[124:127], v[48:51], v[248:251]
    v_mfma_f32_16x16x32_bf16 v[252:255], v[124:127], v[52:55], v[252:255]
    buffer_load_dwordx4 v7, s[4:7], s49 offen offset:768 nt lds
    v_mfma_f32_16x16x32_bf16 a[112:115], v[128:131], v[28:31], a[112:115]
    s_add_u32 m0, m0, s97
    ds_read_b64_tr_b16 v[124:125], v11 offset:16992
    v_mfma_f32_16x16x32_bf16 a[116:119], v[128:131], v[32:35], a[116:119]
    ds_read_b64_tr_b16 v[126:127], v11 offset:17248
    v_mfma_f32_16x16x32_bf16 a[120:123], v[128:131], v[36:39], a[120:123]
    v_mfma_f32_16x16x32_bf16 a[124:127], v[128:131], v[40:43], a[124:127]
    v_mfma_f32_16x16x32_bf16 a[128:131], v[128:131], v[44:47], a[128:131]
    v_mfma_f32_16x16x32_bf16 a[132:135], v[128:131], v[48:51], a[132:135]
    buffer_load_dwordx4 v7, s[4:7], s49 offen offset:1024 nt lds
    v_mfma_f32_16x16x32_bf16 a[136:139], v[128:131], v[52:55], a[136:139]
    s_add_u32 m0, m0, s96
    ds_read_b64_tr_b16 v[128:129], v11 offset:17024
    v_mfma_f32_16x16x32_bf16 a[140:143], v[132:135], v[28:31], a[140:143]
    ds_read_b64_tr_b16 v[130:131], v11 offset:17280
    v_mfma_f32_16x16x32_bf16 a[144:147], v[132:135], v[32:35], a[144:147]
    v_mfma_f32_16x16x32_bf16 a[148:151], v[132:135], v[36:39], a[148:151]
    v_mfma_f32_16x16x32_bf16 a[152:155], v[132:135], v[40:43], a[152:155]
    v_mfma_f32_16x16x32_bf16 a[156:159], v[132:135], v[44:47], a[156:159]
    buffer_load_dwordx4 v7, s[4:7], s49 offen offset:1280 nt lds
    v_mfma_f32_16x16x32_bf16 a[160:163], v[132:135], v[48:51], a[160:163]
    s_add_u32 m0, m0, s97
    v_mfma_f32_16x16x32_bf16 a[164:167], v[132:135], v[52:55], a[164:167]
    ds_read_b64_tr_b16 v[132:133], v11 offset:17056
    v_mfma_f32_16x16x32_bf16 a[168:171], v[136:139], v[28:31], a[168:171]
    ds_read_b64_tr_b16 v[134:135], v11 offset:17312
    v_mfma_f32_16x16x32_bf16 a[172:175], v[136:139], v[32:35], a[172:175]
    v_mfma_f32_16x16x32_bf16 a[176:179], v[136:139], v[36:39], a[176:179]
    v_mfma_f32_16x16x32_bf16 a[180:183], v[136:139], v[40:43], a[180:183]
    buffer_load_dwordx4 v7, s[4:7], s49 offen offset:1536 nt lds
    v_mfma_f32_16x16x32_bf16 a[184:187], v[136:139], v[44:47], a[184:187]
    s_add_u32 m0, m0, s96
    v_mfma_f32_16x16x32_bf16 a[188:191], v[136:139], v[48:51], a[188:191]
    v_mfma_f32_16x16x32_bf16 a[192:195], v[136:139], v[52:55], a[192:195]
    ds_read_b64_tr_b16 v[136:137], v11 offset:17088
    v_mfma_f32_16x16x32_bf16 a[196:199], v[140:143], v[28:31], a[196:199]
    ds_read_b64_tr_b16 v[138:139], v11 offset:17344
    v_mfma_f32_16x16x32_bf16 a[200:203], v[140:143], v[32:35], a[200:203]
    v_mfma_f32_16x16x32_bf16 a[204:207], v[140:143], v[36:39], a[204:207]
    buffer_load_dwordx4 v7, s[4:7], s49 offen offset:1792 nt lds
    v_mfma_f32_16x16x32_bf16 a[208:211], v[140:143], v[40:43], a[208:211]
    v_mfma_f32_16x16x32_bf16 a[212:215], v[140:143], v[44:47], a[212:215]
    v_mfma_f32_16x16x32_bf16 a[216:219], v[140:143], v[48:51], a[216:219]
    v_mfma_f32_16x16x32_bf16 a[220:223], v[140:143], v[52:55], a[220:223]
    ds_read_b64_tr_b16 v[140:141], v11 offset:17120
    ds_read_b64_tr_b16 v[142:143], v11 offset:17376
    s_waitcnt lgkmcnt(14)
    v_mfma_f32_16x16x32_bf16 v[144:147], v[112:115], v[56:59], v[144:147]
    s_add_u32 s29, s34, s100
    v_mfma_f32_16x16x32_bf16 v[148:151], v[112:115], v[60:63], v[148:151]
    s_bfe_u32 s28, s29, 0x20003
    v_mfma_f32_16x16x32_bf16 v[152:155], v[112:115], v[64:67], v[152:155]
    s_lshl_b32 s28, s28, 16
    v_mfma_f32_16x16x32_bf16 v[156:159], v[112:115], v[68:71], v[156:159]
    s_and_b32 s29, s29, 7
    v_mfma_f32_16x16x32_bf16 v[160:163], v[112:115], v[72:75], v[160:163]
    s_lshl_b32 s29, s29, 11
    v_mfma_f32_16x16x32_bf16 v[164:167], v[112:115], v[76:79], v[164:167]
    s_add_u32 s29, s28, s29
    v_mfma_f32_16x16x32_bf16 v[168:171], v[112:115], v[80:83], v[168:171]
    s_lshr_b32 s28, s34, 5
    s_waitcnt vmcnt(21) lgkmcnt(0)
    s_barrier
    ds_read_b64_tr_b16 v[112:113], v11 offset:25344
    v_mfma_f32_16x16x32_bf16 v[172:175], v[116:119], v[56:59], v[172:175]
    s_lshl_b32 s28, s28, 19
    ds_read_b64_tr_b16 v[114:115], v11 offset:25600
    v_mfma_f32_16x16x32_bf16 v[176:179], v[116:119], v[60:63], v[176:179]
    s_add_u32 s49, s28, s29
    ds_read_b128 v[28:31], v27 offset:25344
    v_mfma_f32_16x16x32_bf16 v[180:183], v[116:119], v[64:67], v[180:183]
    s_add_u32 m0, s33, 16896
    ds_read_b128 v[32:35], v27 offset:26368
    v_mfma_f32_16x16x32_bf16 v[184:187], v[116:119], v[68:71], v[184:187]
    s_add_u32 s34, s34, 1
    ds_read_b128 v[36:39], v27 offset:27392
    v_mfma_f32_16x16x32_bf16 v[188:191], v[116:119], v[72:75], v[188:191]
    buffer_load_dwordx4 v7, s[4:7], s49 offen offset:0 nt lds
    v_mfma_f32_16x16x32_bf16 v[192:195], v[116:119], v[76:79], v[192:195]
    s_add_u32 m0, m0, s96
    ds_read_b128 v[40:43], v27 offset:28416
    v_mfma_f32_16x16x32_bf16 v[196:199], v[116:119], v[80:83], v[196:199]
    ds_read_b128 v[44:47], v27 offset:29440
    v_mfma_f32_16x16x32_bf16 v[200:203], v[120:123], v[56:59], v[200:203]
    ds_read_b128 v[48:51], v27 offset:30464
    v_mfma_f32_16x16x32_bf16 v[204:207], v[120:123], v[60:63], v[204:207]
    buffer_load_dwordx4 v7, s[4:7], s49 offen offset:256 nt lds
    v_mfma_f32_16x16x32_bf16 v[208:211], v[120:123], v[64:67], v[208:211]
    s_add_u32 m0, m0, s97
    ds_read_b128 v[52:55], v27 offset:31488
    v_mfma_f32_16x16x32_bf16 v[212:215], v[120:123], v[68:71], v[212:215]
    ds_read_b64_tr_b16 v[116:117], v11 offset:25376
    v_mfma_f32_16x16x32_bf16 v[216:219], v[120:123], v[72:75], v[216:219]
    ds_read_b64_tr_b16 v[118:119], v11 offset:25632
    v_mfma_f32_16x16x32_bf16 v[220:223], v[120:123], v[76:79], v[220:223]
    v_mfma_f32_16x16x32_bf16 v[224:227], v[120:123], v[80:83], v[224:227]
    ds_read_b64_tr_b16 v[120:121], v11 offset:25408
    v_mfma_f32_16x16x32_bf16 v[228:231], v[124:127], v[56:59], v[228:231]
    buffer_load_dwordx4 v7, s[4:7], s49 offen offset:512 nt lds
    v_mfma_f32_16x16x32_bf16 v[232:235], v[124:127], v[60:63], v[232:235]
    s_add_u32 m0, m0, s96
    ds_read_b64_tr_b16 v[122:123], v11 offset:25664
    v_mfma_f32_16x16x32_bf16 v[236:239], v[124:127], v[64:67], v[236:239]
    v_mfma_f32_16x16x32_bf16 v[240:243], v[124:127], v[68:71], v[240:243]
    v_mfma_f32_16x16x32_bf16 v[244:247], v[124:127], v[72:75], v[244:247]
    v_mfma_f32_16x16x32_bf16 v[248:251], v[124:127], v[76:79], v[248:251]
    v_mfma_f32_16x16x32_bf16 v[252:255], v[124:127], v[80:83], v[252:255]
    buffer_load_dwordx4 v7, s[4:7], s49 offen offset:768 nt lds
    v_mfma_f32_16x16x32_bf16 a[112:115], v[128:131], v[56:59], a[112:115]
    s_add_u32 m0, m0, s97
    ds_read_b64_tr_b16 v[124:125], v11 offset:25440
    v_mfma_f32_16x16x32_bf16 a[116:119], v[128:131], v[60:63], a[116:119]
    ds_read_b64_tr_b16 v[126:127], v11 offset:25696
    v_mfma_f32_16x16x32_bf16 a[120:123], v[128:131], v[64:67], a[120:123]
    v_mfma_f32_16x16x32_bf16 a[124:127], v[128:131], v[68:71], a[124:127]
    v_mfma_f32_16x16x32_bf16 a[128:131], v[128:131], v[72:75], a[128:131]
    v_mfma_f32_16x16x32_bf16 a[132:135], v[128:131], v[76:79], a[132:135]
    buffer_load_dwordx4 v7, s[4:7], s49 offen offset:1024 nt lds
    v_mfma_f32_16x16x32_bf16 a[136:139], v[128:131], v[80:83], a[136:139]
    s_add_u32 m0, m0, s96
    ds_read_b64_tr_b16 v[128:129], v11 offset:25472
    v_mfma_f32_16x16x32_bf16 a[140:143], v[132:135], v[56:59], a[140:143]
    ds_read_b64_tr_b16 v[130:131], v11 offset:25728
    v_mfma_f32_16x16x32_bf16 a[144:147], v[132:135], v[60:63], a[144:147]
    v_mfma_f32_16x16x32_bf16 a[148:151], v[132:135], v[64:67], a[148:151]
    v_mfma_f32_16x16x32_bf16 a[152:155], v[132:135], v[68:71], a[152:155]
    v_mfma_f32_16x16x32_bf16 a[156:159], v[132:135], v[72:75], a[156:159]
    buffer_load_dwordx4 v7, s[4:7], s49 offen offset:1280 nt lds
    v_mfma_f32_16x16x32_bf16 a[160:163], v[132:135], v[76:79], a[160:163]
    s_add_u32 m0, m0, s97
    v_mfma_f32_16x16x32_bf16 a[164:167], v[132:135], v[80:83], a[164:167]
    ds_read_b64_tr_b16 v[132:133], v11 offset:25504
    v_mfma_f32_16x16x32_bf16 a[168:171], v[136:139], v[56:59], a[168:171]
    ds_read_b64_tr_b16 v[134:135], v11 offset:25760
    v_mfma_f32_16x16x32_bf16 a[172:175], v[136:139], v[60:63], a[172:175]
    v_mfma_f32_16x16x32_bf16 a[176:179], v[136:139], v[64:67], a[176:179]
    v_mfma_f32_16x16x32_bf16 a[180:183], v[136:139], v[68:71], a[180:183]
    buffer_load_dwordx4 v7, s[4:7], s49 offen offset:1536 nt lds
    v_mfma_f32_16x16x32_bf16 a[184:187], v[136:139], v[72:75], a[184:187]
    s_add_u32 m0, m0, s96
    v_mfma_f32_16x16x32_bf16 a[188:191], v[136:139], v[76:79], a[188:191]
    v_mfma_f32_16x16x32_bf16 a[192:195], v[136:139], v[80:83], a[192:195]
    ds_read_b64_tr_b16 v[136:137], v11 offset:25536
    v_mfma_f32_16x16x32_bf16 a[196:199], v[140:143], v[56:59], a[196:199]
    ds_read_b64_tr_b16 v[138:139], v11 offset:25792
    v_mfma_f32_16x16x32_bf16 a[200:203], v[140:143], v[60:63], a[200:203]
    v_mfma_f32_16x16x32_bf16 a[204:207], v[140:143], v[64:67], a[204:207]
    buffer_load_dwordx4 v7, s[4:7], s49 offen offset:1792 nt lds
    v_mfma_f32_16x16x32_bf16 a[208:211], v[140:143], v[68:71], a[208:211]
    v_mfma_f32_16x16x32_bf16 a[212:215], v[140:143], v[72:75], a[212:215]
    v_mfma_f32_16x16x32_bf16 a[216:219], v[140:143], v[76:79], a[216:219]
    v_mfma_f32_16x16x32_bf16 a[220:223], v[140:143], v[80:83], a[220:223]
    ds_read_b64_tr_b16 v[140:141], v11 offset:25568
    ds_read_b64_tr_b16 v[142:143], v11 offset:25824
    s_waitcnt lgkmcnt(14)
    v_mfma_f32_16x16x32_bf16 v[144:147], v[112:115], v[28:31], v[144:147]
    s_add_u32 s29, s34, s100
    v_mfma_f32_16x16x32_bf16 v[148:151], v[112:115], v[32:35], v[148:151]
    s_bfe_u32 s28, s29, 0x20003
    v_mfma_f32_16x16x32_bf16 v[152:155], v[112:115], v[36:39], v[152:155]
    s_lshl_b32 s28, s28, 16
    v_mfma_f32_16x16x32_bf16 v[156:159], v[112:115], v[40:43], v[156:159]
    s_and_b32 s29, s29, 7
    v_mfma_f32_16x16x32_bf16 v[160:163], v[112:115], v[44:47], v[160:163]
    s_lshl_b32 s29, s29, 11
    v_mfma_f32_16x16x32_bf16 v[164:167], v[112:115], v[48:51], v[164:167]
    s_add_u32 s29, s28, s29
    v_mfma_f32_16x16x32_bf16 v[168:171], v[112:115], v[52:55], v[168:171]
    s_lshr_b32 s28, s34, 5
    s_waitcnt vmcnt(21) lgkmcnt(0)
    s_barrier
    ds_read_b128 v[56:59], v8 offset:0
    v_mfma_f32_16x16x32_bf16 v[172:175], v[116:119], v[28:31], v[172:175]
    s_lshl_b32 s28, s28, 19
    ds_read_b128 v[60:63], v8 offset:64
    v_mfma_f32_16x16x32_bf16 v[176:179], v[116:119], v[32:35], v[176:179]
    s_add_u32 s49, s28, s29
    ds_read_b128 v[64:67], v8 offset:128
    v_mfma_f32_16x16x32_bf16 v[180:183], v[116:119], v[36:39], v[180:183]
    s_add_u32 m0, s33, 25344
    ds_read_b128 v[68:71], v8 offset:192
    v_mfma_f32_16x16x32_bf16 v[184:187], v[116:119], v[40:43], v[184:187]
    s_add_u32 s34, s34, 1
    ds_read_b128 v[72:75], v8 offset:512
    v_mfma_f32_16x16x32_bf16 v[188:191], v[116:119], v[44:47], v[188:191]
    buffer_load_dwordx4 v7, s[4:7], s49 offen offset:0 nt lds
    v_mfma_f32_16x16x32_bf16 v[192:195], v[116:119], v[48:51], v[192:195]
    s_add_u32 m0, m0, s96
    ds_read_b128 v[76:79], v8 offset:576
    v_mfma_f32_16x16x32_bf16 v[196:199], v[116:119], v[52:55], v[196:199]
    ds_read_b128 v[80:83], v8 offset:640
    v_mfma_f32_16x16x32_bf16 v[200:203], v[120:123], v[28:31], v[200:203]
    ds_read_b128 v[84:87], v8 offset:704
    v_mfma_f32_16x16x32_bf16 v[204:207], v[120:123], v[32:35], v[204:207]
    buffer_load_dwordx4 v7, s[4:7], s49 offen offset:256 nt lds
    v_mfma_f32_16x16x32_bf16 v[208:211], v[120:123], v[36:39], v[208:211]
    s_add_u32 m0, m0, s97
    v_mfma_f32_16x16x32_bf16 v[212:215], v[120:123], v[40:43], v[212:215]
    v_mfma_f32_16x16x32_bf16 v[216:219], v[120:123], v[44:47], v[216:219]
    v_mfma_f32_16x16x32_bf16 v[220:223], v[120:123], v[48:51], v[220:223]
    v_mfma_f32_16x16x32_bf16 v[224:227], v[120:123], v[52:55], v[224:227]
    v_mfma_f32_16x16x32_bf16 v[228:231], v[124:127], v[28:31], v[228:231]
    buffer_load_dwordx4 v7, s[4:7], s49 offen offset:512 nt lds
    v_mfma_f32_16x16x32_bf16 v[232:235], v[124:127], v[32:35], v[232:235]
    s_add_u32 m0, m0, s96
    v_mfma_f32_16x16x32_bf16 v[236:239], v[124:127], v[36:39], v[236:239]
    v_mfma_f32_16x16x32_bf16 v[240:243], v[124:127], v[40:43], v[240:243]
    v_mfma_f32_16x16x32_bf16 v[244:247], v[124:127], v[44:47], v[244:247]
    v_mfma_f32_16x16x32_bf16 v[248:251], v[124:127], v[48:51], v[248:251]
    v_mfma_f32_16x16x32_bf16 v[252:255], v[124:127], v[52:55], v[252:255]
    buffer_load_dwordx4 v7, s[4:7], s49 offen offset:768 nt lds
    v_mfma_f32_16x16x32_bf16 a[112:115], v[128:131], v[28:31], a[112:115]
    s_add_u32 m0, m0, s97
    v_mfma_f32_16x16x32_bf16 a[116:119], v[128:131], v[32:35], a[116:119]
    v_mfma_f32_16x16x32_bf16 a[120:123], v[128:131], v[36:39], a[120:123]
    v_mfma_f32_16x16x32_bf16 a[124:127], v[128:131], v[40:43], a[124:127]
    v_mfma_f32_16x16x32_bf16 a[128:131], v[128:131], v[44:47], a[128:131]
    v_mfma_f32_16x16x32_bf16 a[132:135], v[128:131], v[48:51], a[132:135]
    buffer_load_dwordx4 v7, s[4:7], s49 offen offset:1024 nt lds
    v_mfma_f32_16x16x32_bf16 a[136:139], v[128:131], v[52:55], a[136:139]
    s_add_u32 m0, m0, s96
    v_mfma_f32_16x16x32_bf16 a[140:143], v[132:135], v[28:31], a[140:143]
    v_mfma_f32_16x16x32_bf16 a[144:147], v[132:135], v[32:35], a[144:147]
    v_mfma_f32_16x16x32_bf16 a[148:151], v[132:135], v[36:39], a[148:151]
    v_mfma_f32_16x16x32_bf16 a[152:155], v[132:135], v[40:43], a[152:155]
    v_mfma_f32_16x16x32_bf16 a[156:159], v[132:135], v[44:47], a[156:159]
    buffer_load_dwordx4 v7, s[4:7], s49 offen offset:1280 nt lds
    v_mfma_f32_16x16x32_bf16 a[160:163], v[132:135], v[48:51], a[160:163]
    s_add_u32 m0, m0, s97
    v_mfma_f32_16x16x32_bf16 a[164:167], v[132:135], v[52:55], a[164:167]
    v_mfma_f32_16x16x32_bf16 a[168:171], v[136:139], v[28:31], a[168:171]
    v_mfma_f32_16x16x32_bf16 a[172:175], v[136:139], v[32:35], a[172:175]
    v_mfma_f32_16x16x32_bf16 a[176:179], v[136:139], v[36:39], a[176:179]
    v_mfma_f32_16x16x32_bf16 a[180:183], v[136:139], v[40:43], a[180:183]
    buffer_load_dwordx4 v7, s[4:7], s49 offen offset:1536 nt lds
    v_mfma_f32_16x16x32_bf16 a[184:187], v[136:139], v[44:47], a[184:187]
    s_add_u32 m0, m0, s96
    v_mfma_f32_16x16x32_bf16 a[188:191], v[136:139], v[48:51], a[188:191]
    v_mfma_f32_16x16x32_bf16 a[192:195], v[136:139], v[52:55], a[192:195]
    v_mfma_f32_16x16x32_bf16 a[196:199], v[140:143], v[28:31], a[196:199]
    v_mfma_f32_16x16x32_bf16 a[200:203], v[140:143], v[32:35], a[200:203]
    v_mfma_f32_16x16x32_bf16 a[204:207], v[140:143], v[36:39], a[204:207]
    buffer_load_dwordx4 v7, s[4:7], s49 offen offset:1792 nt lds
    v_mfma_f32_16x16x32_bf16 a[208:211], v[140:143], v[40:43], a[208:211]
    v_mfma_f32_16x16x32_bf16 a[212:215], v[140:143], v[44:47], a[212:215]
    v_mfma_f32_16x16x32_bf16 a[216:219], v[140:143], v[48:51], a[216:219]
    v_mfma_f32_16x16x32_bf16 a[220:223], v[140:143], v[52:55], a[220:223]
    s_branch L_at_qpepi
L_at_qptailB:
    s_mul_i32 s50, s21, s52
    s_mov_b32 s101, s21
    s_add_u32 s50, s50, s55
    s_cmp_ge_u32 s21, 2
    s_cselect_b32 s28, 0x40000000, 0
    s_add_u32 s50, s50, s28
    s_mov_b32 s82, s26
    s_mul_i32 s28, s26, s51
    s_add_u32 s50, s50, s28
    s_waitcnt lgkmcnt(14)
    v_mfma_f32_16x16x32_bf16 v[144:147], v[112:115], v[56:59], v[144:147]
    s_add_u32 m0, s33, 0
    v_mfma_f32_16x16x32_bf16 v[148:151], v[112:115], v[60:63], v[148:151]
    s_mov_b32 s49, s50
    v_mfma_f32_16x16x32_bf16 v[152:155], v[112:115], v[64:67], v[152:155]
    s_add_u32 s50, s50, s51
    v_mfma_f32_16x16x32_bf16 v[156:159], v[112:115], v[68:71], v[156:159]
    s_add_u32 s82, s82, 1
    v_mfma_f32_16x16x32_bf16 v[160:163], v[112:115], v[72:75], v[160:163]
    s_cmp_eq_u32 s82, 20
    v_mfma_f32_16x16x32_bf16 v[164:167], v[112:115], v[76:79], v[164:167]
    s_cselect_b32 s29, s83, 0
    v_mfma_f32_16x16x32_bf16 v[168:171], v[112:115], v[80:83], v[168:171]
    s_sub_u32 s50, s50, s29
    s_waitcnt vmcnt(16) lgkmcnt(0)
    s_barrier
    ds_read_b64_tr_b16 v[112:113], v11 offset:8448
    v_mfma_f32_16x16x32_bf16 v[172:175], v[116:119], v[56:59], v[172:175]
    ds_read_b64_tr_b16 v[114:115], v11 offset:8704
    v_mfma_f32_16x16x32_bf16 v[176:179], v[116:119], v[60:63], v[176:179]
    ds_read_b128 v[28:31], v27 offset:8448
    v_mfma_f32_16x16x32_bf16 v[180:183], v[116:119], v[64:67], v[180:183]
    s_add_u32 s28, s49, s88
    buffer_load_dwordx4 v26, s[16:19], s28 offen lds
    v_mfma_f32_16x16x32_bf16 v[184:187], v[116:119], v[68:71], v[184:187]
    s_add_u32 m0, m0, s53
    ds_read_b128 v[32:35], v27 offset:9472
    v_mfma_f32_16x16x32_bf16 v[188:191], v[116:119], v[72:75], v[188:191]
    ds_read_b128 v[36:39], v27 offset:10496
    v_mfma_f32_16x16x32_bf16 v[192:195], v[116:119], v[76:79], v[192:195]
    ds_read_b128 v[40:43], v27 offset:11520
    v_mfma_f32_16x16x32_bf16 v[196:199], v[116:119], v[80:83], v[196:199]
    ds_read_b128 v[44:47], v27 offset:12544
    v_mfma_f32_16x16x32_bf16 v[200:203], v[120:123], v[56:59], v[200:203]
    ds_read_b128 v[48:51], v27 offset:13568
    v_mfma_f32_16x16x32_bf16 v[204:207], v[120:123], v[60:63], v[204:207]
    s_add_u32 s28, s49, s89
    buffer_load_dwordx4 v26, s[16:19], s28 offen lds
    v_mfma_f32_16x16x32_bf16 v[208:211], v[120:123], v[64:67], v[208:211]
    s_add_u32 m0, m0, s53
    ds_read_b128 v[52:55], v27 offset:14592
    v_mfma_f32_16x16x32_bf16 v[212:215], v[120:123], v[68:71], v[212:215]
    ds_read_b64_tr_b16 v[116:117], v11 offset:8480
    v_mfma_f32_16x16x32_bf16 v[216:219], v[120:123], v[72:75], v[216:219]
    ds_read_b64_tr_b16 v[118:119], v11 offset:8736
    v_mfma_f32_16x16x32_bf16 v[220:223], v[120:123], v[76:79], v[220:223]
    v_mfma_f32_16x16x32_bf16 v[224:227], v[120:123], v[80:83], v[224:227]
    ds_read_b64_tr_b16 v[120:121], v11 offset:8512
    v_mfma_f32_16x16x32_bf16 v[228:231], v[124:127], v[56:59], v[228:231]
    s_add_u32 s28, s49, s90
    buffer_load_dwordx4 v26, s[16:19], s28 offen lds
    v_mfma_f32_16x16x32_bf16 v[232:235], v[124:127], v[60:63], v[232:235]
    s_add_u32 m0, m0, s53
    ds_read_b64_tr_b16 v[122:123], v11 offset:8768
    v_mfma_f32_16x16x32_bf16 v[236:239], v[124:127], v[64:67], v[236:239]
    v_mfma_f32_16x16x32_bf16 v[240:243], v[124:127], v[68:71], v[240:243]
    v_mfma_f32_16x16x32_bf16 v[244:247], v[124:127], v[72:75], v[244:247]
    v_mfma_f32_16x16x32_bf16 v[248:251], v[124:127], v[76:79], v[248:251]
    v_mfma_f32_16x16x32_bf16 v[252:255], v[124:127], v[80:83], v[252:255]
    s_add_u32 s28, s49, s91
    buffer_load_dwordx4 v26, s[16:19], s28 offen lds
    v_mfma_f32_16x16x32_bf16 a[112:115], v[128:131], v[56:59], a[112:115]
    s_add_u32 m0, m0, s53
    ds_read_b64_tr_b16 v[124:125], v11 offset:8544
    v_mfma_f32_16x16x32_bf16 a[116:119], v[128:131], v[60:63], a[116:119]
    ds_read_b64_tr_b16 v[126:127], v11 offset:8800
    v_mfma_f32_16x16x32_bf16 a[120:123], v[128:131], v[64:67], a[120:123]
    v_mfma_f32_16x16x32_bf16 a[124:127], v[128:131], v[68:71], a[124:127]
    v_mfma_f32_16x16x32_bf16 a[128:131], v[128:131], v[72:75], a[128:131]
    v_mfma_f32_16x16x32_bf16 a[132:135], v[128:131], v[76:79], a[132:135]
    s_add_u32 s28, s49, s92
    buffer_load_dwordx4 v26, s[16:19], s28 offen lds
    v_mfma_f32_16x16x32_bf16 a[136:139], v[128:131], v[80:83], a[136:139]
    s_add_u32 m0, m0, s53
    ds_read_b64_tr_b16 v[128:129], v11 offset:8576
    v_mfma_f32_16x16x32_bf16 a[140:143], v[132:135], v[56:59], a[140:143]
    ds_read_b64_tr_b16 v[130:131], v11 offset:8832
    v_mfma_f32_16x16x32_bf16 a[144:147], v[132:135], v[60:63], a[144:147]
    v_mfma_f32_16x16x32_bf16 a[148:151], v[132:135], v[64:67], a[148:151]
    v_mfma_f32_16x16x32_bf16 a[152:155], v[132:135], v[68:71], a[152:155]
    v_mfma_f32_16x16x32_bf16 a[156:159], v[132:135], v[72:75], a[156:159]
    s_add_u32 s28, s49, s93
    buffer_load_dwordx4 v26, s[16:19], s28 offen lds
    v_mfma_f32_16x16x32_bf16 a[160:163], v[132:135], v[76:79], a[160:163]
    s_add_u32 m0, m0, s53
    v_mfma_f32_16x16x32_bf16 a[164:167], v[132:135], v[80:83], a[164:167]
    ds_read_b64_tr_b16 v[132:133], v11 offset:8608
    v_mfma_f32_16x16x32_bf16 a[168:171], v[136:139], v[56:59], a[168:171]
    ds_read_b64_tr_b16 v[134:135], v11 offset:8864
    v_mfma_f32_16x16x32_bf16 a[172:175], v[136:139], v[60:63], a[172:175]
    v_mfma_f32_16x16x32_bf16 a[176:179], v[136:139], v[64:67], a[176:179]
    v_mfma_f32_16x16x32_bf16 a[180:183], v[136:139], v[68:71], a[180:183]
    s_add_u32 s28, s49, s94
    buffer_load_dwordx4 v26, s[16:19], s28 offen lds
    v_mfma_f32_16x16x32_bf16 a[184:187], v[136:139], v[72:75], a[184:187]
    s_add_u32 m0, m0, s53
    v_mfma_f32_16x16x32_bf16 a[188:191], v[136:139], v[76:79], a[188:191]
    v_mfma_f32_16x16x32_bf16 a[192:195], v[136:139], v[80:83], a[192:195]
    ds_read_b64_tr_b16 v[136:137], v11 offset:8640
    v_mfma_f32_16x16x32_bf16 a[196:199], v[140:143], v[56:59], a[196:199]
    ds_read_b64_tr_b16 v[138:139], v11 offset:8896
    v_mfma_f32_16x16x32_bf16 a[200:203], v[140:143], v[60:63], a[200:203]
    v_mfma_f32_16x16x32_bf16 a[204:207], v[140:143], v[64:67], a[204:207]
    s_add_u32 s28, s49, s95
    buffer_load_dwordx4 v26, s[16:19], s28 offen lds
    v_mfma_f32_16x16x32_bf16 a[208:211], v[140:143], v[68:71], a[208:211]
    v_mfma_f32_16x16x32_bf16 a[212:215], v[140:143], v[72:75], a[212:215]
    v_mfma_f32_16x16x32_bf16 a[216:219], v[140:143], v[76:79], a[216:219]
    v_mfma_f32_16x16x32_bf16 a[220:223], v[140:143], v[80:83], a[220:223]
    ds_read_b64_tr_b16 v[140:141], v11 offset:8672
    ds_read_b64_tr_b16 v[142:143], v11 offset:8928
    s_waitcnt lgkmcnt(14)
    v_mfma_f32_16x16x32_bf16 v[144:147], v[112:115], v[28:31], v[144:147]
    s_add_u32 m0, s33, 8448
    v_mfma_f32_16x16x32_bf16 v[148:151], v[112:115], v[32:35], v[148:151]
    s_mov_b32 s49, s50
    v_mfma_f32_16x16x32_bf16 v[152:155], v[112:115], v[36:39], v[152:155]
    s_add_u32 s50, s50, s51
    v_mfma_f32_16x16x32_bf16 v[156:159], v[112:115], v[40:43], v[156:159]
    s_add_u32 s82, s82, 1
    v_mfma_f32_16x16x32_bf16 v[160:163], v[112:115], v[44:47], v[160:163]
    s_cmp_eq_u32 s82, 20
    v_mfma_f32_16x16x32_bf16 v[164:167], v[112:115], v[48:51], v[164:167]
    s_cselect_b32 s29, s83, 0
    v_mfma_f32_16x16x32_bf16 v[168:171], v[112:115], v[52:55], v[168:171]
    s_sub_u32 s50, s50, s29
    s_waitcnt vmcnt(16) lgkmcnt(0)
    s_barrier
    ds_read_b64_tr_b16 v[112:113], v11 offset:16896
    v_mfma_f32_16x16x32_bf16 v[172:175], v[116:119], v[28:31], v[172:175]
    ds_read_b64_tr_b16 v[114:115], v11 offset:17152
    v_mfma_f32_16x16x32_bf16 v[176:179], v[116:119], v[32:35], v[176:179]
    ds_read_b128 v[56:59], v27 offset:16896
    v_mfma_f32_16x16x32_bf16 v[180:183], v[116:119], v[36:39], v[180:183]
    s_add_u32 s28, s49, s88
    buffer_load_dwordx4 v26, s[16:19], s28 offen lds
    v_mfma_f32_16x16x32_bf16 v[184:187], v[116:119], v[40:43], v[184:187]
    s_add_u32 m0, m0, s53
    ds_read_b128 v[60:63], v27 offset:17920
    v_mfma_f32_16x16x32_bf16 v[188:191], v[116:119], v[44:47], v[188:191]
    ds_read_b128 v[64:67], v27 offset:18944
    v_mfma_f32_16x16x32_bf16 v[192:195], v[116:119], v[48:51], v[192:195]
    ds_read_b128 v[68:71], v27 offset:19968
    v_mfma_f32_16x16x32_bf16 v[196:199], v[116:119], v[52:55], v[196:199]
    ds_read_b128 v[72:75], v27 offset:20992
    v_mfma_f32_16x16x32_bf16 v[200:203], v[120:123], v[28:31], v[200:203]
    ds_read_b128 v[76:79], v27 offset:22016
    v_mfma_f32_16x16x32_bf16 v[204:207], v[120:123], v[32:35], v[204:207]
    s_add_u32 s28, s49, s89
    buffer_load_dwordx4 v26, s[16:19], s28 offen lds
    v_mfma_f32_16x16x32_bf16 v[208:211], v[120:123], v[36:39], v[208:211]
    s_add_u32 m0, m0, s53
    ds_read_b128 v[80:83], v27 offset:23040
    v_mfma_f32_16x16x32_bf16 v[212:215], v[120:123], v[40:43], v[212:215]
    ds_read_b64_tr_b16 v[116:117], v11 offset:16928
    v_mfma_f32_16x16x32_bf16 v[216:219], v[120:123], v[44:47], v[216:219]
    ds_read_b64_tr_b16 v[118:119], v11 offset:17184
    v_mfma_f32_16x16x32_bf16 v[220:223], v[120:123], v[48:51], v[220:223]
    v_mfma_f32_16x16x32_bf16 v[224:227], v[120:123], v[52:55], v[224:227]
    ds_read_b64_tr_b16 v[120:121], v11 offset:16960
    v_mfma_f32_16x16x32_bf16 v[228:231], v[124:127], v[28:31], v[228:231]
    s_add_u32 s28, s49, s90
    buffer_load_dwordx4 v26, s[16:19], s28 offen lds
    v_mfma_f32_16x16x32_bf16 v[232:235], v[124:127], v[32:35], v[232:235]
    s_add_u32 m0, m0, s53
    ds_read_b64_tr_b16 v[122:123], v11 offset:17216
    v_mfma_f32_16x16x32_bf16 v[236:239], v[124:127], v[36:39], v[236:239]
    v_mfma_f32_16x16x32_bf16 v[240:243], v[124:127], v[40:43], v[240:243]
    v_mfma_f32_16x16x32_bf16 v[244:247], v[124:127], v[44:47], v[244:247]
    v_mfma_f32_16x16x32_bf16 v[248:251], v[124:127], v[48:51], v[248:251]
    v_mfma_f32_16x16x32_bf16 v[252:255], v[124:127], v[52:55], v[252:255]
    s_add_u32 s28, s49, s91
    buffer_load_dwordx4 v26, s[16:19], s28 offen lds
    v_mfma_f32_16x16x32_bf16 a[112:115], v[128:131], v[28:31], a[112:115]
    s_add_u32 m0, m0, s53
    ds_read_b64_tr_b16 v[124:125], v11 offset:16992
    v_mfma_f32_16x16x32_bf16 a[116:119], v[128:131], v[32:35], a[116:119]
    ds_read_b64_tr_b16 v[126:127], v11 offset:17248
    v_mfma_f32_16x16x32_bf16 a[120:123], v[128:131], v[36:39], a[120:123]
    v_mfma_f32_16x16x32_bf16 a[124:127], v[128:131], v[40:43], a[124:127]
    v_mfma_f32_16x16x32_bf16 a[128:131], v[128:131], v[44:47], a[128:131]
    v_mfma_f32_16x16x32_bf16 a[132:135], v[128:131], v[48:51], a[132:135]
    s_add_u32 s28, s49, s92
    buffer_load_dwordx4 v26, s[16:19], s28 offen lds
    v_mfma_f32_16x16x32_bf16 a[136:139], v[128:131], v[52:55], a[136:139]
    s_add_u32 m0, m0, s53
    ds_read_b64_tr_b16 v[128:129], v11 offset:17024
    v_mfma_f32_16x16x32_bf16 a[140:143], v[132:135], v[28:31], a[140:143]
    ds_read_b64_tr_b16 v[130:131], v11 offset:17280
    v_mfma_f32_16x16x32_bf16 a[144:147], v[132:135], v[32:35], a[144:147]
    v_mfma_f32_16x16x32_bf16 a[148:151], v[132:135], v[36:39], a[148:151]
    v_mfma_f32_16x16x32_bf16 a[152:155], v[132:135], v[40:43], a[152:155]
    v_mfma_f32_16x16x32_bf16 a[156:159], v[132:135], v[44:47], a[156:159]
    s_add_u32 s28, s49, s93
    buffer_load_dwordx4 v26, s[16:19], s28 offen lds
    v_mfma_f32_16x16x32_bf16 a[160:163], v[132:135], v[48:51], a[160:163]
    s_add_u32 m0, m0, s53
    v_mfma_f32_16x16x32_bf16 a[164:167], v[132:135], v[52:55], a[164:167]
    ds_read_b64_tr_b16 v[132:133], v11 offset:17056
    v_mfma_f32_16x16x32_bf16 a[168:171], v[136:139], v[28:31], a[168:171]
    ds_read_b64_tr_b16 v[134:135], v11 offset:17312
    v_mfma_f32_16x16x32_bf16 a[172:175], v[136:139], v[32:35], a[172:175]
    v_mfma_f32_16x16x32_bf16 a[176:179], v[136:139], v[36:39], a[176:179]
    v_mfma_f32_16x16x32_bf16 a[180:183], v[136:139], v[40:43], a[180:183]
    s_add_u32 s28, s49, s94
    buffer_load_dwordx4 v26, s[16:19], s28 offen lds
    v_mfma_f32_16x16x32_bf16 a[184:187], v[136:139], v[44:47], a[184:187]
    s_add_u32 m0, m0, s53
    v_mfma_f32_16x16x32_bf16 a[188:191], v[136:139], v[48:51], a[188:191]
    v_mfma_f32_16x16x32_bf16 a[192:195], v[136:139], v[52:55], a[192:195]
    ds_read_b64_tr_b16 v[136:137], v11 offset:17088
    v_mfma_f32_16x16x32_bf16 a[196:199], v[140:143], v[28:31], a[196:199]
    ds_read_b64_tr_b16 v[138:139], v11 offset:17344
    v_mfma_f32_16x16x32_bf16 a[200:203], v[140:143], v[32:35], a[200:203]
    v_mfma_f32_16x16x32_bf16 a[204:207], v[140:143], v[36:39], a[204:207]
    s_add_u32 s28, s49, s95
    buffer_load_dwordx4 v26, s[16:19], s28 offen lds
    v_mfma_f32_16x16x32_bf16 a[208:211], v[140:143], v[40:43], a[208:211]
    v_mfma_f32_16x16x32_bf16 a[212:215], v[140:143], v[44:47], a[212:215]
    v_mfma_f32_16x16x32_bf16 a[216:219], v[140:143], v[48:51], a[216:219]
    v_mfma_f32_16x16x32_bf16 a[220:223], v[140:143], v[52:55], a[220:223]
    ds_read_b64_tr_b16 v[140:141], v11 offset:17120
    ds_read_b64_tr_b16 v[142:143], v11 offset:17376
    s_waitcnt lgkmcnt(14)
    v_mfma_f32_16x16x32_bf16 v[144:147], v[112:115], v[56:59], v[144:147]
    s_add_u32 m0, s33, 16896
    v_mfma_f32_16x16x32_bf16 v[148:151], v[112:115], v[60:63], v[148:151]
    s_mov_b32 s49, s50
    v_mfma_f32_16x16x32_bf16 v[152:155], v[112:115], v[64:67], v[152:155]
    s_add_u32 s50, s50, s51
    v_mfma_f32_16x16x32_bf16 v[156:159], v[112:115], v[68:71], v[156:159]
    s_add_u32 s82, s82, 1
    v_mfma_f32_16x16x32_bf16 v[160:163], v[112:115], v[72:75], v[160:163]
    s_cmp_eq_u32 s82, 20
    v_mfma_f32_16x16x32_bf16 v[164:167], v[112:115], v[76:79], v[164:167]
    s_cselect_b32 s29, s83, 0
    v_mfma_f32_16x16x32_bf16 v[168:171], v[112:115], v[80:83], v[168:171]
    s_sub_u32 s50, s50, s29
    s_waitcnt vmcnt(16) lgkmcnt(0)
    s_barrier
    ds_read_b64_tr_b16 v[112:113], v11 offset:25344
    v_mfma_f32_16x16x32_bf16 v[172:175], v[116:119], v[56:59], v[172:175]
    ds_read_b64_tr_b16 v[114:115], v11 offset:25600
    v_mfma_f32_16x16x32_bf16 v[176:179], v[116:119], v[60:63], v[176:179]
    ds_read_b128 v[28:31], v27 offset:25344
    v_mfma_f32_16x16x32_bf16 v[180:183], v[116:119], v[64:67], v[180:183]
    s_add_u32 s28, s49, s88
    buffer_load_dwordx4 v26, s[16:19], s28 offen lds
    v_mfma_f32_16x16x32_bf16 v[184:187], v[116:119], v[68:71], v[184:187]
    s_add_u32 m0, m0, s53
    ds_read_b128 v[32:35], v27 offset:26368
    v_mfma_f32_16x16x32_bf16 v[188:191], v[116:119], v[72:75], v[188:191]
    ds_read_b128 v[36:39], v27 offset:27392
    v_mfma_f32_16x16x32_bf16 v[192:195], v[116:119], v[76:79], v[192:195]
    ds_read_b128 v[40:43], v27 offset:28416
    v_mfma_f32_16x16x32_bf16 v[196:199], v[116:119], v[80:83], v[196:199]
    ds_read_b128 v[44:47], v27 offset:29440
    v_mfma_f32_16x16x32_bf16 v[200:203], v[120:123], v[56:59], v[200:203]
    ds_read_b128 v[48:51], v27 offset:30464
    v_mfma_f32_16x16x32_bf16 v[204:207], v[120:123], v[60:63], v[204:207]
    s_add_u32 s28, s49, s89
    buffer_load_dwordx4 v26, s[16:19], s28 offen lds
    v_mfma_f32_16x16x32_bf16 v[208:211], v[120:123], v[64:67], v[208:211]
    s_add_u32 m0, m0, s53
    ds_read_b128 v[52:55], v27 offset:31488
    v_mfma_f32_16x16x32_bf16 v[212:215], v[120:123], v[68:71], v[212:215]
    ds_read_b64_tr_b16 v[116:117], v11 offset:25376
    v_mfma_f32_16x16x32_bf16 v[216:219], v[120:123], v[72:75], v[216:219]
    ds_read_b64_tr_b16 v[118:119], v11 offset:25632
    v_mfma_f32_16x16x32_bf16 v[220:223], v[120:123], v[76:79], v[220:223]
    v_mfma_f32_16x16x32_bf16 v[224:227], v[120:123], v[80:83], v[224:227]
    ds_read_b64_tr_b16 v[120:121], v11 offset:25408
    v_mfma_f32_16x16x32_bf16 v[228:231], v[124:127], v[56:59], v[228:231]
    s_add_u32 s28, s49, s90
    buffer_load_dwordx4 v26, s[16:19], s28 offen lds
    v_mfma_f32_16x16x32_bf16 v[232:235], v[124:127], v[60:63], v[232:235]
    s_add_u32 m0, m0, s53
    ds_read_b64_tr_b16 v[122:123], v11 offset:25664
    v_mfma_f32_16x16x32_bf16 v[236:239], v[124:127], v[64:67], v[236:239]
    v_mfma_f32_16x16x32_bf16 v[240:243], v[124:127], v[68:71], v[240:243]
    v_mfma_f32_16x16x32_bf16 v[244:247], v[124:127], v[72:75], v[244:247]
    v_mfma_f32_16x16x32_bf16 v[248:251], v[124:127], v[76:79], v[248:251]
    v_mfma_f32_16x16x32_bf16 v[252:255], v[124:127], v[80:83], v[252:255]
    s_add_u32 s28, s49, s91
    buffer_load_dwordx4 v26, s[16:19], s28 offen lds
    v_mfma_f32_16x16x32_bf16 a[112:115], v[128:131], v[56:59], a[112:115]
    s_add_u32 m0, m0, s53
    ds_read_b64_tr_b16 v[124:125], v11 offset:25440
    v_mfma_f32_16x16x32_bf16 a[116:119], v[128:131], v[60:63], a[116:119]
    ds_read_b64_tr_b16 v[126:127], v11 offset:25696
    v_mfma_f32_16x16x32_bf16 a[120:123], v[128:131], v[64:67], a[120:123]
    v_mfma_f32_16x16x32_bf16 a[124:127], v[128:131], v[68:71], a[124:127]
    v_mfma_f32_16x16x32_bf16 a[128:131], v[128:131], v[72:75], a[128:131]
    v_mfma_f32_16x16x32_bf16 a[132:135], v[128:131], v[76:79], a[132:135]
    s_add_u32 s28, s49, s92
    buffer_load_dwordx4 v26, s[16:19], s28 offen lds
    v_mfma_f32_16x16x32_bf16 a[136:139], v[128:131], v[80:83], a[136:139]
    s_add_u32 m0, m0, s53
    ds_read_b64_tr_b16 v[128:129], v11 offset:25472
    v_mfma_f32_16x16x32_bf16 a[140:143], v[132:135], v[56:59], a[140:143]
    ds_read_b64_tr_b16 v[130:131], v11 offset:25728
    v_mfma_f32_16x16x32_bf16 a[144:147], v[132:135], v[60:63], a[144:147]
    v_mfma_f32_16x16x32_bf16 a[148:151], v[132:135], v[64:67], a[148:151]
    v_mfma_f32_16x16x32_bf16 a[152:155], v[132:135], v[68:71], a[152:155]
    v_mfma_f32_16x16x32_bf16 a[156:159], v[132:135], v[72:75], a[156:159]
    s_add_u32 s28, s49, s93
    buffer_load_dwordx4 v26, s[16:19], s28 offen lds
    v_mfma_f32_16x16x32_bf16 a[160:163], v[132:135], v[76:79], a[160:163]
    s_add_u32 m0, m0, s53
    v_mfma_f32_16x16x32_bf16 a[164:167], v[132:135], v[80:83], a[164:167]
    ds_read_b64_tr_b16 v[132:133], v11 offset:25504
    v_mfma_f32_16x16x32_bf16 a[168:171], v[136:139], v[56:59], a[168:171]
    ds_read_b64_tr_b16 v[134:135], v11 offset:25760
    v_mfma_f32_16x16x32_bf16 a[172:175], v[136:139], v[60:63], a[172:175]
    v_mfma_f32_16x16x32_bf16 a[176:179], v[136:139], v[64:67], a[176:179]
    v_mfma_f32_16x16x32_bf16 a[180:183], v[136:139], v[68:71], a[180:183]
    s_add_u32 s28, s49, s94
    buffer_load_dwordx4 v26, s[16:19], s28 offen lds
    v_mfma_f32_16x16x32_bf16 a[184:187], v[136:139], v[72:75], a[184:187]
    s_add_u32 m0, m0, s53
    v_mfma_f32_16x16x32_bf16 a[188:191], v[136:139], v[76:79], a[188:191]
    v_mfma_f32_16x16x32_bf16 a[192:195], v[136:139], v[80:83], a[192:195]
    ds_read_b64_tr_b16 v[136:137], v11 offset:25536
    v_mfma_f32_16x16x32_bf16 a[196:199], v[140:143], v[56:59], a[196:199]
    ds_read_b64_tr_b16 v[138:139], v11 offset:25792
    v_mfma_f32_16x16x32_bf16 a[200:203], v[140:143], v[60:63], a[200:203]
    v_mfma_f32_16x16x32_bf16 a[204:207], v[140:143], v[64:67], a[204:207]
    s_add_u32 s28, s49, s95
    buffer_load_dwordx4 v26, s[16:19], s28 offen lds
    v_mfma_f32_16x16x32_bf16 a[208:211], v[140:143], v[68:71], a[208:211]
    v_mfma_f32_16x16x32_bf16 a[212:215], v[140:143], v[72:75], a[212:215]
    v_mfma_f32_16x16x32_bf16 a[216:219], v[140:143], v[76:79], a[216:219]
    v_mfma_f32_16x16x32_bf16 a[220:223], v[140:143], v[80:83], a[220:223]
    ds_read_b64_tr_b16 v[140:141], v11 offset:25568
    ds_read_b64_tr_b16 v[142:143], v11 offset:25824
    s_waitcnt lgkmcnt(14)
    v_mfma_f32_16x16x32_bf16 v[144:147], v[112:115], v[28:31], v[144:147]
    s_add_u32 m0, s33, 25344
    v_mfma_f32_16x16x32_bf16 v[148:151], v[112:115], v[32:35], v[148:151]
    s_mov_b32 s49, s50
    v_mfma_f32_16x16x32_bf16 v[152:155], v[112:115], v[36:39], v[152:155]
    s_add_u32 s50, s50, s51
    v_mfma_f32_16x16x32_bf16 v[156:159], v[112:115], v[40:43], v[156:159]
    s_add_u32 s82, s82, 1
    v_mfma_f32_16x16x32_bf16 v[160:163], v[112:115], v[44:47], v[160:163]
    s_cmp_eq_u32 s82, 20
    v_mfma_f32_16x16x32_bf16 v[164:167], v[112:115], v[48:51], v[164:167]
    s_cselect_b32 s29, s83, 0
    v_mfma_f32_16x16x32_bf16 v[168:171], v[112:115], v[52:55], v[168:171]
    s_sub_u32 s50, s50, s29
    s_waitcnt vmcnt(16) lgkmcnt(0)
    s_barrier
    v_mfma_f32_16x16x32_bf16 v[172:175], v[116:119], v[28:31], v[172:175]
    v_mfma_f32_16x16x32_bf16 v[176:179], v[116:119], v[32:35], v[176:179]
    v_mfma_f32_16x16x32_bf16 v[180:183], v[116:119], v[36:39], v[180:183]
    s_add_u32 s28, s49, s88
    buffer_load_dwordx4 v26, s[16:19], s28 offen lds
    v_mfma_f32_16x16x32_bf16 v[184:187], v[116:119], v[40:43], v[184:187]
    s_add_u32 m0, m0, s53
    v_mfma_f32_16x16x32_bf16 v[188:191], v[116:119], v[44:47], v[188:191]
    v_mfma_f32_16x16x32_bf16 v[192:195], v[116:119], v[48:51], v[192:195]
    v_mfma_f32_16x16x32_bf16 v[196:199], v[116:119], v[52:55], v[196:199]
    v_mfma_f32_16x16x32_bf16 v[200:203], v[120:123], v[28:31], v[200:203]
    v_mfma_f32_16x16x32_bf16 v[204:207], v[120:123], v[32:35], v[204:207]
    s_add_u32 s28, s49, s89
    buffer_load_dwordx4 v26, s[16:19], s28 offen lds
    v_mfma_f32_16x16x32_bf16 v[208:211], v[120:123], v[36:39], v[208:211]
    s_add_u32 m0, m0, s53
    v_mfma_f32_16x16x32_bf16 v[212:215], v[120:123], v[40:43], v[212:215]
    v_mfma_f32_16x16x32_bf16 v[216:219], v[120:123], v[44:47], v[216:219]
    v_mfma_f32_16x16x32_bf16 v[220:223], v[120:123], v[48:51], v[220:223]
    v_mfma_f32_16x16x32_bf16 v[224:227], v[120:123], v[52:55], v[224:227]
    v_mfma_f32_16x16x32_bf16 v[228:231], v[124:127], v[28:31], v[228:231]
    s_add_u32 s28, s49, s90
    buffer_load_dwordx4 v26, s[16:19], s28 offen lds
    v_mfma_f32_16x16x32_bf16 v[232:235], v[124:127], v[32:35], v[232:235]
    s_add_u32 m0, m0, s53
    v_mfma_f32_16x16x32_bf16 v[236:239], v[124:127], v[36:39], v[236:239]
    v_mfma_f32_16x16x32_bf16 v[240:243], v[124:127], v[40:43], v[240:243]
    v_mfma_f32_16x16x32_bf16 v[244:247], v[124:127], v[44:47], v[244:247]
    v_mfma_f32_16x16x32_bf16 v[248:251], v[124:127], v[48:51], v[248:251]
    v_mfma_f32_16x16x32_bf16 v[252:255], v[124:127], v[52:55], v[252:255]
    s_add_u32 s28, s49, s91
    buffer_load_dwordx4 v26, s[16:19], s28 offen lds
    v_mfma_f32_16x16x32_bf16 a[112:115], v[128:131], v[28:31], a[112:115]
    s_add_u32 m0, m0, s53
    v_mfma_f32_16x16x32_bf16 a[116:119], v[128:131], v[32:35], a[116:119]
    v_mfma_f32_16x16x32_bf16 a[120:123], v[128:131], v[36:39], a[120:123]
    v_mfma_f32_16x16x32_bf16 a[124:127], v[128:131], v[40:43], a[124:127]
    v_mfma_f32_16x16x32_bf16 a[128:131], v[128:131], v[44:47], a[128:131]
    v_mfma_f32_16x16x32_bf16 a[132:135], v[128:131], v[48:51], a[132:135]
    s_add_u32 s28, s49, s92
    buffer_load_dwordx4 v26, s[16:19], s28 offen lds
    v_mfma_f32_16x16x32_bf16 a[136:139], v[128:131], v[52:55], a[136:139]
    s_add_u32 m0, m0, s53
    v_mfma_f32_16x16x32_bf16 a[140:143], v[132:135], v[28:31], a[140:143]
    v_mfma_f32_16x16x32_bf16 a[144:147], v[132:135], v[32:35], a[144:147]
    v_mfma_f32_16x16x32_bf16 a[148:151], v[132:135], v[36:39], a[148:151]
    v_mfma_f32_16x16x32_bf16 a[152:155], v[132:135], v[40:43], a[152:155]
    v_mfma_f32_16x16x32_bf16 a[156:159], v[132:135], v[44:47], a[156:159]
    s_add_u32 s28, s49, s93
    buffer_load_dwordx4 v26, s[16:19], s28 offen lds
    v_mfma_f32_16x16x32_bf16 a[160:163], v[132:135], v[48:51], a[160:163]
    s_add_u32 m0, m0, s53
    v_mfma_f32_16x16x32_bf16 a[164:167], v[132:135], v[52:55], a[164:167]
    v_mfma_f32_16x16x32_bf16 a[168:171], v[136:139], v[28:31], a[168:171]
    v_mfma_f32_16x16x32_bf16 a[172:175], v[136:139], v[32:35], a[172:175]
    v_mfma_f32_16x16x32_bf16 a[176:179], v[136:139], v[36:39], a[176:179]
    v_mfma_f32_16x16x32_bf16 a[180:183], v[136:139], v[40:43], a[180:183]
    s_add_u32 s28, s49, s94
    buffer_load_dwordx4 v26, s[16:19], s28 offen lds
    v_mfma_f32_16x16x32_bf16 a[184:187], v[136:139], v[44:47], a[184:187]
    s_add_u32 m0, m0, s53
    v_mfma_f32_16x16x32_bf16 a[188:191], v[136:139], v[48:51], a[188:191]
    v_mfma_f32_16x16x32_bf16 a[192:195], v[136:139], v[52:55], a[192:195]
    v_mfma_f32_16x16x32_bf16 a[196:199], v[140:143], v[28:31], a[196:199]
    v_mfma_f32_16x16x32_bf16 a[200:203], v[140:143], v[32:35], a[200:203]
    v_mfma_f32_16x16x32_bf16 a[204:207], v[140:143], v[36:39], a[204:207]
    s_add_u32 s28, s49, s95
    buffer_load_dwordx4 v26, s[16:19], s28 offen lds
    v_mfma_f32_16x16x32_bf16 a[208:211], v[140:143], v[40:43], a[208:211]
    v_mfma_f32_16x16x32_bf16 a[212:215], v[140:143], v[44:47], a[212:215]
    v_mfma_f32_16x16x32_bf16 a[216:219], v[140:143], v[48:51], a[216:219]
    v_mfma_f32_16x16x32_bf16 a[220:223], v[140:143], v[52:55], a[220:223]
L_at_qpepi:
    v_mov_b32 v4, s54
    v_mov_b32 v5, s54
    s_nop 6
    v_pk_mul_f32 v[144:145], v[144:145], v[4:5]
    v_pk_mul_f32 v[146:147], v[146:147], v[4:5]
    v_pk_mul_f32 v[148:149], v[148:149], v[4:5]
    v_pk_mul_f32 v[150:151], v[150:151], v[4:5]
    v_pk_mul_f32 v[152:153], v[152:153], v[4:5]
    v_pk_mul_f32 v[154:155], v[154:155], v[4:5]
    v_pk_mul_f32 v[156:157], v[156:157], v[4:5]
    v_pk_mul_f32 v[158:159], v[158:159], v[4:5]
    v_pk_mul_f32 v[160:161], v[160:161], v[4:5]
    v_pk_mul_f32 v[162:163], v[162:163], v[4:5]
    v_pk_mul_f32 v[164:165], v[164:165], v[4:5]
    v_pk_mul_f32 v[166:167], v[166:167], v[4:5]
    v_pk_mul_f32 v[168:169], v[168:169], v[4:5]
    v_pk_mul_f32 v[170:171], v[170:171], v[4:5]
    v_pk_mul_f32 v[172:173], v[172:173], v[4:5]
    v_pk_mul_f32 v[174:175], v[174:175], v[4:5]
    v_pk_mul_f32 v[176:177], v[176:177], v[4:5]
    v_pk_mul_f32 v[178:179], v[178:179], v[4:5]
    v_pk_mul_f32 v[180:181], v[180:181], v[4:5]
    v_pk_mul_f32 v[182:183], v[182:183], v[4:5]
    v_pk_mul_f32 v[184:185], v[184:185], v[4:5]
    v_pk_mul_f32 v[186:187], v[186:187], v[4:5]
    v_pk_mul_f32 v[188:189], v[188:189], v[4:5]
    v_pk_mul_f32 v[190:191], v[190:191], v[4:5]
    v_pk_mul_f32 v[192:193], v[192:193], v[4:5]
    v_pk_mul_f32 v[194:195], v[194:195], v[4:5]
    v_pk_mul_f32 v[196:197], v[196:197], v[4:5]
    v_pk_mul_f32 v[198:199], v[198:199], v[4:5]
    v_cvt_pk_bf16_f32 v88, v144, v145
    v_cvt_pk_bf16_f32 v89, v146, v147
    v_cvt_pk_bf16_f32 v90, v172, v173
    v_cvt_pk_bf16_f32 v91, v174, v175
    v_cvt_pk_bf16_f32 v92, v148, v149
    v_cvt_pk_bf16_f32 v93, v150, v151
    v_cvt_pk_bf16_f32 v94, v176, v177
    v_cvt_pk_bf16_f32 v95, v178, v179
    v_cvt_pk_bf16_f32 v96, v152, v153
    v_cvt_pk_bf16_f32 v97, v154, v155
    v_cvt_pk_bf16_f32 v98, v180, v181
    v_cvt_pk_bf16_f32 v99, v182, v183
    v_cvt_pk_bf16_f32 v100, v156, v157
    v_cvt_pk_bf16_f32 v101, v158, v159
    v_cvt_pk_bf16_f32 v102, v184, v185
    v_cvt_pk_bf16_f32 v103, v186, v187
    v_cvt_pk_bf16_f32 v104, v160, v161
    v_cvt_pk_bf16_f32 v105, v162, v163
    v_cvt_pk_bf16_f32 v106, v188, v189
    v_cvt_pk_bf16_f32 v107, v190, v191
    v_cvt_pk_bf16_f32 v108, v164, v165
    v_cvt_pk_bf16_f32 v109, v166, v167
    v_cvt_pk_bf16_f32 v110, v192, v193
    v_cvt_pk_bf16_f32 v111, v194, v195
    v_cvt_pk_bf16_f32 v112, v168, v169
    v_cvt_pk_bf16_f32 v113, v170, v171
    v_cvt_pk_bf16_f32 v114, v196, v197
    v_cvt_pk_bf16_f32 v115, v198, v199
    s_nop 1
    v_permlane16_swap_b32 v88, v90
    v_permlane16_swap_b32 v89, v91
    v_permlane16_swap_b32 v92, v94
    v_permlane16_swap_b32 v93, v95
    v_permlane16_swap_b32 v96, v98
    v_permlane16_swap_b32 v97, v99
    v_permlane16_swap_b32 v100, v102
    v_permlane16_swap_b32 v101, v103
    v_permlane16_swap_b32 v104, v106
    v_permlane16_swap_b32 v105, v107
    v_permlane16_swap_b32 v108, v110
    v_permlane16_swap_b32 v109, v111
    v_permlane16_swap_b32 v112, v114
    v_permlane16_swap_b32 v113, v115
    v_accvgpr_write_b32 a0, v88
    v_accvgpr_write_b32 a1, v89
    v_accvgpr_write_b32 a2, v90
    v_accvgpr_write_b32 a3, v91
    v_accvgpr_write_b32 a16, v92
    v_accvgpr_write_b32 a17, v93
    v_accvgpr_write_b32 a18, v94
    v_accvgpr_write_b32 a19, v95
    v_accvgpr_write_b32 a32, v96
    v_accvgpr_write_b32 a33, v97
    v_accvgpr_write_b32 a34, v98
    v_accvgpr_write_b32 a35, v99
    v_accvgpr_write_b32 a48, v100
    v_accvgpr_write_b32 a49, v101
    v_accvgpr_write_b32 a50, v102
    v_accvgpr_write_b32 a51, v103
    v_accvgpr_write_b32 a64, v104
    v_accvgpr_write_b32 a65, v105
    v_accvgpr_write_b32 a66, v106
    v_accvgpr_write_b32 a67, v107
    v_accvgpr_write_b32 a80, v108
    v_accvgpr_write_b32 a81, v109
    v_accvgpr_write_b32 a82, v110
    v_accvgpr_write_b32 a83, v111
    v_accvgpr_write_b32 a96, v112
    v_accvgpr_write_b32 a97, v113
    v_accvgpr_write_b32 a98, v114
    v_accvgpr_write_b32 a99, v115
    v_pk_mul_f32 v[200:201], v[200:201], v[4:5]
    v_pk_mul_f32 v[202:203], v[202:203], v[4:5]
    v_pk_mul_f32 v[204:205], v[204:205], v[4:5]
    v_pk_mul_f32 v[206:207], v[206:207], v[4:5]
    v_pk_mul_f32 v[208:209], v[208:209], v[4:5]
    v_pk_mul_f32 v[210:211], v[210:211], v[4:5]
    v_pk_mul_f32 v[212:213], v[212:213], v[4:5]
    v_pk_mul_f32 v[214:215], v[214:215], v[4:5]
    v_pk_mul_f32 v[216:217], v[216:217], v[4:5]
    v_pk_mul_f32 v[218:219], v[218:219], v[4:5]
    v_pk_mul_f32 v[220:221], v[220:221], v[4:5]
    v_pk_mul_f32 v[222:223], v[222:223], v[4:5]
    v_pk_mul_f32 v[224:225], v[224:225], v[4:5]
    v_pk_mul_f32 v[226:227], v[226:227], v[4:5]
    v_pk_mul_f32 v[228:229], v[228:229], v[4:5]
    v_pk_mul_f32 v[230:231], v[230:231], v[4:5]
    v_pk_mul_f32 v[232:233], v[232:233], v[4:5]
    v_pk_mul_f32 v[234:235], v[234:235], v[4:5]
    v_pk_mul_f32 v[236:237], v[236:237], v[4:5]
    v_pk_mul_f32 v[238:239], v[238:239], v[4:5]
    v_pk_mul_f32 v[240:241], v[240:241], v[4:5]
    v_pk_mul_f32 v[242:243], v[242:243], v[4:5]
    v_pk_mul_f32 v[244:245], v[244:245], v[4:5]
    v_pk_mul_f32 v[246:247], v[246:247], v[4:5]
    v_pk_mul_f32 v[248:249], v[248:249], v[4:5]
    v_pk_mul_f32 v[250:251], v[250:251], v[4:5]
    v_pk_mul_f32 v[252:253], v[252:253], v[4:5]
    v_pk_mul_f32 v[254:255], v[254:255], v[4:5]
    v_cvt_pk_bf16_f32 v116, v200, v201
    v_cvt_pk_bf16_f32 v117, v202, v203
    v_cvt_pk_bf16_f32 v118, v228, v229
    v_cvt_pk_bf16_f32 v119, v230, v231
    v_cvt_pk_bf16_f32 v120, v204, v205
    v_cvt_pk_bf16_f32 v121, v206, v207
    v_cvt_pk_bf16_f32 v122, v232, v233
    v_cvt_pk_bf16_f32 v123, v234, v235
    v_cvt_pk_bf16_f32 v124, v208, v209
    v_cvt_pk_bf16_f32 v125, v210, v211
    v_cvt_pk_bf16_f32 v126, v236, v237
    v_cvt_pk_bf16_f32 v127, v238, v239
    v_cvt_pk_bf16_f32 v128, v212, v213
    v_cvt_pk_bf16_f32 v129, v214, v215
    v_cvt_pk_bf16_f32 v130, v240, v241
    v_cvt_pk_bf16_f32 v131, v242, v243
    v_cvt_pk_bf16_f32 v132, v216, v217
    v_cvt_pk_bf16_f32 v133, v218, v219
    v_cvt_pk_bf16_f32 v134, v244, v245
    v_cvt_pk_bf16_f32 v135, v246, v247
    v_cvt_pk_bf16_f32 v136, v220, v221
    v_cvt_pk_bf16_f32 v137, v222, v223
    v_cvt_pk_bf16_f32 v138, v248, v249
    v_cvt_pk_bf16_f32 v139, v250, v251
    v_cvt_pk_bf16_f32 v140, v224, v225
    v_cvt_pk_bf16_f32 v141, v226, v227
    v_cvt_pk_bf16_f32 v142, v252, v253
    v_cvt_pk_bf16_f32 v143, v254, v255
    s_nop 1
    v_permlane16_swap_b32 v116, v118
    v_permlane16_swap_b32 v117, v119
    v_permlane16_swap_b32 v120, v122
    v_permlane16_swap_b32 v121, v123
    v_permlane16_swap_b32 v124, v126
    v_permlane16_swap_b32 v125, v127
    v_permlane16_swap_b32 v128, v130
    v_permlane16_swap_b32 v129, v131
    v_permlane16_swap_b32 v132, v134
    v_permlane16_swap_b32 v133, v135
    v_permlane16_swap_b32 v136, v138
    v_permlane16_swap_b32 v137, v139
    v_permlane16_swap_b32 v140, v142
    v_permlane16_swap_b32 v141, v143
    v_accvgpr_write_b32 a4, v116
    v_accvgpr_write_b32 a5, v117
    v_accvgpr_write_b32 a6, v118
    v_accvgpr_write_b32 a7, v119
    v_accvgpr_write_b32 a20, v120
    v_accvgpr_write_b32 a21, v121
    v_accvgpr_write_b32 a22, v122
    v_accvgpr_write_b32 a23, v123
    v_accvgpr_write_b32 a36, v124
    v_accvgpr_write_b32 a37, v125
    v_accvgpr_write_b32 a38, v126
    v_accvgpr_write_b32 a39, v127
    v_accvgpr_write_b32 a52, v128
    v_accvgpr_write_b32 a53, v129
    v_accvgpr_write_b32 a54, v130
    v_accvgpr_write_b32 a55, v131
    v_accvgpr_write_b32 a68, v132
    v_accvgpr_write_b32 a69, v133
    v_accvgpr_write_b32 a70, v134
    v_accvgpr_write_b32 a71, v135
    v_accvgpr_write_b32 a84, v136
    v_accvgpr_write_b32 a85, v137
    v_accvgpr_write_b32 a86, v138
    v_accvgpr_write_b32 a87, v139
    v_accvgpr_write_b32 a100, v140
    v_accvgpr_write_b32 a101, v141
    v_accvgpr_write_b32 a102, v142
    v_accvgpr_write_b32 a103, v143
    v_accvgpr_read_b32 v144, a112
    v_accvgpr_read_b32 v145, a113
    v_accvgpr_read_b32 v146, a114
    v_accvgpr_read_b32 v147, a115
    v_accvgpr_read_b32 v148, a116
    v_accvgpr_read_b32 v149, a117
    v_accvgpr_read_b32 v150, a118
    v_accvgpr_read_b32 v151, a119
    v_accvgpr_read_b32 v152, a120
    v_accvgpr_read_b32 v153, a121
    v_accvgpr_read_b32 v154, a122
    v_accvgpr_read_b32 v155, a123
    v_accvgpr_read_b32 v156, a124
    v_accvgpr_read_b32 v157, a125
    v_accvgpr_read_b32 v158, a126
    v_accvgpr_read_b32 v159, a127
    v_accvgpr_read_b32 v160, a128
    v_accvgpr_read_b32 v161, a129
    v_accvgpr_read_b32 v162, a130
    v_accvgpr_read_b32 v163, a131
    v_accvgpr_read_b32 v164, a132
    v_accvgpr_read_b32 v165, a133
    v_accvgpr_read_b32 v166, a134
    v_accvgpr_read_b32 v167, a135
    v_accvgpr_read_b32 v168, a136
    v_accvgpr_read_b32 v169, a137
    v_accvgpr_read_b32 v170, a138
    v_accvgpr_read_b32 v171, a139
    v_accvgpr_read_b32 v172, a140
    v_accvgpr_read_b32 v173, a141
    v_accvgpr_read_b32 v174, a142
    v_accvgpr_read_b32 v175, a143
    v_accvgpr_read_b32 v176, a144
    v_accvgpr_read_b32 v177, a145
    v_accvgpr_read_b32 v178, a146
    v_accvgpr_read_b32 v179, a147
    v_accvgpr_read_b32 v180, a148
    v_accvgpr_read_b32 v181, a149
    v_accvgpr_read_b32 v182, a150
    v_accvgpr_read_b32 v183, a151
    v_accvgpr_read_b32 v184, a152
    v_accvgpr_read_b32 v185, a153
    v_accvgpr_read_b32 v186, a154
    v_accvgpr_read_b32 v187, a155
    v_accvgpr_read_b32 v188, a156
    v_accvgpr_read_b32 v189, a157
    v_accvgpr_read_b32 v190, a158
    v_accvgpr_read_b32 v191, a159
    v_accvgpr_read_b32 v192, a160
    v_accvgpr_read_b32 v193, a161
    v_accvgpr_read_b32 v194, a162
    v_accvgpr_read_b32 v195, a163
    v_accvgpr_read_b32 v196, a164
    v_accvgpr_read_b32 v197, a165
    v_accvgpr_read_b32 v198, a166
    v_accvgpr_read_b32 v199, a167
    v_pk_mul_f32 v[144:145], v[144:145], v[4:5]
    v_pk_mul_f32 v[146:147], v[146:147], v[4:5]
    v_pk_mul_f32 v[148:149], v[148:149], v[4:5]
    v_pk_mul_f32 v[150:151], v[150:151], v[4:5]
    v_pk_mul_f32 v[152:153], v[152:153], v[4:5]
    v_pk_mul_f32 v[154:155], v[154:155], v[4:5]
    v_pk_mul_f32 v[156:157], v[156:157], v[4:5]
    v_pk_mul_f32 v[158:159], v[158:159], v[4:5]
    v_pk_mul_f32 v[160:161], v[160:161], v[4:5]
    v_pk_mul_f32 v[162:163], v[162:163], v[4:5]
    v_pk_mul_f32 v[164:165], v[164:165], v[4:5]
    v_pk_mul_f32 v[166:167], v[166:167], v[4:5]
    v_pk_mul_f32 v[168:169], v[168:169], v[4:5]
    v_pk_mul_f32 v[170:171], v[170:171], v[4:5]
    v_pk_mul_f32 v[172:173], v[172:173], v[4:5]
    v_pk_mul_f32 v[174:175], v[174:175], v[4:5]
    v_pk_mul_f32 v[176:177], v[176:177], v[4:5]
    v_pk_mul_f32 v[178:179], v[178:179], v[4:5]
    v_pk_mul_f32 v[180:181], v[180:181], v[4:5]
    v_pk_mul_f32 v[182:183], v[182:183], v[4:5]
    v_pk_mul_f32 v[184:185], v[184:185], v[4:5]
    v_pk_mul_f32 v[186:187], v[186:187], v[4:5]
    v_pk_mul_f32 v[188:189], v[188:189], v[4:5]
    v_pk_mul_f32 v[190:191], v[190:191], v[4:5]
    v_pk_mul_f32 v[192:193], v[192:193], v[4:5]
    v_pk_mul_f32 v[194:195], v[194:195], v[4:5]
    v_pk_mul_f32 v[196:197], v[196:197], v[4:5]
    v_pk_mul_f32 v[198:199], v[198:199], v[4:5]
    v_cvt_pk_bf16_f32 v88, v144, v145
    v_cvt_pk_bf16_f32 v89, v146, v147
    v_cvt_pk_bf16_f32 v90, v172, v173
    v_cvt_pk_bf16_f32 v91, v174, v175
    v_cvt_pk_bf16_f32 v92, v148, v149
    v_cvt_pk_bf16_f32 v93, v150, v151
    v_cvt_pk_bf16_f32 v94, v176, v177
    v_cvt_pk_bf16_f32 v95, v178, v179
    v_cvt_pk_bf16_f32 v96, v152, v153
    v_cvt_pk_bf16_f32 v97, v154, v155
    v_cvt_pk_bf16_f32 v98, v180, v181
    v_cvt_pk_bf16_f32 v99, v182, v183
    v_cvt_pk_bf16_f32 v100, v156, v157
    v_cvt_pk_bf16_f32 v101, v158, v159
    v_cvt_pk_bf16_f32 v102, v184, v185
    v_cvt_pk_bf16_f32 v103, v186, v187
    v_cvt_pk_bf16_f32 v104, v160, v161
    v_cvt_pk_bf16_f32 v105, v162, v163
    v_cvt_pk_bf16_f32 v106, v188, v189
    v_cvt_pk_bf16_f32 v107, v190, v191
    v_cvt_pk_bf16_f32 v108, v164, v165
    v_cvt_pk_bf16_f32 v109, v166, v167
    v_cvt_pk_bf16_f32 v110, v192, v193
    v_cvt_pk_bf16_f32 v111, v194, v195
    v_cvt_pk_bf16_f32 v112, v168, v169
    v_cvt_pk_bf16_f32 v113, v170, v171
    v_cvt_pk_bf16_f32 v114, v196, v197
    v_cvt_pk_bf16_f32 v115, v198, v199
    s_nop 1
    v_permlane16_swap_b32 v88, v90
    v_permlane16_swap_b32 v89, v91
    v_permlane16_swap_b32 v92, v94
    v_permlane16_swap_b32 v93, v95
    v_permlane16_swap_b32 v96, v98
    v_permlane16_swap_b32 v97, v99
    v_permlane16_swap_b32 v100, v102
    v_permlane16_swap_b32 v101, v103
    v_permlane16_swap_b32 v104, v106
    v_permlane16_swap_b32 v105, v107
    v_permlane16_swap_b32 v108, v110
    v_permlane16_swap_b32 v109, v111
    v_permlane16_swap_b32 v112, v114
    v_permlane16_swap_b32 v113, v115
    v_accvgpr_write_b32 a8, v88
    v_accvgpr_write_b32 a9, v89
    v_accvgpr_write_b32 a10, v90
    v_accvgpr_write_b32 a11, v91
    v_accvgpr_write_b32 a24, v92
    v_accvgpr_write_b32 a25, v93
    v_accvgpr_write_b32 a26, v94
    v_accvgpr_write_b32 a27, v95
    v_accvgpr_write_b32 a40, v96
    v_accvgpr_write_b32 a41, v97
    v_accvgpr_write_b32 a42, v98
    v_accvgpr_write_b32 a43, v99
    v_accvgpr_write_b32 a56, v100
    v_accvgpr_write_b32 a57, v101
    v_accvgpr_write_b32 a58, v102
    v_accvgpr_write_b32 a59, v103
    v_accvgpr_write_b32 a72, v104
    v_accvgpr_write_b32 a73, v105
    v_accvgpr_write_b32 a74, v106
    v_accvgpr_write_b32 a75, v107
    v_accvgpr_write_b32 a88, v108
    v_accvgpr_write_b32 a89, v109
    v_accvgpr_write_b32 a90, v110
    v_accvgpr_write_b32 a91, v111
    v_accvgpr_write_b32 a104, v112
    v_accvgpr_write_b32 a105, v113
    v_accvgpr_write_b32 a106, v114
    v_accvgpr_write_b32 a107, v115
    v_accvgpr_read_b32 v200, a168
    v_accvgpr_read_b32 v201, a169
    v_accvgpr_read_b32 v202, a170
    v_accvgpr_read_b32 v203, a171
    v_accvgpr_read_b32 v204, a172
    v_accvgpr_read_b32 v205, a173
    v_accvgpr_read_b32 v206, a174
    v_accvgpr_read_b32 v207, a175
    v_accvgpr_read_b32 v208, a176
    v_accvgpr_read_b32 v209, a177
    v_accvgpr_read_b32 v210, a178
    v_accvgpr_read_b32 v211, a179
    v_accvgpr_read_b32 v212, a180
    v_accvgpr_read_b32 v213, a181
    v_accvgpr_read_b32 v214, a182
    v_accvgpr_read_b32 v215, a183
    v_accvgpr_read_b32 v216, a184
    v_accvgpr_read_b32 v217, a185
    v_accvgpr_read_b32 v218, a186
    v_accvgpr_read_b32 v219, a187
    v_accvgpr_read_b32 v220, a188
    v_accvgpr_read_b32 v221, a189
    v_accvgpr_read_b32 v222, a190
    v_accvgpr_read_b32 v223, a191
    v_accvgpr_read_b32 v224, a192
    v_accvgpr_read_b32 v225, a193
    v_accvgpr_read_b32 v226, a194
    v_accvgpr_read_b32 v227, a195
    v_accvgpr_read_b32 v228, a196
    v_accvgpr_read_b32 v229, a197
    v_accvgpr_read_b32 v230, a198
    v_accvgpr_read_b32 v231, a199
    v_accvgpr_read_b32 v232, a200
    v_accvgpr_read_b32 v233, a201
    v_accvgpr_read_b32 v234, a202
    v_accvgpr_read_b32 v235, a203
    v_accvgpr_read_b32 v236, a204
    v_accvgpr_read_b32 v237, a205
    v_accvgpr_read_b32 v238, a206
    v_accvgpr_read_b32 v239, a207
    v_accvgpr_read_b32 v240, a208
    v_accvgpr_read_b32 v241, a209
    v_accvgpr_read_b32 v242, a210
    v_accvgpr_read_b32 v243, a211
    v_accvgpr_read_b32 v244, a212
    v_accvgpr_read_b32 v245, a213
    v_accvgpr_read_b32 v246, a214
    v_accvgpr_read_b32 v247, a215
    v_accvgpr_read_b32 v248, a216
    v_accvgpr_read_b32 v249, a217
    v_accvgpr_read_b32 v250, a218
    v_accvgpr_read_b32 v251, a219
    v_accvgpr_read_b32 v252, a220
    v_accvgpr_read_b32 v253, a221
    v_accvgpr_read_b32 v254, a222
    v_accvgpr_read_b32 v255, a223
    v_pk_mul_f32 v[200:201], v[200:201], v[4:5]
    v_pk_mul_f32 v[202:203], v[202:203], v[4:5]
    v_pk_mul_f32 v[204:205], v[204:205], v[4:5]
    v_pk_mul_f32 v[206:207], v[206:207], v[4:5]
    v_pk_mul_f32 v[208:209], v[208:209], v[4:5]
    v_pk_mul_f32 v[210:211], v[210:211], v[4:5]
    v_pk_mul_f32 v[212:213], v[212:213], v[4:5]
    v_pk_mul_f32 v[214:215], v[214:215], v[4:5]
    v_pk_mul_f32 v[216:217], v[216:217], v[4:5]
    v_pk_mul_f32 v[218:219], v[218:219], v[4:5]
    v_pk_mul_f32 v[220:221], v[220:221], v[4:5]
    v_pk_mul_f32 v[222:223], v[222:223], v[4:5]
    v_pk_mul_f32 v[224:225], v[224:225], v[4:5]
    v_pk_mul_f32 v[226:227], v[226:227], v[4:5]
    v_pk_mul_f32 v[228:229], v[228:229], v[4:5]
    v_pk_mul_f32 v[230:231], v[230:231], v[4:5]
    v_pk_mul_f32 v[232:233], v[232:233], v[4:5]
    v_pk_mul_f32 v[234:235], v[234:235], v[4:5]
    v_pk_mul_f32 v[236:237], v[236:237], v[4:5]
    v_pk_mul_f32 v[238:239], v[238:239], v[4:5]
    v_pk_mul_f32 v[240:241], v[240:241], v[4:5]
    v_pk_mul_f32 v[242:243], v[242:243], v[4:5]
    v_pk_mul_f32 v[244:245], v[244:245], v[4:5]
    v_pk_mul_f32 v[246:247], v[246:247], v[4:5]
    v_pk_mul_f32 v[248:249], v[248:249], v[4:5]
    v_pk_mul_f32 v[250:251], v[250:251], v[4:5]
    v_pk_mul_f32 v[252:253], v[252:253], v[4:5]
    v_pk_mul_f32 v[254:255], v[254:255], v[4:5]
    v_cvt_pk_bf16_f32 v116, v200, v201
    v_cvt_pk_bf16_f32 v117, v202, v203
    v_cvt_pk_bf16_f32 v118, v228, v229
    v_cvt_pk_bf16_f32 v119, v230, v231
    v_cvt_pk_bf16_f32 v120, v204, v205
    v_cvt_pk_bf16_f32 v121, v206, v207
    v_cvt_pk_bf16_f32 v122, v232, v233
    v_cvt_pk_bf16_f32 v123, v234, v235
    v_cvt_pk_bf16_f32 v124, v208, v209
    v_cvt_pk_bf16_f32 v125, v210, v211
    v_cvt_pk_bf16_f32 v126, v236, v237
    v_cvt_pk_bf16_f32 v127, v238, v239
    v_cvt_pk_bf16_f32 v128, v212, v213
    v_cvt_pk_bf16_f32 v129, v214, v215
    v_cvt_pk_bf16_f32 v130, v240, v241
    v_cvt_pk_bf16_f32 v131, v242, v243
    v_cvt_pk_bf16_f32 v132, v216, v217
    v_cvt_pk_bf16_f32 v133, v218, v219
    v_cvt_pk_bf16_f32 v134, v244, v245
    v_cvt_pk_bf16_f32 v135, v246, v247
    v_cvt_pk_bf16_f32 v136, v220, v221
    v_cvt_pk_bf16_f32 v137, v222, v223
    v_cvt_pk_bf16_f32 v138, v248, v249
    v_cvt_pk_bf16_f32 v139, v250, v251
    v_cvt_pk_bf16_f32 v140, v224, v225
    v_cvt_pk_bf16_f32 v141, v226, v227
    v_cvt_pk_bf16_f32 v142, v252, v253
    v_cvt_pk_bf16_f32 v143, v254, v255
    s_nop 1
    v_permlane16_swap_b32 v116, v118
    v_permlane16_swap_b32 v117, v119
    v_permlane16_swap_b32 v120, v122
    v_permlane16_swap_b32 v121, v123
    v_permlane16_swap_b32 v124, v126
    v_permlane16_swap_b32 v125, v127
    v_permlane16_swap_b32 v128, v130
    v_permlane16_swap_b32 v129, v131
    v_permlane16_swap_b32 v132, v134
    v_permlane16_swap_b32 v133, v135
    v_permlane16_swap_b32 v136, v138
    v_permlane16_swap_b32 v137, v139
    v_permlane16_swap_b32 v140, v142
    v_permlane16_swap_b32 v141, v143
    v_accvgpr_write_b32 a12, v116
    v_accvgpr_write_b32 a13, v117
    v_accvgpr_write_b32 a14, v118
    v_accvgpr_write_b32 a15, v119
    v_accvgpr_write_b32 a28, v120
    v_accvgpr_write_b32 a29, v121
    v_accvgpr_write_b32 a30, v122
    v_accvgpr_write_b32 a31, v123
    v_accvgpr_write_b32 a44, v124
    v_accvgpr_write_b32 a45, v125
    v_accvgpr_write_b32 a46, v126
    v_accvgpr_write_b32 a47, v127
    v_accvgpr_write_b32 a60, v128
    v_accvgpr_write_b32 a61, v129
    v_accvgpr_write_b32 a62, v130
    v_accvgpr_write_b32 a63, v131
    v_accvgpr_write_b32 a76, v132
    v_accvgpr_write_b32 a77, v133
    v_accvgpr_write_b32 a78, v134
    v_accvgpr_write_b32 a79, v135
    v_accvgpr_write_b32 a92, v136
    v_accvgpr_write_b32 a93, v137
    v_accvgpr_write_b32 a94, v138
    v_accvgpr_write_b32 a95, v139
    v_accvgpr_write_b32 a108, v140
    v_accvgpr_write_b32 a109, v141
    v_accvgpr_write_b32 a110, v142
    v_accvgpr_write_b32 a111, v143
    s_cmp_eq_u32 s70, 0
    s_cbranch_scc1 L_at_nostash
    s_mov_b32 s70, 0
    s_lshl_b32 s30, s2, 2
    s_add_u32 s30, s30, s20
    s_mul_i32 s30, s30, 28672
    v_lshlrev_b32 v4, 4, v1
    buffer_store_dwordx4 a[0:3], v4, s[12:15], s30 offen offset:0
    buffer_store_dwordx4 a[4:7], v4, s[12:15], s30 offen offset:1024
    buffer_store_dwordx4 a[8:11], v4, s[12:15], s30 offen offset:2048
    buffer_store_dwordx4 a[12:15], v4, s[12:15], s30 offen offset:3072
    s_add_u32 s30, s30, 4096
    buffer_store_dwordx4 a[16:19], v4, s[12:15], s30 offen offset:0
    buffer_store_dwordx4 a[20:23], v4, s[12:15], s30 offen offset:1024
    buffer_store_dwordx4 a[24:27], v4, s[12:15], s30 offen offset:2048
    buffer_store_dwordx4 a[28:31], v4, s[12:15], s30 offen offset:3072
    s_add_u32 s30, s30, 4096
    buffer_store_dwordx4 a[32:35], v4, s[12:15], s30 offen offset:0
    buffer_store_dwordx4 a[36:39], v4, s[12:15], s30 offen offset:1024
    buffer_store_dwordx4 a[40:43], v4, s[12:15], s30 offen offset:2048
    buffer_store_dwordx4 a[44:47], v4, s[12:15], s30 offen offset:3072
    s_add_u32 s30, s30, 4096
    buffer_store_dwordx4 a[48:51], v4, s[12:15], s30 offen offset:0
    buffer_store_dwordx4 a[52:55], v4, s[12:15], s30 offen offset:1024
    buffer_store_dwordx4 a[56:59], v4, s[12:15], s30 offen offset:2048
    buffer_store_dwordx4 a[60:63], v4, s[12:15], s30 offen offset:3072
    s_add_u32 s30, s30, 4096
    buffer_store_dwordx4 a[64:67], v4, s[12:15], s30 offen offset:0
    buffer_store_dwordx4 a[68:71], v4, s[12:15], s30 offen offset:1024
    buffer_store_dwordx4 a[72:75], v4, s[12:15], s30 offen offset:2048
    buffer_store_dwordx4 a[76:79], v4, s[12:15], s30 offen offset:3072
    s_add_u32 s30, s30, 4096
    buffer_store_dwordx4 a[80:83], v4, s[12:15], s30 offen offset:0
    buffer_store_dwordx4 a[84:87], v4, s[12:15], s30 offen offset:1024
    buffer_store_dwordx4 a[88:91], v4, s[12:15], s30 offen offset:2048
    buffer_store_dwordx4 a[92:95], v4, s[12:15], s30 offen offset:3072
    s_add_u32 s30, s30, 4096
    buffer_store_dwordx4 a[96:99], v4, s[12:15], s30 offen offset:0
    buffer_store_dwordx4 a[100:103], v4, s[12:15], s30 offen offset:1024
    buffer_store_dwordx4 a[104:107], v4, s[12:15], s30 offen offset:2048
    buffer_store_dwordx4 a[108:111], v4, s[12:15], s30 offen offset:3072
    s_mov_b32 s68, 3
    s_branch L_at_round
L_at_nostash:
    s_cmp_lg_u32 s25, 0
    s_cbranch_scc1 L_at_maxpass
L_at_pre:
    s_cmp_lg_u32 s71, 0
    s_cbranch_scc1 L_at_nowo1a
    s_mov_b32 s71, 2
    s_mov_b32 s68, 0x103
    v_accvgpr_read_b32 v3, a249
    s_add_u32 s57, s56, 160
    s_waitcnt vmcnt(24)
    ds_read_b64_tr_b16 a[224:225], v3 offset:0
    ds_read_b64_tr_b16 a[226:227], v3 offset:640
    ds_read_b64_tr_b16 a[228:229], v3 offset:32
    ds_read_b64_tr_b16 a[230:231], v3 offset:672
    ds_read_b64_tr_b16 a[232:233], v3 offset:64
    ds_read_b64_tr_b16 a[234:235], v3 offset:704
    ds_read_b64_tr_b16 a[236:237], v3 offset:96
    ds_read_b64_tr_b16 a[238:239], v3 offset:736
    ds_read_b64_tr_b16 a[240:241], v3 offset:128
    ds_read_b64_tr_b16 a[242:243], v3 offset:768
    s_waitcnt lgkmcnt(0)
    s_add_u32 m0, s58, 0
    v_accvgpr_read_b32 v5, a244
    buffer_load_dwordx4 v5, s[84:87], s57 offen lds
    s_add_u32 m0, s58, 1024
    v_accvgpr_read_b32 v5, a245
    buffer_load_dwordx4 v5, s[84:87], s57 offen lds
    s_add_u32 m0, s58, 2048
    v_accvgpr_read_b32 v5, a246
    buffer_load_dwordx4 v5, s[84:87], s57 offen lds
    s_add_u32 m0, s58, 3072
    v_accvgpr_read_b32 v5, a247
    buffer_load_dwordx4 v5, s[84:87], s57 offen lds
    s_add_u32 m0, s58, 4096
    v_accvgpr_read_b32 v5, a248
    buffer_load_dwordx4 v5, s[84:87], s57 offen lds
L_at_nowo1a:
L_at_nowo1:
    s_waitcnt lgkmcnt(0)
    v_mfma_f32_16x16x32_bf16 v[88:91], v[56:59], a[0:3], 0
    v_mov_b32 v168, 0
    v_mov_b32 v169, 0
    v_mfma_f32_16x16x32_bf16 v[88:91], v[60:63], a[4:7], v[88:91]
    v_mov_b32 v170, 0
    v_mov_b32 v171, 0
    v_mfma_f32_16x16x32_bf16 v[88:91], v[64:67], a[8:11], v[88:91]
    v_mov_b32 v196, 0
    v_mov_b32 v197, 0
    v_mfma_f32_16x16x32_bf16 v[88:91], v[68:71], a[12:15], v[88:91]
    v_mov_b32 v198, 0
    v_mov_b32 v199, 0
    v_mfma_f32_16x16x32_bf16 v[92:95], v[72:75], a[0:3], 0
    v_mov_b32 v224, 0
    v_mov_b32 v225, 0
    v_mfma_f32_16x16x32_bf16 v[92:95], v[76:79], a[4:7], v[92:95]
    v_mov_b32 v226, 0
    v_mov_b32 v227, 0
    v_mfma_f32_16x16x32_bf16 v[92:95], v[80:83], a[8:11], v[92:95]
    v_mov_b32 v252, 0
    v_mov_b32 v253, 0
    v_mfma_f32_16x16x32_bf16 v[92:95], v[84:87], a[12:15], v[92:95]
    v_mov_b32 v254, 0
    v_mov_b32 v255, 0
    v_accvgpr_write_b32 a136, 0
    v_accvgpr_write_b32 a137, 0
    v_accvgpr_write_b32 a138, 0
    v_accvgpr_write_b32 a139, 0
    v_accvgpr_write_b32 a164, 0
    v_accvgpr_write_b32 a165, 0
    v_accvgpr_write_b32 a166, 0
    v_accvgpr_write_b32 a167, 0
    v_accvgpr_write_b32 a192, 0
    v_accvgpr_write_b32 a193, 0
    v_accvgpr_write_b32 a194, 0
    v_accvgpr_write_b32 a195, 0
    v_accvgpr_write_b32 a220, 0
    v_accvgpr_write_b32 a221, 0
    v_accvgpr_write_b32 a222, 0
    v_accvgpr_write_b32 a223, 0
    v_mfma_f32_16x16x32_bf16 v[96:99], v[56:59], a[16:19], 0
    v_max3_f32 v2, v88, v89, v12
    v_max3_f32 v3, v90, v91, v92
    v_max3_f32 v2, v93, v94, v2
    v_mfma_f32_16x16x32_bf16 v[96:99], v[60:63], a[20:23], v[96:99]
    v_max3_f32 v2, v95, v2, v3
    v_mov_b32 v3, v2
    s_nop 1
    v_permlane16_swap_b32 v2, v3
    v_mfma_f32_16x16x32_bf16 v[96:99], v[64:67], a[24:27], v[96:99]
    s_nop 1
    v_max_f32 v2, v2, v3
    v_mov_b32 v3, v2
    v_mfma_f32_16x16x32_bf16 v[96:99], v[68:71], a[28:31], v[96:99]
    s_nop 1
    v_permlane32_swap_b32 v2, v3
    s_nop 1
    v_max_f32 v2, v2, v3
    v_mfma_f32_16x16x32_bf16 v[100:103], v[72:75], a[16:19], 0
    v_mov_b32 v12, 0
    v_mov_b32 v13, 0
    v_sub_f32 v88, v88, v2
    v_mfma_f32_16x16x32_bf16 v[100:103], v[76:79], a[20:23], v[100:103]
    v_sub_f32 v89, v89, v2
    v_sub_f32 v90, v90, v2
    v_sub_f32 v91, v91, v2
    v_sub_f32 v92, v92, v2
    v_mfma_f32_16x16x32_bf16 v[100:103], v[80:83], a[24:27], v[100:103]
    v_sub_f32 v93, v93, v2
    v_sub_f32 v94, v94, v2
    v_sub_f32 v95, v95, v2
    v_mfma_f32_16x16x32_bf16 v[100:103], v[84:87], a[28:31], v[100:103]
    v_sub_f32 v28, 0, v2
    v_sub_f32 v29, 0, v2
    v_sub_f32 v30, 0, v2
    v_sub_f32 v31, 0, v2
    ds_read_b64_tr_b16 v[112:113], v9 offset:0
    ds_read_b64_tr_b16 v[114:115], v9 offset:512
    v_exp_f32 v88, v88
    ds_read_b64_tr_b16 v[116:117], v9 offset:32
    ds_read_b64_tr_b16 v[118:119], v9 offset:544
    v_exp_f32 v89, v89
    v_exp_f32 v90, v90
    ds_read_b64_tr_b16 v[120:121], v9 offset:64
    ds_read_b64_tr_b16 v[122:123], v9 offset:576
    v_exp_f32 v91, v91
    v_add_f32 v12, v12, v88
    v_add_f32 v13, v13, v89
    ds_read_b64_tr_b16 v[124:125], v9 offset:96
    ds_read_b64_tr_b16 v[126:127], v9 offset:608
    v_cvt_pk_bf16_f32 v104, v88, v89
    v_exp_f32 v92, v92
    ds_read_b64_tr_b16 v[128:129], v9 offset:128
    ds_read_b64_tr_b16 v[130:131], v9 offset:640
    v_exp_f32 v93, v93
    v_add_f32 v12, v12, v90
    v_add_f32 v13, v13, v91
    ds_read_b64_tr_b16 v[132:133], v9 offset:160
    ds_read_b64_tr_b16 v[134:135], v9 offset:672
    v_cvt_pk_bf16_f32 v105, v90, v91
    v_exp_f32 v94, v94
    ds_read_b64_tr_b16 v[136:137], v9 offset:192
    ds_read_b64_tr_b16 v[138:139], v9 offset:704
    v_exp_f32 v95, v95
    v_add_f32 v12, v12, v92
    v_add_f32 v13, v13, v93
    ds_read_b64_tr_b16 v[140:141], v9 offset:224
    ds_read_b64_tr_b16 v[142:143], v9 offset:736
    v_cvt_pk_bf16_f32 v106, v92, v93
    v_add_f32 v12, v12, v94
    v_add_f32 v13, v13, v95
    v_cvt_pk_bf16_f32 v107, v94, v95
    v_mfma_f32_16x16x32_bf16 v[88:91], v[56:59], a[32:35], 0
    v_max3_f32 v2, v96, v97, v14
    v_max3_f32 v3, v98, v99, v100
    v_max3_f32 v2, v101, v102, v2
    v_mfma_f32_16x16x32_bf16 v[88:91], v[60:63], a[36:39], v[88:91]
    v_max3_f32 v2, v103, v2, v3
    v_mov_b32 v3, v2
    s_nop 1
    v_permlane16_swap_b32 v2, v3
    v_mfma_f32_16x16x32_bf16 v[88:91], v[64:67], a[40:43], v[88:91]
    s_nop 1
    v_max_f32 v2, v2, v3
    v_mov_b32 v3, v2
    v_mfma_f32_16x16x32_bf16 v[88:91], v[68:71], a[44:47], v[88:91]
    s_nop 1
    v_permlane32_swap_b32 v2, v3
    s_nop 1
    v_max_f32 v2, v2, v3
    v_mfma_f32_16x16x32_bf16 v[92:95], v[72:75], a[32:35], 0
    v_mov_b32 v14, 0
    v_mov_b32 v15, 0
    v_sub_f32 v96, v96, v2
    v_mfma_f32_16x16x32_bf16 v[92:95], v[76:79], a[36:39], v[92:95]
    v_sub_f32 v97, v97, v2
    v_sub_f32 v98, v98, v2
    v_sub_f32 v99, v99, v2
    v_sub_f32 v100, v100, v2
    v_mfma_f32_16x16x32_bf16 v[92:95], v[80:83], a[40:43], v[92:95]
    v_sub_f32 v101, v101, v2
    v_sub_f32 v102, v102, v2
    v_sub_f32 v103, v103, v2
    v_mfma_f32_16x16x32_bf16 v[92:95], v[84:87], a[44:47], v[92:95]
    v_sub_f32 v32, 0, v2
    v_sub_f32 v33, 0, v2
    v_sub_f32 v34, 0, v2
    v_sub_f32 v35, 0, v2
    s_waitcnt lgkmcnt(0)
    v_mfma_f32_16x16x32_bf16 v[144:147], v[112:115], v[104:107], 0
    v_exp_f32 v96, v96
    v_mfma_f32_16x16x32_bf16 v[172:175], v[116:119], v[104:107], 0
    v_exp_f32 v97, v97
    v_exp_f32 v98, v98
    v_mfma_f32_16x16x32_bf16 v[200:203], v[120:123], v[104:107], 0
    v_exp_f32 v99, v99
    v_add_f32 v14, v14, v96
    v_add_f32 v15, v15, v97
    v_mfma_f32_16x16x32_bf16 v[228:231], v[124:127], v[104:107], 0
    v_cvt_pk_bf16_f32 v108, v96, v97
    v_exp_f32 v100, v100
    v_mfma_f32_16x16x32_bf16 a[112:115], v[128:131], v[104:107], 0
    v_exp_f32 v101, v101
    v_add_f32 v14, v14, v98
    v_add_f32 v15, v15, v99
    v_mfma_f32_16x16x32_bf16 a[140:143], v[132:135], v[104:107], 0
    v_cvt_pk_bf16_f32 v109, v98, v99
    v_exp_f32 v102, v102
    v_mfma_f32_16x16x32_bf16 a[168:171], v[136:139], v[104:107], 0
    v_exp_f32 v103, v103
    v_add_f32 v14, v14, v100
    v_add_f32 v15, v15, v101
    v_mfma_f32_16x16x32_bf16 a[196:199], v[140:143], v[104:107], 0
    v_cvt_pk_bf16_f32 v110, v100, v101
    v_add_f32 v14, v14, v102
    v_add_f32 v15, v15, v103
    v_cvt_pk_bf16_f32 v111, v102, v103
    v_mfma_f32_16x16x32_bf16 v[96:99], v[56:59], a[48:51], 0
    v_max3_f32 v2, v88, v89, v16
    v_max3_f32 v3, v90, v91, v92
    v_max3_f32 v2, v93, v94, v2
    v_mfma_f32_16x16x32_bf16 v[96:99], v[60:63], a[52:55], v[96:99]
    v_max3_f32 v2, v95, v2, v3
    v_mov_b32 v3, v2
    s_nop 1
    v_permlane16_swap_b32 v2, v3
    v_mfma_f32_16x16x32_bf16 v[96:99], v[64:67], a[56:59], v[96:99]
    s_nop 1
    v_max_f32 v2, v2, v3
    v_mov_b32 v3, v2
    v_mfma_f32_16x16x32_bf16 v[96:99], v[68:71], a[60:63], v[96:99]
    s_nop 1
    v_permlane32_swap_b32 v2, v3
    s_nop 1
    v_max_f32 v2, v2, v3
    v_mfma_f32_16x16x32_bf16 v[100:103], v[72:75], a[48:51], 0
    v_mov_b32 v16, 0
    v_mov_b32 v17, 0
    v_sub_f32 v88, v88, v2
    v_mfma_f32_16x16x32_bf16 v[100:103], v[76:79], a[52:55], v[100:103]
    v_sub_f32 v89, v89, v2
    v_sub_f32 v90, v90, v2
    v_sub_f32 v91, v91, v2
    v_sub_f32 v92, v92, v2
    v_mfma_f32_16x16x32_bf16 v[100:103], v[80:83], a[56:59], v[100:103]
    v_sub_f32 v93, v93, v2
    v_sub_f32 v94, v94, v2
    v_sub_f32 v95, v95, v2
    v_mfma_f32_16x16x32_bf16 v[100:103], v[84:87], a[60:63], v[100:103]
    v_sub_f32 v36, 0, v2
    v_sub_f32 v37, 0, v2
    v_sub_f32 v38, 0, v2
    v_sub_f32 v39, 0, v2
    v_mfma_f32_16x16x32_bf16 v[148:151], v[112:115], v[108:111], 0
    v_exp_f32 v88, v88
    v_mfma_f32_16x16x32_bf16 v[176:179], v[116:119], v[108:111], 0
    v_exp_f32 v89, v89
    v_exp_f32 v90, v90
    v_mfma_f32_16x16x32_bf16 v[204:207], v[120:123], v[108:111], 0
    v_exp_f32 v91, v91
    v_add_f32 v16, v16, v88
    v_add_f32 v17, v17, v89
    v_mfma_f32_16x16x32_bf16 v[232:235], v[124:127], v[108:111], 0
    v_cvt_pk_bf16_f32 v104, v88, v89
    v_exp_f32 v92, v92
    v_mfma_f32_16x16x32_bf16 a[116:119], v[128:131], v[108:111], 0
    v_exp_f32 v93, v93
    v_add_f32 v16, v16, v90
    v_add_f32 v17, v17, v91
    v_mfma_f32_16x16x32_bf16 a[144:147], v[132:135], v[108:111], 0
    v_cvt_pk_bf16_f32 v105, v90, v91
    v_exp_f32 v94, v94
    v_mfma_f32_16x16x32_bf16 a[172:175], v[136:139], v[108:111], 0
    v_exp_f32 v95, v95
    v_add_f32 v16, v16, v92
    v_add_f32 v17, v17, v93
    v_mfma_f32_16x16x32_bf16 a[200:203], v[140:143], v[108:111], 0
    v_cvt_pk_bf16_f32 v106, v92, v93
    v_add_f32 v16, v16, v94
    v_add_f32 v17, v17, v95
    v_cvt_pk_bf16_f32 v107, v94, v95
    v_mfma_f32_16x16x32_bf16 v[88:91], v[56:59], a[64:67], 0
    v_max3_f32 v2, v96, v97, v18
    v_max3_f32 v3, v98, v99, v100
    v_max3_f32 v2, v101, v102, v2
    v_mfma_f32_16x16x32_bf16 v[88:91], v[60:63], a[68:71], v[88:91]
    v_max3_f32 v2, v103, v2, v3
    v_mov_b32 v3, v2
    s_nop 1
    v_permlane16_swap_b32 v2, v3
    v_mfma_f32_16x16x32_bf16 v[88:91], v[64:67], a[72:75], v[88:91]
    s_nop 1
    v_max_f32 v2, v2, v3
    v_mov_b32 v3, v2
    v_mfma_f32_16x16x32_bf16 v[88:91], v[68:71], a[76:79], v[88:91]
    s_nop 1
    v_permlane32_swap_b32 v2, v3
    s_nop 1
    v_max_f32 v2, v2, v3
    v_mfma_f32_16x16x32_bf16 v[92:95], v[72:75], a[64:67], 0
    v_mov_b32 v18, 0
    v_mov_b32 v19, 0
    v_sub_f32 v96, v96, v2
    v_mfma_f32_16x16x32_bf16 v[92:95], v[76:79], a[68:71], v[92:95]
    v_sub_f32 v97, v97, v2
    v_sub_f32 v98, v98, v2
    v_sub_f32 v99, v99, v2
    v_sub_f32 v100, v100, v2
    v_mfma_f32_16x16x32_bf16 v[92:95], v[80:83], a[72:75], v[92:95]
    v_sub_f32 v101, v101, v2
    v_sub_f32 v102, v102, v2
    v_sub_f32 v103, v103, v2
    v_mfma_f32_16x16x32_bf16 v[92:95], v[84:87], a[76:79], v[92:95]
    v_sub_f32 v40, 0, v2
    v_sub_f32 v41, 0, v2
    v_sub_f32 v42, 0, v2
    v_sub_f32 v43, 0, v2
    v_mfma_f32_16x16x32_bf16 v[152:155], v[112:115], v[104:107], 0
    v_exp_f32 v96, v96
    v_mfma_f32_16x16x32_bf16 v[180:183], v[116:119], v[104:107], 0
    v_exp_f32 v97, v97
    v_exp_f32 v98, v98
    v_mfma_f32_16x16x32_bf16 v[208:211], v[120:123], v[104:107], 0
    v_exp_f32 v99, v99
    v_add_f32 v18, v18, v96
    v_add_f32 v19, v19, v97
    v_mfma_f32_16x16x32_bf16 v[236:239], v[124:127], v[104:107], 0
    v_cvt_pk_bf16_f32 v108, v96, v97
    v_exp_f32 v100, v100
    v_mfma_f32_16x16x32_bf16 a[120:123], v[128:131], v[104:107], 0
    v_exp_f32 v101, v101
    v_add_f32 v18, v18, v98
    v_add_f32 v19, v19, v99
    v_mfma_f32_16x16x32_bf16 a[148:151], v[132:135], v[104:107], 0
    v_cvt_pk_bf16_f32 v109, v98, v99
    v_exp_f32 v102, v102
    v_mfma_f32_16x16x32_bf16 a[176:179], v[136:139], v[104:107], 0
    v_exp_f32 v103, v103
    v_add_f32 v18, v18, v100
    v_add_f32 v19, v19, v101
    v_mfma_f32_16x16x32_bf16 a[204:207], v[140:143], v[104:107], 0
    v_cvt_pk_bf16_f32 v110, v100, v101
    v_add_f32 v18, v18, v102
    v_add_f32 v19, v19, v103
    v_cvt_pk_bf16_f32 v111, v102, v103
    v_mfma_f32_16x16x32_bf16 v[96:99], v[56:59], a[80:83], 0
    v_max3_f32 v2, v88, v89, v20
    v_max3_f32 v3, v90, v91, v92
    v_max3_f32 v2, v93, v94, v2
    v_mfma_f32_16x16x32_bf16 v[96:99], v[60:63], a[84:87], v[96:99]
    v_max3_f32 v2, v95, v2, v3
    v_mov_b32 v3, v2
    s_nop 1
    v_permlane16_swap_b32 v2, v3
    v_mfma_f32_16x16x32_bf16 v[96:99], v[64:67], a[88:91], v[96:99]
    s_nop 1
    v_max_f32 v2, v2, v3
    v_mov_b32 v3, v2
    v_mfma_f32_16x16x32_bf16 v[96:99], v[68:71], a[92:95], v[96:99]
    s_nop 1
    v_permlane32_swap_b32 v2, v3
    s_nop 1
    v_max_f32 v2, v2, v3
    v_mfma_f32_16x16x32_bf16 v[100:103], v[72:75], a[80:83], 0
    v_mov_b32 v20, 0
    v_mov_b32 v21, 0
    v_sub_f32 v88, v88, v2
    v_mfma_f32_16x16x32_bf16 v[100:103], v[76:79], a[84:87], v[100:103]
    v_sub_f32 v89, v89, v2
    v_sub_f32 v90, v90, v2
    v_sub_f32 v91, v91, v2
    v_sub_f32 v92, v92, v2
    v_mfma_f32_16x16x32_bf16 v[100:103], v[80:83], a[88:91], v[100:103]
    v_sub_f32 v93, v93, v2
    v_sub_f32 v94, v94, v2
    v_sub_f32 v95, v95, v2
    v_mfma_f32_16x16x32_bf16 v[100:103], v[84:87], a[92:95], v[100:103]
    v_sub_f32 v44, 0, v2
    v_sub_f32 v45, 0, v2
    v_sub_f32 v46, 0, v2
    v_sub_f32 v47, 0, v2
    v_mfma_f32_16x16x32_bf16 v[156:159], v[112:115], v[108:111], 0
    v_exp_f32 v88, v88
    v_mfma_f32_16x16x32_bf16 v[184:187], v[116:119], v[108:111], 0
    v_exp_f32 v89, v89
    v_exp_f32 v90, v90
    v_mfma_f32_16x16x32_bf16 v[212:215], v[120:123], v[108:111], 0
    v_exp_f32 v91, v91
    v_add_f32 v20, v20, v88
    v_add_f32 v21, v21, v89
    v_mfma_f32_16x16x32_bf16 v[240:243], v[124:127], v[108:111], 0
    v_cvt_pk_bf16_f32 v104, v88, v89
    v_exp_f32 v92, v92
    v_mfma_f32_16x16x32_bf16 a[124:127], v[128:131], v[108:111], 0
    v_exp_f32 v93, v93
    v_add_f32 v20, v20, v90
    v_add_f32 v21, v21, v91
    v_mfma_f32_16x16x32_bf16 a[152:155], v[132:135], v[108:111], 0
    v_cvt_pk_bf16_f32 v105, v90, v91
    v_exp_f32 v94, v94
    v_mfma_f32_16x16x32_bf16 a[180:183], v[136:139], v[108:111], 0
    v_exp_f32 v95, v95
    v_add_f32 v20, v20, v92
    v_add_f32 v21, v21, v93
    v_mfma_f32_16x16x32_bf16 a[208:211], v[140:143], v[108:111], 0
    v_cvt_pk_bf16_f32 v106, v92, v93
    v_add_f32 v20, v20, v94
    v_add_f32 v21, v21, v95
    v_cvt_pk_bf16_f32 v107, v94, v95
    s_cmp_eq_u32 s68, 0
    s_cbranch_scc0 L_bw1_3256
    s_waitcnt vmcnt(16) lgkmcnt(0)
L_bw2_3256:
    s_barrier
    s_cmp_le_u32 s21, s27
    s_cbranch_scc1 L_at_nofb_3261
    s_sub_u32 s28, s21, 1
    s_cmp_eq_u32 s28, s23
    s_cbranch_scc1 L_at_nofb_3261
    s_lshl_b32 s29, s28, 2
    s_add_u32 s29, s29, 76000
    v_mov_b32 v4, s29
    ds_read_b32 v4, v4
    s_waitcnt lgkmcnt(0)
    v_readfirstlane_b32 s29, v4
    s_nop 3
    s_cmp_lg_u32 s29, 0
    s_cbranch_scc1 L_at_fallback
L_at_nofb_3261:
    v_mfma_f32_16x16x32_bf16 v[88:91], v[56:59], a[96:99], 0
    ds_read_b128 v[56:59], v8 offset:8448
    v_max3_f32 v2, v96, v97, v22
    v_max3_f32 v3, v98, v99, v100
    v_max3_f32 v2, v101, v102, v2
    v_mfma_f32_16x16x32_bf16 v[88:91], v[60:63], a[100:103], v[88:91]
    ds_read_b128 v[60:63], v8 offset:8512
    v_max3_f32 v2, v103, v2, v3
    v_mov_b32 v3, v2
    s_nop 1
    v_permlane16_swap_b32 v2, v3
    v_mfma_f32_16x16x32_bf16 v[88:91], v[64:67], a[104:107], v[88:91]
    ds_read_b128 v[64:67], v8 offset:8576
    s_nop 1
    v_max_f32 v2, v2, v3
    v_mov_b32 v3, v2
    v_mfma_f32_16x16x32_bf16 v[88:91], v[68:71], a[108:111], v[88:91]
    ds_read_b128 v[68:71], v8 offset:8640
    s_nop 1
    v_permlane32_swap_b32 v2, v3
    s_nop 1
    v_max_f32 v2, v2, v3
    v_mfma_f32_16x16x32_bf16 v[92:95], v[72:75], a[96:99], 0
    ds_read_b128 v[72:75], v8 offset:8960
    v_mov_b32 v22, 0
    v_mov_b32 v23, 0
    v_sub_f32 v96, v96, v2
    v_mfma_f32_16x16x32_bf16 v[92:95], v[76:79], a[100:103], v[92:95]
    ds_read_b128 v[76:79], v8 offset:9024
    v_sub_f32 v97, v97, v2
    v_sub_f32 v98, v98, v2
    v_sub_f32 v99, v99, v2
    v_sub_f32 v100, v100, v2
    v_mfma_f32_16x16x32_bf16 v[92:95], v[80:83], a[104:107], v[92:95]
    ds_read_b128 v[80:83], v8 offset:9088
    v_sub_f32 v101, v101, v2
    v_sub_f32 v102, v102, v2
    v_sub_f32 v103, v103, v2
    v_mfma_f32_16x16x32_bf16 v[92:95], v[84:87], a[108:111], v[92:95]
    ds_read_b128 v[84:87], v8 offset:9152
    v_sub_f32 v48, 0, v2
    v_sub_f32 v49, 0, v2
    v_sub_f32 v50, 0, v2
    v_sub_f32 v51, 0, v2
    v_mfma_f32_16x16x32_bf16 v[160:163], v[112:115], v[104:107], 0
    v_exp_f32 v96, v96
    v_mfma_f32_16x16x32_bf16 v[188:191], v[116:119], v[104:107], 0
    v_exp_f32 v97, v97
    v_exp_f32 v98, v98
    v_mfma_f32_16x16x32_bf16 v[216:219], v[120:123], v[104:107], 0
    v_exp_f32 v99, v99
    v_add_f32 v22, v22, v96
    v_add_f32 v23, v23, v97
    v_mfma_f32_16x16x32_bf16 v[244:247], v[124:127], v[104:107], 0
    v_cvt_pk_bf16_f32 v108, v96, v97
    v_exp_f32 v100, v100
    v_mfma_f32_16x16x32_bf16 a[128:131], v[128:131], v[104:107], 0
    v_exp_f32 v101, v101
    v_add_f32 v22, v22, v98
    v_add_f32 v23, v23, v99
    v_mfma_f32_16x16x32_bf16 a[156:159], v[132:135], v[104:107], 0
    v_cvt_pk_bf16_f32 v109, v98, v99
    v_exp_f32 v102, v102
    v_mfma_f32_16x16x32_bf16 a[184:187], v[136:139], v[104:107], 0
    v_exp_f32 v103, v103
    v_add_f32 v22, v22, v100
    v_add_f32 v23, v23, v101
    v_mfma_f32_16x16x32_bf16 a[212:215], v[140:143], v[104:107], 0
    v_cvt_pk_bf16_f32 v110, v100, v101
    v_add_f32 v22, v22, v102
    v_add_f32 v23, v23, v103
    v_cvt_pk_bf16_f32 v111, v102, v103
    s_waitcnt lgkmcnt(0)
    v_mfma_f32_16x16x32_bf16 v[96:99], v[56:59], a[0:3], v[28:31]
    v_max3_f32 v2, v88, v89, v24
    v_max3_f32 v3, v90, v91, v92
    v_max3_f32 v2, v93, v94, v2
    v_mfma_f32_16x16x32_bf16 v[96:99], v[60:63], a[4:7], v[96:99]
    v_max3_f32 v2, v95, v2, v3
    v_mov_b32 v3, v2
    s_nop 1
    v_permlane16_swap_b32 v2, v3
    v_mfma_f32_16x16x32_bf16 v[96:99], v[64:67], a[8:11], v[96:99]
    s_nop 1
    v_max_f32 v2, v2, v3
    v_mov_b32 v3, v2
    v_mfma_f32_16x16x32_bf16 v[96:99], v[68:71], a[12:15], v[96:99]
    s_nop 1
    v_permlane32_swap_b32 v2, v3
    s_nop 1
    v_max_f32 v2, v2, v3
    v_mfma_f32_16x16x32_bf16 v[100:103], v[72:75], a[0:3], v[28:31]
    v_mov_b32 v24, 0
    v_mov_b32 v25, 0
    v_sub_f32 v88, v88, v2
    v_mfma_f32_16x16x32_bf16 v[100:103], v[76:79], a[4:7], v[100:103]
    v_sub_f32 v89, v89, v2
    v_sub_f32 v90, v90, v2
    v_sub_f32 v91, v91, v2
    v_sub_f32 v92, v92, v2
    v_mfma_f32_16x16x32_bf16 v[100:103], v[80:83], a[8:11], v[100:103]
    v_sub_f32 v93, v93, v2
    v_sub_f32 v94, v94, v2
    v_sub_f32 v95, v95, v2
    v_mfma_f32_16x16x32_bf16 v[100:103], v[84:87], a[12:15], v[100:103]
    v_sub_f32 v52, 0, v2
    v_sub_f32 v53, 0, v2
    v_sub_f32 v54, 0, v2
    v_sub_f32 v55, 0, v2
    v_mfma_f32_16x16x32_bf16 v[164:167], v[112:115], v[108:111], 0
    v_exp_f32 v88, v88
    v_mfma_f32_16x16x32_bf16 v[192:195], v[116:119], v[108:111], 0
    v_exp_f32 v89, v89
    v_exp_f32 v90, v90
    v_mfma_f32_16x16x32_bf16 v[220:223], v[120:123], v[108:111], 0
    v_exp_f32 v91, v91
    v_add_f32 v24, v24, v88
    v_add_f32 v25, v25, v89
    v_mfma_f32_16x16x32_bf16 v[248:251], v[124:127], v[108:111], 0
    v_cvt_pk_bf16_f32 v104, v88, v89
    v_exp_f32 v92, v92
    v_mfma_f32_16x16x32_bf16 a[132:135], v[128:131], v[108:111], 0
    v_exp_f32 v93, v93
    v_add_f32 v24, v24, v90
    v_add_f32 v25, v25, v91
    v_mfma_f32_16x16x32_bf16 a[160:163], v[132:135], v[108:111], 0
    v_cvt_pk_bf16_f32 v105, v90, v91
    v_exp_f32 v94, v94
    v_mfma_f32_16x16x32_bf16 a[188:191], v[136:139], v[108:111], 0
    v_exp_f32 v95, v95
    v_add_f32 v24, v24, v92
    v_add_f32 v25, v25, v93
    v_mfma_f32_16x16x32_bf16 a[216:219], v[140:143], v[108:111], 0
    v_cvt_pk_bf16_f32 v106, v92, v93
    v_add_f32 v24, v24, v94
    v_add_f32 v25, v25, v95
    v_cvt_pk_bf16_f32 v107, v94, v95
    s_mov_b32 s22, 0
L_at_loop:
    v_mfma_f32_16x16x32_bf16 v[88:91], v[56:59], a[16:19], v[32:35]
    v_mfma_f32_16x16x32_bf16 v[88:91], v[60:63], a[20:23], v[88:91]
    v_exp_f32 v96, v96
    v_mfma_f32_16x16x32_bf16 v[88:91], v[64:67], a[24:27], v[88:91]
    v_exp_f32 v97, v97
    v_mfma_f32_16x16x32_bf16 v[88:91], v[68:71], a[28:31], v[88:91]
    v_exp_f32 v98, v98
    v_mfma_f32_16x16x32_bf16 v[92:95], v[72:75], a[16:19], v[32:35]
    v_exp_f32 v99, v99
    v_mfma_f32_16x16x32_bf16 v[92:95], v[76:79], a[20:23], v[92:95]
    v_add_f32 v12, v12, v96
    v_add_f32 v13, v13, v97
    v_mfma_f32_16x16x32_bf16 v[92:95], v[80:83], a[24:27], v[92:95]
    v_cvt_pk_bf16_f32 v108, v96, v97
    v_mfma_f32_16x16x32_bf16 v[92:95], v[84:87], a[28:31], v[92:95]
    v_exp_f32 v100, v100
    v_mfma_f32_16x16x32_bf16 v[168:171], v[112:115], v[104:107], v[168:171]
    ds_read_b64_tr_b16 v[112:113], v9 offset:8448
    ds_read_b64_tr_b16 v[114:115], v9 offset:8960
    v_exp_f32 v101, v101
    v_mfma_f32_16x16x32_bf16 v[196:199], v[116:119], v[104:107], v[196:199]
    ds_read_b64_tr_b16 v[116:117], v9 offset:8480
    ds_read_b64_tr_b16 v[118:119], v9 offset:8992
    v_add_f32 v12, v12, v98
    v_add_f32 v13, v13, v99
    v_mfma_f32_16x16x32_bf16 v[224:227], v[120:123], v[104:107], v[224:227]
    ds_read_b64_tr_b16 v[120:121], v9 offset:8512
    ds_read_b64_tr_b16 v[122:123], v9 offset:9024
    v_cvt_pk_bf16_f32 v109, v98, v99
    v_mfma_f32_16x16x32_bf16 v[252:255], v[124:127], v[104:107], v[252:255]
    ds_read_b64_tr_b16 v[124:125], v9 offset:8544
    ds_read_b64_tr_b16 v[126:127], v9 offset:9056
    v_exp_f32 v102, v102
    v_mfma_f32_16x16x32_bf16 a[136:139], v[128:131], v[104:107], a[136:139]
    ds_read_b64_tr_b16 v[128:129], v9 offset:8576
    ds_read_b64_tr_b16 v[130:131], v9 offset:9088
    v_exp_f32 v103, v103
    v_mfma_f32_16x16x32_bf16 a[164:167], v[132:135], v[104:107], a[164:167]
    ds_read_b64_tr_b16 v[132:133], v9 offset:8608
    ds_read_b64_tr_b16 v[134:135], v9 offset:9120
    v_add_f32 v12, v12, v100
    v_add_f32 v13, v13, v101
    v_mfma_f32_16x16x32_bf16 a[192:195], v[136:139], v[104:107], a[192:195]
    ds_read_b64_tr_b16 v[136:137], v9 offset:8640
    ds_read_b64_tr_b16 v[138:139], v9 offset:9152
    v_cvt_pk_bf16_f32 v110, v100, v101
    v_add_f32 v12, v12, v102
    v_mfma_f32_16x16x32_bf16 a[220:223], v[140:143], v[104:107], a[220:223]
    ds_read_b64_tr_b16 v[140:141], v9 offset:8672
    ds_read_b64_tr_b16 v[142:143], v9 offset:9184
    v_add_f32 v13, v13, v103
    v_cvt_pk_bf16_f32 v111, v102, v103
    v_mfma_f32_16x16x32_bf16 v[96:99], v[56:59], a[32:35], v[36:39]
    v_mfma_f32_16x16x32_bf16 v[96:99], v[60:63], a[36:39], v[96:99]
    s_add_u32 s29, s34, s100
    v_exp_f32 v88, v88
    v_mfma_f32_16x16x32_bf16 v[96:99], v[64:67], a[40:43], v[96:99]
    v_exp_f32 v89, v89
    v_mfma_f32_16x16x32_bf16 v[96:99], v[68:71], a[44:47], v[96:99]
    s_bfe_u32 s28, s29, 0x20003
    v_exp_f32 v90, v90
    v_mfma_f32_16x16x32_bf16 v[100:103], v[72:75], a[32:35], v[36:39]
    v_exp_f32 v91, v91
    v_mfma_f32_16x16x32_bf16 v[100:103], v[76:79], a[36:39], v[100:103]
    s_lshl_b32 s28, s28, 16
    v_add_f32 v14, v14, v88
    v_add_f32 v15, v15, v89
    v_mfma_f32_16x16x32_bf16 v[100:103], v[80:83], a[40:43], v[100:103]
    v_cvt_pk_bf16_f32 v104, v88, v89
    v_mfma_f32_16x16x32_bf16 v[100:103], v[84:87], a[44:47], v[100:103]
    v_exp_f32 v92, v92
    s_waitcnt lgkmcnt(0)
    v_mfma_f32_16x16x32_bf16 v[144:147], v[112:115], v[108:111], v[144:147]
    s_and_b32 s29, s29, 7
    v_exp_f32 v93, v93
    v_mfma_f32_16x16x32_bf16 v[172:175], v[116:119], v[108:111], v[172:175]
    v_add_f32 v14, v14, v90
    v_add_f32 v15, v15, v91
    v_mfma_f32_16x16x32_bf16 v[200:203], v[120:123], v[108:111], v[200:203]
    s_lshl_b32 s29, s29, 11
    v_cvt_pk_bf16_f32 v105, v90, v91
    v_mfma_f32_16x16x32_bf16 v[228:231], v[124:127], v[108:111], v[228:231]
    v_exp_f32 v94, v94
    v_mfma_f32_16x16x32_bf16 a[112:115], v[128:131], v[108:111], a[112:115]
    s_add_u32 s29, s28, s29
    v_exp_f32 v95, v95
    v_mfma_f32_16x16x32_bf16 a[140:143], v[132:135], v[108:111], a[140:143]
    v_add_f32 v14, v14, v92
    v_add_f32 v15, v15, v93
    v_mfma_f32_16x16x32_bf16 a[168:171], v[136:139], v[108:111], a[168:171]
    s_lshr_b32 s28, s34, 5
    v_cvt_pk_bf16_f32 v106, v92, v93
    v_add_f32 v14, v14, v94
    v_mfma_f32_16x16x32_bf16 a[196:199], v[140:143], v[108:111], a[196:199]
    v_add_f32 v15, v15, v95
    v_cvt_pk_bf16_f32 v107, v94, v95
    v_mfma_f32_16x16x32_bf16 v[88:91], v[56:59], a[48:51], v[40:43]
    v_mfma_f32_16x16x32_bf16 v[88:91], v[60:63], a[52:55], v[88:91]
    s_lshl_b32 s28, s28, 19
    v_exp_f32 v96, v96
    v_mfma_f32_16x16x32_bf16 v[88:91], v[64:67], a[56:59], v[88:91]
    v_exp_f32 v97, v97
    v_mfma_f32_16x16x32_bf16 v[88:91], v[68:71], a[60:63], v[88:91]
    s_add_u32 s49, s28, s29
    v_exp_f32 v98, v98
    v_mfma_f32_16x16x32_bf16 v[92:95], v[72:75], a[48:51], v[40:43]
    v_exp_f32 v99, v99
    v_mfma_f32_16x16x32_bf16 v[92:95], v[76:79], a[52:55], v[92:95]
    s_add_u32 m0, s33, 0
    v_add_f32 v16, v16, v96
    v_add_f32 v17, v17, v97
    v_mfma_f32_16x16x32_bf16 v[92:95], v[80:83], a[56:59], v[92:95]
    v_cvt_pk_bf16_f32 v108, v96, v97
    v_mfma_f32_16x16x32_bf16 v[92:95], v[84:87], a[60:63], v[92:95]
    v_exp_f32 v100, v100
    v_mfma_f32_16x16x32_bf16 v[148:151], v[112:115], v[104:107], v[148:151]
    s_add_u32 s34, s34, 1
    v_exp_f32 v101, v101
    v_mfma_f32_16x16x32_bf16 v[176:179], v[116:119], v[104:107], v[176:179]
    v_add_f32 v16, v16, v98
    v_add_f32 v17, v17, v99
    v_mfma_f32_16x16x32_bf16 v[204:207], v[120:123], v[104:107], v[204:207]
    buffer_load_dwordx4 v7, s[4:7], s49 offen offset:0 nt lds
    v_cvt_pk_bf16_f32 v109, v98, v99
    v_mfma_f32_16x16x32_bf16 v[232:235], v[124:127], v[104:107], v[232:235]
    v_exp_f32 v102, v102
    v_mfma_f32_16x16x32_bf16 a[116:119], v[128:131], v[104:107], a[116:119]
    s_add_u32 m0, m0, s96
    v_exp_f32 v103, v103
    v_mfma_f32_16x16x32_bf16 a[144:147], v[132:135], v[104:107], a[144:147]
    v_add_f32 v16, v16, v100
    v_add_f32 v17, v17, v101
    v_mfma_f32_16x16x32_bf16 a[172:175], v[136:139], v[104:107], a[172:175]
    buffer_load_dwordx4 v7, s[4:7], s49 offen offset:256 nt lds
    v_cvt_pk_bf16_f32 v110, v100, v101
    v_add_f32 v16, v16, v102
    v_mfma_f32_16x16x32_bf16 a[200:203], v[140:143], v[104:107], a[200:203]
    v_add_f32 v17, v17, v103
    v_cvt_pk_bf16_f32 v111, v102, v103
    v_mfma_f32_16x16x32_bf16 v[96:99], v[56:59], a[64:67], v[44:47]
    v_mfma_f32_16x16x32_bf16 v[96:99], v[60:63], a[68:71], v[96:99]
    s_add_u32 m0, m0, s97
    v_exp_f32 v88, v88
    v_mfma_f32_16x16x32_bf16 v[96:99], v[64:67], a[72:75], v[96:99]
    v_exp_f32 v89, v89
    v_mfma_f32_16x16x32_bf16 v[96:99], v[68:71], a[76:79], v[96:99]
    buffer_load_dwordx4 v7, s[4:7], s49 offen offset:512 nt lds
    v_exp_f32 v90, v90
    v_mfma_f32_16x16x32_bf16 v[100:103], v[72:75], a[64:67], v[44:47]
    v_exp_f32 v91, v91
    v_mfma_f32_16x16x32_bf16 v[100:103], v[76:79], a[68:71], v[100:103]
    s_add_u32 m0, m0, s96
    v_add_f32 v18, v18, v88
    v_add_f32 v19, v19, v89
    v_mfma_f32_16x16x32_bf16 v[100:103], v[80:83], a[72:75], v[100:103]
    v_cvt_pk_bf16_f32 v104, v88, v89
    v_mfma_f32_16x16x32_bf16 v[100:103], v[84:87], a[76:79], v[100:103]
    v_exp_f32 v92, v92
    v_mfma_f32_16x16x32_bf16 v[152:155], v[112:115], v[108:111], v[152:155]
    buffer_load_dwordx4 v7, s[4:7], s49 offen offset:768 nt lds
    v_exp_f32 v93, v93
    v_mfma_f32_16x16x32_bf16 v[180:183], v[116:119], v[108:111], v[180:183]
    v_add_f32 v18, v18, v90
    v_add_f32 v19, v19, v91
    v_mfma_f32_16x16x32_bf16 v[208:211], v[120:123], v[108:111], v[208:211]
    s_add_u32 m0, m0, s97
    v_cvt_pk_bf16_f32 v105, v90, v91
    v_mfma_f32_16x16x32_bf16 v[236:239], v[124:127], v[108:111], v[236:239]
    v_exp_f32 v94, v94
    v_mfma_f32_16x16x32_bf16 a[120:123], v[128:131], v[108:111], a[120:123]
    buffer_load_dwordx4 v7, s[4:7], s49 offen offset:1024 nt lds
    v_exp_f32 v95, v95
    v_mfma_f32_16x16x32_bf16 a[148:151], v[132:135], v[108:111], a[148:151]
    v_add_f32 v18, v18, v92
    v_add_f32 v19, v19, v93
    v_mfma_f32_16x16x32_bf16 a[176:179], v[136:139], v[108:111], a[176:179]
    s_add_u32 m0, m0, s96
    v_cvt_pk_bf16_f32 v106, v92, v93
    v_add_f32 v18, v18, v94
    v_mfma_f32_16x16x32_bf16 a[204:207], v[140:143], v[108:111], a[204:207]
    v_add_f32 v19, v19, v95
    v_cvt_pk_bf16_f32 v107, v94, v95
    v_mfma_f32_16x16x32_bf16 v[88:91], v[56:59], a[80:83], v[48:51]
    v_mfma_f32_16x16x32_bf16 v[88:91], v[60:63], a[84:87], v[88:91]
    buffer_load_dwordx4 v7, s[4:7], s49 offen offset:1280 nt lds
    v_exp_f32 v96, v96
    v_mfma_f32_16x16x32_bf16 v[88:91], v[64:67], a[88:91], v[88:91]
    v_exp_f32 v97, v97
    v_mfma_f32_16x16x32_bf16 v[88:91], v[68:71], a[92:95], v[88:91]
    s_add_u32 m0, m0, s97
    v_exp_f32 v98, v98
    v_mfma_f32_16x16x32_bf16 v[92:95], v[72:75], a[80:83], v[48:51]
    v_exp_f32 v99, v99
    v_mfma_f32_16x16x32_bf16 v[92:95], v[76:79], a[84:87], v[92:95]
    buffer_load_dwordx4 v7, s[4:7], s49 offen offset:1536 nt lds
    v_add_f32 v20, v20, v96
    v_add_f32 v21, v21, v97
    v_mfma_f32_16x16x32_bf16 v[92:95], v[80:83], a[88:91], v[92:95]
    v_cvt_pk_bf16_f32 v108, v96, v97
    v_mfma_f32_16x16x32_bf16 v[92:95], v[84:87], a[92:95], v[92:95]
    v_exp_f32 v100, v100
    v_mfma_f32_16x16x32_bf16 v[156:159], v[112:115], v[104:107], v[156:159]
    s_add_u32 m0, m0, s96
    v_exp_f32 v101, v101
    v_mfma_f32_16x16x32_bf16 v[184:187], v[116:119], v[104:107], v[184:187]
    v_add_f32 v20, v20, v98
    v_add_f32 v21, v21, v99
    v_mfma_f32_16x16x32_bf16 v[212:215], v[120:123], v[104:107], v[212:215]
    buffer_load_dwordx4 v7, s[4:7], s49 offen offset:1792 nt lds
    v_cvt_pk_bf16_f32 v109, v98, v99
    v_mfma_f32_16x16x32_bf16 v[240:243], v[124:127], v[104:107], v[240:243]
    v_exp_f32 v102, v102
    v_mfma_f32_16x16x32_bf16 a[124:127], v[128:131], v[104:107], a[124:127]
    v_exp_f32 v103, v103
    v_mfma_f32_16x16x32_bf16 a[152:155], v[132:135], v[104:107], a[152:155]
    v_add_f32 v20, v20, v100
    v_add_f32 v21, v21, v101
    v_mfma_f32_16x16x32_bf16 a[180:183], v[136:139], v[104:107], a[180:183]
    v_cvt_pk_bf16_f32 v110, v100, v101
    v_add_f32 v20, v20, v102
    v_mfma_f32_16x16x32_bf16 a[208:211], v[140:143], v[104:107], a[208:211]
    v_add_f32 v21, v21, v103
    v_cvt_pk_bf16_f32 v111, v102, v103
    s_cmp_eq_u32 s68, 0
    s_cbranch_scc0 L_bw1_3638
    s_waitcnt vmcnt(16) lgkmcnt(0)
L_bw2_3638:
    s_barrier
    v_mfma_f32_16x16x32_bf16 v[96:99], v[56:59], a[96:99], v[52:55]
    ds_read_b128 v[56:59], v8 offset:16896
    v_mfma_f32_16x16x32_bf16 v[96:99], v[60:63], a[100:103], v[96:99]
    ds_read_b128 v[60:63], v8 offset:16960
    v_exp_f32 v88, v88
    v_mfma_f32_16x16x32_bf16 v[96:99], v[64:67], a[104:107], v[96:99]
    ds_read_b128 v[64:67], v8 offset:17024
    v_exp_f32 v89, v89
    v_mfma_f32_16x16x32_bf16 v[96:99], v[68:71], a[108:111], v[96:99]
    ds_read_b128 v[68:71], v8 offset:17088
    v_exp_f32 v90, v90
    v_mfma_f32_16x16x32_bf16 v[100:103], v[72:75], a[96:99], v[52:55]
    ds_read_b128 v[72:75], v8 offset:17408
    v_exp_f32 v91, v91
    v_mfma_f32_16x16x32_bf16 v[100:103], v[76:79], a[100:103], v[100:103]
    ds_read_b128 v[76:79], v8 offset:17472
    v_add_f32 v22, v22, v88
    v_add_f32 v23, v23, v89
    v_mfma_f32_16x16x32_bf16 v[100:103], v[80:83], a[104:107], v[100:103]
    ds_read_b128 v[80:83], v8 offset:17536
    v_cvt_pk_bf16_f32 v104, v88, v89
    v_mfma_f32_16x16x32_bf16 v[100:103], v[84:87], a[108:111], v[100:103]
    ds_read_b128 v[84:87], v8 offset:17600
    v_exp_f32 v92, v92
    v_mfma_f32_16x16x32_bf16 v[160:163], v[112:115], v[108:111], v[160:163]
    v_exp_f32 v93, v93
    v_mfma_f32_16x16x32_bf16 v[188:191], v[116:119], v[108:111], v[188:191]
    v_add_f32 v22, v22, v90
    v_add_f32 v23, v23, v91
    v_mfma_f32_16x16x32_bf16 v[216:219], v[120:123], v[108:111], v[216:219]
    v_cvt_pk_bf16_f32 v105, v90, v91
    v_mfma_f32_16x16x32_bf16 v[244:247], v[124:127], v[108:111], v[244:247]
    v_exp_f32 v94, v94
    v_mfma_f32_16x16x32_bf16 a[128:131], v[128:131], v[108:111], a[128:131]
    v_exp_f32 v95, v95
    v_mfma_f32_16x16x32_bf16 a[156:159], v[132:135], v[108:111], a[156:159]
    v_add_f32 v22, v22, v92
    v_add_f32 v23, v23, v93
    v_mfma_f32_16x16x32_bf16 a[184:187], v[136:139], v[108:111], a[184:187]
    v_cvt_pk_bf16_f32 v106, v92, v93
    v_add_f32 v22, v22, v94
    v_mfma_f32_16x16x32_bf16 a[212:215], v[140:143], v[108:111], a[212:215]
    v_add_f32 v23, v23, v95
    v_cvt_pk_bf16_f32 v107, v94, v95
    s_waitcnt lgkmcnt(0)
    v_mfma_f32_16x16x32_bf16 v[88:91], v[56:59], a[0:3], v[28:31]
    v_mfma_f32_16x16x32_bf16 v[88:91], v[60:63], a[4:7], v[88:91]
    v_exp_f32 v96, v96
    v_mfma_f32_16x16x32_bf16 v[88:91], v[64:67], a[8:11], v[88:91]
    v_exp_f32 v97, v97
    v_mfma_f32_16x16x32_bf16 v[88:91], v[68:71], a[12:15], v[88:91]
    v_exp_f32 v98, v98
    v_mfma_f32_16x16x32_bf16 v[92:95], v[72:75], a[0:3], v[28:31]
    v_exp_f32 v99, v99
    v_mfma_f32_16x16x32_bf16 v[92:95], v[76:79], a[4:7], v[92:95]
    v_add_f32 v24, v24, v96
    v_add_f32 v25, v25, v97
    v_mfma_f32_16x16x32_bf16 v[92:95], v[80:83], a[8:11], v[92:95]
    v_cvt_pk_bf16_f32 v108, v96, v97
    v_mfma_f32_16x16x32_bf16 v[92:95], v[84:87], a[12:15], v[92:95]
    v_exp_f32 v100, v100
    v_mfma_f32_16x16x32_bf16 v[164:167], v[112:115], v[104:107], v[164:167]
    v_exp_f32 v101, v101
    v_mfma_f32_16x16x32_bf16 v[192:195], v[116:119], v[104:107], v[192:195]
    v_add_f32 v24, v24, v98
    v_add_f32 v25, v25, v99
    v_mfma_f32_16x16x32_bf16 v[220:223], v[120:123], v[104:107], v[220:223]
    v_cvt_pk_bf16_f32 v109, v98, v99
    v_mfma_f32_16x16x32_bf16 v[248:251], v[124:127], v[104:107], v[248:251]
    v_exp_f32 v102, v102
    v_mfma_f32_16x16x32_bf16 a[132:135], v[128:131], v[104:107], a[132:135]
    v_exp_f32 v103, v103
    v_mfma_f32_16x16x32_bf16 a[160:163], v[132:135], v[104:107], a[160:163]
    v_add_f32 v24, v24, v100
    v_add_f32 v25, v25, v101
    v_mfma_f32_16x16x32_bf16 a[188:191], v[136:139], v[104:107], a[188:191]
    v_cvt_pk_bf16_f32 v110, v100, v101
    v_add_f32 v24, v24, v102
    v_mfma_f32_16x16x32_bf16 a[216:219], v[140:143], v[104:107], a[216:219]
    v_add_f32 v25, v25, v103
    v_cvt_pk_bf16_f32 v111, v102, v103
    v_mfma_f32_16x16x32_bf16 v[96:99], v[56:59], a[16:19], v[32:35]
    v_mfma_f32_16x16x32_bf16 v[96:99], v[60:63], a[20:23], v[96:99]
    v_exp_f32 v88, v88
    v_mfma_f32_16x16x32_bf16 v[96:99], v[64:67], a[24:27], v[96:99]
    v_exp_f32 v89, v89
    v_mfma_f32_16x16x32_bf16 v[96:99], v[68:71], a[28:31], v[96:99]
    v_exp_f32 v90, v90
    v_mfma_f32_16x16x32_bf16 v[100:103], v[72:75], a[16:19], v[32:35]
    v_exp_f32 v91, v91
    v_mfma_f32_16x16x32_bf16 v[100:103], v[76:79], a[20:23], v[100:103]
    v_add_f32 v12, v12, v88
    v_add_f32 v13, v13, v89
    v_mfma_f32_16x16x32_bf16 v[100:103], v[80:83], a[24:27], v[100:103]
    v_cvt_pk_bf16_f32 v104, v88, v89
    v_mfma_f32_16x16x32_bf16 v[100:103], v[84:87], a[28:31], v[100:103]
    v_exp_f32 v92, v92
    v_mfma_f32_16x16x32_bf16 v[168:171], v[112:115], v[108:111], v[168:171]
    ds_read_b64_tr_b16 v[112:113], v9 offset:16896
    ds_read_b64_tr_b16 v[114:115], v9 offset:17408
    v_exp_f32 v93, v93
    v_mfma_f32_16x16x32_bf16 v[196:199], v[116:119], v[108:111], v[196:199]
    ds_read_b64_tr_b16 v[116:117], v9 offset:16928
    ds_read_b64_tr_b16 v[118:119], v9 offset:17440
    v_add_f32 v12, v12, v90
    v_add_f32 v13, v13, v91
    v_mfma_f32_16x16x32_bf16 v[224:227], v[120:123], v[108:111], v[224:227]
    ds_read_b64_tr_b16 v[120:121], v9 offset:16960
    ds_read_b64_tr_b16 v[122:123], v9 offset:17472
    v_cvt_pk_bf16_f32 v105, v90, v91
    v_mfma_f32_16x16x32_bf16 v[252:255], v[124:127], v[108:111], v[252:255]
    ds_read_b64_tr_b16 v[124:125], v9 offset:16992
    ds_read_b64_tr_b16 v[126:127], v9 offset:17504
    v_exp_f32 v94, v94
    v_mfma_f32_16x16x32_bf16 a[136:139], v[128:131], v[108:111], a[136:139]
    ds_read_b64_tr_b16 v[128:129], v9 offset:17024
    ds_read_b64_tr_b16 v[130:131], v9 offset:17536
    v_exp_f32 v95, v95
    v_mfma_f32_16x16x32_bf16 a[164:167], v[132:135], v[108:111], a[164:167]
    ds_read_b64_tr_b16 v[132:133], v9 offset:17056
    ds_read_b64_tr_b16 v[134:135], v9 offset:17568
    v_add_f32 v12, v12, v92
    v_add_f32 v13, v13, v93
    v_mfma_f32_16x16x32_bf16 a[192:195], v[136:139], v[108:111], a[192:195]
    ds_read_b64_tr_b16 v[136:137], v9 offset:17088
    ds_read_b64_tr_b16 v[138:139], v9 offset:17600
    v_cvt_pk_bf16_f32 v106, v92, v93
    v_add_f32 v12, v12, v94
    v_mfma_f32_16x16x32_bf16 a[220:223], v[140:143], v[108:111], a[220:223]
    ds_read_b64_tr_b16 v[140:141], v9 offset:17120
    ds_read_b64_tr_b16 v[142:143], v9 offset:17632
    v_add_f32 v13, v13, v95
    v_cvt_pk_bf16_f32 v107, v94, v95
    v_mfma_f32_16x16x32_bf16 v[88:91], v[56:59], a[32:35], v[36:39]
    v_mfma_f32_16x16x32_bf16 v[88:91], v[60:63], a[36:39], v[88:91]
    s_add_u32 s29, s34, s100
    v_exp_f32 v96, v96
    v_mfma_f32_16x16x32_bf16 v[88:91], v[64:67], a[40:43], v[88:91]
    v_exp_f32 v97, v97
    v_mfma_f32_16x16x32_bf16 v[88:91], v[68:71], a[44:47], v[88:91]
    s_bfe_u32 s28, s29, 0x20003
    v_exp_f32 v98, v98
    v_mfma_f32_16x16x32_bf16 v[92:95], v[72:75], a[32:35], v[36:39]
    v_exp_f32 v99, v99
    v_mfma_f32_16x16x32_bf16 v[92:95], v[76:79], a[36:39], v[92:95]
    s_lshl_b32 s28, s28, 16
    v_add_f32 v14, v14, v96
    v_add_f32 v15, v15, v97
    v_mfma_f32_16x16x32_bf16 v[92:95], v[80:83], a[40:43], v[92:95]
    v_cvt_pk_bf16_f32 v108, v96, v97
    v_mfma_f32_16x16x32_bf16 v[92:95], v[84:87], a[44:47], v[92:95]
    v_exp_f32 v100, v100
    s_waitcnt lgkmcnt(0)
    v_mfma_f32_16x16x32_bf16 v[144:147], v[112:115], v[104:107], v[144:147]
    s_and_b32 s29, s29, 7
    v_exp_f32 v101, v101
    v_mfma_f32_16x16x32_bf16 v[172:175], v[116:119], v[104:107], v[172:175]
    v_add_f32 v14, v14, v98
    v_add_f32 v15, v15, v99
    v_mfma_f32_16x16x32_bf16 v[200:203], v[120:123], v[104:107], v[200:203]
    s_lshl_b32 s29, s29, 11
    v_cvt_pk_bf16_f32 v109, v98, v99
    v_mfma_f32_16x16x32_bf16 v[228:231], v[124:127], v[104:107], v[228:231]
    v_exp_f32 v102, v102
    v_mfma_f32_16x16x32_bf16 a[112:115], v[128:131], v[104:107], a[112:115]
    s_add_u32 s29, s28, s29
    v_exp_f32 v103, v103
    v_mfma_f32_16x16x32_bf16 a[140:143], v[132:135], v[104:107], a[140:143]
    v_add_f32 v14, v14, v100
    v_add_f32 v15, v15, v101
    v_mfma_f32_16x16x32_bf16 a[168:171], v[136:139], v[104:107], a[168:171]
    s_lshr_b32 s28, s34, 5
    v_cvt_pk_bf16_f32 v110, v100, v101
    v_add_f32 v14, v14, v102
    v_mfma_f32_16x16x32_bf16 a[196:199], v[140:143], v[104:107], a[196:199]
    v_add_f32 v15, v15, v103
    v_cvt_pk_bf16_f32 v111, v102, v103
    v_mfma_f32_16x16x32_bf16 v[96:99], v[56:59], a[48:51], v[40:43]
    v_mfma_f32_16x16x32_bf16 v[96:99], v[60:63], a[52:55], v[96:99]
    s_lshl_b32 s28, s28, 19
    v_exp_f32 v88, v88
    v_mfma_f32_16x16x32_bf16 v[96:99], v[64:67], a[56:59], v[96:99]
    v_exp_f32 v89, v89
    v_mfma_f32_16x16x32_bf16 v[96:99], v[68:71], a[60:63], v[96:99]
    s_add_u32 s49, s28, s29
    v_exp_f32 v90, v90
    v_mfma_f32_16x16x32_bf16 v[100:103], v[72:75], a[48:51], v[40:43]
    v_exp_f32 v91, v91
    v_mfma_f32_16x16x32_bf16 v[100:103], v[76:79], a[52:55], v[100:103]
    s_add_u32 m0, s33, 8448
    v_add_f32 v16, v16, v88
    v_add_f32 v17, v17, v89
    v_mfma_f32_16x16x32_bf16 v[100:103], v[80:83], a[56:59], v[100:103]
    v_cvt_pk_bf16_f32 v104, v88, v89
    v_mfma_f32_16x16x32_bf16 v[100:103], v[84:87], a[60:63], v[100:103]
    v_exp_f32 v92, v92
    v_mfma_f32_16x16x32_bf16 v[148:151], v[112:115], v[108:111], v[148:151]
    s_add_u32 s34, s34, 1
    v_exp_f32 v93, v93
    v_mfma_f32_16x16x32_bf16 v[176:179], v[116:119], v[108:111], v[176:179]
    v_add_f32 v16, v16, v90
    v_add_f32 v17, v17, v91
    v_mfma_f32_16x16x32_bf16 v[204:207], v[120:123], v[108:111], v[204:207]
    buffer_load_dwordx4 v7, s[4:7], s49 offen offset:0 nt lds
    v_cvt_pk_bf16_f32 v105, v90, v91
    v_mfma_f32_16x16x32_bf16 v[232:235], v[124:127], v[108:111], v[232:235]
    v_exp_f32 v94, v94
    v_mfma_f32_16x16x32_bf16 a[116:119], v[128:131], v[108:111], a[116:119]
    s_add_u32 m0, m0, s96
    v_exp_f32 v95, v95
    v_mfma_f32_16x16x32_bf16 a[144:147], v[132:135], v[108:111], a[144:147]
    v_add_f32 v16, v16, v92
    v_add_f32 v17, v17, v93
    v_mfma_f32_16x16x32_bf16 a[172:175], v[136:139], v[108:111], a[172:175]
    buffer_load_dwordx4 v7, s[4:7], s49 offen offset:256 nt lds
    v_cvt_pk_bf16_f32 v106, v92, v93
    v_add_f32 v16, v16, v94
    v_mfma_f32_16x16x32_bf16 a[200:203], v[140:143], v[108:111], a[200:203]
    v_add_f32 v17, v17, v95
    v_cvt_pk_bf16_f32 v107, v94, v95
    v_mfma_f32_16x16x32_bf16 v[88:91], v[56:59], a[64:67], v[44:47]
    v_mfma_f32_16x16x32_bf16 v[88:91], v[60:63], a[68:71], v[88:91]
    s_add_u32 m0, m0, s97
    v_exp_f32 v96, v96
    v_mfma_f32_16x16x32_bf16 v[88:91], v[64:67], a[72:75], v[88:91]
    v_exp_f32 v97, v97
    v_mfma_f32_16x16x32_bf16 v[88:91], v[68:71], a[76:79], v[88:91]
    buffer_load_dwordx4 v7, s[4:7], s49 offen offset:512 nt lds
    v_exp_f32 v98, v98
    v_mfma_f32_16x16x32_bf16 v[92:95], v[72:75], a[64:67], v[44:47]
    v_exp_f32 v99, v99
    v_mfma_f32_16x16x32_bf16 v[92:95], v[76:79], a[68:71], v[92:95]
    s_add_u32 m0, m0, s96
    v_add_f32 v18, v18, v96
    v_add_f32 v19, v19, v97
    v_mfma_f32_16x16x32_bf16 v[92:95], v[80:83], a[72:75], v[92:95]
    v_cvt_pk_bf16_f32 v108, v96, v97
    v_mfma_f32_16x16x32_bf16 v[92:95], v[84:87], a[76:79], v[92:95]
    v_exp_f32 v100, v100
    v_mfma_f32_16x16x32_bf16 v[152:155], v[112:115], v[104:107], v[152:155]
    buffer_load_dwordx4 v7, s[4:7], s49 offen offset:768 nt lds
    v_exp_f32 v101, v101
    v_mfma_f32_16x16x32_bf16 v[180:183], v[116:119], v[104:107], v[180:183]
    v_add_f32 v18, v18, v98
    v_add_f32 v19, v19, v99
    v_mfma_f32_16x16x32_bf16 v[208:211], v[120:123], v[104:107], v[208:211]
    s_add_u32 m0, m0, s97
    v_cvt_pk_bf16_f32 v109, v98, v99
    v_mfma_f32_16x16x32_bf16 v[236:239], v[124:127], v[104:107], v[236:239]
    v_exp_f32 v102, v102
    v_mfma_f32_16x16x32_bf16 a[120:123], v[128:131], v[104:107], a[120:123]
    buffer_load_dwordx4 v7, s[4:7], s49 offen offset:1024 nt lds
    v_exp_f32 v103, v103
    v_mfma_f32_16x16x32_bf16 a[148:151], v[132:135], v[104:107], a[148:151]
    v_add_f32 v18, v18, v100
    v_add_f32 v19, v19, v101
    v_mfma_f32_16x16x32_bf16 a[176:179], v[136:139], v[104:107], a[176:179]
    s_add_u32 m0, m0, s96
    v_cvt_pk_bf16_f32 v110, v100, v101
    v_add_f32 v18, v18, v102
    v_mfma_f32_16x16x32_bf16 a[204:207], v[140:143], v[104:107], a[204:207]
    v_add_f32 v19, v19, v103
    v_cvt_pk_bf16_f32 v111, v102, v103
    v_mfma_f32_16x16x32_bf16 v[96:99], v[56:59], a[80:83], v[48:51]
    v_mfma_f32_16x16x32_bf16 v[96:99], v[60:63], a[84:87], v[96:99]
    buffer_load_dwordx4 v7, s[4:7], s49 offen offset:1280 nt lds
    v_exp_f32 v88, v88
    v_mfma_f32_16x16x32_bf16 v[96:99], v[64:67], a[88:91], v[96:99]
    v_exp_f32 v89, v89
    v_mfma_f32_16x16x32_bf16 v[96:99], v[68:71], a[92:95], v[96:99]
    s_add_u32 m0, m0, s97
    v_exp_f32 v90, v90
    v_mfma_f32_16x16x32_bf16 v[100:103], v[72:75], a[80:83], v[48:51]
    v_exp_f32 v91, v91
    v_mfma_f32_16x16x32_bf16 v[100:103], v[76:79], a[84:87], v[100:103]
    buffer_load_dwordx4 v7, s[4:7], s49 offen offset:1536 nt lds
    v_add_f32 v20, v20, v88
    v_add_f32 v21, v21, v89
    v_mfma_f32_16x16x32_bf16 v[100:103], v[80:83], a[88:91], v[100:103]
    v_cvt_pk_bf16_f32 v104, v88, v89
    v_mfma_f32_16x16x32_bf16 v[100:103], v[84:87], a[92:95], v[100:103]
    v_exp_f32 v92, v92
    v_mfma_f32_16x16x32_bf16 v[156:159], v[112:115], v[108:111], v[156:159]
    s_add_u32 m0, m0, s96
    v_exp_f32 v93, v93
    v_mfma_f32_16x16x32_bf16 v[184:187], v[116:119], v[108:111], v[184:187]
    v_add_f32 v20, v20, v90
    v_add_f32 v21, v21, v91
    v_mfma_f32_16x16x32_bf16 v[212:215], v[120:123], v[108:111], v[212:215]
    buffer_load_dwordx4 v7, s[4:7], s49 offen offset:1792 nt lds
    v_cvt_pk_bf16_f32 v105, v90, v91
    v_mfma_f32_16x16x32_bf16 v[240:243], v[124:127], v[108:111], v[240:243]
    v_exp_f32 v94, v94
    v_mfma_f32_16x16x32_bf16 a[124:127], v[128:131], v[108:111], a[124:127]
    v_exp_f32 v95, v95
    v_mfma_f32_16x16x32_bf16 a[152:155], v[132:135], v[108:111], a[152:155]
    v_add_f32 v20, v20, v92
    v_add_f32 v21, v21, v93
    v_mfma_f32_16x16x32_bf16 a[180:183], v[136:139], v[108:111], a[180:183]
    v_cvt_pk_bf16_f32 v106, v92, v93
    v_add_f32 v20, v20, v94
    v_mfma_f32_16x16x32_bf16 a[208:211], v[140:143], v[108:111], a[208:211]
    v_add_f32 v21, v21, v95
    v_cvt_pk_bf16_f32 v107, v94, v95
    s_cmp_eq_u32 s68, 0
    s_cbranch_scc0 L_bw1_3947
    s_waitcnt vmcnt(16) lgkmcnt(0)
L_bw2_3947:
    s_barrier
    v_mfma_f32_16x16x32_bf16 v[88:91], v[56:59], a[96:99], v[52:55]
    ds_read_b128 v[56:59], v8 offset:25344
    v_mfma_f32_16x16x32_bf16 v[88:91], v[60:63], a[100:103], v[88:91]
    ds_read_b128 v[60:63], v8 offset:25408
    v_exp_f32 v96, v96
    v_mfma_f32_16x16x32_bf16 v[88:91], v[64:67], a[104:107], v[88:91]
    ds_read_b128 v[64:67], v8 offset:25472
    v_exp_f32 v97, v97
    v_mfma_f32_16x16x32_bf16 v[88:91], v[68:71], a[108:111], v[88:91]
    ds_read_b128 v[68:71], v8 offset:25536
    v_exp_f32 v98, v98
    v_mfma_f32_16x16x32_bf16 v[92:95], v[72:75], a[96:99], v[52:55]
    ds_read_b128 v[72:75], v8 offset:25856
    v_exp_f32 v99, v99
    v_mfma_f32_16x16x32_bf16 v[92:95], v[76:79], a[100:103], v[92:95]
    ds_read_b128 v[76:79], v8 offset:25920
    v_add_f32 v22, v22, v96
    v_add_f32 v23, v23, v97
    v_mfma_f32_16x16x32_bf16 v[92:95], v[80:83], a[104:107], v[92:95]
    ds_read_b128 v[80:83], v8 offset:25984
    v_cvt_pk_bf16_f32 v108, v96, v97
    v_mfma_f32_16x16x32_bf16 v[92:95], v[84:87], a[108:111], v[92:95]
    ds_read_b128 v[84:87], v8 offset:26048
    v_exp_f32 v100, v100
    v_mfma_f32_16x16x32_bf16 v[160:163], v[112:115], v[104:107], v[160:163]
    v_exp_f32 v101, v101
    v_mfma_f32_16x16x32_bf16 v[188:191], v[116:119], v[104:107], v[188:191]
    v_add_f32 v22, v22, v98
    v_add_f32 v23, v23, v99
    v_mfma_f32_16x16x32_bf16 v[216:219], v[120:123], v[104:107], v[216:219]
    v_cvt_pk_bf16_f32 v109, v98, v99
    v_mfma_f32_16x16x32_bf16 v[244:247], v[124:127], v[104:107], v[244:247]
    v_exp_f32 v102, v102
    v_mfma_f32_16x16x32_bf16 a[128:131], v[128:131], v[104:107], a[128:131]
    v_exp_f32 v103, v103
    v_mfma_f32_16x16x32_bf16 a[156:159], v[132:135], v[104:107], a[156:159]
    v_add_f32 v22, v22, v100
    v_add_f32 v23, v23, v101
    v_mfma_f32_16x16x32_bf16 a[184:187], v[136:139], v[104:107], a[184:187]
    v_cvt_pk_bf16_f32 v110, v100, v101
    v_add_f32 v22, v22, v102
    v_mfma_f32_16x16x32_bf16 a[212:215], v[140:143], v[104:107], a[212:215]
    v_add_f32 v23, v23, v103
    v_cvt_pk_bf16_f32 v111, v102, v103
    s_waitcnt lgkmcnt(0)
    v_mfma_f32_16x16x32_bf16 v[96:99], v[56:59], a[0:3], v[28:31]
    v_mfma_f32_16x16x32_bf16 v[96:99], v[60:63], a[4:7], v[96:99]
    v_exp_f32 v88, v88
    v_mfma_f32_16x16x32_bf16 v[96:99], v[64:67], a[8:11], v[96:99]
    v_exp_f32 v89, v89
    v_mfma_f32_16x16x32_bf16 v[96:99], v[68:71], a[12:15], v[96:99]
    v_exp_f32 v90, v90
    v_mfma_f32_16x16x32_bf16 v[100:103], v[72:75], a[0:3], v[28:31]
    v_exp_f32 v91, v91
    v_mfma_f32_16x16x32_bf16 v[100:103], v[76:79], a[4:7], v[100:103]
    v_add_f32 v24, v24, v88
    v_add_f32 v25, v25, v89
    v_mfma_f32_16x16x32_bf16 v[100:103], v[80:83], a[8:11], v[100:103]
    v_cvt_pk_bf16_f32 v104, v88, v89
    v_mfma_f32_16x16x32_bf16 v[100:103], v[84:87], a[12:15], v[100:103]
    v_exp_f32 v92, v92
    v_mfma_f32_16x16x32_bf16 v[164:167], v[112:115], v[108:111], v[164:167]
    v_exp_f32 v93, v93
    v_mfma_f32_16x16x32_bf16 v[192:195], v[116:119], v[108:111], v[192:195]
    v_add_f32 v24, v24, v90
    v_add_f32 v25, v25, v91
    v_mfma_f32_16x16x32_bf16 v[220:223], v[120:123], v[108:111], v[220:223]
    v_cvt_pk_bf16_f32 v105, v90, v91
    v_mfma_f32_16x16x32_bf16 v[248:251], v[124:127], v[108:111], v[248:251]
    v_exp_f32 v94, v94
    v_mfma_f32_16x16x32_bf16 a[132:135], v[128:131], v[108:111], a[132:135]
    v_exp_f32 v95, v95
    v_mfma_f32_16x16x32_bf16 a[160:163], v[132:135], v[108:111], a[160:163]
    v_add_f32 v24, v24, v92
    v_add_f32 v25, v25, v93
    v_mfma_f32_16x16x32_bf16 a[188:191], v[136:139], v[108:111], a[188:191]
    v_cvt_pk_bf16_f32 v106, v92, v93
    v_add_f32 v24, v24, v94
    v_mfma_f32_16x16x32_bf16 a[216:219], v[140:143], v[108:111], a[216:219]
    v_add_f32 v25, v25, v95
    v_cvt_pk_bf16_f32 v107, v94, v95
    v_mfma_f32_16x16x32_bf16 v[88:91], v[56:59], a[16:19], v[32:35]
    v_mfma_f32_16x16x32_bf16 v[88:91], v[60:63], a[20:23], v[88:91]
    v_exp_f32 v96, v96
    v_mfma_f32_16x16x32_bf16 v[88:91], v[64:67], a[24:27], v[88:91]
    v_exp_f32 v97, v97
    v_mfma_f32_16x16x32_bf16 v[88:91], v[68:71], a[28:31], v[88:91]
    v_exp_f32 v98, v98
    v_mfma_f32_16x16x32_bf16 v[92:95], v[72:75], a[16:19], v[32:35]
    v_exp_f32 v99, v99
    v_mfma_f32_16x16x32_bf16 v[92:95], v[76:79], a[20:23], v[92:95]
    v_add_f32 v12, v12, v96
    v_add_f32 v13, v13, v97
    v_mfma_f32_16x16x32_bf16 v[92:95], v[80:83], a[24:27], v[92:95]
    v_cvt_pk_bf16_f32 v108, v96, v97
    v_mfma_f32_16x16x32_bf16 v[92:95], v[84:87], a[28:31], v[92:95]
    v_exp_f32 v100, v100
    v_mfma_f32_16x16x32_bf16 v[168:171], v[112:115], v[104:107], v[168:171]
    ds_read_b64_tr_b16 v[112:113], v9 offset:25344
    ds_read_b64_tr_b16 v[114:115], v9 offset:25856
    v_exp_f32 v101, v101
    v_mfma_f32_16x16x32_bf16 v[196:199], v[116:119], v[104:107], v[196:199]
    ds_read_b64_tr_b16 v[116:117], v9 offset:25376
    ds_read_b64_tr_b16 v[118:119], v9 offset:25888
    v_add_f32 v12, v12, v98
    v_add_f32 v13, v13, v99
    v_mfma_f32_16x16x32_bf16 v[224:227], v[120:123], v[104:107], v[224:227]
    ds_read_b64_tr_b16 v[120:121], v9 offset:25408
    ds_read_b64_tr_b16 v[122:123], v9 offset:25920
    v_cvt_pk_bf16_f32 v109, v98, v99
    v_mfma_f32_16x16x32_bf16 v[252:255], v[124:127], v[104:107], v[252:255]
    ds_read_b64_tr_b16 v[124:125], v9 offset:25440
    ds_read_b64_tr_b16 v[126:127], v9 offset:25952
    v_exp_f32 v102, v102
    v_mfma_f32_16x16x32_bf16 a[136:139], v[128:131], v[104:107], a[136:139]
    ds_read_b64_tr_b16 v[128:129], v9 offset:25472
    ds_read_b64_tr_b16 v[130:131], v9 offset:25984
    v_exp_f32 v103, v103
    v_mfma_f32_16x16x32_bf16 a[164:167], v[132:135], v[104:107], a[164:167]
    ds_read_b64_tr_b16 v[132:133], v9 offset:25504
    ds_read_b64_tr_b16 v[134:135], v9 offset:26016
    v_add_f32 v12, v12, v100
    v_add_f32 v13, v13, v101
    v_mfma_f32_16x16x32_bf16 a[192:195], v[136:139], v[104:107], a[192:195]
    ds_read_b64_tr_b16 v[136:137], v9 offset:25536
    ds_read_b64_tr_b16 v[138:139], v9 offset:26048
    v_cvt_pk_bf16_f32 v110, v100, v101
    v_add_f32 v12, v12, v102
    v_mfma_f32_16x16x32_bf16 a[220:223], v[140:143], v[104:107], a[220:223]
    ds_read_b64_tr_b16 v[140:141], v9 offset:25568
    ds_read_b64_tr_b16 v[142:143], v9 offset:26080
    v_add_f32 v13, v13, v103
    v_cvt_pk_bf16_f32 v111, v102, v103
    v_mfma_f32_16x16x32_bf16 v[96:99], v[56:59], a[32:35], v[36:39]
    v_mfma_f32_16x16x32_bf16 v[96:99], v[60:63], a[36:39], v[96:99]
    s_add_u32 s29, s34, s100
    v_exp_f32 v88, v88
    v_mfma_f32_16x16x32_bf16 v[96:99], v[64:67], a[40:43], v[96:99]
    v_exp_f32 v89, v89
    v_mfma_f32_16x16x32_bf16 v[96:99], v[68:71], a[44:47], v[96:99]
    s_bfe_u32 s28, s29, 0x20003
    v_exp_f32 v90, v90
    v_mfma_f32_16x16x32_bf16 v[100:103], v[72:75], a[32:35], v[36:39]
    v_exp_f32 v91, v91
    v_mfma_f32_16x16x32_bf16 v[100:103], v[76:79], a[36:39], v[100:103]
    s_lshl_b32 s28, s28, 16
    v_add_f32 v14, v14, v88
    v_add_f32 v15, v15, v89
    v_mfma_f32_16x16x32_bf16 v[100:103], v[80:83], a[40:43], v[100:103]
    v_cvt_pk_bf16_f32 v104, v88, v89
    v_mfma_f32_16x16x32_bf16 v[100:103], v[84:87], a[44:47], v[100:103]
    v_exp_f32 v92, v92
    s_waitcnt lgkmcnt(0)
    v_mfma_f32_16x16x32_bf16 v[144:147], v[112:115], v[108:111], v[144:147]
    s_and_b32 s29, s29, 7
    v_exp_f32 v93, v93
    v_mfma_f32_16x16x32_bf16 v[172:175], v[116:119], v[108:111], v[172:175]
    v_add_f32 v14, v14, v90
    v_add_f32 v15, v15, v91
    v_mfma_f32_16x16x32_bf16 v[200:203], v[120:123], v[108:111], v[200:203]
    s_lshl_b32 s29, s29, 11
    v_cvt_pk_bf16_f32 v105, v90, v91
    v_mfma_f32_16x16x32_bf16 v[228:231], v[124:127], v[108:111], v[228:231]
    v_exp_f32 v94, v94
    v_mfma_f32_16x16x32_bf16 a[112:115], v[128:131], v[108:111], a[112:115]
    s_add_u32 s29, s28, s29
    v_exp_f32 v95, v95
    v_mfma_f32_16x16x32_bf16 a[140:143], v[132:135], v[108:111], a[140:143]
    v_add_f32 v14, v14, v92
    v_add_f32 v15, v15, v93
    v_mfma_f32_16x16x32_bf16 a[168:171], v[136:139], v[108:111], a[168:171]
    s_lshr_b32 s28, s34, 5
    v_cvt_pk_bf16_f32 v106, v92, v93
    v_add_f32 v14, v14, v94
    v_mfma_f32_16x16x32_bf16 a[196:199], v[140:143], v[108:111], a[196:199]
    v_add_f32 v15, v15, v95
    v_cvt_pk_bf16_f32 v107, v94, v95
    v_mfma_f32_16x16x32_bf16 v[88:91], v[56:59], a[48:51], v[40:43]
    v_mfma_f32_16x16x32_bf16 v[88:91], v[60:63], a[52:55], v[88:91]
    s_lshl_b32 s28, s28, 19
    v_exp_f32 v96, v96
    v_mfma_f32_16x16x32_bf16 v[88:91], v[64:67], a[56:59], v[88:91]
    v_exp_f32 v97, v97
    v_mfma_f32_16x16x32_bf16 v[88:91], v[68:71], a[60:63], v[88:91]
    s_add_u32 s49, s28, s29
    v_exp_f32 v98, v98
    v_mfma_f32_16x16x32_bf16 v[92:95], v[72:75], a[48:51], v[40:43]
    v_exp_f32 v99, v99
    v_mfma_f32_16x16x32_bf16 v[92:95], v[76:79], a[52:55], v[92:95]
    s_add_u32 m0, s33, 16896
    v_add_f32 v16, v16, v96
    v_add_f32 v17, v17, v97
    v_mfma_f32_16x16x32_bf16 v[92:95], v[80:83], a[56:59], v[92:95]
    v_cvt_pk_bf16_f32 v108, v96, v97
    v_mfma_f32_16x16x32_bf16 v[92:95], v[84:87], a[60:63], v[92:95]
    v_exp_f32 v100, v100
    v_mfma_f32_16x16x32_bf16 v[148:151], v[112:115], v[104:107], v[148:151]
    s_add_u32 s34, s34, 1
    v_exp_f32 v101, v101
    v_mfma_f32_16x16x32_bf16 v[176:179], v[116:119], v[104:107], v[176:179]
    v_add_f32 v16, v16, v98
    v_add_f32 v17, v17, v99
    v_mfma_f32_16x16x32_bf16 v[204:207], v[120:123], v[104:107], v[204:207]
    buffer_load_dwordx4 v7, s[4:7], s49 offen offset:0 nt lds
    v_cvt_pk_bf16_f32 v109, v98, v99
    v_mfma_f32_16x16x32_bf16 v[232:235], v[124:127], v[104:107], v[232:235]
    v_exp_f32 v102, v102
    v_mfma_f32_16x16x32_bf16 a[116:119], v[128:131], v[104:107], a[116:119]
    s_add_u32 m0, m0, s96
    v_exp_f32 v103, v103
    v_mfma_f32_16x16x32_bf16 a[144:147], v[132:135], v[104:107], a[144:147]
    v_add_f32 v16, v16, v100
    v_add_f32 v17, v17, v101
    v_mfma_f32_16x16x32_bf16 a[172:175], v[136:139], v[104:107], a[172:175]
    buffer_load_dwordx4 v7, s[4:7], s49 offen offset:256 nt lds
    v_cvt_pk_bf16_f32 v110, v100, v101
    v_add_f32 v16, v16, v102
    v_mfma_f32_16x16x32_bf16 a[200:203], v[140:143], v[104:107], a[200:203]
    v_add_f32 v17, v17, v103
    v_cvt_pk_bf16_f32 v111, v102, v103
    v_mfma_f32_16x16x32_bf16 v[96:99], v[56:59], a[64:67], v[44:47]
    v_mfma_f32_16x16x32_bf16 v[96:99], v[60:63], a[68:71], v[96:99]
    s_add_u32 m0, m0, s97
    v_exp_f32 v88, v88
    v_mfma_f32_16x16x32_bf16 v[96:99], v[64:67], a[72:75], v[96:99]
    v_exp_f32 v89, v89
    v_mfma_f32_16x16x32_bf16 v[96:99], v[68:71], a[76:79], v[96:99]
    buffer_load_dwordx4 v7, s[4:7], s49 offen offset:512 nt lds
    v_exp_f32 v90, v90
    v_mfma_f32_16x16x32_bf16 v[100:103], v[72:75], a[64:67], v[44:47]
    v_exp_f32 v91, v91
    v_mfma_f32_16x16x32_bf16 v[100:103], v[76:79], a[68:71], v[100:103]
    s_add_u32 m0, m0, s96
    v_add_f32 v18, v18, v88
    v_add_f32 v19, v19, v89
    v_mfma_f32_16x16x32_bf16 v[100:103], v[80:83], a[72:75], v[100:103]
    v_cvt_pk_bf16_f32 v104, v88, v89
    v_mfma_f32_16x16x32_bf16 v[100:103], v[84:87], a[76:79], v[100:103]
    v_exp_f32 v92, v92
    v_mfma_f32_16x16x32_bf16 v[152:155], v[112:115], v[108:111], v[152:155]
    buffer_load_dwordx4 v7, s[4:7], s49 offen offset:768 nt lds
    v_exp_f32 v93, v93
    v_mfma_f32_16x16x32_bf16 v[180:183], v[116:119], v[108:111], v[180:183]
    v_add_f32 v18, v18, v90
    v_add_f32 v19, v19, v91
    v_mfma_f32_16x16x32_bf16 v[208:211], v[120:123], v[108:111], v[208:211]
    s_add_u32 m0, m0, s97
    v_cvt_pk_bf16_f32 v105, v90, v91
    v_mfma_f32_16x16x32_bf16 v[236:239], v[124:127], v[108:111], v[236:239]
    v_exp_f32 v94, v94
    v_mfma_f32_16x16x32_bf16 a[120:123], v[128:131], v[108:111], a[120:123]
    buffer_load_dwordx4 v7, s[4:7], s49 offen offset:1024 nt lds
    v_exp_f32 v95, v95
    v_mfma_f32_16x16x32_bf16 a[148:151], v[132:135], v[108:111], a[148:151]
    v_add_f32 v18, v18, v92
    v_add_f32 v19, v19, v93
    v_mfma_f32_16x16x32_bf16 a[176:179], v[136:139], v[108:111], a[176:179]
    s_add_u32 m0, m0, s96
    v_cvt_pk_bf16_f32 v106, v92, v93
    v_add_f32 v18, v18, v94
    v_mfma_f32_16x16x32_bf16 a[204:207], v[140:143], v[108:111], a[204:207]
    v_add_f32 v19, v19, v95
    v_cvt_pk_bf16_f32 v107, v94, v95
    v_mfma_f32_16x16x32_bf16 v[88:91], v[56:59], a[80:83], v[48:51]
    v_mfma_f32_16x16x32_bf16 v[88:91], v[60:63], a[84:87], v[88:91]
    buffer_load_dwordx4 v7, s[4:7], s49 offen offset:1280 nt lds
    v_exp_f32 v96, v96
    v_mfma_f32_16x16x32_bf16 v[88:91], v[64:67], a[88:91], v[88:91]
    v_exp_f32 v97, v97
    v_mfma_f32_16x16x32_bf16 v[88:91], v[68:71], a[92:95], v[88:91]
    s_add_u32 m0, m0, s97
    v_exp_f32 v98, v98
    v_mfma_f32_16x16x32_bf16 v[92:95], v[72:75], a[80:83], v[48:51]
    v_exp_f32 v99, v99
    v_mfma_f32_16x16x32_bf16 v[92:95], v[76:79], a[84:87], v[92:95]
    buffer_load_dwordx4 v7, s[4:7], s49 offen offset:1536 nt lds
    v_add_f32 v20, v20, v96
    v_add_f32 v21, v21, v97
    v_mfma_f32_16x16x32_bf16 v[92:95], v[80:83], a[88:91], v[92:95]
    v_cvt_pk_bf16_f32 v108, v96, v97
    v_mfma_f32_16x16x32_bf16 v[92:95], v[84:87], a[92:95], v[92:95]
    v_exp_f32 v100, v100
    v_mfma_f32_16x16x32_bf16 v[156:159], v[112:115], v[104:107], v[156:159]
    s_add_u32 m0, m0, s96
    v_exp_f32 v101, v101
    v_mfma_f32_16x16x32_bf16 v[184:187], v[116:119], v[104:107], v[184:187]
    v_add_f32 v20, v20, v98
    v_add_f32 v21, v21, v99
    v_mfma_f32_16x16x32_bf16 v[212:215], v[120:123], v[104:107], v[212:215]
    buffer_load_dwordx4 v7, s[4:7], s49 offen offset:1792 nt lds
    v_cvt_pk_bf16_f32 v109, v98, v99
    v_mfma_f32_16x16x32_bf16 v[240:243], v[124:127], v[104:107], v[240:243]
    v_exp_f32 v102, v102
    v_mfma_f32_16x16x32_bf16 a[124:127], v[128:131], v[104:107], a[124:127]
    v_exp_f32 v103, v103
    v_mfma_f32_16x16x32_bf16 a[152:155], v[132:135], v[104:107], a[152:155]
    v_add_f32 v20, v20, v100
    v_add_f32 v21, v21, v101
    v_mfma_f32_16x16x32_bf16 a[180:183], v[136:139], v[104:107], a[180:183]
    v_cvt_pk_bf16_f32 v110, v100, v101
    v_add_f32 v20, v20, v102
    v_mfma_f32_16x16x32_bf16 a[208:211], v[140:143], v[104:107], a[208:211]
    v_add_f32 v21, v21, v103
    v_cvt_pk_bf16_f32 v111, v102, v103
    s_waitcnt vmcnt(16) lgkmcnt(0)
    s_barrier
    v_mfma_f32_16x16x32_bf16 v[96:99], v[56:59], a[96:99], v[52:55]
    ds_read_b128 v[56:59], v8 offset:0
    v_mfma_f32_16x16x32_bf16 v[96:99], v[60:63], a[100:103], v[96:99]
    ds_read_b128 v[60:63], v8 offset:64
    v_exp_f32 v88, v88
    v_mfma_f32_16x16x32_bf16 v[96:99], v[64:67], a[104:107], v[96:99]
    ds_read_b128 v[64:67], v8 offset:128
    v_exp_f32 v89, v89
    v_mfma_f32_16x16x32_bf16 v[96:99], v[68:71], a[108:111], v[96:99]
    ds_read_b128 v[68:71], v8 offset:192
    v_exp_f32 v90, v90
    v_mfma_f32_16x16x32_bf16 v[100:103], v[72:75], a[96:99], v[52:55]
    ds_read_b128 v[72:75], v8 offset:512
    v_exp_f32 v91, v91
    v_mfma_f32_16x16x32_bf16 v[100:103], v[76:79], a[100:103], v[100:103]
    ds_read_b128 v[76:79], v8 offset:576
    v_add_f32 v22, v22, v88
    v_add_f32 v23, v23, v89
    v_mfma_f32_16x16x32_bf16 v[100:103], v[80:83], a[104:107], v[100:103]
    ds_read_b128 v[80:83], v8 offset:640
    v_cvt_pk_bf16_f32 v104, v88, v89
    v_mfma_f32_16x16x32_bf16 v[100:103], v[84:87], a[108:111], v[100:103]
    ds_read_b128 v[84:87], v8 offset:704
    v_exp_f32 v92, v92
    v_mfma_f32_16x16x32_bf16 v[160:163], v[112:115], v[108:111], v[160:163]
    v_exp_f32 v93, v93
    v_mfma_f32_16x16x32_bf16 v[188:191], v[116:119], v[108:111], v[188:191]
    v_add_f32 v22, v22, v90
    v_add_f32 v23, v23, v91
    v_mfma_f32_16x16x32_bf16 v[216:219], v[120:123], v[108:111], v[216:219]
    v_cvt_pk_bf16_f32 v105, v90, v91
    v_mfma_f32_16x16x32_bf16 v[244:247], v[124:127], v[108:111], v[244:247]
    v_exp_f32 v94, v94
    v_mfma_f32_16x16x32_bf16 a[128:131], v[128:131], v[108:111], a[128:131]
    v_exp_f32 v95, v95
    v_mfma_f32_16x16x32_bf16 a[156:159], v[132:135], v[108:111], a[156:159]
    v_add_f32 v22, v22, v92
    v_add_f32 v23, v23, v93
    v_mfma_f32_16x16x32_bf16 a[184:187], v[136:139], v[108:111], a[184:187]
    v_cvt_pk_bf16_f32 v106, v92, v93
    v_add_f32 v22, v22, v94
    v_mfma_f32_16x16x32_bf16 a[212:215], v[140:143], v[108:111], a[212:215]
    v_add_f32 v23, v23, v95
    v_cvt_pk_bf16_f32 v107, v94, v95
    s_waitcnt lgkmcnt(0)
    v_mfma_f32_16x16x32_bf16 v[88:91], v[56:59], a[0:3], v[28:31]
    v_mfma_f32_16x16x32_bf16 v[88:91], v[60:63], a[4:7], v[88:91]
    v_exp_f32 v96, v96
    v_mfma_f32_16x16x32_bf16 v[88:91], v[64:67], a[8:11], v[88:91]
    v_exp_f32 v97, v97
    v_mfma_f32_16x16x32_bf16 v[88:91], v[68:71], a[12:15], v[88:91]
    v_exp_f32 v98, v98
    v_mfma_f32_16x16x32_bf16 v[92:95], v[72:75], a[0:3], v[28:31]
    v_exp_f32 v99, v99
    v_mfma_f32_16x16x32_bf16 v[92:95], v[76:79], a[4:7], v[92:95]
    v_add_f32 v24, v24, v96
    v_add_f32 v25, v25, v97
    v_mfma_f32_16x16x32_bf16 v[92:95], v[80:83], a[8:11], v[92:95]
    v_cvt_pk_bf16_f32 v108, v96, v97
    v_mfma_f32_16x16x32_bf16 v[92:95], v[84:87], a[12:15], v[92:95]
    v_exp_f32 v100, v100
    v_mfma_f32_16x16x32_bf16 v[164:167], v[112:115], v[104:107], v[164:167]
    v_exp_f32 v101, v101
    v_mfma_f32_16x16x32_bf16 v[192:195], v[116:119], v[104:107], v[192:195]
    v_add_f32 v24, v24, v98
    v_add_f32 v25, v25, v99
    v_mfma_f32_16x16x32_bf16 v[220:223], v[120:123], v[104:107], v[220:223]
    v_cvt_pk_bf16_f32 v109, v98, v99
    v_mfma_f32_16x16x32_bf16 v[248:251], v[124:127], v[104:107], v[248:251]
    v_exp_f32 v102, v102
    v_mfma_f32_16x16x32_bf16 a[132:135], v[128:131], v[104:107], a[132:135]
    v_exp_f32 v103, v103
    v_mfma_f32_16x16x32_bf16 a[160:163], v[132:135], v[104:107], a[160:163]
    v_add_f32 v24, v24, v100
    v_add_f32 v25, v25, v101
    v_mfma_f32_16x16x32_bf16 a[188:191], v[136:139], v[104:107], a[188:191]
    v_cvt_pk_bf16_f32 v110, v100, v101
    v_add_f32 v24, v24, v102
    v_mfma_f32_16x16x32_bf16 a[216:219], v[140:143], v[104:107], a[216:219]
    v_add_f32 v25, v25, v103
    v_cvt_pk_bf16_f32 v111, v102, v103
    v_mfma_f32_16x16x32_bf16 v[96:99], v[56:59], a[16:19], v[32:35]
    v_mfma_f32_16x16x32_bf16 v[96:99], v[60:63], a[20:23], v[96:99]
    v_exp_f32 v88, v88
    v_mfma_f32_16x16x32_bf16 v[96:99], v[64:67], a[24:27], v[96:99]
    v_exp_f32 v89, v89
    v_mfma_f32_16x16x32_bf16 v[96:99], v[68:71], a[28:31], v[96:99]
    v_exp_f32 v90, v90
    v_mfma_f32_16x16x32_bf16 v[100:103], v[72:75], a[16:19], v[32:35]
    v_exp_f32 v91, v91
    v_mfma_f32_16x16x32_bf16 v[100:103], v[76:79], a[20:23], v[100:103]
    v_add_f32 v12, v12, v88
    v_add_f32 v13, v13, v89
    v_mfma_f32_16x16x32_bf16 v[100:103], v[80:83], a[24:27], v[100:103]
    v_cvt_pk_bf16_f32 v104, v88, v89
    v_mfma_f32_16x16x32_bf16 v[100:103], v[84:87], a[28:31], v[100:103]
    v_exp_f32 v92, v92
    v_mfma_f32_16x16x32_bf16 v[168:171], v[112:115], v[108:111], v[168:171]
    ds_read_b64_tr_b16 v[112:113], v9 offset:0
    ds_read_b64_tr_b16 v[114:115], v9 offset:512
    v_exp_f32 v93, v93
    v_mfma_f32_16x16x32_bf16 v[196:199], v[116:119], v[108:111], v[196:199]
    ds_read_b64_tr_b16 v[116:117], v9 offset:32
    ds_read_b64_tr_b16 v[118:119], v9 offset:544
    v_add_f32 v12, v12, v90
    v_add_f32 v13, v13, v91
    v_mfma_f32_16x16x32_bf16 v[224:227], v[120:123], v[108:111], v[224:227]
    ds_read_b64_tr_b16 v[120:121], v9 offset:64
    ds_read_b64_tr_b16 v[122:123], v9 offset:576
    v_cvt_pk_bf16_f32 v105, v90, v91
    v_mfma_f32_16x16x32_bf16 v[252:255], v[124:127], v[108:111], v[252:255]
    ds_read_b64_tr_b16 v[124:125], v9 offset:96
    ds_read_b64_tr_b16 v[126:127], v9 offset:608
    v_exp_f32 v94, v94
    v_mfma_f32_16x16x32_bf16 a[136:139], v[128:131], v[108:111], a[136:139]
    ds_read_b64_tr_b16 v[128:129], v9 offset:128
    ds_read_b64_tr_b16 v[130:131], v9 offset:640
    v_exp_f32 v95, v95
    v_mfma_f32_16x16x32_bf16 a[164:167], v[132:135], v[108:111], a[164:167]
    ds_read_b64_tr_b16 v[132:133], v9 offset:160
    ds_read_b64_tr_b16 v[134:135], v9 offset:672
    v_add_f32 v12, v12, v92
    v_add_f32 v13, v13, v93
    v_mfma_f32_16x16x32_bf16 a[192:195], v[136:139], v[108:111], a[192:195]
    ds_read_b64_tr_b16 v[136:137], v9 offset:192
    ds_read_b64_tr_b16 v[138:139], v9 offset:704
    v_cvt_pk_bf16_f32 v106, v92, v93
    v_add_f32 v12, v12, v94
    v_mfma_f32_16x16x32_bf16 a[220:223], v[140:143], v[108:111], a[220:223]
    ds_read_b64_tr_b16 v[140:141], v9 offset:224
    ds_read_b64_tr_b16 v[142:143], v9 offset:736
    v_add_f32 v13, v13, v95
    v_cvt_pk_bf16_f32 v107, v94, v95
    v_mfma_f32_16x16x32_bf16 v[88:91], v[56:59], a[32:35], v[36:39]
    v_mfma_f32_16x16x32_bf16 v[88:91], v[60:63], a[36:39], v[88:91]
    s_add_u32 s29, s34, s100
    v_exp_f32 v96, v96
    v_mfma_f32_16x16x32_bf16 v[88:91], v[64:67], a[40:43], v[88:91]
    v_exp_f32 v97, v97
    v_mfma_f32_16x16x32_bf16 v[88:91], v[68:71], a[44:47], v[88:91]
    s_bfe_u32 s28, s29, 0x20003
    v_exp_f32 v98, v98
    v_mfma_f32_16x16x32_bf16 v[92:95], v[72:75], a[32:35], v[36:39]
    v_exp_f32 v99, v99
    v_mfma_f32_16x16x32_bf16 v[92:95], v[76:79], a[36:39], v[92:95]
    s_lshl_b32 s28, s28, 16
    v_add_f32 v14, v14, v96
    v_add_f32 v15, v15, v97
    v_mfma_f32_16x16x32_bf16 v[92:95], v[80:83], a[40:43], v[92:95]
    v_cvt_pk_bf16_f32 v108, v96, v97
    v_mfma_f32_16x16x32_bf16 v[92:95], v[84:87], a[44:47], v[92:95]
    v_exp_f32 v100, v100
    s_waitcnt lgkmcnt(0)
    v_mfma_f32_16x16x32_bf16 v[144:147], v[112:115], v[104:107], v[144:147]
    s_and_b32 s29, s29, 7
    v_exp_f32 v101, v101
    v_mfma_f32_16x16x32_bf16 v[172:175], v[116:119], v[104:107], v[172:175]
    v_add_f32 v14, v14, v98
    v_add_f32 v15, v15, v99
    v_mfma_f32_16x16x32_bf16 v[200:203], v[120:123], v[104:107], v[200:203]
    s_lshl_b32 s29, s29, 11
    v_cvt_pk_bf16_f32 v109, v98, v99
    v_mfma_f32_16x16x32_bf16 v[228:231], v[124:127], v[104:107], v[228:231]
    v_exp_f32 v102, v102
    v_mfma_f32_16x16x32_bf16 a[112:115], v[128:131], v[104:107], a[112:115]
    s_add_u32 s29, s28, s29
    v_exp_f32 v103, v103
    v_mfma_f32_16x16x32_bf16 a[140:143], v[132:135], v[104:107], a[140:143]
    v_add_f32 v14, v14, v100
    v_add_f32 v15, v15, v101
    v_mfma_f32_16x16x32_bf16 a[168:171], v[136:139], v[104:107], a[168:171]
    s_lshr_b32 s28, s34, 5
    v_cvt_pk_bf16_f32 v110, v100, v101
    v_add_f32 v14, v14, v102
    v_mfma_f32_16x16x32_bf16 a[196:199], v[140:143], v[104:107], a[196:199]
    v_add_f32 v15, v15, v103
    v_cvt_pk_bf16_f32 v111, v102, v103
    v_mfma_f32_16x16x32_bf16 v[96:99], v[56:59], a[48:51], v[40:43]
    v_mfma_f32_16x16x32_bf16 v[96:99], v[60:63], a[52:55], v[96:99]
    s_lshl_b32 s28, s28, 19
    v_exp_f32 v88, v88
    v_mfma_f32_16x16x32_bf16 v[96:99], v[64:67], a[56:59], v[96:99]
    v_exp_f32 v89, v89
    v_mfma_f32_16x16x32_bf16 v[96:99], v[68:71], a[60:63], v[96:99]
    s_add_u32 s49, s28, s29
    v_exp_f32 v90, v90
    v_mfma_f32_16x16x32_bf16 v[100:103], v[72:75], a[48:51], v[40:43]
    v_exp_f32 v91, v91
    v_mfma_f32_16x16x32_bf16 v[100:103], v[76:79], a[52:55], v[100:103]
    s_add_u32 m0, s33, 25344
    v_add_f32 v16, v16, v88
    v_add_f32 v17, v17, v89
    v_mfma_f32_16x16x32_bf16 v[100:103], v[80:83], a[56:59], v[100:103]
    v_cvt_pk_bf16_f32 v104, v88, v89
    v_mfma_f32_16x16x32_bf16 v[100:103], v[84:87], a[60:63], v[100:103]
    v_exp_f32 v92, v92
    v_mfma_f32_16x16x32_bf16 v[148:151], v[112:115], v[108:111], v[148:151]
    s_add_u32 s34, s34, 1
    v_exp_f32 v93, v93
    v_mfma_f32_16x16x32_bf16 v[176:179], v[116:119], v[108:111], v[176:179]
    v_add_f32 v16, v16, v90
    v_add_f32 v17, v17, v91
    v_mfma_f32_16x16x32_bf16 v[204:207], v[120:123], v[108:111], v[204:207]
    buffer_load_dwordx4 v7, s[4:7], s49 offen offset:0 nt lds
    v_cvt_pk_bf16_f32 v105, v90, v91
    v_mfma_f32_16x16x32_bf16 v[232:235], v[124:127], v[108:111], v[232:235]
    v_exp_f32 v94, v94
    v_mfma_f32_16x16x32_bf16 a[116:119], v[128:131], v[108:111], a[116:119]
    s_add_u32 m0, m0, s96
    v_exp_f32 v95, v95
    v_mfma_f32_16x16x32_bf16 a[144:147], v[132:135], v[108:111], a[144:147]
    v_add_f32 v16, v16, v92
    v_add_f32 v17, v17, v93
    v_mfma_f32_16x16x32_bf16 a[172:175], v[136:139], v[108:111], a[172:175]
    buffer_load_dwordx4 v7, s[4:7], s49 offen offset:256 nt lds
    v_cvt_pk_bf16_f32 v106, v92, v93
    v_add_f32 v16, v16, v94
    v_mfma_f32_16x16x32_bf16 a[200:203], v[140:143], v[108:111], a[200:203]
    v_add_f32 v17, v17, v95
    v_cvt_pk_bf16_f32 v107, v94, v95
    v_mfma_f32_16x16x32_bf16 v[88:91], v[56:59], a[64:67], v[44:47]
    v_mfma_f32_16x16x32_bf16 v[88:91], v[60:63], a[68:71], v[88:91]
    s_add_u32 m0, m0, s97
    v_exp_f32 v96, v96
    v_mfma_f32_16x16x32_bf16 v[88:91], v[64:67], a[72:75], v[88:91]
    v_exp_f32 v97, v97
    v_mfma_f32_16x16x32_bf16 v[88:91], v[68:71], a[76:79], v[88:91]
    buffer_load_dwordx4 v7, s[4:7], s49 offen offset:512 nt lds
    v_exp_f32 v98, v98
    v_mfma_f32_16x16x32_bf16 v[92:95], v[72:75], a[64:67], v[44:47]
    v_exp_f32 v99, v99
    v_mfma_f32_16x16x32_bf16 v[92:95], v[76:79], a[68:71], v[92:95]
    s_add_u32 m0, m0, s96
    v_add_f32 v18, v18, v96
    v_add_f32 v19, v19, v97
    v_mfma_f32_16x16x32_bf16 v[92:95], v[80:83], a[72:75], v[92:95]
    v_cvt_pk_bf16_f32 v108, v96, v97
    v_mfma_f32_16x16x32_bf16 v[92:95], v[84:87], a[76:79], v[92:95]
    v_exp_f32 v100, v100
    v_mfma_f32_16x16x32_bf16 v[152:155], v[112:115], v[104:107], v[152:155]
    buffer_load_dwordx4 v7, s[4:7], s49 offen offset:768 nt lds
    v_exp_f32 v101, v101
    v_mfma_f32_16x16x32_bf16 v[180:183], v[116:119], v[104:107], v[180:183]
    v_add_f32 v18, v18, v98
    v_add_f32 v19, v19, v99
    v_mfma_f32_16x16x32_bf16 v[208:211], v[120:123], v[104:107], v[208:211]
    s_add_u32 m0, m0, s97
    v_cvt_pk_bf16_f32 v109, v98, v99
    v_mfma_f32_16x16x32_bf16 v[236:239], v[124:127], v[104:107], v[236:239]
    v_exp_f32 v102, v102
    v_mfma_f32_16x16x32_bf16 a[120:123], v[128:131], v[104:107], a[120:123]
    buffer_load_dwordx4 v7, s[4:7], s49 offen offset:1024 nt lds
    v_exp_f32 v103, v103
    v_mfma_f32_16x16x32_bf16 a[148:151], v[132:135], v[104:107], a[148:151]
    v_add_f32 v18, v18, v100
    v_add_f32 v19, v19, v101
    v_mfma_f32_16x16x32_bf16 a[176:179], v[136:139], v[104:107], a[176:179]
    s_add_u32 m0, m0, s96
    v_cvt_pk_bf16_f32 v110, v100, v101
    v_add_f32 v18, v18, v102
    v_mfma_f32_16x16x32_bf16 a[204:207], v[140:143], v[104:107], a[204:207]
    v_add_f32 v19, v19, v103
    v_cvt_pk_bf16_f32 v111, v102, v103
    v_mfma_f32_16x16x32_bf16 v[96:99], v[56:59], a[80:83], v[48:51]
    v_mfma_f32_16x16x32_bf16 v[96:99], v[60:63], a[84:87], v[96:99]
    buffer_load_dwordx4 v7, s[4:7], s49 offen offset:1280 nt lds
    v_exp_f32 v88, v88
    v_mfma_f32_16x16x32_bf16 v[96:99], v[64:67], a[88:91], v[96:99]
    v_exp_f32 v89, v89
    v_mfma_f32_16x16x32_bf16 v[96:99], v[68:71], a[92:95], v[96:99]
    s_add_u32 m0, m0, s97
    v_exp_f32 v90, v90
    v_mfma_f32_16x16x32_bf16 v[100:103], v[72:75], a[80:83], v[48:51]
    v_exp_f32 v91, v91
    v_mfma_f32_16x16x32_bf16 v[100:103], v[76:79], a[84:87], v[100:103]
    buffer_load_dwordx4 v7, s[4:7], s49 offen offset:1536 nt lds
    v_add_f32 v20, v20, v88
    v_add_f32 v21, v21, v89
    v_mfma_f32_16x16x32_bf16 v[100:103], v[80:83], a[88:91], v[100:103]
    v_cvt_pk_bf16_f32 v104, v88, v89
    v_mfma_f32_16x16x32_bf16 v[100:103], v[84:87], a[92:95], v[100:103]
    v_exp_f32 v92, v92
    v_mfma_f32_16x16x32_bf16 v[156:159], v[112:115], v[108:111], v[156:159]
    s_add_u32 m0, m0, s96
    v_exp_f32 v93, v93
    v_mfma_f32_16x16x32_bf16 v[184:187], v[116:119], v[108:111], v[184:187]
    v_add_f32 v20, v20, v90
    v_add_f32 v21, v21, v91
    v_mfma_f32_16x16x32_bf16 v[212:215], v[120:123], v[108:111], v[212:215]
    buffer_load_dwordx4 v7, s[4:7], s49 offen offset:1792 nt lds
    v_cvt_pk_bf16_f32 v105, v90, v91
    v_mfma_f32_16x16x32_bf16 v[240:243], v[124:127], v[108:111], v[240:243]
    v_exp_f32 v94, v94
    v_mfma_f32_16x16x32_bf16 a[124:127], v[128:131], v[108:111], a[124:127]
    v_exp_f32 v95, v95
    v_mfma_f32_16x16x32_bf16 a[152:155], v[132:135], v[108:111], a[152:155]
    v_add_f32 v20, v20, v92
    v_add_f32 v21, v21, v93
    v_mfma_f32_16x16x32_bf16 a[180:183], v[136:139], v[108:111], a[180:183]
    v_cvt_pk_bf16_f32 v106, v92, v93
    v_add_f32 v20, v20, v94
    v_mfma_f32_16x16x32_bf16 a[208:211], v[140:143], v[108:111], a[208:211]
    v_add_f32 v21, v21, v95
    v_cvt_pk_bf16_f32 v107, v94, v95
    s_waitcnt vmcnt(16) lgkmcnt(0)
    s_barrier
    v_mfma_f32_16x16x32_bf16 v[88:91], v[56:59], a[96:99], v[52:55]
    ds_read_b128 v[56:59], v8 offset:8448
    v_mfma_f32_16x16x32_bf16 v[88:91], v[60:63], a[100:103], v[88:91]
    ds_read_b128 v[60:63], v8 offset:8512
    v_exp_f32 v96, v96
    v_mfma_f32_16x16x32_bf16 v[88:91], v[64:67], a[104:107], v[88:91]
    ds_read_b128 v[64:67], v8 offset:8576
    v_exp_f32 v97, v97
    v_mfma_f32_16x16x32_bf16 v[88:91], v[68:71], a[108:111], v[88:91]
    ds_read_b128 v[68:71], v8 offset:8640
    v_exp_f32 v98, v98
    v_mfma_f32_16x16x32_bf16 v[92:95], v[72:75], a[96:99], v[52:55]
    ds_read_b128 v[72:75], v8 offset:8960
    v_exp_f32 v99, v99
    v_mfma_f32_16x16x32_bf16 v[92:95], v[76:79], a[100:103], v[92:95]
    ds_read_b128 v[76:79], v8 offset:9024
    v_add_f32 v22, v22, v96
    v_add_f32 v23, v23, v97
    v_mfma_f32_16x16x32_bf16 v[92:95], v[80:83], a[104:107], v[92:95]
    ds_read_b128 v[80:83], v8 offset:9088
    v_cvt_pk_bf16_f32 v108, v96, v97
    v_mfma_f32_16x16x32_bf16 v[92:95], v[84:87], a[108:111], v[92:95]
    ds_read_b128 v[84:87], v8 offset:9152
    v_exp_f32 v100, v100
    v_mfma_f32_16x16x32_bf16 v[160:163], v[112:115], v[104:107], v[160:163]
    v_exp_f32 v101, v101
    v_mfma_f32_16x16x32_bf16 v[188:191], v[116:119], v[104:107], v[188:191]
    v_add_f32 v22, v22, v98
    v_add_f32 v23, v23, v99
    v_mfma_f32_16x16x32_bf16 v[216:219], v[120:123], v[104:107], v[216:219]
    v_cvt_pk_bf16_f32 v109, v98, v99
    v_mfma_f32_16x16x32_bf16 v[244:247], v[124:127], v[104:107], v[244:247]
    v_exp_f32 v102, v102
    v_mfma_f32_16x16x32_bf16 a[128:131], v[128:131], v[104:107], a[128:131]
    v_exp_f32 v103, v103
    v_mfma_f32_16x16x32_bf16 a[156:159], v[132:135], v[104:107], a[156:159]
    v_add_f32 v22, v22, v100
    v_add_f32 v23, v23, v101
    v_mfma_f32_16x16x32_bf16 a[184:187], v[136:139], v[104:107], a[184:187]
    v_cvt_pk_bf16_f32 v110, v100, v101
    v_add_f32 v22, v22, v102
    v_mfma_f32_16x16x32_bf16 a[212:215], v[140:143], v[104:107], a[212:215]
    v_add_f32 v23, v23, v103
    v_cvt_pk_bf16_f32 v111, v102, v103
    s_waitcnt lgkmcnt(0)
    v_mfma_f32_16x16x32_bf16 v[96:99], v[56:59], a[0:3], v[28:31]
    v_mfma_f32_16x16x32_bf16 v[96:99], v[60:63], a[4:7], v[96:99]
    v_exp_f32 v88, v88
    v_mfma_f32_16x16x32_bf16 v[96:99], v[64:67], a[8:11], v[96:99]
    v_exp_f32 v89, v89
    v_mfma_f32_16x16x32_bf16 v[96:99], v[68:71], a[12:15], v[96:99]
    v_exp_f32 v90, v90
    v_mfma_f32_16x16x32_bf16 v[100:103], v[72:75], a[0:3], v[28:31]
    v_exp_f32 v91, v91
    v_mfma_f32_16x16x32_bf16 v[100:103], v[76:79], a[4:7], v[100:103]
    v_add_f32 v24, v24, v88
    v_add_f32 v25, v25, v89
    v_mfma_f32_16x16x32_bf16 v[100:103], v[80:83], a[8:11], v[100:103]
    v_cvt_pk_bf16_f32 v104, v88, v89
    v_mfma_f32_16x16x32_bf16 v[100:103], v[84:87], a[12:15], v[100:103]
    v_exp_f32 v92, v92
    v_mfma_f32_16x16x32_bf16 v[164:167], v[112:115], v[108:111], v[164:167]
    v_exp_f32 v93, v93
    v_mfma_f32_16x16x32_bf16 v[192:195], v[116:119], v[108:111], v[192:195]
    v_add_f32 v24, v24, v90
    v_add_f32 v25, v25, v91
    v_mfma_f32_16x16x32_bf16 v[220:223], v[120:123], v[108:111], v[220:223]
    v_cvt_pk_bf16_f32 v105, v90, v91
    v_mfma_f32_16x16x32_bf16 v[248:251], v[124:127], v[108:111], v[248:251]
    v_exp_f32 v94, v94
    v_mfma_f32_16x16x32_bf16 a[132:135], v[128:131], v[108:111], a[132:135]
    v_exp_f32 v95, v95
    v_mfma_f32_16x16x32_bf16 a[160:163], v[132:135], v[108:111], a[160:163]
    v_add_f32 v24, v24, v92
    v_add_f32 v25, v25, v93
    v_mfma_f32_16x16x32_bf16 a[188:191], v[136:139], v[108:111], a[188:191]
    v_cvt_pk_bf16_f32 v106, v92, v93
    v_add_f32 v24, v24, v94
    v_mfma_f32_16x16x32_bf16 a[216:219], v[140:143], v[108:111], a[216:219]
    v_add_f32 v25, v25, v95
    v_cvt_pk_bf16_f32 v107, v94, v95
    s_add_u32 s22, s22, 1
    s_cmp_lt_u32 s22, 7
    s_cbranch_scc1 L_at_loop
    s_add_u32 s21, s21, 1
    s_mul_i32 s50, s21, s52
    s_mov_b32 s101, s21
    s_add_u32 s50, s50, s55
    s_cmp_ge_u32 s21, 2
    s_cselect_b32 s28, 0x40000000, 0
    s_add_u32 s50, s50, s28
    s_mov_b32 s82, s26
    s_mul_i32 s28, s26, s51
    s_add_u32 s50, s50, s28
    s_cmp_lg_u32 s69, 0
    s_cbranch_scc1 L_at_atailB
    v_mfma_f32_16x16x32_bf16 v[88:91], v[56:59], a[16:19], v[32:35]
    v_mfma_f32_16x16x32_bf16 v[88:91], v[60:63], a[20:23], v[88:91]
    v_exp_f32 v96, v96
    v_mfma_f32_16x16x32_bf16 v[88:91], v[64:67], a[24:27], v[88:91]
    v_exp_f32 v97, v97
    v_mfma_f32_16x16x32_bf16 v[88:91], v[68:71], a[28:31], v[88:91]
    v_exp_f32 v98, v98
    v_mfma_f32_16x16x32_bf16 v[92:95], v[72:75], a[16:19], v[32:35]
    v_exp_f32 v99, v99
    v_mfma_f32_16x16x32_bf16 v[92:95], v[76:79], a[20:23], v[92:95]
    v_add_f32 v12, v12, v96
    v_add_f32 v13, v13, v97
    v_mfma_f32_16x16x32_bf16 v[92:95], v[80:83], a[24:27], v[92:95]
    v_cvt_pk_bf16_f32 v108, v96, v97
    v_mfma_f32_16x16x32_bf16 v[92:95], v[84:87], a[28:31], v[92:95]
    v_exp_f32 v100, v100
    v_mfma_f32_16x16x32_bf16 v[168:171], v[112:115], v[104:107], v[168:171]
    ds_read_b64_tr_b16 v[112:113], v9 offset:8448
    ds_read_b64_tr_b16 v[114:115], v9 offset:8960
    v_exp_f32 v101, v101
    v_mfma_f32_16x16x32_bf16 v[196:199], v[116:119], v[104:107], v[196:199]
    ds_read_b64_tr_b16 v[116:117], v9 offset:8480
    ds_read_b64_tr_b16 v[118:119], v9 offset:8992
    v_add_f32 v12, v12, v98
    v_add_f32 v13, v13, v99
    v_mfma_f32_16x16x32_bf16 v[224:227], v[120:123], v[104:107], v[224:227]
    ds_read_b64_tr_b16 v[120:121], v9 offset:8512
    ds_read_b64_tr_b16 v[122:123], v9 offset:9024
    v_cvt_pk_bf16_f32 v109, v98, v99
    v_mfma_f32_16x16x32_bf16 v[252:255], v[124:127], v[104:107], v[252:255]
    ds_read_b64_tr_b16 v[124:125], v9 offset:8544
    ds_read_b64_tr_b16 v[126:127], v9 offset:9056
    v_exp_f32 v102, v102
    v_mfma_f32_16x16x32_bf16 a[136:139], v[128:131], v[104:107], a[136:139]
    ds_read_b64_tr_b16 v[128:129], v9 offset:8576
    ds_read_b64_tr_b16 v[130:131], v9 offset:9088
    v_exp_f32 v103, v103
    v_mfma_f32_16x16x32_bf16 a[164:167], v[132:135], v[104:107], a[164:167]
    ds_read_b64_tr_b16 v[132:133], v9 offset:8608
    ds_read_b64_tr_b16 v[134:135], v9 offset:9120
    v_add_f32 v12, v12, v100
    v_add_f32 v13, v13, v101
    v_mfma_f32_16x16x32_bf16 a[192:195], v[136:139], v[104:107], a[192:195]
    ds_read_b64_tr_b16 v[136:137], v9 offset:8640
    ds_read_b64_tr_b16 v[138:139], v9 offset:9152
    v_cvt_pk_bf16_f32 v110, v100, v101
    v_add_f32 v12, v12, v102
    v_mfma_f32_16x16x32_bf16 a[220:223], v[140:143], v[104:107], a[220:223]
    ds_read_b64_tr_b16 v[140:141], v9 offset:8672
    ds_read_b64_tr_b16 v[142:143], v9 offset:9184
    v_add_f32 v13, v13, v103
    v_cvt_pk_bf16_f32 v111, v102, v103
    v_mfma_f32_16x16x32_bf16 v[96:99], v[56:59], a[32:35], v[36:39]
    v_mfma_f32_16x16x32_bf16 v[96:99], v[60:63], a[36:39], v[96:99]
    s_add_u32 m0, s33, 0
    v_exp_f32 v88, v88
    v_mfma_f32_16x16x32_bf16 v[96:99], v[64:67], a[40:43], v[96:99]
    v_exp_f32 v89, v89
    v_mfma_f32_16x16x32_bf16 v[96:99], v[68:71], a[44:47], v[96:99]
    s_mov_b32 s49, s50
    v_exp_f32 v90, v90
    v_mfma_f32_16x16x32_bf16 v[100:103], v[72:75], a[32:35], v[36:39]
    v_exp_f32 v91, v91
    v_mfma_f32_16x16x32_bf16 v[100:103], v[76:79], a[36:39], v[100:103]
    s_add_u32 s50, s50, s51
    v_add_f32 v14, v14, v88
    v_add_f32 v15, v15, v89
    v_mfma_f32_16x16x32_bf16 v[100:103], v[80:83], a[40:43], v[100:103]
    v_cvt_pk_bf16_f32 v104, v88, v89
    v_mfma_f32_16x16x32_bf16 v[100:103], v[84:87], a[44:47], v[100:103]
    s_add_u32 s82, s82, 1
    v_exp_f32 v92, v92
    s_waitcnt lgkmcnt(0)
    v_mfma_f32_16x16x32_bf16 v[144:147], v[112:115], v[108:111], v[144:147]
    v_exp_f32 v93, v93
    v_mfma_f32_16x16x32_bf16 v[172:175], v[116:119], v[108:111], v[172:175]
    s_cmp_eq_u32 s82, 20
    v_add_f32 v14, v14, v90
    v_add_f32 v15, v15, v91
    v_mfma_f32_16x16x32_bf16 v[200:203], v[120:123], v[108:111], v[200:203]
    v_cvt_pk_bf16_f32 v105, v90, v91
    v_mfma_f32_16x16x32_bf16 v[228:231], v[124:127], v[108:111], v[228:231]
    s_cselect_b32 s29, s83, 0
    v_exp_f32 v94, v94
    v_mfma_f32_16x16x32_bf16 a[112:115], v[128:131], v[108:111], a[112:115]
    v_exp_f32 v95, v95
    v_mfma_f32_16x16x32_bf16 a[140:143], v[132:135], v[108:111], a[140:143]
    s_sub_u32 s50, s50, s29
    v_add_f32 v14, v14, v92
    v_add_f32 v15, v15, v93
    v_mfma_f32_16x16x32_bf16 a[168:171], v[136:139], v[108:111], a[168:171]
    v_cvt_pk_bf16_f32 v106, v92, v93
    v_add_f32 v14, v14, v94
    v_mfma_f32_16x16x32_bf16 a[196:199], v[140:143], v[108:111], a[196:199]
    s_add_u32 s28, s49, s88
    v_add_f32 v15, v15, v95
    v_cvt_pk_bf16_f32 v107, v94, v95
    v_mfma_f32_16x16x32_bf16 v[88:91], v[56:59], a[48:51], v[40:43]
    v_mfma_f32_16x16x32_bf16 v[88:91], v[60:63], a[52:55], v[88:91]
    buffer_load_dwordx4 v26, s[16:19], s28 offen lds
    v_exp_f32 v96, v96
    v_mfma_f32_16x16x32_bf16 v[88:91], v[64:67], a[56:59], v[88:91]
    v_exp_f32 v97, v97
    v_mfma_f32_16x16x32_bf16 v[88:91], v[68:71], a[60:63], v[88:91]
    s_add_u32 m0, m0, s53
    v_exp_f32 v98, v98
    v_mfma_f32_16x16x32_bf16 v[92:95], v[72:75], a[48:51], v[40:43]
    v_exp_f32 v99, v99
    v_mfma_f32_16x16x32_bf16 v[92:95], v[76:79], a[52:55], v[92:95]
    s_add_u32 s28, s49, s89
    v_add_f32 v16, v16, v96
    v_add_f32 v17, v17, v97
    v_mfma_f32_16x16x32_bf16 v[92:95], v[80:83], a[56:59], v[92:95]
    v_cvt_pk_bf16_f32 v108, v96, v97
    v_mfma_f32_16x16x32_bf16 v[92:95], v[84:87], a[60:63], v[92:95]
    buffer_load_dwordx4 v26, s[16:19], s28 offen lds
    v_exp_f32 v100, v100
    v_mfma_f32_16x16x32_bf16 v[148:151], v[112:115], v[104:107], v[148:151]
    v_exp_f32 v101, v101
    v_mfma_f32_16x16x32_bf16 v[176:179], v[116:119], v[104:107], v[176:179]
    s_add_u32 m0, m0, s53
    v_add_f32 v16, v16, v98
    v_add_f32 v17, v17, v99
    v_mfma_f32_16x16x32_bf16 v[204:207], v[120:123], v[104:107], v[204:207]
    v_cvt_pk_bf16_f32 v109, v98, v99
    v_mfma_f32_16x16x32_bf16 v[232:235], v[124:127], v[104:107], v[232:235]
    s_add_u32 s28, s49, s90
    v_exp_f32 v102, v102
    v_mfma_f32_16x16x32_bf16 a[116:119], v[128:131], v[104:107], a[116:119]
    v_exp_f32 v103, v103
    v_mfma_f32_16x16x32_bf16 a[144:147], v[132:135], v[104:107], a[144:147]
    buffer_load_dwordx4 v26, s[16:19], s28 offen lds
    v_add_f32 v16, v16, v100
    v_add_f32 v17, v17, v101
    v_mfma_f32_16x16x32_bf16 a[172:175], v[136:139], v[104:107], a[172:175]
    v_cvt_pk_bf16_f32 v110, v100, v101
    v_add_f32 v16, v16, v102
    v_mfma_f32_16x16x32_bf16 a[200:203], v[140:143], v[104:107], a[200:203]
    s_add_u32 m0, m0, s53
    v_add_f32 v17, v17, v103
    v_cvt_pk_bf16_f32 v111, v102, v103
    v_mfma_f32_16x16x32_bf16 v[96:99], v[56:59], a[64:67], v[44:47]
    v_mfma_f32_16x16x32_bf16 v[96:99], v[60:63], a[68:71], v[96:99]
    s_add_u32 s28, s49, s91
    v_exp_f32 v88, v88
    v_mfma_f32_16x16x32_bf16 v[96:99], v[64:67], a[72:75], v[96:99]
    v_exp_f32 v89, v89
    v_mfma_f32_16x16x32_bf16 v[96:99], v[68:71], a[76:79], v[96:99]
    buffer_load_dwordx4 v26, s[16:19], s28 offen lds
    v_exp_f32 v90, v90
    v_mfma_f32_16x16x32_bf16 v[100:103], v[72:75], a[64:67], v[44:47]
    v_exp_f32 v91, v91
    v_mfma_f32_16x16x32_bf16 v[100:103], v[76:79], a[68:71], v[100:103]
    s_add_u32 m0, m0, s53
    v_add_f32 v18, v18, v88
    v_add_f32 v19, v19, v89
    v_mfma_f32_16x16x32_bf16 v[100:103], v[80:83], a[72:75], v[100:103]
    v_cvt_pk_bf16_f32 v104, v88, v89
    v_mfma_f32_16x16x32_bf16 v[100:103], v[84:87], a[76:79], v[100:103]
    s_add_u32 s28, s49, s92
    v_exp_f32 v92, v92
    v_mfma_f32_16x16x32_bf16 v[152:155], v[112:115], v[108:111], v[152:155]
    v_exp_f32 v93, v93
    v_mfma_f32_16x16x32_bf16 v[180:183], v[116:119], v[108:111], v[180:183]
    buffer_load_dwordx4 v26, s[16:19], s28 offen lds
    v_add_f32 v18, v18, v90
    v_add_f32 v19, v19, v91
    v_mfma_f32_16x16x32_bf16 v[208:211], v[120:123], v[108:111], v[208:211]
    v_cvt_pk_bf16_f32 v105, v90, v91
    v_mfma_f32_16x16x32_bf16 v[236:239], v[124:127], v[108:111], v[236:239]
    s_add_u32 m0, m0, s53
    v_exp_f32 v94, v94
    v_mfma_f32_16x16x32_bf16 a[120:123], v[128:131], v[108:111], a[120:123]
    v_exp_f32 v95, v95
    v_mfma_f32_16x16x32_bf16 a[148:151], v[132:135], v[108:111], a[148:151]
    s_add_u32 s28, s49, s93
    v_add_f32 v18, v18, v92
    v_add_f32 v19, v19, v93
    v_mfma_f32_16x16x32_bf16 a[176:179], v[136:139], v[108:111], a[176:179]
    v_cvt_pk_bf16_f32 v106, v92, v93
    v_add_f32 v18, v18, v94
    v_mfma_f32_16x16x32_bf16 a[204:207], v[140:143], v[108:111], a[204:207]
    buffer_load_dwordx4 v26, s[16:19], s28 offen lds
    v_add_f32 v19, v19, v95
    v_cvt_pk_bf16_f32 v107, v94, v95
    v_mfma_f32_16x16x32_bf16 v[88:91], v[56:59], a[80:83], v[48:51]
    v_mfma_f32_16x16x32_bf16 v[88:91], v[60:63], a[84:87], v[88:91]
    s_add_u32 m0, m0, s53
    v_exp_f32 v96, v96
    v_mfma_f32_16x16x32_bf16 v[88:91], v[64:67], a[88:91], v[88:91]
    v_exp_f32 v97, v97
    v_mfma_f32_16x16x32_bf16 v[88:91], v[68:71], a[92:95], v[88:91]
    s_add_u32 s28, s49, s94
    v_exp_f32 v98, v98
    v_mfma_f32_16x16x32_bf16 v[92:95], v[72:75], a[80:83], v[48:51]
    v_exp_f32 v99, v99
    v_mfma_f32_16x16x32_bf16 v[92:95], v[76:79], a[84:87], v[92:95]
    buffer_load_dwordx4 v26, s[16:19], s28 offen lds
    v_add_f32 v20, v20, v96
    v_add_f32 v21, v21, v97
    v_mfma_f32_16x16x32_bf16 v[92:95], v[80:83], a[88:91], v[92:95]
    v_cvt_pk_bf16_f32 v108, v96, v97
    v_mfma_f32_16x16x32_bf16 v[92:95], v[84:87], a[92:95], v[92:95]
    s_add_u32 m0, m0, s53
    v_exp_f32 v100, v100
    v_mfma_f32_16x16x32_bf16 v[156:159], v[112:115], v[104:107], v[156:159]
    v_exp_f32 v101, v101
    v_mfma_f32_16x16x32_bf16 v[184:187], v[116:119], v[104:107], v[184:187]
    s_add_u32 s28, s49, s95
    v_add_f32 v20, v20, v98
    v_add_f32 v21, v21, v99
    v_mfma_f32_16x16x32_bf16 v[212:215], v[120:123], v[104:107], v[212:215]
    v_cvt_pk_bf16_f32 v109, v98, v99
    v_mfma_f32_16x16x32_bf16 v[240:243], v[124:127], v[104:107], v[240:243]
    buffer_load_dwordx4 v26, s[16:19], s28 offen lds
    v_exp_f32 v102, v102
    v_mfma_f32_16x16x32_bf16 a[124:127], v[128:131], v[104:107], a[124:127]
    v_exp_f32 v103, v103
    v_mfma_f32_16x16x32_bf16 a[152:155], v[132:135], v[104:107], a[152:155]
    v_add_f32 v20, v20, v100
    v_add_f32 v21, v21, v101
    v_mfma_f32_16x16x32_bf16 a[180:183], v[136:139], v[104:107], a[180:183]
    v_cvt_pk_bf16_f32 v110, v100, v101
    v_add_f32 v20, v20, v102
    v_mfma_f32_16x16x32_bf16 a[208:211], v[140:143], v[104:107], a[208:211]
    v_add_f32 v21, v21, v103
    v_cvt_pk_bf16_f32 v111, v102, v103
    s_waitcnt vmcnt(16) lgkmcnt(0)
    s_barrier
    v_mfma_f32_16x16x32_bf16 v[96:99], v[56:59], a[96:99], v[52:55]
    ds_read_b128 v[56:59], v8 offset:16896
    v_mfma_f32_16x16x32_bf16 v[96:99], v[60:63], a[100:103], v[96:99]
    ds_read_b128 v[60:63], v8 offset:16960
    v_exp_f32 v88, v88
    v_mfma_f32_16x16x32_bf16 v[96:99], v[64:67], a[104:107], v[96:99]
    ds_read_b128 v[64:67], v8 offset:17024
    v_exp_f32 v89, v89
    v_mfma_f32_16x16x32_bf16 v[96:99], v[68:71], a[108:111], v[96:99]
    ds_read_b128 v[68:71], v8 offset:17088
    v_exp_f32 v90, v90
    v_mfma_f32_16x16x32_bf16 v[100:103], v[72:75], a[96:99], v[52:55]
    ds_read_b128 v[72:75], v8 offset:17408
    v_exp_f32 v91, v91
    v_mfma_f32_16x16x32_bf16 v[100:103], v[76:79], a[100:103], v[100:103]
    ds_read_b128 v[76:79], v8 offset:17472
    v_add_f32 v22, v22, v88
    v_add_f32 v23, v23, v89
    v_mfma_f32_16x16x32_bf16 v[100:103], v[80:83], a[104:107], v[100:103]
    ds_read_b128 v[80:83], v8 offset:17536
    v_cvt_pk_bf16_f32 v104, v88, v89
    v_mfma_f32_16x16x32_bf16 v[100:103], v[84:87], a[108:111], v[100:103]
    ds_read_b128 v[84:87], v8 offset:17600
    v_exp_f32 v92, v92
    v_mfma_f32_16x16x32_bf16 v[160:163], v[112:115], v[108:111], v[160:163]
    v_exp_f32 v93, v93
    v_mfma_f32_16x16x32_bf16 v[188:191], v[116:119], v[108:111], v[188:191]
    v_add_f32 v22, v22, v90
    v_add_f32 v23, v23, v91
    v_mfma_f32_16x16x32_bf16 v[216:219], v[120:123], v[108:111], v[216:219]
    v_cvt_pk_bf16_f32 v105, v90, v91
    v_mfma_f32_16x16x32_bf16 v[244:247], v[124:127], v[108:111], v[244:247]
    v_exp_f32 v94, v94
    v_mfma_f32_16x16x32_bf16 a[128:131], v[128:131], v[108:111], a[128:131]
    v_exp_f32 v95, v95
    v_mfma_f32_16x16x32_bf16 a[156:159], v[132:135], v[108:111], a[156:159]
    v_add_f32 v22, v22, v92
    v_add_f32 v23, v23, v93
    v_mfma_f32_16x16x32_bf16 a[184:187], v[136:139], v[108:111], a[184:187]
    v_cvt_pk_bf16_f32 v106, v92, v93
    v_add_f32 v22, v22, v94
    v_mfma_f32_16x16x32_bf16 a[212:215], v[140:143], v[108:111], a[212:215]
    v_add_f32 v23, v23, v95
    v_cvt_pk_bf16_f32 v107, v94, v95
    s_waitcnt lgkmcnt(0)
    v_mfma_f32_16x16x32_bf16 v[88:91], v[56:59], a[0:3], v[28:31]
    v_mfma_f32_16x16x32_bf16 v[88:91], v[60:63], a[4:7], v[88:91]
    v_exp_f32 v96, v96
    v_mfma_f32_16x16x32_bf16 v[88:91], v[64:67], a[8:11], v[88:91]
    v_exp_f32 v97, v97
    v_mfma_f32_16x16x32_bf16 v[88:91], v[68:71], a[12:15], v[88:91]
    v_exp_f32 v98, v98
    v_mfma_f32_16x16x32_bf16 v[92:95], v[72:75], a[0:3], v[28:31]
    v_exp_f32 v99, v99
    v_mfma_f32_16x16x32_bf16 v[92:95], v[76:79], a[4:7], v[92:95]
    v_add_f32 v24, v24, v96
    v_add_f32 v25, v25, v97
    v_mfma_f32_16x16x32_bf16 v[92:95], v[80:83], a[8:11], v[92:95]
    v_cvt_pk_bf16_f32 v108, v96, v97
    v_mfma_f32_16x16x32_bf16 v[92:95], v[84:87], a[12:15], v[92:95]
    v_exp_f32 v100, v100
    v_mfma_f32_16x16x32_bf16 v[164:167], v[112:115], v[104:107], v[164:167]
    v_exp_f32 v101, v101
    v_mfma_f32_16x16x32_bf16 v[192:195], v[116:119], v[104:107], v[192:195]
    v_add_f32 v24, v24, v98
    v_add_f32 v25, v25, v99
    v_mfma_f32_16x16x32_bf16 v[220:223], v[120:123], v[104:107], v[220:223]
    v_cvt_pk_bf16_f32 v109, v98, v99
    v_mfma_f32_16x16x32_bf16 v[248:251], v[124:127], v[104:107], v[248:251]
    v_exp_f32 v102, v102
    v_mfma_f32_16x16x32_bf16 a[132:135], v[128:131], v[104:107], a[132:135]
    v_exp_f32 v103, v103
    v_mfma_f32_16x16x32_bf16 a[160:163], v[132:135], v[104:107], a[160:163]
    v_add_f32 v24, v24, v100
    v_add_f32 v25, v25, v101
    v_mfma_f32_16x16x32_bf16 a[188:191], v[136:139], v[104:107], a[188:191]
    v_cvt_pk_bf16_f32 v110, v100, v101
    v_add_f32 v24, v24, v102
    v_mfma_f32_16x16x32_bf16 a[216:219], v[140:143], v[104:107], a[216:219]
    v_add_f32 v25, v25, v103
    v_cvt_pk_bf16_f32 v111, v102, v103
    v_mfma_f32_16x16x32_bf16 v[96:99], v[56:59], a[16:19], v[32:35]
    v_mfma_f32_16x16x32_bf16 v[96:99], v[60:63], a[20:23], v[96:99]
    v_exp_f32 v88, v88
    v_mfma_f32_16x16x32_bf16 v[96:99], v[64:67], a[24:27], v[96:99]
    v_exp_f32 v89, v89
    v_mfma_f32_16x16x32_bf16 v[96:99], v[68:71], a[28:31], v[96:99]
    v_exp_f32 v90, v90
    v_mfma_f32_16x16x32_bf16 v[100:103], v[72:75], a[16:19], v[32:35]
    v_exp_f32 v91, v91
    v_mfma_f32_16x16x32_bf16 v[100:103], v[76:79], a[20:23], v[100:103]
    v_add_f32 v12, v12, v88
    v_add_f32 v13, v13, v89
    v_mfma_f32_16x16x32_bf16 v[100:103], v[80:83], a[24:27], v[100:103]
    v_cvt_pk_bf16_f32 v104, v88, v89
    v_mfma_f32_16x16x32_bf16 v[100:103], v[84:87], a[28:31], v[100:103]
    v_exp_f32 v92, v92
    v_mfma_f32_16x16x32_bf16 v[168:171], v[112:115], v[108:111], v[168:171]
    ds_read_b64_tr_b16 v[112:113], v9 offset:16896
    ds_read_b64_tr_b16 v[114:115], v9 offset:17408
    v_exp_f32 v93, v93
    v_mfma_f32_16x16x32_bf16 v[196:199], v[116:119], v[108:111], v[196:199]
    ds_read_b64_tr_b16 v[116:117], v9 offset:16928
    ds_read_b64_tr_b16 v[118:119], v9 offset:17440
    v_add_f32 v12, v12, v90
    v_add_f32 v13, v13, v91
    v_mfma_f32_16x16x32_bf16 v[224:227], v[120:123], v[108:111], v[224:227]
    ds_read_b64_tr_b16 v[120:121], v9 offset:16960
    ds_read_b64_tr_b16 v[122:123], v9 offset:17472
    v_cvt_pk_bf16_f32 v105, v90, v91
    v_mfma_f32_16x16x32_bf16 v[252:255], v[124:127], v[108:111], v[252:255]
    ds_read_b64_tr_b16 v[124:125], v9 offset:16992
    ds_read_b64_tr_b16 v[126:127], v9 offset:17504
    v_exp_f32 v94, v94
    v_mfma_f32_16x16x32_bf16 a[136:139], v[128:131], v[108:111], a[136:139]
    ds_read_b64_tr_b16 v[128:129], v9 offset:17024
    ds_read_b64_tr_b16 v[130:131], v9 offset:17536
    v_exp_f32 v95, v95
    v_mfma_f32_16x16x32_bf16 a[164:167], v[132:135], v[108:111], a[164:167]
    ds_read_b64_tr_b16 v[132:133], v9 offset:17056
    ds_read_b64_tr_b16 v[134:135], v9 offset:17568
    v_add_f32 v12, v12, v92
    v_add_f32 v13, v13, v93
    v_mfma_f32_16x16x32_bf16 a[192:195], v[136:139], v[108:111], a[192:195]
    ds_read_b64_tr_b16 v[136:137], v9 offset:17088
    ds_read_b64_tr_b16 v[138:139], v9 offset:17600
    v_cvt_pk_bf16_f32 v106, v92, v93
    v_add_f32 v12, v12, v94
    v_mfma_f32_16x16x32_bf16 a[220:223], v[140:143], v[108:111], a[220:223]
    ds_read_b64_tr_b16 v[140:141], v9 offset:17120
    ds_read_b64_tr_b16 v[142:143], v9 offset:17632
    v_add_f32 v13, v13, v95
    v_cvt_pk_bf16_f32 v107, v94, v95
    v_mfma_f32_16x16x32_bf16 v[88:91], v[56:59], a[32:35], v[36:39]
    v_mfma_f32_16x16x32_bf16 v[88:91], v[60:63], a[36:39], v[88:91]
    s_add_u32 m0, s33, 8448
    v_exp_f32 v96, v96
    v_mfma_f32_16x16x32_bf16 v[88:91], v[64:67], a[40:43], v[88:91]
    v_exp_f32 v97, v97
    v_mfma_f32_16x16x32_bf16 v[88:91], v[68:71], a[44:47], v[88:91]
    s_mov_b32 s49, s50
    v_exp_f32 v98, v98
    v_mfma_f32_16x16x32_bf16 v[92:95], v[72:75], a[32:35], v[36:39]
    v_exp_f32 v99, v99
    v_mfma_f32_16x16x32_bf16 v[92:95], v[76:79], a[36:39], v[92:95]
    s_add_u32 s50, s50, s51
    v_add_f32 v14, v14, v96
    v_add_f32 v15, v15, v97
    v_mfma_f32_16x16x32_bf16 v[92:95], v[80:83], a[40:43], v[92:95]
    v_cvt_pk_bf16_f32 v108, v96, v97
    v_mfma_f32_16x16x32_bf16 v[92:95], v[84:87], a[44:47], v[92:95]
    s_add_u32 s82, s82, 1
    v_exp_f32 v100, v100
    s_waitcnt lgkmcnt(0)
    v_mfma_f32_16x16x32_bf16 v[144:147], v[112:115], v[104:107], v[144:147]
    v_exp_f32 v101, v101
    v_mfma_f32_16x16x32_bf16 v[172:175], v[116:119], v[104:107], v[172:175]
    s_cmp_eq_u32 s82, 20
    v_add_f32 v14, v14, v98
    v_add_f32 v15, v15, v99
    v_mfma_f32_16x16x32_bf16 v[200:203], v[120:123], v[104:107], v[200:203]
    v_cvt_pk_bf16_f32 v109, v98, v99
    v_mfma_f32_16x16x32_bf16 v[228:231], v[124:127], v[104:107], v[228:231]
    s_cselect_b32 s29, s83, 0
    v_exp_f32 v102, v102
    v_mfma_f32_16x16x32_bf16 a[112:115], v[128:131], v[104:107], a[112:115]
    v_exp_f32 v103, v103
    v_mfma_f32_16x16x32_bf16 a[140:143], v[132:135], v[104:107], a[140:143]
    s_sub_u32 s50, s50, s29
    v_add_f32 v14, v14, v100
    v_add_f32 v15, v15, v101
    v_mfma_f32_16x16x32_bf16 a[168:171], v[136:139], v[104:107], a[168:171]
    v_cvt_pk_bf16_f32 v110, v100, v101
    v_add_f32 v14, v14, v102
    v_mfma_f32_16x16x32_bf16 a[196:199], v[140:143], v[104:107], a[196:199]
    s_add_u32 s28, s49, s88
    v_add_f32 v15, v15, v103
    v_cvt_pk_bf16_f32 v111, v102, v103
    v_mfma_f32_16x16x32_bf16 v[96:99], v[56:59], a[48:51], v[40:43]
    v_mfma_f32_16x16x32_bf16 v[96:99], v[60:63], a[52:55], v[96:99]
    buffer_load_dwordx4 v26, s[16:19], s28 offen lds
    v_exp_f32 v88, v88
    v_mfma_f32_16x16x32_bf16 v[96:99], v[64:67], a[56:59], v[96:99]
    v_exp_f32 v89, v89
    v_mfma_f32_16x16x32_bf16 v[96:99], v[68:71], a[60:63], v[96:99]
    s_add_u32 m0, m0, s53
    v_exp_f32 v90, v90
    v_mfma_f32_16x16x32_bf16 v[100:103], v[72:75], a[48:51], v[40:43]
    v_exp_f32 v91, v91
    v_mfma_f32_16x16x32_bf16 v[100:103], v[76:79], a[52:55], v[100:103]
    s_add_u32 s28, s49, s89
    v_add_f32 v16, v16, v88
    v_add_f32 v17, v17, v89
    v_mfma_f32_16x16x32_bf16 v[100:103], v[80:83], a[56:59], v[100:103]
    v_cvt_pk_bf16_f32 v104, v88, v89
    v_mfma_f32_16x16x32_bf16 v[100:103], v[84:87], a[60:63], v[100:103]
    buffer_load_dwordx4 v26, s[16:19], s28 offen lds
    v_exp_f32 v92, v92
    v_mfma_f32_16x16x32_bf16 v[148:151], v[112:115], v[108:111], v[148:151]
    v_exp_f32 v93, v93
    v_mfma_f32_16x16x32_bf16 v[176:179], v[116:119], v[108:111], v[176:179]
    s_add_u32 m0, m0, s53
    v_add_f32 v16, v16, v90
    v_add_f32 v17, v17, v91
    v_mfma_f32_16x16x32_bf16 v[204:207], v[120:123], v[108:111], v[204:207]
    v_cvt_pk_bf16_f32 v105, v90, v91
    v_mfma_f32_16x16x32_bf16 v[232:235], v[124:127], v[108:111], v[232:235]
    s_add_u32 s28, s49, s90
    v_exp_f32 v94, v94
    v_mfma_f32_16x16x32_bf16 a[116:119], v[128:131], v[108:111], a[116:119]
    v_exp_f32 v95, v95
    v_mfma_f32_16x16x32_bf16 a[144:147], v[132:135], v[108:111], a[144:147]
    buffer_load_dwordx4 v26, s[16:19], s28 offen lds
    v_add_f32 v16, v16, v92
    v_add_f32 v17, v17, v93
    v_mfma_f32_16x16x32_bf16 a[172:175], v[136:139], v[108:111], a[172:175]
    v_cvt_pk_bf16_f32 v106, v92, v93
    v_add_f32 v16, v16, v94
    v_mfma_f32_16x16x32_bf16 a[200:203], v[140:143], v[108:111], a[200:203]
    s_add_u32 m0, m0, s53
    v_add_f32 v17, v17, v95
    v_cvt_pk_bf16_f32 v107, v94, v95
    v_mfma_f32_16x16x32_bf16 v[88:91], v[56:59], a[64:67], v[44:47]
    v_mfma_f32_16x16x32_bf16 v[88:91], v[60:63], a[68:71], v[88:91]
    s_add_u32 s28, s49, s91
    v_exp_f32 v96, v96
    v_mfma_f32_16x16x32_bf16 v[88:91], v[64:67], a[72:75], v[88:91]
    v_exp_f32 v97, v97
    v_mfma_f32_16x16x32_bf16 v[88:91], v[68:71], a[76:79], v[88:91]
    buffer_load_dwordx4 v26, s[16:19], s28 offen lds
    v_exp_f32 v98, v98
    v_mfma_f32_16x16x32_bf16 v[92:95], v[72:75], a[64:67], v[44:47]
    v_exp_f32 v99, v99
    v_mfma_f32_16x16x32_bf16 v[92:95], v[76:79], a[68:71], v[92:95]
    s_add_u32 m0, m0, s53
    v_add_f32 v18, v18, v96
    v_add_f32 v19, v19, v97
    v_mfma_f32_16x16x32_bf16 v[92:95], v[80:83], a[72:75], v[92:95]
    v_cvt_pk_bf16_f32 v108, v96, v97
    v_mfma_f32_16x16x32_bf16 v[92:95], v[84:87], a[76:79], v[92:95]
    s_add_u32 s28, s49, s92
    v_exp_f32 v100, v100
    v_mfma_f32_16x16x32_bf16 v[152:155], v[112:115], v[104:107], v[152:155]
    v_exp_f32 v101, v101
    v_mfma_f32_16x16x32_bf16 v[180:183], v[116:119], v[104:107], v[180:183]
    buffer_load_dwordx4 v26, s[16:19], s28 offen lds
    v_add_f32 v18, v18, v98
    v_add_f32 v19, v19, v99
    v_mfma_f32_16x16x32_bf16 v[208:211], v[120:123], v[104:107], v[208:211]
    v_cvt_pk_bf16_f32 v109, v98, v99
    v_mfma_f32_16x16x32_bf16 v[236:239], v[124:127], v[104:107], v[236:239]
    s_add_u32 m0, m0, s53
    v_exp_f32 v102, v102
    v_mfma_f32_16x16x32_bf16 a[120:123], v[128:131], v[104:107], a[120:123]
    v_exp_f32 v103, v103
    v_mfma_f32_16x16x32_bf16 a[148:151], v[132:135], v[104:107], a[148:151]
    s_add_u32 s28, s49, s93
    v_add_f32 v18, v18, v100
    v_add_f32 v19, v19, v101
    v_mfma_f32_16x16x32_bf16 a[176:179], v[136:139], v[104:107], a[176:179]
    v_cvt_pk_bf16_f32 v110, v100, v101
    v_add_f32 v18, v18, v102
    v_mfma_f32_16x16x32_bf16 a[204:207], v[140:143], v[104:107], a[204:207]
    buffer_load_dwordx4 v26, s[16:19], s28 offen lds
    v_add_f32 v19, v19, v103
    v_cvt_pk_bf16_f32 v111, v102, v103
    v_mfma_f32_16x16x32_bf16 v[96:99], v[56:59], a[80:83], v[48:51]
    v_mfma_f32_16x16x32_bf16 v[96:99], v[60:63], a[84:87], v[96:99]
    s_add_u32 m0, m0, s53
    v_exp_f32 v88, v88
    v_mfma_f32_16x16x32_bf16 v[96:99], v[64:67], a[88:91], v[96:99]
    v_exp_f32 v89, v89
    v_mfma_f32_16x16x32_bf16 v[96:99], v[68:71], a[92:95], v[96:99]
    s_add_u32 s28, s49, s94
    v_exp_f32 v90, v90
    v_mfma_f32_16x16x32_bf16 v[100:103], v[72:75], a[80:83], v[48:51]
    v_exp_f32 v91, v91
    v_mfma_f32_16x16x32_bf16 v[100:103], v[76:79], a[84:87], v[100:103]
    buffer_load_dwordx4 v26, s[16:19], s28 offen lds
    v_add_f32 v20, v20, v88
    v_add_f32 v21, v21, v89
    v_mfma_f32_16x16x32_bf16 v[100:103], v[80:83], a[88:91], v[100:103]
    v_cvt_pk_bf16_f32 v104, v88, v89
    v_mfma_f32_16x16x32_bf16 v[100:103], v[84:87], a[92:95], v[100:103]
    s_add_u32 m0, m0, s53
    v_exp_f32 v92, v92
    v_mfma_f32_16x16x32_bf16 v[156:159], v[112:115], v[108:111], v[156:159]
    v_exp_f32 v93, v93
    v_mfma_f32_16x16x32_bf16 v[184:187], v[116:119], v[108:111], v[184:187]
    s_add_u32 s28, s49, s95
    v_add_f32 v20, v20, v90
    v_add_f32 v21, v21, v91
    v_mfma_f32_16x16x32_bf16 v[212:215], v[120:123], v[108:111], v[212:215]
    v_cvt_pk_bf16_f32 v105, v90, v91
    v_mfma_f32_16x16x32_bf16 v[240:243], v[124:127], v[108:111], v[240:243]
    buffer_load_dwordx4 v26, s[16:19], s28 offen lds
    v_exp_f32 v94, v94
    v_mfma_f32_16x16x32_bf16 a[124:127], v[128:131], v[108:111], a[124:127]
    v_exp_f32 v95, v95
    v_mfma_f32_16x16x32_bf16 a[152:155], v[132:135], v[108:111], a[152:155]
    v_add_f32 v20, v20, v92
    v_add_f32 v21, v21, v93
    v_mfma_f32_16x16x32_bf16 a[180:183], v[136:139], v[108:111], a[180:183]
    v_cvt_pk_bf16_f32 v106, v92, v93
    v_add_f32 v20, v20, v94
    v_mfma_f32_16x16x32_bf16 a[208:211], v[140:143], v[108:111], a[208:211]
    v_add_f32 v21, v21, v95
    v_cvt_pk_bf16_f32 v107, v94, v95
    s_waitcnt vmcnt(16) lgkmcnt(0)
    s_barrier
    v_mfma_f32_16x16x32_bf16 v[88:91], v[56:59], a[96:99], v[52:55]
    ds_read_b128 v[56:59], v8 offset:25344
    v_mfma_f32_16x16x32_bf16 v[88:91], v[60:63], a[100:103], v[88:91]
    ds_read_b128 v[60:63], v8 offset:25408
    v_exp_f32 v96, v96
    v_mfma_f32_16x16x32_bf16 v[88:91], v[64:67], a[104:107], v[88:91]
    ds_read_b128 v[64:67], v8 offset:25472
    v_exp_f32 v97, v97
    v_mfma_f32_16x16x32_bf16 v[88:91], v[68:71], a[108:111], v[88:91]
    ds_read_b128 v[68:71], v8 offset:25536
    v_exp_f32 v98, v98
    v_mfma_f32_16x16x32_bf16 v[92:95], v[72:75], a[96:99], v[52:55]
    ds_read_b128 v[72:75], v8 offset:25856
    v_exp_f32 v99, v99
    v_mfma_f32_16x16x32_bf16 v[92:95], v[76:79], a[100:103], v[92:95]
    ds_read_b128 v[76:79], v8 offset:25920
    v_add_f32 v22, v22, v96
    v_add_f32 v23, v23, v97
    v_mfma_f32_16x16x32_bf16 v[92:95], v[80:83], a[104:107], v[92:95]
    ds_read_b128 v[80:83], v8 offset:25984
    v_cvt_pk_bf16_f32 v108, v96, v97
    v_mfma_f32_16x16x32_bf16 v[92:95], v[84:87], a[108:111], v[92:95]
    ds_read_b128 v[84:87], v8 offset:26048
    v_exp_f32 v100, v100
    v_mfma_f32_16x16x32_bf16 v[160:163], v[112:115], v[104:107], v[160:163]
    v_exp_f32 v101, v101
    v_mfma_f32_16x16x32_bf16 v[188:191], v[116:119], v[104:107], v[188:191]
    v_add_f32 v22, v22, v98
    v_add_f32 v23, v23, v99
    v_mfma_f32_16x16x32_bf16 v[216:219], v[120:123], v[104:107], v[216:219]
    v_cvt_pk_bf16_f32 v109, v98, v99
    v_mfma_f32_16x16x32_bf16 v[244:247], v[124:127], v[104:107], v[244:247]
    v_exp_f32 v102, v102
    v_mfma_f32_16x16x32_bf16 a[128:131], v[128:131], v[104:107], a[128:131]
    v_exp_f32 v103, v103
    v_mfma_f32_16x16x32_bf16 a[156:159], v[132:135], v[104:107], a[156:159]
    v_add_f32 v22, v22, v100
    v_add_f32 v23, v23, v101
    v_mfma_f32_16x16x32_bf16 a[184:187], v[136:139], v[104:107], a[184:187]
    v_cvt_pk_bf16_f32 v110, v100, v101
    v_add_f32 v22, v22, v102
    v_mfma_f32_16x16x32_bf16 a[212:215], v[140:143], v[104:107], a[212:215]
    v_add_f32 v23, v23, v103
    v_cvt_pk_bf16_f32 v111, v102, v103
    s_waitcnt lgkmcnt(0)
    v_mfma_f32_16x16x32_bf16 v[96:99], v[56:59], a[0:3], v[28:31]
    v_mfma_f32_16x16x32_bf16 v[96:99], v[60:63], a[4:7], v[96:99]
    v_exp_f32 v88, v88
    v_mfma_f32_16x16x32_bf16 v[96:99], v[64:67], a[8:11], v[96:99]
    v_exp_f32 v89, v89
    v_mfma_f32_16x16x32_bf16 v[96:99], v[68:71], a[12:15], v[96:99]
    v_exp_f32 v90, v90
    v_mfma_f32_16x16x32_bf16 v[100:103], v[72:75], a[0:3], v[28:31]
    v_exp_f32 v91, v91
    v_mfma_f32_16x16x32_bf16 v[100:103], v[76:79], a[4:7], v[100:103]
    v_add_f32 v24, v24, v88
    v_add_f32 v25, v25, v89
    v_mfma_f32_16x16x32_bf16 v[100:103], v[80:83], a[8:11], v[100:103]
    v_cvt_pk_bf16_f32 v104, v88, v89
    v_mfma_f32_16x16x32_bf16 v[100:103], v[84:87], a[12:15], v[100:103]
    v_exp_f32 v92, v92
    v_mfma_f32_16x16x32_bf16 v[164:167], v[112:115], v[108:111], v[164:167]
    v_exp_f32 v93, v93
    v_mfma_f32_16x16x32_bf16 v[192:195], v[116:119], v[108:111], v[192:195]
    v_add_f32 v24, v24, v90
    v_add_f32 v25, v25, v91
    v_mfma_f32_16x16x32_bf16 v[220:223], v[120:123], v[108:111], v[220:223]
    v_cvt_pk_bf16_f32 v105, v90, v91
    v_mfma_f32_16x16x32_bf16 v[248:251], v[124:127], v[108:111], v[248:251]
    v_exp_f32 v94, v94
    v_mfma_f32_16x16x32_bf16 a[132:135], v[128:131], v[108:111], a[132:135]
    v_exp_f32 v95, v95
    v_mfma_f32_16x16x32_bf16 a[160:163], v[132:135], v[108:111], a[160:163]
    v_add_f32 v24, v24, v92
    v_add_f32 v25, v25, v93
    v_mfma_f32_16x16x32_bf16 a[188:191], v[136:139], v[108:111], a[188:191]
    v_cvt_pk_bf16_f32 v106, v92, v93
    v_add_f32 v24, v24, v94
    v_mfma_f32_16x16x32_bf16 a[216:219], v[140:143], v[108:111], a[216:219]
    v_add_f32 v25, v25, v95
    v_cvt_pk_bf16_f32 v107, v94, v95
    v_mfma_f32_16x16x32_bf16 v[88:91], v[56:59], a[16:19], v[32:35]
    v_mfma_f32_16x16x32_bf16 v[88:91], v[60:63], a[20:23], v[88:91]
    v_exp_f32 v96, v96
    v_mfma_f32_16x16x32_bf16 v[88:91], v[64:67], a[24:27], v[88:91]
    v_exp_f32 v97, v97
    v_mfma_f32_16x16x32_bf16 v[88:91], v[68:71], a[28:31], v[88:91]
    v_exp_f32 v98, v98
    v_mfma_f32_16x16x32_bf16 v[92:95], v[72:75], a[16:19], v[32:35]
    v_exp_f32 v99, v99
    v_mfma_f32_16x16x32_bf16 v[92:95], v[76:79], a[20:23], v[92:95]
    v_add_f32 v12, v12, v96
    v_add_f32 v13, v13, v97
    v_mfma_f32_16x16x32_bf16 v[92:95], v[80:83], a[24:27], v[92:95]
    v_cvt_pk_bf16_f32 v108, v96, v97
    v_mfma_f32_16x16x32_bf16 v[92:95], v[84:87], a[28:31], v[92:95]
    v_exp_f32 v100, v100
    v_mfma_f32_16x16x32_bf16 v[168:171], v[112:115], v[104:107], v[168:171]
    ds_read_b64_tr_b16 v[112:113], v9 offset:25344
    ds_read_b64_tr_b16 v[114:115], v9 offset:25856
    v_exp_f32 v101, v101
    v_mfma_f32_16x16x32_bf16 v[196:199], v[116:119], v[104:107], v[196:199]
    ds_read_b64_tr_b16 v[116:117], v9 offset:25376
    ds_read_b64_tr_b16 v[118:119], v9 offset:25888
    v_add_f32 v12, v12, v98
    v_add_f32 v13, v13, v99
    v_mfma_f32_16x16x32_bf16 v[224:227], v[120:123], v[104:107], v[224:227]
    ds_read_b64_tr_b16 v[120:121], v9 offset:25408
    ds_read_b64_tr_b16 v[122:123], v9 offset:25920
    v_cvt_pk_bf16_f32 v109, v98, v99
    v_mfma_f32_16x16x32_bf16 v[252:255], v[124:127], v[104:107], v[252:255]
    ds_read_b64_tr_b16 v[124:125], v9 offset:25440
    ds_read_b64_tr_b16 v[126:127], v9 offset:25952
    v_exp_f32 v102, v102
    v_mfma_f32_16x16x32_bf16 a[136:139], v[128:131], v[104:107], a[136:139]
    ds_read_b64_tr_b16 v[128:129], v9 offset:25472
    ds_read_b64_tr_b16 v[130:131], v9 offset:25984
    v_exp_f32 v103, v103
    v_mfma_f32_16x16x32_bf16 a[164:167], v[132:135], v[104:107], a[164:167]
    ds_read_b64_tr_b16 v[132:133], v9 offset:25504
    ds_read_b64_tr_b16 v[134:135], v9 offset:26016
    v_add_f32 v12, v12, v100
    v_add_f32 v13, v13, v101
    v_mfma_f32_16x16x32_bf16 a[192:195], v[136:139], v[104:107], a[192:195]
    ds_read_b64_tr_b16 v[136:137], v9 offset:25536
    ds_read_b64_tr_b16 v[138:139], v9 offset:26048
    v_cvt_pk_bf16_f32 v110, v100, v101
    v_add_f32 v12, v12, v102
    v_mfma_f32_16x16x32_bf16 a[220:223], v[140:143], v[104:107], a[220:223]
    ds_read_b64_tr_b16 v[140:141], v9 offset:25568
    ds_read_b64_tr_b16 v[142:143], v9 offset:26080
    v_add_f32 v13, v13, v103
    v_cvt_pk_bf16_f32 v111, v102, v103
    v_mfma_f32_16x16x32_bf16 v[96:99], v[56:59], a[32:35], v[36:39]
    v_mfma_f32_16x16x32_bf16 v[96:99], v[60:63], a[36:39], v[96:99]
    s_add_u32 m0, s33, 16896
    v_exp_f32 v88, v88
    v_mfma_f32_16x16x32_bf16 v[96:99], v[64:67], a[40:43], v[96:99]
    v_exp_f32 v89, v89
    v_mfma_f32_16x16x32_bf16 v[96:99], v[68:71], a[44:47], v[96:99]
    s_mov_b32 s49, s50
    v_exp_f32 v90, v90
    v_mfma_f32_16x16x32_bf16 v[100:103], v[72:75], a[32:35], v[36:39]
    v_exp_f32 v91, v91
    v_mfma_f32_16x16x32_bf16 v[100:103], v[76:79], a[36:39], v[100:103]
    s_add_u32 s50, s50, s51
    v_add_f32 v14, v14, v88
    v_add_f32 v15, v15, v89
    v_mfma_f32_16x16x32_bf16 v[100:103], v[80:83], a[40:43], v[100:103]
    v_cvt_pk_bf16_f32 v104, v88, v89
    v_mfma_f32_16x16x32_bf16 v[100:103], v[84:87], a[44:47], v[100:103]
    s_add_u32 s82, s82, 1
    v_exp_f32 v92, v92
    s_waitcnt lgkmcnt(0)
    v_mfma_f32_16x16x32_bf16 v[144:147], v[112:115], v[108:111], v[144:147]
    v_exp_f32 v93, v93
    v_mfma_f32_16x16x32_bf16 v[172:175], v[116:119], v[108:111], v[172:175]
    s_cmp_eq_u32 s82, 20
    v_add_f32 v14, v14, v90
    v_add_f32 v15, v15, v91
    v_mfma_f32_16x16x32_bf16 v[200:203], v[120:123], v[108:111], v[200:203]
    v_cvt_pk_bf16_f32 v105, v90, v91
    v_mfma_f32_16x16x32_bf16 v[228:231], v[124:127], v[108:111], v[228:231]
    s_cselect_b32 s29, s83, 0
    v_exp_f32 v94, v94
    v_mfma_f32_16x16x32_bf16 a[112:115], v[128:131], v[108:111], a[112:115]
    v_exp_f32 v95, v95
    v_mfma_f32_16x16x32_bf16 a[140:143], v[132:135], v[108:111], a[140:143]
    s_sub_u32 s50, s50, s29
    v_add_f32 v14, v14, v92
    v_add_f32 v15, v15, v93
    v_mfma_f32_16x16x32_bf16 a[168:171], v[136:139], v[108:111], a[168:171]
    v_cvt_pk_bf16_f32 v106, v92, v93
    v_add_f32 v14, v14, v94
    v_mfma_f32_16x16x32_bf16 a[196:199], v[140:143], v[108:111], a[196:199]
    s_add_u32 s28, s49, s88
    v_add_f32 v15, v15, v95
    v_cvt_pk_bf16_f32 v107, v94, v95
    v_mfma_f32_16x16x32_bf16 v[88:91], v[56:59], a[48:51], v[40:43]
    v_mfma_f32_16x16x32_bf16 v[88:91], v[60:63], a[52:55], v[88:91]
    buffer_load_dwordx4 v26, s[16:19], s28 offen lds
    v_exp_f32 v96, v96
    v_mfma_f32_16x16x32_bf16 v[88:91], v[64:67], a[56:59], v[88:91]
    v_exp_f32 v97, v97
    v_mfma_f32_16x16x32_bf16 v[88:91], v[68:71], a[60:63], v[88:91]
    s_add_u32 m0, m0, s53
    v_exp_f32 v98, v98
    v_mfma_f32_16x16x32_bf16 v[92:95], v[72:75], a[48:51], v[40:43]
    v_exp_f32 v99, v99
    v_mfma_f32_16x16x32_bf16 v[92:95], v[76:79], a[52:55], v[92:95]
    s_add_u32 s28, s49, s89
    v_add_f32 v16, v16, v96
    v_add_f32 v17, v17, v97
    v_mfma_f32_16x16x32_bf16 v[92:95], v[80:83], a[56:59], v[92:95]
    v_cvt_pk_bf16_f32 v108, v96, v97
    v_mfma_f32_16x16x32_bf16 v[92:95], v[84:87], a[60:63], v[92:95]
    buffer_load_dwordx4 v26, s[16:19], s28 offen lds
    v_exp_f32 v100, v100
    v_mfma_f32_16x16x32_bf16 v[148:151], v[112:115], v[104:107], v[148:151]
    v_exp_f32 v101, v101
    v_mfma_f32_16x16x32_bf16 v[176:179], v[116:119], v[104:107], v[176:179]
    s_add_u32 m0, m0, s53
    v_add_f32 v16, v16, v98
    v_add_f32 v17, v17, v99
    v_mfma_f32_16x16x32_bf16 v[204:207], v[120:123], v[104:107], v[204:207]
    v_cvt_pk_bf16_f32 v109, v98, v99
    v_mfma_f32_16x16x32_bf16 v[232:235], v[124:127], v[104:107], v[232:235]
    s_add_u32 s28, s49, s90
    v_exp_f32 v102, v102
    v_mfma_f32_16x16x32_bf16 a[116:119], v[128:131], v[104:107], a[116:119]
    v_exp_f32 v103, v103
    v_mfma_f32_16x16x32_bf16 a[144:147], v[132:135], v[104:107], a[144:147]
    buffer_load_dwordx4 v26, s[16:19], s28 offen lds
    v_add_f32 v16, v16, v100
    v_add_f32 v17, v17, v101
    v_mfma_f32_16x16x32_bf16 a[172:175], v[136:139], v[104:107], a[172:175]
    v_cvt_pk_bf16_f32 v110, v100, v101
    v_add_f32 v16, v16, v102
    v_mfma_f32_16x16x32_bf16 a[200:203], v[140:143], v[104:107], a[200:203]
    s_add_u32 m0, m0, s53
    v_add_f32 v17, v17, v103
    v_cvt_pk_bf16_f32 v111, v102, v103
    v_mfma_f32_16x16x32_bf16 v[96:99], v[56:59], a[64:67], v[44:47]
    v_mfma_f32_16x16x32_bf16 v[96:99], v[60:63], a[68:71], v[96:99]
    s_add_u32 s28, s49, s91
    v_exp_f32 v88, v88
    v_mfma_f32_16x16x32_bf16 v[96:99], v[64:67], a[72:75], v[96:99]
    v_exp_f32 v89, v89
    v_mfma_f32_16x16x32_bf16 v[96:99], v[68:71], a[76:79], v[96:99]
    buffer_load_dwordx4 v26, s[16:19], s28 offen lds
    v_exp_f32 v90, v90
    v_mfma_f32_16x16x32_bf16 v[100:103], v[72:75], a[64:67], v[44:47]
    v_exp_f32 v91, v91
    v_mfma_f32_16x16x32_bf16 v[100:103], v[76:79], a[68:71], v[100:103]
    s_add_u32 m0, m0, s53
    v_add_f32 v18, v18, v88
    v_add_f32 v19, v19, v89
    v_mfma_f32_16x16x32_bf16 v[100:103], v[80:83], a[72:75], v[100:103]
    v_cvt_pk_bf16_f32 v104, v88, v89
    v_mfma_f32_16x16x32_bf16 v[100:103], v[84:87], a[76:79], v[100:103]
    s_add_u32 s28, s49, s92
    v_exp_f32 v92, v92
    v_mfma_f32_16x16x32_bf16 v[152:155], v[112:115], v[108:111], v[152:155]
    v_exp_f32 v93, v93
    v_mfma_f32_16x16x32_bf16 v[180:183], v[116:119], v[108:111], v[180:183]
    buffer_load_dwordx4 v26, s[16:19], s28 offen lds
    v_add_f32 v18, v18, v90
    v_add_f32 v19, v19, v91
    v_mfma_f32_16x16x32_bf16 v[208:211], v[120:123], v[108:111], v[208:211]
    v_cvt_pk_bf16_f32 v105, v90, v91
    v_mfma_f32_16x16x32_bf16 v[236:239], v[124:127], v[108:111], v[236:239]
    s_add_u32 m0, m0, s53
    v_exp_f32 v94, v94
    v_mfma_f32_16x16x32_bf16 a[120:123], v[128:131], v[108:111], a[120:123]
    v_exp_f32 v95, v95
    v_mfma_f32_16x16x32_bf16 a[148:151], v[132:135], v[108:111], a[148:151]
    s_add_u32 s28, s49, s93
    v_add_f32 v18, v18, v92
    v_add_f32 v19, v19, v93
    v_mfma_f32_16x16x32_bf16 a[176:179], v[136:139], v[108:111], a[176:179]
    v_cvt_pk_bf16_f32 v106, v92, v93
    v_add_f32 v18, v18, v94
    v_mfma_f32_16x16x32_bf16 a[204:207], v[140:143], v[108:111], a[204:207]
    buffer_load_dwordx4 v26, s[16:19], s28 offen lds
    v_add_f32 v19, v19, v95
    v_cvt_pk_bf16_f32 v107, v94, v95
    v_mfma_f32_16x16x32_bf16 v[88:91], v[56:59], a[80:83], v[48:51]
    v_mfma_f32_16x16x32_bf16 v[88:91], v[60:63], a[84:87], v[88:91]
    s_add_u32 m0, m0, s53
    v_exp_f32 v96, v96
    v_mfma_f32_16x16x32_bf16 v[88:91], v[64:67], a[88:91], v[88:91]
    v_exp_f32 v97, v97
    v_mfma_f32_16x16x32_bf16 v[88:91], v[68:71], a[92:95], v[88:91]
    s_add_u32 s28, s49, s94
    v_exp_f32 v98, v98
    v_mfma_f32_16x16x32_bf16 v[92:95], v[72:75], a[80:83], v[48:51]
    v_exp_f32 v99, v99
    v_mfma_f32_16x16x32_bf16 v[92:95], v[76:79], a[84:87], v[92:95]
    buffer_load_dwordx4 v26, s[16:19], s28 offen lds
    v_add_f32 v20, v20, v96
    v_add_f32 v21, v21, v97
    v_mfma_f32_16x16x32_bf16 v[92:95], v[80:83], a[88:91], v[92:95]
    v_cvt_pk_bf16_f32 v108, v96, v97
    v_mfma_f32_16x16x32_bf16 v[92:95], v[84:87], a[92:95], v[92:95]
    s_add_u32 m0, m0, s53
    v_exp_f32 v100, v100
    v_mfma_f32_16x16x32_bf16 v[156:159], v[112:115], v[104:107], v[156:159]
    v_exp_f32 v101, v101
    v_mfma_f32_16x16x32_bf16 v[184:187], v[116:119], v[104:107], v[184:187]
    s_add_u32 s28, s49, s95
    v_add_f32 v20, v20, v98
    v_add_f32 v21, v21, v99
    v_mfma_f32_16x16x32_bf16 v[212:215], v[120:123], v[104:107], v[212:215]
    v_cvt_pk_bf16_f32 v109, v98, v99
    v_mfma_f32_16x16x32_bf16 v[240:243], v[124:127], v[104:107], v[240:243]
    buffer_load_dwordx4 v26, s[16:19], s28 offen lds
    v_exp_f32 v102, v102
    v_mfma_f32_16x16x32_bf16 a[124:127], v[128:131], v[104:107], a[124:127]
    v_exp_f32 v103, v103
    v_mfma_f32_16x16x32_bf16 a[152:155], v[132:135], v[104:107], a[152:155]
    v_add_f32 v20, v20, v100
    v_add_f32 v21, v21, v101
    v_mfma_f32_16x16x32_bf16 a[180:183], v[136:139], v[104:107], a[180:183]
    v_cvt_pk_bf16_f32 v110, v100, v101
    v_add_f32 v20, v20, v102
    v_mfma_f32_16x16x32_bf16 a[208:211], v[140:143], v[104:107], a[208:211]
    v_add_f32 v21, v21, v103
    v_cvt_pk_bf16_f32 v111, v102, v103
    s_waitcnt vmcnt(16) lgkmcnt(0)
    s_barrier
    v_mfma_f32_16x16x32_bf16 v[96:99], v[56:59], a[96:99], v[52:55]
    s_add_u32 m0, s33, 25344
    v_mfma_f32_16x16x32_bf16 v[96:99], v[60:63], a[100:103], v[96:99]
    s_mov_b32 s49, s50
    v_exp_f32 v88, v88
    v_mfma_f32_16x16x32_bf16 v[96:99], v[64:67], a[104:107], v[96:99]
    s_add_u32 s50, s50, s51
    v_exp_f32 v89, v89
    v_mfma_f32_16x16x32_bf16 v[96:99], v[68:71], a[108:111], v[96:99]
    s_add_u32 s82, s82, 1
    v_exp_f32 v90, v90
    v_mfma_f32_16x16x32_bf16 v[100:103], v[72:75], a[96:99], v[52:55]
    s_cmp_eq_u32 s82, 20
    v_exp_f32 v91, v91
    v_mfma_f32_16x16x32_bf16 v[100:103], v[76:79], a[100:103], v[100:103]
    s_cselect_b32 s29, s83, 0
    v_add_f32 v22, v22, v88
    v_add_f32 v23, v23, v89
    v_mfma_f32_16x16x32_bf16 v[100:103], v[80:83], a[104:107], v[100:103]
    s_sub_u32 s50, s50, s29
    v_cvt_pk_bf16_f32 v104, v88, v89
    v_mfma_f32_16x16x32_bf16 v[100:103], v[84:87], a[108:111], v[100:103]
    v_exp_f32 v92, v92
    v_mfma_f32_16x16x32_bf16 v[160:163], v[112:115], v[108:111], v[160:163]
    s_add_u32 s28, s49, s88
    v_exp_f32 v93, v93
    v_mfma_f32_16x16x32_bf16 v[188:191], v[116:119], v[108:111], v[188:191]
    buffer_load_dwordx4 v26, s[16:19], s28 offen lds
    v_add_f32 v22, v22, v90
    v_add_f32 v23, v23, v91
    v_mfma_f32_16x16x32_bf16 v[216:219], v[120:123], v[108:111], v[216:219]
    s_add_u32 m0, m0, s53
    v_cvt_pk_bf16_f32 v105, v90, v91
    v_mfma_f32_16x16x32_bf16 v[244:247], v[124:127], v[108:111], v[244:247]
    s_add_u32 s28, s49, s89
    v_exp_f32 v94, v94
    v_mfma_f32_16x16x32_bf16 a[128:131], v[128:131], v[108:111], a[128:131]
    buffer_load_dwordx4 v26, s[16:19], s28 offen lds
    v_exp_f32 v95, v95
    v_mfma_f32_16x16x32_bf16 a[156:159], v[132:135], v[108:111], a[156:159]
    s_add_u32 m0, m0, s53
    v_add_f32 v22, v22, v92
    v_add_f32 v23, v23, v93
    v_mfma_f32_16x16x32_bf16 a[184:187], v[136:139], v[108:111], a[184:187]
    s_add_u32 s28, s49, s90
    v_cvt_pk_bf16_f32 v106, v92, v93
    v_add_f32 v22, v22, v94
    v_mfma_f32_16x16x32_bf16 a[212:215], v[140:143], v[108:111], a[212:215]
    buffer_load_dwordx4 v26, s[16:19], s28 offen lds
    v_add_f32 v23, v23, v95
    v_cvt_pk_bf16_f32 v107, v94, v95
    s_nop 1
    v_mfma_f32_16x16x32_bf16 v[164:167], v[112:115], v[104:107], v[164:167]
    s_add_u32 m0, m0, s53
    s_add_u32 s28, s49, s91
    v_exp_f32 v96, v96
    v_mfma_f32_16x16x32_bf16 v[192:195], v[116:119], v[104:107], v[192:195]
    buffer_load_dwordx4 v26, s[16:19], s28 offen lds
    s_add_u32 m0, m0, s53
    v_exp_f32 v97, v97
    v_exp_f32 v98, v98
    v_mfma_f32_16x16x32_bf16 v[220:223], v[120:123], v[104:107], v[220:223]
    s_add_u32 s28, s49, s92
    buffer_load_dwordx4 v26, s[16:19], s28 offen lds
    v_exp_f32 v99, v99
    v_add_f32 v24, v24, v96
    v_add_f32 v25, v25, v97
    v_mfma_f32_16x16x32_bf16 v[248:251], v[124:127], v[104:107], v[248:251]
    s_add_u32 m0, m0, s53
    v_cvt_pk_bf16_f32 v108, v96, v97
    v_exp_f32 v100, v100
    v_mfma_f32_16x16x32_bf16 a[132:135], v[128:131], v[104:107], a[132:135]
    s_add_u32 s28, s49, s93
    buffer_load_dwordx4 v26, s[16:19], s28 offen lds
    v_exp_f32 v101, v101
    v_add_f32 v24, v24, v98
    v_add_f32 v25, v25, v99
    v_mfma_f32_16x16x32_bf16 a[160:163], v[132:135], v[104:107], a[160:163]
    s_add_u32 m0, m0, s53
    s_add_u32 s28, s49, s94
    v_cvt_pk_bf16_f32 v109, v98, v99
    v_exp_f32 v102, v102
    v_mfma_f32_16x16x32_bf16 a[188:191], v[136:139], v[104:107], a[188:191]
    buffer_load_dwordx4 v26, s[16:19], s28 offen lds
    s_add_u32 m0, m0, s53
    v_exp_f32 v103, v103
    v_add_f32 v24, v24, v100
    v_add_f32 v25, v25, v101
    v_mfma_f32_16x16x32_bf16 a[216:219], v[140:143], v[104:107], a[216:219]
    s_add_u32 s28, s49, s95
    buffer_load_dwordx4 v26, s[16:19], s28 offen lds
    v_cvt_pk_bf16_f32 v110, v100, v101
    v_add_f32 v24, v24, v102
    v_add_f32 v25, v25, v103
    v_cvt_pk_bf16_f32 v111, v102, v103
    s_branch L_at_aepi
L_at_atailB:
    v_mfma_f32_16x16x32_bf16 v[88:91], v[56:59], a[16:19], v[32:35]
    v_mfma_f32_16x16x32_bf16 v[88:91], v[60:63], a[20:23], v[88:91]
    v_exp_f32 v96, v96
    v_mfma_f32_16x16x32_bf16 v[88:91], v[64:67], a[24:27], v[88:91]
    v_exp_f32 v97, v97
    v_mfma_f32_16x16x32_bf16 v[88:91], v[68:71], a[28:31], v[88:91]
    v_exp_f32 v98, v98
    v_mfma_f32_16x16x32_bf16 v[92:95], v[72:75], a[16:19], v[32:35]
    v_exp_f32 v99, v99
    v_mfma_f32_16x16x32_bf16 v[92:95], v[76:79], a[20:23], v[92:95]
    v_add_f32 v12, v12, v96
    v_add_f32 v13, v13, v97
    v_mfma_f32_16x16x32_bf16 v[92:95], v[80:83], a[24:27], v[92:95]
    v_cvt_pk_bf16_f32 v108, v96, v97
    v_mfma_f32_16x16x32_bf16 v[92:95], v[84:87], a[28:31], v[92:95]
    v_exp_f32 v100, v100
    v_mfma_f32_16x16x32_bf16 v[168:171], v[112:115], v[104:107], v[168:171]
    ds_read_b64_tr_b16 v[112:113], v9 offset:8448
    ds_read_b64_tr_b16 v[114:115], v9 offset:8960
    v_exp_f32 v101, v101
    v_mfma_f32_16x16x32_bf16 v[196:199], v[116:119], v[104:107], v[196:199]
    ds_read_b64_tr_b16 v[116:117], v9 offset:8480
    ds_read_b64_tr_b16 v[118:119], v9 offset:8992
    v_add_f32 v12, v12, v98
    v_add_f32 v13, v13, v99
    v_mfma_f32_16x16x32_bf16 v[224:227], v[120:123], v[104:107], v[224:227]
    ds_read_b64_tr_b16 v[120:121], v9 offset:8512
    ds_read_b64_tr_b16 v[122:123], v9 offset:9024
    v_cvt_pk_bf16_f32 v109, v98, v99
    v_mfma_f32_16x16x32_bf16 v[252:255], v[124:127], v[104:107], v[252:255]
    ds_read_b64_tr_b16 v[124:125], v9 offset:8544
    ds_read_b64_tr_b16 v[126:127], v9 offset:9056
    v_exp_f32 v102, v102
    v_mfma_f32_16x16x32_bf16 a[136:139], v[128:131], v[104:107], a[136:139]
    ds_read_b64_tr_b16 v[128:129], v9 offset:8576
    ds_read_b64_tr_b16 v[130:131], v9 offset:9088
    v_exp_f32 v103, v103
    v_mfma_f32_16x16x32_bf16 a[164:167], v[132:135], v[104:107], a[164:167]
    ds_read_b64_tr_b16 v[132:133], v9 offset:8608
    ds_read_b64_tr_b16 v[134:135], v9 offset:9120
    v_add_f32 v12, v12, v100
    v_add_f32 v13, v13, v101
    v_mfma_f32_16x16x32_bf16 a[192:195], v[136:139], v[104:107], a[192:195]
    ds_read_b64_tr_b16 v[136:137], v9 offset:8640
    ds_read_b64_tr_b16 v[138:139], v9 offset:9152
    v_cvt_pk_bf16_f32 v110, v100, v101
    v_add_f32 v12, v12, v102
    v_mfma_f32_16x16x32_bf16 a[220:223], v[140:143], v[104:107], a[220:223]
    ds_read_b64_tr_b16 v[140:141], v9 offset:8672
    ds_read_b64_tr_b16 v[142:143], v9 offset:9184
    v_add_f32 v13, v13, v103
    v_cvt_pk_bf16_f32 v111, v102, v103
    v_mfma_f32_16x16x32_bf16 v[96:99], v[56:59], a[32:35], v[36:39]
    v_mfma_f32_16x16x32_bf16 v[96:99], v[60:63], a[36:39], v[96:99]
    s_add_u32 s29, s34, s100
    v_exp_f32 v88, v88
    v_mfma_f32_16x16x32_bf16 v[96:99], v[64:67], a[40:43], v[96:99]
    v_exp_f32 v89, v89
    v_mfma_f32_16x16x32_bf16 v[96:99], v[68:71], a[44:47], v[96:99]
    s_bfe_u32 s28, s29, 0x20003
    v_exp_f32 v90, v90
    v_mfma_f32_16x16x32_bf16 v[100:103], v[72:75], a[32:35], v[36:39]
    v_exp_f32 v91, v91
    v_mfma_f32_16x16x32_bf16 v[100:103], v[76:79], a[36:39], v[100:103]
    s_lshl_b32 s28, s28, 16
    v_add_f32 v14, v14, v88
    v_add_f32 v15, v15, v89
    v_mfma_f32_16x16x32_bf16 v[100:103], v[80:83], a[40:43], v[100:103]
    v_cvt_pk_bf16_f32 v104, v88, v89
    v_mfma_f32_16x16x32_bf16 v[100:103], v[84:87], a[44:47], v[100:103]
    v_exp_f32 v92, v92
    s_waitcnt lgkmcnt(0)
    v_mfma_f32_16x16x32_bf16 v[144:147], v[112:115], v[108:111], v[144:147]
    s_and_b32 s29, s29, 7
    v_exp_f32 v93, v93
    v_mfma_f32_16x16x32_bf16 v[172:175], v[116:119], v[108:111], v[172:175]
    v_add_f32 v14, v14, v90
    v_add_f32 v15, v15, v91
    v_mfma_f32_16x16x32_bf16 v[200:203], v[120:123], v[108:111], v[200:203]
    s_lshl_b32 s29, s29, 11
    v_cvt_pk_bf16_f32 v105, v90, v91
    v_mfma_f32_16x16x32_bf16 v[228:231], v[124:127], v[108:111], v[228:231]
    v_exp_f32 v94, v94
    v_mfma_f32_16x16x32_bf16 a[112:115], v[128:131], v[108:111], a[112:115]
    s_add_u32 s29, s28, s29
    v_exp_f32 v95, v95
    v_mfma_f32_16x16x32_bf16 a[140:143], v[132:135], v[108:111], a[140:143]
    v_add_f32 v14, v14, v92
    v_add_f32 v15, v15, v93
    v_mfma_f32_16x16x32_bf16 a[168:171], v[136:139], v[108:111], a[168:171]
    s_lshr_b32 s28, s34, 5
    v_cvt_pk_bf16_f32 v106, v92, v93
    v_add_f32 v14, v14, v94
    v_mfma_f32_16x16x32_bf16 a[196:199], v[140:143], v[108:111], a[196:199]
    v_add_f32 v15, v15, v95
    v_cvt_pk_bf16_f32 v107, v94, v95
    v_mfma_f32_16x16x32_bf16 v[88:91], v[56:59], a[48:51], v[40:43]
    v_mfma_f32_16x16x32_bf16 v[88:91], v[60:63], a[52:55], v[88:91]
    s_lshl_b32 s28, s28, 19
    v_exp_f32 v96, v96
    v_mfma_f32_16x16x32_bf16 v[88:91], v[64:67], a[56:59], v[88:91]
    v_exp_f32 v97, v97
    v_mfma_f32_16x16x32_bf16 v[88:91], v[68:71], a[60:63], v[88:91]
    s_add_u32 s49, s28, s29
    v_exp_f32 v98, v98
    v_mfma_f32_16x16x32_bf16 v[92:95], v[72:75], a[48:51], v[40:43]
    v_exp_f32 v99, v99
    v_mfma_f32_16x16x32_bf16 v[92:95], v[76:79], a[52:55], v[92:95]
    s_add_u32 m0, s33, 0
    v_add_f32 v16, v16, v96
    v_add_f32 v17, v17, v97
    v_mfma_f32_16x16x32_bf16 v[92:95], v[80:83], a[56:59], v[92:95]
    v_cvt_pk_bf16_f32 v108, v96, v97
    v_mfma_f32_16x16x32_bf16 v[92:95], v[84:87], a[60:63], v[92:95]
    v_exp_f32 v100, v100
    v_mfma_f32_16x16x32_bf16 v[148:151], v[112:115], v[104:107], v[148:151]
    s_add_u32 s34, s34, 1
    v_exp_f32 v101, v101
    v_mfma_f32_16x16x32_bf16 v[176:179], v[116:119], v[104:107], v[176:179]
    v_add_f32 v16, v16, v98
    v_add_f32 v17, v17, v99
    v_mfma_f32_16x16x32_bf16 v[204:207], v[120:123], v[104:107], v[204:207]
    buffer_load_dwordx4 v7, s[4:7], s49 offen offset:0 nt lds
    v_cvt_pk_bf16_f32 v109, v98, v99
    v_mfma_f32_16x16x32_bf16 v[232:235], v[124:127], v[104:107], v[232:235]
    v_exp_f32 v102, v102
    v_mfma_f32_16x16x32_bf16 a[116:119], v[128:131], v[104:107], a[116:119]
    s_add_u32 m0, m0, s96
    v_exp_f32 v103, v103
    v_mfma_f32_16x16x32_bf16 a[144:147], v[132:135], v[104:107], a[144:147]
    v_add_f32 v16, v16, v100
    v_add_f32 v17, v17, v101
    v_mfma_f32_16x16x32_bf16 a[172:175], v[136:139], v[104:107], a[172:175]
    buffer_load_dwordx4 v7, s[4:7], s49 offen offset:256 nt lds
    v_cvt_pk_bf16_f32 v110, v100, v101
    v_add_f32 v16, v16, v102
    v_mfma_f32_16x16x32_bf16 a[200:203], v[140:143], v[104:107], a[200:203]
    v_add_f32 v17, v17, v103
    v_cvt_pk_bf16_f32 v111, v102, v103
    v_mfma_f32_16x16x32_bf16 v[96:99], v[56:59], a[64:67], v[44:47]
    v_mfma_f32_16x16x32_bf16 v[96:99], v[60:63], a[68:71], v[96:99]
    s_add_u32 m0, m0, s97
    v_exp_f32 v88, v88
    v_mfma_f32_16x16x32_bf16 v[96:99], v[64:67], a[72:75], v[96:99]
    v_exp_f32 v89, v89
    v_mfma_f32_16x16x32_bf16 v[96:99], v[68:71], a[76:79], v[96:99]
    buffer_load_dwordx4 v7, s[4:7], s49 offen offset:512 nt lds
    v_exp_f32 v90, v90
    v_mfma_f32_16x16x32_bf16 v[100:103], v[72:75], a[64:67], v[44:47]
    v_exp_f32 v91, v91
    v_mfma_f32_16x16x32_bf16 v[100:103], v[76:79], a[68:71], v[100:103]
    s_add_u32 m0, m0, s96
    v_add_f32 v18, v18, v88
    v_add_f32 v19, v19, v89
    v_mfma_f32_16x16x32_bf16 v[100:103], v[80:83], a[72:75], v[100:103]
    v_cvt_pk_bf16_f32 v104, v88, v89
    v_mfma_f32_16x16x32_bf16 v[100:103], v[84:87], a[76:79], v[100:103]
    v_exp_f32 v92, v92
    v_mfma_f32_16x16x32_bf16 v[152:155], v[112:115], v[108:111], v[152:155]
    buffer_load_dwordx4 v7, s[4:7], s49 offen offset:768 nt lds
    v_exp_f32 v93, v93
    v_mfma_f32_16x16x32_bf16 v[180:183], v[116:119], v[108:111], v[180:183]
    v_add_f32 v18, v18, v90
    v_add_f32 v19, v19, v91
    v_mfma_f32_16x16x32_bf16 v[208:211], v[120:123], v[108:111], v[208:211]
    s_add_u32 m0, m0, s97
    v_cvt_pk_bf16_f32 v105, v90, v91
    v_mfma_f32_16x16x32_bf16 v[236:239], v[124:127], v[108:111], v[236:239]
    v_exp_f32 v94, v94
    v_mfma_f32_16x16x32_bf16 a[120:123], v[128:131], v[108:111], a[120:123]
    buffer_load_dwordx4 v7, s[4:7], s49 offen offset:1024 nt lds
    v_exp_f32 v95, v95
    v_mfma_f32_16x16x32_bf16 a[148:151], v[132:135], v[108:111], a[148:151]
    v_add_f32 v18, v18, v92
    v_add_f32 v19, v19, v93
    v_mfma_f32_16x16x32_bf16 a[176:179], v[136:139], v[108:111], a[176:179]
    s_add_u32 m0, m0, s96
    v_cvt_pk_bf16_f32 v106, v92, v93
    v_add_f32 v18, v18, v94
    v_mfma_f32_16x16x32_bf16 a[204:207], v[140:143], v[108:111], a[204:207]
    v_add_f32 v19, v19, v95
    v_cvt_pk_bf16_f32 v107, v94, v95
    v_mfma_f32_16x16x32_bf16 v[88:91], v[56:59], a[80:83], v[48:51]
    v_mfma_f32_16x16x32_bf16 v[88:91], v[60:63], a[84:87], v[88:91]
    buffer_load_dwordx4 v7, s[4:7], s49 offen offset:1280 nt lds
    v_exp_f32 v96, v96
    v_mfma_f32_16x16x32_bf16 v[88:91], v[64:67], a[88:91], v[88:91]
    v_exp_f32 v97, v97
    v_mfma_f32_16x16x32_bf16 v[88:91], v[68:71], a[92:95], v[88:91]
    s_add_u32 m0, m0, s97
    v_exp_f32 v98, v98
    v_mfma_f32_16x16x32_bf16 v[92:95], v[72:75], a[80:83], v[48:51]
    v_exp_f32 v99, v99
    v_mfma_f32_16x16x32_bf16 v[92:95], v[76:79], a[84:87], v[92:95]
    buffer_load_dwordx4 v7, s[4:7], s49 offen offset:1536 nt lds
    v_add_f32 v20, v20, v96
    v_add_f32 v21, v21, v97
    v_mfma_f32_16x16x32_bf16 v[92:95], v[80:83], a[88:91], v[92:95]
    v_cvt_pk_bf16_f32 v108, v96, v97
    v_mfma_f32_16x16x32_bf16 v[92:95], v[84:87], a[92:95], v[92:95]
    v_exp_f32 v100, v100
    v_mfma_f32_16x16x32_bf16 v[156:159], v[112:115], v[104:107], v[156:159]
    s_add_u32 m0, m0, s96
    v_exp_f32 v101, v101
    v_mfma_f32_16x16x32_bf16 v[184:187], v[116:119], v[104:107], v[184:187]
    v_add_f32 v20, v20, v98
    v_add_f32 v21, v21, v99
    v_mfma_f32_16x16x32_bf16 v[212:215], v[120:123], v[104:107], v[212:215]
    buffer_load_dwordx4 v7, s[4:7], s49 offen offset:1792 nt lds
    v_cvt_pk_bf16_f32 v109, v98, v99
    v_mfma_f32_16x16x32_bf16 v[240:243], v[124:127], v[104:107], v[240:243]
    v_exp_f32 v102, v102
    v_mfma_f32_16x16x32_bf16 a[124:127], v[128:131], v[104:107], a[124:127]
    v_exp_f32 v103, v103
    v_mfma_f32_16x16x32_bf16 a[152:155], v[132:135], v[104:107], a[152:155]
    v_add_f32 v20, v20, v100
    v_add_f32 v21, v21, v101
    v_mfma_f32_16x16x32_bf16 a[180:183], v[136:139], v[104:107], a[180:183]
    v_cvt_pk_bf16_f32 v110, v100, v101
    v_add_f32 v20, v20, v102
    v_mfma_f32_16x16x32_bf16 a[208:211], v[140:143], v[104:107], a[208:211]
    v_add_f32 v21, v21, v103
    v_cvt_pk_bf16_f32 v111, v102, v103
    s_waitcnt vmcnt(16) lgkmcnt(0)
    s_barrier
    v_mfma_f32_16x16x32_bf16 v[96:99], v[56:59], a[96:99], v[52:55]
    ds_read_b128 v[56:59], v8 offset:16896
    v_mfma_f32_16x16x32_bf16 v[96:99], v[60:63], a[100:103], v[96:99]
    ds_read_b128 v[60:63], v8 offset:16960
    v_exp_f32 v88, v88
    v_mfma_f32_16x16x32_bf16 v[96:99], v[64:67], a[104:107], v[96:99]
    ds_read_b128 v[64:67], v8 offset:17024
    v_exp_f32 v89, v89
    v_mfma_f32_16x16x32_bf16 v[96:99], v[68:71], a[108:111], v[96:99]
    ds_read_b128 v[68:71], v8 offset:17088
    v_exp_f32 v90, v90
    v_mfma_f32_16x16x32_bf16 v[100:103], v[72:75], a[96:99], v[52:55]
    ds_read_b128 v[72:75], v8 offset:17408
    v_exp_f32 v91, v91
    v_mfma_f32_16x16x32_bf16 v[100:103], v[76:79], a[100:103], v[100:103]
    ds_read_b128 v[76:79], v8 offset:17472
    v_add_f32 v22, v22, v88
    v_add_f32 v23, v23, v89
    v_mfma_f32_16x16x32_bf16 v[100:103], v[80:83], a[104:107], v[100:103]
    ds_read_b128 v[80:83], v8 offset:17536
    v_cvt_pk_bf16_f32 v104, v88, v89
    v_mfma_f32_16x16x32_bf16 v[100:103], v[84:87], a[108:111], v[100:103]
    ds_read_b128 v[84:87], v8 offset:17600
    v_exp_f32 v92, v92
    v_mfma_f32_16x16x32_bf16 v[160:163], v[112:115], v[108:111], v[160:163]
    v_exp_f32 v93, v93
    v_mfma_f32_16x16x32_bf16 v[188:191], v[116:119], v[108:111], v[188:191]
    v_add_f32 v22, v22, v90
    v_add_f32 v23, v23, v91
    v_mfma_f32_16x16x32_bf16 v[216:219], v[120:123], v[108:111], v[216:219]
    v_cvt_pk_bf16_f32 v105, v90, v91
    v_mfma_f32_16x16x32_bf16 v[244:247], v[124:127], v[108:111], v[244:247]
    v_exp_f32 v94, v94
    v_mfma_f32_16x16x32_bf16 a[128:131], v[128:131], v[108:111], a[128:131]
    v_exp_f32 v95, v95
    v_mfma_f32_16x16x32_bf16 a[156:159], v[132:135], v[108:111], a[156:159]
    v_add_f32 v22, v22, v92
    v_add_f32 v23, v23, v93
    v_mfma_f32_16x16x32_bf16 a[184:187], v[136:139], v[108:111], a[184:187]
    v_cvt_pk_bf16_f32 v106, v92, v93
    v_add_f32 v22, v22, v94
    v_mfma_f32_16x16x32_bf16 a[212:215], v[140:143], v[108:111], a[212:215]
    v_add_f32 v23, v23, v95
    v_cvt_pk_bf16_f32 v107, v94, v95
    s_waitcnt lgkmcnt(0)
    v_mfma_f32_16x16x32_bf16 v[88:91], v[56:59], a[0:3], v[28:31]
    v_mfma_f32_16x16x32_bf16 v[88:91], v[60:63], a[4:7], v[88:91]
    v_exp_f32 v96, v96
    v_mfma_f32_16x16x32_bf16 v[88:91], v[64:67], a[8:11], v[88:91]
    v_exp_f32 v97, v97
    v_mfma_f32_16x16x32_bf16 v[88:91], v[68:71], a[12:15], v[88:91]
    v_exp_f32 v98, v98
    v_mfma_f32_16x16x32_bf16 v[92:95], v[72:75], a[0:3], v[28:31]
    v_exp_f32 v99, v99
    v_mfma_f32_16x16x32_bf16 v[92:95], v[76:79], a[4:7], v[92:95]
    v_add_f32 v24, v24, v96
    v_add_f32 v25, v25, v97
    v_mfma_f32_16x16x32_bf16 v[92:95], v[80:83], a[8:11], v[92:95]
    v_cvt_pk_bf16_f32 v108, v96, v97
    v_mfma_f32_16x16x32_bf16 v[92:95], v[84:87], a[12:15], v[92:95]
    v_exp_f32 v100, v100
    v_mfma_f32_16x16x32_bf16 v[164:167], v[112:115], v[104:107], v[164:167]
    v_exp_f32 v101, v101
    v_mfma_f32_16x16x32_bf16 v[192:195], v[116:119], v[104:107], v[192:195]
    v_add_f32 v24, v24, v98
    v_add_f32 v25, v25, v99
    v_mfma_f32_16x16x32_bf16 v[220:223], v[120:123], v[104:107], v[220:223]
    v_cvt_pk_bf16_f32 v109, v98, v99
    v_mfma_f32_16x16x32_bf16 v[248:251], v[124:127], v[104:107], v[248:251]
    v_exp_f32 v102, v102
    v_mfma_f32_16x16x32_bf16 a[132:135], v[128:131], v[104:107], a[132:135]
    v_exp_f32 v103, v103
    v_mfma_f32_16x16x32_bf16 a[160:163], v[132:135], v[104:107], a[160:163]
    v_add_f32 v24, v24, v100
    v_add_f32 v25, v25, v101
    v_mfma_f32_16x16x32_bf16 a[188:191], v[136:139], v[104:107], a[188:191]
    v_cvt_pk_bf16_f32 v110, v100, v101
    v_add_f32 v24, v24, v102
    v_mfma_f32_16x16x32_bf16 a[216:219], v[140:143], v[104:107], a[216:219]
    v_add_f32 v25, v25, v103
    v_cvt_pk_bf16_f32 v111, v102, v103
    v_mfma_f32_16x16x32_bf16 v[96:99], v[56:59], a[16:19], v[32:35]
    v_mfma_f32_16x16x32_bf16 v[96:99], v[60:63], a[20:23], v[96:99]
    v_exp_f32 v88, v88
    v_mfma_f32_16x16x32_bf16 v[96:99], v[64:67], a[24:27], v[96:99]
    v_exp_f32 v89, v89
    v_mfma_f32_16x16x32_bf16 v[96:99], v[68:71], a[28:31], v[96:99]
    v_exp_f32 v90, v90
    v_mfma_f32_16x16x32_bf16 v[100:103], v[72:75], a[16:19], v[32:35]
    v_exp_f32 v91, v91
    v_mfma_f32_16x16x32_bf16 v[100:103], v[76:79], a[20:23], v[100:103]
    v_add_f32 v12, v12, v88
    v_add_f32 v13, v13, v89
    v_mfma_f32_16x16x32_bf16 v[100:103], v[80:83], a[24:27], v[100:103]
    v_cvt_pk_bf16_f32 v104, v88, v89
    v_mfma_f32_16x16x32_bf16 v[100:103], v[84:87], a[28:31], v[100:103]
    v_exp_f32 v92, v92
    v_mfma_f32_16x16x32_bf16 v[168:171], v[112:115], v[108:111], v[168:171]
    ds_read_b64_tr_b16 v[112:113], v9 offset:16896
    ds_read_b64_tr_b16 v[114:115], v9 offset:17408
    v_exp_f32 v93, v93
    v_mfma_f32_16x16x32_bf16 v[196:199], v[116:119], v[108:111], v[196:199]
    ds_read_b64_tr_b16 v[116:117], v9 offset:16928
    ds_read_b64_tr_b16 v[118:119], v9 offset:17440
    v_add_f32 v12, v12, v90
    v_add_f32 v13, v13, v91
    v_mfma_f32_16x16x32_bf16 v[224:227], v[120:123], v[108:111], v[224:227]
    ds_read_b64_tr_b16 v[120:121], v9 offset:16960
    ds_read_b64_tr_b16 v[122:123], v9 offset:17472
    v_cvt_pk_bf16_f32 v105, v90, v91
    v_mfma_f32_16x16x32_bf16 v[252:255], v[124:127], v[108:111], v[252:255]
    ds_read_b64_tr_b16 v[124:125], v9 offset:16992
    ds_read_b64_tr_b16 v[126:127], v9 offset:17504
    v_exp_f32 v94, v94
    v_mfma_f32_16x16x32_bf16 a[136:139], v[128:131], v[108:111], a[136:139]
    ds_read_b64_tr_b16 v[128:129], v9 offset:17024
    ds_read_b64_tr_b16 v[130:131], v9 offset:17536
    v_exp_f32 v95, v95
    v_mfma_f32_16x16x32_bf16 a[164:167], v[132:135], v[108:111], a[164:167]
    ds_read_b64_tr_b16 v[132:133], v9 offset:17056
    ds_read_b64_tr_b16 v[134:135], v9 offset:17568
    v_add_f32 v12, v12, v92
    v_add_f32 v13, v13, v93
    v_mfma_f32_16x16x32_bf16 a[192:195], v[136:139], v[108:111], a[192:195]
    ds_read_b64_tr_b16 v[136:137], v9 offset:17088
    ds_read_b64_tr_b16 v[138:139], v9 offset:17600
    v_cvt_pk_bf16_f32 v106, v92, v93
    v_add_f32 v12, v12, v94
    v_mfma_f32_16x16x32_bf16 a[220:223], v[140:143], v[108:111], a[220:223]
    ds_read_b64_tr_b16 v[140:141], v9 offset:17120
    ds_read_b64_tr_b16 v[142:143], v9 offset:17632
    v_add_f32 v13, v13, v95
    v_cvt_pk_bf16_f32 v107, v94, v95
    v_mfma_f32_16x16x32_bf16 v[88:91], v[56:59], a[32:35], v[36:39]
    v_mfma_f32_16x16x32_bf16 v[88:91], v[60:63], a[36:39], v[88:91]
    s_add_u32 s29, s34, s100
    v_exp_f32 v96, v96
    v_mfma_f32_16x16x32_bf16 v[88:91], v[64:67], a[40:43], v[88:91]
    v_exp_f32 v97, v97
    v_mfma_f32_16x16x32_bf16 v[88:91], v[68:71], a[44:47], v[88:91]
    s_bfe_u32 s28, s29, 0x20003
    v_exp_f32 v98, v98
    v_mfma_f32_16x16x32_bf16 v[92:95], v[72:75], a[32:35], v[36:39]
    v_exp_f32 v99, v99
    v_mfma_f32_16x16x32_bf16 v[92:95], v[76:79], a[36:39], v[92:95]
    s_lshl_b32 s28, s28, 16
    v_add_f32 v14, v14, v96
    v_add_f32 v15, v15, v97
    v_mfma_f32_16x16x32_bf16 v[92:95], v[80:83], a[40:43], v[92:95]
    v_cvt_pk_bf16_f32 v108, v96, v97
    v_mfma_f32_16x16x32_bf16 v[92:95], v[84:87], a[44:47], v[92:95]
    v_exp_f32 v100, v100
    s_waitcnt lgkmcnt(0)
    v_mfma_f32_16x16x32_bf16 v[144:147], v[112:115], v[104:107], v[144:147]
    s_and_b32 s29, s29, 7
    v_exp_f32 v101, v101
    v_mfma_f32_16x16x32_bf16 v[172:175], v[116:119], v[104:107], v[172:175]
    v_add_f32 v14, v14, v98
    v_add_f32 v15, v15, v99
    v_mfma_f32_16x16x32_bf16 v[200:203], v[120:123], v[104:107], v[200:203]
    s_lshl_b32 s29, s29, 11
    v_cvt_pk_bf16_f32 v109, v98, v99
    v_mfma_f32_16x16x32_bf16 v[228:231], v[124:127], v[104:107], v[228:231]
    v_exp_f32 v102, v102
    v_mfma_f32_16x16x32_bf16 a[112:115], v[128:131], v[104:107], a[112:115]
    s_add_u32 s29, s28, s29
    v_exp_f32 v103, v103
    v_mfma_f32_16x16x32_bf16 a[140:143], v[132:135], v[104:107], a[140:143]
    v_add_f32 v14, v14, v100
    v_add_f32 v15, v15, v101
    v_mfma_f32_16x16x32_bf16 a[168:171], v[136:139], v[104:107], a[168:171]
    s_lshr_b32 s28, s34, 5
    v_cvt_pk_bf16_f32 v110, v100, v101
    v_add_f32 v14, v14, v102
    v_mfma_f32_16x16x32_bf16 a[196:199], v[140:143], v[104:107], a[196:199]
    v_add_f32 v15, v15, v103
    v_cvt_pk_bf16_f32 v111, v102, v103
    v_mfma_f32_16x16x32_bf16 v[96:99], v[56:59], a[48:51], v[40:43]
    v_mfma_f32_16x16x32_bf16 v[96:99], v[60:63], a[52:55], v[96:99]
    s_lshl_b32 s28, s28, 19
    v_exp_f32 v88, v88
    v_mfma_f32_16x16x32_bf16 v[96:99], v[64:67], a[56:59], v[96:99]
    v_exp_f32 v89, v89
    v_mfma_f32_16x16x32_bf16 v[96:99], v[68:71], a[60:63], v[96:99]
    s_add_u32 s49, s28, s29
    v_exp_f32 v90, v90
    v_mfma_f32_16x16x32_bf16 v[100:103], v[72:75], a[48:51], v[40:43]
    v_exp_f32 v91, v91
    v_mfma_f32_16x16x32_bf16 v[100:103], v[76:79], a[52:55], v[100:103]
    s_add_u32 m0, s33, 8448
    v_add_f32 v16, v16, v88
    v_add_f32 v17, v17, v89
    v_mfma_f32_16x16x32_bf16 v[100:103], v[80:83], a[56:59], v[100:103]
    v_cvt_pk_bf16_f32 v104, v88, v89
    v_mfma_f32_16x16x32_bf16 v[100:103], v[84:87], a[60:63], v[100:103]
    v_exp_f32 v92, v92
    v_mfma_f32_16x16x32_bf16 v[148:151], v[112:115], v[108:111], v[148:151]
    s_add_u32 s34, s34, 1
    v_exp_f32 v93, v93
    v_mfma_f32_16x16x32_bf16 v[176:179], v[116:119], v[108:111], v[176:179]
    v_add_f32 v16, v16, v90
    v_add_f32 v17, v17, v91
    v_mfma_f32_16x16x32_bf16 v[204:207], v[120:123], v[108:111], v[204:207]
    buffer_load_dwordx4 v7, s[4:7], s49 offen offset:0 nt lds
    v_cvt_pk_bf16_f32 v105, v90, v91
    v_mfma_f32_16x16x32_bf16 v[232:235], v[124:127], v[108:111], v[232:235]
    v_exp_f32 v94, v94
    v_mfma_f32_16x16x32_bf16 a[116:119], v[128:131], v[108:111], a[116:119]
    s_add_u32 m0, m0, s96
    v_exp_f32 v95, v95
    v_mfma_f32_16x16x32_bf16 a[144:147], v[132:135], v[108:111], a[144:147]
    v_add_f32 v16, v16, v92
    v_add_f32 v17, v17, v93
    v_mfma_f32_16x16x32_bf16 a[172:175], v[136:139], v[108:111], a[172:175]
    buffer_load_dwordx4 v7, s[4:7], s49 offen offset:256 nt lds
    v_cvt_pk_bf16_f32 v106, v92, v93
    v_add_f32 v16, v16, v94
    v_mfma_f32_16x16x32_bf16 a[200:203], v[140:143], v[108:111], a[200:203]
    v_add_f32 v17, v17, v95
    v_cvt_pk_bf16_f32 v107, v94, v95
    v_mfma_f32_16x16x32_bf16 v[88:91], v[56:59], a[64:67], v[44:47]
    v_mfma_f32_16x16x32_bf16 v[88:91], v[60:63], a[68:71], v[88:91]
    s_add_u32 m0, m0, s97
    v_exp_f32 v96, v96
    v_mfma_f32_16x16x32_bf16 v[88:91], v[64:67], a[72:75], v[88:91]
    v_exp_f32 v97, v97
    v_mfma_f32_16x16x32_bf16 v[88:91], v[68:71], a[76:79], v[88:91]
    buffer_load_dwordx4 v7, s[4:7], s49 offen offset:512 nt lds
    v_exp_f32 v98, v98
    v_mfma_f32_16x16x32_bf16 v[92:95], v[72:75], a[64:67], v[44:47]
    v_exp_f32 v99, v99
    v_mfma_f32_16x16x32_bf16 v[92:95], v[76:79], a[68:71], v[92:95]
    s_add_u32 m0, m0, s96
    v_add_f32 v18, v18, v96
    v_add_f32 v19, v19, v97
    v_mfma_f32_16x16x32_bf16 v[92:95], v[80:83], a[72:75], v[92:95]
    v_cvt_pk_bf16_f32 v108, v96, v97
    v_mfma_f32_16x16x32_bf16 v[92:95], v[84:87], a[76:79], v[92:95]
    v_exp_f32 v100, v100
    v_mfma_f32_16x16x32_bf16 v[152:155], v[112:115], v[104:107], v[152:155]
    buffer_load_dwordx4 v7, s[4:7], s49 offen offset:768 nt lds
    v_exp_f32 v101, v101
    v_mfma_f32_16x16x32_bf16 v[180:183], v[116:119], v[104:107], v[180:183]
    v_add_f32 v18, v18, v98
    v_add_f32 v19, v19, v99
    v_mfma_f32_16x16x32_bf16 v[208:211], v[120:123], v[104:107], v[208:211]
    s_add_u32 m0, m0, s97
    v_cvt_pk_bf16_f32 v109, v98, v99
    v_mfma_f32_16x16x32_bf16 v[236:239], v[124:127], v[104:107], v[236:239]
    v_exp_f32 v102, v102
    v_mfma_f32_16x16x32_bf16 a[120:123], v[128:131], v[104:107], a[120:123]
    buffer_load_dwordx4 v7, s[4:7], s49 offen offset:1024 nt lds
    v_exp_f32 v103, v103
    v_mfma_f32_16x16x32_bf16 a[148:151], v[132:135], v[104:107], a[148:151]
    v_add_f32 v18, v18, v100
    v_add_f32 v19, v19, v101
    v_mfma_f32_16x16x32_bf16 a[176:179], v[136:139], v[104:107], a[176:179]
    s_add_u32 m0, m0, s96
    v_cvt_pk_bf16_f32 v110, v100, v101
    v_add_f32 v18, v18, v102
    v_mfma_f32_16x16x32_bf16 a[204:207], v[140:143], v[104:107], a[204:207]
    v_add_f32 v19, v19, v103
    v_cvt_pk_bf16_f32 v111, v102, v103
    v_mfma_f32_16x16x32_bf16 v[96:99], v[56:59], a[80:83], v[48:51]
    v_mfma_f32_16x16x32_bf16 v[96:99], v[60:63], a[84:87], v[96:99]
    buffer_load_dwordx4 v7, s[4:7], s49 offen offset:1280 nt lds
    v_exp_f32 v88, v88
    v_mfma_f32_16x16x32_bf16 v[96:99], v[64:67], a[88:91], v[96:99]
    v_exp_f32 v89, v89
    v_mfma_f32_16x16x32_bf16 v[96:99], v[68:71], a[92:95], v[96:99]
    s_add_u32 m0, m0, s97
    v_exp_f32 v90, v90
    v_mfma_f32_16x16x32_bf16 v[100:103], v[72:75], a[80:83], v[48:51]
    v_exp_f32 v91, v91
    v_mfma_f32_16x16x32_bf16 v[100:103], v[76:79], a[84:87], v[100:103]
    buffer_load_dwordx4 v7, s[4:7], s49 offen offset:1536 nt lds
    v_add_f32 v20, v20, v88
    v_add_f32 v21, v21, v89
    v_mfma_f32_16x16x32_bf16 v[100:103], v[80:83], a[88:91], v[100:103]
    v_cvt_pk_bf16_f32 v104, v88, v89
    v_mfma_f32_16x16x32_bf16 v[100:103], v[84:87], a[92:95], v[100:103]
    v_exp_f32 v92, v92
    v_mfma_f32_16x16x32_bf16 v[156:159], v[112:115], v[108:111], v[156:159]
    s_add_u32 m0, m0, s96
    v_exp_f32 v93, v93
    v_mfma_f32_16x16x32_bf16 v[184:187], v[116:119], v[108:111], v[184:187]
    v_add_f32 v20, v20, v90
    v_add_f32 v21, v21, v91
    v_mfma_f32_16x16x32_bf16 v[212:215], v[120:123], v[108:111], v[212:215]
    buffer_load_dwordx4 v7, s[4:7], s49 offen offset:1792 nt lds
    v_cvt_pk_bf16_f32 v105, v90, v91
    v_mfma_f32_16x16x32_bf16 v[240:243], v[124:127], v[108:111], v[240:243]
    v_exp_f32 v94, v94
    v_mfma_f32_16x16x32_bf16 a[124:127], v[128:131], v[108:111], a[124:127]
    v_exp_f32 v95, v95
    v_mfma_f32_16x16x32_bf16 a[152:155], v[132:135], v[108:111], a[152:155]
    v_add_f32 v20, v20, v92
    v_add_f32 v21, v21, v93
    v_mfma_f32_16x16x32_bf16 a[180:183], v[136:139], v[108:111], a[180:183]
    v_cvt_pk_bf16_f32 v106, v92, v93
    v_add_f32 v20, v20, v94
    v_mfma_f32_16x16x32_bf16 a[208:211], v[140:143], v[108:111], a[208:211]
    v_add_f32 v21, v21, v95
    v_cvt_pk_bf16_f32 v107, v94, v95
    s_waitcnt vmcnt(16) lgkmcnt(0)
    s_barrier
    v_mfma_f32_16x16x32_bf16 v[88:91], v[56:59], a[96:99], v[52:55]
    ds_read_b128 v[56:59], v8 offset:25344
    v_mfma_f32_16x16x32_bf16 v[88:91], v[60:63], a[100:103], v[88:91]
    ds_read_b128 v[60:63], v8 offset:25408
    v_exp_f32 v96, v96
    v_mfma_f32_16x16x32_bf16 v[88:91], v[64:67], a[104:107], v[88:91]
    ds_read_b128 v[64:67], v8 offset:25472
    v_exp_f32 v97, v97
    v_mfma_f32_16x16x32_bf16 v[88:91], v[68:71], a[108:111], v[88:91]
    ds_read_b128 v[68:71], v8 offset:25536
    v_exp_f32 v98, v98
    v_mfma_f32_16x16x32_bf16 v[92:95], v[72:75], a[96:99], v[52:55]
    ds_read_b128 v[72:75], v8 offset:25856
    v_exp_f32 v99, v99
    v_mfma_f32_16x16x32_bf16 v[92:95], v[76:79], a[100:103], v[92:95]
    ds_read_b128 v[76:79], v8 offset:25920
    v_add_f32 v22, v22, v96
    v_add_f32 v23, v23, v97
    v_mfma_f32_16x16x32_bf16 v[92:95], v[80:83], a[104:107], v[92:95]
    ds_read_b128 v[80:83], v8 offset:25984
    v_cvt_pk_bf16_f32 v108, v96, v97
    v_mfma_f32_16x16x32_bf16 v[92:95], v[84:87], a[108:111], v[92:95]
    ds_read_b128 v[84:87], v8 offset:26048
    v_exp_f32 v100, v100
    v_mfma_f32_16x16x32_bf16 v[160:163], v[112:115], v[104:107], v[160:163]
    v_exp_f32 v101, v101
    v_mfma_f32_16x16x32_bf16 v[188:191], v[116:119], v[104:107], v[188:191]
    v_add_f32 v22, v22, v98
    v_add_f32 v23, v23, v99
    v_mfma_f32_16x16x32_bf16 v[216:219], v[120:123], v[104:107], v[216:219]
    v_cvt_pk_bf16_f32 v109, v98, v99
    v_mfma_f32_16x16x32_bf16 v[244:247], v[124:127], v[104:107], v[244:247]
    v_exp_f32 v102, v102
    v_mfma_f32_16x16x32_bf16 a[128:131], v[128:131], v[104:107], a[128:131]
    v_exp_f32 v103, v103
    v_mfma_f32_16x16x32_bf16 a[156:159], v[132:135], v[104:107], a[156:159]
    v_add_f32 v22, v22, v100
    v_add_f32 v23, v23, v101
    v_mfma_f32_16x16x32_bf16 a[184:187], v[136:139], v[104:107], a[184:187]
    v_cvt_pk_bf16_f32 v110, v100, v101
    v_add_f32 v22, v22, v102
    v_mfma_f32_16x16x32_bf16 a[212:215], v[140:143], v[104:107], a[212:215]
    v_add_f32 v23, v23, v103
    v_cvt_pk_bf16_f32 v111, v102, v103
    s_waitcnt lgkmcnt(0)
    v_mfma_f32_16x16x32_bf16 v[96:99], v[56:59], a[0:3], v[28:31]
    v_mfma_f32_16x16x32_bf16 v[96:99], v[60:63], a[4:7], v[96:99]
    v_exp_f32 v88, v88
    v_mfma_f32_16x16x32_bf16 v[96:99], v[64:67], a[8:11], v[96:99]
    v_exp_f32 v89, v89
    v_mfma_f32_16x16x32_bf16 v[96:99], v[68:71], a[12:15], v[96:99]
    v_exp_f32 v90, v90
    v_mfma_f32_16x16x32_bf16 v[100:103], v[72:75], a[0:3], v[28:31]
    v_exp_f32 v91, v91
    v_mfma_f32_16x16x32_bf16 v[100:103], v[76:79], a[4:7], v[100:103]
    v_add_f32 v24, v24, v88
    v_add_f32 v25, v25, v89
    v_mfma_f32_16x16x32_bf16 v[100:103], v[80:83], a[8:11], v[100:103]
    v_cvt_pk_bf16_f32 v104, v88, v89
    v_mfma_f32_16x16x32_bf16 v[100:103], v[84:87], a[12:15], v[100:103]
    v_exp_f32 v92, v92
    v_mfma_f32_16x16x32_bf16 v[164:167], v[112:115], v[108:111], v[164:167]
    v_exp_f32 v93, v93
    v_mfma_f32_16x16x32_bf16 v[192:195], v[116:119], v[108:111], v[192:195]
    v_add_f32 v24, v24, v90
    v_add_f32 v25, v25, v91
    v_mfma_f32_16x16x32_bf16 v[220:223], v[120:123], v[108:111], v[220:223]
    v_cvt_pk_bf16_f32 v105, v90, v91
    v_mfma_f32_16x16x32_bf16 v[248:251], v[124:127], v[108:111], v[248:251]
    v_exp_f32 v94, v94
    v_mfma_f32_16x16x32_bf16 a[132:135], v[128:131], v[108:111], a[132:135]
    v_exp_f32 v95, v95
    v_mfma_f32_16x16x32_bf16 a[160:163], v[132:135], v[108:111], a[160:163]
    v_add_f32 v24, v24, v92
    v_add_f32 v25, v25, v93
    v_mfma_f32_16x16x32_bf16 a[188:191], v[136:139], v[108:111], a[188:191]
    v_cvt_pk_bf16_f32 v106, v92, v93
    v_add_f32 v24, v24, v94
    v_mfma_f32_16x16x32_bf16 a[216:219], v[140:143], v[108:111], a[216:219]
    v_add_f32 v25, v25, v95
    v_cvt_pk_bf16_f32 v107, v94, v95
    v_mfma_f32_16x16x32_bf16 v[88:91], v[56:59], a[16:19], v[32:35]
    v_mfma_f32_16x16x32_bf16 v[88:91], v[60:63], a[20:23], v[88:91]
    v_exp_f32 v96, v96
    v_mfma_f32_16x16x32_bf16 v[88:91], v[64:67], a[24:27], v[88:91]
    v_exp_f32 v97, v97
    v_mfma_f32_16x16x32_bf16 v[88:91], v[68:71], a[28:31], v[88:91]
    v_exp_f32 v98, v98
    v_mfma_f32_16x16x32_bf16 v[92:95], v[72:75], a[16:19], v[32:35]
    v_exp_f32 v99, v99
    v_mfma_f32_16x16x32_bf16 v[92:95], v[76:79], a[20:23], v[92:95]
    v_add_f32 v12, v12, v96
    v_add_f32 v13, v13, v97
    v_mfma_f32_16x16x32_bf16 v[92:95], v[80:83], a[24:27], v[92:95]
    v_cvt_pk_bf16_f32 v108, v96, v97
    v_mfma_f32_16x16x32_bf16 v[92:95], v[84:87], a[28:31], v[92:95]
    v_exp_f32 v100, v100
    v_mfma_f32_16x16x32_bf16 v[168:171], v[112:115], v[104:107], v[168:171]
    ds_read_b64_tr_b16 v[112:113], v9 offset:25344
    ds_read_b64_tr_b16 v[114:115], v9 offset:25856
    v_exp_f32 v101, v101
    v_mfma_f32_16x16x32_bf16 v[196:199], v[116:119], v[104:107], v[196:199]
    ds_read_b64_tr_b16 v[116:117], v9 offset:25376
    ds_read_b64_tr_b16 v[118:119], v9 offset:25888
    v_add_f32 v12, v12, v98
    v_add_f32 v13, v13, v99
    v_mfma_f32_16x16x32_bf16 v[224:227], v[120:123], v[104:107], v[224:227]
    ds_read_b64_tr_b16 v[120:121], v9 offset:25408
    ds_read_b64_tr_b16 v[122:123], v9 offset:25920
    v_cvt_pk_bf16_f32 v109, v98, v99
    v_mfma_f32_16x16x32_bf16 v[252:255], v[124:127], v[104:107], v[252:255]
    ds_read_b64_tr_b16 v[124:125], v9 offset:25440
    ds_read_b64_tr_b16 v[126:127], v9 offset:25952
    v_exp_f32 v102, v102
    v_mfma_f32_16x16x32_bf16 a[136:139], v[128:131], v[104:107], a[136:139]
    ds_read_b64_tr_b16 v[128:129], v9 offset:25472
    ds_read_b64_tr_b16 v[130:131], v9 offset:25984
    v_exp_f32 v103, v103
    v_mfma_f32_16x16x32_bf16 a[164:167], v[132:135], v[104:107], a[164:167]
    ds_read_b64_tr_b16 v[132:133], v9 offset:25504
    ds_read_b64_tr_b16 v[134:135], v9 offset:26016
    v_add_f32 v12, v12, v100
    v_add_f32 v13, v13, v101
    v_mfma_f32_16x16x32_bf16 a[192:195], v[136:139], v[104:107], a[192:195]
    ds_read_b64_tr_b16 v[136:137], v9 offset:25536
    ds_read_b64_tr_b16 v[138:139], v9 offset:26048
    v_cvt_pk_bf16_f32 v110, v100, v101
    v_add_f32 v12, v12, v102
    v_mfma_f32_16x16x32_bf16 a[220:223], v[140:143], v[104:107], a[220:223]
    ds_read_b64_tr_b16 v[140:141], v9 offset:25568
    ds_read_b64_tr_b16 v[142:143], v9 offset:26080
    v_add_f32 v13, v13, v103
    v_cvt_pk_bf16_f32 v111, v102, v103
    v_mfma_f32_16x16x32_bf16 v[96:99], v[56:59], a[32:35], v[36:39]
    v_mfma_f32_16x16x32_bf16 v[96:99], v[60:63], a[36:39], v[96:99]
    s_add_u32 s29, s34, s100
    v_exp_f32 v88, v88
    v_mfma_f32_16x16x32_bf16 v[96:99], v[64:67], a[40:43], v[96:99]
    v_exp_f32 v89, v89
    v_mfma_f32_16x16x32_bf16 v[96:99], v[68:71], a[44:47], v[96:99]
    s_bfe_u32 s28, s29, 0x20003
    v_exp_f32 v90, v90
    v_mfma_f32_16x16x32_bf16 v[100:103], v[72:75], a[32:35], v[36:39]
    v_exp_f32 v91, v91
    v_mfma_f32_16x16x32_bf16 v[100:103], v[76:79], a[36:39], v[100:103]
    s_lshl_b32 s28, s28, 16
    v_add_f32 v14, v14, v88
    v_add_f32 v15, v15, v89
    v_mfma_f32_16x16x32_bf16 v[100:103], v[80:83], a[40:43], v[100:103]
    v_cvt_pk_bf16_f32 v104, v88, v89
    v_mfma_f32_16x16x32_bf16 v[100:103], v[84:87], a[44:47], v[100:103]
    v_exp_f32 v92, v92
    s_waitcnt lgkmcnt(0)
    v_mfma_f32_16x16x32_bf16 v[144:147], v[112:115], v[108:111], v[144:147]
    s_and_b32 s29, s29, 7
    v_exp_f32 v93, v93
    v_mfma_f32_16x16x32_bf16 v[172:175], v[116:119], v[108:111], v[172:175]
    v_add_f32 v14, v14, v90
    v_add_f32 v15, v15, v91
    v_mfma_f32_16x16x32_bf16 v[200:203], v[120:123], v[108:111], v[200:203]
    s_lshl_b32 s29, s29, 11
    v_cvt_pk_bf16_f32 v105, v90, v91
    v_mfma_f32_16x16x32_bf16 v[228:231], v[124:127], v[108:111], v[228:231]
    v_exp_f32 v94, v94
    v_mfma_f32_16x16x32_bf16 a[112:115], v[128:131], v[108:111], a[112:115]
    s_add_u32 s29, s28, s29
    v_exp_f32 v95, v95
    v_mfma_f32_16x16x32_bf16 a[140:143], v[132:135], v[108:111], a[140:143]
    v_add_f32 v14, v14, v92
    v_add_f32 v15, v15, v93
    v_mfma_f32_16x16x32_bf16 a[168:171], v[136:139], v[108:111], a[168:171]
    s_lshr_b32 s28, s34, 5
    v_cvt_pk_bf16_f32 v106, v92, v93
    v_add_f32 v14, v14, v94
    v_mfma_f32_16x16x32_bf16 a[196:199], v[140:143], v[108:111], a[196:199]
    v_add_f32 v15, v15, v95
    v_cvt_pk_bf16_f32 v107, v94, v95
    v_mfma_f32_16x16x32_bf16 v[88:91], v[56:59], a[48:51], v[40:43]
    v_mfma_f32_16x16x32_bf16 v[88:91], v[60:63], a[52:55], v[88:91]
    s_lshl_b32 s28, s28, 19
    v_exp_f32 v96, v96
    v_mfma_f32_16x16x32_bf16 v[88:91], v[64:67], a[56:59], v[88:91]
    v_exp_f32 v97, v97
    v_mfma_f32_16x16x32_bf16 v[88:91], v[68:71], a[60:63], v[88:91]
    s_add_u32 s49, s28, s29
    v_exp_f32 v98, v98
    v_mfma_f32_16x16x32_bf16 v[92:95], v[72:75], a[48:51], v[40:43]
    v_exp_f32 v99, v99
    v_mfma_f32_16x16x32_bf16 v[92:95], v[76:79], a[52:55], v[92:95]
    s_add_u32 m0, s33, 16896
    v_add_f32 v16, v16, v96
    v_add_f32 v17, v17, v97
    v_mfma_f32_16x16x32_bf16 v[92:95], v[80:83], a[56:59], v[92:95]
    v_cvt_pk_bf16_f32 v108, v96, v97
    v_mfma_f32_16x16x32_bf16 v[92:95], v[84:87], a[60:63], v[92:95]
    v_exp_f32 v100, v100
    v_mfma_f32_16x16x32_bf16 v[148:151], v[112:115], v[104:107], v[148:151]
    s_add_u32 s34, s34, 1
    v_exp_f32 v101, v101
    v_mfma_f32_16x16x32_bf16 v[176:179], v[116:119], v[104:107], v[176:179]
    v_add_f32 v16, v16, v98
    v_add_f32 v17, v17, v99
    v_mfma_f32_16x16x32_bf16 v[204:207], v[120:123], v[104:107], v[204:207]
    buffer_load_dwordx4 v7, s[4:7], s49 offen offset:0 nt lds
    v_cvt_pk_bf16_f32 v109, v98, v99
    v_mfma_f32_16x16x32_bf16 v[232:235], v[124:127], v[104:107], v[232:235]
    v_exp_f32 v102, v102
    v_mfma_f32_16x16x32_bf16 a[116:119], v[128:131], v[104:107], a[116:119]
    s_add_u32 m0, m0, s96
    v_exp_f32 v103, v103
    v_mfma_f32_16x16x32_bf16 a[144:147], v[132:135], v[104:107], a[144:147]
    v_add_f32 v16, v16, v100
    v_add_f32 v17, v17, v101
    v_mfma_f32_16x16x32_bf16 a[172:175], v[136:139], v[104:107], a[172:175]
    buffer_load_dwordx4 v7, s[4:7], s49 offen offset:256 nt lds
    v_cvt_pk_bf16_f32 v110, v100, v101
    v_add_f32 v16, v16, v102
    v_mfma_f32_16x16x32_bf16 a[200:203], v[140:143], v[104:107], a[200:203]
    v_add_f32 v17, v17, v103
    v_cvt_pk_bf16_f32 v111, v102, v103
    v_mfma_f32_16x16x32_bf16 v[96:99], v[56:59], a[64:67], v[44:47]
    v_mfma_f32_16x16x32_bf16 v[96:99], v[60:63], a[68:71], v[96:99]
    s_add_u32 m0, m0, s97
    v_exp_f32 v88, v88
    v_mfma_f32_16x16x32_bf16 v[96:99], v[64:67], a[72:75], v[96:99]
    v_exp_f32 v89, v89
    v_mfma_f32_16x16x32_bf16 v[96:99], v[68:71], a[76:79], v[96:99]
    buffer_load_dwordx4 v7, s[4:7], s49 offen offset:512 nt lds
    v_exp_f32 v90, v90
    v_mfma_f32_16x16x32_bf16 v[100:103], v[72:75], a[64:67], v[44:47]
    v_exp_f32 v91, v91
    v_mfma_f32_16x16x32_bf16 v[100:103], v[76:79], a[68:71], v[100:103]
    s_add_u32 m0, m0, s96
    v_add_f32 v18, v18, v88
    v_add_f32 v19, v19, v89
    v_mfma_f32_16x16x32_bf16 v[100:103], v[80:83], a[72:75], v[100:103]
    v_cvt_pk_bf16_f32 v104, v88, v89
    v_mfma_f32_16x16x32_bf16 v[100:103], v[84:87], a[76:79], v[100:103]
    v_exp_f32 v92, v92
    v_mfma_f32_16x16x32_bf16 v[152:155], v[112:115], v[108:111], v[152:155]
    buffer_load_dwordx4 v7, s[4:7], s49 offen offset:768 nt lds
    v_exp_f32 v93, v93
    v_mfma_f32_16x16x32_bf16 v[180:183], v[116:119], v[108:111], v[180:183]
    v_add_f32 v18, v18, v90
    v_add_f32 v19, v19, v91
    v_mfma_f32_16x16x32_bf16 v[208:211], v[120:123], v[108:111], v[208:211]
    s_add_u32 m0, m0, s97
    v_cvt_pk_bf16_f32 v105, v90, v91
    v_mfma_f32_16x16x32_bf16 v[236:239], v[124:127], v[108:111], v[236:239]
    v_exp_f32 v94, v94
    v_mfma_f32_16x16x32_bf16 a[120:123], v[128:131], v[108:111], a[120:123]
    buffer_load_dwordx4 v7, s[4:7], s49 offen offset:1024 nt lds
    v_exp_f32 v95, v95
    v_mfma_f32_16x16x32_bf16 a[148:151], v[132:135], v[108:111], a[148:151]
    v_add_f32 v18, v18, v92
    v_add_f32 v19, v19, v93
    v_mfma_f32_16x16x32_bf16 a[176:179], v[136:139], v[108:111], a[176:179]
    s_add_u32 m0, m0, s96
    v_cvt_pk_bf16_f32 v106, v92, v93
    v_add_f32 v18, v18, v94
    v_mfma_f32_16x16x32_bf16 a[204:207], v[140:143], v[108:111], a[204:207]
    v_add_f32 v19, v19, v95
    v_cvt_pk_bf16_f32 v107, v94, v95
    v_mfma_f32_16x16x32_bf16 v[88:91], v[56:59], a[80:83], v[48:51]
    v_mfma_f32_16x16x32_bf16 v[88:91], v[60:63], a[84:87], v[88:91]
    buffer_load_dwordx4 v7, s[4:7], s49 offen offset:1280 nt lds
    v_exp_f32 v96, v96
    v_mfma_f32_16x16x32_bf16 v[88:91], v[64:67], a[88:91], v[88:91]
    v_exp_f32 v97, v97
    v_mfma_f32_16x16x32_bf16 v[88:91], v[68:71], a[92:95], v[88:91]
    s_add_u32 m0, m0, s97
    v_exp_f32 v98, v98
    v_mfma_f32_16x16x32_bf16 v[92:95], v[72:75], a[80:83], v[48:51]
    v_exp_f32 v99, v99
    v_mfma_f32_16x16x32_bf16 v[92:95], v[76:79], a[84:87], v[92:95]
    buffer_load_dwordx4 v7, s[4:7], s49 offen offset:1536 nt lds
    v_add_f32 v20, v20, v96
    v_add_f32 v21, v21, v97
    v_mfma_f32_16x16x32_bf16 v[92:95], v[80:83], a[88:91], v[92:95]
    v_cvt_pk_bf16_f32 v108, v96, v97
    v_mfma_f32_16x16x32_bf16 v[92:95], v[84:87], a[92:95], v[92:95]
    v_exp_f32 v100, v100
    v_mfma_f32_16x16x32_bf16 v[156:159], v[112:115], v[104:107], v[156:159]
    s_add_u32 m0, m0, s96
    v_exp_f32 v101, v101
    v_mfma_f32_16x16x32_bf16 v[184:187], v[116:119], v[104:107], v[184:187]
    v_add_f32 v20, v20, v98
    v_add_f32 v21, v21, v99
    v_mfma_f32_16x16x32_bf16 v[212:215], v[120:123], v[104:107], v[212:215]
    buffer_load_dwordx4 v7, s[4:7], s49 offen offset:1792 nt lds
    v_cvt_pk_bf16_f32 v109, v98, v99
    v_mfma_f32_16x16x32_bf16 v[240:243], v[124:127], v[104:107], v[240:243]
    v_exp_f32 v102, v102
    v_mfma_f32_16x16x32_bf16 a[124:127], v[128:131], v[104:107], a[124:127]
    v_exp_f32 v103, v103
    v_mfma_f32_16x16x32_bf16 a[152:155], v[132:135], v[104:107], a[152:155]
    v_add_f32 v20, v20, v100
    v_add_f32 v21, v21, v101
    v_mfma_f32_16x16x32_bf16 a[180:183], v[136:139], v[104:107], a[180:183]
    v_cvt_pk_bf16_f32 v110, v100, v101
    v_add_f32 v20, v20, v102
    v_mfma_f32_16x16x32_bf16 a[208:211], v[140:143], v[104:107], a[208:211]
    v_add_f32 v21, v21, v103
    v_cvt_pk_bf16_f32 v111, v102, v103
    s_waitcnt vmcnt(16) lgkmcnt(0)
    s_barrier
    v_mfma_f32_16x16x32_bf16 v[96:99], v[56:59], a[96:99], v[52:55]
    ds_read_b128 v[56:59], v8 offset:0
    s_add_u32 s29, s34, s100
    v_mfma_f32_16x16x32_bf16 v[96:99], v[60:63], a[100:103], v[96:99]
    ds_read_b128 v[60:63], v8 offset:64
    s_bfe_u32 s28, s29, 0x20003
    v_exp_f32 v88, v88
    v_mfma_f32_16x16x32_bf16 v[96:99], v[64:67], a[104:107], v[96:99]
    ds_read_b128 v[64:67], v8 offset:128
    s_lshl_b32 s28, s28, 16
    v_exp_f32 v89, v89
    v_mfma_f32_16x16x32_bf16 v[96:99], v[68:71], a[108:111], v[96:99]
    ds_read_b128 v[68:71], v8 offset:192
    s_and_b32 s29, s29, 7
    v_exp_f32 v90, v90
    v_mfma_f32_16x16x32_bf16 v[100:103], v[72:75], a[96:99], v[52:55]
    ds_read_b128 v[72:75], v8 offset:512
    s_lshl_b32 s29, s29, 11
    v_exp_f32 v91, v91
    v_mfma_f32_16x16x32_bf16 v[100:103], v[76:79], a[100:103], v[100:103]
    ds_read_b128 v[76:79], v8 offset:576
    s_add_u32 s29, s28, s29
    v_add_f32 v22, v22, v88
    v_add_f32 v23, v23, v89
    v_mfma_f32_16x16x32_bf16 v[100:103], v[80:83], a[104:107], v[100:103]
    ds_read_b128 v[80:83], v8 offset:640
    s_lshr_b32 s28, s34, 5
    v_cvt_pk_bf16_f32 v104, v88, v89
    v_mfma_f32_16x16x32_bf16 v[100:103], v[84:87], a[108:111], v[100:103]
    ds_read_b128 v[84:87], v8 offset:704
    s_lshl_b32 s28, s28, 19
    v_exp_f32 v92, v92
    v_mfma_f32_16x16x32_bf16 v[160:163], v[112:115], v[108:111], v[160:163]
    s_add_u32 s49, s28, s29
    s_add_u32 m0, s33, 25344
    v_exp_f32 v93, v93
    v_mfma_f32_16x16x32_bf16 v[188:191], v[116:119], v[108:111], v[188:191]
    s_add_u32 s34, s34, 1
    v_add_f32 v22, v22, v90
    v_add_f32 v23, v23, v91
    v_mfma_f32_16x16x32_bf16 v[216:219], v[120:123], v[108:111], v[216:219]
    s_nop 0
    v_cvt_pk_bf16_f32 v105, v90, v91
    v_mfma_f32_16x16x32_bf16 v[244:247], v[124:127], v[108:111], v[244:247]
    buffer_load_dwordx4 v7, s[4:7], s49 offen offset:0 nt lds
    v_exp_f32 v94, v94
    v_mfma_f32_16x16x32_bf16 a[128:131], v[128:131], v[108:111], a[128:131]
    s_add_u32 m0, m0, s96
    v_exp_f32 v95, v95
    v_mfma_f32_16x16x32_bf16 a[156:159], v[132:135], v[108:111], a[156:159]
    s_nop 0
    v_add_f32 v22, v22, v92
    v_add_f32 v23, v23, v93
    v_mfma_f32_16x16x32_bf16 a[184:187], v[136:139], v[108:111], a[184:187]
    buffer_load_dwordx4 v7, s[4:7], s49 offen offset:256 nt lds
    v_cvt_pk_bf16_f32 v106, v92, v93
    v_add_f32 v22, v22, v94
    v_mfma_f32_16x16x32_bf16 a[212:215], v[140:143], v[108:111], a[212:215]
    s_add_u32 m0, m0, s97
    v_add_f32 v23, v23, v95
    v_cvt_pk_bf16_f32 v107, v94, v95
    s_lshl_b32 s30, s2, 2
    s_add_u32 s30, s30, s20
    s_mul_i32 s30, s30, 28672
    v_lshlrev_b32 v4, 4, v1
    buffer_load_dwordx4 a[0:3], v4, s[12:15], s30 offen offset:0
    buffer_load_dwordx4 a[4:7], v4, s[12:15], s30 offen offset:1024
    buffer_load_dwordx4 a[8:11], v4, s[12:15], s30 offen offset:2048
    buffer_load_dwordx4 a[12:15], v4, s[12:15], s30 offen offset:3072
    s_add_u32 s30, s30, 4096
    buffer_load_dwordx4 a[16:19], v4, s[12:15], s30 offen offset:0
    buffer_load_dwordx4 a[20:23], v4, s[12:15], s30 offen offset:1024
    buffer_load_dwordx4 a[24:27], v4, s[12:15], s30 offen offset:2048
    buffer_load_dwordx4 a[28:31], v4, s[12:15], s30 offen offset:3072
    s_add_u32 s30, s30, 4096
    buffer_load_dwordx4 a[32:35], v4, s[12:15], s30 offen offset:0
    buffer_load_dwordx4 a[36:39], v4, s[12:15], s30 offen offset:1024
    buffer_load_dwordx4 a[40:43], v4, s[12:15], s30 offen offset:2048
    buffer_load_dwordx4 a[44:47], v4, s[12:15], s30 offen offset:3072
    s_add_u32 s30, s30, 4096
    buffer_load_dwordx4 a[48:51], v4, s[12:15], s30 offen offset:0
    buffer_load_dwordx4 a[52:55], v4, s[12:15], s30 offen offset:1024
    buffer_load_dwordx4 a[56:59], v4, s[12:15], s30 offen offset:2048
    buffer_load_dwordx4 a[60:63], v4, s[12:15], s30 offen offset:3072
    s_add_u32 s30, s30, 4096
    buffer_load_dwordx4 a[64:67], v4, s[12:15], s30 offen offset:0
    buffer_load_dwordx4 a[68:71], v4, s[12:15], s30 offen offset:1024
    buffer_load_dwordx4 a[72:75], v4, s[12:15], s30 offen offset:2048
    buffer_load_dwordx4 a[76:79], v4, s[12:15], s30 offen offset:3072
    s_add_u32 s30, s30, 4096
    buffer_load_dwordx4 a[80:83], v4, s[12:15], s30 offen offset:0
    buffer_load_dwordx4 a[84:87], v4, s[12:15], s30 offen offset:1024
    buffer_load_dwordx4 a[88:91], v4, s[12:15], s30 offen offset:2048
    buffer_load_dwordx4 a[92:95], v4, s[12:15], s30 offen offset:3072
    s_add_u32 s30, s30, 4096
    buffer_load_dwordx4 a[96:99], v4, s[12:15], s30 offen offset:0
    buffer_load_dwordx4 a[100:103], v4, s[12:15], s30 offen offset:1024
    buffer_load_dwordx4 a[104:107], v4, s[12:15], s30 offen offset:2048
    buffer_load_dwordx4 a[108:111], v4, s[12:15], s30 offen offset:3072
    s_nop 1
    v_mfma_f32_16x16x32_bf16 v[164:167], v[112:115], v[104:107], v[164:167]
    s_nop 0
    buffer_load_dwordx4 v7, s[4:7], s49 offen offset:512 nt lds
    v_exp_f32 v96, v96
    v_mfma_f32_16x16x32_bf16 v[192:195], v[116:119], v[104:107], v[192:195]
    s_add_u32 m0, m0, s96
    s_nop 0
    v_exp_f32 v97, v97
    v_exp_f32 v98, v98
    v_mfma_f32_16x16x32_bf16 v[220:223], v[120:123], v[104:107], v[220:223]
    buffer_load_dwordx4 v7, s[4:7], s49 offen offset:768 nt lds
    s_add_u32 m0, m0, s97
    v_exp_f32 v99, v99
    v_add_f32 v24, v24, v96
    v_add_f32 v25, v25, v97
    v_mfma_f32_16x16x32_bf16 v[248:251], v[124:127], v[104:107], v[248:251]
    s_nop 0
    buffer_load_dwordx4 v7, s[4:7], s49 offen offset:1024 nt lds
    v_cvt_pk_bf16_f32 v108, v96, v97
    v_exp_f32 v100, v100
    v_mfma_f32_16x16x32_bf16 a[132:135], v[128:131], v[104:107], a[132:135]
    s_add_u32 m0, m0, s96
    s_nop 0
    buffer_load_dwordx4 v7, s[4:7], s49 offen offset:1280 nt lds
    v_exp_f32 v101, v101
    v_add_f32 v24, v24, v98
    v_add_f32 v25, v25, v99
    v_mfma_f32_16x16x32_bf16 a[160:163], v[132:135], v[104:107], a[160:163]
    s_add_u32 m0, m0, s97
    s_nop 0
    v_cvt_pk_bf16_f32 v109, v98, v99
    v_exp_f32 v102, v102
    v_mfma_f32_16x16x32_bf16 a[188:191], v[136:139], v[104:107], a[188:191]
    buffer_load_dwordx4 v7, s[4:7], s49 offen offset:1536 nt lds
    s_add_u32 m0, m0, s96
    v_exp_f32 v103, v103
    v_add_f32 v24, v24, v100
    v_add_f32 v25, v25, v101
    v_mfma_f32_16x16x32_bf16 a[216:219], v[140:143], v[104:107], a[216:219]
    s_nop 0
    buffer_load_dwordx4 v7, s[4:7], s49 offen offset:1792 nt lds
    v_cvt_pk_bf16_f32 v110, v100, v101
    v_add_f32 v24, v24, v102
    v_add_f32 v25, v25, v103
    v_cvt_pk_bf16_f32 v111, v102, v103
L_at_aepi:
    s_nop 1
    s_waitcnt lgkmcnt(0)
    v_mfma_f32_16x16x32_bf16 v[168:171], v[112:115], v[108:111], v[168:171]
    v_add_f32 v12, v12, v13
    v_add_f32 v14, v14, v15
    v_add_f32 v16, v16, v17
    v_add_f32 v18, v18, v19
    v_add_f32 v20, v20, v21
    v_add_f32 v22, v22, v23
    v_mfma_f32_16x16x32_bf16 v[196:199], v[116:119], v[108:111], v[196:199]
    v_add_f32 v24, v24, v25
    v_mov_b32 v88, v12
    v_mov_b32 v89, v14
    v_mov_b32 v90, v16
    v_mov_b32 v91, v18
    v_mov_b32 v92, v20
    v_mfma_f32_16x16x32_bf16 v[224:227], v[120:123], v[108:111], v[224:227]
    v_mov_b32 v93, v22
    v_mov_b32 v94, v24
    v_permlane16_swap_b32 v12, v88
    v_permlane16_swap_b32 v14, v89
    v_permlane16_swap_b32 v16, v90
    v_permlane16_swap_b32 v18, v91
    v_mfma_f32_16x16x32_bf16 v[252:255], v[124:127], v[108:111], v[252:255]
    v_permlane16_swap_b32 v20, v92
    v_permlane16_swap_b32 v22, v93
    v_permlane16_swap_b32 v24, v94
    v_add_f32 v12, v12, v88
    v_add_f32 v14, v14, v89
    v_add_f32 v16, v16, v90
    v_mfma_f32_16x16x32_bf16 a[136:139], v[128:131], v[108:111], a[136:139]
    v_add_f32 v18, v18, v91
    v_add_f32 v20, v20, v92
    v_add_f32 v22, v22, v93
    v_add_f32 v24, v24, v94
    v_mov_b32 v88, v12
    v_mov_b32 v89, v14
    v_mfma_f32_16x16x32_bf16 a[164:167], v[132:135], v[108:111], a[164:167]
    v_mov_b32 v90, v16
    v_mov_b32 v91, v18
    v_mov_b32 v92, v20
    v_mov_b32 v93, v22
    v_mov_b32 v94, v24
    v_permlane32_swap_b32 v12, v88
    v_mfma_f32_16x16x32_bf16 a[192:195], v[136:139], v[108:111], a[192:195]
    v_permlane32_swap_b32 v14, v89
    v_permlane32_swap_b32 v16, v90
    v_permlane32_swap_b32 v18, v91
    v_permlane32_swap_b32 v20, v92
    v_permlane32_swap_b32 v22, v93
    v_permlane32_swap_b32 v24, v94
    v_mfma_f32_16x16x32_bf16 a[220:223], v[140:143], v[108:111], a[220:223]
    v_add_f32 v12, v12, v88
    v_add_f32 v14, v14, v89
    v_add_f32 v16, v16, v90
    v_add_f32 v18, v18, v91
    v_add_f32 v20, v20, v92
    v_add_f32 v22, v22, v93
    v_add_f32 v24, v24, v94
    v_rcp_f32 v28, v12
    v_rcp_f32 v32, v14
    v_rcp_f32 v36, v16
    v_rcp_f32 v40, v18
    v_rcp_f32 v44, v20
    v_rcp_f32 v48, v22
    v_rcp_f32 v52, v24
    v_add_f32 v90, v12, v14
    v_add_f32 v91, v16, v18
    v_add_f32 v92, v20, v22
    v_add_f32 v90, v90, v24
    v_add_f32 v91, v91, v92
    v_add_f32 v90, v90, v91
    v_cmp_nge_f32 vcc, s32, v90
    v_mov_b32 v12, 0xff800000
    v_mov_b32 v14, 0xff800000
    v_mov_b32 v16, 0xff800000
    v_mov_b32 v18, 0xff800000
    v_mov_b32 v20, 0xff800000
    v_mov_b32 v22, 0xff800000
    v_mov_b32 v24, 0xff800000
    s_cmp_eq_u64 vcc, 0
    s_cbranch_scc1 L_at_noflag
    s_lshl_b32 s29, s21, 2
    s_add_u32 s29, s29, 75996
    v_mov_b32 v90, s29
    v_mov_b32 v91, 1
    ds_write_b32 v90, v91
L_at_noflag:
    s_mul_i32 s31, s21, 114688
    s_add_u32 s31, s31, s24
    s_sub_u32 s31, s31, 114688
    v_pk_mul_f32 v[144:145], v[144:145], v[28:29] op_sel_hi:[1,0]
    v_pk_mul_f32 v[146:147], v[146:147], v[28:29] op_sel_hi:[1,0]
    v_pk_mul_f32 v[148:149], v[148:149], v[32:33] op_sel_hi:[1,0]
    v_pk_mul_f32 v[150:151], v[150:151], v[32:33] op_sel_hi:[1,0]
    v_pk_mul_f32 v[152:153], v[152:153], v[36:37] op_sel_hi:[1,0]
    v_pk_mul_f32 v[154:155], v[154:155], v[36:37] op_sel_hi:[1,0]
    v_pk_mul_f32 v[156:157], v[156:157], v[40:41] op_sel_hi:[1,0]
    v_pk_mul_f32 v[158:159], v[158:159], v[40:41] op_sel_hi:[1,0]
    v_pk_mul_f32 v[160:161], v[160:161], v[44:45] op_sel_hi:[1,0]
    v_pk_mul_f32 v[162:163], v[162:163], v[44:45] op_sel_hi:[1,0]
    v_pk_mul_f32 v[164:165], v[164:165], v[48:49] op_sel_hi:[1,0]
    v_pk_mul_f32 v[166:167], v[166:167], v[48:49] op_sel_hi:[1,0]
    v_pk_mul_f32 v[168:169], v[168:169], v[52:53] op_sel_hi:[1,0]
    v_pk_mul_f32 v[170:171], v[170:171], v[52:53] op_sel_hi:[1,0]
    v_pk_mul_f32 v[172:173], v[172:173], v[28:29] op_sel_hi:[1,0]
    v_pk_mul_f32 v[174:175], v[174:175], v[28:29] op_sel_hi:[1,0]
    v_pk_mul_f32 v[176:177], v[176:177], v[32:33] op_sel_hi:[1,0]
    v_pk_mul_f32 v[178:179], v[178:179], v[32:33] op_sel_hi:[1,0]
    v_pk_mul_f32 v[180:181], v[180:181], v[36:37] op_sel_hi:[1,0]
    v_pk_mul_f32 v[182:183], v[182:183], v[36:37] op_sel_hi:[1,0]
    v_pk_mul_f32 v[184:185], v[184:185], v[40:41] op_sel_hi:[1,0]
    v_pk_mul_f32 v[186:187], v[186:187], v[40:41] op_sel_hi:[1,0]
    v_pk_mul_f32 v[188:189], v[188:189], v[44:45] op_sel_hi:[1,0]
    v_pk_mul_f32 v[190:191], v[190:191], v[44:45] op_sel_hi:[1,0]
    v_pk_mul_f32 v[192:193], v[192:193], v[48:49] op_sel_hi:[1,0]
    v_pk_mul_f32 v[194:195], v[194:195], v[48:49] op_sel_hi:[1,0]
    v_pk_mul_f32 v[196:197], v[196:197], v[52:53] op_sel_hi:[1,0]
    v_pk_mul_f32 v[198:199], v[198:199], v[52:53] op_sel_hi:[1,0]
    v_cvt_pk_bf16_f32 v88, v144, v145
    v_cvt_pk_bf16_f32 v89, v146, v147
    v_cvt_pk_bf16_f32 v90, v172, v173
    v_cvt_pk_bf16_f32 v91, v174, v175
    v_cvt_pk_bf16_f32 v92, v148, v149
    v_cvt_pk_bf16_f32 v93, v150, v151
    v_cvt_pk_bf16_f32 v94, v176, v177
    v_cvt_pk_bf16_f32 v95, v178, v179
    v_cvt_pk_bf16_f32 v96, v152, v153
    v_cvt_pk_bf16_f32 v97, v154, v155
    v_cvt_pk_bf16_f32 v98, v180, v181
    v_cvt_pk_bf16_f32 v99, v182, v183
    v_cvt_pk_bf16_f32 v100, v156, v157
    v_cvt_pk_bf16_f32 v101, v158, v159
    v_cvt_pk_bf16_f32 v102, v184, v185
    v_cvt_pk_bf16_f32 v103, v186, v187
    v_cvt_pk_bf16_f32 v104, v160, v161
    v_cvt_pk_bf16_f32 v105, v162, v163
    v_cvt_pk_bf16_f32 v106, v188, v189
    v_cvt_pk_bf16_f32 v107, v190, v191
    v_cvt_pk_bf16_f32 v108, v164, v165
    v_cvt_pk_bf16_f32 v109, v166, v167
    v_cvt_pk_bf16_f32 v110, v192, v193
    v_cvt_pk_bf16_f32 v111, v194, v195
    v_cvt_pk_bf16_f32 v112, v168, v169
    v_cvt_pk_bf16_f32 v113, v170, v171
    v_cvt_pk_bf16_f32 v114, v196, v197
    v_cvt_pk_bf16_f32 v115, v198, v199
    s_nop 1
    v_permlane16_swap_b32 v88, v90
    v_permlane16_swap_b32 v89, v91
    v_permlane16_swap_b32 v92, v94
    v_permlane16_swap_b32 v93, v95
    v_permlane16_swap_b32 v96, v98
    v_permlane16_swap_b32 v97, v99
    v_permlane16_swap_b32 v100, v102
    v_permlane16_swap_b32 v101, v103
    v_permlane16_swap_b32 v104, v106
    v_permlane16_swap_b32 v105, v107
    v_permlane16_swap_b32 v108, v110
    v_permlane16_swap_b32 v109, v111
    v_permlane16_swap_b32 v112, v114
    v_permlane16_swap_b32 v113, v115
    s_mov_b32 s28, s31
    buffer_store_dwordx4 v[88:91], v10, s[12:15], s28 offen offset:0 sc0 sc1
    s_add_u32 s28, s28, 4096
    buffer_store_dwordx4 v[92:95], v10, s[12:15], s28 offen offset:0 sc0 sc1
    s_add_u32 s28, s28, 4096
    buffer_store_dwordx4 v[96:99], v10, s[12:15], s28 offen offset:0 sc0 sc1
    s_add_u32 s28, s28, 4096
    buffer_store_dwordx4 v[100:103], v10, s[12:15], s28 offen offset:0 sc0 sc1
    s_add_u32 s28, s28, 4096
    buffer_store_dwordx4 v[104:107], v10, s[12:15], s28 offen offset:0 sc0 sc1
    s_add_u32 s28, s28, 4096
    buffer_store_dwordx4 v[108:111], v10, s[12:15], s28 offen offset:0 sc0 sc1
    s_add_u32 s28, s28, 4096
    buffer_store_dwordx4 v[112:115], v10, s[12:15], s28 offen offset:0 sc0 sc1
    v_pk_mul_f32 v[200:201], v[200:201], v[28:29] op_sel_hi:[1,0]
    v_pk_mul_f32 v[202:203], v[202:203], v[28:29] op_sel_hi:[1,0]
    v_pk_mul_f32 v[204:205], v[204:205], v[32:33] op_sel_hi:[1,0]
    v_pk_mul_f32 v[206:207], v[206:207], v[32:33] op_sel_hi:[1,0]
    v_pk_mul_f32 v[208:209], v[208:209], v[36:37] op_sel_hi:[1,0]
    v_pk_mul_f32 v[210:211], v[210:211], v[36:37] op_sel_hi:[1,0]
    v_pk_mul_f32 v[212:213], v[212:213], v[40:41] op_sel_hi:[1,0]
    v_pk_mul_f32 v[214:215], v[214:215], v[40:41] op_sel_hi:[1,0]
    v_pk_mul_f32 v[216:217], v[216:217], v[44:45] op_sel_hi:[1,0]
    v_pk_mul_f32 v[218:219], v[218:219], v[44:45] op_sel_hi:[1,0]
    v_pk_mul_f32 v[220:221], v[220:221], v[48:49] op_sel_hi:[1,0]
    v_pk_mul_f32 v[222:223], v[222:223], v[48:49] op_sel_hi:[1,0]
    v_pk_mul_f32 v[224:225], v[224:225], v[52:53] op_sel_hi:[1,0]
    v_pk_mul_f32 v[226:227], v[226:227], v[52:53] op_sel_hi:[1,0]
    v_pk_mul_f32 v[228:229], v[228:229], v[28:29] op_sel_hi:[1,0]
    v_pk_mul_f32 v[230:231], v[230:231], v[28:29] op_sel_hi:[1,0]
    v_pk_mul_f32 v[232:233], v[232:233], v[32:33] op_sel_hi:[1,0]
    v_pk_mul_f32 v[234:235], v[234:235], v[32:33] op_sel_hi:[1,0]
    v_pk_mul_f32 v[236:237], v[236:237], v[36:37] op_sel_hi:[1,0]
    v_pk_mul_f32 v[238:239], v[238:239], v[36:37] op_sel_hi:[1,0]
    v_pk_mul_f32 v[240:241], v[240:241], v[40:41] op_sel_hi:[1,0]
    v_pk_mul_f32 v[242:243], v[242:243], v[40:41] op_sel_hi:[1,0]
    v_pk_mul_f32 v[244:245], v[244:245], v[44:45] op_sel_hi:[1,0]
    v_pk_mul_f32 v[246:247], v[246:247], v[44:45] op_sel_hi:[1,0]
    v_pk_mul_f32 v[248:249], v[248:249], v[48:49] op_sel_hi:[1,0]
    v_pk_mul_f32 v[250:251], v[250:251], v[48:49] op_sel_hi:[1,0]
    v_pk_mul_f32 v[252:253], v[252:253], v[52:53] op_sel_hi:[1,0]
    v_pk_mul_f32 v[254:255], v[254:255], v[52:53] op_sel_hi:[1,0]
    v_cvt_pk_bf16_f32 v116, v200, v201
    v_cvt_pk_bf16_f32 v117, v202, v203
    v_cvt_pk_bf16_f32 v118, v228, v229
    v_cvt_pk_bf16_f32 v119, v230, v231
    v_cvt_pk_bf16_f32 v120, v204, v205
    v_cvt_pk_bf16_f32 v121, v206, v207
    v_cvt_pk_bf16_f32 v122, v232, v233
    v_cvt_pk_bf16_f32 v123, v234, v235
    v_cvt_pk_bf16_f32 v124, v208, v209
    v_cvt_pk_bf16_f32 v125, v210, v211
    v_cvt_pk_bf16_f32 v126, v236, v237
    v_cvt_pk_bf16_f32 v127, v238, v239
    v_cvt_pk_bf16_f32 v128, v212, v213
    v_cvt_pk_bf16_f32 v129, v214, v215
    v_cvt_pk_bf16_f32 v130, v240, v241
    v_cvt_pk_bf16_f32 v131, v242, v243
    v_cvt_pk_bf16_f32 v132, v216, v217
    v_cvt_pk_bf16_f32 v133, v218, v219
    v_cvt_pk_bf16_f32 v134, v244, v245
    v_cvt_pk_bf16_f32 v135, v246, v247
    v_cvt_pk_bf16_f32 v136, v220, v221
    v_cvt_pk_bf16_f32 v137, v222, v223
    v_cvt_pk_bf16_f32 v138, v248, v249
    v_cvt_pk_bf16_f32 v139, v250, v251
    v_cvt_pk_bf16_f32 v140, v224, v225
    v_cvt_pk_bf16_f32 v141, v226, v227
    v_cvt_pk_bf16_f32 v142, v252, v253
    v_cvt_pk_bf16_f32 v143, v254, v255
    s_nop 1
    v_permlane16_swap_b32 v116, v118
    v_permlane16_swap_b32 v117, v119
    v_permlane16_swap_b32 v120, v122
    v_permlane16_swap_b32 v121, v123
    v_permlane16_swap_b32 v124, v126
    v_permlane16_swap_b32 v125, v127
    v_permlane16_swap_b32 v128, v130
    v_permlane16_swap_b32 v129, v131
    v_permlane16_swap_b32 v132, v134
    v_permlane16_swap_b32 v133, v135
    v_permlane16_swap_b32 v136, v138
    v_permlane16_swap_b32 v137, v139
    v_permlane16_swap_b32 v140, v142
    v_permlane16_swap_b32 v141, v143
    s_mov_b32 s28, s31
    buffer_store_dwordx4 v[116:119], v10, s[12:15], s28 offen offset:1024 sc0 sc1
    s_add_u32 s28, s28, 4096
    buffer_store_dwordx4 v[120:123], v10, s[12:15], s28 offen offset:1024 sc0 sc1
    s_add_u32 s28, s28, 4096
    buffer_store_dwordx4 v[124:127], v10, s[12:15], s28 offen offset:1024 sc0 sc1
    s_add_u32 s28, s28, 4096
    buffer_store_dwordx4 v[128:131], v10, s[12:15], s28 offen offset:1024 sc0 sc1
    s_add_u32 s28, s28, 4096
    buffer_store_dwordx4 v[132:135], v10, s[12:15], s28 offen offset:1024 sc0 sc1
    s_add_u32 s28, s28, 4096
    buffer_store_dwordx4 v[136:139], v10, s[12:15], s28 offen offset:1024 sc0 sc1
    s_add_u32 s28, s28, 4096
    buffer_store_dwordx4 v[140:143], v10, s[12:15], s28 offen offset:1024 sc0 sc1
    v_accvgpr_read_b32 v144, a112
    v_accvgpr_read_b32 v145, a113
    v_accvgpr_read_b32 v146, a114
    v_accvgpr_read_b32 v147, a115
    v_accvgpr_read_b32 v148, a116
    v_accvgpr_read_b32 v149, a117
    v_accvgpr_read_b32 v150, a118
    v_accvgpr_read_b32 v151, a119
    v_accvgpr_read_b32 v152, a120
    v_accvgpr_read_b32 v153, a121
    v_accvgpr_read_b32 v154, a122
    v_accvgpr_read_b32 v155, a123
    v_accvgpr_read_b32 v156, a124
    v_accvgpr_read_b32 v157, a125
    v_accvgpr_read_b32 v158, a126
    v_accvgpr_read_b32 v159, a127
    v_accvgpr_read_b32 v160, a128
    v_accvgpr_read_b32 v161, a129
    v_accvgpr_read_b32 v162, a130
    v_accvgpr_read_b32 v163, a131
    v_accvgpr_read_b32 v164, a132
    v_accvgpr_read_b32 v165, a133
    v_accvgpr_read_b32 v166, a134
    v_accvgpr_read_b32 v167, a135
    v_accvgpr_read_b32 v168, a136
    v_accvgpr_read_b32 v169, a137
    v_accvgpr_read_b32 v170, a138
    v_accvgpr_read_b32 v171, a139
    v_accvgpr_read_b32 v172, a140
    v_accvgpr_read_b32 v173, a141
    v_accvgpr_read_b32 v174, a142
    v_accvgpr_read_b32 v175, a143
    v_accvgpr_read_b32 v176, a144
    v_accvgpr_read_b32 v177, a145
    v_accvgpr_read_b32 v178, a146
    v_accvgpr_read_b32 v179, a147
    v_accvgpr_read_b32 v180, a148
    v_accvgpr_read_b32 v181, a149
    v_accvgpr_read_b32 v182, a150
    v_accvgpr_read_b32 v183, a151
    v_accvgpr_read_b32 v184, a152
    v_accvgpr_read_b32 v185, a153
    v_accvgpr_read_b32 v186, a154
    v_accvgpr_read_b32 v187, a155
    v_accvgpr_read_b32 v188, a156
    v_accvgpr_read_b32 v189, a157
    v_accvgpr_read_b32 v190, a158
    v_accvgpr_read_b32 v191, a159
    v_accvgpr_read_b32 v192, a160
    v_accvgpr_read_b32 v193, a161
    v_accvgpr_read_b32 v194, a162
    v_accvgpr_read_b32 v195, a163
    v_accvgpr_read_b32 v196, a164
    v_accvgpr_read_b32 v197, a165
    v_accvgpr_read_b32 v198, a166
    v_accvgpr_read_b32 v199, a167
    v_pk_mul_f32 v[144:145], v[144:145], v[28:29] op_sel_hi:[1,0]
    v_pk_mul_f32 v[146:147], v[146:147], v[28:29] op_sel_hi:[1,0]
    v_pk_mul_f32 v[148:149], v[148:149], v[32:33] op_sel_hi:[1,0]
    v_pk_mul_f32 v[150:151], v[150:151], v[32:33] op_sel_hi:[1,0]
    v_pk_mul_f32 v[152:153], v[152:153], v[36:37] op_sel_hi:[1,0]
    v_pk_mul_f32 v[154:155], v[154:155], v[36:37] op_sel_hi:[1,0]
    v_pk_mul_f32 v[156:157], v[156:157], v[40:41] op_sel_hi:[1,0]
    v_pk_mul_f32 v[158:159], v[158:159], v[40:41] op_sel_hi:[1,0]
    v_pk_mul_f32 v[160:161], v[160:161], v[44:45] op_sel_hi:[1,0]
    v_pk_mul_f32 v[162:163], v[162:163], v[44:45] op_sel_hi:[1,0]
    v_pk_mul_f32 v[164:165], v[164:165], v[48:49] op_sel_hi:[1,0]
    v_pk_mul_f32 v[166:167], v[166:167], v[48:49] op_sel_hi:[1,0]
    v_pk_mul_f32 v[168:169], v[168:169], v[52:53] op_sel_hi:[1,0]
    v_pk_mul_f32 v[170:171], v[170:171], v[52:53] op_sel_hi:[1,0]
    v_pk_mul_f32 v[172:173], v[172:173], v[28:29] op_sel_hi:[1,0]
    v_pk_mul_f32 v[174:175], v[174:175], v[28:29] op_sel_hi:[1,0]
    v_pk_mul_f32 v[176:177], v[176:177], v[32:33] op_sel_hi:[1,0]
    v_pk_mul_f32 v[178:179], v[178:179], v[32:33] op_sel_hi:[1,0]
    v_pk_mul_f32 v[180:181], v[180:181], v[36:37] op_sel_hi:[1,0]
    v_pk_mul_f32 v[182:183], v[182:183], v[36:37] op_sel_hi:[1,0]
    v_pk_mul_f32 v[184:185], v[184:185], v[40:41] op_sel_hi:[1,0]
    v_pk_mul_f32 v[186:187], v[186:187], v[40:41] op_sel_hi:[1,0]
    v_pk_mul_f32 v[188:189], v[188:189], v[44:45] op_sel_hi:[1,0]
    v_pk_mul_f32 v[190:191], v[190:191], v[44:45] op_sel_hi:[1,0]
    v_pk_mul_f32 v[192:193], v[192:193], v[48:49] op_sel_hi:[1,0]
    v_pk_mul_f32 v[194:195], v[194:195], v[48:49] op_sel_hi:[1,0]
    v_pk_mul_f32 v[196:197], v[196:197], v[52:53] op_sel_hi:[1,0]
    v_pk_mul_f32 v[198:199], v[198:199], v[52:53] op_sel_hi:[1,0]
    v_cvt_pk_bf16_f32 v88, v144, v145
    v_cvt_pk_bf16_f32 v89, v146, v147
    v_cvt_pk_bf16_f32 v90, v172, v173
    v_cvt_pk_bf16_f32 v91, v174, v175
    v_cvt_pk_bf16_f32 v92, v148, v149
    v_cvt_pk_bf16_f32 v93, v150, v151
    v_cvt_pk_bf16_f32 v94, v176, v177
    v_cvt_pk_bf16_f32 v95, v178, v179
    v_cvt_pk_bf16_f32 v96, v152, v153
    v_cvt_pk_bf16_f32 v97, v154, v155
    v_cvt_pk_bf16_f32 v98, v180, v181
    v_cvt_pk_bf16_f32 v99, v182, v183
    v_cvt_pk_bf16_f32 v100, v156, v157
    v_cvt_pk_bf16_f32 v101, v158, v159
    v_cvt_pk_bf16_f32 v102, v184, v185
    v_cvt_pk_bf16_f32 v103, v186, v187
    v_cvt_pk_bf16_f32 v104, v160, v161
    v_cvt_pk_bf16_f32 v105, v162, v163
    v_cvt_pk_bf16_f32 v106, v188, v189
    v_cvt_pk_bf16_f32 v107, v190, v191
    v_cvt_pk_bf16_f32 v108, v164, v165
    v_cvt_pk_bf16_f32 v109, v166, v167
    v_cvt_pk_bf16_f32 v110, v192, v193
    v_cvt_pk_bf16_f32 v111, v194, v195
    v_cvt_pk_bf16_f32 v112, v168, v169
    v_cvt_pk_bf16_f32 v113, v170, v171
    v_cvt_pk_bf16_f32 v114, v196, v197
    v_cvt_pk_bf16_f32 v115, v198, v199
    s_nop 1
    v_permlane16_swap_b32 v88, v90
    v_permlane16_swap_b32 v89, v91
    v_permlane16_swap_b32 v92, v94
    v_permlane16_swap_b32 v93, v95
    v_permlane16_swap_b32 v96, v98
    v_permlane16_swap_b32 v97, v99
    v_permlane16_swap_b32 v100, v102
    v_permlane16_swap_b32 v101, v103
    v_permlane16_swap_b32 v104, v106
    v_permlane16_swap_b32 v105, v107
    v_permlane16_swap_b32 v108, v110
    v_permlane16_swap_b32 v109, v111
    v_permlane16_swap_b32 v112, v114
    v_permlane16_swap_b32 v113, v115
    s_mov_b32 s28, s31
    buffer_store_dwordx4 v[88:91], v10, s[12:15], s28 offen offset:2048 sc0 sc1
    s_add_u32 s28, s28, 4096
    buffer_store_dwordx4 v[92:95], v10, s[12:15], s28 offen offset:2048 sc0 sc1
    s_add_u32 s28, s28, 4096
    buffer_store_dwordx4 v[96:99], v10, s[12:15], s28 offen offset:2048 sc0 sc1
    s_add_u32 s28, s28, 4096
    buffer_store_dwordx4 v[100:103], v10, s[12:15], s28 offen offset:2048 sc0 sc1
    s_add_u32 s28, s28, 4096
    buffer_store_dwordx4 v[104:107], v10, s[12:15], s28 offen offset:2048 sc0 sc1
    s_add_u32 s28, s28, 4096
    buffer_store_dwordx4 v[108:111], v10, s[12:15], s28 offen offset:2048 sc0 sc1
    s_add_u32 s28, s28, 4096
    buffer_store_dwordx4 v[112:115], v10, s[12:15], s28 offen offset:2048 sc0 sc1
    v_accvgpr_read_b32 v200, a168
    v_accvgpr_read_b32 v201, a169
    v_accvgpr_read_b32 v202, a170
    v_accvgpr_read_b32 v203, a171
    v_accvgpr_read_b32 v204, a172
    v_accvgpr_read_b32 v205, a173
    v_accvgpr_read_b32 v206, a174
    v_accvgpr_read_b32 v207, a175
    v_accvgpr_read_b32 v208, a176
    v_accvgpr_read_b32 v209, a177
    v_accvgpr_read_b32 v210, a178
    v_accvgpr_read_b32 v211, a179
    v_accvgpr_read_b32 v212, a180
    v_accvgpr_read_b32 v213, a181
    v_accvgpr_read_b32 v214, a182
    v_accvgpr_read_b32 v215, a183
    v_accvgpr_read_b32 v216, a184
    v_accvgpr_read_b32 v217, a185
    v_accvgpr_read_b32 v218, a186
    v_accvgpr_read_b32 v219, a187
    v_accvgpr_read_b32 v220, a188
    v_accvgpr_read_b32 v221, a189
    v_accvgpr_read_b32 v222, a190
    v_accvgpr_read_b32 v223, a191
    v_accvgpr_read_b32 v224, a192
    v_accvgpr_read_b32 v225, a193
    v_accvgpr_read_b32 v226, a194
    v_accvgpr_read_b32 v227, a195
    v_accvgpr_read_b32 v228, a196
    v_accvgpr_read_b32 v229, a197
    v_accvgpr_read_b32 v230, a198
    v_accvgpr_read_b32 v231, a199
    v_accvgpr_read_b32 v232, a200
    v_accvgpr_read_b32 v233, a201
    v_accvgpr_read_b32 v234, a202
    v_accvgpr_read_b32 v235, a203
    v_accvgpr_read_b32 v236, a204
    v_accvgpr_read_b32 v237, a205
    v_accvgpr_read_b32 v238, a206
    v_accvgpr_read_b32 v239, a207
    v_accvgpr_read_b32 v240, a208
    v_accvgpr_read_b32 v241, a209
    v_accvgpr_read_b32 v242, a210
    v_accvgpr_read_b32 v243, a211
    v_accvgpr_read_b32 v244, a212
    v_accvgpr_read_b32 v245, a213
    v_accvgpr_read_b32 v246, a214
    v_accvgpr_read_b32 v247, a215
    v_accvgpr_read_b32 v248, a216
    v_accvgpr_read_b32 v249, a217
    v_accvgpr_read_b32 v250, a218
    v_accvgpr_read_b32 v251, a219
    v_accvgpr_read_b32 v252, a220
    v_accvgpr_read_b32 v253, a221
    v_accvgpr_read_b32 v254, a222
    v_accvgpr_read_b32 v255, a223
    v_pk_mul_f32 v[200:201], v[200:201], v[28:29] op_sel_hi:[1,0]
    v_pk_mul_f32 v[202:203], v[202:203], v[28:29] op_sel_hi:[1,0]
    v_pk_mul_f32 v[204:205], v[204:205], v[32:33] op_sel_hi:[1,0]
    v_pk_mul_f32 v[206:207], v[206:207], v[32:33] op_sel_hi:[1,0]
    v_pk_mul_f32 v[208:209], v[208:209], v[36:37] op_sel_hi:[1,0]
    v_pk_mul_f32 v[210:211], v[210:211], v[36:37] op_sel_hi:[1,0]
    v_pk_mul_f32 v[212:213], v[212:213], v[40:41] op_sel_hi:[1,0]
    v_pk_mul_f32 v[214:215], v[214:215], v[40:41] op_sel_hi:[1,0]
    v_pk_mul_f32 v[216:217], v[216:217], v[44:45] op_sel_hi:[1,0]
    v_pk_mul_f32 v[218:219], v[218:219], v[44:45] op_sel_hi:[1,0]
    v_pk_mul_f32 v[220:221], v[220:221], v[48:49] op_sel_hi:[1,0]
    v_pk_mul_f32 v[222:223], v[222:223], v[48:49] op_sel_hi:[1,0]
    v_pk_mul_f32 v[224:225], v[224:225], v[52:53] op_sel_hi:[1,0]
    v_pk_mul_f32 v[226:227], v[226:227], v[52:53] op_sel_hi:[1,0]
    v_pk_mul_f32 v[228:229], v[228:229], v[28:29] op_sel_hi:[1,0]
    v_pk_mul_f32 v[230:231], v[230:231], v[28:29] op_sel_hi:[1,0]
    v_pk_mul_f32 v[232:233], v[232:233], v[32:33] op_sel_hi:[1,0]
    v_pk_mul_f32 v[234:235], v[234:235], v[32:33] op_sel_hi:[1,0]
    v_pk_mul_f32 v[236:237], v[236:237], v[36:37] op_sel_hi:[1,0]
    v_pk_mul_f32 v[238:239], v[238:239], v[36:37] op_sel_hi:[1,0]
    v_pk_mul_f32 v[240:241], v[240:241], v[40:41] op_sel_hi:[1,0]
    v_pk_mul_f32 v[242:243], v[242:243], v[40:41] op_sel_hi:[1,0]
    v_pk_mul_f32 v[244:245], v[244:245], v[44:45] op_sel_hi:[1,0]
    v_pk_mul_f32 v[246:247], v[246:247], v[44:45] op_sel_hi:[1,0]
    v_pk_mul_f32 v[248:249], v[248:249], v[48:49] op_sel_hi:[1,0]
    v_pk_mul_f32 v[250:251], v[250:251], v[48:49] op_sel_hi:[1,0]
    v_pk_mul_f32 v[252:253], v[252:253], v[52:53] op_sel_hi:[1,0]
    v_pk_mul_f32 v[254:255], v[254:255], v[52:53] op_sel_hi:[1,0]
    v_cvt_pk_bf16_f32 v116, v200, v201
    v_cvt_pk_bf16_f32 v117, v202, v203
    v_cvt_pk_bf16_f32 v118, v228, v229
    v_cvt_pk_bf16_f32 v119, v230, v231
    v_cvt_pk_bf16_f32 v120, v204, v205
    v_cvt_pk_bf16_f32 v121, v206, v207
    v_cvt_pk_bf16_f32 v122, v232, v233
    v_cvt_pk_bf16_f32 v123, v234, v235
    v_cvt_pk_bf16_f32 v124, v208, v209
    v_cvt_pk_bf16_f32 v125, v210, v211
    v_cvt_pk_bf16_f32 v126, v236, v237
    v_cvt_pk_bf16_f32 v127, v238, v239
    v_cvt_pk_bf16_f32 v128, v212, v213
    v_cvt_pk_bf16_f32 v129, v214, v215
    v_cvt_pk_bf16_f32 v130, v240, v241
    v_cvt_pk_bf16_f32 v131, v242, v243
    v_cvt_pk_bf16_f32 v132, v216, v217
    v_cvt_pk_bf16_f32 v133, v218, v219
    v_cvt_pk_bf16_f32 v134, v244, v245
    v_cvt_pk_bf16_f32 v135, v246, v247
    v_cvt_pk_bf16_f32 v136, v220, v221
    v_cvt_pk_bf16_f32 v137, v222, v223
    v_cvt_pk_bf16_f32 v138, v248, v249
    v_cvt_pk_bf16_f32 v139, v250, v251
    v_cvt_pk_bf16_f32 v140, v224, v225
    v_cvt_pk_bf16_f32 v141, v226, v227
    v_cvt_pk_bf16_f32 v142, v252, v253
    v_cvt_pk_bf16_f32 v143, v254, v255
    s_nop 1
    v_permlane16_swap_b32 v116, v118
    v_permlane16_swap_b32 v117, v119
    v_permlane16_swap_b32 v120, v122
    v_permlane16_swap_b32 v121, v123
    v_permlane16_swap_b32 v124, v126
    v_permlane16_swap_b32 v125, v127
    v_permlane16_swap_b32 v128, v130
    v_permlane16_swap_b32 v129, v131
    v_permlane16_swap_b32 v132, v134
    v_permlane16_swap_b32 v133, v135
    v_permlane16_swap_b32 v136, v138
    v_permlane16_swap_b32 v137, v139
    v_permlane16_swap_b32 v140, v142
    v_permlane16_swap_b32 v141, v143
    s_mov_b32 s28, s31
    buffer_store_dwordx4 v[116:119], v10, s[12:15], s28 offen offset:3072 sc0 sc1
    s_add_u32 s28, s28, 4096
    buffer_store_dwordx4 v[120:123], v10, s[12:15], s28 offen offset:3072 sc0 sc1
    s_add_u32 s28, s28, 4096
    buffer_store_dwordx4 v[124:127], v10, s[12:15], s28 offen offset:3072 sc0 sc1
    s_add_u32 s28, s28, 4096
    buffer_store_dwordx4 v[128:131], v10, s[12:15], s28 offen offset:3072 sc0 sc1
    s_add_u32 s28, s28, 4096
    buffer_store_dwordx4 v[132:135], v10, s[12:15], s28 offen offset:3072 sc0 sc1
    s_add_u32 s28, s28, 4096
    buffer_store_dwordx4 v[136:139], v10, s[12:15], s28 offen offset:3072 sc0 sc1
    s_add_u32 s28, s28, 4096
    buffer_store_dwordx4 v[140:143], v10, s[12:15], s28 offen offset:3072 sc0 sc1
    s_nop 1
    s_mov_b32 s68, 3
    s_cmp_lg_u32 s71, 2
    s_cbranch_scc1 L_at_nowo2
    s_mov_b32 s71, 4
    s_mov_b32 s68, 0x303
    v_accvgpr_read_b32 v3, a249
    v_lshlrev_b32 v4, 4, v1
    s_mul_i32 s28, s2, 40960
    s_mul_i32 s29, s20, 10240
    s_add_u32 s28, s28, s29
    s_add_u32 s28, s28, 117440512
    ds_read_b64_tr_b16 v[112:113], v3 offset:0
    ds_read_b64_tr_b16 v[114:115], v3 offset:640
    ds_read_b64_tr_b16 v[116:117], v3 offset:32
    ds_read_b64_tr_b16 v[118:119], v3 offset:672
    ds_read_b64_tr_b16 v[120:121], v3 offset:64
    ds_read_b64_tr_b16 v[122:123], v3 offset:704
    ds_read_b64_tr_b16 v[124:125], v3 offset:96
    ds_read_b64_tr_b16 v[126:127], v3 offset:736
    ds_read_b64_tr_b16 v[128:129], v3 offset:128
    ds_read_b64_tr_b16 v[130:131], v3 offset:768
    buffer_store_dwordx4 a[224:227], v4, s[12:15], s28 offen offset:0 sc0 sc1
    buffer_store_dwordx4 a[228:231], v4, s[12:15], s28 offen offset:1024 sc0 sc1
    buffer_store_dwordx4 a[232:235], v4, s[12:15], s28 offen offset:2048 sc0 sc1
    buffer_store_dwordx4 a[236:239], v4, s[12:15], s28 offen offset:3072 sc0 sc1
    s_add_u32 s28, s28, 4096
    buffer_store_dwordx4 a[240:243], v4, s[12:15], s28 offen offset:0 sc0 sc1
    s_add_u32 s28, s28, 1024
    s_waitcnt lgkmcnt(0)
    buffer_store_dwordx4 v[112:115], v4, s[12:15], s28 offen offset:0 sc0 sc1
    buffer_store_dwordx4 v[116:119], v4, s[12:15], s28 offen offset:1024 sc0 sc1
    buffer_store_dwordx4 v[120:123], v4, s[12:15], s28 offen offset:2048 sc0 sc1
    buffer_store_dwordx4 v[124:127], v4, s[12:15], s28 offen offset:3072 sc0 sc1
    s_add_u32 s28, s28, 4096
    buffer_store_dwordx4 v[128:131], v4, s[12:15], s28 offen offset:0 sc0 sc1
    s_nop 1
L_at_nowo2:
    s_cmp_ge_u32 s21, 2
    s_cbranch_scc1 L_at_fin
    s_cmp_eq_u32 s69, 0
    s_cbranch_scc1 L_at_round
    s_waitcnt vmcnt(38)
    s_branch L_at_pre
L_at_fin:
    s_waitcnt lgkmcnt(0)
    s_barrier
    s_cmp_le_u32 s21, s27
    s_cbranch_scc1 L_at_nofb_7179
    s_sub_u32 s28, s21, 1
    s_cmp_eq_u32 s28, s23
    s_cbranch_scc1 L_at_nofb_7179
    s_lshl_b32 s29, s28, 2
    s_add_u32 s29, s29, 76000
    v_mov_b32 v4, s29
    ds_read_b32 v4, v4
    s_waitcnt lgkmcnt(0)
    v_readfirstlane_b32 s29, v4
    s_nop 3
    s_cmp_lg_u32 s29, 0
    s_cbranch_scc1 L_at_fallback
L_at_nofb_7179:
    s_branch L_at_end
L_bw1_510:
    s_sub_u32 s68, s68, 1
    s_bitcmp1_b32 s68, 8
    s_cbranch_scc1 L_bw3_510
    s_waitcnt vmcnt(44) lgkmcnt(0)
    s_branch L_bw2_510
L_bw3_510:
    s_bitcmp1_b32 s68, 9
    s_cbranch_scc1 L_bw4_510
    s_and_b32 s99, s68, 0xff
    s_cselect_b32 s68, s68, 0
    s_waitcnt vmcnt(21) lgkmcnt(0)
    s_branch L_bw2_510
L_bw4_510:
    s_and_b32 s99, s68, 0xff
    s_cselect_b32 s68, s68, 0
    s_waitcnt vmcnt(54) lgkmcnt(0)
    s_branch L_bw2_510
L_bw1_640:
    s_sub_u32 s68, s68, 1
    s_bitcmp1_b32 s68, 8
    s_cbranch_scc1 L_bw3_640
    s_waitcnt vmcnt(44) lgkmcnt(0)
    s_branch L_bw2_640
L_bw3_640:
    s_bitcmp1_b32 s68, 9
    s_cbranch_scc1 L_bw4_640
    s_and_b32 s99, s68, 0xff
    s_cselect_b32 s68, s68, 0
    s_waitcnt vmcnt(21) lgkmcnt(0)
    s_branch L_bw2_640
L_bw4_640:
    s_and_b32 s99, s68, 0xff
    s_cselect_b32 s68, s68, 0
    s_waitcnt vmcnt(54) lgkmcnt(0)
    s_branch L_bw2_640
L_bw1_755:
    s_sub_u32 s68, s68, 1
    s_bitcmp1_b32 s68, 8
    s_cbranch_scc1 L_bw3_755
    s_waitcnt vmcnt(44) lgkmcnt(0)
    s_branch L_bw2_755
L_bw3_755:
    s_bitcmp1_b32 s68, 9
    s_cbranch_scc1 L_bw4_755
    s_and_b32 s99, s68, 0xff
    s_cselect_b32 s68, s68, 0
    s_waitcnt vmcnt(21) lgkmcnt(0)
    s_branch L_bw2_755
L_bw4_755:
    s_and_b32 s99, s68, 0xff
    s_cselect_b32 s68, s68, 0
    s_waitcnt vmcnt(54) lgkmcnt(0)
    s_branch L_bw2_755
L_bw1_3256:
    s_sub_u32 s68, s68, 1
    s_bitcmp1_b32 s68, 8
    s_cbranch_scc1 L_bw3_3256
    s_waitcnt vmcnt(44) lgkmcnt(0)
    s_branch L_bw2_3256
L_bw3_3256:
    s_bitcmp1_b32 s68, 9
    s_cbranch_scc1 L_bw4_3256
    s_and_b32 s99, s68, 0xff
    s_cselect_b32 s68, s68, 0
    s_waitcnt vmcnt(21) lgkmcnt(0)
    s_branch L_bw2_3256
L_bw4_3256:
    s_and_b32 s99, s68, 0xff
    s_cselect_b32 s68, s68, 0
    s_waitcnt vmcnt(54) lgkmcnt(0)
    s_branch L_bw2_3256
L_bw1_3638:
    s_sub_u32 s68, s68, 1
    s_bitcmp1_b32 s68, 8
    s_cbranch_scc1 L_bw3_3638
    s_waitcnt vmcnt(44) lgkmcnt(0)
    s_branch L_bw2_3638
L_bw3_3638:
    s_bitcmp1_b32 s68, 9
    s_cbranch_scc1 L_bw4_3638
    s_and_b32 s99, s68, 0xff
    s_cselect_b32 s68, s68, 0
    s_waitcnt vmcnt(21) lgkmcnt(0)
    s_branch L_bw2_3638
L_bw4_3638:
    s_and_b32 s99, s68, 0xff
    s_cselect_b32 s68, s68, 0
    s_waitcnt vmcnt(54) lgkmcnt(0)
    s_branch L_bw2_3638
L_bw1_3947:
    s_sub_u32 s68, s68, 1
    s_bitcmp1_b32 s68, 8
    s_cbranch_scc1 L_bw3_3947
    s_waitcnt vmcnt(44) lgkmcnt(0)
    s_branch L_bw2_3947
L_bw3_3947:
    s_bitcmp1_b32 s68, 9
    s_cbranch_scc1 L_bw4_3947
    s_and_b32 s99, s68, 0xff
    s_cselect_b32 s68, s68, 0
    s_waitcnt vmcnt(21) lgkmcnt(0)
    s_branch L_bw2_3947
L_bw4_3947:
    s_and_b32 s99, s68, 0xff
    s_cselect_b32 s68, s68, 0
    s_waitcnt vmcnt(54) lgkmcnt(0)
    s_branch L_bw2_3947
L_at_fallback:
    s_sub_u32 s27, s21, 1
    s_mov_b32 s23, s27
    s_mov_b32 s25, 1
    s_mov_b32 s69, 0
    s_mov_b32 s70, 0
    s_mov_b32 s68, 0
    v_mov_b32 v12, 0xff800000
    v_mov_b32 v14, 0xff800000
    v_mov_b32 v16, 0xff800000
    v_mov_b32 v18, 0xff800000
    v_mov_b32 v20, 0xff800000
    v_mov_b32 v22, 0xff800000
    v_mov_b32 v24, 0xff800000
    s_waitcnt vmcnt(0) lgkmcnt(0)
    s_barrier
    s_branch L_at_start
L_at_maxpass:
    s_mov_b32 s25, 0
    s_waitcnt lgkmcnt(0)
    v_and_b32 v2, 15, v1
    v_lshlrev_b32 v2, 8, v2
    v_bfe_u32 v3, v1, 4, 1
    v_lshl_add_u32 v2, v3, 5, v2
    v_bfe_u32 v3, v1, 5, 1
    v_lshl_add_u32 v4, v3, 4, v2
    v_add_u32 v5, 4096, v4
    s_lshl_b32 s29, s21, 19
    s_mov_b32 s22, 0
L_at_mp:
    buffer_load_dwordx4 v[112:115], v4, s[8:11], s29 offen offset:0
    buffer_load_dwordx4 v[116:119], v4, s[8:11], s29 offen offset:64
    buffer_load_dwordx4 v[120:123], v4, s[8:11], s29 offen offset:128
    buffer_load_dwordx4 v[124:127], v4, s[8:11], s29 offen offset:192
    buffer_load_dwordx4 v[128:131], v5, s[8:11], s29 offen offset:0
    buffer_load_dwordx4 v[132:135], v5, s[8:11], s29 offen offset:64
    buffer_load_dwordx4 v[136:139], v5, s[8:11], s29 offen offset:128
    buffer_load_dwordx4 v[140:143], v5, s[8:11], s29 offen offset:192
    s_waitcnt vmcnt(0)
    v_mfma_f32_16x16x32_bf16 v[88:91], v[112:115], a[0:3], 0
    v_mfma_f32_16x16x32_bf16 v[88:91], v[116:119], a[4:7], v[88:91]
    v_mfma_f32_16x16x32_bf16 v[88:91], v[120:123], a[8:11], v[88:91]
    v_mfma_f32_16x16x32_bf16 v[88:91], v[124:127], a[12:15], v[88:91]
    v_mfma_f32_16x16x32_bf16 v[92:95], v[128:131], a[0:3], 0
    v_mfma_f32_16x16x32_bf16 v[92:95], v[132:135], a[4:7], v[92:95]
    v_mfma_f32_16x16x32_bf16 v[92:95], v[136:139], a[8:11], v[92:95]
    v_mfma_f32_16x16x32_bf16 v[92:95], v[140:143], a[12:15], v[92:95]
    s_nop 9
    v_max3_f32 v12, v88, v89, v12
    v_max3_f32 v12, v90, v91, v12
    v_max3_f32 v12, v92, v93, v12
    v_max3_f32 v12, v94, v95, v12
    s_nop 3
    v_mfma_f32_16x16x32_bf16 v[88:91], v[112:115], a[16:19], 0
    v_mfma_f32_16x16x32_bf16 v[88:91], v[116:119], a[20:23], v[88:91]
    v_mfma_f32_16x16x32_bf16 v[88:91], v[120:123], a[24:27], v[88:91]
    v_mfma_f32_16x16x32_bf16 v[88:91], v[124:127], a[28:31], v[88:91]
    v_mfma_f32_16x16x32_bf16 v[92:95], v[128:131], a[16:19], 0
    v_mfma_f32_16x16x32_bf16 v[92:95], v[132:135], a[20:23], v[92:95]
    v_mfma_f32_16x16x32_bf16 v[92:95], v[136:139], a[24:27], v[92:95]
    v_mfma_f32_16x16x32_bf16 v[92:95], v[140:143], a[28:31], v[92:95]
    s_nop 9
    v_max3_f32 v14, v88, v89, v14
    v_max3_f32 v14, v90, v91, v14
    v_max3_f32 v14, v92, v93, v14
    v_max3_f32 v14, v94, v95, v14
    s_nop 3
    v_mfma_f32_16x16x32_bf16 v[88:91], v[112:115], a[32:35], 0
    v_mfma_f32_16x16x32_bf16 v[88:91], v[116:119], a[36:39], v[88:91]
    v_mfma_f32_16x16x32_bf16 v[88:91], v[120:123], a[40:43], v[88:91]
    v_mfma_f32_16x16x32_bf16 v[88:91], v[124:127], a[44:47], v[88:91]
    v_mfma_f32_16x16x32_bf16 v[92:95], v[128:131], a[32:35], 0
    v_mfma_f32_16x16x32_bf16 v[92:95], v[132:135], a[36:39], v[92:95]
    v_mfma_f32_16x16x32_bf16 v[92:95], v[136:139], a[40:43], v[92:95]
    v_mfma_f32_16x16x32_bf16 v[92:95], v[140:143], a[44:47], v[92:95]
    s_nop 9
    v_max3_f32 v16, v88, v89, v16
    v_max3_f32 v16, v90, v91, v16
    v_max3_f32 v16, v92, v93, v16
    v_max3_f32 v16, v94, v95, v16
    s_nop 3
    v_mfma_f32_16x16x32_bf16 v[88:91], v[112:115], a[48:51], 0
    v_mfma_f32_16x16x32_bf16 v[88:91], v[116:119], a[52:55], v[88:91]
    v_mfma_f32_16x16x32_bf16 v[88:91], v[120:123], a[56:59], v[88:91]
    v_mfma_f32_16x16x32_bf16 v[88:91], v[124:127], a[60:63], v[88:91]
    v_mfma_f32_16x16x32_bf16 v[92:95], v[128:131], a[48:51], 0
    v_mfma_f32_16x16x32_bf16 v[92:95], v[132:135], a[52:55], v[92:95]
    v_mfma_f32_16x16x32_bf16 v[92:95], v[136:139], a[56:59], v[92:95]
    v_mfma_f32_16x16x32_bf16 v[92:95], v[140:143], a[60:63], v[92:95]
    s_nop 9
    v_max3_f32 v18, v88, v89, v18
    v_max3_f32 v18, v90, v91, v18
    v_max3_f32 v18, v92, v93, v18
    v_max3_f32 v18, v94, v95, v18
    s_nop 3
    v_mfma_f32_16x16x32_bf16 v[88:91], v[112:115], a[64:67], 0
    v_mfma_f32_16x16x32_bf16 v[88:91], v[116:119], a[68:71], v[88:91]
    v_mfma_f32_16x16x32_bf16 v[88:91], v[120:123], a[72:75], v[88:91]
    v_mfma_f32_16x16x32_bf16 v[88:91], v[124:127], a[76:79], v[88:91]
    v_mfma_f32_16x16x32_bf16 v[92:95], v[128:131], a[64:67], 0
    v_mfma_f32_16x16x32_bf16 v[92:95], v[132:135], a[68:71], v[92:95]
    v_mfma_f32_16x16x32_bf16 v[92:95], v[136:139], a[72:75], v[92:95]
    v_mfma_f32_16x16x32_bf16 v[92:95], v[140:143], a[76:79], v[92:95]
    s_nop 9
    v_max3_f32 v20, v88, v89, v20
    v_max3_f32 v20, v90, v91, v20
    v_max3_f32 v20, v92, v93, v20
    v_max3_f32 v20, v94, v95, v20
    s_nop 3
    v_mfma_f32_16x16x32_bf16 v[88:91], v[112:115], a[80:83], 0
    v_mfma_f32_16x16x32_bf16 v[88:91], v[116:119], a[84:87], v[88:91]
    v_mfma_f32_16x16x32_bf16 v[88:91], v[120:123], a[88:91], v[88:91]
    v_mfma_f32_16x16x32_bf16 v[88:91], v[124:127], a[92:95], v[88:91]
    v_mfma_f32_16x16x32_bf16 v[92:95], v[128:131], a[80:83], 0
    v_mfma_f32_16x16x32_bf16 v[92:95], v[132:135], a[84:87], v[92:95]
    v_mfma_f32_16x16x32_bf16 v[92:95], v[136:139], a[88:91], v[92:95]
    v_mfma_f32_16x16x32_bf16 v[92:95], v[140:143], a[92:95], v[92:95]
    s_nop 9
    v_max3_f32 v22, v88, v89, v22
    v_max3_f32 v22, v90, v91, v22
    v_max3_f32 v22, v92, v93, v22
    v_max3_f32 v22, v94, v95, v22
    s_nop 3
    v_mfma_f32_16x16x32_bf16 v[88:91], v[112:115], a[96:99], 0
    v_mfma_f32_16x16x32_bf16 v[88:91], v[116:119], a[100:103], v[88:91]
    v_mfma_f32_16x16x32_bf16 v[88:91], v[120:123], a[104:107], v[88:91]
    v_mfma_f32_16x16x32_bf16 v[88:91], v[124:127], a[108:111], v[88:91]
    v_mfma_f32_16x16x32_bf16 v[92:95], v[128:131], a[96:99], 0
    v_mfma_f32_16x16x32_bf16 v[92:95], v[132:135], a[100:103], v[92:95]
    v_mfma_f32_16x16x32_bf16 v[92:95], v[136:139], a[104:107], v[92:95]
    v_mfma_f32_16x16x32_bf16 v[92:95], v[140:143], a[108:111], v[92:95]
    s_nop 9
    v_max3_f32 v24, v88, v89, v24
    v_max3_f32 v24, v90, v91, v24
    v_max3_f32 v24, v92, v93, v24
    v_max3_f32 v24, v94, v95, v24
    s_nop 3
    s_add_u32 s29, s29, 8192
    s_add_u32 s22, s22, 1
    s_cmp_lt_u32 s22, 32
    s_cbranch_scc1 L_at_mp
    s_branch L_at_pre
L_at_end:
    s_endpgm
.globl op_kernel
.p2align 8
.type op_kernel,@function
op_kernel:
    s_cmp_ge_u32 s2, 256
    s_cbranch_scc1 L_op_end
    s_load_dwordx2 s[36:37], s[0:1], 32
    s_load_dwordx2 s[38:39], s[0:1], 72
    s_load_dwordx2 s[40:41], s[0:1], 80
    s_load_dwordx2 s[44:45], s[0:1], 96
    v_and_b32 v1, 63, v0
    v_lshrrev_b32 v2, 6, v0
    s_nop 0
    v_readfirstlane_b32 s20, v2
    s_and_b32 s3, s2, 7
    s_lshl_b32 s3, s3, 3
    s_lshr_b32 s30, s2, 5
    s_add_u32 s3, s3, s30
    s_bfe_u32 s31, s2, 0x20003
    s_waitcnt lgkmcnt(0)
    s_cmp_ge_u32 s3, 32
    s_add_u32 s44, s44, 0
    s_addc_u32 s45, s45, 0
    s_mov_b32 s8, s44
    s_mov_b32 s9, s45
    s_mov_b32 s10, 127926272
    s_mov_b32 s11, 0x20000
    s_mov_b32 s4, s44
    s_mov_b32 s5, s45
    s_mov_b32 s6, 127926272
    s_mov_b32 s7, 0x20000
    s_mov_b32 s12, s40
    s_mov_b32 s13, s41
    s_mov_b32 s14, 9175040
    s_mov_b32 s15, 0x20000
    s_lshr_b32 s22, s3, 1
    s_mul_i32 s22, s22, 1835008
    s_and_b32 s23, s3, 1
    s_mul_i32 s23, s23, 28672
    s_add_u32 s22, s22, s23
    s_lshl_b32 s23, s20, 10
    s_add_u32 s22, s22, s23
    s_add_u32 s25, s22, 58720256
    s_lshr_b32 s22, s3, 5
    s_lshl_b32 s22, s22, 7
    s_add_u32 s22, s22, s20
    s_mul_i32 s22, s22, 40960
    s_mul_i32 s23, s31, 10240
    s_add_u32 s22, s22, s23
    s_add_u32 s26, s22, 117440512
    s_mul_i32 s27, s20, 40960
    v_lshlrev_b32 v6, 4, v1
    v_add_u32 v7, s27, v6
    v_bfe_u32 v4, v1, 4, 1
    v_lshlrev_b32 v4, 5, v4
    v_and_b32 v2, 15, v1
    v_mul_u32_u24 v2, 2560, v2
    v_add_u32 v2, v2, v4
    v_bfe_u32 v4, v1, 5, 1
    v_lshl_add_u32 v9, v4, 4, v2
    s_add_u32 m0, s27, 0
    s_mov_b32 s23, s26
    buffer_load_dwordx4 v6, s[8:11], s23 offen offset:0 lds
    buffer_load_dwordx4 v6, s[8:11], s23 offen offset:1024 lds
    buffer_load_dwordx4 v6, s[8:11], s23 offen offset:2048 lds
    buffer_load_dwordx4 v6, s[8:11], s23 offen offset:3072 lds
    s_add_u32 m0, s27, 4096
    s_add_u32 s23, s23, 4096
    buffer_load_dwordx4 v6, s[8:11], s23 offen offset:0 lds
    buffer_load_dwordx4 v6, s[8:11], s23 offen offset:1024 lds
    buffer_load_dwordx4 v6, s[8:11], s23 offen offset:2048 lds
    buffer_load_dwordx4 v6, s[8:11], s23 offen offset:3072 lds
    s_add_u32 m0, s27, 8192
    s_add_u32 s23, s23, 4096
    buffer_load_dwordx4 v6, s[8:11], s23 offen offset:0 lds
    buffer_load_dwordx4 v6, s[8:11], s23 offen offset:1024 lds
    s_add_u32 s26, s26, 163840
    s_mov_b32 s22, s25
    buffer_load_dwordx4 v[84:87], v6, s[4:7], s22 offen
    s_add_u32 s22, s22, 4096
    buffer_load_dwordx4 v[88:91], v6, s[4:7], s22 offen
    s_add_u32 s22, s22, 4096
    buffer_load_dwordx4 v[92:95], v6, s[4:7], s22 offen
    s_add_u32 s22, s22, 4096
    buffer_load_dwordx4 v[96:99], v6, s[4:7], s22 offen
    s_add_u32 s22, s22, 4096
    buffer_load_dwordx4 v[100:103], v6, s[4:7], s22 offen
    s_add_u32 s22, s22, 4096
    buffer_load_dwordx4 v[104:107], v6, s[4:7], s22 offen
    s_add_u32 s22, s22, 4096
    buffer_load_dwordx4 v[108:111], v6, s[4:7], s22 offen
    s_add_u32 s25, s25, 57344
    s_add_u32 m0, s27, 10240
    s_mov_b32 s23, s26
    buffer_load_dwordx4 v6, s[8:11], s23 offen offset:0 lds
    buffer_load_dwordx4 v6, s[8:11], s23 offen offset:1024 lds
    buffer_load_dwordx4 v6, s[8:11], s23 offen offset:2048 lds
    buffer_load_dwordx4 v6, s[8:11], s23 offen offset:3072 lds
    s_add_u32 m0, s27, 14336
    s_add_u32 s23, s23, 4096
    buffer_load_dwordx4 v6, s[8:11], s23 offen offset:0 lds
    buffer_load_dwordx4 v6, s[8:11], s23 offen offset:1024 lds
    buffer_load_dwordx4 v6, s[8:11], s23 offen offset:2048 lds
    buffer_load_dwordx4 v6, s[8:11], s23 offen offset:3072 lds
    s_add_u32 m0, s27, 18432
    s_add_u32 s23, s23, 4096
    buffer_load_dwordx4 v6, s[8:11], s23 offen offset:0 lds
    buffer_load_dwordx4 v6, s[8:11], s23 offen offset:1024 lds
    s_add_u32 s26, s26, 163840
    s_lshl_b32 s22, s20, 11
    v_add_u32 v2, s22, v6
    v_add_u32 v3, 40960, v2
    v_add_u32 v4, 81920, v2
    v_add_u32 v5, 122880, v2
    s_and_b32 s22, s3, 31
    s_mul_i32 s22, s22, 286720
    s_lshr_b32 s32, s3, 5
    s_mul_i32 s32, s32, 1280
    s_add_u32 s22, s22, s32
    s_mul_i32 s32, s31, 320
    s_add_u32 s24, s22, s32
    s_waitcnt vmcnt(17)
    ds_read_b128 v[44:47], v7 offset:0
    ds_read_b128 v[48:51], v7 offset:1024
    ds_read_b128 v[52:55], v7 offset:2048
    ds_read_b128 v[56:59], v7 offset:3072
    ds_read_b128 v[60:63], v7 offset:4096
    ds_read_b128 v[64:67], v7 offset:5120
    ds_read_b128 v[68:71], v7 offset:6144
    ds_read_b128 v[72:75], v7 offset:7168
    ds_read_b128 v[76:79], v7 offset:8192
    ds_read_b128 v[80:83], v7 offset:9216
    s_waitcnt vmcnt(0) lgkmcnt(7)
    v_mfma_f32_16x16x32_bf16 a[0:3], v[44:47], v[84:87], 0
    s_mov_b32 s22, s25
    v_mfma_f32_16x16x32_bf16 a[4:7], v[44:47], v[88:91], 0
    buffer_load_dwordx4 v[112:115], v6, s[4:7], s22 offen
    v_mfma_f32_16x16x32_bf16 a[8:11], v[44:47], v[92:95], 0
    s_add_u32 s22, s22, 4096
    v_mfma_f32_16x16x32_bf16 a[12:15], v[44:47], v[96:99], 0
    buffer_load_dwordx4 v[116:119], v6, s[4:7], s22 offen
    v_mfma_f32_16x16x32_bf16 a[16:19], v[44:47], v[100:103], 0
    s_add_u32 s22, s22, 4096
    v_mfma_f32_16x16x32_bf16 a[20:23], v[44:47], v[104:107], 0
    buffer_load_dwordx4 v[120:123], v6, s[4:7], s22 offen
    v_mfma_f32_16x16x32_bf16 a[24:27], v[44:47], v[108:111], 0
    ds_read_b128 v[44:47], v7 offset:10240
    v_mfma_f32_16x16x32_bf16 a[28:31], v[48:51], v[84:87], 0
    s_add_u32 s22, s22, 4096
    v_mfma_f32_16x16x32_bf16 a[32:35], v[48:51], v[88:91], 0
    buffer_load_dwordx4 v[124:127], v6, s[4:7], s22 offen
    v_mfma_f32_16x16x32_bf16 a[36:39], v[48:51], v[92:95], 0
    s_add_u32 s22, s22, 4096
    v_mfma_f32_16x16x32_bf16 a[40:43], v[48:51], v[96:99], 0
    buffer_load_dwordx4 v[128:131], v6, s[4:7], s22 offen
    v_mfma_f32_16x16x32_bf16 a[44:47], v[48:51], v[100:103], 0
    s_add_u32 s22, s22, 4096
    v_mfma_f32_16x16x32_bf16 a[48:51], v[48:51], v[104:107], 0
    buffer_load_dwordx4 v[132:135], v6, s[4:7], s22 offen
    v_mfma_f32_16x16x32_bf16 a[52:55], v[48:51], v[108:111], 0
    ds_read_b128 v[48:51], v7 offset:11264
    s_waitcnt lgkmcnt(2)
    v_mfma_f32_16x16x32_bf16 a[56:59], v[52:55], v[84:87], 0
    s_add_u32 s22, s22, 4096
    v_mfma_f32_16x16x32_bf16 a[60:63], v[52:55], v[88:91], 0
    buffer_load_dwordx4 v[136:139], v6, s[4:7], s22 offen
    v_mfma_f32_16x16x32_bf16 a[64:67], v[52:55], v[92:95], 0
    s_add_u32 s25, s25, 57344
    v_mfma_f32_16x16x32_bf16 a[68:71], v[52:55], v[96:99], 0
    s_add_u32 m0, s27, 20480
    v_mfma_f32_16x16x32_bf16 a[72:75], v[52:55], v[100:103], 0
    s_mov_b32 s23, s26
    v_mfma_f32_16x16x32_bf16 a[76:79], v[52:55], v[104:107], 0
    buffer_load_dwordx4 v6, s[8:11], s23 offen offset:0 lds
    v_mfma_f32_16x16x32_bf16 a[80:83], v[52:55], v[108:111], 0
    ds_read_b128 v[52:55], v7 offset:12288
    v_mfma_f32_16x16x32_bf16 a[84:87], v[56:59], v[84:87], 0
    buffer_load_dwordx4 v6, s[8:11], s23 offen offset:1024 lds
    v_mfma_f32_16x16x32_bf16 a[88:91], v[56:59], v[88:91], 0
    buffer_load_dwordx4 v6, s[8:11], s23 offen offset:2048 lds
    v_mfma_f32_16x16x32_bf16 a[92:95], v[56:59], v[92:95], 0
    buffer_load_dwordx4 v6, s[8:11], s23 offen offset:3072 lds
    v_mfma_f32_16x16x32_bf16 a[96:99], v[56:59], v[96:99], 0
    s_add_u32 m0, s27, 24576
    v_mfma_f32_16x16x32_bf16 a[100:103], v[56:59], v[100:103], 0
    s_add_u32 s23, s23, 4096
    v_mfma_f32_16x16x32_bf16 a[104:107], v[56:59], v[104:107], 0
    buffer_load_dwordx4 v6, s[8:11], s23 offen offset:0 lds
    v_mfma_f32_16x16x32_bf16 a[108:111], v[56:59], v[108:111], 0
    ds_read_b128 v[56:59], v7 offset:13312
    v_mfma_f32_16x16x32_bf16 a[112:115], v[60:63], v[84:87], 0
    buffer_load_dwordx4 v6, s[8:11], s23 offen offset:1024 lds
    v_mfma_f32_16x16x32_bf16 a[116:119], v[60:63], v[88:91], 0
    buffer_load_dwordx4 v6, s[8:11], s23 offen offset:2048 lds
    v_mfma_f32_16x16x32_bf16 a[120:123], v[60:63], v[92:95], 0
    buffer_load_dwordx4 v6, s[8:11], s23 offen offset:3072 lds
    v_mfma_f32_16x16x32_bf16 a[124:127], v[60:63], v[96:99], 0
    s_add_u32 m0, s27, 28672
    v_mfma_f32_16x16x32_bf16 a[128:131], v[60:63], v[100:103], 0
    s_add_u32 s23, s23, 4096
    v_mfma_f32_16x16x32_bf16 a[132:135], v[60:63], v[104:107], 0
    buffer_load_dwordx4 v6, s[8:11], s23 offen offset:0 lds
    v_mfma_f32_16x16x32_bf16 a[136:139], v[60:63], v[108:111], 0
    ds_read_b128 v[60:63], v7 offset:14336
    v_mfma_f32_16x16x32_bf16 a[140:143], v[64:67], v[84:87], 0
    buffer_load_dwordx4 v6, s[8:11], s23 offen offset:1024 lds
    v_mfma_f32_16x16x32_bf16 a[144:147], v[64:67], v[88:91], 0
    s_add_u32 s26, s26, 163840
    v_mfma_f32_16x16x32_bf16 a[148:151], v[64:67], v[92:95], 0
    s_mov_b32 s22, s25
    v_mfma_f32_16x16x32_bf16 a[152:155], v[64:67], v[96:99], 0
    buffer_load_dwordx4 v[140:143], v6, s[4:7], s22 offen
    v_mfma_f32_16x16x32_bf16 a[156:159], v[64:67], v[100:103], 0
    s_add_u32 s22, s22, 4096
    v_mfma_f32_16x16x32_bf16 a[160:163], v[64:67], v[104:107], 0
    buffer_load_dwordx4 v[144:147], v6, s[4:7], s22 offen
    v_mfma_f32_16x16x32_bf16 a[164:167], v[64:67], v[108:111], 0
    ds_read_b128 v[64:67], v7 offset:15360
    v_mfma_f32_16x16x32_bf16 a[168:171], v[68:71], v[84:87], 0
    s_add_u32 s22, s22, 4096
    v_mfma_f32_16x16x32_bf16 a[172:175], v[68:71], v[88:91], 0
    buffer_load_dwordx4 v[148:151], v6, s[4:7], s22 offen
    v_mfma_f32_16x16x32_bf16 a[176:179], v[68:71], v[92:95], 0
    s_add_u32 s22, s22, 4096
    v_mfma_f32_16x16x32_bf16 a[180:183], v[68:71], v[96:99], 0
    buffer_load_dwordx4 v[152:155], v6, s[4:7], s22 offen
    v_mfma_f32_16x16x32_bf16 a[184:187], v[68:71], v[100:103], 0
    s_add_u32 s22, s22, 4096
    v_mfma_f32_16x16x32_bf16 a[188:191], v[68:71], v[104:107], 0
    buffer_load_dwordx4 v[156:159], v6, s[4:7], s22 offen
    v_mfma_f32_16x16x32_bf16 a[192:195], v[68:71], v[108:111], 0
    ds_read_b128 v[68:71], v7 offset:16384
    v_mfma_f32_16x16x32_bf16 a[196:199], v[72:75], v[84:87], 0
    s_add_u32 s22, s22, 4096
    v_mfma_f32_16x16x32_bf16 a[200:203], v[72:75], v[88:91], 0
    buffer_load_dwordx4 v[160:163], v6, s[4:7], s22 offen
    v_mfma_f32_16x16x32_bf16 a[204:207], v[72:75], v[92:95], 0
    s_add_u32 s22, s22, 4096
    v_mfma_f32_16x16x32_bf16 a[208:211], v[72:75], v[96:99], 0
    buffer_load_dwordx4 v[164:167], v6, s[4:7], s22 offen
    v_mfma_f32_16x16x32_bf16 a[212:215], v[72:75], v[100:103], 0
    s_add_u32 s25, s25, 57344
    v_mfma_f32_16x16x32_bf16 a[216:219], v[72:75], v[104:107], 0
    v_mfma_f32_16x16x32_bf16 a[220:223], v[72:75], v[108:111], 0
    ds_read_b128 v[72:75], v7 offset:17408
    v_mfma_f32_16x16x32_bf16 a[224:227], v[76:79], v[84:87], 0
    v_mfma_f32_16x16x32_bf16 a[228:231], v[76:79], v[88:91], 0
    v_mfma_f32_16x16x32_bf16 a[232:235], v[76:79], v[92:95], 0
    v_mfma_f32_16x16x32_bf16 a[236:239], v[76:79], v[96:99], 0
    v_mfma_f32_16x16x32_bf16 a[240:243], v[76:79], v[100:103], 0
    v_mfma_f32_16x16x32_bf16 a[244:247], v[76:79], v[104:107], 0
    v_mfma_f32_16x16x32_bf16 a[248:251], v[76:79], v[108:111], 0
    ds_read_b128 v[76:79], v7 offset:18432
    v_mfma_f32_16x16x32_bf16 a[252:255], v[80:83], v[84:87], 0
    v_mfma_f32_16x16x32_bf16 v[20:23], v[80:83], v[88:91], 0
    v_mfma_f32_16x16x32_bf16 v[24:27], v[80:83], v[92:95], 0
    v_mfma_f32_16x16x32_bf16 v[28:31], v[80:83], v[96:99], 0
    v_mfma_f32_16x16x32_bf16 v[32:35], v[80:83], v[100:103], 0
    v_mfma_f32_16x16x32_bf16 v[36:39], v[80:83], v[104:107], 0
    v_mfma_f32_16x16x32_bf16 v[40:43], v[80:83], v[108:111], 0
    ds_read_b128 v[80:83], v7 offset:19456
    s_waitcnt vmcnt(7) lgkmcnt(7)
    v_mfma_f32_16x16x32_bf16 a[0:3], v[44:47], v[112:115], a[0:3]
    v_mfma_f32_16x16x32_bf16 a[4:7], v[44:47], v[116:119], a[4:7]
    v_mfma_f32_16x16x32_bf16 a[8:11], v[44:47], v[120:123], a[8:11]
    v_mfma_f32_16x16x32_bf16 a[12:15], v[44:47], v[124:127], a[12:15]
    v_mfma_f32_16x16x32_bf16 a[16:19], v[44:47], v[128:131], a[16:19]
    v_mfma_f32_16x16x32_bf16 a[20:23], v[44:47], v[132:135], a[20:23]
    v_mfma_f32_16x16x32_bf16 a[24:27], v[44:47], v[136:139], a[24:27]
    ds_read_b128 v[44:47], v7 offset:20480
    v_mfma_f32_16x16x32_bf16 a[28:31], v[48:51], v[112:115], a[28:31]
    v_mfma_f32_16x16x32_bf16 a[32:35], v[48:51], v[116:119], a[32:35]
    v_mfma_f32_16x16x32_bf16 a[36:39], v[48:51], v[120:123], a[36:39]
    v_mfma_f32_16x16x32_bf16 a[40:43], v[48:51], v[124:127], a[40:43]
    v_mfma_f32_16x16x32_bf16 a[44:47], v[48:51], v[128:131], a[44:47]
    v_mfma_f32_16x16x32_bf16 a[48:51], v[48:51], v[132:135], a[48:51]
    v_mfma_f32_16x16x32_bf16 a[52:55], v[48:51], v[136:139], a[52:55]
    ds_read_b128 v[48:51], v7 offset:21504
    s_waitcnt lgkmcnt(2)
    v_mfma_f32_16x16x32_bf16 a[56:59], v[52:55], v[112:115], a[56:59]
    s_add_u32 m0, s27, 30720
    v_mfma_f32_16x16x32_bf16 a[60:63], v[52:55], v[116:119], a[60:63]
    s_mov_b32 s23, s26
    v_mfma_f32_16x16x32_bf16 a[64:67], v[52:55], v[120:123], a[64:67]
    buffer_load_dwordx4 v6, s[8:11], s23 offen offset:0 lds
    v_mfma_f32_16x16x32_bf16 a[68:71], v[52:55], v[124:127], a[68:71]
    buffer_load_dwordx4 v6, s[8:11], s23 offen offset:1024 lds
    v_mfma_f32_16x16x32_bf16 a[72:75], v[52:55], v[128:131], a[72:75]
    buffer_load_dwordx4 v6, s[8:11], s23 offen offset:2048 lds
    v_mfma_f32_16x16x32_bf16 a[76:79], v[52:55], v[132:135], a[76:79]
    buffer_load_dwordx4 v6, s[8:11], s23 offen offset:3072 lds
    v_mfma_f32_16x16x32_bf16 a[80:83], v[52:55], v[136:139], a[80:83]
    ds_read_b128 v[52:55], v7 offset:22528
    v_mfma_f32_16x16x32_bf16 a[84:87], v[56:59], v[112:115], a[84:87]
    s_add_u32 m0, s27, 34816
    v_mfma_f32_16x16x32_bf16 a[88:91], v[56:59], v[116:119], a[88:91]
    s_add_u32 s23, s23, 4096
    v_mfma_f32_16x16x32_bf16 a[92:95], v[56:59], v[120:123], a[92:95]
    buffer_load_dwordx4 v6, s[8:11], s23 offen offset:0 lds
    v_mfma_f32_16x16x32_bf16 a[96:99], v[56:59], v[124:127], a[96:99]
    buffer_load_dwordx4 v6, s[8:11], s23 offen offset:1024 lds
    v_mfma_f32_16x16x32_bf16 a[100:103], v[56:59], v[128:131], a[100:103]
    buffer_load_dwordx4 v6, s[8:11], s23 offen offset:2048 lds
    v_mfma_f32_16x16x32_bf16 a[104:107], v[56:59], v[132:135], a[104:107]
    buffer_load_dwordx4 v6, s[8:11], s23 offen offset:3072 lds
    v_mfma_f32_16x16x32_bf16 a[108:111], v[56:59], v[136:139], a[108:111]
    ds_read_b128 v[56:59], v7 offset:23552
    v_mfma_f32_16x16x32_bf16 a[112:115], v[60:63], v[112:115], a[112:115]
    s_add_u32 m0, s27, 38912
    v_mfma_f32_16x16x32_bf16 a[116:119], v[60:63], v[116:119], a[116:119]
    s_add_u32 s23, s23, 4096
    v_mfma_f32_16x16x32_bf16 a[120:123], v[60:63], v[120:123], a[120:123]
    buffer_load_dwordx4 v6, s[8:11], s23 offen offset:0 lds
    v_mfma_f32_16x16x32_bf16 a[124:127], v[60:63], v[124:127], a[124:127]
    buffer_load_dwordx4 v6, s[8:11], s23 offen offset:1024 lds
    v_mfma_f32_16x16x32_bf16 a[128:131], v[60:63], v[128:131], a[128:131]
    s_add_u32 s26, s26, 163840
    v_mfma_f32_16x16x32_bf16 a[132:135], v[60:63], v[132:135], a[132:135]
    s_mov_b32 s22, s25
    v_mfma_f32_16x16x32_bf16 a[136:139], v[60:63], v[136:139], a[136:139]
    ds_read_b128 v[60:63], v7 offset:24576
    v_mfma_f32_16x16x32_bf16 a[140:143], v[64:67], v[112:115], a[140:143]
    buffer_load_dwordx4 v[168:171], v6, s[4:7], s22 offen
    v_mfma_f32_16x16x32_bf16 a[144:147], v[64:67], v[116:119], a[144:147]
    s_add_u32 s22, s22, 4096
    v_mfma_f32_16x16x32_bf16 a[148:151], v[64:67], v[120:123], a[148:151]
    buffer_load_dwordx4 v[172:175], v6, s[4:7], s22 offen
    v_mfma_f32_16x16x32_bf16 a[152:155], v[64:67], v[124:127], a[152:155]
    s_add_u32 s22, s22, 4096
    v_mfma_f32_16x16x32_bf16 a[156:159], v[64:67], v[128:131], a[156:159]
    buffer_load_dwordx4 v[176:179], v6, s[4:7], s22 offen
    v_mfma_f32_16x16x32_bf16 a[160:163], v[64:67], v[132:135], a[160:163]
    s_add_u32 s22, s22, 4096
    v_mfma_f32_16x16x32_bf16 a[164:167], v[64:67], v[136:139], a[164:167]
    ds_read_b128 v[64:67], v7 offset:25600
    v_mfma_f32_16x16x32_bf16 a[168:171], v[68:71], v[112:115], a[168:171]
    buffer_load_dwordx4 v[180:183], v6, s[4:7], s22 offen
    v_mfma_f32_16x16x32_bf16 a[172:175], v[68:71], v[116:119], a[172:175]
    s_add_u32 s22, s22, 4096
    v_mfma_f32_16x16x32_bf16 a[176:179], v[68:71], v[120:123], a[176:179]
    buffer_load_dwordx4 v[184:187], v6, s[4:7], s22 offen
    v_mfma_f32_16x16x32_bf16 a[180:183], v[68:71], v[124:127], a[180:183]
    s_add_u32 s22, s22, 4096
    v_mfma_f32_16x16x32_bf16 a[184:187], v[68:71], v[128:131], a[184:187]
    buffer_load_dwordx4 v[188:191], v6, s[4:7], s22 offen
    v_mfma_f32_16x16x32_bf16 a[188:191], v[68:71], v[132:135], a[188:191]
    s_add_u32 s22, s22, 4096
    v_mfma_f32_16x16x32_bf16 a[192:195], v[68:71], v[136:139], a[192:195]
    ds_read_b128 v[68:71], v7 offset:26624
    v_mfma_f32_16x16x32_bf16 a[196:199], v[72:75], v[112:115], a[196:199]
    buffer_load_dwordx4 v[192:195], v6, s[4:7], s22 offen
    v_mfma_f32_16x16x32_bf16 a[200:203], v[72:75], v[116:119], a[200:203]
    s_add_u32 s25, s25, 57344
    v_mfma_f32_16x16x32_bf16 a[204:207], v[72:75], v[120:123], a[204:207]
    s_add_u32 m0, s27, 0
    v_mfma_f32_16x16x32_bf16 a[208:211], v[72:75], v[124:127], a[208:211]
    s_mov_b32 s23, s26
    v_mfma_f32_16x16x32_bf16 a[212:215], v[72:75], v[128:131], a[212:215]
    buffer_load_dwordx4 v6, s[8:11], s23 offen offset:0 lds
    v_mfma_f32_16x16x32_bf16 a[216:219], v[72:75], v[132:135], a[216:219]
    buffer_load_dwordx4 v6, s[8:11], s23 offen offset:1024 lds
    v_mfma_f32_16x16x32_bf16 a[220:223], v[72:75], v[136:139], a[220:223]
    ds_read_b128 v[72:75], v7 offset:27648
    v_mfma_f32_16x16x32_bf16 a[224:227], v[76:79], v[112:115], a[224:227]
    buffer_load_dwordx4 v6, s[8:11], s23 offen offset:2048 lds
    v_mfma_f32_16x16x32_bf16 a[228:231], v[76:79], v[116:119], a[228:231]
    buffer_load_dwordx4 v6, s[8:11], s23 offen offset:3072 lds
    v_mfma_f32_16x16x32_bf16 a[232:235], v[76:79], v[120:123], a[232:235]
    s_add_u32 m0, s27, 4096
    v_mfma_f32_16x16x32_bf16 a[236:239], v[76:79], v[124:127], a[236:239]
    s_add_u32 s23, s23, 4096
    v_mfma_f32_16x16x32_bf16 a[240:243], v[76:79], v[128:131], a[240:243]
    buffer_load_dwordx4 v6, s[8:11], s23 offen offset:0 lds
    v_mfma_f32_16x16x32_bf16 a[244:247], v[76:79], v[132:135], a[244:247]
    buffer_load_dwordx4 v6, s[8:11], s23 offen offset:1024 lds
    v_mfma_f32_16x16x32_bf16 a[248:251], v[76:79], v[136:139], a[248:251]
    ds_read_b128 v[76:79], v7 offset:28672
    v_mfma_f32_16x16x32_bf16 a[252:255], v[80:83], v[112:115], a[252:255]
    buffer_load_dwordx4 v6, s[8:11], s23 offen offset:2048 lds
    v_mfma_f32_16x16x32_bf16 v[20:23], v[80:83], v[116:119], v[20:23]
    buffer_load_dwordx4 v6, s[8:11], s23 offen offset:3072 lds
    v_mfma_f32_16x16x32_bf16 v[24:27], v[80:83], v[120:123], v[24:27]
    s_add_u32 m0, s27, 8192
    v_mfma_f32_16x16x32_bf16 v[28:31], v[80:83], v[124:127], v[28:31]
    s_add_u32 s23, s23, 4096
    v_mfma_f32_16x16x32_bf16 v[32:35], v[80:83], v[128:131], v[32:35]
    buffer_load_dwordx4 v6, s[8:11], s23 offen offset:0 lds
    v_mfma_f32_16x16x32_bf16 v[36:39], v[80:83], v[132:135], v[36:39]
    buffer_load_dwordx4 v6, s[8:11], s23 offen offset:1024 lds
    v_mfma_f32_16x16x32_bf16 v[40:43], v[80:83], v[136:139], v[40:43]
    ds_read_b128 v[80:83], v7 offset:29696
    s_add_u32 s26, s26, 163840
    s_waitcnt vmcnt(17) lgkmcnt(7)
    v_mfma_f32_16x16x32_bf16 a[0:3], v[44:47], v[140:143], a[0:3]
    s_mov_b32 s22, s25
    v_mfma_f32_16x16x32_bf16 a[4:7], v[44:47], v[144:147], a[4:7]
    buffer_load_dwordx4 v[84:87], v6, s[4:7], s22 offen
    v_mfma_f32_16x16x32_bf16 a[8:11], v[44:47], v[148:151], a[8:11]
    s_add_u32 s22, s22, 4096
    v_mfma_f32_16x16x32_bf16 a[12:15], v[44:47], v[152:155], a[12:15]
    buffer_load_dwordx4 v[88:91], v6, s[4:7], s22 offen
    v_mfma_f32_16x16x32_bf16 a[16:19], v[44:47], v[156:159], a[16:19]
    s_add_u32 s22, s22, 4096
    v_mfma_f32_16x16x32_bf16 a[20:23], v[44:47], v[160:163], a[20:23]
    buffer_load_dwordx4 v[92:95], v6, s[4:7], s22 offen
    v_mfma_f32_16x16x32_bf16 a[24:27], v[44:47], v[164:167], a[24:27]
    ds_read_b128 v[44:47], v7 offset:30720
    v_mfma_f32_16x16x32_bf16 a[28:31], v[48:51], v[140:143], a[28:31]
    s_add_u32 s22, s22, 4096
    v_mfma_f32_16x16x32_bf16 a[32:35], v[48:51], v[144:147], a[32:35]
    buffer_load_dwordx4 v[96:99], v6, s[4:7], s22 offen
    v_mfma_f32_16x16x32_bf16 a[36:39], v[48:51], v[148:151], a[36:39]
    s_add_u32 s22, s22, 4096
    v_mfma_f32_16x16x32_bf16 a[40:43], v[48:51], v[152:155], a[40:43]
    buffer_load_dwordx4 v[100:103], v6, s[4:7], s22 offen
    v_mfma_f32_16x16x32_bf16 a[44:47], v[48:51], v[156:159], a[44:47]
    s_add_u32 s22, s22, 4096
    v_mfma_f32_16x16x32_bf16 a[48:51], v[48:51], v[160:163], a[48:51]
    buffer_load_dwordx4 v[104:107], v6, s[4:7], s22 offen
    v_mfma_f32_16x16x32_bf16 a[52:55], v[48:51], v[164:167], a[52:55]
    ds_read_b128 v[48:51], v7 offset:31744
    s_waitcnt lgkmcnt(2)
    v_mfma_f32_16x16x32_bf16 a[56:59], v[52:55], v[140:143], a[56:59]
    s_add_u32 s22, s22, 4096
    v_mfma_f32_16x16x32_bf16 a[60:63], v[52:55], v[144:147], a[60:63]
    buffer_load_dwordx4 v[108:111], v6, s[4:7], s22 offen
    v_mfma_f32_16x16x32_bf16 a[64:67], v[52:55], v[148:151], a[64:67]
    s_add_u32 s25, s25, 57344
    v_mfma_f32_16x16x32_bf16 a[68:71], v[52:55], v[152:155], a[68:71]
    s_add_u32 m0, s27, 10240
    v_mfma_f32_16x16x32_bf16 a[72:75], v[52:55], v[156:159], a[72:75]
    s_mov_b32 s23, s26
    v_mfma_f32_16x16x32_bf16 a[76:79], v[52:55], v[160:163], a[76:79]
    buffer_load_dwordx4 v6, s[8:11], s23 offen offset:0 lds
    v_mfma_f32_16x16x32_bf16 a[80:83], v[52:55], v[164:167], a[80:83]
    ds_read_b128 v[52:55], v7 offset:32768
    v_mfma_f32_16x16x32_bf16 a[84:87], v[56:59], v[140:143], a[84:87]
    buffer_load_dwordx4 v6, s[8:11], s23 offen offset:1024 lds
    v_mfma_f32_16x16x32_bf16 a[88:91], v[56:59], v[144:147], a[88:91]
    buffer_load_dwordx4 v6, s[8:11], s23 offen offset:2048 lds
    v_mfma_f32_16x16x32_bf16 a[92:95], v[56:59], v[148:151], a[92:95]
    buffer_load_dwordx4 v6, s[8:11], s23 offen offset:3072 lds
    v_mfma_f32_16x16x32_bf16 a[96:99], v[56:59], v[152:155], a[96:99]
    s_add_u32 m0, s27, 14336
    v_mfma_f32_16x16x32_bf16 a[100:103], v[56:59], v[156:159], a[100:103]
    s_add_u32 s23, s23, 4096
    v_mfma_f32_16x16x32_bf16 a[104:107], v[56:59], v[160:163], a[104:107]
    buffer_load_dwordx4 v6, s[8:11], s23 offen offset:0 lds
    v_mfma_f32_16x16x32_bf16 a[108:111], v[56:59], v[164:167], a[108:111]
    ds_read_b128 v[56:59], v7 offset:33792
    v_mfma_f32_16x16x32_bf16 a[112:115], v[60:63], v[140:143], a[112:115]
    buffer_load_dwordx4 v6, s[8:11], s23 offen offset:1024 lds
    v_mfma_f32_16x16x32_bf16 a[116:119], v[60:63], v[144:147], a[116:119]
    buffer_load_dwordx4 v6, s[8:11], s23 offen offset:2048 lds
    v_mfma_f32_16x16x32_bf16 a[120:123], v[60:63], v[148:151], a[120:123]
    buffer_load_dwordx4 v6, s[8:11], s23 offen offset:3072 lds
    v_mfma_f32_16x16x32_bf16 a[124:127], v[60:63], v[152:155], a[124:127]
    s_add_u32 m0, s27, 18432
    v_mfma_f32_16x16x32_bf16 a[128:131], v[60:63], v[156:159], a[128:131]
    s_add_u32 s23, s23, 4096
    v_mfma_f32_16x16x32_bf16 a[132:135], v[60:63], v[160:163], a[132:135]
    buffer_load_dwordx4 v6, s[8:11], s23 offen offset:0 lds
    v_mfma_f32_16x16x32_bf16 a[136:139], v[60:63], v[164:167], a[136:139]
    ds_read_b128 v[60:63], v7 offset:34816
    v_mfma_f32_16x16x32_bf16 a[140:143], v[64:67], v[140:143], a[140:143]
    buffer_load_dwordx4 v6, s[8:11], s23 offen offset:1024 lds
    v_mfma_f32_16x16x32_bf16 a[144:147], v[64:67], v[144:147], a[144:147]
    s_add_u32 s26, s26, 163840
    v_mfma_f32_16x16x32_bf16 a[148:151], v[64:67], v[148:151], a[148:151]
    s_mov_b32 s22, s25
    v_mfma_f32_16x16x32_bf16 a[152:155], v[64:67], v[152:155], a[152:155]
    buffer_load_dwordx4 v[112:115], v6, s[4:7], s22 offen
    v_mfma_f32_16x16x32_bf16 a[156:159], v[64:67], v[156:159], a[156:159]
    s_add_u32 s22, s22, 4096
    v_mfma_f32_16x16x32_bf16 a[160:163], v[64:67], v[160:163], a[160:163]
    buffer_load_dwordx4 v[116:119], v6, s[4:7], s22 offen
    v_mfma_f32_16x16x32_bf16 a[164:167], v[64:67], v[164:167], a[164:167]
    ds_read_b128 v[64:67], v7 offset:35840
    v_mfma_f32_16x16x32_bf16 a[168:171], v[68:71], v[140:143], a[168:171]
    s_add_u32 s22, s22, 4096
    v_mfma_f32_16x16x32_bf16 a[172:175], v[68:71], v[144:147], a[172:175]
    buffer_load_dwordx4 v[120:123], v6, s[4:7], s22 offen
    v_mfma_f32_16x16x32_bf16 a[176:179], v[68:71], v[148:151], a[176:179]
    s_add_u32 s22, s22, 4096
    v_mfma_f32_16x16x32_bf16 a[180:183], v[68:71], v[152:155], a[180:183]
    buffer_load_dwordx4 v[124:127], v6, s[4:7], s22 offen
    v_mfma_f32_16x16x32_bf16 a[184:187], v[68:71], v[156:159], a[184:187]
    s_add_u32 s22, s22, 4096
    v_mfma_f32_16x16x32_bf16 a[188:191], v[68:71], v[160:163], a[188:191]
    buffer_load_dwordx4 v[128:131], v6, s[4:7], s22 offen
    v_mfma_f32_16x16x32_bf16 a[192:195], v[68:71], v[164:167], a[192:195]
    ds_read_b128 v[68:71], v7 offset:36864
    v_mfma_f32_16x16x32_bf16 a[196:199], v[72:75], v[140:143], a[196:199]
    s_add_u32 s22, s22, 4096
    v_mfma_f32_16x16x32_bf16 a[200:203], v[72:75], v[144:147], a[200:203]
    buffer_load_dwordx4 v[132:135], v6, s[4:7], s22 offen
    v_mfma_f32_16x16x32_bf16 a[204:207], v[72:75], v[148:151], a[204:207]
    s_add_u32 s22, s22, 4096
    v_mfma_f32_16x16x32_bf16 a[208:211], v[72:75], v[152:155], a[208:211]
    buffer_load_dwordx4 v[136:139], v6, s[4:7], s22 offen
    v_mfma_f32_16x16x32_bf16 a[212:215], v[72:75], v[156:159], a[212:215]
    s_add_u32 s25, s25, 57344
    v_mfma_f32_16x16x32_bf16 a[216:219], v[72:75], v[160:163], a[216:219]
    v_mfma_f32_16x16x32_bf16 a[220:223], v[72:75], v[164:167], a[220:223]
    ds_read_b128 v[72:75], v7 offset:37888
    v_mfma_f32_16x16x32_bf16 a[224:227], v[76:79], v[140:143], a[224:227]
    v_mfma_f32_16x16x32_bf16 a[228:231], v[76:79], v[144:147], a[228:231]
    v_mfma_f32_16x16x32_bf16 a[232:235], v[76:79], v[148:151], a[232:235]
    v_mfma_f32_16x16x32_bf16 a[236:239], v[76:79], v[152:155], a[236:239]
    v_mfma_f32_16x16x32_bf16 a[240:243], v[76:79], v[156:159], a[240:243]
    v_mfma_f32_16x16x32_bf16 a[244:247], v[76:79], v[160:163], a[244:247]
    v_mfma_f32_16x16x32_bf16 a[248:251], v[76:79], v[164:167], a[248:251]
    ds_read_b128 v[76:79], v7 offset:38912
    v_mfma_f32_16x16x32_bf16 a[252:255], v[80:83], v[140:143], a[252:255]
    v_mfma_f32_16x16x32_bf16 v[20:23], v[80:83], v[144:147], v[20:23]
    v_mfma_f32_16x16x32_bf16 v[24:27], v[80:83], v[148:151], v[24:27]
    v_mfma_f32_16x16x32_bf16 v[28:31], v[80:83], v[152:155], v[28:31]
    v_mfma_f32_16x16x32_bf16 v[32:35], v[80:83], v[156:159], v[32:35]
    v_mfma_f32_16x16x32_bf16 v[36:39], v[80:83], v[160:163], v[36:39]
    v_mfma_f32_16x16x32_bf16 v[40:43], v[80:83], v[164:167], v[40:43]
    ds_read_b128 v[80:83], v7 offset:39936
    s_waitcnt vmcnt(24) lgkmcnt(7)
    v_mfma_f32_16x16x32_bf16 a[0:3], v[44:47], v[168:171], a[0:3]
    v_mfma_f32_16x16x32_bf16 a[4:7], v[44:47], v[172:175], a[4:7]
    v_mfma_f32_16x16x32_bf16 a[8:11], v[44:47], v[176:179], a[8:11]
    v_mfma_f32_16x16x32_bf16 a[12:15], v[44:47], v[180:183], a[12:15]
    v_mfma_f32_16x16x32_bf16 a[16:19], v[44:47], v[184:187], a[16:19]
    v_mfma_f32_16x16x32_bf16 a[20:23], v[44:47], v[188:191], a[20:23]
    v_mfma_f32_16x16x32_bf16 a[24:27], v[44:47], v[192:195], a[24:27]
    ds_read_b128 v[44:47], v7 offset:0
    v_mfma_f32_16x16x32_bf16 a[28:31], v[48:51], v[168:171], a[28:31]
    v_mfma_f32_16x16x32_bf16 a[32:35], v[48:51], v[172:175], a[32:35]
    v_mfma_f32_16x16x32_bf16 a[36:39], v[48:51], v[176:179], a[36:39]
    v_mfma_f32_16x16x32_bf16 a[40:43], v[48:51], v[180:183], a[40:43]
    v_mfma_f32_16x16x32_bf16 a[44:47], v[48:51], v[184:187], a[44:47]
    v_mfma_f32_16x16x32_bf16 a[48:51], v[48:51], v[188:191], a[48:51]
    v_mfma_f32_16x16x32_bf16 a[52:55], v[48:51], v[192:195], a[52:55]
    ds_read_b128 v[48:51], v7 offset:1024
    s_waitcnt lgkmcnt(2)
    v_mfma_f32_16x16x32_bf16 a[56:59], v[52:55], v[168:171], a[56:59]
    s_add_u32 m0, s27, 20480
    v_mfma_f32_16x16x32_bf16 a[60:63], v[52:55], v[172:175], a[60:63]
    s_mov_b32 s23, s26
    v_mfma_f32_16x16x32_bf16 a[64:67], v[52:55], v[176:179], a[64:67]
    buffer_load_dwordx4 v6, s[8:11], s23 offen offset:0 lds
    v_mfma_f32_16x16x32_bf16 a[68:71], v[52:55], v[180:183], a[68:71]
    buffer_load_dwordx4 v6, s[8:11], s23 offen offset:1024 lds
    v_mfma_f32_16x16x32_bf16 a[72:75], v[52:55], v[184:187], a[72:75]
    buffer_load_dwordx4 v6, s[8:11], s23 offen offset:2048 lds
    v_mfma_f32_16x16x32_bf16 a[76:79], v[52:55], v[188:191], a[76:79]
    buffer_load_dwordx4 v6, s[8:11], s23 offen offset:3072 lds
    v_mfma_f32_16x16x32_bf16 a[80:83], v[52:55], v[192:195], a[80:83]
    ds_read_b128 v[52:55], v7 offset:2048
    v_mfma_f32_16x16x32_bf16 a[84:87], v[56:59], v[168:171], a[84:87]
    s_add_u32 m0, s27, 24576
    v_mfma_f32_16x16x32_bf16 a[88:91], v[56:59], v[172:175], a[88:91]
    s_add_u32 s23, s23, 4096
    v_mfma_f32_16x16x32_bf16 a[92:95], v[56:59], v[176:179], a[92:95]
    buffer_load_dwordx4 v6, s[8:11], s23 offen offset:0 lds
    v_mfma_f32_16x16x32_bf16 a[96:99], v[56:59], v[180:183], a[96:99]
    buffer_load_dwordx4 v6, s[8:11], s23 offen offset:1024 lds
    v_mfma_f32_16x16x32_bf16 a[100:103], v[56:59], v[184:187], a[100:103]
    buffer_load_dwordx4 v6, s[8:11], s23 offen offset:2048 lds
    v_mfma_f32_16x16x32_bf16 a[104:107], v[56:59], v[188:191], a[104:107]
    buffer_load_dwordx4 v6, s[8:11], s23 offen offset:3072 lds
    v_mfma_f32_16x16x32_bf16 a[108:111], v[56:59], v[192:195], a[108:111]
    ds_read_b128 v[56:59], v7 offset:3072
    v_mfma_f32_16x16x32_bf16 a[112:115], v[60:63], v[168:171], a[112:115]
    s_add_u32 m0, s27, 28672
    v_mfma_f32_16x16x32_bf16 a[116:119], v[60:63], v[172:175], a[116:119]
    s_add_u32 s23, s23, 4096
    v_mfma_f32_16x16x32_bf16 a[120:123], v[60:63], v[176:179], a[120:123]
    buffer_load_dwordx4 v6, s[8:11], s23 offen offset:0 lds
    v_mfma_f32_16x16x32_bf16 a[124:127], v[60:63], v[180:183], a[124:127]
    buffer_load_dwordx4 v6, s[8:11], s23 offen offset:1024 lds
    v_mfma_f32_16x16x32_bf16 a[128:131], v[60:63], v[184:187], a[128:131]
    s_add_u32 s26, s26, 163840
    v_mfma_f32_16x16x32_bf16 a[132:135], v[60:63], v[188:191], a[132:135]
    s_mov_b32 s22, s25
    v_mfma_f32_16x16x32_bf16 a[136:139], v[60:63], v[192:195], a[136:139]
    ds_read_b128 v[60:63], v7 offset:4096
    v_mfma_f32_16x16x32_bf16 a[140:143], v[64:67], v[168:171], a[140:143]
    buffer_load_dwordx4 v[140:143], v6, s[4:7], s22 offen
    v_mfma_f32_16x16x32_bf16 a[144:147], v[64:67], v[172:175], a[144:147]
    s_add_u32 s22, s22, 4096
    v_mfma_f32_16x16x32_bf16 a[148:151], v[64:67], v[176:179], a[148:151]
    buffer_load_dwordx4 v[144:147], v6, s[4:7], s22 offen
    v_mfma_f32_16x16x32_bf16 a[152:155], v[64:67], v[180:183], a[152:155]
    s_add_u32 s22, s22, 4096
    v_mfma_f32_16x16x32_bf16 a[156:159], v[64:67], v[184:187], a[156:159]
    buffer_load_dwordx4 v[148:151], v6, s[4:7], s22 offen
    v_mfma_f32_16x16x32_bf16 a[160:163], v[64:67], v[188:191], a[160:163]
    s_add_u32 s22, s22, 4096
    v_mfma_f32_16x16x32_bf16 a[164:167], v[64:67], v[192:195], a[164:167]
    ds_read_b128 v[64:67], v7 offset:5120
    v_mfma_f32_16x16x32_bf16 a[168:171], v[68:71], v[168:171], a[168:171]
    buffer_load_dwordx4 v[152:155], v6, s[4:7], s22 offen
    v_mfma_f32_16x16x32_bf16 a[172:175], v[68:71], v[172:175], a[172:175]
    s_add_u32 s22, s22, 4096
    v_mfma_f32_16x16x32_bf16 a[176:179], v[68:71], v[176:179], a[176:179]
    buffer_load_dwordx4 v[156:159], v6, s[4:7], s22 offen
    v_mfma_f32_16x16x32_bf16 a[180:183], v[68:71], v[180:183], a[180:183]
    s_add_u32 s22, s22, 4096
    v_mfma_f32_16x16x32_bf16 a[184:187], v[68:71], v[184:187], a[184:187]
    buffer_load_dwordx4 v[160:163], v6, s[4:7], s22 offen
    v_mfma_f32_16x16x32_bf16 a[188:191], v[68:71], v[188:191], a[188:191]
    s_add_u32 s22, s22, 4096
    v_mfma_f32_16x16x32_bf16 a[192:195], v[68:71], v[192:195], a[192:195]
    ds_read_b128 v[68:71], v7 offset:6144
    v_mfma_f32_16x16x32_bf16 a[196:199], v[72:75], v[168:171], a[196:199]
    buffer_load_dwordx4 v[164:167], v6, s[4:7], s22 offen
    v_mfma_f32_16x16x32_bf16 a[200:203], v[72:75], v[172:175], a[200:203]
    s_add_u32 s25, s25, 57344
    v_mfma_f32_16x16x32_bf16 a[204:207], v[72:75], v[176:179], a[204:207]
    s_add_u32 m0, s27, 30720
    v_mfma_f32_16x16x32_bf16 a[208:211], v[72:75], v[180:183], a[208:211]
    s_mov_b32 s23, s26
    v_mfma_f32_16x16x32_bf16 a[212:215], v[72:75], v[184:187], a[212:215]
    buffer_load_dwordx4 v6, s[8:11], s23 offen offset:0 lds
    v_mfma_f32_16x16x32_bf16 a[216:219], v[72:75], v[188:191], a[216:219]
    buffer_load_dwordx4 v6, s[8:11], s23 offen offset:1024 lds
    v_mfma_f32_16x16x32_bf16 a[220:223], v[72:75], v[192:195], a[220:223]
    ds_read_b128 v[72:75], v7 offset:7168
    v_mfma_f32_16x16x32_bf16 a[224:227], v[76:79], v[168:171], a[224:227]
    buffer_load_dwordx4 v6, s[8:11], s23 offen offset:2048 lds
    v_mfma_f32_16x16x32_bf16 a[228:231], v[76:79], v[172:175], a[228:231]
    buffer_load_dwordx4 v6, s[8:11], s23 offen offset:3072 lds
    v_mfma_f32_16x16x32_bf16 a[232:235], v[76:79], v[176:179], a[232:235]
    s_add_u32 m0, s27, 34816
    v_mfma_f32_16x16x32_bf16 a[236:239], v[76:79], v[180:183], a[236:239]
    s_add_u32 s23, s23, 4096
    v_mfma_f32_16x16x32_bf16 a[240:243], v[76:79], v[184:187], a[240:243]
    buffer_load_dwordx4 v6, s[8:11], s23 offen offset:0 lds
    v_mfma_f32_16x16x32_bf16 a[244:247], v[76:79], v[188:191], a[244:247]
    buffer_load_dwordx4 v6, s[8:11], s23 offen offset:1024 lds
    v_mfma_f32_16x16x32_bf16 a[248:251], v[76:79], v[192:195], a[248:251]
    ds_read_b128 v[76:79], v7 offset:8192
    v_mfma_f32_16x16x32_bf16 a[252:255], v[80:83], v[168:171], a[252:255]
    buffer_load_dwordx4 v6, s[8:11], s23 offen offset:2048 lds
    v_mfma_f32_16x16x32_bf16 v[20:23], v[80:83], v[172:175], v[20:23]
    buffer_load_dwordx4 v6, s[8:11], s23 offen offset:3072 lds
    v_mfma_f32_16x16x32_bf16 v[24:27], v[80:83], v[176:179], v[24:27]
    s_add_u32 m0, s27, 38912
    v_mfma_f32_16x16x32_bf16 v[28:31], v[80:83], v[180:183], v[28:31]
    s_add_u32 s23, s23, 4096
    v_mfma_f32_16x16x32_bf16 v[32:35], v[80:83], v[184:187], v[32:35]
    buffer_load_dwordx4 v6, s[8:11], s23 offen offset:0 lds
    v_mfma_f32_16x16x32_bf16 v[36:39], v[80:83], v[188:191], v[36:39]
    buffer_load_dwordx4 v6, s[8:11], s23 offen offset:1024 lds
    v_mfma_f32_16x16x32_bf16 v[40:43], v[80:83], v[192:195], v[40:43]
    ds_read_b128 v[80:83], v7 offset:9216
    s_add_u32 s26, s26, 163840
    s_mov_b32 s21, 0
L_op_loop:
    s_waitcnt vmcnt(34) lgkmcnt(7)
    v_mfma_f32_16x16x32_bf16 a[0:3], v[44:47], v[84:87], a[0:3]
    s_mov_b32 s22, s25
    v_mfma_f32_16x16x32_bf16 a[4:7], v[44:47], v[88:91], a[4:7]
    buffer_load_dwordx4 v[168:171], v6, s[4:7], s22 offen
    v_mfma_f32_16x16x32_bf16 a[8:11], v[44:47], v[92:95], a[8:11]
    s_add_u32 s22, s22, 4096
    v_mfma_f32_16x16x32_bf16 a[12:15], v[44:47], v[96:99], a[12:15]
    buffer_load_dwordx4 v[172:175], v6, s[4:7], s22 offen
    v_mfma_f32_16x16x32_bf16 a[16:19], v[44:47], v[100:103], a[16:19]
    s_add_u32 s22, s22, 4096
    v_mfma_f32_16x16x32_bf16 a[20:23], v[44:47], v[104:107], a[20:23]
    buffer_load_dwordx4 v[176:179], v6, s[4:7], s22 offen
    v_mfma_f32_16x16x32_bf16 a[24:27], v[44:47], v[108:111], a[24:27]
    ds_read_b128 v[44:47], v7 offset:10240
    v_mfma_f32_16x16x32_bf16 a[28:31], v[48:51], v[84:87], a[28:31]
    s_add_u32 s22, s22, 4096
    v_mfma_f32_16x16x32_bf16 a[32:35], v[48:51], v[88:91], a[32:35]
    buffer_load_dwordx4 v[180:183], v6, s[4:7], s22 offen
    v_mfma_f32_16x16x32_bf16 a[36:39], v[48:51], v[92:95], a[36:39]
    s_add_u32 s22, s22, 4096
    v_mfma_f32_16x16x32_bf16 a[40:43], v[48:51], v[96:99], a[40:43]
    buffer_load_dwordx4 v[184:187], v6, s[4:7], s22 offen
    v_mfma_f32_16x16x32_bf16 a[44:47], v[48:51], v[100:103], a[44:47]
    s_add_u32 s22, s22, 4096
    v_mfma_f32_16x16x32_bf16 a[48:51], v[48:51], v[104:107], a[48:51]
    buffer_load_dwordx4 v[188:191], v6, s[4:7], s22 offen
    v_mfma_f32_16x16x32_bf16 a[52:55], v[48:51], v[108:111], a[52:55]
    ds_read_b128 v[48:51], v7 offset:11264
    s_waitcnt lgkmcnt(2)
    v_mfma_f32_16x16x32_bf16 a[56:59], v[52:55], v[84:87], a[56:59]
    s_add_u32 s22, s22, 4096
    v_mfma_f32_16x16x32_bf16 a[60:63], v[52:55], v[88:91], a[60:63]
    buffer_load_dwordx4 v[192:195], v6, s[4:7], s22 offen
    v_mfma_f32_16x16x32_bf16 a[64:67], v[52:55], v[92:95], a[64:67]
    s_add_u32 s25, s25, 57344
    v_mfma_f32_16x16x32_bf16 a[68:71], v[52:55], v[96:99], a[68:71]
    s_add_u32 m0, s27, 0
    v_mfma_f32_16x16x32_bf16 a[72:75], v[52:55], v[100:103], a[72:75]
    s_mov_b32 s23, s26
    v_mfma_f32_16x16x32_bf16 a[76:79], v[52:55], v[104:107], a[76:79]
    buffer_load_dwordx4 v6, s[8:11], s23 offen offset:0 lds
    v_mfma_f32_16x16x32_bf16 a[80:83], v[52:55], v[108:111], a[80:83]
    ds_read_b128 v[52:55], v7 offset:12288
    v_mfma_f32_16x16x32_bf16 a[84:87], v[56:59], v[84:87], a[84:87]
    buffer_load_dwordx4 v6, s[8:11], s23 offen offset:1024 lds
    v_mfma_f32_16x16x32_bf16 a[88:91], v[56:59], v[88:91], a[88:91]
    buffer_load_dwordx4 v6, s[8:11], s23 offen offset:2048 lds
    v_mfma_f32_16x16x32_bf16 a[92:95], v[56:59], v[92:95], a[92:95]
    buffer_load_dwordx4 v6, s[8:11], s23 offen offset:3072 lds
    v_mfma_f32_16x16x32_bf16 a[96:99], v[56:59], v[96:99], a[96:99]
    s_add_u32 m0, s27, 4096
    v_mfma_f32_16x16x32_bf16 a[100:103], v[56:59], v[100:103], a[100:103]
    s_add_u32 s23, s23, 4096
    v_mfma_f32_16x16x32_bf16 a[104:107], v[56:59], v[104:107], a[104:107]
    buffer_load_dwordx4 v6, s[8:11], s23 offen offset:0 lds
    v_mfma_f32_16x16x32_bf16 a[108:111], v[56:59], v[108:111], a[108:111]
    ds_read_b128 v[56:59], v7 offset:13312
    v_mfma_f32_16x16x32_bf16 a[112:115], v[60:63], v[84:87], a[112:115]
    buffer_load_dwordx4 v6, s[8:11], s23 offen offset:1024 lds
    v_mfma_f32_16x16x32_bf16 a[116:119], v[60:63], v[88:91], a[116:119]
    buffer_load_dwordx4 v6, s[8:11], s23 offen offset:2048 lds
    v_mfma_f32_16x16x32_bf16 a[120:123], v[60:63], v[92:95], a[120:123]
    buffer_load_dwordx4 v6, s[8:11], s23 offen offset:3072 lds
    v_mfma_f32_16x16x32_bf16 a[124:127], v[60:63], v[96:99], a[124:127]
    s_add_u32 m0, s27, 8192
    v_mfma_f32_16x16x32_bf16 a[128:131], v[60:63], v[100:103], a[128:131]
    s_add_u32 s23, s23, 4096
    v_mfma_f32_16x16x32_bf16 a[132:135], v[60:63], v[104:107], a[132:135]
    buffer_load_dwordx4 v6, s[8:11], s23 offen offset:0 lds
    v_mfma_f32_16x16x32_bf16 a[136:139], v[60:63], v[108:111], a[136:139]
    ds_read_b128 v[60:63], v7 offset:14336
    v_mfma_f32_16x16x32_bf16 a[140:143], v[64:67], v[84:87], a[140:143]
    buffer_load_dwordx4 v6, s[8:11], s23 offen offset:1024 lds
    v_mfma_f32_16x16x32_bf16 a[144:147], v[64:67], v[88:91], a[144:147]
    s_add_u32 s26, s26, 163840
    v_mfma_f32_16x16x32_bf16 a[148:151], v[64:67], v[92:95], a[148:151]
    v_mfma_f32_16x16x32_bf16 a[152:155], v[64:67], v[96:99], a[152:155]
    v_mfma_f32_16x16x32_bf16 a[156:159], v[64:67], v[100:103], a[156:159]
    v_mfma_f32_16x16x32_bf16 a[160:163], v[64:67], v[104:107], a[160:163]
    v_mfma_f32_16x16x32_bf16 a[164:167], v[64:67], v[108:111], a[164:167]
    ds_read_b128 v[64:67], v7 offset:15360
    v_mfma_f32_16x16x32_bf16 a[168:171], v[68:71], v[84:87], a[168:171]
    v_mfma_f32_16x16x32_bf16 a[172:175], v[68:71], v[88:91], a[172:175]
    v_mfma_f32_16x16x32_bf16 a[176:179], v[68:71], v[92:95], a[176:179]
    v_mfma_f32_16x16x32_bf16 a[180:183], v[68:71], v[96:99], a[180:183]
    v_mfma_f32_16x16x32_bf16 a[184:187], v[68:71], v[100:103], a[184:187]
    v_mfma_f32_16x16x32_bf16 a[188:191], v[68:71], v[104:107], a[188:191]
    v_mfma_f32_16x16x32_bf16 a[192:195], v[68:71], v[108:111], a[192:195]
    ds_read_b128 v[68:71], v7 offset:16384
    v_mfma_f32_16x16x32_bf16 a[196:199], v[72:75], v[84:87], a[196:199]
    v_mfma_f32_16x16x32_bf16 a[200:203], v[72:75], v[88:91], a[200:203]
    v_mfma_f32_16x16x32_bf16 a[204:207], v[72:75], v[92:95], a[204:207]
    v_mfma_f32_16x16x32_bf16 a[208:211], v[72:75], v[96:99], a[208:211]
    v_mfma_f32_16x16x32_bf16 a[212:215], v[72:75], v[100:103], a[212:215]
    v_mfma_f32_16x16x32_bf16 a[216:219], v[72:75], v[104:107], a[216:219]
    v_mfma_f32_16x16x32_bf16 a[220:223], v[72:75], v[108:111], a[220:223]
    ds_read_b128 v[72:75], v7 offset:17408
    v_mfma_f32_16x16x32_bf16 a[224:227], v[76:79], v[84:87], a[224:227]
    v_mfma_f32_16x16x32_bf16 a[228:231], v[76:79], v[88:91], a[228:231]
    v_mfma_f32_16x16x32_bf16 a[232:235], v[76:79], v[92:95], a[232:235]
    v_mfma_f32_16x16x32_bf16 a[236:239], v[76:79], v[96:99], a[236:239]
    v_mfma_f32_16x16x32_bf16 a[240:243], v[76:79], v[100:103], a[240:243]
    v_mfma_f32_16x16x32_bf16 a[244:247], v[76:79], v[104:107], a[244:247]
    v_mfma_f32_16x16x32_bf16 a[248:251], v[76:79], v[108:111], a[248:251]
    ds_read_b128 v[76:79], v7 offset:18432
    v_mfma_f32_16x16x32_bf16 a[252:255], v[80:83], v[84:87], a[252:255]
    v_mfma_f32_16x16x32_bf16 v[20:23], v[80:83], v[88:91], v[20:23]
    v_mfma_f32_16x16x32_bf16 v[24:27], v[80:83], v[92:95], v[24:27]
    v_mfma_f32_16x16x32_bf16 v[28:31], v[80:83], v[96:99], v[28:31]
    v_mfma_f32_16x16x32_bf16 v[32:35], v[80:83], v[100:103], v[32:35]
    v_mfma_f32_16x16x32_bf16 v[36:39], v[80:83], v[104:107], v[36:39]
    v_mfma_f32_16x16x32_bf16 v[40:43], v[80:83], v[108:111], v[40:43]
    ds_read_b128 v[80:83], v7 offset:19456
    s_waitcnt vmcnt(34) lgkmcnt(7)
    v_mfma_f32_16x16x32_bf16 a[0:3], v[44:47], v[112:115], a[0:3]
    s_mov_b32 s22, s25
    v_mfma_f32_16x16x32_bf16 a[4:7], v[44:47], v[116:119], a[4:7]
    buffer_load_dwordx4 v[84:87], v6, s[4:7], s22 offen
    v_mfma_f32_16x16x32_bf16 a[8:11], v[44:47], v[120:123], a[8:11]
    s_add_u32 s22, s22, 4096
    v_mfma_f32_16x16x32_bf16 a[12:15], v[44:47], v[124:127], a[12:15]
    buffer_load_dwordx4 v[88:91], v6, s[4:7], s22 offen
    v_mfma_f32_16x16x32_bf16 a[16:19], v[44:47], v[128:131], a[16:19]
    s_add_u32 s22, s22, 4096
    v_mfma_f32_16x16x32_bf16 a[20:23], v[44:47], v[132:135], a[20:23]
    buffer_load_dwordx4 v[92:95], v6, s[4:7], s22 offen
    v_mfma_f32_16x16x32_bf16 a[24:27], v[44:47], v[136:139], a[24:27]
    ds_read_b128 v[44:47], v7 offset:20480
    v_mfma_f32_16x16x32_bf16 a[28:31], v[48:51], v[112:115], a[28:31]
    s_add_u32 s22, s22, 4096
    v_mfma_f32_16x16x32_bf16 a[32:35], v[48:51], v[116:119], a[32:35]
    buffer_load_dwordx4 v[96:99], v6, s[4:7], s22 offen
    v_mfma_f32_16x16x32_bf16 a[36:39], v[48:51], v[120:123], a[36:39]
    s_add_u32 s22, s22, 4096
    v_mfma_f32_16x16x32_bf16 a[40:43], v[48:51], v[124:127], a[40:43]
    buffer_load_dwordx4 v[100:103], v6, s[4:7], s22 offen
    v_mfma_f32_16x16x32_bf16 a[44:47], v[48:51], v[128:131], a[44:47]
    s_add_u32 s22, s22, 4096
    v_mfma_f32_16x16x32_bf16 a[48:51], v[48:51], v[132:135], a[48:51]
    buffer_load_dwordx4 v[104:107], v6, s[4:7], s22 offen
    v_mfma_f32_16x16x32_bf16 a[52:55], v[48:51], v[136:139], a[52:55]
    ds_read_b128 v[48:51], v7 offset:21504
    s_waitcnt lgkmcnt(2)
    v_mfma_f32_16x16x32_bf16 a[56:59], v[52:55], v[112:115], a[56:59]
    s_add_u32 s22, s22, 4096
    v_mfma_f32_16x16x32_bf16 a[60:63], v[52:55], v[116:119], a[60:63]
    buffer_load_dwordx4 v[108:111], v6, s[4:7], s22 offen
    v_mfma_f32_16x16x32_bf16 a[64:67], v[52:55], v[120:123], a[64:67]
    s_add_u32 s25, s25, 57344
    v_mfma_f32_16x16x32_bf16 a[68:71], v[52:55], v[124:127], a[68:71]
    s_add_u32 m0, s27, 10240
    v_mfma_f32_16x16x32_bf16 a[72:75], v[52:55], v[128:131], a[72:75]
    s_mov_b32 s23, s26
    v_mfma_f32_16x16x32_bf16 a[76:79], v[52:55], v[132:135], a[76:79]
    buffer_load_dwordx4 v6, s[8:11], s23 offen offset:0 lds
    v_mfma_f32_16x16x32_bf16 a[80:83], v[52:55], v[136:139], a[80:83]
    ds_read_b128 v[52:55], v7 offset:22528
    v_mfma_f32_16x16x32_bf16 a[84:87], v[56:59], v[112:115], a[84:87]
    buffer_load_dwordx4 v6, s[8:11], s23 offen offset:1024 lds
    v_mfma_f32_16x16x32_bf16 a[88:91], v[56:59], v[116:119], a[88:91]
    buffer_load_dwordx4 v6, s[8:11], s23 offen offset:2048 lds
    v_mfma_f32_16x16x32_bf16 a[92:95], v[56:59], v[120:123], a[92:95]
    buffer_load_dwordx4 v6, s[8:11], s23 offen offset:3072 lds
    v_mfma_f32_16x16x32_bf16 a[96:99], v[56:59], v[124:127], a[96:99]
    s_add_u32 m0, s27, 14336
    v_mfma_f32_16x16x32_bf16 a[100:103], v[56:59], v[128:131], a[100:103]
    s_add_u32 s23, s23, 4096
    v_mfma_f32_16x16x32_bf16 a[104:107], v[56:59], v[132:135], a[104:107]
    buffer_load_dwordx4 v6, s[8:11], s23 offen offset:0 lds
    v_mfma_f32_16x16x32_bf16 a[108:111], v[56:59], v[136:139], a[108:111]
    ds_read_b128 v[56:59], v7 offset:23552
    v_mfma_f32_16x16x32_bf16 a[112:115], v[60:63], v[112:115], a[112:115]
    buffer_load_dwordx4 v6, s[8:11], s23 offen offset:1024 lds
    v_mfma_f32_16x16x32_bf16 a[116:119], v[60:63], v[116:119], a[116:119]
    buffer_load_dwordx4 v6, s[8:11], s23 offen offset:2048 lds
    v_mfma_f32_16x16x32_bf16 a[120:123], v[60:63], v[120:123], a[120:123]
    buffer_load_dwordx4 v6, s[8:11], s23 offen offset:3072 lds
    v_mfma_f32_16x16x32_bf16 a[124:127], v[60:63], v[124:127], a[124:127]
    s_add_u32 m0, s27, 18432
    v_mfma_f32_16x16x32_bf16 a[128:131], v[60:63], v[128:131], a[128:131]
    s_add_u32 s23, s23, 4096
    v_mfma_f32_16x16x32_bf16 a[132:135], v[60:63], v[132:135], a[132:135]
    buffer_load_dwordx4 v6, s[8:11], s23 offen offset:0 lds
    v_mfma_f32_16x16x32_bf16 a[136:139], v[60:63], v[136:139], a[136:139]
    ds_read_b128 v[60:63], v7 offset:24576
    v_mfma_f32_16x16x32_bf16 a[140:143], v[64:67], v[112:115], a[140:143]
    buffer_load_dwordx4 v6, s[8:11], s23 offen offset:1024 lds
    v_mfma_f32_16x16x32_bf16 a[144:147], v[64:67], v[116:119], a[144:147]
    s_add_u32 s26, s26, 163840
    v_mfma_f32_16x16x32_bf16 a[148:151], v[64:67], v[120:123], a[148:151]
    v_mfma_f32_16x16x32_bf16 a[152:155], v[64:67], v[124:127], a[152:155]
    v_mfma_f32_16x16x32_bf16 a[156:159], v[64:67], v[128:131], a[156:159]
    v_mfma_f32_16x16x32_bf16 a[160:163], v[64:67], v[132:135], a[160:163]
    v_mfma_f32_16x16x32_bf16 a[164:167], v[64:67], v[136:139], a[164:167]
    ds_read_b128 v[64:67], v7 offset:25600
    v_mfma_f32_16x16x32_bf16 a[168:171], v[68:71], v[112:115], a[168:171]
    v_mfma_f32_16x16x32_bf16 a[172:175], v[68:71], v[116:119], a[172:175]
    v_mfma_f32_16x16x32_bf16 a[176:179], v[68:71], v[120:123], a[176:179]
    v_mfma_f32_16x16x32_bf16 a[180:183], v[68:71], v[124:127], a[180:183]
    v_mfma_f32_16x16x32_bf16 a[184:187], v[68:71], v[128:131], a[184:187]
    v_mfma_f32_16x16x32_bf16 a[188:191], v[68:71], v[132:135], a[188:191]
    v_mfma_f32_16x16x32_bf16 a[192:195], v[68:71], v[136:139], a[192:195]
    ds_read_b128 v[68:71], v7 offset:26624
    v_mfma_f32_16x16x32_bf16 a[196:199], v[72:75], v[112:115], a[196:199]
    v_mfma_f32_16x16x32_bf16 a[200:203], v[72:75], v[116:119], a[200:203]
    v_mfma_f32_16x16x32_bf16 a[204:207], v[72:75], v[120:123], a[204:207]
    v_mfma_f32_16x16x32_bf16 a[208:211], v[72:75], v[124:127], a[208:211]
    v_mfma_f32_16x16x32_bf16 a[212:215], v[72:75], v[128:131], a[212:215]
    v_mfma_f32_16x16x32_bf16 a[216:219], v[72:75], v[132:135], a[216:219]
    v_mfma_f32_16x16x32_bf16 a[220:223], v[72:75], v[136:139], a[220:223]
    ds_read_b128 v[72:75], v7 offset:27648
    v_mfma_f32_16x16x32_bf16 a[224:227], v[76:79], v[112:115], a[224:227]
    v_mfma_f32_16x16x32_bf16 a[228:231], v[76:79], v[116:119], a[228:231]
    v_mfma_f32_16x16x32_bf16 a[232:235], v[76:79], v[120:123], a[232:235]
    v_mfma_f32_16x16x32_bf16 a[236:239], v[76:79], v[124:127], a[236:239]
    v_mfma_f32_16x16x32_bf16 a[240:243], v[76:79], v[128:131], a[240:243]
    v_mfma_f32_16x16x32_bf16 a[244:247], v[76:79], v[132:135], a[244:247]
    v_mfma_f32_16x16x32_bf16 a[248:251], v[76:79], v[136:139], a[248:251]
    ds_read_b128 v[76:79], v7 offset:28672
    v_mfma_f32_16x16x32_bf16 a[252:255], v[80:83], v[112:115], a[252:255]
    v_mfma_f32_16x16x32_bf16 v[20:23], v[80:83], v[116:119], v[20:23]
    v_mfma_f32_16x16x32_bf16 v[24:27], v[80:83], v[120:123], v[24:27]
    v_mfma_f32_16x16x32_bf16 v[28:31], v[80:83], v[124:127], v[28:31]
    v_mfma_f32_16x16x32_bf16 v[32:35], v[80:83], v[128:131], v[32:35]
    v_mfma_f32_16x16x32_bf16 v[36:39], v[80:83], v[132:135], v[36:39]
    v_mfma_f32_16x16x32_bf16 v[40:43], v[80:83], v[136:139], v[40:43]
    ds_read_b128 v[80:83], v7 offset:29696
    s_waitcnt vmcnt(34) lgkmcnt(7)
    v_mfma_f32_16x16x32_bf16 a[0:3], v[44:47], v[140:143], a[0:3]
    s_mov_b32 s22, s25
    v_mfma_f32_16x16x32_bf16 a[4:7], v[44:47], v[144:147], a[4:7]
    buffer_load_dwordx4 v[112:115], v6, s[4:7], s22 offen
    v_mfma_f32_16x16x32_bf16 a[8:11], v[44:47], v[148:151], a[8:11]
    s_add_u32 s22, s22, 4096
    v_mfma_f32_16x16x32_bf16 a[12:15], v[44:47], v[152:155], a[12:15]
    buffer_load_dwordx4 v[116:119], v6, s[4:7], s22 offen
    v_mfma_f32_16x16x32_bf16 a[16:19], v[44:47], v[156:159], a[16:19]
    s_add_u32 s22, s22, 4096
    v_mfma_f32_16x16x32_bf16 a[20:23], v[44:47], v[160:163], a[20:23]
    buffer_load_dwordx4 v[120:123], v6, s[4:7], s22 offen
    v_mfma_f32_16x16x32_bf16 a[24:27], v[44:47], v[164:167], a[24:27]
    ds_read_b128 v[44:47], v7 offset:30720
    v_mfma_f32_16x16x32_bf16 a[28:31], v[48:51], v[140:143], a[28:31]
    s_add_u32 s22, s22, 4096
    v_mfma_f32_16x16x32_bf16 a[32:35], v[48:51], v[144:147], a[32:35]
    buffer_load_dwordx4 v[124:127], v6, s[4:7], s22 offen
    v_mfma_f32_16x16x32_bf16 a[36:39], v[48:51], v[148:151], a[36:39]
    s_add_u32 s22, s22, 4096
    v_mfma_f32_16x16x32_bf16 a[40:43], v[48:51], v[152:155], a[40:43]
    buffer_load_dwordx4 v[128:131], v6, s[4:7], s22 offen
    v_mfma_f32_16x16x32_bf16 a[44:47], v[48:51], v[156:159], a[44:47]
    s_add_u32 s22, s22, 4096
    v_mfma_f32_16x16x32_bf16 a[48:51], v[48:51], v[160:163], a[48:51]
    buffer_load_dwordx4 v[132:135], v6, s[4:7], s22 offen
    v_mfma_f32_16x16x32_bf16 a[52:55], v[48:51], v[164:167], a[52:55]
    ds_read_b128 v[48:51], v7 offset:31744
    s_waitcnt lgkmcnt(2)
    v_mfma_f32_16x16x32_bf16 a[56:59], v[52:55], v[140:143], a[56:59]
    s_add_u32 s22, s22, 4096
    v_mfma_f32_16x16x32_bf16 a[60:63], v[52:55], v[144:147], a[60:63]
    buffer_load_dwordx4 v[136:139], v6, s[4:7], s22 offen
    v_mfma_f32_16x16x32_bf16 a[64:67], v[52:55], v[148:151], a[64:67]
    s_add_u32 s25, s25, 57344
    v_mfma_f32_16x16x32_bf16 a[68:71], v[52:55], v[152:155], a[68:71]
    s_add_u32 m0, s27, 20480
    v_mfma_f32_16x16x32_bf16 a[72:75], v[52:55], v[156:159], a[72:75]
    s_mov_b32 s23, s26
    v_mfma_f32_16x16x32_bf16 a[76:79], v[52:55], v[160:163], a[76:79]
    buffer_load_dwordx4 v6, s[8:11], s23 offen offset:0 lds
    v_mfma_f32_16x16x32_bf16 a[80:83], v[52:55], v[164:167], a[80:83]
    ds_read_b128 v[52:55], v7 offset:32768
    v_mfma_f32_16x16x32_bf16 a[84:87], v[56:59], v[140:143], a[84:87]
    buffer_load_dwordx4 v6, s[8:11], s23 offen offset:1024 lds
    v_mfma_f32_16x16x32_bf16 a[88:91], v[56:59], v[144:147], a[88:91]
    buffer_load_dwordx4 v6, s[8:11], s23 offen offset:2048 lds
    v_mfma_f32_16x16x32_bf16 a[92:95], v[56:59], v[148:151], a[92:95]
    buffer_load_dwordx4 v6, s[8:11], s23 offen offset:3072 lds
    v_mfma_f32_16x16x32_bf16 a[96:99], v[56:59], v[152:155], a[96:99]
    s_add_u32 m0, s27, 24576
    v_mfma_f32_16x16x32_bf16 a[100:103], v[56:59], v[156:159], a[100:103]
    s_add_u32 s23, s23, 4096
    v_mfma_f32_16x16x32_bf16 a[104:107], v[56:59], v[160:163], a[104:107]
    buffer_load_dwordx4 v6, s[8:11], s23 offen offset:0 lds
    v_mfma_f32_16x16x32_bf16 a[108:111], v[56:59], v[164:167], a[108:111]
    ds_read_b128 v[56:59], v7 offset:33792
    v_mfma_f32_16x16x32_bf16 a[112:115], v[60:63], v[140:143], a[112:115]
    buffer_load_dwordx4 v6, s[8:11], s23 offen offset:1024 lds
    v_mfma_f32_16x16x32_bf16 a[116:119], v[60:63], v[144:147], a[116:119]
    buffer_load_dwordx4 v6, s[8:11], s23 offen offset:2048 lds
    v_mfma_f32_16x16x32_bf16 a[120:123], v[60:63], v[148:151], a[120:123]
    buffer_load_dwordx4 v6, s[8:11], s23 offen offset:3072 lds
    v_mfma_f32_16x16x32_bf16 a[124:127], v[60:63], v[152:155], a[124:127]
    s_add_u32 m0, s27, 28672
    v_mfma_f32_16x16x32_bf16 a[128:131], v[60:63], v[156:159], a[128:131]
    s_add_u32 s23, s23, 4096
    v_mfma_f32_16x16x32_bf16 a[132:135], v[60:63], v[160:163], a[132:135]
    buffer_load_dwordx4 v6, s[8:11], s23 offen offset:0 lds
    v_mfma_f32_16x16x32_bf16 a[136:139], v[60:63], v[164:167], a[136:139]
    ds_read_b128 v[60:63], v7 offset:34816
    v_mfma_f32_16x16x32_bf16 a[140:143], v[64:67], v[140:143], a[140:143]
    buffer_load_dwordx4 v6, s[8:11], s23 offen offset:1024 lds
    v_mfma_f32_16x16x32_bf16 a[144:147], v[64:67], v[144:147], a[144:147]
    s_add_u32 s26, s26, 163840
    v_mfma_f32_16x16x32_bf16 a[148:151], v[64:67], v[148:151], a[148:151]
    v_mfma_f32_16x16x32_bf16 a[152:155], v[64:67], v[152:155], a[152:155]
    v_mfma_f32_16x16x32_bf16 a[156:159], v[64:67], v[156:159], a[156:159]
    v_mfma_f32_16x16x32_bf16 a[160:163], v[64:67], v[160:163], a[160:163]
    v_mfma_f32_16x16x32_bf16 a[164:167], v[64:67], v[164:167], a[164:167]
    ds_read_b128 v[64:67], v7 offset:35840
    v_mfma_f32_16x16x32_bf16 a[168:171], v[68:71], v[140:143], a[168:171]
    v_mfma_f32_16x16x32_bf16 a[172:175], v[68:71], v[144:147], a[172:175]
    v_mfma_f32_16x16x32_bf16 a[176:179], v[68:71], v[148:151], a[176:179]
    v_mfma_f32_16x16x32_bf16 a[180:183], v[68:71], v[152:155], a[180:183]
    v_mfma_f32_16x16x32_bf16 a[184:187], v[68:71], v[156:159], a[184:187]
    v_mfma_f32_16x16x32_bf16 a[188:191], v[68:71], v[160:163], a[188:191]
    v_mfma_f32_16x16x32_bf16 a[192:195], v[68:71], v[164:167], a[192:195]
    ds_read_b128 v[68:71], v7 offset:36864
    v_mfma_f32_16x16x32_bf16 a[196:199], v[72:75], v[140:143], a[196:199]
    v_mfma_f32_16x16x32_bf16 a[200:203], v[72:75], v[144:147], a[200:203]
    v_mfma_f32_16x16x32_bf16 a[204:207], v[72:75], v[148:151], a[204:207]
    v_mfma_f32_16x16x32_bf16 a[208:211], v[72:75], v[152:155], a[208:211]
    v_mfma_f32_16x16x32_bf16 a[212:215], v[72:75], v[156:159], a[212:215]
    v_mfma_f32_16x16x32_bf16 a[216:219], v[72:75], v[160:163], a[216:219]
    v_mfma_f32_16x16x32_bf16 a[220:223], v[72:75], v[164:167], a[220:223]
    ds_read_b128 v[72:75], v7 offset:37888
    v_mfma_f32_16x16x32_bf16 a[224:227], v[76:79], v[140:143], a[224:227]
    v_mfma_f32_16x16x32_bf16 a[228:231], v[76:79], v[144:147], a[228:231]
    v_mfma_f32_16x16x32_bf16 a[232:235], v[76:79], v[148:151], a[232:235]
    v_mfma_f32_16x16x32_bf16 a[236:239], v[76:79], v[152:155], a[236:239]
    v_mfma_f32_16x16x32_bf16 a[240:243], v[76:79], v[156:159], a[240:243]
    v_mfma_f32_16x16x32_bf16 a[244:247], v[76:79], v[160:163], a[244:247]
    v_mfma_f32_16x16x32_bf16 a[248:251], v[76:79], v[164:167], a[248:251]
    ds_read_b128 v[76:79], v7 offset:38912
    v_mfma_f32_16x16x32_bf16 a[252:255], v[80:83], v[140:143], a[252:255]
    v_mfma_f32_16x16x32_bf16 v[20:23], v[80:83], v[144:147], v[20:23]
    v_mfma_f32_16x16x32_bf16 v[24:27], v[80:83], v[148:151], v[24:27]
    v_mfma_f32_16x16x32_bf16 v[28:31], v[80:83], v[152:155], v[28:31]
    v_mfma_f32_16x16x32_bf16 v[32:35], v[80:83], v[156:159], v[32:35]
    v_mfma_f32_16x16x32_bf16 v[36:39], v[80:83], v[160:163], v[36:39]
    v_mfma_f32_16x16x32_bf16 v[40:43], v[80:83], v[164:167], v[40:43]
    ds_read_b128 v[80:83], v7 offset:39936
    s_waitcnt vmcnt(34) lgkmcnt(7)
    v_mfma_f32_16x16x32_bf16 a[0:3], v[44:47], v[168:171], a[0:3]
    s_mov_b32 s22, s25
    v_mfma_f32_16x16x32_bf16 a[4:7], v[44:47], v[172:175], a[4:7]
    buffer_load_dwordx4 v[140:143], v6, s[4:7], s22 offen
    v_mfma_f32_16x16x32_bf16 a[8:11], v[44:47], v[176:179], a[8:11]
    s_add_u32 s22, s22, 4096
    v_mfma_f32_16x16x32_bf16 a[12:15], v[44:47], v[180:183], a[12:15]
    buffer_load_dwordx4 v[144:147], v6, s[4:7], s22 offen
    v_mfma_f32_16x16x32_bf16 a[16:19], v[44:47], v[184:187], a[16:19]
    s_add_u32 s22, s22, 4096
    v_mfma_f32_16x16x32_bf16 a[20:23], v[44:47], v[188:191], a[20:23]
    buffer_load_dwordx4 v[148:151], v6, s[4:7], s22 offen
    v_mfma_f32_16x16x32_bf16 a[24:27], v[44:47], v[192:195], a[24:27]
    ds_read_b128 v[44:47], v7 offset:0
    v_mfma_f32_16x16x32_bf16 a[28:31], v[48:51], v[168:171], a[28:31]
    s_add_u32 s22, s22, 4096
    v_mfma_f32_16x16x32_bf16 a[32:35], v[48:51], v[172:175], a[32:35]
    buffer_load_dwordx4 v[152:155], v6, s[4:7], s22 offen
    v_mfma_f32_16x16x32_bf16 a[36:39], v[48:51], v[176:179], a[36:39]
    s_add_u32 s22, s22, 4096
    v_mfma_f32_16x16x32_bf16 a[40:43], v[48:51], v[180:183], a[40:43]
    buffer_load_dwordx4 v[156:159], v6, s[4:7], s22 offen
    v_mfma_f32_16x16x32_bf16 a[44:47], v[48:51], v[184:187], a[44:47]
    s_add_u32 s22, s22, 4096
    v_mfma_f32_16x16x32_bf16 a[48:51], v[48:51], v[188:191], a[48:51]
    buffer_load_dwordx4 v[160:163], v6, s[4:7], s22 offen
    v_mfma_f32_16x16x32_bf16 a[52:55], v[48:51], v[192:195], a[52:55]
    ds_read_b128 v[48:51], v7 offset:1024
    s_waitcnt lgkmcnt(2)
    v_mfma_f32_16x16x32_bf16 a[56:59], v[52:55], v[168:171], a[56:59]
    s_add_u32 s22, s22, 4096
    v_mfma_f32_16x16x32_bf16 a[60:63], v[52:55], v[172:175], a[60:63]
    buffer_load_dwordx4 v[164:167], v6, s[4:7], s22 offen
    v_mfma_f32_16x16x32_bf16 a[64:67], v[52:55], v[176:179], a[64:67]
    s_add_u32 s25, s25, 57344
    v_mfma_f32_16x16x32_bf16 a[68:71], v[52:55], v[180:183], a[68:71]
    s_add_u32 m0, s27, 30720
    v_mfma_f32_16x16x32_bf16 a[72:75], v[52:55], v[184:187], a[72:75]
    s_mov_b32 s23, s26
    v_mfma_f32_16x16x32_bf16 a[76:79], v[52:55], v[188:191], a[76:79]
    buffer_load_dwordx4 v6, s[8:11], s23 offen offset:0 lds
    v_mfma_f32_16x16x32_bf16 a[80:83], v[52:55], v[192:195], a[80:83]
    ds_read_b128 v[52:55], v7 offset:2048
    v_mfma_f32_16x16x32_bf16 a[84:87], v[56:59], v[168:171], a[84:87]
    buffer_load_dwordx4 v6, s[8:11], s23 offen offset:1024 lds
    v_mfma_f32_16x16x32_bf16 a[88:91], v[56:59], v[172:175], a[88:91]
    buffer_load_dwordx4 v6, s[8:11], s23 offen offset:2048 lds
    v_mfma_f32_16x16x32_bf16 a[92:95], v[56:59], v[176:179], a[92:95]
    buffer_load_dwordx4 v6, s[8:11], s23 offen offset:3072 lds
    v_mfma_f32_16x16x32_bf16 a[96:99], v[56:59], v[180:183], a[96:99]
    s_add_u32 m0, s27, 34816
    v_mfma_f32_16x16x32_bf16 a[100:103], v[56:59], v[184:187], a[100:103]
    s_add_u32 s23, s23, 4096
    v_mfma_f32_16x16x32_bf16 a[104:107], v[56:59], v[188:191], a[104:107]
    buffer_load_dwordx4 v6, s[8:11], s23 offen offset:0 lds
    v_mfma_f32_16x16x32_bf16 a[108:111], v[56:59], v[192:195], a[108:111]
    ds_read_b128 v[56:59], v7 offset:3072
    v_mfma_f32_16x16x32_bf16 a[112:115], v[60:63], v[168:171], a[112:115]
    buffer_load_dwordx4 v6, s[8:11], s23 offen offset:1024 lds
    v_mfma_f32_16x16x32_bf16 a[116:119], v[60:63], v[172:175], a[116:119]
    buffer_load_dwordx4 v6, s[8:11], s23 offen offset:2048 lds
    v_mfma_f32_16x16x32_bf16 a[120:123], v[60:63], v[176:179], a[120:123]
    buffer_load_dwordx4 v6, s[8:11], s23 offen offset:3072 lds
    v_mfma_f32_16x16x32_bf16 a[124:127], v[60:63], v[180:183], a[124:127]
    s_add_u32 m0, s27, 38912
    v_mfma_f32_16x16x32_bf16 a[128:131], v[60:63], v[184:187], a[128:131]
    s_add_u32 s23, s23, 4096
    v_mfma_f32_16x16x32_bf16 a[132:135], v[60:63], v[188:191], a[132:135]
    buffer_load_dwordx4 v6, s[8:11], s23 offen offset:0 lds
    v_mfma_f32_16x16x32_bf16 a[136:139], v[60:63], v[192:195], a[136:139]
    ds_read_b128 v[60:63], v7 offset:4096
    v_mfma_f32_16x16x32_bf16 a[140:143], v[64:67], v[168:171], a[140:143]
    buffer_load_dwordx4 v6, s[8:11], s23 offen offset:1024 lds
    v_mfma_f32_16x16x32_bf16 a[144:147], v[64:67], v[172:175], a[144:147]
    s_add_u32 s26, s26, 163840
    v_mfma_f32_16x16x32_bf16 a[148:151], v[64:67], v[176:179], a[148:151]
    v_mfma_f32_16x16x32_bf16 a[152:155], v[64:67], v[180:183], a[152:155]
    v_mfma_f32_16x16x32_bf16 a[156:159], v[64:67], v[184:187], a[156:159]
    v_mfma_f32_16x16x32_bf16 a[160:163], v[64:67], v[188:191], a[160:163]
    v_mfma_f32_16x16x32_bf16 a[164:167], v[64:67], v[192:195], a[164:167]
    ds_read_b128 v[64:67], v7 offset:5120
    v_mfma_f32_16x16x32_bf16 a[168:171], v[68:71], v[168:171], a[168:171]
    v_mfma_f32_16x16x32_bf16 a[172:175], v[68:71], v[172:175], a[172:175]
    v_mfma_f32_16x16x32_bf16 a[176:179], v[68:71], v[176:179], a[176:179]
    v_mfma_f32_16x16x32_bf16 a[180:183], v[68:71], v[180:183], a[180:183]
    v_mfma_f32_16x16x32_bf16 a[184:187], v[68:71], v[184:187], a[184:187]
    v_mfma_f32_16x16x32_bf16 a[188:191], v[68:71], v[188:191], a[188:191]
    v_mfma_f32_16x16x32_bf16 a[192:195], v[68:71], v[192:195], a[192:195]
    ds_read_b128 v[68:71], v7 offset:6144
    v_mfma_f32_16x16x32_bf16 a[196:199], v[72:75], v[168:171], a[196:199]
    v_mfma_f32_16x16x32_bf16 a[200:203], v[72:75], v[172:175], a[200:203]
    v_mfma_f32_16x16x32_bf16 a[204:207], v[72:75], v[176:179], a[204:207]
    v_mfma_f32_16x16x32_bf16 a[208:211], v[72:75], v[180:183], a[208:211]
    v_mfma_f32_16x16x32_bf16 a[212:215], v[72:75], v[184:187], a[212:215]
    v_mfma_f32_16x16x32_bf16 a[216:219], v[72:75], v[188:191], a[216:219]
    v_mfma_f32_16x16x32_bf16 a[220:223], v[72:75], v[192:195], a[220:223]
    ds_read_b128 v[72:75], v7 offset:7168
    v_mfma_f32_16x16x32_bf16 a[224:227], v[76:79], v[168:171], a[224:227]
    v_mfma_f32_16x16x32_bf16 a[228:231], v[76:79], v[172:175], a[228:231]
    v_mfma_f32_16x16x32_bf16 a[232:235], v[76:79], v[176:179], a[232:235]
    v_mfma_f32_16x16x32_bf16 a[236:239], v[76:79], v[180:183], a[236:239]
    v_mfma_f32_16x16x32_bf16 a[240:243], v[76:79], v[184:187], a[240:243]
    v_mfma_f32_16x16x32_bf16 a[244:247], v[76:79], v[188:191], a[244:247]
    v_mfma_f32_16x16x32_bf16 a[248:251], v[76:79], v[192:195], a[248:251]
    ds_read_b128 v[76:79], v7 offset:8192
    v_mfma_f32_16x16x32_bf16 a[252:255], v[80:83], v[168:171], a[252:255]
    v_mfma_f32_16x16x32_bf16 v[20:23], v[80:83], v[172:175], v[20:23]
    v_mfma_f32_16x16x32_bf16 v[24:27], v[80:83], v[176:179], v[24:27]
    v_mfma_f32_16x16x32_bf16 v[28:31], v[80:83], v[180:183], v[28:31]
    v_mfma_f32_16x16x32_bf16 v[32:35], v[80:83], v[184:187], v[32:35]
    v_mfma_f32_16x16x32_bf16 v[36:39], v[80:83], v[188:191], v[36:39]
    v_mfma_f32_16x16x32_bf16 v[40:43], v[80:83], v[192:195], v[40:43]
    ds_read_b128 v[80:83], v7 offset:9216
    s_add_u32 s21, s21, 1
    s_cmp_lt_u32 s21, 6
    s_cbranch_scc1 L_op_loop
    s_waitcnt vmcnt(34) lgkmcnt(7)
    v_mfma_f32_16x16x32_bf16 a[0:3], v[44:47], v[84:87], a[0:3]
    s_mov_b32 s22, s25
    v_mfma_f32_16x16x32_bf16 a[4:7], v[44:47], v[88:91], a[4:7]
    buffer_load_dwordx4 v[168:171], v6, s[4:7], s22 offen
    v_mfma_f32_16x16x32_bf16 a[8:11], v[44:47], v[92:95], a[8:11]
    s_add_u32 s22, s22, 4096
    v_mfma_f32_16x16x32_bf16 a[12:15], v[44:47], v[96:99], a[12:15]
    buffer_load_dwordx4 v[172:175], v6, s[4:7], s22 offen
    v_mfma_f32_16x16x32_bf16 a[16:19], v[44:47], v[100:103], a[16:19]
    s_add_u32 s22, s22, 4096
    v_mfma_f32_16x16x32_bf16 a[20:23], v[44:47], v[104:107], a[20:23]
    buffer_load_dwordx4 v[176:179], v6, s[4:7], s22 offen
    v_mfma_f32_16x16x32_bf16 a[24:27], v[44:47], v[108:111], a[24:27]
    ds_read_b128 v[44:47], v7 offset:10240
    v_mfma_f32_16x16x32_bf16 a[28:31], v[48:51], v[84:87], a[28:31]
    s_add_u32 s22, s22, 4096
    v_mfma_f32_16x16x32_bf16 a[32:35], v[48:51], v[88:91], a[32:35]
    buffer_load_dwordx4 v[180:183], v6, s[4:7], s22 offen
    v_mfma_f32_16x16x32_bf16 a[36:39], v[48:51], v[92:95], a[36:39]
    s_add_u32 s22, s22, 4096
    v_mfma_f32_16x16x32_bf16 a[40:43], v[48:51], v[96:99], a[40:43]
    buffer_load_dwordx4 v[184:187], v6, s[4:7], s22 offen
    v_mfma_f32_16x16x32_bf16 a[44:47], v[48:51], v[100:103], a[44:47]
    s_add_u32 s22, s22, 4096
    v_mfma_f32_16x16x32_bf16 a[48:51], v[48:51], v[104:107], a[48:51]
    buffer_load_dwordx4 v[188:191], v6, s[4:7], s22 offen
    v_mfma_f32_16x16x32_bf16 a[52:55], v[48:51], v[108:111], a[52:55]
    ds_read_b128 v[48:51], v7 offset:11264
    s_waitcnt lgkmcnt(2)
    v_mfma_f32_16x16x32_bf16 a[56:59], v[52:55], v[84:87], a[56:59]
    s_add_u32 s22, s22, 4096
    v_mfma_f32_16x16x32_bf16 a[60:63], v[52:55], v[88:91], a[60:63]
    buffer_load_dwordx4 v[192:195], v6, s[4:7], s22 offen
    v_mfma_f32_16x16x32_bf16 a[64:67], v[52:55], v[92:95], a[64:67]
    s_add_u32 s25, s25, 57344
    v_mfma_f32_16x16x32_bf16 a[68:71], v[52:55], v[96:99], a[68:71]
    v_mfma_f32_16x16x32_bf16 a[72:75], v[52:55], v[100:103], a[72:75]
    v_mfma_f32_16x16x32_bf16 a[76:79], v[52:55], v[104:107], a[76:79]
    v_mfma_f32_16x16x32_bf16 a[80:83], v[52:55], v[108:111], a[80:83]
    ds_read_b128 v[52:55], v7 offset:12288
    v_mfma_f32_16x16x32_bf16 a[84:87], v[56:59], v[84:87], a[84:87]
    v_mfma_f32_16x16x32_bf16 a[88:91], v[56:59], v[88:91], a[88:91]
    v_mfma_f32_16x16x32_bf16 a[92:95], v[56:59], v[92:95], a[92:95]
    v_mfma_f32_16x16x32_bf16 a[96:99], v[56:59], v[96:99], a[96:99]
    v_mfma_f32_16x16x32_bf16 a[100:103], v[56:59], v[100:103], a[100:103]
    v_mfma_f32_16x16x32_bf16 a[104:107], v[56:59], v[104:107], a[104:107]
    v_mfma_f32_16x16x32_bf16 a[108:111], v[56:59], v[108:111], a[108:111]
    ds_read_b128 v[56:59], v7 offset:13312
    v_mfma_f32_16x16x32_bf16 a[112:115], v[60:63], v[84:87], a[112:115]
    v_mfma_f32_16x16x32_bf16 a[116:119], v[60:63], v[88:91], a[116:119]
    v_mfma_f32_16x16x32_bf16 a[120:123], v[60:63], v[92:95], a[120:123]
    v_mfma_f32_16x16x32_bf16 a[124:127], v[60:63], v[96:99], a[124:127]
    v_mfma_f32_16x16x32_bf16 a[128:131], v[60:63], v[100:103], a[128:131]
    v_mfma_f32_16x16x32_bf16 a[132:135], v[60:63], v[104:107], a[132:135]
    v_mfma_f32_16x16x32_bf16 a[136:139], v[60:63], v[108:111], a[136:139]
    ds_read_b128 v[60:63], v7 offset:14336
    v_mfma_f32_16x16x32_bf16 a[140:143], v[64:67], v[84:87], a[140:143]
    v_mfma_f32_16x16x32_bf16 a[144:147], v[64:67], v[88:91], a[144:147]
    v_mfma_f32_16x16x32_bf16 a[148:151], v[64:67], v[92:95], a[148:151]
    v_mfma_f32_16x16x32_bf16 a[152:155], v[64:67], v[96:99], a[152:155]
    v_mfma_f32_16x16x32_bf16 a[156:159], v[64:67], v[100:103], a[156:159]
    v_mfma_f32_16x16x32_bf16 a[160:163], v[64:67], v[104:107], a[160:163]
    v_mfma_f32_16x16x32_bf16 a[164:167], v[64:67], v[108:111], a[164:167]
    ds_read_b128 v[64:67], v7 offset:15360
    v_mfma_f32_16x16x32_bf16 a[168:171], v[68:71], v[84:87], a[168:171]
    v_mfma_f32_16x16x32_bf16 a[172:175], v[68:71], v[88:91], a[172:175]
    v_mfma_f32_16x16x32_bf16 a[176:179], v[68:71], v[92:95], a[176:179]
    v_mfma_f32_16x16x32_bf16 a[180:183], v[68:71], v[96:99], a[180:183]
    v_mfma_f32_16x16x32_bf16 a[184:187], v[68:71], v[100:103], a[184:187]
    v_mfma_f32_16x16x32_bf16 a[188:191], v[68:71], v[104:107], a[188:191]
    v_mfma_f32_16x16x32_bf16 a[192:195], v[68:71], v[108:111], a[192:195]
    ds_read_b128 v[68:71], v7 offset:16384
    v_mfma_f32_16x16x32_bf16 a[196:199], v[72:75], v[84:87], a[196:199]
    v_mfma_f32_16x16x32_bf16 a[200:203], v[72:75], v[88:91], a[200:203]
    v_mfma_f32_16x16x32_bf16 a[204:207], v[72:75], v[92:95], a[204:207]
    v_mfma_f32_16x16x32_bf16 a[208:211], v[72:75], v[96:99], a[208:211]
    v_mfma_f32_16x16x32_bf16 a[212:215], v[72:75], v[100:103], a[212:215]
    v_mfma_f32_16x16x32_bf16 a[216:219], v[72:75], v[104:107], a[216:219]
    v_mfma_f32_16x16x32_bf16 a[220:223], v[72:75], v[108:111], a[220:223]
    ds_read_b128 v[72:75], v7 offset:17408
    v_mfma_f32_16x16x32_bf16 a[224:227], v[76:79], v[84:87], a[224:227]
    v_mfma_f32_16x16x32_bf16 a[228:231], v[76:79], v[88:91], a[228:231]
    v_mfma_f32_16x16x32_bf16 a[232:235], v[76:79], v[92:95], a[232:235]
    v_mfma_f32_16x16x32_bf16 a[236:239], v[76:79], v[96:99], a[236:239]
    v_mfma_f32_16x16x32_bf16 a[240:243], v[76:79], v[100:103], a[240:243]
    v_mfma_f32_16x16x32_bf16 a[244:247], v[76:79], v[104:107], a[244:247]
    v_mfma_f32_16x16x32_bf16 a[248:251], v[76:79], v[108:111], a[248:251]
    ds_read_b128 v[76:79], v7 offset:18432
    v_mfma_f32_16x16x32_bf16 a[252:255], v[80:83], v[84:87], a[252:255]
    v_mfma_f32_16x16x32_bf16 v[20:23], v[80:83], v[88:91], v[20:23]
    v_mfma_f32_16x16x32_bf16 v[24:27], v[80:83], v[92:95], v[24:27]
    v_mfma_f32_16x16x32_bf16 v[28:31], v[80:83], v[96:99], v[28:31]
    v_mfma_f32_16x16x32_bf16 v[32:35], v[80:83], v[100:103], v[32:35]
    v_mfma_f32_16x16x32_bf16 v[36:39], v[80:83], v[104:107], v[36:39]
    v_mfma_f32_16x16x32_bf16 v[40:43], v[80:83], v[108:111], v[40:43]
    ds_read_b128 v[80:83], v7 offset:19456
    s_waitcnt vmcnt(24) lgkmcnt(7)
    v_mfma_f32_16x16x32_bf16 a[0:3], v[44:47], v[112:115], a[0:3]
    v_mfma_f32_16x16x32_bf16 a[4:7], v[44:47], v[116:119], a[4:7]
    v_mfma_f32_16x16x32_bf16 a[8:11], v[44:47], v[120:123], a[8:11]
    v_mfma_f32_16x16x32_bf16 a[12:15], v[44:47], v[124:127], a[12:15]
    v_mfma_f32_16x16x32_bf16 a[16:19], v[44:47], v[128:131], a[16:19]
    v_mfma_f32_16x16x32_bf16 a[20:23], v[44:47], v[132:135], a[20:23]
    v_mfma_f32_16x16x32_bf16 a[24:27], v[44:47], v[136:139], a[24:27]
    ds_read_b128 v[44:47], v7 offset:20480
    v_mfma_f32_16x16x32_bf16 a[28:31], v[48:51], v[112:115], a[28:31]
    v_mfma_f32_16x16x32_bf16 a[32:35], v[48:51], v[116:119], a[32:35]
    v_mfma_f32_16x16x32_bf16 a[36:39], v[48:51], v[120:123], a[36:39]
    v_mfma_f32_16x16x32_bf16 a[40:43], v[48:51], v[124:127], a[40:43]
    v_mfma_f32_16x16x32_bf16 a[44:47], v[48:51], v[128:131], a[44:47]
    v_mfma_f32_16x16x32_bf16 a[48:51], v[48:51], v[132:135], a[48:51]
    v_mfma_f32_16x16x32_bf16 a[52:55], v[48:51], v[136:139], a[52:55]
    ds_read_b128 v[48:51], v7 offset:21504
    s_waitcnt lgkmcnt(2)
    v_mfma_f32_16x16x32_bf16 a[56:59], v[52:55], v[112:115], a[56:59]
    v_mfma_f32_16x16x32_bf16 a[60:63], v[52:55], v[116:119], a[60:63]
    v_mfma_f32_16x16x32_bf16 a[64:67], v[52:55], v[120:123], a[64:67]
    v_mfma_f32_16x16x32_bf16 a[68:71], v[52:55], v[124:127], a[68:71]
    v_mfma_f32_16x16x32_bf16 a[72:75], v[52:55], v[128:131], a[72:75]
    v_mfma_f32_16x16x32_bf16 a[76:79], v[52:55], v[132:135], a[76:79]
    v_mfma_f32_16x16x32_bf16 a[80:83], v[52:55], v[136:139], a[80:83]
    ds_read_b128 v[52:55], v7 offset:22528
    v_mfma_f32_16x16x32_bf16 a[84:87], v[56:59], v[112:115], a[84:87]
    v_mfma_f32_16x16x32_bf16 a[88:91], v[56:59], v[116:119], a[88:91]
    v_mfma_f32_16x16x32_bf16 a[92:95], v[56:59], v[120:123], a[92:95]
    v_mfma_f32_16x16x32_bf16 a[96:99], v[56:59], v[124:127], a[96:99]
    v_mfma_f32_16x16x32_bf16 a[100:103], v[56:59], v[128:131], a[100:103]
    v_mfma_f32_16x16x32_bf16 a[104:107], v[56:59], v[132:135], a[104:107]
    v_mfma_f32_16x16x32_bf16 a[108:111], v[56:59], v[136:139], a[108:111]
    ds_read_b128 v[56:59], v7 offset:23552
    v_mfma_f32_16x16x32_bf16 a[112:115], v[60:63], v[112:115], a[112:115]
    v_mfma_f32_16x16x32_bf16 a[116:119], v[60:63], v[116:119], a[116:119]
    v_mfma_f32_16x16x32_bf16 a[120:123], v[60:63], v[120:123], a[120:123]
    v_mfma_f32_16x16x32_bf16 a[124:127], v[60:63], v[124:127], a[124:127]
    v_mfma_f32_16x16x32_bf16 a[128:131], v[60:63], v[128:131], a[128:131]
    v_mfma_f32_16x16x32_bf16 a[132:135], v[60:63], v[132:135], a[132:135]
    v_mfma_f32_16x16x32_bf16 a[136:139], v[60:63], v[136:139], a[136:139]
    ds_read_b128 v[60:63], v7 offset:24576
    v_mfma_f32_16x16x32_bf16 a[140:143], v[64:67], v[112:115], a[140:143]
    v_mfma_f32_16x16x32_bf16 a[144:147], v[64:67], v[116:119], a[144:147]
    v_mfma_f32_16x16x32_bf16 a[148:151], v[64:67], v[120:123], a[148:151]
    v_mfma_f32_16x16x32_bf16 a[152:155], v[64:67], v[124:127], a[152:155]
    v_mfma_f32_16x16x32_bf16 a[156:159], v[64:67], v[128:131], a[156:159]
    v_mfma_f32_16x16x32_bf16 a[160:163], v[64:67], v[132:135], a[160:163]
    v_mfma_f32_16x16x32_bf16 a[164:167], v[64:67], v[136:139], a[164:167]
    ds_read_b128 v[64:67], v7 offset:25600
    v_mfma_f32_16x16x32_bf16 a[168:171], v[68:71], v[112:115], a[168:171]
    v_mfma_f32_16x16x32_bf16 a[172:175], v[68:71], v[116:119], a[172:175]
    v_mfma_f32_16x16x32_bf16 a[176:179], v[68:71], v[120:123], a[176:179]
    v_mfma_f32_16x16x32_bf16 a[180:183], v[68:71], v[124:127], a[180:183]
    v_mfma_f32_16x16x32_bf16 a[184:187], v[68:71], v[128:131], a[184:187]
    v_mfma_f32_16x16x32_bf16 a[188:191], v[68:71], v[132:135], a[188:191]
    v_mfma_f32_16x16x32_bf16 a[192:195], v[68:71], v[136:139], a[192:195]
    ds_read_b128 v[68:71], v7 offset:26624
    v_mfma_f32_16x16x32_bf16 a[196:199], v[72:75], v[112:115], a[196:199]
    v_mfma_f32_16x16x32_bf16 a[200:203], v[72:75], v[116:119], a[200:203]
    v_mfma_f32_16x16x32_bf16 a[204:207], v[72:75], v[120:123], a[204:207]
    v_mfma_f32_16x16x32_bf16 a[208:211], v[72:75], v[124:127], a[208:211]
    v_mfma_f32_16x16x32_bf16 a[212:215], v[72:75], v[128:131], a[212:215]
    v_mfma_f32_16x16x32_bf16 a[216:219], v[72:75], v[132:135], a[216:219]
    v_mfma_f32_16x16x32_bf16 a[220:223], v[72:75], v[136:139], a[220:223]
    ds_read_b128 v[72:75], v7 offset:27648
    v_mfma_f32_16x16x32_bf16 a[224:227], v[76:79], v[112:115], a[224:227]
    v_mfma_f32_16x16x32_bf16 a[228:231], v[76:79], v[116:119], a[228:231]
    v_mfma_f32_16x16x32_bf16 a[232:235], v[76:79], v[120:123], a[232:235]
    v_mfma_f32_16x16x32_bf16 a[236:239], v[76:79], v[124:127], a[236:239]
    v_mfma_f32_16x16x32_bf16 a[240:243], v[76:79], v[128:131], a[240:243]
    v_mfma_f32_16x16x32_bf16 a[244:247], v[76:79], v[132:135], a[244:247]
    v_mfma_f32_16x16x32_bf16 a[248:251], v[76:79], v[136:139], a[248:251]
    ds_read_b128 v[76:79], v7 offset:28672
    v_mfma_f32_16x16x32_bf16 a[252:255], v[80:83], v[112:115], a[252:255]
    v_mfma_f32_16x16x32_bf16 v[20:23], v[80:83], v[116:119], v[20:23]
    v_mfma_f32_16x16x32_bf16 v[24:27], v[80:83], v[120:123], v[24:27]
    v_mfma_f32_16x16x32_bf16 v[28:31], v[80:83], v[124:127], v[28:31]
    v_mfma_f32_16x16x32_bf16 v[32:35], v[80:83], v[128:131], v[32:35]
    v_mfma_f32_16x16x32_bf16 v[36:39], v[80:83], v[132:135], v[36:39]
    v_mfma_f32_16x16x32_bf16 v[40:43], v[80:83], v[136:139], v[40:43]
    ds_read_b128 v[80:83], v7 offset:29696
    s_waitcnt vmcnt(7) lgkmcnt(7)
    v_mfma_f32_16x16x32_bf16 a[0:3], v[44:47], v[140:143], a[0:3]
    v_mfma_f32_16x16x32_bf16 a[4:7], v[44:47], v[144:147], a[4:7]
    v_mfma_f32_16x16x32_bf16 a[8:11], v[44:47], v[148:151], a[8:11]
    v_mfma_f32_16x16x32_bf16 a[12:15], v[44:47], v[152:155], a[12:15]
    v_mfma_f32_16x16x32_bf16 a[16:19], v[44:47], v[156:159], a[16:19]
    v_mfma_f32_16x16x32_bf16 a[20:23], v[44:47], v[160:163], a[20:23]
    v_mfma_f32_16x16x32_bf16 a[24:27], v[44:47], v[164:167], a[24:27]
    ds_read_b128 v[44:47], v7 offset:30720
    v_mfma_f32_16x16x32_bf16 a[28:31], v[48:51], v[140:143], a[28:31]
    v_mfma_f32_16x16x32_bf16 a[32:35], v[48:51], v[144:147], a[32:35]
    v_mfma_f32_16x16x32_bf16 a[36:39], v[48:51], v[148:151], a[36:39]
    v_mfma_f32_16x16x32_bf16 a[40:43], v[48:51], v[152:155], a[40:43]
    v_mfma_f32_16x16x32_bf16 a[44:47], v[48:51], v[156:159], a[44:47]
    v_mfma_f32_16x16x32_bf16 a[48:51], v[48:51], v[160:163], a[48:51]
    v_mfma_f32_16x16x32_bf16 a[52:55], v[48:51], v[164:167], a[52:55]
    ds_read_b128 v[48:51], v7 offset:31744
    s_waitcnt lgkmcnt(2)
    v_mfma_f32_16x16x32_bf16 a[56:59], v[52:55], v[140:143], a[56:59]
    v_mfma_f32_16x16x32_bf16 a[60:63], v[52:55], v[144:147], a[60:63]
    v_mfma_f32_16x16x32_bf16 a[64:67], v[52:55], v[148:151], a[64:67]
    v_mfma_f32_16x16x32_bf16 a[68:71], v[52:55], v[152:155], a[68:71]
    v_mfma_f32_16x16x32_bf16 a[72:75], v[52:55], v[156:159], a[72:75]
    v_mfma_f32_16x16x32_bf16 a[76:79], v[52:55], v[160:163], a[76:79]
    v_mfma_f32_16x16x32_bf16 a[80:83], v[52:55], v[164:167], a[80:83]
    ds_read_b128 v[52:55], v7 offset:32768
    v_mfma_f32_16x16x32_bf16 a[84:87], v[56:59], v[140:143], a[84:87]
    v_mfma_f32_16x16x32_bf16 a[88:91], v[56:59], v[144:147], a[88:91]
    v_mfma_f32_16x16x32_bf16 a[92:95], v[56:59], v[148:151], a[92:95]
    v_mfma_f32_16x16x32_bf16 a[96:99], v[56:59], v[152:155], a[96:99]
    v_mfma_f32_16x16x32_bf16 a[100:103], v[56:59], v[156:159], a[100:103]
    v_mfma_f32_16x16x32_bf16 a[104:107], v[56:59], v[160:163], a[104:107]
    v_mfma_f32_16x16x32_bf16 a[108:111], v[56:59], v[164:167], a[108:111]
    ds_read_b128 v[56:59], v7 offset:33792
    v_mfma_f32_16x16x32_bf16 a[112:115], v[60:63], v[140:143], a[112:115]
    v_mfma_f32_16x16x32_bf16 a[116:119], v[60:63], v[144:147], a[116:119]
    v_mfma_f32_16x16x32_bf16 a[120:123], v[60:63], v[148:151], a[120:123]
    v_mfma_f32_16x16x32_bf16 a[124:127], v[60:63], v[152:155], a[124:127]
    v_mfma_f32_16x16x32_bf16 a[128:131], v[60:63], v[156:159], a[128:131]
    v_mfma_f32_16x16x32_bf16 a[132:135], v[60:63], v[160:163], a[132:135]
    v_mfma_f32_16x16x32_bf16 a[136:139], v[60:63], v[164:167], a[136:139]
    ds_read_b128 v[60:63], v7 offset:34816
    v_mfma_f32_16x16x32_bf16 a[140:143], v[64:67], v[140:143], a[140:143]
    v_mfma_f32_16x16x32_bf16 a[144:147], v[64:67], v[144:147], a[144:147]
    v_mfma_f32_16x16x32_bf16 a[148:151], v[64:67], v[148:151], a[148:151]
    v_mfma_f32_16x16x32_bf16 a[152:155], v[64:67], v[152:155], a[152:155]
    v_mfma_f32_16x16x32_bf16 a[156:159], v[64:67], v[156:159], a[156:159]
    v_mfma_f32_16x16x32_bf16 a[160:163], v[64:67], v[160:163], a[160:163]
    v_mfma_f32_16x16x32_bf16 a[164:167], v[64:67], v[164:167], a[164:167]
    ds_read_b128 v[64:67], v7 offset:35840
    v_mfma_f32_16x16x32_bf16 a[168:171], v[68:71], v[140:143], a[168:171]
    v_mfma_f32_16x16x32_bf16 a[172:175], v[68:71], v[144:147], a[172:175]
    v_mfma_f32_16x16x32_bf16 a[176:179], v[68:71], v[148:151], a[176:179]
    v_mfma_f32_16x16x32_bf16 a[180:183], v[68:71], v[152:155], a[180:183]
    v_mfma_f32_16x16x32_bf16 a[184:187], v[68:71], v[156:159], a[184:187]
    v_mfma_f32_16x16x32_bf16 a[188:191], v[68:71], v[160:163], a[188:191]
    v_mfma_f32_16x16x32_bf16 a[192:195], v[68:71], v[164:167], a[192:195]
    ds_read_b128 v[68:71], v7 offset:36864
    v_mfma_f32_16x16x32_bf16 a[196:199], v[72:75], v[140:143], a[196:199]
    v_mfma_f32_16x16x32_bf16 a[200:203], v[72:75], v[144:147], a[200:203]
    v_mfma_f32_16x16x32_bf16 a[204:207], v[72:75], v[148:151], a[204:207]
    v_mfma_f32_16x16x32_bf16 a[208:211], v[72:75], v[152:155], a[208:211]
    v_mfma_f32_16x16x32_bf16 a[212:215], v[72:75], v[156:159], a[212:215]
    v_mfma_f32_16x16x32_bf16 a[216:219], v[72:75], v[160:163], a[216:219]
    v_mfma_f32_16x16x32_bf16 a[220:223], v[72:75], v[164:167], a[220:223]
    ds_read_b128 v[72:75], v7 offset:37888
    v_mfma_f32_16x16x32_bf16 a[224:227], v[76:79], v[140:143], a[224:227]
    v_mfma_f32_16x16x32_bf16 a[228:231], v[76:79], v[144:147], a[228:231]
    v_mfma_f32_16x16x32_bf16 a[232:235], v[76:79], v[148:151], a[232:235]
    v_mfma_f32_16x16x32_bf16 a[236:239], v[76:79], v[152:155], a[236:239]
    v_mfma_f32_16x16x32_bf16 a[240:243], v[76:79], v[156:159], a[240:243]
    v_mfma_f32_16x16x32_bf16 a[244:247], v[76:79], v[160:163], a[244:247]
    v_mfma_f32_16x16x32_bf16 a[248:251], v[76:79], v[164:167], a[248:251]
    ds_read_b128 v[76:79], v7 offset:38912
    v_mfma_f32_16x16x32_bf16 a[252:255], v[80:83], v[140:143], a[252:255]
    v_mfma_f32_16x16x32_bf16 v[20:23], v[80:83], v[144:147], v[20:23]
    v_mfma_f32_16x16x32_bf16 v[24:27], v[80:83], v[148:151], v[24:27]
    v_mfma_f32_16x16x32_bf16 v[28:31], v[80:83], v[152:155], v[28:31]
    v_mfma_f32_16x16x32_bf16 v[32:35], v[80:83], v[156:159], v[32:35]
    v_mfma_f32_16x16x32_bf16 v[36:39], v[80:83], v[160:163], v[36:39]
    v_mfma_f32_16x16x32_bf16 v[40:43], v[80:83], v[164:167], v[40:43]
    ds_read_b128 v[80:83], v7 offset:39936
    s_waitcnt vmcnt(0) lgkmcnt(7)
    v_mfma_f32_16x16x32_bf16 a[0:3], v[44:47], v[168:171], a[0:3]
    v_mfma_f32_16x16x32_bf16 a[4:7], v[44:47], v[172:175], a[4:7]
    v_mfma_f32_16x16x32_bf16 a[8:11], v[44:47], v[176:179], a[8:11]
    v_mfma_f32_16x16x32_bf16 a[12:15], v[44:47], v[180:183], a[12:15]
    v_mfma_f32_16x16x32_bf16 a[16:19], v[44:47], v[184:187], a[16:19]
    v_mfma_f32_16x16x32_bf16 a[20:23], v[44:47], v[188:191], a[20:23]
    v_mfma_f32_16x16x32_bf16 a[24:27], v[44:47], v[192:195], a[24:27]
    v_mfma_f32_16x16x32_bf16 a[28:31], v[48:51], v[168:171], a[28:31]
    v_mfma_f32_16x16x32_bf16 a[32:35], v[48:51], v[172:175], a[32:35]
    v_mfma_f32_16x16x32_bf16 a[36:39], v[48:51], v[176:179], a[36:39]
    v_mfma_f32_16x16x32_bf16 a[40:43], v[48:51], v[180:183], a[40:43]
    v_mfma_f32_16x16x32_bf16 a[44:47], v[48:51], v[184:187], a[44:47]
    v_mfma_f32_16x16x32_bf16 a[48:51], v[48:51], v[188:191], a[48:51]
    v_mfma_f32_16x16x32_bf16 a[52:55], v[48:51], v[192:195], a[52:55]
    s_waitcnt lgkmcnt(0)
    v_mfma_f32_16x16x32_bf16 a[56:59], v[52:55], v[168:171], a[56:59]
    v_mfma_f32_16x16x32_bf16 a[60:63], v[52:55], v[172:175], a[60:63]
    ds_write_b128 v7, a[0:3] offset:0
    v_mfma_f32_16x16x32_bf16 a[64:67], v[52:55], v[176:179], a[64:67]
    ds_write_b128 v7, a[28:31] offset:1024
    v_mfma_f32_16x16x32_bf16 a[68:71], v[52:55], v[180:183], a[68:71]
    ds_write_b128 v7, a[4:7] offset:2048
    v_mfma_f32_16x16x32_bf16 a[72:75], v[52:55], v[184:187], a[72:75]
    ds_write_b128 v7, a[32:35] offset:3072
    v_mfma_f32_16x16x32_bf16 a[76:79], v[52:55], v[188:191], a[76:79]
    ds_write_b128 v7, a[8:11] offset:4096
    v_mfma_f32_16x16x32_bf16 a[80:83], v[52:55], v[192:195], a[80:83]
    ds_write_b128 v7, a[36:39] offset:5120
    v_mfma_f32_16x16x32_bf16 a[84:87], v[56:59], v[168:171], a[84:87]
    ds_write_b128 v7, a[12:15] offset:6144
    v_mfma_f32_16x16x32_bf16 a[88:91], v[56:59], v[172:175], a[88:91]
    ds_write_b128 v7, a[40:43] offset:7168
    v_mfma_f32_16x16x32_bf16 a[92:95], v[56:59], v[176:179], a[92:95]
    ds_write_b128 v7, a[16:19] offset:8192
    v_mfma_f32_16x16x32_bf16 a[96:99], v[56:59], v[180:183], a[96:99]
    ds_write_b128 v7, a[44:47] offset:9216
    v_mfma_f32_16x16x32_bf16 a[100:103], v[56:59], v[184:187], a[100:103]
    ds_write_b128 v7, a[20:23] offset:10240
    v_mfma_f32_16x16x32_bf16 a[104:107], v[56:59], v[188:191], a[104:107]
    ds_write_b128 v7, a[48:51] offset:11264
    v_mfma_f32_16x16x32_bf16 a[108:111], v[56:59], v[192:195], a[108:111]
    ds_write_b128 v7, a[24:27] offset:12288
    v_mfma_f32_16x16x32_bf16 a[112:115], v[60:63], v[168:171], a[112:115]
    ds_write_b128 v7, a[52:55] offset:13312
    v_mfma_f32_16x16x32_bf16 a[116:119], v[60:63], v[172:175], a[116:119]
    ds_write_b128 v7, a[56:59] offset:14336
    v_mfma_f32_16x16x32_bf16 a[120:123], v[60:63], v[176:179], a[120:123]
    ds_write_b128 v7, a[84:87] offset:15360
    v_mfma_f32_16x16x32_bf16 a[124:127], v[60:63], v[180:183], a[124:127]
    ds_write_b128 v7, a[60:63] offset:16384
    v_mfma_f32_16x16x32_bf16 a[128:131], v[60:63], v[184:187], a[128:131]
    ds_write_b128 v7, a[88:91] offset:17408
    v_mfma_f32_16x16x32_bf16 a[132:135], v[60:63], v[188:191], a[132:135]
    ds_write_b128 v7, a[64:67] offset:18432
    v_mfma_f32_16x16x32_bf16 a[136:139], v[60:63], v[192:195], a[136:139]
    ds_write_b128 v7, a[92:95] offset:19456
    v_mfma_f32_16x16x32_bf16 a[140:143], v[64:67], v[168:171], a[140:143]
    ds_write_b128 v7, a[68:71] offset:20480
    v_mfma_f32_16x16x32_bf16 a[144:147], v[64:67], v[172:175], a[144:147]
    ds_write_b128 v7, a[96:99] offset:21504
    v_mfma_f32_16x16x32_bf16 a[148:151], v[64:67], v[176:179], a[148:151]
    ds_write_b128 v7, a[72:75] offset:22528
    v_mfma_f32_16x16x32_bf16 a[152:155], v[64:67], v[180:183], a[152:155]
    ds_write_b128 v7, a[100:103] offset:23552
    v_mfma_f32_16x16x32_bf16 a[156:159], v[64:67], v[184:187], a[156:159]
    ds_write_b128 v7, a[76:79] offset:24576
    v_mfma_f32_16x16x32_bf16 a[160:163], v[64:67], v[188:191], a[160:163]
    ds_write_b128 v7, a[104:107] offset:25600
    v_mfma_f32_16x16x32_bf16 a[164:167], v[64:67], v[192:195], a[164:167]
    ds_write_b128 v7, a[80:83] offset:26624
    v_mfma_f32_16x16x32_bf16 a[168:171], v[68:71], v[168:171], a[168:171]
    ds_write_b128 v7, a[108:111] offset:27648
    v_mfma_f32_16x16x32_bf16 a[172:175], v[68:71], v[172:175], a[172:175]
    ds_write_b128 v7, a[112:115] offset:28672
    v_mfma_f32_16x16x32_bf16 a[176:179], v[68:71], v[176:179], a[176:179]
    ds_write_b128 v7, a[140:143] offset:29696
    v_mfma_f32_16x16x32_bf16 a[180:183], v[68:71], v[180:183], a[180:183]
    ds_write_b128 v7, a[116:119] offset:30720
    v_mfma_f32_16x16x32_bf16 a[184:187], v[68:71], v[184:187], a[184:187]
    ds_write_b128 v7, a[144:147] offset:31744
    v_mfma_f32_16x16x32_bf16 a[188:191], v[68:71], v[188:191], a[188:191]
    ds_write_b128 v7, a[120:123] offset:32768
    v_mfma_f32_16x16x32_bf16 a[192:195], v[68:71], v[192:195], a[192:195]
    ds_write_b128 v7, a[148:151] offset:33792
    v_mfma_f32_16x16x32_bf16 a[196:199], v[72:75], v[168:171], a[196:199]
    ds_write_b128 v7, a[124:127] offset:34816
    v_mfma_f32_16x16x32_bf16 a[200:203], v[72:75], v[172:175], a[200:203]
    ds_write_b128 v7, a[152:155] offset:35840
    v_mfma_f32_16x16x32_bf16 a[204:207], v[72:75], v[176:179], a[204:207]
    ds_write_b128 v7, a[128:131] offset:36864
    v_mfma_f32_16x16x32_bf16 a[208:211], v[72:75], v[180:183], a[208:211]
    ds_write_b128 v7, a[156:159] offset:37888
    v_mfma_f32_16x16x32_bf16 a[212:215], v[72:75], v[184:187], a[212:215]
    ds_write_b128 v7, a[132:135] offset:38912
    v_mfma_f32_16x16x32_bf16 a[216:219], v[72:75], v[188:191], a[216:219]
    ds_write_b128 v7, a[160:163] offset:39936
    v_mfma_f32_16x16x32_bf16 a[220:223], v[72:75], v[192:195], a[220:223]
    v_mfma_f32_16x16x32_bf16 a[224:227], v[76:79], v[168:171], a[224:227]
    v_mfma_f32_16x16x32_bf16 a[228:231], v[76:79], v[172:175], a[228:231]
    v_mfma_f32_16x16x32_bf16 a[232:235], v[76:79], v[176:179], a[232:235]
    v_mfma_f32_16x16x32_bf16 a[236:239], v[76:79], v[180:183], a[236:239]
    v_mfma_f32_16x16x32_bf16 a[240:243], v[76:79], v[184:187], a[240:243]
    v_mfma_f32_16x16x32_bf16 a[244:247], v[76:79], v[188:191], a[244:247]
    v_mfma_f32_16x16x32_bf16 a[248:251], v[76:79], v[192:195], a[248:251]
    v_mfma_f32_16x16x32_bf16 a[252:255], v[80:83], v[168:171], a[252:255]
    v_mfma_f32_16x16x32_bf16 v[20:23], v[80:83], v[172:175], v[20:23]
    v_mfma_f32_16x16x32_bf16 v[24:27], v[80:83], v[176:179], v[24:27]
    v_mfma_f32_16x16x32_bf16 v[28:31], v[80:83], v[180:183], v[28:31]
    v_mfma_f32_16x16x32_bf16 v[32:35], v[80:83], v[184:187], v[32:35]
    v_mfma_f32_16x16x32_bf16 v[36:39], v[80:83], v[188:191], v[36:39]
    v_mfma_f32_16x16x32_bf16 v[40:43], v[80:83], v[192:195], v[40:43]
    s_waitcnt lgkmcnt(0)
    s_barrier
    ds_read_b128 v[44:47], v2 offset:0
    ds_read_b128 v[48:51], v2 offset:1024
    ds_read_b128 v[52:55], v3 offset:0
    ds_read_b128 v[56:59], v3 offset:1024
    ds_read_b128 v[60:63], v4 offset:0
    ds_read_b128 v[64:67], v4 offset:1024
    ds_read_b128 v[68:71], v5 offset:0
    ds_read_b128 v[72:75], v5 offset:1024
    ds_read_b128 v[76:79], v2 offset:8192
    ds_read_b128 v[80:83], v2 offset:9216
    ds_read_b128 v[84:87], v3 offset:8192
    ds_read_b128 v[88:91], v3 offset:9216
    ds_read_b128 v[92:95], v4 offset:8192
    ds_read_b128 v[96:99], v4 offset:9216
    ds_read_b128 v[100:103], v5 offset:8192
    ds_read_b128 v[104:107], v5 offset:9216
    ds_read_b128 v[108:111], v2 offset:16384
    ds_read_b128 v[112:115], v2 offset:17408
    ds_read_b128 v[116:119], v3 offset:16384
    ds_read_b128 v[120:123], v3 offset:17408
    ds_read_b128 v[124:127], v4 offset:16384
    ds_read_b128 v[128:131], v4 offset:17408
    ds_read_b128 v[132:135], v5 offset:16384
    ds_read_b128 v[136:139], v5 offset:17408
    ds_read_b128 v[140:143], v2 offset:24576
    ds_read_b128 v[144:147], v2 offset:25600
    ds_read_b128 v[148:151], v3 offset:24576
    ds_read_b128 v[152:155], v3 offset:25600
    ds_read_b128 v[156:159], v4 offset:24576
    ds_read_b128 v[160:163], v4 offset:25600
    ds_read_b128 v[164:167], v5 offset:24576
    ds_read_b128 v[168:171], v5 offset:25600
    ds_read_b128 v[172:175], v2 offset:32768
    ds_read_b128 v[176:179], v2 offset:33792
    ds_read_b128 v[180:183], v3 offset:32768
    ds_read_b128 v[184:187], v3 offset:33792
    ds_read_b128 v[188:191], v4 offset:32768
    ds_read_b128 v[192:195], v4 offset:33792
    ds_read_b128 v[196:199], v5 offset:32768
    ds_read_b128 v[200:203], v5 offset:33792
    s_waitcnt lgkmcnt(0)
    s_barrier
    ds_write_b128 v7, a[136:139] offset:0
    v_pk_add_f32 v[44:45], v[44:45], v[52:53]
    v_pk_add_f32 v[60:61], v[60:61], v[68:69]
    v_pk_add_f32 v[46:47], v[46:47], v[54:55]
    v_pk_add_f32 v[62:63], v[62:63], v[70:71]
    ds_write_b128 v7, a[164:167] offset:1024
    v_pk_add_f32 v[48:49], v[48:49], v[56:57]
    v_pk_add_f32 v[64:65], v[64:65], v[72:73]
    v_pk_add_f32 v[50:51], v[50:51], v[58:59]
    v_pk_add_f32 v[66:67], v[66:67], v[74:75]
    ds_write_b128 v7, a[168:171] offset:2048
    v_pk_add_f32 v[44:45], v[44:45], v[60:61]
    v_pk_add_f32 v[46:47], v[46:47], v[62:63]
    v_pk_add_f32 v[48:49], v[48:49], v[64:65]
    v_pk_add_f32 v[50:51], v[50:51], v[66:67]
    ds_write_b128 v7, a[196:199] offset:3072
    v_cvt_pk_bf16_f32 v52, v44, v45
    v_cvt_pk_bf16_f32 v53, v46, v47
    v_cvt_pk_bf16_f32 v54, v48, v49
    v_cvt_pk_bf16_f32 v55, v50, v51
    ds_write_b128 v7, a[172:175] offset:4096
    s_add_u32 s22, s20, 0
    s_mul_i32 s23, s22, 9363
    s_lshr_b32 s23, s23, 16
    v_permlane16_swap_b32 v52, v54
    ds_write_b128 v7, a[200:203] offset:5120
    v_permlane16_swap_b32 v53, v55
    s_mul_i32 s30, s23, 7
    s_sub_u32 s30, s22, s30
    s_mul_i32 s30, s30, 40960
    ds_write_b128 v7, a[176:179] offset:6144
    s_lshl_b32 s23, s23, 6
    s_add_u32 s30, s30, s23
    s_add_u32 s30, s30, s24
    buffer_store_dwordx4 v[52:55], v9, s[12:15], s30 offen sc0 sc1
    ds_write_b128 v7, a[204:207] offset:7168
    v_pk_add_f32 v[76:77], v[76:77], v[84:85]
    v_pk_add_f32 v[92:93], v[92:93], v[100:101]
    v_pk_add_f32 v[78:79], v[78:79], v[86:87]
    v_pk_add_f32 v[94:95], v[94:95], v[102:103]
    ds_write_b128 v7, a[180:183] offset:8192
    v_pk_add_f32 v[80:81], v[80:81], v[88:89]
    v_pk_add_f32 v[96:97], v[96:97], v[104:105]
    v_pk_add_f32 v[82:83], v[82:83], v[90:91]
    v_pk_add_f32 v[98:99], v[98:99], v[106:107]
    ds_write_b128 v7, a[208:211] offset:9216
    v_pk_add_f32 v[76:77], v[76:77], v[92:93]
    v_pk_add_f32 v[78:79], v[78:79], v[94:95]
    v_pk_add_f32 v[80:81], v[80:81], v[96:97]
    v_pk_add_f32 v[82:83], v[82:83], v[98:99]
    ds_write_b128 v7, a[184:187] offset:10240
    v_cvt_pk_bf16_f32 v84, v76, v77
    v_cvt_pk_bf16_f32 v85, v78, v79
    v_cvt_pk_bf16_f32 v86, v80, v81
    v_cvt_pk_bf16_f32 v87, v82, v83
    ds_write_b128 v7, a[212:215] offset:11264
    s_add_u32 s22, s20, 4
    s_mul_i32 s23, s22, 9363
    s_lshr_b32 s23, s23, 16
    v_permlane16_swap_b32 v84, v86
    ds_write_b128 v7, a[188:191] offset:12288
    v_permlane16_swap_b32 v85, v87
    s_mul_i32 s30, s23, 7
    s_sub_u32 s30, s22, s30
    s_mul_i32 s30, s30, 40960
    ds_write_b128 v7, a[216:219] offset:13312
    s_lshl_b32 s23, s23, 6
    s_add_u32 s30, s30, s23
    s_add_u32 s30, s30, s24
    buffer_store_dwordx4 v[84:87], v9, s[12:15], s30 offen sc0 sc1
    ds_write_b128 v7, a[192:195] offset:14336
    v_pk_add_f32 v[108:109], v[108:109], v[116:117]
    v_pk_add_f32 v[124:125], v[124:125], v[132:133]
    v_pk_add_f32 v[110:111], v[110:111], v[118:119]
    v_pk_add_f32 v[126:127], v[126:127], v[134:135]
    ds_write_b128 v7, a[220:223] offset:15360
    v_pk_add_f32 v[112:113], v[112:113], v[120:121]
    v_pk_add_f32 v[128:129], v[128:129], v[136:137]
    v_pk_add_f32 v[114:115], v[114:115], v[122:123]
    v_pk_add_f32 v[130:131], v[130:131], v[138:139]
    ds_write_b128 v7, a[224:227] offset:16384
    v_pk_add_f32 v[108:109], v[108:109], v[124:125]
    v_pk_add_f32 v[110:111], v[110:111], v[126:127]
    v_pk_add_f32 v[112:113], v[112:113], v[128:129]
    v_pk_add_f32 v[114:115], v[114:115], v[130:131]
    ds_write_b128 v7, a[252:255] offset:17408
    v_cvt_pk_bf16_f32 v116, v108, v109
    v_cvt_pk_bf16_f32 v117, v110, v111
    v_cvt_pk_bf16_f32 v118, v112, v113
    v_cvt_pk_bf16_f32 v119, v114, v115
    ds_write_b128 v7, a[228:231] offset:18432
    s_add_u32 s22, s20, 8
    s_mul_i32 s23, s22, 9363
    s_lshr_b32 s23, s23, 16
    v_permlane16_swap_b32 v116, v118
    ds_write_b128 v7, v[20:23] offset:19456
    v_permlane16_swap_b32 v117, v119
    s_mul_i32 s30, s23, 7
    s_sub_u32 s30, s22, s30
    s_mul_i32 s30, s30, 40960
    ds_write_b128 v7, a[232:235] offset:20480
    s_lshl_b32 s23, s23, 6
    s_add_u32 s30, s30, s23
    s_add_u32 s30, s30, s24
    buffer_store_dwordx4 v[116:119], v9, s[12:15], s30 offen sc0 sc1
    ds_write_b128 v7, v[24:27] offset:21504
    v_pk_add_f32 v[140:141], v[140:141], v[148:149]
    v_pk_add_f32 v[156:157], v[156:157], v[164:165]
    v_pk_add_f32 v[142:143], v[142:143], v[150:151]
    v_pk_add_f32 v[158:159], v[158:159], v[166:167]
    ds_write_b128 v7, a[236:239] offset:22528
    v_pk_add_f32 v[144:145], v[144:145], v[152:153]
    v_pk_add_f32 v[160:161], v[160:161], v[168:169]
    v_pk_add_f32 v[146:147], v[146:147], v[154:155]
    v_pk_add_f32 v[162:163], v[162:163], v[170:171]
    ds_write_b128 v7, v[28:31] offset:23552
    v_pk_add_f32 v[140:141], v[140:141], v[156:157]
    v_pk_add_f32 v[142:143], v[142:143], v[158:159]
    v_pk_add_f32 v[144:145], v[144:145], v[160:161]
    v_pk_add_f32 v[146:147], v[146:147], v[162:163]
    ds_write_b128 v7, a[240:243] offset:24576
    v_cvt_pk_bf16_f32 v148, v140, v141
    v_cvt_pk_bf16_f32 v149, v142, v143
    v_cvt_pk_bf16_f32 v150, v144, v145
    v_cvt_pk_bf16_f32 v151, v146, v147
    ds_write_b128 v7, v[32:35] offset:25600
    s_add_u32 s22, s20, 12
    s_mul_i32 s23, s22, 9363
    s_lshr_b32 s23, s23, 16
    v_permlane16_swap_b32 v148, v150
    ds_write_b128 v7, a[244:247] offset:26624
    v_permlane16_swap_b32 v149, v151
    s_mul_i32 s30, s23, 7
    s_sub_u32 s30, s22, s30
    s_mul_i32 s30, s30, 40960
    ds_write_b128 v7, v[36:39] offset:27648
    s_lshl_b32 s23, s23, 6
    s_add_u32 s30, s30, s23
    s_add_u32 s30, s30, s24
    buffer_store_dwordx4 v[148:151], v9, s[12:15], s30 offen sc0 sc1
    ds_write_b128 v7, a[248:251] offset:28672
    v_pk_add_f32 v[172:173], v[172:173], v[180:181]
    v_pk_add_f32 v[188:189], v[188:189], v[196:197]
    v_pk_add_f32 v[174:175], v[174:175], v[182:183]
    v_pk_add_f32 v[190:191], v[190:191], v[198:199]
    ds_write_b128 v7, v[40:43] offset:29696
    v_pk_add_f32 v[176:177], v[176:177], v[184:185]
    v_pk_add_f32 v[192:193], v[192:193], v[200:201]
    v_pk_add_f32 v[178:179], v[178:179], v[186:187]
    v_pk_add_f32 v[194:195], v[194:195], v[202:203]
    v_pk_add_f32 v[172:173], v[172:173], v[188:189]
    v_pk_add_f32 v[174:175], v[174:175], v[190:191]
    v_pk_add_f32 v[176:177], v[176:177], v[192:193]
    v_pk_add_f32 v[178:179], v[178:179], v[194:195]
    v_cvt_pk_bf16_f32 v180, v172, v173
    v_cvt_pk_bf16_f32 v181, v174, v175
    v_cvt_pk_bf16_f32 v182, v176, v177
    v_cvt_pk_bf16_f32 v183, v178, v179
    s_add_u32 s22, s20, 16
    s_mul_i32 s23, s22, 9363
    s_lshr_b32 s23, s23, 16
    v_permlane16_swap_b32 v180, v182
    v_permlane16_swap_b32 v181, v183
    s_mul_i32 s30, s23, 7
    s_sub_u32 s30, s22, s30
    s_mul_i32 s30, s30, 40960
    s_lshl_b32 s23, s23, 6
    s_add_u32 s30, s30, s23
    s_add_u32 s30, s30, s24
    buffer_store_dwordx4 v[180:183], v9, s[12:15], s30 offen sc0 sc1
    s_waitcnt lgkmcnt(0)
    s_barrier
    ds_read_b128 v[44:47], v2 offset:0
    ds_read_b128 v[48:51], v2 offset:1024
    ds_read_b128 v[52:55], v3 offset:0
    ds_read_b128 v[56:59], v3 offset:1024
    ds_read_b128 v[60:63], v4 offset:0
    ds_read_b128 v[64:67], v4 offset:1024
    ds_read_b128 v[68:71], v5 offset:0
    ds_read_b128 v[72:75], v5 offset:1024
    ds_read_b128 v[76:79], v2 offset:8192
    ds_read_b128 v[80:83], v2 offset:9216
    ds_read_b128 v[84:87], v3 offset:8192
    ds_read_b128 v[88:91], v3 offset:9216
    ds_read_b128 v[92:95], v4 offset:8192
    ds_read_b128 v[96:99], v4 offset:9216
    ds_read_b128 v[100:103], v5 offset:8192
    ds_read_b128 v[104:107], v5 offset:9216
    ds_read_b128 v[108:111], v2 offset:16384
    ds_read_b128 v[112:115], v2 offset:17408
    ds_read_b128 v[116:119], v3 offset:16384
    ds_read_b128 v[120:123], v3 offset:17408
    ds_read_b128 v[124:127], v4 offset:16384
    ds_read_b128 v[128:131], v4 offset:17408
    ds_read_b128 v[132:135], v5 offset:16384
    ds_read_b128 v[136:139], v5 offset:17408
    ds_read_b128 v[140:143], v2 offset:24576
    ds_read_b128 v[144:147], v2 offset:25600
    ds_read_b128 v[148:151], v3 offset:24576
    ds_read_b128 v[152:155], v3 offset:25600
    ds_read_b128 v[156:159], v4 offset:24576
    ds_read_b128 v[160:163], v4 offset:25600
    ds_read_b128 v[164:167], v5 offset:24576
    ds_read_b128 v[168:171], v5 offset:25600
    s_waitcnt lgkmcnt(15)
    v_pk_add_f32 v[44:45], v[44:45], v[52:53]
    v_pk_add_f32 v[60:61], v[60:61], v[68:69]
    v_pk_add_f32 v[46:47], v[46:47], v[54:55]
    v_pk_add_f32 v[62:63], v[62:63], v[70:71]
    v_pk_add_f32 v[48:49], v[48:49], v[56:57]
    v_pk_add_f32 v[64:65], v[64:65], v[72:73]
    v_pk_add_f32 v[50:51], v[50:51], v[58:59]
    v_pk_add_f32 v[66:67], v[66:67], v[74:75]
    v_pk_add_f32 v[44:45], v[44:45], v[60:61]
    v_pk_add_f32 v[46:47], v[46:47], v[62:63]
    v_pk_add_f32 v[48:49], v[48:49], v[64:65]
    v_pk_add_f32 v[50:51], v[50:51], v[66:67]
    v_cvt_pk_bf16_f32 v52, v44, v45
    v_cvt_pk_bf16_f32 v53, v46, v47
    v_cvt_pk_bf16_f32 v54, v48, v49
    v_cvt_pk_bf16_f32 v55, v50, v51
    s_add_u32 s22, s20, 20
    s_mul_i32 s23, s22, 9363
    s_lshr_b32 s23, s23, 16
    v_permlane16_swap_b32 v52, v54
    v_permlane16_swap_b32 v53, v55
    s_mul_i32 s30, s23, 7
    s_sub_u32 s30, s22, s30
    s_mul_i32 s30, s30, 40960
    s_lshl_b32 s23, s23, 6
    s_add_u32 s30, s30, s23
    s_add_u32 s30, s30, s24
    buffer_store_dwordx4 v[52:55], v9, s[12:15], s30 offen sc0 sc1
    s_waitcnt lgkmcnt(15)
    v_pk_add_f32 v[76:77], v[76:77], v[84:85]
    v_pk_add_f32 v[92:93], v[92:93], v[100:101]
    v_pk_add_f32 v[78:79], v[78:79], v[86:87]
    v_pk_add_f32 v[94:95], v[94:95], v[102:103]
    v_pk_add_f32 v[80:81], v[80:81], v[88:89]
    v_pk_add_f32 v[96:97], v[96:97], v[104:105]
    v_pk_add_f32 v[82:83], v[82:83], v[90:91]
    v_pk_add_f32 v[98:99], v[98:99], v[106:107]
    v_pk_add_f32 v[76:77], v[76:77], v[92:93]
    v_pk_add_f32 v[78:79], v[78:79], v[94:95]
    v_pk_add_f32 v[80:81], v[80:81], v[96:97]
    v_pk_add_f32 v[82:83], v[82:83], v[98:99]
    v_cvt_pk_bf16_f32 v84, v76, v77
    v_cvt_pk_bf16_f32 v85, v78, v79
    v_cvt_pk_bf16_f32 v86, v80, v81
    v_cvt_pk_bf16_f32 v87, v82, v83
    s_add_u32 s22, s20, 24
    s_mul_i32 s23, s22, 9363
    s_lshr_b32 s23, s23, 16
    v_permlane16_swap_b32 v84, v86
    v_permlane16_swap_b32 v85, v87
    s_mul_i32 s30, s23, 7
    s_sub_u32 s30, s22, s30
    s_mul_i32 s30, s30, 40960
    s_lshl_b32 s23, s23, 6
    s_add_u32 s30, s30, s23
    s_add_u32 s30, s30, s24
    buffer_store_dwordx4 v[84:87], v9, s[12:15], s30 offen sc0 sc1
    s_waitcnt lgkmcnt(8)
    v_pk_add_f32 v[108:109], v[108:109], v[116:117]
    v_pk_add_f32 v[124:125], v[124:125], v[132:133]
    v_pk_add_f32 v[110:111], v[110:111], v[118:119]
    v_pk_add_f32 v[126:127], v[126:127], v[134:135]
    v_pk_add_f32 v[112:113], v[112:113], v[120:121]
    v_pk_add_f32 v[128:129], v[128:129], v[136:137]
    v_pk_add_f32 v[114:115], v[114:115], v[122:123]
    v_pk_add_f32 v[130:131], v[130:131], v[138:139]
    v_pk_add_f32 v[108:109], v[108:109], v[124:125]
    v_pk_add_f32 v[110:111], v[110:111], v[126:127]
    v_pk_add_f32 v[112:113], v[112:113], v[128:129]
    v_pk_add_f32 v[114:115], v[114:115], v[130:131]
    v_cvt_pk_bf16_f32 v116, v108, v109
    v_cvt_pk_bf16_f32 v117, v110, v111
    v_cvt_pk_bf16_f32 v118, v112, v113
    v_cvt_pk_bf16_f32 v119, v114, v115
    s_add_u32 s22, s20, 28
    s_mul_i32 s23, s22, 9363
    s_lshr_b32 s23, s23, 16
    v_permlane16_swap_b32 v116, v118
    v_permlane16_swap_b32 v117, v119
    s_mul_i32 s30, s23, 7
    s_sub_u32 s30, s22, s30
    s_mul_i32 s30, s30, 40960
    s_lshl_b32 s23, s23, 6
    s_add_u32 s30, s30, s23
    s_add_u32 s30, s30, s24
    buffer_store_dwordx4 v[116:119], v9, s[12:15], s30 offen sc0 sc1
    s_waitcnt lgkmcnt(0)
    v_pk_add_f32 v[140:141], v[140:141], v[148:149]
    v_pk_add_f32 v[156:157], v[156:157], v[164:165]
    v_pk_add_f32 v[142:143], v[142:143], v[150:151]
    v_pk_add_f32 v[158:159], v[158:159], v[166:167]
    v_pk_add_f32 v[144:145], v[144:145], v[152:153]
    v_pk_add_f32 v[160:161], v[160:161], v[168:169]
    v_pk_add_f32 v[146:147], v[146:147], v[154:155]
    v_pk_add_f32 v[162:163], v[162:163], v[170:171]
    v_pk_add_f32 v[140:141], v[140:141], v[156:157]
    v_pk_add_f32 v[142:143], v[142:143], v[158:159]
    v_pk_add_f32 v[144:145], v[144:145], v[160:161]
    v_pk_add_f32 v[146:147], v[146:147], v[162:163]
    v_cvt_pk_bf16_f32 v148, v140, v141
    v_cvt_pk_bf16_f32 v149, v142, v143
    v_cvt_pk_bf16_f32 v150, v144, v145
    v_cvt_pk_bf16_f32 v151, v146, v147
    s_add_u32 s22, s20, 32
    s_mul_i32 s23, s22, 9363
    s_lshr_b32 s23, s23, 16
    v_permlane16_swap_b32 v148, v150
    v_permlane16_swap_b32 v149, v151
    s_mul_i32 s30, s23, 7
    s_sub_u32 s30, s22, s30
    s_mul_i32 s30, s30, 40960
    s_lshl_b32 s23, s23, 6
    s_add_u32 s30, s30, s23
    s_add_u32 s30, s30, s24
    s_cmp_ge_u32 s22, 35
    s_cselect_b32 s23, 0x40000000, 0
    s_add_u32 s30, s30, s23
    buffer_store_dwordx4 v[148:151], v9, s[12:15], s30 offen sc0 sc1
L_op_end:
    s_endpgm
L_code_end:
.section .rodata,"a"
.p2align 6
.amdhsa_kernel fused_kernel
  .amdhsa_next_free_vgpr 512
  .amdhsa_next_free_sgpr 102
  .amdhsa_accum_offset 256
  .amdhsa_group_segment_fixed_size 0
  .amdhsa_kernarg_size 104
  .amdhsa_user_sgpr_count 2
  .amdhsa_user_sgpr_kernarg_segment_ptr 1
  .amdhsa_system_sgpr_workgroup_id_x 1
.end_amdhsa_kernel
.p2align 6
.amdhsa_kernel op_kernel
  .amdhsa_next_free_vgpr 512
  .amdhsa_next_free_sgpr 102
  .amdhsa_accum_offset 256
  .amdhsa_group_segment_fixed_size 0
  .amdhsa_kernarg_size 104
  .amdhsa_user_sgpr_count 2
  .amdhsa_user_sgpr_kernarg_segment_ptr 1
  .amdhsa_system_sgpr_workgroup_id_x 1
.end_amdhsa_kernel
```

```asm
; @launch kernel=fused_kernel grid=(256,1,1) block=(256,1,1) lds=163840
; @launch kernel=op_kernel grid=(256,1,1) block=(256,1,1) lds=163840
.amdgcn_target "amdgcn-amd-amdhsa--gfx950"
.text
.globl fused_kernel
.p2align 8
.type fused_kernel,@function
fused_kernel:
    s_cmp_ge_u32 s2, 256
    s_cbranch_scc1 L_at_end
    s_and_b32 s3, s2, 7
    s_lshl_b32 s3, s3, 5
    s_lshr_b32 s36, s2, 6
    s_lshl_b32 s36, s36, 3
    s_or_b32 s3, s3, s36
    s_bfe_u32 s36, s2, 0x30003
    s_or_b32 s2, s3, s36
    s_load_dwordx8 s[36:43], s[0:1], 0
    s_load_dwordx8 s[56:63], s[0:1], 40
    s_load_dwordx2 s[44:45], s[0:1], 96
    s_load_dwordx2 s[84:85], s[0:1], 32
    s_load_dwordx2 s[86:87], s[0:1], 72
    s_getpc_b64 s[72:73]
L_pc0:
    v_lshlrev_b32 v105, 7, v0
    v_add_u32 v104, 0, v105
    v_min_u32 v104, L_code_end - L_pc0 - 4, v104
    v_mov_b32 v107, s73
    v_add_co_u32 v106, vcc, s72, v104
    v_addc_co_u32 v107, vcc, 0, v107, vcc
    global_load_dword v108, v[106:107], off
    v_add_u32 v104, 32768, v105
    v_min_u32 v104, L_code_end - L_pc0 - 4, v104
    v_mov_b32 v107, s73
    v_add_co_u32 v106, vcc, s72, v104
    v_addc_co_u32 v107, vcc, 0, v107, vcc
    global_load_dword v108, v[106:107], off
    v_add_u32 v104, 65536, v105
    v_min_u32 v104, L_code_end - L_pc0 - 4, v104
    v_mov_b32 v107, s73
    v_add_co_u32 v106, vcc, s72, v104
    v_addc_co_u32 v107, vcc, 0, v107, vcc
    global_load_dword v108, v[106:107], off
    v_and_b32 v1, 63, v0
    v_lshrrev_b32 v2, 6, v0
    s_nop 0
    v_readfirstlane_b32 s20, v2
    s_waitcnt lgkmcnt(0)
    s_and_b32 s48, s20, 1
    s_lshr_b32 s35, s20, 1
    s_cmp_ge_u32 s2, 128
    s_cselect_b32 s36, s56, s36
    s_cselect_b32 s37, s57, s37
    s_cselect_b32 s38, s58, s38
    s_cselect_b32 s39, s59, s39
    s_cselect_b32 s40, s60, s40
    s_cselect_b32 s41, s61, s41
    s_cselect_b32 s42, s62, s42
    s_cselect_b32 s43, s63, s43
    s_cselect_b32 s84, s86, s84
    s_cselect_b32 s85, s87, s85
    s_mov_b32 s86, 5242880
    s_mov_b32 s87, 0x20000
    s_and_b32 s28, s2, 127
    s_lshl_b32 s29, s28, 20
    s_lshl_b32 s30, s35, 18
    s_add_u32 s29, s29, s30
    s_add_u32 s38, s38, s29
    s_addc_u32 s39, s39, 0
    s_add_u32 s40, s40, s29
    s_addc_u32 s41, s41, 0
    s_sub_u32 s30, 0x100000, s30
    s_mov_b32 s8, s38
    s_mov_b32 s9, s39
    s_mov_b32 s10, s30
    s_mov_b32 s11, 0x20000
    s_cmp_eq_u32 s48, 0
    s_cselect_b32 s4, s38, s40
    s_cselect_b32 s5, s39, s41
    s_mov_b32 s6, s30
    s_mov_b32 s7, 0x20000
    s_cselect_b32 s16, s42, s36
    s_cselect_b32 s17, s43, s37
    s_mov_b32 s28, 5242880
    s_mov_b32 s29, 4587520
    s_cselect_b32 s18, s28, s29
    s_mov_b32 s19, 0x20000
    s_mov_b32 s28, 262144
    s_mov_b32 s29, 64
    s_cselect_b32 s51, s28, s29
    s_cselect_b32 s52, 512, 0
    s_mov_b32 s28, 1056
    s_mov_b32 s29, 1024
    s_cselect_b32 s53, s28, s29
    s_mov_b32 s28, 0
    s_mov_b32 s29, 0
    s_cselect_b32 s88, s28, s29
    s_mov_b32 s28, 8192
    s_mov_b32 s29, 20480
    s_cselect_b32 s89, s28, s29
    s_mov_b32 s28, 16384
    s_mov_b32 s29, 40960
    s_cselect_b32 s90, s28, s29
    s_mov_b32 s28, 24576
    s_mov_b32 s29, 61440
    s_cselect_b32 s91, s28, s29
    s_mov_b32 s28, 65536
    s_mov_b32 s29, 81920
    s_cselect_b32 s92, s28, s29
    s_mov_b32 s28, 73728
    s_mov_b32 s29, 102400
    s_cselect_b32 s93, s28, s29
    s_mov_b32 s28, 81920
    s_mov_b32 s29, 122880
    s_cselect_b32 s94, s28, s29
    s_mov_b32 s28, 90112
    s_mov_b32 s29, 1073741824
    s_cselect_b32 s95, s28, s29
    s_and_b32 s28, s2, 7
    s_lshl_b32 s28, s28, 2
    s_add_u32 s28, s28, s35
    s_lshl_b32 s28, s28, 8
    s_bfe_u32 s29, s2, 262147
    s_lshl_b32 s29, s29, 1
    s_add_u32 s29, s29, s35
    s_mul_i32 s29, s29, 143360
    s_cmp_eq_u32 s48, 0
    s_cselect_b32 s55, s28, s29
    s_add_u32 s12, s44, 0
    s_addc_u32 s13, s45, 0
    s_mov_b32 s14, 127926272
    s_mov_b32 s15, 0x20000
    s_lshl_b32 s28, s2, 2
    s_add_u32 s28, s28, s35
    s_mul_i32 s24, s28, 57344
    s_mul_i32 s28, s48, 28672
    s_add_u32 s24, s24, s28
    s_add_u32 s24, s24, 58720256
    s_mov_b32 s23, -1
    s_mov_b32 s60, s42
    s_mov_b32 s61, s43
    s_mov_b32 s62, 5242880
    s_mov_b32 s63, 0x20000
    s_mov_b32 s27, 0
    s_mov_b32 s25, 0
    s_mov_b32 s68, 0
    s_mov_b32 s71, 0
    s_lshr_b32 s26, s2, 3
    s_lshr_b32 s28, s2, 1
    s_add_u32 s26, s26, s28
    s_and_b32 s26, s26, 3
    s_mul_i32 s26, s26, 5
    s_mul_i32 s83, s51, 20
    s_and_b32 s69, s2, 1
    s_min_u32 s69, s69, 1
    s_bfe_u32 s3, s2, 0x10005
    s_xor_b32 s3, s3, 1
    s_and_b32 s69, s2, s3
    s_nop 0
    s_mov_b32 s70, s69
    s_mov_b32 s32, 0x4e800000
    s_mov_b32 s54, 0x3e0293ee
    s_lshl_b32 s28, s48, 1
    s_add_u32 s28, s28, s35
    s_mul_i32 s33, s28, 33792
    v_lshlrev_b32 v6, 4, v1
    v_lshrrev_b32 v2, 4, v1
    v_and_b32 v3, 15, v1
    v_lshlrev_b32 v4, 4, v3
    v_lshl_add_u32 v7, v2, 14, v4
    v_bfe_u32 v5, v1, 4, 1
    v_lshl_add_u32 v26, v5, 15, v4
    v_bfe_u32 v5, v1, 5, 1
    v_lshl_add_u32 v26, v5, 17, v26
    v_mul_u32_u24 v27, 1280, v3
    v_lshl_add_u32 v27, v2, 4, v27
    v_lshrrev_b32 v5, 4, v1
    v_and_b32 v27, 1, v5
    v_lshlrev_b32 v27, 1, v27
    v_lshrrev_b32 v5, 1, v5
    v_mul_u32_u24 v5, 3, v5
    v_xor_b32 v27, v27, v5
    v_and_b32 v5, 3, v1
    v_xor_b32 v27, v27, v5
    v_lshlrev_b32 v27, 4, v27
    v_lshrrev_b32 v5, 2, v1
    v_mul_u32_u24 v5, 1280, v5
    v_add_u32 v27, v27, v5
    s_cmp_eq_u32 s48, 0
    s_cselect_b64 vcc, -1, 0
    s_nop 1
    v_cndmask_b32 v26, v27, v26, vcc
    s_add_u32 s28, s48, 2
    s_mul_i32 s28, s28, 33792
    v_bfe_u32 v5, v1, 2, 2
    v_and_b32 v27, 1, v5
    v_lshlrev_b32 v27, 1, v27
    v_lshrrev_b32 v5, 1, v5
    v_mul_u32_u24 v5, 3, v5
    v_xor_b32 v27, v27, v5
    v_xor_b32 v27, v27, v2
    v_lshlrev_b32 v27, 4, v27
    v_lshl_add_u32 v27, v3, 6, v27
    v_add_u32 v27, s28, v27
    v_bfe_u32 v5, v1, 4, 1
    v_lshl_add_u32 v4, v5, 9, v4
    v_bfe_u32 v5, v1, 5, 1
    v_lshl_add_u32 v10, v5, 8, v4
    v_and_b32 v4, 7, v3
    v_lshlrev_b32 v8, 10, v4
    v_and_b32 v5, 1, v3
    v_lshl_add_u32 v8, v5, 4, v8
    v_bfe_u32 v5, v3, 1, 2
    v_lshl_add_u32 v8, v5, 6, v8
    v_lshrrev_b32 v5, 3, v3
    v_lshl_add_u32 v8, v5, 8, v8
    v_bfe_u32 v5, v1, 4, 1
    v_lshl_add_u32 v8, v5, 5, v8
    v_bfe_u32 v5, v1, 5, 1
    v_lshl_add_u32 v8, v5, 4, v8
    s_mul_i32 s28, s35, 33792
    v_add_u32 v8, s28, v8
    v_bfe_u32 v3, v1, 2, 2
    v_bfe_u32 v5, v1, 4, 1
    v_lshl_add_u32 v4, v5, 2, v3
    v_mul_u32_u24 v4, 1056, v4
    v_bfe_u32 v5, v1, 5, 1
    v_lshl_add_u32 v4, v5, 9, v4
    v_and_b32 v5, 3, v1
    v_lshl_add_u32 v4, v5, 3, v4
    v_add_u32 v11, s28, v4
    v_lshl_add_u32 v3, v2, 2, v3
    v_and_b32 v4, 7, v3
    v_mul_u32_u24 v4, 1056, v4
    v_lshrrev_b32 v5, 3, v3
    v_lshl_add_u32 v4, v5, 8, v4
    v_and_b32 v5, 3, v1
    v_lshl_add_u32 v4, v5, 3, v4
    s_add_u32 s28, s28, 67584
    v_add_u32 v9, s28, v4
    v_mov_b32 v12, 0xff800000
    v_mov_b32 v14, 0xff800000
    v_mov_b32 v16, 0xff800000
    v_mov_b32 v18, 0xff800000
    v_mov_b32 v20, 0xff800000
    v_mov_b32 v22, 0xff800000
    v_mov_b32 v24, 0xff800000
    v_mov_b32 v2, 0x3f803f80
    v_accvgpr_write_b32 a252, v2
    v_accvgpr_write_b32 a253, v2
    v_accvgpr_write_b32 a254, v2
    v_accvgpr_write_b32 a255, v2
    v_and_b32 v2, 3, v1
    v_lshlrev_b32 v2, 2, v2
    v_add_u32 v2, 76000, v2
    v_mov_b32 v3, 0
    ds_write_b32 v2, v3
    s_cmp_eq_u32 s48, 0
    s_mov_b32 s28, 784
    s_mov_b32 s29, 800
    s_cselect_b32 s96, s28, s29
    s_mov_b32 s28, 816
    s_cselect_b32 s97, s28, s29
    v_lshrrev_b32 v2, 1, v1
    v_lshlrev_b32 v2, 13, v2
    v_and_b32 v3, 1, v1
    v_lshl_add_u32 v2, v3, 7, v2
    v_lshlrev_b32 v3, 7, v1
    s_bfe_u32 s28, s2, 0x20003
    s_lshl_b32 s28, s28, 18
    s_and_b32 s29, s2, 7
    s_mul_i32 s29, s29, 17920
    s_cmp_eq_u32 s48, 0
    s_cselect_b64 vcc, -1, 0
    s_cselect_b32 s100, s28, s29
    s_add_u32 s100, s100, s55
    s_cmp_eq_u32 s48, 0
    s_mov_b32 s28, 1048576
    s_mov_b32 s29, 8192
    s_cselect_b32 s99, s28, s29
    v_cndmask_b32 v6, v3, v2, vcc
    s_mul_i32 s100, s2, 11
    s_lshr_b32 s28, s2, 5
    s_mul_i32 s28, s28, 7
    s_add_u32 s100, s100, s28
    s_lshl_b32 s28, s35, 4
    s_add_u32 s100, s100, s28
    s_and_b32 s100, s100, 31
L_at_start:
    s_mov_b32 s21, s27
    s_lshl_b32 s34, s27, 5
    s_add_u32 s31, s21, s70
    s_mul_i32 s50, s31, s52
    s_mov_b32 s101, s31
    s_add_u32 s50, s50, s55
    s_cmp_ge_u32 s31, 2
    s_cselect_b32 s28, 0x40000000, 0
    s_add_u32 s50, s50, s28
    s_mov_b32 s82, s26
    s_mul_i32 s28, s26, s51
    s_add_u32 s50, s50, s28
    s_add_u32 m0, s33, 0
    s_mov_b32 s49, s50
    s_add_u32 s50, s50, s51
    s_add_u32 s82, s82, 1
    s_cmp_eq_u32 s82, 20
    s_cselect_b32 s29, s83, 0
    s_sub_u32 s50, s50, s29
    s_add_u32 s28, s49, s88
    buffer_load_dwordx4 v26, s[16:19], s28 offen lds
    s_add_u32 m0, m0, s53
    s_add_u32 s28, s49, s89
    buffer_load_dwordx4 v26, s[16:19], s28 offen lds
    s_add_u32 m0, m0, s53
    s_add_u32 s28, s49, s90
    buffer_load_dwordx4 v26, s[16:19], s28 offen lds
    s_add_u32 m0, m0, s53
    s_add_u32 s28, s49, s91
    buffer_load_dwordx4 v26, s[16:19], s28 offen lds
    s_add_u32 m0, m0, s53
    s_add_u32 s28, s49, s92
    buffer_load_dwordx4 v26, s[16:19], s28 offen lds
    s_add_u32 m0, m0, s53
    s_add_u32 s28, s49, s93
    buffer_load_dwordx4 v26, s[16:19], s28 offen lds
    s_add_u32 m0, m0, s53
    s_add_u32 s28, s49, s94
    buffer_load_dwordx4 v26, s[16:19], s28 offen lds
    s_add_u32 m0, m0, s53
    s_add_u32 s28, s49, s95
    buffer_load_dwordx4 v26, s[16:19], s28 offen lds
    s_add_u32 m0, s33, 8448
    s_mov_b32 s49, s50
    s_add_u32 s50, s50, s51
    s_add_u32 s82, s82, 1
    s_cmp_eq_u32 s82, 20
    s_cselect_b32 s29, s83, 0
    s_sub_u32 s50, s50, s29
    s_add_u32 s28, s49, s88
    buffer_load_dwordx4 v26, s[16:19], s28 offen lds
    s_add_u32 m0, m0, s53
    s_add_u32 s28, s49, s89
    buffer_load_dwordx4 v26, s[16:19], s28 offen lds
    s_add_u32 m0, m0, s53
    s_add_u32 s28, s49, s90
    buffer_load_dwordx4 v26, s[16:19], s28 offen lds
    s_add_u32 m0, m0, s53
    s_add_u32 s28, s49, s91
    buffer_load_dwordx4 v26, s[16:19], s28 offen lds
    s_add_u32 m0, m0, s53
    s_add_u32 s28, s49, s92
    buffer_load_dwordx4 v26, s[16:19], s28 offen lds
    s_add_u32 m0, m0, s53
    s_add_u32 s28, s49, s93
    buffer_load_dwordx4 v26, s[16:19], s28 offen lds
    s_add_u32 m0, m0, s53
    s_add_u32 s28, s49, s94
    buffer_load_dwordx4 v26, s[16:19], s28 offen lds
    s_add_u32 m0, m0, s53
    s_add_u32 s28, s49, s95
    buffer_load_dwordx4 v26, s[16:19], s28 offen lds
    s_add_u32 m0, s33, 16896
    s_mov_b32 s49, s50
    s_add_u32 s50, s50, s51
    s_add_u32 s82, s82, 1
    s_cmp_eq_u32 s82, 20
    s_cselect_b32 s29, s83, 0
    s_sub_u32 s50, s50, s29
    s_add_u32 s28, s49, s88
    buffer_load_dwordx4 v26, s[16:19], s28 offen lds
    s_add_u32 m0, m0, s53
    s_add_u32 s28, s49, s89
    buffer_load_dwordx4 v26, s[16:19], s28 offen lds
    s_add_u32 m0, m0, s53
    s_add_u32 s28, s49, s90
    buffer_load_dwordx4 v26, s[16:19], s28 offen lds
    s_add_u32 m0, m0, s53
    s_add_u32 s28, s49, s91
    buffer_load_dwordx4 v26, s[16:19], s28 offen lds
    s_add_u32 m0, m0, s53
    s_add_u32 s28, s49, s92
    buffer_load_dwordx4 v26, s[16:19], s28 offen lds
    s_add_u32 m0, m0, s53
    s_add_u32 s28, s49, s93
    buffer_load_dwordx4 v26, s[16:19], s28 offen lds
    s_add_u32 m0, m0, s53
    s_add_u32 s28, s49, s94
    buffer_load_dwordx4 v26, s[16:19], s28 offen lds
    s_add_u32 m0, m0, s53
    s_add_u32 s28, s49, s95
    buffer_load_dwordx4 v26, s[16:19], s28 offen lds
    s_add_u32 m0, s33, 25344
    s_mov_b32 s49, s50
    s_add_u32 s50, s50, s51
    s_add_u32 s82, s82, 1
    s_cmp_eq_u32 s82, 20
    s_cselect_b32 s29, s83, 0
    s_sub_u32 s50, s50, s29
    s_add_u32 s28, s49, s88
    buffer_load_dwordx4 v26, s[16:19], s28 offen lds
    s_add_u32 m0, m0, s53
    s_add_u32 s28, s49, s89
    buffer_load_dwordx4 v26, s[16:19], s28 offen lds
    s_add_u32 m0, m0, s53
    s_add_u32 s28, s49, s90
    buffer_load_dwordx4 v26, s[16:19], s28 offen lds
    s_add_u32 m0, m0, s53
    s_add_u32 s28, s49, s91
    buffer_load_dwordx4 v26, s[16:19], s28 offen lds
    s_add_u32 m0, m0, s53
    s_add_u32 s28, s49, s92
    buffer_load_dwordx4 v26, s[16:19], s28 offen lds
    s_add_u32 m0, m0, s53
    s_add_u32 s28, s49, s93
    buffer_load_dwordx4 v26, s[16:19], s28 offen lds
    s_add_u32 m0, m0, s53
    s_add_u32 s28, s49, s94
    buffer_load_dwordx4 v26, s[16:19], s28 offen lds
    s_add_u32 m0, m0, s53
    s_add_u32 s28, s49, s95
    buffer_load_dwordx4 v26, s[16:19], s28 offen lds
    s_waitcnt vmcnt(24) lgkmcnt(0)
    s_barrier
L_at_round:
    ds_read_b64_tr_b16 v[112:113], v11 offset:0
    ds_read_b64_tr_b16 v[114:115], v11 offset:256
    ds_read_b64_tr_b16 v[116:117], v11 offset:32
    ds_read_b64_tr_b16 v[118:119], v11 offset:288
    ds_read_b64_tr_b16 v[120:121], v11 offset:64
    ds_read_b64_tr_b16 v[122:123], v11 offset:320
    ds_read_b64_tr_b16 v[124:125], v11 offset:96
    ds_read_b64_tr_b16 v[126:127], v11 offset:352
    ds_read_b64_tr_b16 v[128:129], v11 offset:128
    ds_read_b64_tr_b16 v[130:131], v11 offset:384
    ds_read_b64_tr_b16 v[132:133], v11 offset:160
    ds_read_b64_tr_b16 v[134:135], v11 offset:416
    ds_read_b64_tr_b16 v[136:137], v11 offset:192
    ds_read_b64_tr_b16 v[138:139], v11 offset:448
    ds_read_b64_tr_b16 v[140:141], v11 offset:224
    ds_read_b64_tr_b16 v[142:143], v11 offset:480
    ds_read_b128 v[56:59], v27 offset:0
    ds_read_b128 v[60:63], v27 offset:1024
    ds_read_b128 v[64:67], v27 offset:2048
    ds_read_b128 v[68:71], v27 offset:3072
    ds_read_b128 v[72:75], v27 offset:4096
    ds_read_b128 v[76:79], v27 offset:5120
    ds_read_b128 v[80:83], v27 offset:6144
    s_waitcnt lgkmcnt(0)
    s_waitcnt lgkmcnt(14)
    v_mfma_f32_16x16x32_bf16 v[144:147], v[112:115], v[56:59], 0
    s_add_u32 m0, s33, 0
    v_mfma_f32_16x16x32_bf16 v[148:151], v[112:115], v[60:63], 0
    s_mov_b32 s49, s50
    v_mfma_f32_16x16x32_bf16 v[152:155], v[112:115], v[64:67], 0
    s_add_u32 s50, s50, s51
    v_mfma_f32_16x16x32_bf16 v[156:159], v[112:115], v[68:71], 0
    s_add_u32 s82, s82, 1
    v_mfma_f32_16x16x32_bf16 v[160:163], v[112:115], v[72:75], 0
    s_cmp_eq_u32 s82, 20
    v_mfma_f32_16x16x32_bf16 v[164:167], v[112:115], v[76:79], 0
    s_cselect_b32 s29, s83, 0
    v_mfma_f32_16x16x32_bf16 v[168:171], v[112:115], v[80:83], 0
    s_sub_u32 s50, s50, s29
    s_cmp_eq_u32 s68, 0
    s_cbranch_scc0 L_bw1_455
    s_waitcnt vmcnt(16) lgkmcnt(0)
L_bw2_455:
    s_barrier
    s_cmp_le_u32 s21, s27
    s_cbranch_scc1 L_at_nofb_460
    s_sub_u32 s28, s21, 1
    s_cmp_eq_u32 s28, s23
    s_cbranch_scc1 L_at_nofb_460
    s_lshl_b32 s29, s28, 2
    s_add_u32 s29, s29, 76000
    v_mov_b32 v4, s29
    ds_read_b32 v4, v4
    s_waitcnt lgkmcnt(0)
    v_readfirstlane_b32 s29, v4
    s_nop 3
    s_cmp_lg_u32 s29, 0
    s_cbranch_scc1 L_at_fallback
L_at_nofb_460:
    ds_read_b64_tr_b16 v[112:113], v11 offset:8448
    v_mfma_f32_16x16x32_bf16 v[172:175], v[116:119], v[56:59], 0
    ds_read_b64_tr_b16 v[114:115], v11 offset:8704
    v_mfma_f32_16x16x32_bf16 v[176:179], v[116:119], v[60:63], 0
    ds_read_b128 v[28:31], v27 offset:8448
    v_mfma_f32_16x16x32_bf16 v[180:183], v[116:119], v[64:67], 0
    s_add_u32 s28, s49, s88
    buffer_load_dwordx4 v26, s[16:19], s28 offen lds
    v_mfma_f32_16x16x32_bf16 v[184:187], v[116:119], v[68:71], 0
    s_add_u32 m0, m0, s53
    ds_read_b128 v[32:35], v27 offset:9472
    v_mfma_f32_16x16x32_bf16 v[188:191], v[116:119], v[72:75], 0
    ds_read_b128 v[36:39], v27 offset:10496
    v_mfma_f32_16x16x32_bf16 v[192:195], v[116:119], v[76:79], 0
    ds_read_b128 v[40:43], v27 offset:11520
    v_mfma_f32_16x16x32_bf16 v[196:199], v[116:119], v[80:83], 0
    ds_read_b128 v[44:47], v27 offset:12544
    v_mfma_f32_16x16x32_bf16 v[200:203], v[120:123], v[56:59], 0
    ds_read_b128 v[48:51], v27 offset:13568
    v_mfma_f32_16x16x32_bf16 v[204:207], v[120:123], v[60:63], 0
    s_add_u32 s28, s49, s89
    buffer_load_dwordx4 v26, s[16:19], s28 offen lds
    v_mfma_f32_16x16x32_bf16 v[208:211], v[120:123], v[64:67], 0
    s_add_u32 m0, m0, s53
    ds_read_b128 v[52:55], v27 offset:14592
    v_mfma_f32_16x16x32_bf16 v[212:215], v[120:123], v[68:71], 0
    ds_read_b64_tr_b16 v[116:117], v11 offset:8480
    v_mfma_f32_16x16x32_bf16 v[216:219], v[120:123], v[72:75], 0
    ds_read_b64_tr_b16 v[118:119], v11 offset:8736
    v_mfma_f32_16x16x32_bf16 v[220:223], v[120:123], v[76:79], 0
    v_mfma_f32_16x16x32_bf16 v[224:227], v[120:123], v[80:83], 0
    ds_read_b64_tr_b16 v[120:121], v11 offset:8512
    v_mfma_f32_16x16x32_bf16 v[228:231], v[124:127], v[56:59], 0
    s_add_u32 s28, s49, s90
    buffer_load_dwordx4 v26, s[16:19], s28 offen lds
    v_mfma_f32_16x16x32_bf16 v[232:235], v[124:127], v[60:63], 0
    s_add_u32 m0, m0, s53
    ds_read_b64_tr_b16 v[122:123], v11 offset:8768
    v_mfma_f32_16x16x32_bf16 v[236:239], v[124:127], v[64:67], 0
    v_mfma_f32_16x16x32_bf16 v[240:243], v[124:127], v[68:71], 0
    v_mfma_f32_16x16x32_bf16 v[244:247], v[124:127], v[72:75], 0
    v_mfma_f32_16x16x32_bf16 v[248:251], v[124:127], v[76:79], 0
    v_mfma_f32_16x16x32_bf16 v[252:255], v[124:127], v[80:83], 0
    s_add_u32 s28, s49, s91
    buffer_load_dwordx4 v26, s[16:19], s28 offen lds
    v_mfma_f32_16x16x32_bf16 a[112:115], v[128:131], v[56:59], 0
    s_add_u32 m0, m0, s53
    ds_read_b64_tr_b16 v[124:125], v11 offset:8544
    v_mfma_f32_16x16x32_bf16 a[116:119], v[128:131], v[60:63], 0
    ds_read_b64_tr_b16 v[126:127], v11 offset:8800
    v_mfma_f32_16x16x32_bf16 a[120:123], v[128:131], v[64:67], 0
    v_mfma_f32_16x16x32_bf16 a[124:127], v[128:131], v[68:71], 0
    v_mfma_f32_16x16x32_bf16 a[128:131], v[128:131], v[72:75], 0
    v_mfma_f32_16x16x32_bf16 a[132:135], v[128:131], v[76:79], 0
    s_add_u32 s28, s49, s92
    buffer_load_dwordx4 v26, s[16:19], s28 offen lds
    v_mfma_f32_16x16x32_bf16 a[136:139], v[128:131], v[80:83], 0
    s_add_u32 m0, m0, s53
    ds_read_b64_tr_b16 v[128:129], v11 offset:8576
    v_mfma_f32_16x16x32_bf16 a[140:143], v[132:135], v[56:59], 0
    ds_read_b64_tr_b16 v[130:131], v11 offset:8832
    v_mfma_f32_16x16x32_bf16 a[144:147], v[132:135], v[60:63], 0
    v_mfma_f32_16x16x32_bf16 a[148:151], v[132:135], v[64:67], 0
    v_mfma_f32_16x16x32_bf16 a[152:155], v[132:135], v[68:71], 0
    v_mfma_f32_16x16x32_bf16 a[156:159], v[132:135], v[72:75], 0
    s_add_u32 s28, s49, s93
    buffer_load_dwordx4 v26, s[16:19], s28 offen lds
    v_mfma_f32_16x16x32_bf16 a[160:163], v[132:135], v[76:79], 0
    s_add_u32 m0, m0, s53
    v_mfma_f32_16x16x32_bf16 a[164:167], v[132:135], v[80:83], 0
    ds_read_b64_tr_b16 v[132:133], v11 offset:8608
    v_mfma_f32_16x16x32_bf16 a[168:171], v[136:139], v[56:59], 0
    ds_read_b64_tr_b16 v[134:135], v11 offset:8864
    v_mfma_f32_16x16x32_bf16 a[172:175], v[136:139], v[60:63], 0
    v_mfma_f32_16x16x32_bf16 a[176:179], v[136:139], v[64:67], 0
    v_mfma_f32_16x16x32_bf16 a[180:183], v[136:139], v[68:71], 0
    s_add_u32 s28, s49, s94
    buffer_load_dwordx4 v26, s[16:19], s28 offen lds
    v_mfma_f32_16x16x32_bf16 a[184:187], v[136:139], v[72:75], 0
    s_add_u32 m0, m0, s53
    v_mfma_f32_16x16x32_bf16 a[188:191], v[136:139], v[76:79], 0
    v_mfma_f32_16x16x32_bf16 a[192:195], v[136:139], v[80:83], 0
    ds_read_b64_tr_b16 v[136:137], v11 offset:8640
    v_mfma_f32_16x16x32_bf16 a[196:199], v[140:143], v[56:59], 0
    ds_read_b64_tr_b16 v[138:139], v11 offset:8896
    v_mfma_f32_16x16x32_bf16 a[200:203], v[140:143], v[60:63], 0
    v_mfma_f32_16x16x32_bf16 a[204:207], v[140:143], v[64:67], 0
    s_add_u32 s28, s49, s95
    buffer_load_dwordx4 v26, s[16:19], s28 offen lds
    v_mfma_f32_16x16x32_bf16 a[208:211], v[140:143], v[68:71], 0
    v_mfma_f32_16x16x32_bf16 a[212:215], v[140:143], v[72:75], 0
    v_mfma_f32_16x16x32_bf16 a[216:219], v[140:143], v[76:79], 0
    v_mfma_f32_16x16x32_bf16 a[220:223], v[140:143], v[80:83], 0
    ds_read_b64_tr_b16 v[140:141], v11 offset:8672
    ds_read_b64_tr_b16 v[142:143], v11 offset:8928
    s_waitcnt lgkmcnt(14)
    v_mfma_f32_16x16x32_bf16 v[144:147], v[112:115], v[28:31], v[144:147]
    s_add_u32 m0, s33, 8448
    v_mfma_f32_16x16x32_bf16 v[148:151], v[112:115], v[32:35], v[148:151]
    s_mov_b32 s49, s50
    v_mfma_f32_16x16x32_bf16 v[152:155], v[112:115], v[36:39], v[152:155]
    s_add_u32 s50, s50, s51
    v_mfma_f32_16x16x32_bf16 v[156:159], v[112:115], v[40:43], v[156:159]
    s_add_u32 s82, s82, 1
    v_mfma_f32_16x16x32_bf16 v[160:163], v[112:115], v[44:47], v[160:163]
    s_cmp_eq_u32 s82, 20
    v_mfma_f32_16x16x32_bf16 v[164:167], v[112:115], v[48:51], v[164:167]
    s_cselect_b32 s29, s83, 0
    v_mfma_f32_16x16x32_bf16 v[168:171], v[112:115], v[52:55], v[168:171]
    s_sub_u32 s50, s50, s29
    s_cmp_eq_u32 s68, 0
    s_cbranch_scc0 L_bw1_585
    s_waitcnt vmcnt(16) lgkmcnt(0)
L_bw2_585:
    s_barrier
    ds_read_b64_tr_b16 v[112:113], v11 offset:16896
    v_mfma_f32_16x16x32_bf16 v[172:175], v[116:119], v[28:31], v[172:175]
    ds_read_b64_tr_b16 v[114:115], v11 offset:17152
    v_mfma_f32_16x16x32_bf16 v[176:179], v[116:119], v[32:35], v[176:179]
    ds_read_b128 v[56:59], v27 offset:16896
    v_mfma_f32_16x16x32_bf16 v[180:183], v[116:119], v[36:39], v[180:183]
    s_add_u32 s28, s49, s88
    buffer_load_dwordx4 v26, s[16:19], s28 offen lds
    v_mfma_f32_16x16x32_bf16 v[184:187], v[116:119], v[40:43], v[184:187]
    s_add_u32 m0, m0, s53
    ds_read_b128 v[60:63], v27 offset:17920
    v_mfma_f32_16x16x32_bf16 v[188:191], v[116:119], v[44:47], v[188:191]
    ds_read_b128 v[64:67], v27 offset:18944
    v_mfma_f32_16x16x32_bf16 v[192:195], v[116:119], v[48:51], v[192:195]
    ds_read_b128 v[68:71], v27 offset:19968
    v_mfma_f32_16x16x32_bf16 v[196:199], v[116:119], v[52:55], v[196:199]
    ds_read_b128 v[72:75], v27 offset:20992
    v_mfma_f32_16x16x32_bf16 v[200:203], v[120:123], v[28:31], v[200:203]
    ds_read_b128 v[76:79], v27 offset:22016
    v_mfma_f32_16x16x32_bf16 v[204:207], v[120:123], v[32:35], v[204:207]
    s_add_u32 s28, s49, s89
    buffer_load_dwordx4 v26, s[16:19], s28 offen lds
    v_mfma_f32_16x16x32_bf16 v[208:211], v[120:123], v[36:39], v[208:211]
    s_add_u32 m0, m0, s53
    ds_read_b128 v[80:83], v27 offset:23040
    v_mfma_f32_16x16x32_bf16 v[212:215], v[120:123], v[40:43], v[212:215]
    ds_read_b64_tr_b16 v[116:117], v11 offset:16928
    v_mfma_f32_16x16x32_bf16 v[216:219], v[120:123], v[44:47], v[216:219]
    ds_read_b64_tr_b16 v[118:119], v11 offset:17184
    v_mfma_f32_16x16x32_bf16 v[220:223], v[120:123], v[48:51], v[220:223]
    v_mfma_f32_16x16x32_bf16 v[224:227], v[120:123], v[52:55], v[224:227]
    ds_read_b64_tr_b16 v[120:121], v11 offset:16960
    v_mfma_f32_16x16x32_bf16 v[228:231], v[124:127], v[28:31], v[228:231]
    s_add_u32 s28, s49, s90
    buffer_load_dwordx4 v26, s[16:19], s28 offen lds
    v_mfma_f32_16x16x32_bf16 v[232:235], v[124:127], v[32:35], v[232:235]
    s_add_u32 m0, m0, s53
    ds_read_b64_tr_b16 v[122:123], v11 offset:17216
    v_mfma_f32_16x16x32_bf16 v[236:239], v[124:127], v[36:39], v[236:239]
    v_mfma_f32_16x16x32_bf16 v[240:243], v[124:127], v[40:43], v[240:243]
    v_mfma_f32_16x16x32_bf16 v[244:247], v[124:127], v[44:47], v[244:247]
    v_mfma_f32_16x16x32_bf16 v[248:251], v[124:127], v[48:51], v[248:251]
    v_mfma_f32_16x16x32_bf16 v[252:255], v[124:127], v[52:55], v[252:255]
    s_add_u32 s28, s49, s91
    buffer_load_dwordx4 v26, s[16:19], s28 offen lds
    v_mfma_f32_16x16x32_bf16 a[112:115], v[128:131], v[28:31], a[112:115]
    s_add_u32 m0, m0, s53
    ds_read_b64_tr_b16 v[124:125], v11 offset:16992
    v_mfma_f32_16x16x32_bf16 a[116:119], v[128:131], v[32:35], a[116:119]
    ds_read_b64_tr_b16 v[126:127], v11 offset:17248
    v_mfma_f32_16x16x32_bf16 a[120:123], v[128:131], v[36:39], a[120:123]
    v_mfma_f32_16x16x32_bf16 a[124:127], v[128:131], v[40:43], a[124:127]
    v_mfma_f32_16x16x32_bf16 a[128:131], v[128:131], v[44:47], a[128:131]
    v_mfma_f32_16x16x32_bf16 a[132:135], v[128:131], v[48:51], a[132:135]
    s_add_u32 s28, s49, s92
    buffer_load_dwordx4 v26, s[16:19], s28 offen lds
    v_mfma_f32_16x16x32_bf16 a[136:139], v[128:131], v[52:55], a[136:139]
    s_add_u32 m0, m0, s53
    ds_read_b64_tr_b16 v[128:129], v11 offset:17024
    v_mfma_f32_16x16x32_bf16 a[140:143], v[132:135], v[28:31], a[140:143]
    ds_read_b64_tr_b16 v[130:131], v11 offset:17280
    v_mfma_f32_16x16x32_bf16 a[144:147], v[132:135], v[32:35], a[144:147]
    v_mfma_f32_16x16x32_bf16 a[148:151], v[132:135], v[36:39], a[148:151]
    v_mfma_f32_16x16x32_bf16 a[152:155], v[132:135], v[40:43], a[152:155]
    v_mfma_f32_16x16x32_bf16 a[156:159], v[132:135], v[44:47], a[156:159]
    s_add_u32 s28, s49, s93
    buffer_load_dwordx4 v26, s[16:19], s28 offen lds
    v_mfma_f32_16x16x32_bf16 a[160:163], v[132:135], v[48:51], a[160:163]
    s_add_u32 m0, m0, s53
    v_mfma_f32_16x16x32_bf16 a[164:167], v[132:135], v[52:55], a[164:167]
    ds_read_b64_tr_b16 v[132:133], v11 offset:17056
    v_mfma_f32_16x16x32_bf16 a[168:171], v[136:139], v[28:31], a[168:171]
    ds_read_b64_tr_b16 v[134:135], v11 offset:17312
    v_mfma_f32_16x16x32_bf16 a[172:175], v[136:139], v[32:35], a[172:175]
    v_mfma_f32_16x16x32_bf16 a[176:179], v[136:139], v[36:39], a[176:179]
    v_mfma_f32_16x16x32_bf16 a[180:183], v[136:139], v[40:43], a[180:183]
    s_add_u32 s28, s49, s94
    buffer_load_dwordx4 v26, s[16:19], s28 offen lds
    v_mfma_f32_16x16x32_bf16 a[184:187], v[136:139], v[44:47], a[184:187]
    s_add_u32 m0, m0, s53
    v_mfma_f32_16x16x32_bf16 a[188:191], v[136:139], v[48:51], a[188:191]
    v_mfma_f32_16x16x32_bf16 a[192:195], v[136:139], v[52:55], a[192:195]
    ds_read_b64_tr_b16 v[136:137], v11 offset:17088
    v_mfma_f32_16x16x32_bf16 a[196:199], v[140:143], v[28:31], a[196:199]
    ds_read_b64_tr_b16 v[138:139], v11 offset:17344
    v_mfma_f32_16x16x32_bf16 a[200:203], v[140:143], v[32:35], a[200:203]
    v_mfma_f32_16x16x32_bf16 a[204:207], v[140:143], v[36:39], a[204:207]
    s_add_u32 s28, s49, s95
    buffer_load_dwordx4 v26, s[16:19], s28 offen lds
    v_mfma_f32_16x16x32_bf16 a[208:211], v[140:143], v[40:43], a[208:211]
    v_mfma_f32_16x16x32_bf16 a[212:215], v[140:143], v[44:47], a[212:215]
    v_mfma_f32_16x16x32_bf16 a[216:219], v[140:143], v[48:51], a[216:219]
    v_mfma_f32_16x16x32_bf16 a[220:223], v[140:143], v[52:55], a[220:223]
    ds_read_b64_tr_b16 v[140:141], v11 offset:17120
    ds_read_b64_tr_b16 v[142:143], v11 offset:17376
    s_waitcnt lgkmcnt(14)
    v_mfma_f32_16x16x32_bf16 v[144:147], v[112:115], v[56:59], v[144:147]
    s_add_u32 m0, s33, 16896
    v_mfma_f32_16x16x32_bf16 v[148:151], v[112:115], v[60:63], v[148:151]
    s_mov_b32 s49, s50
    v_mfma_f32_16x16x32_bf16 v[152:155], v[112:115], v[64:67], v[152:155]
    s_add_u32 s50, s50, s51
    v_mfma_f32_16x16x32_bf16 v[156:159], v[112:115], v[68:71], v[156:159]
    s_add_u32 s82, s82, 1
    v_mfma_f32_16x16x32_bf16 v[160:163], v[112:115], v[72:75], v[160:163]
    s_cmp_eq_u32 s82, 20
    v_mfma_f32_16x16x32_bf16 v[164:167], v[112:115], v[76:79], v[164:167]
    s_cselect_b32 s29, s83, 0
    v_mfma_f32_16x16x32_bf16 v[168:171], v[112:115], v[80:83], v[168:171]
    s_sub_u32 s50, s50, s29
    s_cmp_eq_u32 s68, 0
    s_cbranch_scc0 L_bw1_700
    s_waitcnt vmcnt(16) lgkmcnt(0)
L_bw2_700:
    s_barrier
    ds_read_b64_tr_b16 v[112:113], v11 offset:25344
    v_mfma_f32_16x16x32_bf16 v[172:175], v[116:119], v[56:59], v[172:175]
    ds_read_b64_tr_b16 v[114:115], v11 offset:25600
    v_mfma_f32_16x16x32_bf16 v[176:179], v[116:119], v[60:63], v[176:179]
    ds_read_b128 v[28:31], v27 offset:25344
    v_mfma_f32_16x16x32_bf16 v[180:183], v[116:119], v[64:67], v[180:183]
    s_add_u32 s28, s49, s88
    buffer_load_dwordx4 v26, s[16:19], s28 offen lds
    v_mfma_f32_16x16x32_bf16 v[184:187], v[116:119], v[68:71], v[184:187]
    s_add_u32 m0, m0, s53
    ds_read_b128 v[32:35], v27 offset:26368
    v_mfma_f32_16x16x32_bf16 v[188:191], v[116:119], v[72:75], v[188:191]
    ds_read_b128 v[36:39], v27 offset:27392
    v_mfma_f32_16x16x32_bf16 v[192:195], v[116:119], v[76:79], v[192:195]
    ds_read_b128 v[40:43], v27 offset:28416
    v_mfma_f32_16x16x32_bf16 v[196:199], v[116:119], v[80:83], v[196:199]
    ds_read_b128 v[44:47], v27 offset:29440
    v_mfma_f32_16x16x32_bf16 v[200:203], v[120:123], v[56:59], v[200:203]
    ds_read_b128 v[48:51], v27 offset:30464
    v_mfma_f32_16x16x32_bf16 v[204:207], v[120:123], v[60:63], v[204:207]
    s_add_u32 s28, s49, s89
    buffer_load_dwordx4 v26, s[16:19], s28 offen lds
    v_mfma_f32_16x16x32_bf16 v[208:211], v[120:123], v[64:67], v[208:211]
    s_add_u32 m0, m0, s53
    ds_read_b128 v[52:55], v27 offset:31488
    v_mfma_f32_16x16x32_bf16 v[212:215], v[120:123], v[68:71], v[212:215]
    ds_read_b64_tr_b16 v[116:117], v11 offset:25376
    v_mfma_f32_16x16x32_bf16 v[216:219], v[120:123], v[72:75], v[216:219]
    ds_read_b64_tr_b16 v[118:119], v11 offset:25632
    v_mfma_f32_16x16x32_bf16 v[220:223], v[120:123], v[76:79], v[220:223]
    v_mfma_f32_16x16x32_bf16 v[224:227], v[120:123], v[80:83], v[224:227]
    ds_read_b64_tr_b16 v[120:121], v11 offset:25408
    v_mfma_f32_16x16x32_bf16 v[228:231], v[124:127], v[56:59], v[228:231]
    s_add_u32 s28, s49, s90
    buffer_load_dwordx4 v26, s[16:19], s28 offen lds
    v_mfma_f32_16x16x32_bf16 v[232:235], v[124:127], v[60:63], v[232:235]
    s_add_u32 m0, m0, s53
    ds_read_b64_tr_b16 v[122:123], v11 offset:25664
    v_mfma_f32_16x16x32_bf16 v[236:239], v[124:127], v[64:67], v[236:239]
    v_mfma_f32_16x16x32_bf16 v[240:243], v[124:127], v[68:71], v[240:243]
    v_mfma_f32_16x16x32_bf16 v[244:247], v[124:127], v[72:75], v[244:247]
    v_mfma_f32_16x16x32_bf16 v[248:251], v[124:127], v[76:79], v[248:251]
    v_mfma_f32_16x16x32_bf16 v[252:255], v[124:127], v[80:83], v[252:255]
    s_add_u32 s28, s49, s91
    buffer_load_dwordx4 v26, s[16:19], s28 offen lds
    v_mfma_f32_16x16x32_bf16 a[112:115], v[128:131], v[56:59], a[112:115]
    s_add_u32 m0, m0, s53
    ds_read_b64_tr_b16 v[124:125], v11 offset:25440
    v_mfma_f32_16x16x32_bf16 a[116:119], v[128:131], v[60:63], a[116:119]
    ds_read_b64_tr_b16 v[126:127], v11 offset:25696
    v_mfma_f32_16x16x32_bf16 a[120:123], v[128:131], v[64:67], a[120:123]
    v_mfma_f32_16x16x32_bf16 a[124:127], v[128:131], v[68:71], a[124:127]
    v_mfma_f32_16x16x32_bf16 a[128:131], v[128:131], v[72:75], a[128:131]
    v_mfma_f32_16x16x32_bf16 a[132:135], v[128:131], v[76:79], a[132:135]
    s_add_u32 s28, s49, s92
    buffer_load_dwordx4 v26, s[16:19], s28 offen lds
    v_mfma_f32_16x16x32_bf16 a[136:139], v[128:131], v[80:83], a[136:139]
    s_add_u32 m0, m0, s53
    ds_read_b64_tr_b16 v[128:129], v11 offset:25472
    v_mfma_f32_16x16x32_bf16 a[140:143], v[132:135], v[56:59], a[140:143]
    ds_read_b64_tr_b16 v[130:131], v11 offset:25728
    v_mfma_f32_16x16x32_bf16 a[144:147], v[132:135], v[60:63], a[144:147]
    v_mfma_f32_16x16x32_bf16 a[148:151], v[132:135], v[64:67], a[148:151]
    v_mfma_f32_16x16x32_bf16 a[152:155], v[132:135], v[68:71], a[152:155]
    v_mfma_f32_16x16x32_bf16 a[156:159], v[132:135], v[72:75], a[156:159]
    s_add_u32 s28, s49, s93
    buffer_load_dwordx4 v26, s[16:19], s28 offen lds
    v_mfma_f32_16x16x32_bf16 a[160:163], v[132:135], v[76:79], a[160:163]
    s_add_u32 m0, m0, s53
    v_mfma_f32_16x16x32_bf16 a[164:167], v[132:135], v[80:83], a[164:167]
    ds_read_b64_tr_b16 v[132:133], v11 offset:25504
    v_mfma_f32_16x16x32_bf16 a[168:171], v[136:139], v[56:59], a[168:171]
    ds_read_b64_tr_b16 v[134:135], v11 offset:25760
    v_mfma_f32_16x16x32_bf16 a[172:175], v[136:139], v[60:63], a[172:175]
    v_mfma_f32_16x16x32_bf16 a[176:179], v[136:139], v[64:67], a[176:179]
    v_mfma_f32_16x16x32_bf16 a[180:183], v[136:139], v[68:71], a[180:183]
    s_add_u32 s28, s49, s94
    buffer_load_dwordx4 v26, s[16:19], s28 offen lds
    v_mfma_f32_16x16x32_bf16 a[184:187], v[136:139], v[72:75], a[184:187]
    s_add_u32 m0, m0, s53
    v_mfma_f32_16x16x32_bf16 a[188:191], v[136:139], v[76:79], a[188:191]
    v_mfma_f32_16x16x32_bf16 a[192:195], v[136:139], v[80:83], a[192:195]
    ds_read_b64_tr_b16 v[136:137], v11 offset:25536
    v_mfma_f32_16x16x32_bf16 a[196:199], v[140:143], v[56:59], a[196:199]
    ds_read_b64_tr_b16 v[138:139], v11 offset:25792
    v_mfma_f32_16x16x32_bf16 a[200:203], v[140:143], v[60:63], a[200:203]
    v_mfma_f32_16x16x32_bf16 a[204:207], v[140:143], v[64:67], a[204:207]
    s_add_u32 s28, s49, s95
    buffer_load_dwordx4 v26, s[16:19], s28 offen lds
    v_mfma_f32_16x16x32_bf16 a[208:211], v[140:143], v[68:71], a[208:211]
    v_mfma_f32_16x16x32_bf16 a[212:215], v[140:143], v[72:75], a[212:215]
    v_mfma_f32_16x16x32_bf16 a[216:219], v[140:143], v[76:79], a[216:219]
    v_mfma_f32_16x16x32_bf16 a[220:223], v[140:143], v[80:83], a[220:223]
    ds_read_b64_tr_b16 v[140:141], v11 offset:25568
    ds_read_b64_tr_b16 v[142:143], v11 offset:25824
    s_waitcnt lgkmcnt(14)
    v_mfma_f32_16x16x32_bf16 v[144:147], v[112:115], v[28:31], v[144:147]
    s_add_u32 m0, s33, 25344
    v_mfma_f32_16x16x32_bf16 v[148:151], v[112:115], v[32:35], v[148:151]
    s_mov_b32 s49, s50
    v_mfma_f32_16x16x32_bf16 v[152:155], v[112:115], v[36:39], v[152:155]
    s_add_u32 s50, s50, s51
    v_mfma_f32_16x16x32_bf16 v[156:159], v[112:115], v[40:43], v[156:159]
    s_add_u32 s82, s82, 1
    v_mfma_f32_16x16x32_bf16 v[160:163], v[112:115], v[44:47], v[160:163]
    s_cmp_eq_u32 s82, 20
    v_mfma_f32_16x16x32_bf16 v[164:167], v[112:115], v[48:51], v[164:167]
    s_cselect_b32 s29, s83, 0
    v_mfma_f32_16x16x32_bf16 v[168:171], v[112:115], v[52:55], v[168:171]
    s_sub_u32 s50, s50, s29
    s_waitcnt vmcnt(16) lgkmcnt(0)
    s_barrier
    ds_read_b64_tr_b16 v[112:113], v11 offset:0
    v_mfma_f32_16x16x32_bf16 v[172:175], v[116:119], v[28:31], v[172:175]
    ds_read_b64_tr_b16 v[114:115], v11 offset:256
    v_mfma_f32_16x16x32_bf16 v[176:179], v[116:119], v[32:35], v[176:179]
    ds_read_b128 v[56:59], v27 offset:0
    v_mfma_f32_16x16x32_bf16 v[180:183], v[116:119], v[36:39], v[180:183]
    s_add_u32 s28, s49, s88
    buffer_load_dwordx4 v26, s[16:19], s28 offen lds
    v_mfma_f32_16x16x32_bf16 v[184:187], v[116:119], v[40:43], v[184:187]
    s_add_u32 m0, m0, s53
    ds_read_b128 v[60:63], v27 offset:1024
    v_mfma_f32_16x16x32_bf16 v[188:191], v[116:119], v[44:47], v[188:191]
    ds_read_b128 v[64:67], v27 offset:2048
    v_mfma_f32_16x16x32_bf16 v[192:195], v[116:119], v[48:51], v[192:195]
    ds_read_b128 v[68:71], v27 offset:3072
    v_mfma_f32_16x16x32_bf16 v[196:199], v[116:119], v[52:55], v[196:199]
    ds_read_b128 v[72:75], v27 offset:4096
    v_mfma_f32_16x16x32_bf16 v[200:203], v[120:123], v[28:31], v[200:203]
    ds_read_b128 v[76:79], v27 offset:5120
    v_mfma_f32_16x16x32_bf16 v[204:207], v[120:123], v[32:35], v[204:207]
    s_add_u32 s28, s49, s89
    buffer_load_dwordx4 v26, s[16:19], s28 offen lds
    v_mfma_f32_16x16x32_bf16 v[208:211], v[120:123], v[36:39], v[208:211]
    s_add_u32 m0, m0, s53
    ds_read_b128 v[80:83], v27 offset:6144
    v_mfma_f32_16x16x32_bf16 v[212:215], v[120:123], v[40:43], v[212:215]
    ds_read_b64_tr_b16 v[116:117], v11 offset:32
    v_mfma_f32_16x16x32_bf16 v[216:219], v[120:123], v[44:47], v[216:219]
    ds_read_b64_tr_b16 v[118:119], v11 offset:288
    v_mfma_f32_16x16x32_bf16 v[220:223], v[120:123], v[48:51], v[220:223]
    v_mfma_f32_16x16x32_bf16 v[224:227], v[120:123], v[52:55], v[224:227]
    ds_read_b64_tr_b16 v[120:121], v11 offset:64
    v_mfma_f32_16x16x32_bf16 v[228:231], v[124:127], v[28:31], v[228:231]
    s_add_u32 s28, s49, s90
    buffer_load_dwordx4 v26, s[16:19], s28 offen lds
    v_mfma_f32_16x16x32_bf16 v[232:235], v[124:127], v[32:35], v[232:235]
    s_add_u32 m0, m0, s53
    ds_read_b64_tr_b16 v[122:123], v11 offset:320
    v_mfma_f32_16x16x32_bf16 v[236:239], v[124:127], v[36:39], v[236:239]
    v_mfma_f32_16x16x32_bf16 v[240:243], v[124:127], v[40:43], v[240:243]
    v_mfma_f32_16x16x32_bf16 v[244:247], v[124:127], v[44:47], v[244:247]
    v_mfma_f32_16x16x32_bf16 v[248:251], v[124:127], v[48:51], v[248:251]
    v_mfma_f32_16x16x32_bf16 v[252:255], v[124:127], v[52:55], v[252:255]
    s_add_u32 s28, s49, s91
    buffer_load_dwordx4 v26, s[16:19], s28 offen lds
    v_mfma_f32_16x16x32_bf16 a[112:115], v[128:131], v[28:31], a[112:115]
    s_add_u32 m0, m0, s53
    ds_read_b64_tr_b16 v[124:125], v11 offset:96
    v_mfma_f32_16x16x32_bf16 a[116:119], v[128:131], v[32:35], a[116:119]
    ds_read_b64_tr_b16 v[126:127], v11 offset:352
    v_mfma_f32_16x16x32_bf16 a[120:123], v[128:131], v[36:39], a[120:123]
    v_mfma_f32_16x16x32_bf16 a[124:127], v[128:131], v[40:43], a[124:127]
    v_mfma_f32_16x16x32_bf16 a[128:131], v[128:131], v[44:47], a[128:131]
    v_mfma_f32_16x16x32_bf16 a[132:135], v[128:131], v[48:51], a[132:135]
    s_add_u32 s28, s49, s92
    buffer_load_dwordx4 v26, s[16:19], s28 offen lds
    v_mfma_f32_16x16x32_bf16 a[136:139], v[128:131], v[52:55], a[136:139]
    s_add_u32 m0, m0, s53
    ds_read_b64_tr_b16 v[128:129], v11 offset:128
    v_mfma_f32_16x16x32_bf16 a[140:143], v[132:135], v[28:31], a[140:143]
    ds_read_b64_tr_b16 v[130:131], v11 offset:384
    v_mfma_f32_16x16x32_bf16 a[144:147], v[132:135], v[32:35], a[144:147]
    v_mfma_f32_16x16x32_bf16 a[148:151], v[132:135], v[36:39], a[148:151]
    v_mfma_f32_16x16x32_bf16 a[152:155], v[132:135], v[40:43], a[152:155]
    v_mfma_f32_16x16x32_bf16 a[156:159], v[132:135], v[44:47], a[156:159]
    s_add_u32 s28, s49, s93
    buffer_load_dwordx4 v26, s[16:19], s28 offen lds
    v_mfma_f32_16x16x32_bf16 a[160:163], v[132:135], v[48:51], a[160:163]
    s_add_u32 m0, m0, s53
    v_mfma_f32_16x16x32_bf16 a[164:167], v[132:135], v[52:55], a[164:167]
    ds_read_b64_tr_b16 v[132:133], v11 offset:160
    v_mfma_f32_16x16x32_bf16 a[168:171], v[136:139], v[28:31], a[168:171]
    ds_read_b64_tr_b16 v[134:135], v11 offset:416
    v_mfma_f32_16x16x32_bf16 a[172:175], v[136:139], v[32:35], a[172:175]
    v_mfma_f32_16x16x32_bf16 a[176:179], v[136:139], v[36:39], a[176:179]
    v_mfma_f32_16x16x32_bf16 a[180:183], v[136:139], v[40:43], a[180:183]
    s_add_u32 s28, s49, s94
    buffer_load_dwordx4 v26, s[16:19], s28 offen lds
    v_mfma_f32_16x16x32_bf16 a[184:187], v[136:139], v[44:47], a[184:187]
    s_add_u32 m0, m0, s53
    v_mfma_f32_16x16x32_bf16 a[188:191], v[136:139], v[48:51], a[188:191]
    v_mfma_f32_16x16x32_bf16 a[192:195], v[136:139], v[52:55], a[192:195]
    ds_read_b64_tr_b16 v[136:137], v11 offset:192
    v_mfma_f32_16x16x32_bf16 a[196:199], v[140:143], v[28:31], a[196:199]
    ds_read_b64_tr_b16 v[138:139], v11 offset:448
    v_mfma_f32_16x16x32_bf16 a[200:203], v[140:143], v[32:35], a[200:203]
    v_mfma_f32_16x16x32_bf16 a[204:207], v[140:143], v[36:39], a[204:207]
    s_add_u32 s28, s49, s95
    buffer_load_dwordx4 v26, s[16:19], s28 offen lds
    v_mfma_f32_16x16x32_bf16 a[208:211], v[140:143], v[40:43], a[208:211]
    v_mfma_f32_16x16x32_bf16 a[212:215], v[140:143], v[44:47], a[212:215]
    v_mfma_f32_16x16x32_bf16 a[216:219], v[140:143], v[48:51], a[216:219]
    v_mfma_f32_16x16x32_bf16 a[220:223], v[140:143], v[52:55], a[220:223]
    ds_read_b64_tr_b16 v[140:141], v11 offset:224
    ds_read_b64_tr_b16 v[142:143], v11 offset:480
    s_mov_b32 s22, 0
L_at_qploop:
    s_waitcnt lgkmcnt(14)
    v_mfma_f32_16x16x32_bf16 v[144:147], v[112:115], v[56:59], v[144:147]
    s_add_u32 m0, s33, 0
    v_mfma_f32_16x16x32_bf16 v[148:151], v[112:115], v[60:63], v[148:151]
    s_mov_b32 s49, s50
    v_mfma_f32_16x16x32_bf16 v[152:155], v[112:115], v[64:67], v[152:155]
    s_add_u32 s50, s50, s51
    v_mfma_f32_16x16x32_bf16 v[156:159], v[112:115], v[68:71], v[156:159]
    s_add_u32 s82, s82, 1
    v_mfma_f32_16x16x32_bf16 v[160:163], v[112:115], v[72:75], v[160:163]
    s_cmp_eq_u32 s82, 20
    v_mfma_f32_16x16x32_bf16 v[164:167], v[112:115], v[76:79], v[164:167]
    s_cselect_b32 s29, s83, 0
    v_mfma_f32_16x16x32_bf16 v[168:171], v[112:115], v[80:83], v[168:171]
    s_sub_u32 s50, s50, s29
    s_waitcnt vmcnt(16) lgkmcnt(0)
    s_barrier
    ds_read_b64_tr_b16 v[112:113], v11 offset:8448
    v_mfma_f32_16x16x32_bf16 v[172:175], v[116:119], v[56:59], v[172:175]
    ds_read_b64_tr_b16 v[114:115], v11 offset:8704
    v_mfma_f32_16x16x32_bf16 v[176:179], v[116:119], v[60:63], v[176:179]
    ds_read_b128 v[28:31], v27 offset:8448
    v_mfma_f32_16x16x32_bf16 v[180:183], v[116:119], v[64:67], v[180:183]
    s_add_u32 s28, s49, s88
    buffer_load_dwordx4 v26, s[16:19], s28 offen lds
    v_mfma_f32_16x16x32_bf16 v[184:187], v[116:119], v[68:71], v[184:187]
    s_add_u32 m0, m0, s53
    ds_read_b128 v[32:35], v27 offset:9472
    v_mfma_f32_16x16x32_bf16 v[188:191], v[116:119], v[72:75], v[188:191]
    ds_read_b128 v[36:39], v27 offset:10496
    v_mfma_f32_16x16x32_bf16 v[192:195], v[116:119], v[76:79], v[192:195]
    ds_read_b128 v[40:43], v27 offset:11520
    v_mfma_f32_16x16x32_bf16 v[196:199], v[116:119], v[80:83], v[196:199]
    ds_read_b128 v[44:47], v27 offset:12544
    v_mfma_f32_16x16x32_bf16 v[200:203], v[120:123], v[56:59], v[200:203]
    ds_read_b128 v[48:51], v27 offset:13568
    v_mfma_f32_16x16x32_bf16 v[204:207], v[120:123], v[60:63], v[204:207]
    s_add_u32 s28, s49, s89
    buffer_load_dwordx4 v26, s[16:19], s28 offen lds
    v_mfma_f32_16x16x32_bf16 v[208:211], v[120:123], v[64:67], v[208:211]
    s_add_u32 m0, m0, s53
    ds_read_b128 v[52:55], v27 offset:14592
    v_mfma_f32_16x16x32_bf16 v[212:215], v[120:123], v[68:71], v[212:215]
    ds_read_b64_tr_b16 v[116:117], v11 offset:8480
    v_mfma_f32_16x16x32_bf16 v[216:219], v[120:123], v[72:75], v[216:219]
    ds_read_b64_tr_b16 v[118:119], v11 offset:8736
    v_mfma_f32_16x16x32_bf16 v[220:223], v[120:123], v[76:79], v[220:223]
    v_mfma_f32_16x16x32_bf16 v[224:227], v[120:123], v[80:83], v[224:227]
    ds_read_b64_tr_b16 v[120:121], v11 offset:8512
    v_mfma_f32_16x16x32_bf16 v[228:231], v[124:127], v[56:59], v[228:231]
    s_add_u32 s28, s49, s90
    buffer_load_dwordx4 v26, s[16:19], s28 offen lds
    v_mfma_f32_16x16x32_bf16 v[232:235], v[124:127], v[60:63], v[232:235]
    s_add_u32 m0, m0, s53
    ds_read_b64_tr_b16 v[122:123], v11 offset:8768
    v_mfma_f32_16x16x32_bf16 v[236:239], v[124:127], v[64:67], v[236:239]
    v_mfma_f32_16x16x32_bf16 v[240:243], v[124:127], v[68:71], v[240:243]
    v_mfma_f32_16x16x32_bf16 v[244:247], v[124:127], v[72:75], v[244:247]
    v_mfma_f32_16x16x32_bf16 v[248:251], v[124:127], v[76:79], v[248:251]
    v_mfma_f32_16x16x32_bf16 v[252:255], v[124:127], v[80:83], v[252:255]
    s_add_u32 s28, s49, s91
    buffer_load_dwordx4 v26, s[16:19], s28 offen lds
    v_mfma_f32_16x16x32_bf16 a[112:115], v[128:131], v[56:59], a[112:115]
    s_add_u32 m0, m0, s53
    ds_read_b64_tr_b16 v[124:125], v11 offset:8544
    v_mfma_f32_16x16x32_bf16 a[116:119], v[128:131], v[60:63], a[116:119]
    ds_read_b64_tr_b16 v[126:127], v11 offset:8800
    v_mfma_f32_16x16x32_bf16 a[120:123], v[128:131], v[64:67], a[120:123]
    v_mfma_f32_16x16x32_bf16 a[124:127], v[128:131], v[68:71], a[124:127]
    v_mfma_f32_16x16x32_bf16 a[128:131], v[128:131], v[72:75], a[128:131]
    v_mfma_f32_16x16x32_bf16 a[132:135], v[128:131], v[76:79], a[132:135]
    s_add_u32 s28, s49, s92
    buffer_load_dwordx4 v26, s[16:19], s28 offen lds
    v_mfma_f32_16x16x32_bf16 a[136:139], v[128:131], v[80:83], a[136:139]
    s_add_u32 m0, m0, s53
    ds_read_b64_tr_b16 v[128:129], v11 offset:8576
    v_mfma_f32_16x16x32_bf16 a[140:143], v[132:135], v[56:59], a[140:143]
    ds_read_b64_tr_b16 v[130:131], v11 offset:8832
    v_mfma_f32_16x16x32_bf16 a[144:147], v[132:135], v[60:63], a[144:147]
    v_mfma_f32_16x16x32_bf16 a[148:151], v[132:135], v[64:67], a[148:151]
    v_mfma_f32_16x16x32_bf16 a[152:155], v[132:135], v[68:71], a[152:155]
    v_mfma_f32_16x16x32_bf16 a[156:159], v[132:135], v[72:75], a[156:159]
    s_add_u32 s28, s49, s93
    buffer_load_dwordx4 v26, s[16:19], s28 offen lds
    v_mfma_f32_16x16x32_bf16 a[160:163], v[132:135], v[76:79], a[160:163]
    s_add_u32 m0, m0, s53
    v_mfma_f32_16x16x32_bf16 a[164:167], v[132:135], v[80:83], a[164:167]
    ds_read_b64_tr_b16 v[132:133], v11 offset:8608
    v_mfma_f32_16x16x32_bf16 a[168:171], v[136:139], v[56:59], a[168:171]
    ds_read_b64_tr_b16 v[134:135], v11 offset:8864
    v_mfma_f32_16x16x32_bf16 a[172:175], v[136:139], v[60:63], a[172:175]
    v_mfma_f32_16x16x32_bf16 a[176:179], v[136:139], v[64:67], a[176:179]
    v_mfma_f32_16x16x32_bf16 a[180:183], v[136:139], v[68:71], a[180:183]
    s_add_u32 s28, s49, s94
    buffer_load_dwordx4 v26, s[16:19], s28 offen lds
    v_mfma_f32_16x16x32_bf16 a[184:187], v[136:139], v[72:75], a[184:187]
    s_add_u32 m0, m0, s53
    v_mfma_f32_16x16x32_bf16 a[188:191], v[136:139], v[76:79], a[188:191]
    v_mfma_f32_16x16x32_bf16 a[192:195], v[136:139], v[80:83], a[192:195]
    ds_read_b64_tr_b16 v[136:137], v11 offset:8640
    v_mfma_f32_16x16x32_bf16 a[196:199], v[140:143], v[56:59], a[196:199]
    ds_read_b64_tr_b16 v[138:139], v11 offset:8896
    v_mfma_f32_16x16x32_bf16 a[200:203], v[140:143], v[60:63], a[200:203]
    v_mfma_f32_16x16x32_bf16 a[204:207], v[140:143], v[64:67], a[204:207]
    s_add_u32 s28, s49, s95
    buffer_load_dwordx4 v26, s[16:19], s28 offen lds
    v_mfma_f32_16x16x32_bf16 a[208:211], v[140:143], v[68:71], a[208:211]
    v_mfma_f32_16x16x32_bf16 a[212:215], v[140:143], v[72:75], a[212:215]
    v_mfma_f32_16x16x32_bf16 a[216:219], v[140:143], v[76:79], a[216:219]
    v_mfma_f32_16x16x32_bf16 a[220:223], v[140:143], v[80:83], a[220:223]
    ds_read_b64_tr_b16 v[140:141], v11 offset:8672
    ds_read_b64_tr_b16 v[142:143], v11 offset:8928
    s_waitcnt lgkmcnt(14)
    v_mfma_f32_16x16x32_bf16 v[144:147], v[112:115], v[28:31], v[144:147]
    s_add_u32 m0, s33, 8448
    v_mfma_f32_16x16x32_bf16 v[148:151], v[112:115], v[32:35], v[148:151]
    s_mov_b32 s49, s50
    v_mfma_f32_16x16x32_bf16 v[152:155], v[112:115], v[36:39], v[152:155]
    s_add_u32 s50, s50, s51
    v_mfma_f32_16x16x32_bf16 v[156:159], v[112:115], v[40:43], v[156:159]
    s_add_u32 s82, s82, 1
    v_mfma_f32_16x16x32_bf16 v[160:163], v[112:115], v[44:47], v[160:163]
    s_cmp_eq_u32 s82, 20
    v_mfma_f32_16x16x32_bf16 v[164:167], v[112:115], v[48:51], v[164:167]
    s_cselect_b32 s29, s83, 0
    v_mfma_f32_16x16x32_bf16 v[168:171], v[112:115], v[52:55], v[168:171]
    s_sub_u32 s50, s50, s29
    s_waitcnt vmcnt(16) lgkmcnt(0)
    s_barrier
    ds_read_b64_tr_b16 v[112:113], v11 offset:16896
    v_mfma_f32_16x16x32_bf16 v[172:175], v[116:119], v[28:31], v[172:175]
    ds_read_b64_tr_b16 v[114:115], v11 offset:17152
    v_mfma_f32_16x16x32_bf16 v[176:179], v[116:119], v[32:35], v[176:179]
    ds_read_b128 v[56:59], v27 offset:16896
    v_mfma_f32_16x16x32_bf16 v[180:183], v[116:119], v[36:39], v[180:183]
    s_add_u32 s28, s49, s88
    buffer_load_dwordx4 v26, s[16:19], s28 offen lds
    v_mfma_f32_16x16x32_bf16 v[184:187], v[116:119], v[40:43], v[184:187]
    s_add_u32 m0, m0, s53
    ds_read_b128 v[60:63], v27 offset:17920
    v_mfma_f32_16x16x32_bf16 v[188:191], v[116:119], v[44:47], v[188:191]
    ds_read_b128 v[64:67], v27 offset:18944
    v_mfma_f32_16x16x32_bf16 v[192:195], v[116:119], v[48:51], v[192:195]
    ds_read_b128 v[68:71], v27 offset:19968
    v_mfma_f32_16x16x32_bf16 v[196:199], v[116:119], v[52:55], v[196:199]
    ds_read_b128 v[72:75], v27 offset:20992
    v_mfma_f32_16x16x32_bf16 v[200:203], v[120:123], v[28:31], v[200:203]
    ds_read_b128 v[76:79], v27 offset:22016
    v_mfma_f32_16x16x32_bf16 v[204:207], v[120:123], v[32:35], v[204:207]
    s_add_u32 s28, s49, s89
    buffer_load_dwordx4 v26, s[16:19], s28 offen lds
    v_mfma_f32_16x16x32_bf16 v[208:211], v[120:123], v[36:39], v[208:211]
    s_add_u32 m0, m0, s53
    ds_read_b128 v[80:83], v27 offset:23040
    v_mfma_f32_16x16x32_bf16 v[212:215], v[120:123], v[40:43], v[212:215]
    ds_read_b64_tr_b16 v[116:117], v11 offset:16928
    v_mfma_f32_16x16x32_bf16 v[216:219], v[120:123], v[44:47], v[216:219]
    ds_read_b64_tr_b16 v[118:119], v11 offset:17184
    v_mfma_f32_16x16x32_bf16 v[220:223], v[120:123], v[48:51], v[220:223]
    v_mfma_f32_16x16x32_bf16 v[224:227], v[120:123], v[52:55], v[224:227]
    ds_read_b64_tr_b16 v[120:121], v11 offset:16960
    v_mfma_f32_16x16x32_bf16 v[228:231], v[124:127], v[28:31], v[228:231]
    s_add_u32 s28, s49, s90
    buffer_load_dwordx4 v26, s[16:19], s28 offen lds
    v_mfma_f32_16x16x32_bf16 v[232:235], v[124:127], v[32:35], v[232:235]
    s_add_u32 m0, m0, s53
    ds_read_b64_tr_b16 v[122:123], v11 offset:17216
    v_mfma_f32_16x16x32_bf16 v[236:239], v[124:127], v[36:39], v[236:239]
    v_mfma_f32_16x16x32_bf16 v[240:243], v[124:127], v[40:43], v[240:243]
    v_mfma_f32_16x16x32_bf16 v[244:247], v[124:127], v[44:47], v[244:247]
    v_mfma_f32_16x16x32_bf16 v[248:251], v[124:127], v[48:51], v[248:251]
    v_mfma_f32_16x16x32_bf16 v[252:255], v[124:127], v[52:55], v[252:255]
    s_add_u32 s28, s49, s91
    buffer_load_dwordx4 v26, s[16:19], s28 offen lds
    v_mfma_f32_16x16x32_bf16 a[112:115], v[128:131], v[28:31], a[112:115]
    s_add_u32 m0, m0, s53
    ds_read_b64_tr_b16 v[124:125], v11 offset:16992
    v_mfma_f32_16x16x32_bf16 a[116:119], v[128:131], v[32:35], a[116:119]
    ds_read_b64_tr_b16 v[126:127], v11 offset:17248
    v_mfma_f32_16x16x32_bf16 a[120:123], v[128:131], v[36:39], a[120:123]
    v_mfma_f32_16x16x32_bf16 a[124:127], v[128:131], v[40:43], a[124:127]
    v_mfma_f32_16x16x32_bf16 a[128:131], v[128:131], v[44:47], a[128:131]
    v_mfma_f32_16x16x32_bf16 a[132:135], v[128:131], v[48:51], a[132:135]
    s_add_u32 s28, s49, s92
    buffer_load_dwordx4 v26, s[16:19], s28 offen lds
    v_mfma_f32_16x16x32_bf16 a[136:139], v[128:131], v[52:55], a[136:139]
    s_add_u32 m0, m0, s53
    ds_read_b64_tr_b16 v[128:129], v11 offset:17024
    v_mfma_f32_16x16x32_bf16 a[140:143], v[132:135], v[28:31], a[140:143]
    ds_read_b64_tr_b16 v[130:131], v11 offset:17280
    v_mfma_f32_16x16x32_bf16 a[144:147], v[132:135], v[32:35], a[144:147]
    v_mfma_f32_16x16x32_bf16 a[148:151], v[132:135], v[36:39], a[148:151]
    v_mfma_f32_16x16x32_bf16 a[152:155], v[132:135], v[40:43], a[152:155]
    v_mfma_f32_16x16x32_bf16 a[156:159], v[132:135], v[44:47], a[156:159]
    s_add_u32 s28, s49, s93
    buffer_load_dwordx4 v26, s[16:19], s28 offen lds
    v_mfma_f32_16x16x32_bf16 a[160:163], v[132:135], v[48:51], a[160:163]
    s_add_u32 m0, m0, s53
    v_mfma_f32_16x16x32_bf16 a[164:167], v[132:135], v[52:55], a[164:167]
    ds_read_b64_tr_b16 v[132:133], v11 offset:17056
    v_mfma_f32_16x16x32_bf16 a[168:171], v[136:139], v[28:31], a[168:171]
    ds_read_b64_tr_b16 v[134:135], v11 offset:17312
    v_mfma_f32_16x16x32_bf16 a[172:175], v[136:139], v[32:35], a[172:175]
    v_mfma_f32_16x16x32_bf16 a[176:179], v[136:139], v[36:39], a[176:179]
    v_mfma_f32_16x16x32_bf16 a[180:183], v[136:139], v[40:43], a[180:183]
    s_add_u32 s28, s49, s94
    buffer_load_dwordx4 v26, s[16:19], s28 offen lds
    v_mfma_f32_16x16x32_bf16 a[184:187], v[136:139], v[44:47], a[184:187]
    s_add_u32 m0, m0, s53
    v_mfma_f32_16x16x32_bf16 a[188:191], v[136:139], v[48:51], a[188:191]
    v_mfma_f32_16x16x32_bf16 a[192:195], v[136:139], v[52:55], a[192:195]
    ds_read_b64_tr_b16 v[136:137], v11 offset:17088
    v_mfma_f32_16x16x32_bf16 a[196:199], v[140:143], v[28:31], a[196:199]
    ds_read_b64_tr_b16 v[138:139], v11 offset:17344
    v_mfma_f32_16x16x32_bf16 a[200:203], v[140:143], v[32:35], a[200:203]
    v_mfma_f32_16x16x32_bf16 a[204:207], v[140:143], v[36:39], a[204:207]
    s_add_u32 s28, s49, s95
    buffer_load_dwordx4 v26, s[16:19], s28 offen lds
    v_mfma_f32_16x16x32_bf16 a[208:211], v[140:143], v[40:43], a[208:211]
    v_mfma_f32_16x16x32_bf16 a[212:215], v[140:143], v[44:47], a[212:215]
    v_mfma_f32_16x16x32_bf16 a[216:219], v[140:143], v[48:51], a[216:219]
    v_mfma_f32_16x16x32_bf16 a[220:223], v[140:143], v[52:55], a[220:223]
    ds_read_b64_tr_b16 v[140:141], v11 offset:17120
    ds_read_b64_tr_b16 v[142:143], v11 offset:17376
    s_waitcnt lgkmcnt(14)
    v_mfma_f32_16x16x32_bf16 v[144:147], v[112:115], v[56:59], v[144:147]
    s_add_u32 m0, s33, 16896
    v_mfma_f32_16x16x32_bf16 v[148:151], v[112:115], v[60:63], v[148:151]
    s_mov_b32 s49, s50
    v_mfma_f32_16x16x32_bf16 v[152:155], v[112:115], v[64:67], v[152:155]
    s_add_u32 s50, s50, s51
    v_mfma_f32_16x16x32_bf16 v[156:159], v[112:115], v[68:71], v[156:159]
    s_add_u32 s82, s82, 1
    v_mfma_f32_16x16x32_bf16 v[160:163], v[112:115], v[72:75], v[160:163]
    s_cmp_eq_u32 s82, 20
    v_mfma_f32_16x16x32_bf16 v[164:167], v[112:115], v[76:79], v[164:167]
    s_cselect_b32 s29, s83, 0
    v_mfma_f32_16x16x32_bf16 v[168:171], v[112:115], v[80:83], v[168:171]
    s_sub_u32 s50, s50, s29
    s_waitcnt vmcnt(16) lgkmcnt(0)
    s_barrier
    ds_read_b64_tr_b16 v[112:113], v11 offset:25344
    v_mfma_f32_16x16x32_bf16 v[172:175], v[116:119], v[56:59], v[172:175]
    ds_read_b64_tr_b16 v[114:115], v11 offset:25600
    v_mfma_f32_16x16x32_bf16 v[176:179], v[116:119], v[60:63], v[176:179]
    ds_read_b128 v[28:31], v27 offset:25344
    v_mfma_f32_16x16x32_bf16 v[180:183], v[116:119], v[64:67], v[180:183]
    s_add_u32 s28, s49, s88
    buffer_load_dwordx4 v26, s[16:19], s28 offen lds
    v_mfma_f32_16x16x32_bf16 v[184:187], v[116:119], v[68:71], v[184:187]
    s_add_u32 m0, m0, s53
    ds_read_b128 v[32:35], v27 offset:26368
    v_mfma_f32_16x16x32_bf16 v[188:191], v[116:119], v[72:75], v[188:191]
    ds_read_b128 v[36:39], v27 offset:27392
    v_mfma_f32_16x16x32_bf16 v[192:195], v[116:119], v[76:79], v[192:195]
    ds_read_b128 v[40:43], v27 offset:28416
    v_mfma_f32_16x16x32_bf16 v[196:199], v[116:119], v[80:83], v[196:199]
    ds_read_b128 v[44:47], v27 offset:29440
    v_mfma_f32_16x16x32_bf16 v[200:203], v[120:123], v[56:59], v[200:203]
    ds_read_b128 v[48:51], v27 offset:30464
    v_mfma_f32_16x16x32_bf16 v[204:207], v[120:123], v[60:63], v[204:207]
    s_add_u32 s28, s49, s89
    buffer_load_dwordx4 v26, s[16:19], s28 offen lds
    v_mfma_f32_16x16x32_bf16 v[208:211], v[120:123], v[64:67], v[208:211]
    s_add_u32 m0, m0, s53
    ds_read_b128 v[52:55], v27 offset:31488
    v_mfma_f32_16x16x32_bf16 v[212:215], v[120:123], v[68:71], v[212:215]
    ds_read_b64_tr_b16 v[116:117], v11 offset:25376
    v_mfma_f32_16x16x32_bf16 v[216:219], v[120:123], v[72:75], v[216:219]
    ds_read_b64_tr_b16 v[118:119], v11 offset:25632
    v_mfma_f32_16x16x32_bf16 v[220:223], v[120:123], v[76:79], v[220:223]
    v_mfma_f32_16x16x32_bf16 v[224:227], v[120:123], v[80:83], v[224:227]
    ds_read_b64_tr_b16 v[120:121], v11 offset:25408
    v_mfma_f32_16x16x32_bf16 v[228:231], v[124:127], v[56:59], v[228:231]
    s_add_u32 s28, s49, s90
    buffer_load_dwordx4 v26, s[16:19], s28 offen lds
    v_mfma_f32_16x16x32_bf16 v[232:235], v[124:127], v[60:63], v[232:235]
    s_add_u32 m0, m0, s53
    ds_read_b64_tr_b16 v[122:123], v11 offset:25664
    v_mfma_f32_16x16x32_bf16 v[236:239], v[124:127], v[64:67], v[236:239]
    v_mfma_f32_16x16x32_bf16 v[240:243], v[124:127], v[68:71], v[240:243]
    v_mfma_f32_16x16x32_bf16 v[244:247], v[124:127], v[72:75], v[244:247]
    v_mfma_f32_16x16x32_bf16 v[248:251], v[124:127], v[76:79], v[248:251]
    v_mfma_f32_16x16x32_bf16 v[252:255], v[124:127], v[80:83], v[252:255]
    s_add_u32 s28, s49, s91
    buffer_load_dwordx4 v26, s[16:19], s28 offen lds
    v_mfma_f32_16x16x32_bf16 a[112:115], v[128:131], v[56:59], a[112:115]
    s_add_u32 m0, m0, s53
    ds_read_b64_tr_b16 v[124:125], v11 offset:25440
    v_mfma_f32_16x16x32_bf16 a[116:119], v[128:131], v[60:63], a[116:119]
    ds_read_b64_tr_b16 v[126:127], v11 offset:25696
    v_mfma_f32_16x16x32_bf16 a[120:123], v[128:131], v[64:67], a[120:123]
    v_mfma_f32_16x16x32_bf16 a[124:127], v[128:131], v[68:71], a[124:127]
    v_mfma_f32_16x16x32_bf16 a[128:131], v[128:131], v[72:75], a[128:131]
    v_mfma_f32_16x16x32_bf16 a[132:135], v[128:131], v[76:79], a[132:135]
    s_add_u32 s28, s49, s92
    buffer_load_dwordx4 v26, s[16:19], s28 offen lds
    v_mfma_f32_16x16x32_bf16 a[136:139], v[128:131], v[80:83], a[136:139]
    s_add_u32 m0, m0, s53
    ds_read_b64_tr_b16 v[128:129], v11 offset:25472
    v_mfma_f32_16x16x32_bf16 a[140:143], v[132:135], v[56:59], a[140:143]
    ds_read_b64_tr_b16 v[130:131], v11 offset:25728
    v_mfma_f32_16x16x32_bf16 a[144:147], v[132:135], v[60:63], a[144:147]
    v_mfma_f32_16x16x32_bf16 a[148:151], v[132:135], v[64:67], a[148:151]
    v_mfma_f32_16x16x32_bf16 a[152:155], v[132:135], v[68:71], a[152:155]
    v_mfma_f32_16x16x32_bf16 a[156:159], v[132:135], v[72:75], a[156:159]
    s_add_u32 s28, s49, s93
    buffer_load_dwordx4 v26, s[16:19], s28 offen lds
    v_mfma_f32_16x16x32_bf16 a[160:163], v[132:135], v[76:79], a[160:163]
    s_add_u32 m0, m0, s53
    v_mfma_f32_16x16x32_bf16 a[164:167], v[132:135], v[80:83], a[164:167]
    ds_read_b64_tr_b16 v[132:133], v11 offset:25504
    v_mfma_f32_16x16x32_bf16 a[168:171], v[136:139], v[56:59], a[168:171]
    ds_read_b64_tr_b16 v[134:135], v11 offset:25760
    v_mfma_f32_16x16x32_bf16 a[172:175], v[136:139], v[60:63], a[172:175]
    v_mfma_f32_16x16x32_bf16 a[176:179], v[136:139], v[64:67], a[176:179]
    v_mfma_f32_16x16x32_bf16 a[180:183], v[136:139], v[68:71], a[180:183]
    s_add_u32 s28, s49, s94
    buffer_load_dwordx4 v26, s[16:19], s28 offen lds
    v_mfma_f32_16x16x32_bf16 a[184:187], v[136:139], v[72:75], a[184:187]
    s_add_u32 m0, m0, s53
    v_mfma_f32_16x16x32_bf16 a[188:191], v[136:139], v[76:79], a[188:191]
    v_mfma_f32_16x16x32_bf16 a[192:195], v[136:139], v[80:83], a[192:195]
    ds_read_b64_tr_b16 v[136:137], v11 offset:25536
    v_mfma_f32_16x16x32_bf16 a[196:199], v[140:143], v[56:59], a[196:199]
    ds_read_b64_tr_b16 v[138:139], v11 offset:25792
    v_mfma_f32_16x16x32_bf16 a[200:203], v[140:143], v[60:63], a[200:203]
    v_mfma_f32_16x16x32_bf16 a[204:207], v[140:143], v[64:67], a[204:207]
    s_add_u32 s28, s49, s95
    buffer_load_dwordx4 v26, s[16:19], s28 offen lds
    v_mfma_f32_16x16x32_bf16 a[208:211], v[140:143], v[68:71], a[208:211]
    v_mfma_f32_16x16x32_bf16 a[212:215], v[140:143], v[72:75], a[212:215]
    v_mfma_f32_16x16x32_bf16 a[216:219], v[140:143], v[76:79], a[216:219]
    v_mfma_f32_16x16x32_bf16 a[220:223], v[140:143], v[80:83], a[220:223]
    ds_read_b64_tr_b16 v[140:141], v11 offset:25568
    ds_read_b64_tr_b16 v[142:143], v11 offset:25824
    s_waitcnt lgkmcnt(14)
    v_mfma_f32_16x16x32_bf16 v[144:147], v[112:115], v[28:31], v[144:147]
    s_add_u32 m0, s33, 25344
    v_mfma_f32_16x16x32_bf16 v[148:151], v[112:115], v[32:35], v[148:151]
    s_mov_b32 s49, s50
    v_mfma_f32_16x16x32_bf16 v[152:155], v[112:115], v[36:39], v[152:155]
    s_add_u32 s50, s50, s51
    v_mfma_f32_16x16x32_bf16 v[156:159], v[112:115], v[40:43], v[156:159]
    s_add_u32 s82, s82, 1
    v_mfma_f32_16x16x32_bf16 v[160:163], v[112:115], v[44:47], v[160:163]
    s_cmp_eq_u32 s82, 20
    v_mfma_f32_16x16x32_bf16 v[164:167], v[112:115], v[48:51], v[164:167]
    s_cselect_b32 s29, s83, 0
    v_mfma_f32_16x16x32_bf16 v[168:171], v[112:115], v[52:55], v[168:171]
    s_sub_u32 s50, s50, s29
    s_waitcnt vmcnt(16) lgkmcnt(0)
    s_barrier
    ds_read_b64_tr_b16 v[112:113], v11 offset:0
    v_mfma_f32_16x16x32_bf16 v[172:175], v[116:119], v[28:31], v[172:175]
    ds_read_b64_tr_b16 v[114:115], v11 offset:256
    v_mfma_f32_16x16x32_bf16 v[176:179], v[116:119], v[32:35], v[176:179]
    ds_read_b128 v[56:59], v27 offset:0
    v_mfma_f32_16x16x32_bf16 v[180:183], v[116:119], v[36:39], v[180:183]
    s_add_u32 s28, s49, s88
    buffer_load_dwordx4 v26, s[16:19], s28 offen lds
    v_mfma_f32_16x16x32_bf16 v[184:187], v[116:119], v[40:43], v[184:187]
    s_add_u32 m0, m0, s53
    ds_read_b128 v[60:63], v27 offset:1024
    v_mfma_f32_16x16x32_bf16 v[188:191], v[116:119], v[44:47], v[188:191]
    ds_read_b128 v[64:67], v27 offset:2048
    v_mfma_f32_16x16x32_bf16 v[192:195], v[116:119], v[48:51], v[192:195]
    ds_read_b128 v[68:71], v27 offset:3072
    v_mfma_f32_16x16x32_bf16 v[196:199], v[116:119], v[52:55], v[196:199]
    ds_read_b128 v[72:75], v27 offset:4096
    v_mfma_f32_16x16x32_bf16 v[200:203], v[120:123], v[28:31], v[200:203]
    ds_read_b128 v[76:79], v27 offset:5120
    v_mfma_f32_16x16x32_bf16 v[204:207], v[120:123], v[32:35], v[204:207]
    s_add_u32 s28, s49, s89
    buffer_load_dwordx4 v26, s[16:19], s28 offen lds
    v_mfma_f32_16x16x32_bf16 v[208:211], v[120:123], v[36:39], v[208:211]
    s_add_u32 m0, m0, s53
    ds_read_b128 v[80:83], v27 offset:6144
    v_mfma_f32_16x16x32_bf16 v[212:215], v[120:123], v[40:43], v[212:215]
    ds_read_b64_tr_b16 v[116:117], v11 offset:32
    v_mfma_f32_16x16x32_bf16 v[216:219], v[120:123], v[44:47], v[216:219]
    ds_read_b64_tr_b16 v[118:119], v11 offset:288
    v_mfma_f32_16x16x32_bf16 v[220:223], v[120:123], v[48:51], v[220:223]
    v_mfma_f32_16x16x32_bf16 v[224:227], v[120:123], v[52:55], v[224:227]
    ds_read_b64_tr_b16 v[120:121], v11 offset:64
    v_mfma_f32_16x16x32_bf16 v[228:231], v[124:127], v[28:31], v[228:231]
    s_add_u32 s28, s49, s90
    buffer_load_dwordx4 v26, s[16:19], s28 offen lds
    v_mfma_f32_16x16x32_bf16 v[232:235], v[124:127], v[32:35], v[232:235]
    s_add_u32 m0, m0, s53
    ds_read_b64_tr_b16 v[122:123], v11 offset:320
    v_mfma_f32_16x16x32_bf16 v[236:239], v[124:127], v[36:39], v[236:239]
    v_mfma_f32_16x16x32_bf16 v[240:243], v[124:127], v[40:43], v[240:243]
    v_mfma_f32_16x16x32_bf16 v[244:247], v[124:127], v[44:47], v[244:247]
    v_mfma_f32_16x16x32_bf16 v[248:251], v[124:127], v[48:51], v[248:251]
    v_mfma_f32_16x16x32_bf16 v[252:255], v[124:127], v[52:55], v[252:255]
    s_add_u32 s28, s49, s91
    buffer_load_dwordx4 v26, s[16:19], s28 offen lds
    v_mfma_f32_16x16x32_bf16 a[112:115], v[128:131], v[28:31], a[112:115]
    s_add_u32 m0, m0, s53
    ds_read_b64_tr_b16 v[124:125], v11 offset:96
    v_mfma_f32_16x16x32_bf16 a[116:119], v[128:131], v[32:35], a[116:119]
    ds_read_b64_tr_b16 v[126:127], v11 offset:352
    v_mfma_f32_16x16x32_bf16 a[120:123], v[128:131], v[36:39], a[120:123]
    v_mfma_f32_16x16x32_bf16 a[124:127], v[128:131], v[40:43], a[124:127]
    v_mfma_f32_16x16x32_bf16 a[128:131], v[128:131], v[44:47], a[128:131]
    v_mfma_f32_16x16x32_bf16 a[132:135], v[128:131], v[48:51], a[132:135]
    s_add_u32 s28, s49, s92
    buffer_load_dwordx4 v26, s[16:19], s28 offen lds
    v_mfma_f32_16x16x32_bf16 a[136:139], v[128:131], v[52:55], a[136:139]
    s_add_u32 m0, m0, s53
    ds_read_b64_tr_b16 v[128:129], v11 offset:128
    v_mfma_f32_16x16x32_bf16 a[140:143], v[132:135], v[28:31], a[140:143]
    ds_read_b64_tr_b16 v[130:131], v11 offset:384
    v_mfma_f32_16x16x32_bf16 a[144:147], v[132:135], v[32:35], a[144:147]
    v_mfma_f32_16x16x32_bf16 a[148:151], v[132:135], v[36:39], a[148:151]
    v_mfma_f32_16x16x32_bf16 a[152:155], v[132:135], v[40:43], a[152:155]
    v_mfma_f32_16x16x32_bf16 a[156:159], v[132:135], v[44:47], a[156:159]
    s_add_u32 s28, s49, s93
    buffer_load_dwordx4 v26, s[16:19], s28 offen lds
    v_mfma_f32_16x16x32_bf16 a[160:163], v[132:135], v[48:51], a[160:163]
    s_add_u32 m0, m0, s53
    v_mfma_f32_16x16x32_bf16 a[164:167], v[132:135], v[52:55], a[164:167]
    ds_read_b64_tr_b16 v[132:133], v11 offset:160
    v_mfma_f32_16x16x32_bf16 a[168:171], v[136:139], v[28:31], a[168:171]
    ds_read_b64_tr_b16 v[134:135], v11 offset:416
    v_mfma_f32_16x16x32_bf16 a[172:175], v[136:139], v[32:35], a[172:175]
    v_mfma_f32_16x16x32_bf16 a[176:179], v[136:139], v[36:39], a[176:179]
    v_mfma_f32_16x16x32_bf16 a[180:183], v[136:139], v[40:43], a[180:183]
    s_add_u32 s28, s49, s94
    buffer_load_dwordx4 v26, s[16:19], s28 offen lds
    v_mfma_f32_16x16x32_bf16 a[184:187], v[136:139], v[44:47], a[184:187]
    s_add_u32 m0, m0, s53
    v_mfma_f32_16x16x32_bf16 a[188:191], v[136:139], v[48:51], a[188:191]
    v_mfma_f32_16x16x32_bf16 a[192:195], v[136:139], v[52:55], a[192:195]
    ds_read_b64_tr_b16 v[136:137], v11 offset:192
    v_mfma_f32_16x16x32_bf16 a[196:199], v[140:143], v[28:31], a[196:199]
    ds_read_b64_tr_b16 v[138:139], v11 offset:448
    v_mfma_f32_16x16x32_bf16 a[200:203], v[140:143], v[32:35], a[200:203]
    v_mfma_f32_16x16x32_bf16 a[204:207], v[140:143], v[36:39], a[204:207]
    s_add_u32 s28, s49, s95
    buffer_load_dwordx4 v26, s[16:19], s28 offen lds
    v_mfma_f32_16x16x32_bf16 a[208:211], v[140:143], v[40:43], a[208:211]
    v_mfma_f32_16x16x32_bf16 a[212:215], v[140:143], v[44:47], a[212:215]
    v_mfma_f32_16x16x32_bf16 a[216:219], v[140:143], v[48:51], a[216:219]
    v_mfma_f32_16x16x32_bf16 a[220:223], v[140:143], v[52:55], a[220:223]
    ds_read_b64_tr_b16 v[140:141], v11 offset:224
    ds_read_b64_tr_b16 v[142:143], v11 offset:480
    s_add_u32 s22, s22, 1
    s_cmp_lt_u32 s22, 3
    s_cbranch_scc1 L_at_qploop
    s_cmp_lg_u32 s70, 0
    s_cbranch_scc1 L_at_qptailB
    s_waitcnt lgkmcnt(14)
    v_mfma_f32_16x16x32_bf16 v[144:147], v[112:115], v[56:59], v[144:147]
    s_add_u32 s29, s34, s100
    v_mfma_f32_16x16x32_bf16 v[148:151], v[112:115], v[60:63], v[148:151]
    s_bfe_u32 s28, s29, 0x20003
    v_mfma_f32_16x16x32_bf16 v[152:155], v[112:115], v[64:67], v[152:155]
    s_lshl_b32 s28, s28, 16
    v_mfma_f32_16x16x32_bf16 v[156:159], v[112:115], v[68:71], v[156:159]
    s_and_b32 s29, s29, 7
    v_mfma_f32_16x16x32_bf16 v[160:163], v[112:115], v[72:75], v[160:163]
    s_lshl_b32 s29, s29, 11
    v_mfma_f32_16x16x32_bf16 v[164:167], v[112:115], v[76:79], v[164:167]
    s_add_u32 s29, s28, s29
    v_mfma_f32_16x16x32_bf16 v[168:171], v[112:115], v[80:83], v[168:171]
    s_lshr_b32 s28, s34, 5
    s_waitcnt vmcnt(16) lgkmcnt(0)
    s_barrier
    ds_read_b64_tr_b16 v[112:113], v11 offset:8448
    v_mfma_f32_16x16x32_bf16 v[172:175], v[116:119], v[56:59], v[172:175]
    s_lshl_b32 s28, s28, 19
    ds_read_b64_tr_b16 v[114:115], v11 offset:8704
    v_mfma_f32_16x16x32_bf16 v[176:179], v[116:119], v[60:63], v[176:179]
    s_add_u32 s49, s28, s29
    ds_read_b128 v[28:31], v27 offset:8448
    v_mfma_f32_16x16x32_bf16 v[180:183], v[116:119], v[64:67], v[180:183]
    s_add_u32 m0, s33, 0
    ds_read_b128 v[32:35], v27 offset:9472
    v_mfma_f32_16x16x32_bf16 v[184:187], v[116:119], v[68:71], v[184:187]
    s_add_u32 s34, s34, 1
    ds_read_b128 v[36:39], v27 offset:10496
    v_mfma_f32_16x16x32_bf16 v[188:191], v[116:119], v[72:75], v[188:191]
    buffer_load_dwordx4 v7, s[4:7], s49 offen offset:0 nt lds
    v_mfma_f32_16x16x32_bf16 v[192:195], v[116:119], v[76:79], v[192:195]
    s_add_u32 m0, m0, s96
    ds_read_b128 v[40:43], v27 offset:11520
    v_mfma_f32_16x16x32_bf16 v[196:199], v[116:119], v[80:83], v[196:199]
    ds_read_b128 v[44:47], v27 offset:12544
    v_mfma_f32_16x16x32_bf16 v[200:203], v[120:123], v[56:59], v[200:203]
    ds_read_b128 v[48:51], v27 offset:13568
    v_mfma_f32_16x16x32_bf16 v[204:207], v[120:123], v[60:63], v[204:207]
    buffer_load_dwordx4 v7, s[4:7], s49 offen offset:256 nt lds
    v_mfma_f32_16x16x32_bf16 v[208:211], v[120:123], v[64:67], v[208:211]
    s_add_u32 m0, m0, s97
    ds_read_b128 v[52:55], v27 offset:14592
    v_mfma_f32_16x16x32_bf16 v[212:215], v[120:123], v[68:71], v[212:215]
    ds_read_b64_tr_b16 v[116:117], v11 offset:8480
    v_mfma_f32_16x16x32_bf16 v[216:219], v[120:123], v[72:75], v[216:219]
    ds_read_b64_tr_b16 v[118:119], v11 offset:8736
    v_mfma_f32_16x16x32_bf16 v[220:223], v[120:123], v[76:79], v[220:223]
    v_mfma_f32_16x16x32_bf16 v[224:227], v[120:123], v[80:83], v[224:227]
    ds_read_b64_tr_b16 v[120:121], v11 offset:8512
    v_mfma_f32_16x16x32_bf16 v[228:231], v[124:127], v[56:59], v[228:231]
    buffer_load_dwordx4 v7, s[4:7], s49 offen offset:512 nt lds
    v_mfma_f32_16x16x32_bf16 v[232:235], v[124:127], v[60:63], v[232:235]
    s_add_u32 m0, m0, s96
    ds_read_b64_tr_b16 v[122:123], v11 offset:8768
    v_mfma_f32_16x16x32_bf16 v[236:239], v[124:127], v[64:67], v[236:239]
    v_mfma_f32_16x16x32_bf16 v[240:243], v[124:127], v[68:71], v[240:243]
    v_mfma_f32_16x16x32_bf16 v[244:247], v[124:127], v[72:75], v[244:247]
    v_mfma_f32_16x16x32_bf16 v[248:251], v[124:127], v[76:79], v[248:251]
    v_mfma_f32_16x16x32_bf16 v[252:255], v[124:127], v[80:83], v[252:255]
    buffer_load_dwordx4 v7, s[4:7], s49 offen offset:768 nt lds
    v_mfma_f32_16x16x32_bf16 a[112:115], v[128:131], v[56:59], a[112:115]
    s_add_u32 m0, m0, s97
    ds_read_b64_tr_b16 v[124:125], v11 offset:8544
    v_mfma_f32_16x16x32_bf16 a[116:119], v[128:131], v[60:63], a[116:119]
    ds_read_b64_tr_b16 v[126:127], v11 offset:8800
    v_mfma_f32_16x16x32_bf16 a[120:123], v[128:131], v[64:67], a[120:123]
    v_mfma_f32_16x16x32_bf16 a[124:127], v[128:131], v[68:71], a[124:127]
    v_mfma_f32_16x16x32_bf16 a[128:131], v[128:131], v[72:75], a[128:131]
    v_mfma_f32_16x16x32_bf16 a[132:135], v[128:131], v[76:79], a[132:135]
    buffer_load_dwordx4 v7, s[4:7], s49 offen offset:1024 nt lds
    v_mfma_f32_16x16x32_bf16 a[136:139], v[128:131], v[80:83], a[136:139]
    s_add_u32 m0, m0, s96
    ds_read_b64_tr_b16 v[128:129], v11 offset:8576
    v_mfma_f32_16x16x32_bf16 a[140:143], v[132:135], v[56:59], a[140:143]
    ds_read_b64_tr_b16 v[130:131], v11 offset:8832
    v_mfma_f32_16x16x32_bf16 a[144:147], v[132:135], v[60:63], a[144:147]
    v_mfma_f32_16x16x32_bf16 a[148:151], v[132:135], v[64:67], a[148:151]
    v_mfma_f32_16x16x32_bf16 a[152:155], v[132:135], v[68:71], a[152:155]
    v_mfma_f32_16x16x32_bf16 a[156:159], v[132:135], v[72:75], a[156:159]
    buffer_load_dwordx4 v7, s[4:7], s49 offen offset:1280 nt lds
    v_mfma_f32_16x16x32_bf16 a[160:163], v[132:135], v[76:79], a[160:163]
    s_add_u32 m0, m0, s97
    v_mfma_f32_16x16x32_bf16 a[164:167], v[132:135], v[80:83], a[164:167]
    ds_read_b64_tr_b16 v[132:133], v11 offset:8608
    v_mfma_f32_16x16x32_bf16 a[168:171], v[136:139], v[56:59], a[168:171]
    ds_read_b64_tr_b16 v[134:135], v11 offset:8864
    v_mfma_f32_16x16x32_bf16 a[172:175], v[136:139], v[60:63], a[172:175]
    v_mfma_f32_16x16x32_bf16 a[176:179], v[136:139], v[64:67], a[176:179]
    v_mfma_f32_16x16x32_bf16 a[180:183], v[136:139], v[68:71], a[180:183]
    buffer_load_dwordx4 v7, s[4:7], s49 offen offset:1536 nt lds
    v_mfma_f32_16x16x32_bf16 a[184:187], v[136:139], v[72:75], a[184:187]
    s_add_u32 m0, m0, s96
    v_mfma_f32_16x16x32_bf16 a[188:191], v[136:139], v[76:79], a[188:191]
    v_mfma_f32_16x16x32_bf16 a[192:195], v[136:139], v[80:83], a[192:195]
    ds_read_b64_tr_b16 v[136:137], v11 offset:8640
    v_mfma_f32_16x16x32_bf16 a[196:199], v[140:143], v[56:59], a[196:199]
    ds_read_b64_tr_b16 v[138:139], v11 offset:8896
    v_mfma_f32_16x16x32_bf16 a[200:203], v[140:143], v[60:63], a[200:203]
    v_mfma_f32_16x16x32_bf16 a[204:207], v[140:143], v[64:67], a[204:207]
    buffer_load_dwordx4 v7, s[4:7], s49 offen offset:1792 nt lds
    v_mfma_f32_16x16x32_bf16 a[208:211], v[140:143], v[68:71], a[208:211]
    v_mfma_f32_16x16x32_bf16 a[212:215], v[140:143], v[72:75], a[212:215]
    v_mfma_f32_16x16x32_bf16 a[216:219], v[140:143], v[76:79], a[216:219]
    v_mfma_f32_16x16x32_bf16 a[220:223], v[140:143], v[80:83], a[220:223]
    ds_read_b64_tr_b16 v[140:141], v11 offset:8672
    ds_read_b64_tr_b16 v[142:143], v11 offset:8928
    s_waitcnt lgkmcnt(14)
    v_mfma_f32_16x16x32_bf16 v[144:147], v[112:115], v[28:31], v[144:147]
    s_add_u32 s29, s34, s100
    v_mfma_f32_16x16x32_bf16 v[148:151], v[112:115], v[32:35], v[148:151]
    s_bfe_u32 s28, s29, 0x20003
    v_mfma_f32_16x16x32_bf16 v[152:155], v[112:115], v[36:39], v[152:155]
    s_lshl_b32 s28, s28, 16
    v_mfma_f32_16x16x32_bf16 v[156:159], v[112:115], v[40:43], v[156:159]
    s_and_b32 s29, s29, 7
    v_mfma_f32_16x16x32_bf16 v[160:163], v[112:115], v[44:47], v[160:163]
    s_lshl_b32 s29, s29, 11
    v_mfma_f32_16x16x32_bf16 v[164:167], v[112:115], v[48:51], v[164:167]
    s_add_u32 s29, s28, s29
    v_mfma_f32_16x16x32_bf16 v[168:171], v[112:115], v[52:55], v[168:171]
    s_lshr_b32 s28, s34, 5
    s_waitcnt vmcnt(16) lgkmcnt(0)
    s_barrier
    ds_read_b64_tr_b16 v[112:113], v11 offset:16896
    v_mfma_f32_16x16x32_bf16 v[172:175], v[116:119], v[28:31], v[172:175]
    s_lshl_b32 s28, s28, 19
    ds_read_b64_tr_b16 v[114:115], v11 offset:17152
    v_mfma_f32_16x16x32_bf16 v[176:179], v[116:119], v[32:35], v[176:179]
    s_add_u32 s49, s28, s29
    ds_read_b128 v[56:59], v27 offset:16896
    v_mfma_f32_16x16x32_bf16 v[180:183], v[116:119], v[36:39], v[180:183]
    s_add_u32 m0, s33, 8448
    ds_read_b128 v[60:63], v27 offset:17920
    v_mfma_f32_16x16x32_bf16 v[184:187], v[116:119], v[40:43], v[184:187]
    s_add_u32 s34, s34, 1
    ds_read_b128 v[64:67], v27 offset:18944
    v_mfma_f32_16x16x32_bf16 v[188:191], v[116:119], v[44:47], v[188:191]
    buffer_load_dwordx4 v7, s[4:7], s49 offen offset:0 nt lds
    v_mfma_f32_16x16x32_bf16 v[192:195], v[116:119], v[48:51], v[192:195]
    s_add_u32 m0, m0, s96
    ds_read_b128 v[68:71], v27 offset:19968
    v_mfma_f32_16x16x32_bf16 v[196:199], v[116:119], v[52:55], v[196:199]
    ds_read_b128 v[72:75], v27 offset:20992
    v_mfma_f32_16x16x32_bf16 v[200:203], v[120:123], v[28:31], v[200:203]
    ds_read_b128 v[76:79], v27 offset:22016
    v_mfma_f32_16x16x32_bf16 v[204:207], v[120:123], v[32:35], v[204:207]
    buffer_load_dwordx4 v7, s[4:7], s49 offen offset:256 nt lds
    v_mfma_f32_16x16x32_bf16 v[208:211], v[120:123], v[36:39], v[208:211]
    s_add_u32 m0, m0, s97
    ds_read_b128 v[80:83], v27 offset:23040
    v_mfma_f32_16x16x32_bf16 v[212:215], v[120:123], v[40:43], v[212:215]
    ds_read_b64_tr_b16 v[116:117], v11 offset:16928
    v_mfma_f32_16x16x32_bf16 v[216:219], v[120:123], v[44:47], v[216:219]
    ds_read_b64_tr_b16 v[118:119], v11 offset:17184
    v_mfma_f32_16x16x32_bf16 v[220:223], v[120:123], v[48:51], v[220:223]
    v_mfma_f32_16x16x32_bf16 v[224:227], v[120:123], v[52:55], v[224:227]
    ds_read_b64_tr_b16 v[120:121], v11 offset:16960
    v_mfma_f32_16x16x32_bf16 v[228:231], v[124:127], v[28:31], v[228:231]
    buffer_load_dwordx4 v7, s[4:7], s49 offen offset:512 nt lds
    v_mfma_f32_16x16x32_bf16 v[232:235], v[124:127], v[32:35], v[232:235]
    s_add_u32 m0, m0, s96
    ds_read_b64_tr_b16 v[122:123], v11 offset:17216
    v_mfma_f32_16x16x32_bf16 v[236:239], v[124:127], v[36:39], v[236:239]
    v_mfma_f32_16x16x32_bf16 v[240:243], v[124:127], v[40:43], v[240:243]
    v_mfma_f32_16x16x32_bf16 v[244:247], v[124:127], v[44:47], v[244:247]
    v_mfma_f32_16x16x32_bf16 v[248:251], v[124:127], v[48:51], v[248:251]
    v_mfma_f32_16x16x32_bf16 v[252:255], v[124:127], v[52:55], v[252:255]
    buffer_load_dwordx4 v7, s[4:7], s49 offen offset:768 nt lds
    v_mfma_f32_16x16x32_bf16 a[112:115], v[128:131], v[28:31], a[112:115]
    s_add_u32 m0, m0, s97
    ds_read_b64_tr_b16 v[124:125], v11 offset:16992
    v_mfma_f32_16x16x32_bf16 a[116:119], v[128:131], v[32:35], a[116:119]
    ds_read_b64_tr_b16 v[126:127], v11 offset:17248
    v_mfma_f32_16x16x32_bf16 a[120:123], v[128:131], v[36:39], a[120:123]
    v_mfma_f32_16x16x32_bf16 a[124:127], v[128:131], v[40:43], a[124:127]
    v_mfma_f32_16x16x32_bf16 a[128:131], v[128:131], v[44:47], a[128:131]
    v_mfma_f32_16x16x32_bf16 a[132:135], v[128:131], v[48:51], a[132:135]
    buffer_load_dwordx4 v7, s[4:7], s49 offen offset:1024 nt lds
    v_mfma_f32_16x16x32_bf16 a[136:139], v[128:131], v[52:55], a[136:139]
    s_add_u32 m0, m0, s96
    ds_read_b64_tr_b16 v[128:129], v11 offset:17024
    v_mfma_f32_16x16x32_bf16 a[140:143], v[132:135], v[28:31], a[140:143]
    ds_read_b64_tr_b16 v[130:131], v11 offset:17280
    v_mfma_f32_16x16x32_bf16 a[144:147], v[132:135], v[32:35], a[144:147]
    v_mfma_f32_16x16x32_bf16 a[148:151], v[132:135], v[36:39], a[148:151]
    v_mfma_f32_16x16x32_bf16 a[152:155], v[132:135], v[40:43], a[152:155]
    v_mfma_f32_16x16x32_bf16 a[156:159], v[132:135], v[44:47], a[156:159]
    buffer_load_dwordx4 v7, s[4:7], s49 offen offset:1280 nt lds
    v_mfma_f32_16x16x32_bf16 a[160:163], v[132:135], v[48:51], a[160:163]
    s_add_u32 m0, m0, s97
    v_mfma_f32_16x16x32_bf16 a[164:167], v[132:135], v[52:55], a[164:167]
    ds_read_b64_tr_b16 v[132:133], v11 offset:17056
    v_mfma_f32_16x16x32_bf16 a[168:171], v[136:139], v[28:31], a[168:171]
    ds_read_b64_tr_b16 v[134:135], v11 offset:17312
    v_mfma_f32_16x16x32_bf16 a[172:175], v[136:139], v[32:35], a[172:175]
    v_mfma_f32_16x16x32_bf16 a[176:179], v[136:139], v[36:39], a[176:179]
    v_mfma_f32_16x16x32_bf16 a[180:183], v[136:139], v[40:43], a[180:183]
    buffer_load_dwordx4 v7, s[4:7], s49 offen offset:1536 nt lds
    v_mfma_f32_16x16x32_bf16 a[184:187], v[136:139], v[44:47], a[184:187]
    s_add_u32 m0, m0, s96
    v_mfma_f32_16x16x32_bf16 a[188:191], v[136:139], v[48:51], a[188:191]
    v_mfma_f32_16x16x32_bf16 a[192:195], v[136:139], v[52:55], a[192:195]
    ds_read_b64_tr_b16 v[136:137], v11 offset:17088
    v_mfma_f32_16x16x32_bf16 a[196:199], v[140:143], v[28:31], a[196:199]
    ds_read_b64_tr_b16 v[138:139], v11 offset:17344
    v_mfma_f32_16x16x32_bf16 a[200:203], v[140:143], v[32:35], a[200:203]
    v_mfma_f32_16x16x32_bf16 a[204:207], v[140:143], v[36:39], a[204:207]
    buffer_load_dwordx4 v7, s[4:7], s49 offen offset:1792 nt lds
    v_mfma_f32_16x16x32_bf16 a[208:211], v[140:143], v[40:43], a[208:211]
    v_mfma_f32_16x16x32_bf16 a[212:215], v[140:143], v[44:47], a[212:215]
    v_mfma_f32_16x16x32_bf16 a[216:219], v[140:143], v[48:51], a[216:219]
    v_mfma_f32_16x16x32_bf16 a[220:223], v[140:143], v[52:55], a[220:223]
    ds_read_b64_tr_b16 v[140:141], v11 offset:17120
    ds_read_b64_tr_b16 v[142:143], v11 offset:17376
    s_waitcnt lgkmcnt(14)
    v_mfma_f32_16x16x32_bf16 v[144:147], v[112:115], v[56:59], v[144:147]
    s_add_u32 s29, s34, s100
    v_mfma_f32_16x16x32_bf16 v[148:151], v[112:115], v[60:63], v[148:151]
    s_bfe_u32 s28, s29, 0x20003
    v_mfma_f32_16x16x32_bf16 v[152:155], v[112:115], v[64:67], v[152:155]
    s_lshl_b32 s28, s28, 16
    v_mfma_f32_16x16x32_bf16 v[156:159], v[112:115], v[68:71], v[156:159]
    s_and_b32 s29, s29, 7
    v_mfma_f32_16x16x32_bf16 v[160:163], v[112:115], v[72:75], v[160:163]
    s_lshl_b32 s29, s29, 11
    v_mfma_f32_16x16x32_bf16 v[164:167], v[112:115], v[76:79], v[164:167]
    s_add_u32 s29, s28, s29
    v_mfma_f32_16x16x32_bf16 v[168:171], v[112:115], v[80:83], v[168:171]
    s_lshr_b32 s28, s34, 5
    s_waitcnt vmcnt(16) lgkmcnt(0)
    s_barrier
    ds_read_b64_tr_b16 v[112:113], v11 offset:25344
    v_mfma_f32_16x16x32_bf16 v[172:175], v[116:119], v[56:59], v[172:175]
    s_lshl_b32 s28, s28, 19
    ds_read_b64_tr_b16 v[114:115], v11 offset:25600
    v_mfma_f32_16x16x32_bf16 v[176:179], v[116:119], v[60:63], v[176:179]
    s_add_u32 s49, s28, s29
    ds_read_b128 v[28:31], v27 offset:25344
    v_mfma_f32_16x16x32_bf16 v[180:183], v[116:119], v[64:67], v[180:183]
    s_add_u32 m0, s33, 16896
    ds_read_b128 v[32:35], v27 offset:26368
    v_mfma_f32_16x16x32_bf16 v[184:187], v[116:119], v[68:71], v[184:187]
    s_add_u32 s34, s34, 1
    ds_read_b128 v[36:39], v27 offset:27392
    v_mfma_f32_16x16x32_bf16 v[188:191], v[116:119], v[72:75], v[188:191]
    buffer_load_dwordx4 v7, s[4:7], s49 offen offset:0 nt lds
    v_mfma_f32_16x16x32_bf16 v[192:195], v[116:119], v[76:79], v[192:195]
    s_add_u32 m0, m0, s96
    ds_read_b128 v[40:43], v27 offset:28416
    v_mfma_f32_16x16x32_bf16 v[196:199], v[116:119], v[80:83], v[196:199]
    ds_read_b128 v[44:47], v27 offset:29440
    v_mfma_f32_16x16x32_bf16 v[200:203], v[120:123], v[56:59], v[200:203]
    ds_read_b128 v[48:51], v27 offset:30464
    v_mfma_f32_16x16x32_bf16 v[204:207], v[120:123], v[60:63], v[204:207]
    buffer_load_dwordx4 v7, s[4:7], s49 offen offset:256 nt lds
    v_mfma_f32_16x16x32_bf16 v[208:211], v[120:123], v[64:67], v[208:211]
    s_add_u32 m0, m0, s97
    ds_read_b128 v[52:55], v27 offset:31488
    v_mfma_f32_16x16x32_bf16 v[212:215], v[120:123], v[68:71], v[212:215]
    ds_read_b64_tr_b16 v[116:117], v11 offset:25376
    v_mfma_f32_16x16x32_bf16 v[216:219], v[120:123], v[72:75], v[216:219]
    ds_read_b64_tr_b16 v[118:119], v11 offset:25632
    v_mfma_f32_16x16x32_bf16 v[220:223], v[120:123], v[76:79], v[220:223]
    v_mfma_f32_16x16x32_bf16 v[224:227], v[120:123], v[80:83], v[224:227]
    ds_read_b64_tr_b16 v[120:121], v11 offset:25408
    v_mfma_f32_16x16x32_bf16 v[228:231], v[124:127], v[56:59], v[228:231]
    buffer_load_dwordx4 v7, s[4:7], s49 offen offset:512 nt lds
    v_mfma_f32_16x16x32_bf16 v[232:235], v[124:127], v[60:63], v[232:235]
    s_add_u32 m0, m0, s96
    ds_read_b64_tr_b16 v[122:123], v11 offset:25664
    v_mfma_f32_16x16x32_bf16 v[236:239], v[124:127], v[64:67], v[236:239]
    v_mfma_f32_16x16x32_bf16 v[240:243], v[124:127], v[68:71], v[240:243]
    v_mfma_f32_16x16x32_bf16 v[244:247], v[124:127], v[72:75], v[244:247]
    v_mfma_f32_16x16x32_bf16 v[248:251], v[124:127], v[76:79], v[248:251]
    v_mfma_f32_16x16x32_bf16 v[252:255], v[124:127], v[80:83], v[252:255]
    buffer_load_dwordx4 v7, s[4:7], s49 offen offset:768 nt lds
    v_mfma_f32_16x16x32_bf16 a[112:115], v[128:131], v[56:59], a[112:115]
    s_add_u32 m0, m0, s97
    ds_read_b64_tr_b16 v[124:125], v11 offset:25440
    v_mfma_f32_16x16x32_bf16 a[116:119], v[128:131], v[60:63], a[116:119]
    ds_read_b64_tr_b16 v[126:127], v11 offset:25696
    v_mfma_f32_16x16x32_bf16 a[120:123], v[128:131], v[64:67], a[120:123]
    v_mfma_f32_16x16x32_bf16 a[124:127], v[128:131], v[68:71], a[124:127]
    v_mfma_f32_16x16x32_bf16 a[128:131], v[128:131], v[72:75], a[128:131]
    v_mfma_f32_16x16x32_bf16 a[132:135], v[128:131], v[76:79], a[132:135]
    buffer_load_dwordx4 v7, s[4:7], s49 offen offset:1024 nt lds
    v_mfma_f32_16x16x32_bf16 a[136:139], v[128:131], v[80:83], a[136:139]
    s_add_u32 m0, m0, s96
    ds_read_b64_tr_b16 v[128:129], v11 offset:25472
    v_mfma_f32_16x16x32_bf16 a[140:143], v[132:135], v[56:59], a[140:143]
    ds_read_b64_tr_b16 v[130:131], v11 offset:25728
    v_mfma_f32_16x16x32_bf16 a[144:147], v[132:135], v[60:63], a[144:147]
    v_mfma_f32_16x16x32_bf16 a[148:151], v[132:135], v[64:67], a[148:151]
    v_mfma_f32_16x16x32_bf16 a[152:155], v[132:135], v[68:71], a[152:155]
    v_mfma_f32_16x16x32_bf16 a[156:159], v[132:135], v[72:75], a[156:159]
    buffer_load_dwordx4 v7, s[4:7], s49 offen offset:1280 nt lds
    v_mfma_f32_16x16x32_bf16 a[160:163], v[132:135], v[76:79], a[160:163]
    s_add_u32 m0, m0, s97
    v_mfma_f32_16x16x32_bf16 a[164:167], v[132:135], v[80:83], a[164:167]
    ds_read_b64_tr_b16 v[132:133], v11 offset:25504
    v_mfma_f32_16x16x32_bf16 a[168:171], v[136:139], v[56:59], a[168:171]
    ds_read_b64_tr_b16 v[134:135], v11 offset:25760
    v_mfma_f32_16x16x32_bf16 a[172:175], v[136:139], v[60:63], a[172:175]
    v_mfma_f32_16x16x32_bf16 a[176:179], v[136:139], v[64:67], a[176:179]
    v_mfma_f32_16x16x32_bf16 a[180:183], v[136:139], v[68:71], a[180:183]
    buffer_load_dwordx4 v7, s[4:7], s49 offen offset:1536 nt lds
    v_mfma_f32_16x16x32_bf16 a[184:187], v[136:139], v[72:75], a[184:187]
    s_add_u32 m0, m0, s96
    v_mfma_f32_16x16x32_bf16 a[188:191], v[136:139], v[76:79], a[188:191]
    v_mfma_f32_16x16x32_bf16 a[192:195], v[136:139], v[80:83], a[192:195]
    ds_read_b64_tr_b16 v[136:137], v11 offset:25536
    v_mfma_f32_16x16x32_bf16 a[196:199], v[140:143], v[56:59], a[196:199]
    ds_read_b64_tr_b16 v[138:139], v11 offset:25792
    v_mfma_f32_16x16x32_bf16 a[200:203], v[140:143], v[60:63], a[200:203]
    v_mfma_f32_16x16x32_bf16 a[204:207], v[140:143], v[64:67], a[204:207]
    buffer_load_dwordx4 v7, s[4:7], s49 offen offset:1792 nt lds
    v_mfma_f32_16x16x32_bf16 a[208:211], v[140:143], v[68:71], a[208:211]
    v_mfma_f32_16x16x32_bf16 a[212:215], v[140:143], v[72:75], a[212:215]
    v_mfma_f32_16x16x32_bf16 a[216:219], v[140:143], v[76:79], a[216:219]
    v_mfma_f32_16x16x32_bf16 a[220:223], v[140:143], v[80:83], a[220:223]
    ds_read_b64_tr_b16 v[140:141], v11 offset:25568
    ds_read_b64_tr_b16 v[142:143], v11 offset:25824
    s_waitcnt lgkmcnt(14)
    v_mfma_f32_16x16x32_bf16 v[144:147], v[112:115], v[28:31], v[144:147]
    s_add_u32 s29, s34, s100
    v_mfma_f32_16x16x32_bf16 v[148:151], v[112:115], v[32:35], v[148:151]
    s_bfe_u32 s28, s29, 0x20003
    v_mfma_f32_16x16x32_bf16 v[152:155], v[112:115], v[36:39], v[152:155]
    s_lshl_b32 s28, s28, 16
    v_mfma_f32_16x16x32_bf16 v[156:159], v[112:115], v[40:43], v[156:159]
    s_and_b32 s29, s29, 7
    v_mfma_f32_16x16x32_bf16 v[160:163], v[112:115], v[44:47], v[160:163]
    s_lshl_b32 s29, s29, 11
    v_mfma_f32_16x16x32_bf16 v[164:167], v[112:115], v[48:51], v[164:167]
    s_add_u32 s29, s28, s29
    v_mfma_f32_16x16x32_bf16 v[168:171], v[112:115], v[52:55], v[168:171]
    s_lshr_b32 s28, s34, 5
    s_waitcnt vmcnt(16) lgkmcnt(0)
    s_barrier
    ds_read_b128 v[56:59], v8 offset:0
    v_mfma_f32_16x16x32_bf16 v[172:175], v[116:119], v[28:31], v[172:175]
    s_lshl_b32 s28, s28, 19
    ds_read_b128 v[60:63], v8 offset:64
    v_mfma_f32_16x16x32_bf16 v[176:179], v[116:119], v[32:35], v[176:179]
    s_add_u32 s49, s28, s29
    ds_read_b128 v[64:67], v8 offset:128
    v_mfma_f32_16x16x32_bf16 v[180:183], v[116:119], v[36:39], v[180:183]
    s_add_u32 m0, s33, 25344
    ds_read_b128 v[68:71], v8 offset:192
    v_mfma_f32_16x16x32_bf16 v[184:187], v[116:119], v[40:43], v[184:187]
    s_add_u32 s34, s34, 1
    ds_read_b128 v[72:75], v8 offset:512
    v_mfma_f32_16x16x32_bf16 v[188:191], v[116:119], v[44:47], v[188:191]
    buffer_load_dwordx4 v7, s[4:7], s49 offen offset:0 nt lds
    v_mfma_f32_16x16x32_bf16 v[192:195], v[116:119], v[48:51], v[192:195]
    s_add_u32 m0, m0, s96
    ds_read_b128 v[76:79], v8 offset:576
    v_mfma_f32_16x16x32_bf16 v[196:199], v[116:119], v[52:55], v[196:199]
    ds_read_b128 v[80:83], v8 offset:640
    v_mfma_f32_16x16x32_bf16 v[200:203], v[120:123], v[28:31], v[200:203]
    ds_read_b128 v[84:87], v8 offset:704
    v_mfma_f32_16x16x32_bf16 v[204:207], v[120:123], v[32:35], v[204:207]
    buffer_load_dwordx4 v7, s[4:7], s49 offen offset:256 nt lds
    v_mfma_f32_16x16x32_bf16 v[208:211], v[120:123], v[36:39], v[208:211]
    s_add_u32 m0, m0, s97
    v_mfma_f32_16x16x32_bf16 v[212:215], v[120:123], v[40:43], v[212:215]
    v_mfma_f32_16x16x32_bf16 v[216:219], v[120:123], v[44:47], v[216:219]
    v_mfma_f32_16x16x32_bf16 v[220:223], v[120:123], v[48:51], v[220:223]
    v_mfma_f32_16x16x32_bf16 v[224:227], v[120:123], v[52:55], v[224:227]
    v_mfma_f32_16x16x32_bf16 v[228:231], v[124:127], v[28:31], v[228:231]
    buffer_load_dwordx4 v7, s[4:7], s49 offen offset:512 nt lds
    v_mfma_f32_16x16x32_bf16 v[232:235], v[124:127], v[32:35], v[232:235]
    s_add_u32 m0, m0, s96
    v_mfma_f32_16x16x32_bf16 v[236:239], v[124:127], v[36:39], v[236:239]
    v_mfma_f32_16x16x32_bf16 v[240:243], v[124:127], v[40:43], v[240:243]
    v_mfma_f32_16x16x32_bf16 v[244:247], v[124:127], v[44:47], v[244:247]
    v_mfma_f32_16x16x32_bf16 v[248:251], v[124:127], v[48:51], v[248:251]
    v_mfma_f32_16x16x32_bf16 v[252:255], v[124:127], v[52:55], v[252:255]
    buffer_load_dwordx4 v7, s[4:7], s49 offen offset:768 nt lds
    v_mfma_f32_16x16x32_bf16 a[112:115], v[128:131], v[28:31], a[112:115]
    s_add_u32 m0, m0, s97
    v_mfma_f32_16x16x32_bf16 a[116:119], v[128:131], v[32:35], a[116:119]
    v_mfma_f32_16x16x32_bf16 a[120:123], v[128:131], v[36:39], a[120:123]
    v_mfma_f32_16x16x32_bf16 a[124:127], v[128:131], v[40:43], a[124:127]
    v_mfma_f32_16x16x32_bf16 a[128:131], v[128:131], v[44:47], a[128:131]
    v_mfma_f32_16x16x32_bf16 a[132:135], v[128:131], v[48:51], a[132:135]
    buffer_load_dwordx4 v7, s[4:7], s49 offen offset:1024 nt lds
    v_mfma_f32_16x16x32_bf16 a[136:139], v[128:131], v[52:55], a[136:139]
    s_add_u32 m0, m0, s96
    v_mfma_f32_16x16x32_bf16 a[140:143], v[132:135], v[28:31], a[140:143]
    v_mfma_f32_16x16x32_bf16 a[144:147], v[132:135], v[32:35], a[144:147]
    v_mfma_f32_16x16x32_bf16 a[148:151], v[132:135], v[36:39], a[148:151]
    v_mfma_f32_16x16x32_bf16 a[152:155], v[132:135], v[40:43], a[152:155]
    v_mfma_f32_16x16x32_bf16 a[156:159], v[132:135], v[44:47], a[156:159]
    buffer_load_dwordx4 v7, s[4:7], s49 offen offset:1280 nt lds
    v_mfma_f32_16x16x32_bf16 a[160:163], v[132:135], v[48:51], a[160:163]
    s_add_u32 m0, m0, s97
    v_mfma_f32_16x16x32_bf16 a[164:167], v[132:135], v[52:55], a[164:167]
    v_mfma_f32_16x16x32_bf16 a[168:171], v[136:139], v[28:31], a[168:171]
    v_mfma_f32_16x16x32_bf16 a[172:175], v[136:139], v[32:35], a[172:175]
    v_mfma_f32_16x16x32_bf16 a[176:179], v[136:139], v[36:39], a[176:179]
    v_mfma_f32_16x16x32_bf16 a[180:183], v[136:139], v[40:43], a[180:183]
    buffer_load_dwordx4 v7, s[4:7], s49 offen offset:1536 nt lds
    v_mfma_f32_16x16x32_bf16 a[184:187], v[136:139], v[44:47], a[184:187]
    s_add_u32 m0, m0, s96
    v_mfma_f32_16x16x32_bf16 a[188:191], v[136:139], v[48:51], a[188:191]
    v_mfma_f32_16x16x32_bf16 a[192:195], v[136:139], v[52:55], a[192:195]
    v_mfma_f32_16x16x32_bf16 a[196:199], v[140:143], v[28:31], a[196:199]
    v_mfma_f32_16x16x32_bf16 a[200:203], v[140:143], v[32:35], a[200:203]
    v_mfma_f32_16x16x32_bf16 a[204:207], v[140:143], v[36:39], a[204:207]
    buffer_load_dwordx4 v7, s[4:7], s49 offen offset:1792 nt lds
    v_mfma_f32_16x16x32_bf16 a[208:211], v[140:143], v[40:43], a[208:211]
    v_mfma_f32_16x16x32_bf16 a[212:215], v[140:143], v[44:47], a[212:215]
    v_mfma_f32_16x16x32_bf16 a[216:219], v[140:143], v[48:51], a[216:219]
    v_mfma_f32_16x16x32_bf16 a[220:223], v[140:143], v[52:55], a[220:223]
    s_branch L_at_qpepi
L_at_qptailB:
    s_mul_i32 s50, s21, s52
    s_mov_b32 s101, s21
    s_add_u32 s50, s50, s55
    s_cmp_ge_u32 s21, 2
    s_cselect_b32 s28, 0x40000000, 0
    s_add_u32 s50, s50, s28
    s_mov_b32 s82, s26
    s_mul_i32 s28, s26, s51
    s_add_u32 s50, s50, s28
    s_waitcnt lgkmcnt(14)
    v_mfma_f32_16x16x32_bf16 v[144:147], v[112:115], v[56:59], v[144:147]
    s_add_u32 m0, s33, 0
    v_mfma_f32_16x16x32_bf16 v[148:151], v[112:115], v[60:63], v[148:151]
    s_mov_b32 s49, s50
    v_mfma_f32_16x16x32_bf16 v[152:155], v[112:115], v[64:67], v[152:155]
    s_add_u32 s50, s50, s51
    v_mfma_f32_16x16x32_bf16 v[156:159], v[112:115], v[68:71], v[156:159]
    s_add_u32 s82, s82, 1
    v_mfma_f32_16x16x32_bf16 v[160:163], v[112:115], v[72:75], v[160:163]
    s_cmp_eq_u32 s82, 20
    v_mfma_f32_16x16x32_bf16 v[164:167], v[112:115], v[76:79], v[164:167]
    s_cselect_b32 s29, s83, 0
    v_mfma_f32_16x16x32_bf16 v[168:171], v[112:115], v[80:83], v[168:171]
    s_sub_u32 s50, s50, s29
    s_waitcnt vmcnt(16) lgkmcnt(0)
    s_barrier
    ds_read_b64_tr_b16 v[112:113], v11 offset:8448
    v_mfma_f32_16x16x32_bf16 v[172:175], v[116:119], v[56:59], v[172:175]
    ds_read_b64_tr_b16 v[114:115], v11 offset:8704
    v_mfma_f32_16x16x32_bf16 v[176:179], v[116:119], v[60:63], v[176:179]
    ds_read_b128 v[28:31], v27 offset:8448
    v_mfma_f32_16x16x32_bf16 v[180:183], v[116:119], v[64:67], v[180:183]
    s_add_u32 s28, s49, s88
    buffer_load_dwordx4 v26, s[16:19], s28 offen lds
    v_mfma_f32_16x16x32_bf16 v[184:187], v[116:119], v[68:71], v[184:187]
    s_add_u32 m0, m0, s53
    ds_read_b128 v[32:35], v27 offset:9472
    v_mfma_f32_16x16x32_bf16 v[188:191], v[116:119], v[72:75], v[188:191]
    ds_read_b128 v[36:39], v27 offset:10496
    v_mfma_f32_16x16x32_bf16 v[192:195], v[116:119], v[76:79], v[192:195]
    ds_read_b128 v[40:43], v27 offset:11520
    v_mfma_f32_16x16x32_bf16 v[196:199], v[116:119], v[80:83], v[196:199]
    ds_read_b128 v[44:47], v27 offset:12544
    v_mfma_f32_16x16x32_bf16 v[200:203], v[120:123], v[56:59], v[200:203]
    ds_read_b128 v[48:51], v27 offset:13568
    v_mfma_f32_16x16x32_bf16 v[204:207], v[120:123], v[60:63], v[204:207]
    s_add_u32 s28, s49, s89
    buffer_load_dwordx4 v26, s[16:19], s28 offen lds
    v_mfma_f32_16x16x32_bf16 v[208:211], v[120:123], v[64:67], v[208:211]
    s_add_u32 m0, m0, s53
    ds_read_b128 v[52:55], v27 offset:14592
    v_mfma_f32_16x16x32_bf16 v[212:215], v[120:123], v[68:71], v[212:215]
    ds_read_b64_tr_b16 v[116:117], v11 offset:8480
    v_mfma_f32_16x16x32_bf16 v[216:219], v[120:123], v[72:75], v[216:219]
    ds_read_b64_tr_b16 v[118:119], v11 offset:8736
    v_mfma_f32_16x16x32_bf16 v[220:223], v[120:123], v[76:79], v[220:223]
    v_mfma_f32_16x16x32_bf16 v[224:227], v[120:123], v[80:83], v[224:227]
    ds_read_b64_tr_b16 v[120:121], v11 offset:8512
    v_mfma_f32_16x16x32_bf16 v[228:231], v[124:127], v[56:59], v[228:231]
    s_add_u32 s28, s49, s90
    buffer_load_dwordx4 v26, s[16:19], s28 offen lds
    v_mfma_f32_16x16x32_bf16 v[232:235], v[124:127], v[60:63], v[232:235]
    s_add_u32 m0, m0, s53
    ds_read_b64_tr_b16 v[122:123], v11 offset:8768
    v_mfma_f32_16x16x32_bf16 v[236:239], v[124:127], v[64:67], v[236:239]
    v_mfma_f32_16x16x32_bf16 v[240:243], v[124:127], v[68:71], v[240:243]
    v_mfma_f32_16x16x32_bf16 v[244:247], v[124:127], v[72:75], v[244:247]
    v_mfma_f32_16x16x32_bf16 v[248:251], v[124:127], v[76:79], v[248:251]
    v_mfma_f32_16x16x32_bf16 v[252:255], v[124:127], v[80:83], v[252:255]
    s_add_u32 s28, s49, s91
    buffer_load_dwordx4 v26, s[16:19], s28 offen lds
    v_mfma_f32_16x16x32_bf16 a[112:115], v[128:131], v[56:59], a[112:115]
    s_add_u32 m0, m0, s53
    ds_read_b64_tr_b16 v[124:125], v11 offset:8544
    v_mfma_f32_16x16x32_bf16 a[116:119], v[128:131], v[60:63], a[116:119]
    ds_read_b64_tr_b16 v[126:127], v11 offset:8800
    v_mfma_f32_16x16x32_bf16 a[120:123], v[128:131], v[64:67], a[120:123]
    v_mfma_f32_16x16x32_bf16 a[124:127], v[128:131], v[68:71], a[124:127]
    v_mfma_f32_16x16x32_bf16 a[128:131], v[128:131], v[72:75], a[128:131]
    v_mfma_f32_16x16x32_bf16 a[132:135], v[128:131], v[76:79], a[132:135]
    s_add_u32 s28, s49, s92
    buffer_load_dwordx4 v26, s[16:19], s28 offen lds
    v_mfma_f32_16x16x32_bf16 a[136:139], v[128:131], v[80:83], a[136:139]
    s_add_u32 m0, m0, s53
    ds_read_b64_tr_b16 v[128:129], v11 offset:8576
    v_mfma_f32_16x16x32_bf16 a[140:143], v[132:135], v[56:59], a[140:143]
    ds_read_b64_tr_b16 v[130:131], v11 offset:8832
    v_mfma_f32_16x16x32_bf16 a[144:147], v[132:135], v[60:63], a[144:147]
    v_mfma_f32_16x16x32_bf16 a[148:151], v[132:135], v[64:67], a[148:151]
    v_mfma_f32_16x16x32_bf16 a[152:155], v[132:135], v[68:71], a[152:155]
    v_mfma_f32_16x16x32_bf16 a[156:159], v[132:135], v[72:75], a[156:159]
    s_add_u32 s28, s49, s93
    buffer_load_dwordx4 v26, s[16:19], s28 offen lds
    v_mfma_f32_16x16x32_bf16 a[160:163], v[132:135], v[76:79], a[160:163]
    s_add_u32 m0, m0, s53
    v_mfma_f32_16x16x32_bf16 a[164:167], v[132:135], v[80:83], a[164:167]
    ds_read_b64_tr_b16 v[132:133], v11 offset:8608
    v_mfma_f32_16x16x32_bf16 a[168:171], v[136:139], v[56:59], a[168:171]
    ds_read_b64_tr_b16 v[134:135], v11 offset:8864
    v_mfma_f32_16x16x32_bf16 a[172:175], v[136:139], v[60:63], a[172:175]
    v_mfma_f32_16x16x32_bf16 a[176:179], v[136:139], v[64:67], a[176:179]
    v_mfma_f32_16x16x32_bf16 a[180:183], v[136:139], v[68:71], a[180:183]
    s_add_u32 s28, s49, s94
    buffer_load_dwordx4 v26, s[16:19], s28 offen lds
    v_mfma_f32_16x16x32_bf16 a[184:187], v[136:139], v[72:75], a[184:187]
    s_add_u32 m0, m0, s53
    v_mfma_f32_16x16x32_bf16 a[188:191], v[136:139], v[76:79], a[188:191]
    v_mfma_f32_16x16x32_bf16 a[192:195], v[136:139], v[80:83], a[192:195]
    ds_read_b64_tr_b16 v[136:137], v11 offset:8640
    v_mfma_f32_16x16x32_bf16 a[196:199], v[140:143], v[56:59], a[196:199]
    ds_read_b64_tr_b16 v[138:139], v11 offset:8896
    v_mfma_f32_16x16x32_bf16 a[200:203], v[140:143], v[60:63], a[200:203]
    v_mfma_f32_16x16x32_bf16 a[204:207], v[140:143], v[64:67], a[204:207]
    s_add_u32 s28, s49, s95
    buffer_load_dwordx4 v26, s[16:19], s28 offen lds
    v_mfma_f32_16x16x32_bf16 a[208:211], v[140:143], v[68:71], a[208:211]
    v_mfma_f32_16x16x32_bf16 a[212:215], v[140:143], v[72:75], a[212:215]
    v_mfma_f32_16x16x32_bf16 a[216:219], v[140:143], v[76:79], a[216:219]
    v_mfma_f32_16x16x32_bf16 a[220:223], v[140:143], v[80:83], a[220:223]
    ds_read_b64_tr_b16 v[140:141], v11 offset:8672
    ds_read_b64_tr_b16 v[142:143], v11 offset:8928
    s_waitcnt lgkmcnt(14)
    v_mfma_f32_16x16x32_bf16 v[144:147], v[112:115], v[28:31], v[144:147]
    s_add_u32 m0, s33, 8448
    v_mfma_f32_16x16x32_bf16 v[148:151], v[112:115], v[32:35], v[148:151]
    s_mov_b32 s49, s50
    v_mfma_f32_16x16x32_bf16 v[152:155], v[112:115], v[36:39], v[152:155]
    s_add_u32 s50, s50, s51
    v_mfma_f32_16x16x32_bf16 v[156:159], v[112:115], v[40:43], v[156:159]
    s_add_u32 s82, s82, 1
    v_mfma_f32_16x16x32_bf16 v[160:163], v[112:115], v[44:47], v[160:163]
    s_cmp_eq_u32 s82, 20
    v_mfma_f32_16x16x32_bf16 v[164:167], v[112:115], v[48:51], v[164:167]
    s_cselect_b32 s29, s83, 0
    v_mfma_f32_16x16x32_bf16 v[168:171], v[112:115], v[52:55], v[168:171]
    s_sub_u32 s50, s50, s29
    s_waitcnt vmcnt(16) lgkmcnt(0)
    s_barrier
    ds_read_b64_tr_b16 v[112:113], v11 offset:16896
    v_mfma_f32_16x16x32_bf16 v[172:175], v[116:119], v[28:31], v[172:175]
    ds_read_b64_tr_b16 v[114:115], v11 offset:17152
    v_mfma_f32_16x16x32_bf16 v[176:179], v[116:119], v[32:35], v[176:179]
    ds_read_b128 v[56:59], v27 offset:16896
    v_mfma_f32_16x16x32_bf16 v[180:183], v[116:119], v[36:39], v[180:183]
    s_add_u32 s28, s49, s88
    buffer_load_dwordx4 v26, s[16:19], s28 offen lds
    v_mfma_f32_16x16x32_bf16 v[184:187], v[116:119], v[40:43], v[184:187]
    s_add_u32 m0, m0, s53
    ds_read_b128 v[60:63], v27 offset:17920
    v_mfma_f32_16x16x32_bf16 v[188:191], v[116:119], v[44:47], v[188:191]
    ds_read_b128 v[64:67], v27 offset:18944
    v_mfma_f32_16x16x32_bf16 v[192:195], v[116:119], v[48:51], v[192:195]
    ds_read_b128 v[68:71], v27 offset:19968
    v_mfma_f32_16x16x32_bf16 v[196:199], v[116:119], v[52:55], v[196:199]
    ds_read_b128 v[72:75], v27 offset:20992
    v_mfma_f32_16x16x32_bf16 v[200:203], v[120:123], v[28:31], v[200:203]
    ds_read_b128 v[76:79], v27 offset:22016
    v_mfma_f32_16x16x32_bf16 v[204:207], v[120:123], v[32:35], v[204:207]
    s_add_u32 s28, s49, s89
    buffer_load_dwordx4 v26, s[16:19], s28 offen lds
    v_mfma_f32_16x16x32_bf16 v[208:211], v[120:123], v[36:39], v[208:211]
    s_add_u32 m0, m0, s53
    ds_read_b128 v[80:83], v27 offset:23040
    v_mfma_f32_16x16x32_bf16 v[212:215], v[120:123], v[40:43], v[212:215]
    ds_read_b64_tr_b16 v[116:117], v11 offset:16928
    v_mfma_f32_16x16x32_bf16 v[216:219], v[120:123], v[44:47], v[216:219]
    ds_read_b64_tr_b16 v[118:119], v11 offset:17184
    v_mfma_f32_16x16x32_bf16 v[220:223], v[120:123], v[48:51], v[220:223]
    v_mfma_f32_16x16x32_bf16 v[224:227], v[120:123], v[52:55], v[224:227]
    ds_read_b64_tr_b16 v[120:121], v11 offset:16960
    v_mfma_f32_16x16x32_bf16 v[228:231], v[124:127], v[28:31], v[228:231]
    s_add_u32 s28, s49, s90
    buffer_load_dwordx4 v26, s[16:19], s28 offen lds
    v_mfma_f32_16x16x32_bf16 v[232:235], v[124:127], v[32:35], v[232:235]
    s_add_u32 m0, m0, s53
    ds_read_b64_tr_b16 v[122:123], v11 offset:17216
    v_mfma_f32_16x16x32_bf16 v[236:239], v[124:127], v[36:39], v[236:239]
    v_mfma_f32_16x16x32_bf16 v[240:243], v[124:127], v[40:43], v[240:243]
    v_mfma_f32_16x16x32_bf16 v[244:247], v[124:127], v[44:47], v[244:247]
    v_mfma_f32_16x16x32_bf16 v[248:251], v[124:127], v[48:51], v[248:251]
    v_mfma_f32_16x16x32_bf16 v[252:255], v[124:127], v[52:55], v[252:255]
    s_add_u32 s28, s49, s91
    buffer_load_dwordx4 v26, s[16:19], s28 offen lds
    v_mfma_f32_16x16x32_bf16 a[112:115], v[128:131], v[28:31], a[112:115]
    s_add_u32 m0, m0, s53
    ds_read_b64_tr_b16 v[124:125], v11 offset:16992
    v_mfma_f32_16x16x32_bf16 a[116:119], v[128:131], v[32:35], a[116:119]
    ds_read_b64_tr_b16 v[126:127], v11 offset:17248
    v_mfma_f32_16x16x32_bf16 a[120:123], v[128:131], v[36:39], a[120:123]
    v_mfma_f32_16x16x32_bf16 a[124:127], v[128:131], v[40:43], a[124:127]
    v_mfma_f32_16x16x32_bf16 a[128:131], v[128:131], v[44:47], a[128:131]
    v_mfma_f32_16x16x32_bf16 a[132:135], v[128:131], v[48:51], a[132:135]
    s_add_u32 s28, s49, s92
    buffer_load_dwordx4 v26, s[16:19], s28 offen lds
    v_mfma_f32_16x16x32_bf16 a[136:139], v[128:131], v[52:55], a[136:139]
    s_add_u32 m0, m0, s53
    ds_read_b64_tr_b16 v[128:129], v11 offset:17024
    v_mfma_f32_16x16x32_bf16 a[140:143], v[132:135], v[28:31], a[140:143]
    ds_read_b64_tr_b16 v[130:131], v11 offset:17280
    v_mfma_f32_16x16x32_bf16 a[144:147], v[132:135], v[32:35], a[144:147]
    v_mfma_f32_16x16x32_bf16 a[148:151], v[132:135], v[36:39], a[148:151]
    v_mfma_f32_16x16x32_bf16 a[152:155], v[132:135], v[40:43], a[152:155]
    v_mfma_f32_16x16x32_bf16 a[156:159], v[132:135], v[44:47], a[156:159]
    s_add_u32 s28, s49, s93
    buffer_load_dwordx4 v26, s[16:19], s28 offen lds
    v_mfma_f32_16x16x32_bf16 a[160:163], v[132:135], v[48:51], a[160:163]
    s_add_u32 m0, m0, s53
    v_mfma_f32_16x16x32_bf16 a[164:167], v[132:135], v[52:55], a[164:167]
    ds_read_b64_tr_b16 v[132:133], v11 offset:17056
    v_mfma_f32_16x16x32_bf16 a[168:171], v[136:139], v[28:31], a[168:171]
    ds_read_b64_tr_b16 v[134:135], v11 offset:17312
    v_mfma_f32_16x16x32_bf16 a[172:175], v[136:139], v[32:35], a[172:175]
    v_mfma_f32_16x16x32_bf16 a[176:179], v[136:139], v[36:39], a[176:179]
    v_mfma_f32_16x16x32_bf16 a[180:183], v[136:139], v[40:43], a[180:183]
    s_add_u32 s28, s49, s94
    buffer_load_dwordx4 v26, s[16:19], s28 offen lds
    v_mfma_f32_16x16x32_bf16 a[184:187], v[136:139], v[44:47], a[184:187]
    s_add_u32 m0, m0, s53
    v_mfma_f32_16x16x32_bf16 a[188:191], v[136:139], v[48:51], a[188:191]
    v_mfma_f32_16x16x32_bf16 a[192:195], v[136:139], v[52:55], a[192:195]
    ds_read_b64_tr_b16 v[136:137], v11 offset:17088
    v_mfma_f32_16x16x32_bf16 a[196:199], v[140:143], v[28:31], a[196:199]
    ds_read_b64_tr_b16 v[138:139], v11 offset:17344
    v_mfma_f32_16x16x32_bf16 a[200:203], v[140:143], v[32:35], a[200:203]
    v_mfma_f32_16x16x32_bf16 a[204:207], v[140:143], v[36:39], a[204:207]
    s_add_u32 s28, s49, s95
    buffer_load_dwordx4 v26, s[16:19], s28 offen lds
    v_mfma_f32_16x16x32_bf16 a[208:211], v[140:143], v[40:43], a[208:211]
    v_mfma_f32_16x16x32_bf16 a[212:215], v[140:143], v[44:47], a[212:215]
    v_mfma_f32_16x16x32_bf16 a[216:219], v[140:143], v[48:51], a[216:219]
    v_mfma_f32_16x16x32_bf16 a[220:223], v[140:143], v[52:55], a[220:223]
    ds_read_b64_tr_b16 v[140:141], v11 offset:17120
    ds_read_b64_tr_b16 v[142:143], v11 offset:17376
    s_waitcnt lgkmcnt(14)
    v_mfma_f32_16x16x32_bf16 v[144:147], v[112:115], v[56:59], v[144:147]
    s_add_u32 m0, s33, 16896
    v_mfma_f32_16x16x32_bf16 v[148:151], v[112:115], v[60:63], v[148:151]
    s_mov_b32 s49, s50
    v_mfma_f32_16x16x32_bf16 v[152:155], v[112:115], v[64:67], v[152:155]
    s_add_u32 s50, s50, s51
    v_mfma_f32_16x16x32_bf16 v[156:159], v[112:115], v[68:71], v[156:159]
    s_add_u32 s82, s82, 1
    v_mfma_f32_16x16x32_bf16 v[160:163], v[112:115], v[72:75], v[160:163]
    s_cmp_eq_u32 s82, 20
    v_mfma_f32_16x16x32_bf16 v[164:167], v[112:115], v[76:79], v[164:167]
    s_cselect_b32 s29, s83, 0
    v_mfma_f32_16x16x32_bf16 v[168:171], v[112:115], v[80:83], v[168:171]
    s_sub_u32 s50, s50, s29
    s_waitcnt vmcnt(16) lgkmcnt(0)
    s_barrier
    ds_read_b64_tr_b16 v[112:113], v11 offset:25344
    v_mfma_f32_16x16x32_bf16 v[172:175], v[116:119], v[56:59], v[172:175]
    ds_read_b64_tr_b16 v[114:115], v11 offset:25600
    v_mfma_f32_16x16x32_bf16 v[176:179], v[116:119], v[60:63], v[176:179]
    ds_read_b128 v[28:31], v27 offset:25344
    v_mfma_f32_16x16x32_bf16 v[180:183], v[116:119], v[64:67], v[180:183]
    s_add_u32 s28, s49, s88
    buffer_load_dwordx4 v26, s[16:19], s28 offen lds
    v_mfma_f32_16x16x32_bf16 v[184:187], v[116:119], v[68:71], v[184:187]
    s_add_u32 m0, m0, s53
    ds_read_b128 v[32:35], v27 offset:26368
    v_mfma_f32_16x16x32_bf16 v[188:191], v[116:119], v[72:75], v[188:191]
    ds_read_b128 v[36:39], v27 offset:27392
    v_mfma_f32_16x16x32_bf16 v[192:195], v[116:119], v[76:79], v[192:195]
    ds_read_b128 v[40:43], v27 offset:28416
    v_mfma_f32_16x16x32_bf16 v[196:199], v[116:119], v[80:83], v[196:199]
    ds_read_b128 v[44:47], v27 offset:29440
    v_mfma_f32_16x16x32_bf16 v[200:203], v[120:123], v[56:59], v[200:203]
    ds_read_b128 v[48:51], v27 offset:30464
    v_mfma_f32_16x16x32_bf16 v[204:207], v[120:123], v[60:63], v[204:207]
    s_add_u32 s28, s49, s89
    buffer_load_dwordx4 v26, s[16:19], s28 offen lds
    v_mfma_f32_16x16x32_bf16 v[208:211], v[120:123], v[64:67], v[208:211]
    s_add_u32 m0, m0, s53
    ds_read_b128 v[52:55], v27 offset:31488
    v_mfma_f32_16x16x32_bf16 v[212:215], v[120:123], v[68:71], v[212:215]
    ds_read_b64_tr_b16 v[116:117], v11 offset:25376
    v_mfma_f32_16x16x32_bf16 v[216:219], v[120:123], v[72:75], v[216:219]
    ds_read_b64_tr_b16 v[118:119], v11 offset:25632
    v_mfma_f32_16x16x32_bf16 v[220:223], v[120:123], v[76:79], v[220:223]
    v_mfma_f32_16x16x32_bf16 v[224:227], v[120:123], v[80:83], v[224:227]
    ds_read_b64_tr_b16 v[120:121], v11 offset:25408
    v_mfma_f32_16x16x32_bf16 v[228:231], v[124:127], v[56:59], v[228:231]
    s_add_u32 s28, s49, s90
    buffer_load_dwordx4 v26, s[16:19], s28 offen lds
    v_mfma_f32_16x16x32_bf16 v[232:235], v[124:127], v[60:63], v[232:235]
    s_add_u32 m0, m0, s53
    ds_read_b64_tr_b16 v[122:123], v11 offset:25664
    v_mfma_f32_16x16x32_bf16 v[236:239], v[124:127], v[64:67], v[236:239]
    v_mfma_f32_16x16x32_bf16 v[240:243], v[124:127], v[68:71], v[240:243]
    v_mfma_f32_16x16x32_bf16 v[244:247], v[124:127], v[72:75], v[244:247]
    v_mfma_f32_16x16x32_bf16 v[248:251], v[124:127], v[76:79], v[248:251]
    v_mfma_f32_16x16x32_bf16 v[252:255], v[124:127], v[80:83], v[252:255]
    s_add_u32 s28, s49, s91
    buffer_load_dwordx4 v26, s[16:19], s28 offen lds
    v_mfma_f32_16x16x32_bf16 a[112:115], v[128:131], v[56:59], a[112:115]
    s_add_u32 m0, m0, s53
    ds_read_b64_tr_b16 v[124:125], v11 offset:25440
    v_mfma_f32_16x16x32_bf16 a[116:119], v[128:131], v[60:63], a[116:119]
    ds_read_b64_tr_b16 v[126:127], v11 offset:25696
    v_mfma_f32_16x16x32_bf16 a[120:123], v[128:131], v[64:67], a[120:123]
    v_mfma_f32_16x16x32_bf16 a[124:127], v[128:131], v[68:71], a[124:127]
    v_mfma_f32_16x16x32_bf16 a[128:131], v[128:131], v[72:75], a[128:131]
    v_mfma_f32_16x16x32_bf16 a[132:135], v[128:131], v[76:79], a[132:135]
    s_add_u32 s28, s49, s92
    buffer_load_dwordx4 v26, s[16:19], s28 offen lds
    v_mfma_f32_16x16x32_bf16 a[136:139], v[128:131], v[80:83], a[136:139]
    s_add_u32 m0, m0, s53
    ds_read_b64_tr_b16 v[128:129], v11 offset:25472
    v_mfma_f32_16x16x32_bf16 a[140:143], v[132:135], v[56:59], a[140:143]
    ds_read_b64_tr_b16 v[130:131], v11 offset:25728
    v_mfma_f32_16x16x32_bf16 a[144:147], v[132:135], v[60:63], a[144:147]
    v_mfma_f32_16x16x32_bf16 a[148:151], v[132:135], v[64:67], a[148:151]
    v_mfma_f32_16x16x32_bf16 a[152:155], v[132:135], v[68:71], a[152:155]
    v_mfma_f32_16x16x32_bf16 a[156:159], v[132:135], v[72:75], a[156:159]
    s_add_u32 s28, s49, s93
    buffer_load_dwordx4 v26, s[16:19], s28 offen lds
    v_mfma_f32_16x16x32_bf16 a[160:163], v[132:135], v[76:79], a[160:163]
    s_add_u32 m0, m0, s53
    v_mfma_f32_16x16x32_bf16 a[164:167], v[132:135], v[80:83], a[164:167]
    ds_read_b64_tr_b16 v[132:133], v11 offset:25504
    v_mfma_f32_16x16x32_bf16 a[168:171], v[136:139], v[56:59], a[168:171]
    ds_read_b64_tr_b16 v[134:135], v11 offset:25760
    v_mfma_f32_16x16x32_bf16 a[172:175], v[136:139], v[60:63], a[172:175]
    v_mfma_f32_16x16x32_bf16 a[176:179], v[136:139], v[64:67], a[176:179]
    v_mfma_f32_16x16x32_bf16 a[180:183], v[136:139], v[68:71], a[180:183]
    s_add_u32 s28, s49, s94
    buffer_load_dwordx4 v26, s[16:19], s28 offen lds
    v_mfma_f32_16x16x32_bf16 a[184:187], v[136:139], v[72:75], a[184:187]
    s_add_u32 m0, m0, s53
    v_mfma_f32_16x16x32_bf16 a[188:191], v[136:139], v[76:79], a[188:191]
    v_mfma_f32_16x16x32_bf16 a[192:195], v[136:139], v[80:83], a[192:195]
    ds_read_b64_tr_b16 v[136:137], v11 offset:25536
    v_mfma_f32_16x16x32_bf16 a[196:199], v[140:143], v[56:59], a[196:199]
    ds_read_b64_tr_b16 v[138:139], v11 offset:25792
    v_mfma_f32_16x16x32_bf16 a[200:203], v[140:143], v[60:63], a[200:203]
    v_mfma_f32_16x16x32_bf16 a[204:207], v[140:143], v[64:67], a[204:207]
    s_add_u32 s28, s49, s95
    buffer_load_dwordx4 v26, s[16:19], s28 offen lds
    v_mfma_f32_16x16x32_bf16 a[208:211], v[140:143], v[68:71], a[208:211]
    v_mfma_f32_16x16x32_bf16 a[212:215], v[140:143], v[72:75], a[212:215]
    v_mfma_f32_16x16x32_bf16 a[216:219], v[140:143], v[76:79], a[216:219]
    v_mfma_f32_16x16x32_bf16 a[220:223], v[140:143], v[80:83], a[220:223]
    ds_read_b64_tr_b16 v[140:141], v11 offset:25568
    ds_read_b64_tr_b16 v[142:143], v11 offset:25824
    s_waitcnt lgkmcnt(14)
    v_mfma_f32_16x16x32_bf16 v[144:147], v[112:115], v[28:31], v[144:147]
    s_add_u32 m0, s33, 25344
    v_mfma_f32_16x16x32_bf16 v[148:151], v[112:115], v[32:35], v[148:151]
    s_mov_b32 s49, s50
    v_mfma_f32_16x16x32_bf16 v[152:155], v[112:115], v[36:39], v[152:155]
    s_add_u32 s50, s50, s51
    v_mfma_f32_16x16x32_bf16 v[156:159], v[112:115], v[40:43], v[156:159]
    s_add_u32 s82, s82, 1
    v_mfma_f32_16x16x32_bf16 v[160:163], v[112:115], v[44:47], v[160:163]
    s_cmp_eq_u32 s82, 20
    v_mfma_f32_16x16x32_bf16 v[164:167], v[112:115], v[48:51], v[164:167]
    s_cselect_b32 s29, s83, 0
    v_mfma_f32_16x16x32_bf16 v[168:171], v[112:115], v[52:55], v[168:171]
    s_sub_u32 s50, s50, s29
    s_waitcnt vmcnt(16) lgkmcnt(0)
    s_barrier
    v_mfma_f32_16x16x32_bf16 v[172:175], v[116:119], v[28:31], v[172:175]
    v_mfma_f32_16x16x32_bf16 v[176:179], v[116:119], v[32:35], v[176:179]
    v_mfma_f32_16x16x32_bf16 v[180:183], v[116:119], v[36:39], v[180:183]
    s_add_u32 s28, s49, s88
    buffer_load_dwordx4 v26, s[16:19], s28 offen lds
    v_mfma_f32_16x16x32_bf16 v[184:187], v[116:119], v[40:43], v[184:187]
    s_add_u32 m0, m0, s53
    v_mfma_f32_16x16x32_bf16 v[188:191], v[116:119], v[44:47], v[188:191]
    v_mfma_f32_16x16x32_bf16 v[192:195], v[116:119], v[48:51], v[192:195]
    v_mfma_f32_16x16x32_bf16 v[196:199], v[116:119], v[52:55], v[196:199]
    v_mfma_f32_16x16x32_bf16 v[200:203], v[120:123], v[28:31], v[200:203]
    v_mfma_f32_16x16x32_bf16 v[204:207], v[120:123], v[32:35], v[204:207]
    s_add_u32 s28, s49, s89
    buffer_load_dwordx4 v26, s[16:19], s28 offen lds
    v_mfma_f32_16x16x32_bf16 v[208:211], v[120:123], v[36:39], v[208:211]
    s_add_u32 m0, m0, s53
    v_mfma_f32_16x16x32_bf16 v[212:215], v[120:123], v[40:43], v[212:215]
    v_mfma_f32_16x16x32_bf16 v[216:219], v[120:123], v[44:47], v[216:219]
    v_mfma_f32_16x16x32_bf16 v[220:223], v[120:123], v[48:51], v[220:223]
    v_mfma_f32_16x16x32_bf16 v[224:227], v[120:123], v[52:55], v[224:227]
    v_mfma_f32_16x16x32_bf16 v[228:231], v[124:127], v[28:31], v[228:231]
    s_add_u32 s28, s49, s90
    buffer_load_dwordx4 v26, s[16:19], s28 offen lds
    v_mfma_f32_16x16x32_bf16 v[232:235], v[124:127], v[32:35], v[232:235]
    s_add_u32 m0, m0, s53
    v_mfma_f32_16x16x32_bf16 v[236:239], v[124:127], v[36:39], v[236:239]
    v_mfma_f32_16x16x32_bf16 v[240:243], v[124:127], v[40:43], v[240:243]
    v_mfma_f32_16x16x32_bf16 v[244:247], v[124:127], v[44:47], v[244:247]
    v_mfma_f32_16x16x32_bf16 v[248:251], v[124:127], v[48:51], v[248:251]
    v_mfma_f32_16x16x32_bf16 v[252:255], v[124:127], v[52:55], v[252:255]
    s_add_u32 s28, s49, s91
    buffer_load_dwordx4 v26, s[16:19], s28 offen lds
    v_mfma_f32_16x16x32_bf16 a[112:115], v[128:131], v[28:31], a[112:115]
    s_add_u32 m0, m0, s53
    v_mfma_f32_16x16x32_bf16 a[116:119], v[128:131], v[32:35], a[116:119]
    v_mfma_f32_16x16x32_bf16 a[120:123], v[128:131], v[36:39], a[120:123]
    v_mfma_f32_16x16x32_bf16 a[124:127], v[128:131], v[40:43], a[124:127]
    v_mfma_f32_16x16x32_bf16 a[128:131], v[128:131], v[44:47], a[128:131]
    v_mfma_f32_16x16x32_bf16 a[132:135], v[128:131], v[48:51], a[132:135]
    s_add_u32 s28, s49, s92
    buffer_load_dwordx4 v26, s[16:19], s28 offen lds
    v_mfma_f32_16x16x32_bf16 a[136:139], v[128:131], v[52:55], a[136:139]
    s_add_u32 m0, m0, s53
    v_mfma_f32_16x16x32_bf16 a[140:143], v[132:135], v[28:31], a[140:143]
    v_mfma_f32_16x16x32_bf16 a[144:147], v[132:135], v[32:35], a[144:147]
    v_mfma_f32_16x16x32_bf16 a[148:151], v[132:135], v[36:39], a[148:151]
    v_mfma_f32_16x16x32_bf16 a[152:155], v[132:135], v[40:43], a[152:155]
    v_mfma_f32_16x16x32_bf16 a[156:159], v[132:135], v[44:47], a[156:159]
    s_add_u32 s28, s49, s93
    buffer_load_dwordx4 v26, s[16:19], s28 offen lds
    v_mfma_f32_16x16x32_bf16 a[160:163], v[132:135], v[48:51], a[160:163]
    s_add_u32 m0, m0, s53
    v_mfma_f32_16x16x32_bf16 a[164:167], v[132:135], v[52:55], a[164:167]
    v_mfma_f32_16x16x32_bf16 a[168:171], v[136:139], v[28:31], a[168:171]
    v_mfma_f32_16x16x32_bf16 a[172:175], v[136:139], v[32:35], a[172:175]
    v_mfma_f32_16x16x32_bf16 a[176:179], v[136:139], v[36:39], a[176:179]
    v_mfma_f32_16x16x32_bf16 a[180:183], v[136:139], v[40:43], a[180:183]
    s_add_u32 s28, s49, s94
    buffer_load_dwordx4 v26, s[16:19], s28 offen lds
    v_mfma_f32_16x16x32_bf16 a[184:187], v[136:139], v[44:47], a[184:187]
    s_add_u32 m0, m0, s53
    v_mfma_f32_16x16x32_bf16 a[188:191], v[136:139], v[48:51], a[188:191]
    v_mfma_f32_16x16x32_bf16 a[192:195], v[136:139], v[52:55], a[192:195]
    v_mfma_f32_16x16x32_bf16 a[196:199], v[140:143], v[28:31], a[196:199]
    v_mfma_f32_16x16x32_bf16 a[200:203], v[140:143], v[32:35], a[200:203]
    v_mfma_f32_16x16x32_bf16 a[204:207], v[140:143], v[36:39], a[204:207]
    s_add_u32 s28, s49, s95
    buffer_load_dwordx4 v26, s[16:19], s28 offen lds
    v_mfma_f32_16x16x32_bf16 a[208:211], v[140:143], v[40:43], a[208:211]
    v_mfma_f32_16x16x32_bf16 a[212:215], v[140:143], v[44:47], a[212:215]
    v_mfma_f32_16x16x32_bf16 a[216:219], v[140:143], v[48:51], a[216:219]
    v_mfma_f32_16x16x32_bf16 a[220:223], v[140:143], v[52:55], a[220:223]
L_at_qpepi:
    v_mov_b32 v4, s54
    v_mov_b32 v5, s54
    s_nop 6
    v_pk_mul_f32 v[144:145], v[144:145], v[4:5]
    v_pk_mul_f32 v[146:147], v[146:147], v[4:5]
    v_pk_mul_f32 v[148:149], v[148:149], v[4:5]
    v_pk_mul_f32 v[150:151], v[150:151], v[4:5]
    v_pk_mul_f32 v[152:153], v[152:153], v[4:5]
    v_pk_mul_f32 v[154:155], v[154:155], v[4:5]
    v_pk_mul_f32 v[156:157], v[156:157], v[4:5]
    v_pk_mul_f32 v[158:159], v[158:159], v[4:5]
    v_pk_mul_f32 v[160:161], v[160:161], v[4:5]
    v_pk_mul_f32 v[162:163], v[162:163], v[4:5]
    v_pk_mul_f32 v[164:165], v[164:165], v[4:5]
    v_pk_mul_f32 v[166:167], v[166:167], v[4:5]
    v_pk_mul_f32 v[168:169], v[168:169], v[4:5]
    v_pk_mul_f32 v[170:171], v[170:171], v[4:5]
    v_pk_mul_f32 v[172:173], v[172:173], v[4:5]
    v_pk_mul_f32 v[174:175], v[174:175], v[4:5]
    v_pk_mul_f32 v[176:177], v[176:177], v[4:5]
    v_pk_mul_f32 v[178:179], v[178:179], v[4:5]
    v_pk_mul_f32 v[180:181], v[180:181], v[4:5]
    v_pk_mul_f32 v[182:183], v[182:183], v[4:5]
    v_pk_mul_f32 v[184:185], v[184:185], v[4:5]
    v_pk_mul_f32 v[186:187], v[186:187], v[4:5]
    v_pk_mul_f32 v[188:189], v[188:189], v[4:5]
    v_pk_mul_f32 v[190:191], v[190:191], v[4:5]
    v_pk_mul_f32 v[192:193], v[192:193], v[4:5]
    v_pk_mul_f32 v[194:195], v[194:195], v[4:5]
    v_pk_mul_f32 v[196:197], v[196:197], v[4:5]
    v_pk_mul_f32 v[198:199], v[198:199], v[4:5]
    v_cvt_pk_bf16_f32 v88, v144, v145
    v_cvt_pk_bf16_f32 v89, v146, v147
    v_cvt_pk_bf16_f32 v90, v172, v173
    v_cvt_pk_bf16_f32 v91, v174, v175
    v_cvt_pk_bf16_f32 v92, v148, v149
    v_cvt_pk_bf16_f32 v93, v150, v151
    v_cvt_pk_bf16_f32 v94, v176, v177
    v_cvt_pk_bf16_f32 v95, v178, v179
    v_cvt_pk_bf16_f32 v96, v152, v153
    v_cvt_pk_bf16_f32 v97, v154, v155
    v_cvt_pk_bf16_f32 v98, v180, v181
    v_cvt_pk_bf16_f32 v99, v182, v183
    v_cvt_pk_bf16_f32 v100, v156, v157
    v_cvt_pk_bf16_f32 v101, v158, v159
    v_cvt_pk_bf16_f32 v102, v184, v185
    v_cvt_pk_bf16_f32 v103, v186, v187
    v_cvt_pk_bf16_f32 v104, v160, v161
    v_cvt_pk_bf16_f32 v105, v162, v163
    v_cvt_pk_bf16_f32 v106, v188, v189
    v_cvt_pk_bf16_f32 v107, v190, v191
    v_cvt_pk_bf16_f32 v108, v164, v165
    v_cvt_pk_bf16_f32 v109, v166, v167
    v_cvt_pk_bf16_f32 v110, v192, v193
    v_cvt_pk_bf16_f32 v111, v194, v195
    v_cvt_pk_bf16_f32 v112, v168, v169
    v_cvt_pk_bf16_f32 v113, v170, v171
    v_cvt_pk_bf16_f32 v114, v196, v197
    v_cvt_pk_bf16_f32 v115, v198, v199
    s_nop 1
    v_permlane16_swap_b32 v88, v90
    v_permlane16_swap_b32 v89, v91
    v_permlane16_swap_b32 v92, v94
    v_permlane16_swap_b32 v93, v95
    v_permlane16_swap_b32 v96, v98
    v_permlane16_swap_b32 v97, v99
    v_permlane16_swap_b32 v100, v102
    v_permlane16_swap_b32 v101, v103
    v_permlane16_swap_b32 v104, v106
    v_permlane16_swap_b32 v105, v107
    v_permlane16_swap_b32 v108, v110
    v_permlane16_swap_b32 v109, v111
    v_permlane16_swap_b32 v112, v114
    v_permlane16_swap_b32 v113, v115
    v_accvgpr_write_b32 a0, v88
    v_accvgpr_write_b32 a1, v89
    v_accvgpr_write_b32 a2, v90
    v_accvgpr_write_b32 a3, v91
    v_accvgpr_write_b32 a16, v92
    v_accvgpr_write_b32 a17, v93
    v_accvgpr_write_b32 a18, v94
    v_accvgpr_write_b32 a19, v95
    v_accvgpr_write_b32 a32, v96
    v_accvgpr_write_b32 a33, v97
    v_accvgpr_write_b32 a34, v98
    v_accvgpr_write_b32 a35, v99
    v_accvgpr_write_b32 a48, v100
    v_accvgpr_write_b32 a49, v101
    v_accvgpr_write_b32 a50, v102
    v_accvgpr_write_b32 a51, v103
    v_accvgpr_write_b32 a64, v104
    v_accvgpr_write_b32 a65, v105
    v_accvgpr_write_b32 a66, v106
    v_accvgpr_write_b32 a67, v107
    v_accvgpr_write_b32 a80, v108
    v_accvgpr_write_b32 a81, v109
    v_accvgpr_write_b32 a82, v110
    v_accvgpr_write_b32 a83, v111
    v_accvgpr_write_b32 a96, v112
    v_accvgpr_write_b32 a97, v113
    v_accvgpr_write_b32 a98, v114
    v_accvgpr_write_b32 a99, v115
    v_pk_mul_f32 v[200:201], v[200:201], v[4:5]
    v_pk_mul_f32 v[202:203], v[202:203], v[4:5]
    v_pk_mul_f32 v[204:205], v[204:205], v[4:5]
    v_pk_mul_f32 v[206:207], v[206:207], v[4:5]
    v_pk_mul_f32 v[208:209], v[208:209], v[4:5]
    v_pk_mul_f32 v[210:211], v[210:211], v[4:5]
    v_pk_mul_f32 v[212:213], v[212:213], v[4:5]
    v_pk_mul_f32 v[214:215], v[214:215], v[4:5]
    v_pk_mul_f32 v[216:217], v[216:217], v[4:5]
    v_pk_mul_f32 v[218:219], v[218:219], v[4:5]
    v_pk_mul_f32 v[220:221], v[220:221], v[4:5]
    v_pk_mul_f32 v[222:223], v[222:223], v[4:5]
    v_pk_mul_f32 v[224:225], v[224:225], v[4:5]
    v_pk_mul_f32 v[226:227], v[226:227], v[4:5]
    v_pk_mul_f32 v[228:229], v[228:229], v[4:5]
    v_pk_mul_f32 v[230:231], v[230:231], v[4:5]
    v_pk_mul_f32 v[232:233], v[232:233], v[4:5]
    v_pk_mul_f32 v[234:235], v[234:235], v[4:5]
    v_pk_mul_f32 v[236:237], v[236:237], v[4:5]
    v_pk_mul_f32 v[238:239], v[238:239], v[4:5]
    v_pk_mul_f32 v[240:241], v[240:241], v[4:5]
    v_pk_mul_f32 v[242:243], v[242:243], v[4:5]
    v_pk_mul_f32 v[244:245], v[244:245], v[4:5]
    v_pk_mul_f32 v[246:247], v[246:247], v[4:5]
    v_pk_mul_f32 v[248:249], v[248:249], v[4:5]
    v_pk_mul_f32 v[250:251], v[250:251], v[4:5]
    v_pk_mul_f32 v[252:253], v[252:253], v[4:5]
    v_pk_mul_f32 v[254:255], v[254:255], v[4:5]
    v_cvt_pk_bf16_f32 v116, v200, v201
    v_cvt_pk_bf16_f32 v117, v202, v203
    v_cvt_pk_bf16_f32 v118, v228, v229
    v_cvt_pk_bf16_f32 v119, v230, v231
    v_cvt_pk_bf16_f32 v120, v204, v205
    v_cvt_pk_bf16_f32 v121, v206, v207
    v_cvt_pk_bf16_f32 v122, v232, v233
    v_cvt_pk_bf16_f32 v123, v234, v235
    v_cvt_pk_bf16_f32 v124, v208, v209
    v_cvt_pk_bf16_f32 v125, v210, v211
    v_cvt_pk_bf16_f32 v126, v236, v237
    v_cvt_pk_bf16_f32 v127, v238, v239
    v_cvt_pk_bf16_f32 v128, v212, v213
    v_cvt_pk_bf16_f32 v129, v214, v215
    v_cvt_pk_bf16_f32 v130, v240, v241
    v_cvt_pk_bf16_f32 v131, v242, v243
    v_cvt_pk_bf16_f32 v132, v216, v217
    v_cvt_pk_bf16_f32 v133, v218, v219
    v_cvt_pk_bf16_f32 v134, v244, v245
    v_cvt_pk_bf16_f32 v135, v246, v247
    v_cvt_pk_bf16_f32 v136, v220, v221
    v_cvt_pk_bf16_f32 v137, v222, v223
    v_cvt_pk_bf16_f32 v138, v248, v249
    v_cvt_pk_bf16_f32 v139, v250, v251
    v_cvt_pk_bf16_f32 v140, v224, v225
    v_cvt_pk_bf16_f32 v141, v226, v227
    v_cvt_pk_bf16_f32 v142, v252, v253
    v_cvt_pk_bf16_f32 v143, v254, v255
    s_nop 1
    v_permlane16_swap_b32 v116, v118
    v_permlane16_swap_b32 v117, v119
    v_permlane16_swap_b32 v120, v122
    v_permlane16_swap_b32 v121, v123
    v_permlane16_swap_b32 v124, v126
    v_permlane16_swap_b32 v125, v127
    v_permlane16_swap_b32 v128, v130
    v_permlane16_swap_b32 v129, v131
    v_permlane16_swap_b32 v132, v134
    v_permlane16_swap_b32 v133, v135
    v_permlane16_swap_b32 v136, v138
    v_permlane16_swap_b32 v137, v139
    v_permlane16_swap_b32 v140, v142
    v_permlane16_swap_b32 v141, v143
    v_accvgpr_write_b32 a4, v116
    v_accvgpr_write_b32 a5, v117
    v_accvgpr_write_b32 a6, v118
    v_accvgpr_write_b32 a7, v119
    v_accvgpr_write_b32 a20, v120
    v_accvgpr_write_b32 a21, v121
    v_accvgpr_write_b32 a22, v122
    v_accvgpr_write_b32 a23, v123
    v_accvgpr_write_b32 a36, v124
    v_accvgpr_write_b32 a37, v125
    v_accvgpr_write_b32 a38, v126
    v_accvgpr_write_b32 a39, v127
    v_accvgpr_write_b32 a52, v128
    v_accvgpr_write_b32 a53, v129
    v_accvgpr_write_b32 a54, v130
    v_accvgpr_write_b32 a55, v131
    v_accvgpr_write_b32 a68, v132
    v_accvgpr_write_b32 a69, v133
    v_accvgpr_write_b32 a70, v134
    v_accvgpr_write_b32 a71, v135
    v_accvgpr_write_b32 a84, v136
    v_accvgpr_write_b32 a85, v137
    v_accvgpr_write_b32 a86, v138
    v_accvgpr_write_b32 a87, v139
    v_accvgpr_write_b32 a100, v140
    v_accvgpr_write_b32 a101, v141
    v_accvgpr_write_b32 a102, v142
    v_accvgpr_write_b32 a103, v143
    v_accvgpr_read_b32 v144, a112
    v_accvgpr_read_b32 v145, a113
    v_accvgpr_read_b32 v146, a114
    v_accvgpr_read_b32 v147, a115
    v_accvgpr_read_b32 v148, a116
    v_accvgpr_read_b32 v149, a117
    v_accvgpr_read_b32 v150, a118
    v_accvgpr_read_b32 v151, a119
    v_accvgpr_read_b32 v152, a120
    v_accvgpr_read_b32 v153, a121
    v_accvgpr_read_b32 v154, a122
    v_accvgpr_read_b32 v155, a123
    v_accvgpr_read_b32 v156, a124
    v_accvgpr_read_b32 v157, a125
    v_accvgpr_read_b32 v158, a126
    v_accvgpr_read_b32 v159, a127
    v_accvgpr_read_b32 v160, a128
    v_accvgpr_read_b32 v161, a129
    v_accvgpr_read_b32 v162, a130
    v_accvgpr_read_b32 v163, a131
    v_accvgpr_read_b32 v164, a132
    v_accvgpr_read_b32 v165, a133
    v_accvgpr_read_b32 v166, a134
    v_accvgpr_read_b32 v167, a135
    v_accvgpr_read_b32 v168, a136
    v_accvgpr_read_b32 v169, a137
    v_accvgpr_read_b32 v170, a138
    v_accvgpr_read_b32 v171, a139
    v_accvgpr_read_b32 v172, a140
    v_accvgpr_read_b32 v173, a141
    v_accvgpr_read_b32 v174, a142
    v_accvgpr_read_b32 v175, a143
    v_accvgpr_read_b32 v176, a144
    v_accvgpr_read_b32 v177, a145
    v_accvgpr_read_b32 v178, a146
    v_accvgpr_read_b32 v179, a147
    v_accvgpr_read_b32 v180, a148
    v_accvgpr_read_b32 v181, a149
    v_accvgpr_read_b32 v182, a150
    v_accvgpr_read_b32 v183, a151
    v_accvgpr_read_b32 v184, a152
    v_accvgpr_read_b32 v185, a153
    v_accvgpr_read_b32 v186, a154
    v_accvgpr_read_b32 v187, a155
    v_accvgpr_read_b32 v188, a156
    v_accvgpr_read_b32 v189, a157
    v_accvgpr_read_b32 v190, a158
    v_accvgpr_read_b32 v191, a159
    v_accvgpr_read_b32 v192, a160
    v_accvgpr_read_b32 v193, a161
    v_accvgpr_read_b32 v194, a162
    v_accvgpr_read_b32 v195, a163
    v_accvgpr_read_b32 v196, a164
    v_accvgpr_read_b32 v197, a165
    v_accvgpr_read_b32 v198, a166
    v_accvgpr_read_b32 v199, a167
    v_pk_mul_f32 v[144:145], v[144:145], v[4:5]
    v_pk_mul_f32 v[146:147], v[146:147], v[4:5]
    v_pk_mul_f32 v[148:149], v[148:149], v[4:5]
    v_pk_mul_f32 v[150:151], v[150:151], v[4:5]
    v_pk_mul_f32 v[152:153], v[152:153], v[4:5]
    v_pk_mul_f32 v[154:155], v[154:155], v[4:5]
    v_pk_mul_f32 v[156:157], v[156:157], v[4:5]
    v_pk_mul_f32 v[158:159], v[158:159], v[4:5]
    v_pk_mul_f32 v[160:161], v[160:161], v[4:5]
    v_pk_mul_f32 v[162:163], v[162:163], v[4:5]
    v_pk_mul_f32 v[164:165], v[164:165], v[4:5]
    v_pk_mul_f32 v[166:167], v[166:167], v[4:5]
    v_pk_mul_f32 v[168:169], v[168:169], v[4:5]
    v_pk_mul_f32 v[170:171], v[170:171], v[4:5]
    v_pk_mul_f32 v[172:173], v[172:173], v[4:5]
    v_pk_mul_f32 v[174:175], v[174:175], v[4:5]
    v_pk_mul_f32 v[176:177], v[176:177], v[4:5]
    v_pk_mul_f32 v[178:179], v[178:179], v[4:5]
    v_pk_mul_f32 v[180:181], v[180:181], v[4:5]
    v_pk_mul_f32 v[182:183], v[182:183], v[4:5]
    v_pk_mul_f32 v[184:185], v[184:185], v[4:5]
    v_pk_mul_f32 v[186:187], v[186:187], v[4:5]
    v_pk_mul_f32 v[188:189], v[188:189], v[4:5]
    v_pk_mul_f32 v[190:191], v[190:191], v[4:5]
    v_pk_mul_f32 v[192:193], v[192:193], v[4:5]
    v_pk_mul_f32 v[194:195], v[194:195], v[4:5]
    v_pk_mul_f32 v[196:197], v[196:197], v[4:5]
    v_pk_mul_f32 v[198:199], v[198:199], v[4:5]
    v_cvt_pk_bf16_f32 v88, v144, v145
    v_cvt_pk_bf16_f32 v89, v146, v147
    v_cvt_pk_bf16_f32 v90, v172, v173
    v_cvt_pk_bf16_f32 v91, v174, v175
    v_cvt_pk_bf16_f32 v92, v148, v149
    v_cvt_pk_bf16_f32 v93, v150, v151
    v_cvt_pk_bf16_f32 v94, v176, v177
    v_cvt_pk_bf16_f32 v95, v178, v179
    v_cvt_pk_bf16_f32 v96, v152, v153
    v_cvt_pk_bf16_f32 v97, v154, v155
    v_cvt_pk_bf16_f32 v98, v180, v181
    v_cvt_pk_bf16_f32 v99, v182, v183
    v_cvt_pk_bf16_f32 v100, v156, v157
    v_cvt_pk_bf16_f32 v101, v158, v159
    v_cvt_pk_bf16_f32 v102, v184, v185
    v_cvt_pk_bf16_f32 v103, v186, v187
    v_cvt_pk_bf16_f32 v104, v160, v161
    v_cvt_pk_bf16_f32 v105, v162, v163
    v_cvt_pk_bf16_f32 v106, v188, v189
    v_cvt_pk_bf16_f32 v107, v190, v191
    v_cvt_pk_bf16_f32 v108, v164, v165
    v_cvt_pk_bf16_f32 v109, v166, v167
    v_cvt_pk_bf16_f32 v110, v192, v193
    v_cvt_pk_bf16_f32 v111, v194, v195
    v_cvt_pk_bf16_f32 v112, v168, v169
    v_cvt_pk_bf16_f32 v113, v170, v171
    v_cvt_pk_bf16_f32 v114, v196, v197
    v_cvt_pk_bf16_f32 v115, v198, v199
    s_nop 1
    v_permlane16_swap_b32 v88, v90
    v_permlane16_swap_b32 v89, v91
    v_permlane16_swap_b32 v92, v94
    v_permlane16_swap_b32 v93, v95
    v_permlane16_swap_b32 v96, v98
    v_permlane16_swap_b32 v97, v99
    v_permlane16_swap_b32 v100, v102
    v_permlane16_swap_b32 v101, v103
    v_permlane16_swap_b32 v104, v106
    v_permlane16_swap_b32 v105, v107
    v_permlane16_swap_b32 v108, v110
    v_permlane16_swap_b32 v109, v111
    v_permlane16_swap_b32 v112, v114
    v_permlane16_swap_b32 v113, v115
    v_accvgpr_write_b32 a8, v88
    v_accvgpr_write_b32 a9, v89
    v_accvgpr_write_b32 a10, v90
    v_accvgpr_write_b32 a11, v91
    v_accvgpr_write_b32 a24, v92
    v_accvgpr_write_b32 a25, v93
    v_accvgpr_write_b32 a26, v94
    v_accvgpr_write_b32 a27, v95
    v_accvgpr_write_b32 a40, v96
    v_accvgpr_write_b32 a41, v97
    v_accvgpr_write_b32 a42, v98
    v_accvgpr_write_b32 a43, v99
    v_accvgpr_write_b32 a56, v100
    v_accvgpr_write_b32 a57, v101
    v_accvgpr_write_b32 a58, v102
    v_accvgpr_write_b32 a59, v103
    v_accvgpr_write_b32 a72, v104
    v_accvgpr_write_b32 a73, v105
    v_accvgpr_write_b32 a74, v106
    v_accvgpr_write_b32 a75, v107
    v_accvgpr_write_b32 a88, v108
    v_accvgpr_write_b32 a89, v109
    v_accvgpr_write_b32 a90, v110
    v_accvgpr_write_b32 a91, v111
    v_accvgpr_write_b32 a104, v112
    v_accvgpr_write_b32 a105, v113
    v_accvgpr_write_b32 a106, v114
    v_accvgpr_write_b32 a107, v115
    v_accvgpr_read_b32 v200, a168
    v_accvgpr_read_b32 v201, a169
    v_accvgpr_read_b32 v202, a170
    v_accvgpr_read_b32 v203, a171
    v_accvgpr_read_b32 v204, a172
    v_accvgpr_read_b32 v205, a173
    v_accvgpr_read_b32 v206, a174
    v_accvgpr_read_b32 v207, a175
    v_accvgpr_read_b32 v208, a176
    v_accvgpr_read_b32 v209, a177
    v_accvgpr_read_b32 v210, a178
    v_accvgpr_read_b32 v211, a179
    v_accvgpr_read_b32 v212, a180
    v_accvgpr_read_b32 v213, a181
    v_accvgpr_read_b32 v214, a182
    v_accvgpr_read_b32 v215, a183
    v_accvgpr_read_b32 v216, a184
    v_accvgpr_read_b32 v217, a185
    v_accvgpr_read_b32 v218, a186
    v_accvgpr_read_b32 v219, a187
    v_accvgpr_read_b32 v220, a188
    v_accvgpr_read_b32 v221, a189
    v_accvgpr_read_b32 v222, a190
    v_accvgpr_read_b32 v223, a191
    v_accvgpr_read_b32 v224, a192
    v_accvgpr_read_b32 v225, a193
    v_accvgpr_read_b32 v226, a194
    v_accvgpr_read_b32 v227, a195
    v_accvgpr_read_b32 v228, a196
    v_accvgpr_read_b32 v229, a197
    v_accvgpr_read_b32 v230, a198
    v_accvgpr_read_b32 v231, a199
    v_accvgpr_read_b32 v232, a200
    v_accvgpr_read_b32 v233, a201
    v_accvgpr_read_b32 v234, a202
    v_accvgpr_read_b32 v235, a203
    v_accvgpr_read_b32 v236, a204
    v_accvgpr_read_b32 v237, a205
    v_accvgpr_read_b32 v238, a206
    v_accvgpr_read_b32 v239, a207
    v_accvgpr_read_b32 v240, a208
    v_accvgpr_read_b32 v241, a209
    v_accvgpr_read_b32 v242, a210
    v_accvgpr_read_b32 v243, a211
    v_accvgpr_read_b32 v244, a212
    v_accvgpr_read_b32 v245, a213
    v_accvgpr_read_b32 v246, a214
    v_accvgpr_read_b32 v247, a215
    v_accvgpr_read_b32 v248, a216
    v_accvgpr_read_b32 v249, a217
    v_accvgpr_read_b32 v250, a218
    v_accvgpr_read_b32 v251, a219
    v_accvgpr_read_b32 v252, a220
    v_accvgpr_read_b32 v253, a221
    v_accvgpr_read_b32 v254, a222
    v_accvgpr_read_b32 v255, a223
    v_pk_mul_f32 v[200:201], v[200:201], v[4:5]
    v_pk_mul_f32 v[202:203], v[202:203], v[4:5]
    v_pk_mul_f32 v[204:205], v[204:205], v[4:5]
    v_pk_mul_f32 v[206:207], v[206:207], v[4:5]
    v_pk_mul_f32 v[208:209], v[208:209], v[4:5]
    v_pk_mul_f32 v[210:211], v[210:211], v[4:5]
    v_pk_mul_f32 v[212:213], v[212:213], v[4:5]
    v_pk_mul_f32 v[214:215], v[214:215], v[4:5]
    v_pk_mul_f32 v[216:217], v[216:217], v[4:5]
    v_pk_mul_f32 v[218:219], v[218:219], v[4:5]
    v_pk_mul_f32 v[220:221], v[220:221], v[4:5]
    v_pk_mul_f32 v[222:223], v[222:223], v[4:5]
    v_pk_mul_f32 v[224:225], v[224:225], v[4:5]
    v_pk_mul_f32 v[226:227], v[226:227], v[4:5]
    v_pk_mul_f32 v[228:229], v[228:229], v[4:5]
    v_pk_mul_f32 v[230:231], v[230:231], v[4:5]
    v_pk_mul_f32 v[232:233], v[232:233], v[4:5]
    v_pk_mul_f32 v[234:235], v[234:235], v[4:5]
    v_pk_mul_f32 v[236:237], v[236:237], v[4:5]
    v_pk_mul_f32 v[238:239], v[238:239], v[4:5]
    v_pk_mul_f32 v[240:241], v[240:241], v[4:5]
    v_pk_mul_f32 v[242:243], v[242:243], v[4:5]
    v_pk_mul_f32 v[244:245], v[244:245], v[4:5]
    v_pk_mul_f32 v[246:247], v[246:247], v[4:5]
    v_pk_mul_f32 v[248:249], v[248:249], v[4:5]
    v_pk_mul_f32 v[250:251], v[250:251], v[4:5]
    v_pk_mul_f32 v[252:253], v[252:253], v[4:5]
    v_pk_mul_f32 v[254:255], v[254:255], v[4:5]
    v_cvt_pk_bf16_f32 v116, v200, v201
    v_cvt_pk_bf16_f32 v117, v202, v203
    v_cvt_pk_bf16_f32 v118, v228, v229
    v_cvt_pk_bf16_f32 v119, v230, v231
    v_cvt_pk_bf16_f32 v120, v204, v205
    v_cvt_pk_bf16_f32 v121, v206, v207
    v_cvt_pk_bf16_f32 v122, v232, v233
    v_cvt_pk_bf16_f32 v123, v234, v235
    v_cvt_pk_bf16_f32 v124, v208, v209
    v_cvt_pk_bf16_f32 v125, v210, v211
    v_cvt_pk_bf16_f32 v126, v236, v237
    v_cvt_pk_bf16_f32 v127, v238, v239
    v_cvt_pk_bf16_f32 v128, v212, v213
    v_cvt_pk_bf16_f32 v129, v214, v215
    v_cvt_pk_bf16_f32 v130, v240, v241
    v_cvt_pk_bf16_f32 v131, v242, v243
    v_cvt_pk_bf16_f32 v132, v216, v217
    v_cvt_pk_bf16_f32 v133, v218, v219
    v_cvt_pk_bf16_f32 v134, v244, v245
    v_cvt_pk_bf16_f32 v135, v246, v247
    v_cvt_pk_bf16_f32 v136, v220, v221
    v_cvt_pk_bf16_f32 v137, v222, v223
    v_cvt_pk_bf16_f32 v138, v248, v249
    v_cvt_pk_bf16_f32 v139, v250, v251
    v_cvt_pk_bf16_f32 v140, v224, v225
    v_cvt_pk_bf16_f32 v141, v226, v227
    v_cvt_pk_bf16_f32 v142, v252, v253
    v_cvt_pk_bf16_f32 v143, v254, v255
    s_nop 1
    v_permlane16_swap_b32 v116, v118
    v_permlane16_swap_b32 v117, v119
    v_permlane16_swap_b32 v120, v122
    v_permlane16_swap_b32 v121, v123
    v_permlane16_swap_b32 v124, v126
    v_permlane16_swap_b32 v125, v127
    v_permlane16_swap_b32 v128, v130
    v_permlane16_swap_b32 v129, v131
    v_permlane16_swap_b32 v132, v134
    v_permlane16_swap_b32 v133, v135
    v_permlane16_swap_b32 v136, v138
    v_permlane16_swap_b32 v137, v139
    v_permlane16_swap_b32 v140, v142
    v_permlane16_swap_b32 v141, v143
    v_accvgpr_write_b32 a12, v116
    v_accvgpr_write_b32 a13, v117
    v_accvgpr_write_b32 a14, v118
    v_accvgpr_write_b32 a15, v119
    v_accvgpr_write_b32 a28, v120
    v_accvgpr_write_b32 a29, v121
    v_accvgpr_write_b32 a30, v122
    v_accvgpr_write_b32 a31, v123
    v_accvgpr_write_b32 a44, v124
    v_accvgpr_write_b32 a45, v125
    v_accvgpr_write_b32 a46, v126
    v_accvgpr_write_b32 a47, v127
    v_accvgpr_write_b32 a60, v128
    v_accvgpr_write_b32 a61, v129
    v_accvgpr_write_b32 a62, v130
    v_accvgpr_write_b32 a63, v131
    v_accvgpr_write_b32 a76, v132
    v_accvgpr_write_b32 a77, v133
    v_accvgpr_write_b32 a78, v134
    v_accvgpr_write_b32 a79, v135
    v_accvgpr_write_b32 a92, v136
    v_accvgpr_write_b32 a93, v137
    v_accvgpr_write_b32 a94, v138
    v_accvgpr_write_b32 a95, v139
    v_accvgpr_write_b32 a108, v140
    v_accvgpr_write_b32 a109, v141
    v_accvgpr_write_b32 a110, v142
    v_accvgpr_write_b32 a111, v143
    s_cmp_eq_u32 s70, 0
    s_cbranch_scc1 L_at_nostash
    s_mov_b32 s70, 0
    s_lshl_b32 s30, s2, 2
    s_add_u32 s30, s30, s20
    s_mul_i32 s30, s30, 28672
    v_lshlrev_b32 v4, 4, v1
    buffer_store_dwordx4 a[0:3], v4, s[12:15], s30 offen offset:0
    buffer_store_dwordx4 a[4:7], v4, s[12:15], s30 offen offset:1024
    buffer_store_dwordx4 a[8:11], v4, s[12:15], s30 offen offset:2048
    buffer_store_dwordx4 a[12:15], v4, s[12:15], s30 offen offset:3072
    s_add_u32 s30, s30, 4096
    buffer_store_dwordx4 a[16:19], v4, s[12:15], s30 offen offset:0
    buffer_store_dwordx4 a[20:23], v4, s[12:15], s30 offen offset:1024
    buffer_store_dwordx4 a[24:27], v4, s[12:15], s30 offen offset:2048
    buffer_store_dwordx4 a[28:31], v4, s[12:15], s30 offen offset:3072
    s_add_u32 s30, s30, 4096
    buffer_store_dwordx4 a[32:35], v4, s[12:15], s30 offen offset:0
    buffer_store_dwordx4 a[36:39], v4, s[12:15], s30 offen offset:1024
    buffer_store_dwordx4 a[40:43], v4, s[12:15], s30 offen offset:2048
    buffer_store_dwordx4 a[44:47], v4, s[12:15], s30 offen offset:3072
    s_add_u32 s30, s30, 4096
    buffer_store_dwordx4 a[48:51], v4, s[12:15], s30 offen offset:0
    buffer_store_dwordx4 a[52:55], v4, s[12:15], s30 offen offset:1024
    buffer_store_dwordx4 a[56:59], v4, s[12:15], s30 offen offset:2048
    buffer_store_dwordx4 a[60:63], v4, s[12:15], s30 offen offset:3072
    s_add_u32 s30, s30, 4096
    buffer_store_dwordx4 a[64:67], v4, s[12:15], s30 offen offset:0
    buffer_store_dwordx4 a[68:71], v4, s[12:15], s30 offen offset:1024
    buffer_store_dwordx4 a[72:75], v4, s[12:15], s30 offen offset:2048
    buffer_store_dwordx4 a[76:79], v4, s[12:15], s30 offen offset:3072
    s_add_u32 s30, s30, 4096
    buffer_store_dwordx4 a[80:83], v4, s[12:15], s30 offen offset:0
    buffer_store_dwordx4 a[84:87], v4, s[12:15], s30 offen offset:1024
    buffer_store_dwordx4 a[88:91], v4, s[12:15], s30 offen offset:2048
    buffer_store_dwordx4 a[92:95], v4, s[12:15], s30 offen offset:3072
    s_add_u32 s30, s30, 4096
    buffer_store_dwordx4 a[96:99], v4, s[12:15], s30 offen offset:0
    buffer_store_dwordx4 a[100:103], v4, s[12:15], s30 offen offset:1024
    buffer_store_dwordx4 a[104:107], v4, s[12:15], s30 offen offset:2048
    buffer_store_dwordx4 a[108:111], v4, s[12:15], s30 offen offset:3072
    s_mov_b32 s68, 3
    s_branch L_at_round
L_at_nostash:
    s_cmp_lg_u32 s25, 0
    s_cbranch_scc1 L_at_maxpass
L_at_pre:
L_at_nowo1:
    s_waitcnt lgkmcnt(0)
    v_mfma_f32_16x16x32_bf16 v[88:91], v[56:59], a[0:3], 0
    v_mov_b32 v168, 0
    v_mov_b32 v169, 0
    v_mfma_f32_16x16x32_bf16 v[88:91], v[60:63], a[4:7], v[88:91]
    v_mov_b32 v170, 0
    v_mov_b32 v171, 0
    v_mfma_f32_16x16x32_bf16 v[88:91], v[64:67], a[8:11], v[88:91]
    v_mov_b32 v196, 0
    v_mov_b32 v197, 0
    v_mfma_f32_16x16x32_bf16 v[88:91], v[68:71], a[12:15], v[88:91]
    v_mov_b32 v198, 0
    v_mov_b32 v199, 0
    v_mfma_f32_16x16x32_bf16 v[92:95], v[72:75], a[0:3], 0
    v_mov_b32 v224, 0
    v_mov_b32 v225, 0
    v_mfma_f32_16x16x32_bf16 v[92:95], v[76:79], a[4:7], v[92:95]
    v_mov_b32 v226, 0
    v_mov_b32 v227, 0
    v_mfma_f32_16x16x32_bf16 v[92:95], v[80:83], a[8:11], v[92:95]
    v_mov_b32 v252, 0
    v_mov_b32 v253, 0
    v_mfma_f32_16x16x32_bf16 v[92:95], v[84:87], a[12:15], v[92:95]
    v_mov_b32 v254, 0
    v_mov_b32 v255, 0
    v_accvgpr_write_b32 a136, 0
    v_accvgpr_write_b32 a137, 0
    v_accvgpr_write_b32 a138, 0
    v_accvgpr_write_b32 a139, 0
    v_accvgpr_write_b32 a164, 0
    v_accvgpr_write_b32 a165, 0
    v_accvgpr_write_b32 a166, 0
    v_accvgpr_write_b32 a167, 0
    v_accvgpr_write_b32 a192, 0
    v_accvgpr_write_b32 a193, 0
    v_accvgpr_write_b32 a194, 0
    v_accvgpr_write_b32 a195, 0
    v_accvgpr_write_b32 a220, 0
    v_accvgpr_write_b32 a221, 0
    v_accvgpr_write_b32 a222, 0
    v_accvgpr_write_b32 a223, 0
    v_mfma_f32_16x16x32_bf16 v[96:99], v[56:59], a[16:19], 0
    v_max3_f32 v2, v88, v89, v12
    v_max3_f32 v3, v90, v91, v92
    v_max3_f32 v2, v93, v94, v2
    v_mfma_f32_16x16x32_bf16 v[96:99], v[60:63], a[20:23], v[96:99]
    v_max3_f32 v2, v95, v2, v3
    v_mov_b32 v3, v2
    s_nop 1
    v_permlane16_swap_b32 v2, v3
    v_mfma_f32_16x16x32_bf16 v[96:99], v[64:67], a[24:27], v[96:99]
    s_nop 1
    v_max_f32 v2, v2, v3
    v_mov_b32 v3, v2
    v_mfma_f32_16x16x32_bf16 v[96:99], v[68:71], a[28:31], v[96:99]
    s_nop 1
    v_permlane32_swap_b32 v2, v3
    s_nop 1
    v_max_f32 v2, v2, v3
    v_mfma_f32_16x16x32_bf16 v[100:103], v[72:75], a[16:19], 0
    v_mov_b32 v12, 0
    v_mov_b32 v13, 0
    v_sub_f32 v88, v88, v2
    v_mfma_f32_16x16x32_bf16 v[100:103], v[76:79], a[20:23], v[100:103]
    v_sub_f32 v89, v89, v2
    v_sub_f32 v90, v90, v2
    v_sub_f32 v91, v91, v2
    v_sub_f32 v92, v92, v2
    v_mfma_f32_16x16x32_bf16 v[100:103], v[80:83], a[24:27], v[100:103]
    v_sub_f32 v93, v93, v2
    v_sub_f32 v94, v94, v2
    v_sub_f32 v95, v95, v2
    v_mfma_f32_16x16x32_bf16 v[100:103], v[84:87], a[28:31], v[100:103]
    v_sub_f32 v28, 0, v2
    v_sub_f32 v29, 0, v2
    v_sub_f32 v30, 0, v2
    v_sub_f32 v31, 0, v2
    ds_read_b64_tr_b16 v[112:113], v9 offset:0
    ds_read_b64_tr_b16 v[114:115], v9 offset:512
    v_exp_f32 v88, v88
    ds_read_b64_tr_b16 v[116:117], v9 offset:32
    ds_read_b64_tr_b16 v[118:119], v9 offset:544
    v_exp_f32 v89, v89
    v_exp_f32 v90, v90
    ds_read_b64_tr_b16 v[120:121], v9 offset:64
    ds_read_b64_tr_b16 v[122:123], v9 offset:576
    v_exp_f32 v91, v91
    v_add_f32 v12, v12, v88
    v_add_f32 v13, v13, v89
    ds_read_b64_tr_b16 v[124:125], v9 offset:96
    ds_read_b64_tr_b16 v[126:127], v9 offset:608
    v_cvt_pk_bf16_f32 v104, v88, v89
    v_exp_f32 v92, v92
    ds_read_b64_tr_b16 v[128:129], v9 offset:128
    ds_read_b64_tr_b16 v[130:131], v9 offset:640
    v_exp_f32 v93, v93
    v_add_f32 v12, v12, v90
    v_add_f32 v13, v13, v91
    ds_read_b64_tr_b16 v[132:133], v9 offset:160
    ds_read_b64_tr_b16 v[134:135], v9 offset:672
    v_cvt_pk_bf16_f32 v105, v90, v91
    v_exp_f32 v94, v94
    ds_read_b64_tr_b16 v[136:137], v9 offset:192
    ds_read_b64_tr_b16 v[138:139], v9 offset:704
    v_exp_f32 v95, v95
    v_add_f32 v12, v12, v92
    v_add_f32 v13, v13, v93
    ds_read_b64_tr_b16 v[140:141], v9 offset:224
    ds_read_b64_tr_b16 v[142:143], v9 offset:736
    v_cvt_pk_bf16_f32 v106, v92, v93
    v_add_f32 v12, v12, v94
    v_add_f32 v13, v13, v95
    v_cvt_pk_bf16_f32 v107, v94, v95
    v_mfma_f32_16x16x32_bf16 v[88:91], v[56:59], a[32:35], 0
    v_max3_f32 v2, v96, v97, v14
    v_max3_f32 v3, v98, v99, v100
    v_max3_f32 v2, v101, v102, v2
    v_mfma_f32_16x16x32_bf16 v[88:91], v[60:63], a[36:39], v[88:91]
    v_max3_f32 v2, v103, v2, v3
    v_mov_b32 v3, v2
    s_nop 1
    v_permlane16_swap_b32 v2, v3
    v_mfma_f32_16x16x32_bf16 v[88:91], v[64:67], a[40:43], v[88:91]
    s_nop 1
    v_max_f32 v2, v2, v3
    v_mov_b32 v3, v2
    v_mfma_f32_16x16x32_bf16 v[88:91], v[68:71], a[44:47], v[88:91]
    s_nop 1
    v_permlane32_swap_b32 v2, v3
    s_nop 1
    v_max_f32 v2, v2, v3
    v_mfma_f32_16x16x32_bf16 v[92:95], v[72:75], a[32:35], 0
    v_mov_b32 v14, 0
    v_mov_b32 v15, 0
    v_sub_f32 v96, v96, v2
    v_mfma_f32_16x16x32_bf16 v[92:95], v[76:79], a[36:39], v[92:95]
    v_sub_f32 v97, v97, v2
    v_sub_f32 v98, v98, v2
    v_sub_f32 v99, v99, v2
    v_sub_f32 v100, v100, v2
    v_mfma_f32_16x16x32_bf16 v[92:95], v[80:83], a[40:43], v[92:95]
    v_sub_f32 v101, v101, v2
    v_sub_f32 v102, v102, v2
    v_sub_f32 v103, v103, v2
    v_mfma_f32_16x16x32_bf16 v[92:95], v[84:87], a[44:47], v[92:95]
    v_sub_f32 v32, 0, v2
    v_sub_f32 v33, 0, v2
    v_sub_f32 v34, 0, v2
    v_sub_f32 v35, 0, v2
    s_waitcnt lgkmcnt(0)
    v_mfma_f32_16x16x32_bf16 v[144:147], v[112:115], v[104:107], 0
    v_exp_f32 v96, v96
    v_mfma_f32_16x16x32_bf16 v[172:175], v[116:119], v[104:107], 0
    v_exp_f32 v97, v97
    v_exp_f32 v98, v98
    v_mfma_f32_16x16x32_bf16 v[200:203], v[120:123], v[104:107], 0
    v_exp_f32 v99, v99
    v_add_f32 v14, v14, v96
    v_add_f32 v15, v15, v97
    v_mfma_f32_16x16x32_bf16 v[228:231], v[124:127], v[104:107], 0
    v_cvt_pk_bf16_f32 v108, v96, v97
    v_exp_f32 v100, v100
    v_mfma_f32_16x16x32_bf16 a[112:115], v[128:131], v[104:107], 0
    v_exp_f32 v101, v101
    v_add_f32 v14, v14, v98
    v_add_f32 v15, v15, v99
    v_mfma_f32_16x16x32_bf16 a[140:143], v[132:135], v[104:107], 0
    v_cvt_pk_bf16_f32 v109, v98, v99
    v_exp_f32 v102, v102
    v_mfma_f32_16x16x32_bf16 a[168:171], v[136:139], v[104:107], 0
    v_exp_f32 v103, v103
    v_add_f32 v14, v14, v100
    v_add_f32 v15, v15, v101
    v_mfma_f32_16x16x32_bf16 a[196:199], v[140:143], v[104:107], 0
    v_cvt_pk_bf16_f32 v110, v100, v101
    v_add_f32 v14, v14, v102
    v_add_f32 v15, v15, v103
    v_cvt_pk_bf16_f32 v111, v102, v103
    v_mfma_f32_16x16x32_bf16 v[96:99], v[56:59], a[48:51], 0
    v_max3_f32 v2, v88, v89, v16
    v_max3_f32 v3, v90, v91, v92
    v_max3_f32 v2, v93, v94, v2
    v_mfma_f32_16x16x32_bf16 v[96:99], v[60:63], a[52:55], v[96:99]
    v_max3_f32 v2, v95, v2, v3
    v_mov_b32 v3, v2
    s_nop 1
    v_permlane16_swap_b32 v2, v3
    v_mfma_f32_16x16x32_bf16 v[96:99], v[64:67], a[56:59], v[96:99]
    s_nop 1
    v_max_f32 v2, v2, v3
    v_mov_b32 v3, v2
    v_mfma_f32_16x16x32_bf16 v[96:99], v[68:71], a[60:63], v[96:99]
    s_nop 1
    v_permlane32_swap_b32 v2, v3
    s_nop 1
    v_max_f32 v2, v2, v3
    v_mfma_f32_16x16x32_bf16 v[100:103], v[72:75], a[48:51], 0
    v_mov_b32 v16, 0
    v_mov_b32 v17, 0
    v_sub_f32 v88, v88, v2
    v_mfma_f32_16x16x32_bf16 v[100:103], v[76:79], a[52:55], v[100:103]
    v_sub_f32 v89, v89, v2
    v_sub_f32 v90, v90, v2
    v_sub_f32 v91, v91, v2
    v_sub_f32 v92, v92, v2
    v_mfma_f32_16x16x32_bf16 v[100:103], v[80:83], a[56:59], v[100:103]
    v_sub_f32 v93, v93, v2
    v_sub_f32 v94, v94, v2
    v_sub_f32 v95, v95, v2
    v_mfma_f32_16x16x32_bf16 v[100:103], v[84:87], a[60:63], v[100:103]
    v_sub_f32 v36, 0, v2
    v_sub_f32 v37, 0, v2
    v_sub_f32 v38, 0, v2
    v_sub_f32 v39, 0, v2
    v_mfma_f32_16x16x32_bf16 v[148:151], v[112:115], v[108:111], 0
    v_exp_f32 v88, v88
    v_mfma_f32_16x16x32_bf16 v[176:179], v[116:119], v[108:111], 0
    v_exp_f32 v89, v89
    v_exp_f32 v90, v90
    v_mfma_f32_16x16x32_bf16 v[204:207], v[120:123], v[108:111], 0
    v_exp_f32 v91, v91
    v_add_f32 v16, v16, v88
    v_add_f32 v17, v17, v89
    v_mfma_f32_16x16x32_bf16 v[232:235], v[124:127], v[108:111], 0
    v_cvt_pk_bf16_f32 v104, v88, v89
    v_exp_f32 v92, v92
    v_mfma_f32_16x16x32_bf16 a[116:119], v[128:131], v[108:111], 0
    v_exp_f32 v93, v93
    v_add_f32 v16, v16, v90
    v_add_f32 v17, v17, v91
    v_mfma_f32_16x16x32_bf16 a[144:147], v[132:135], v[108:111], 0
    v_cvt_pk_bf16_f32 v105, v90, v91
    v_exp_f32 v94, v94
    v_mfma_f32_16x16x32_bf16 a[172:175], v[136:139], v[108:111], 0
    v_exp_f32 v95, v95
    v_add_f32 v16, v16, v92
    v_add_f32 v17, v17, v93
    v_mfma_f32_16x16x32_bf16 a[200:203], v[140:143], v[108:111], 0
    v_cvt_pk_bf16_f32 v106, v92, v93
    v_add_f32 v16, v16, v94
    v_add_f32 v17, v17, v95
    v_cvt_pk_bf16_f32 v107, v94, v95
    v_mfma_f32_16x16x32_bf16 v[88:91], v[56:59], a[64:67], 0
    v_max3_f32 v2, v96, v97, v18
    v_max3_f32 v3, v98, v99, v100
    v_max3_f32 v2, v101, v102, v2
    v_mfma_f32_16x16x32_bf16 v[88:91], v[60:63], a[68:71], v[88:91]
    v_max3_f32 v2, v103, v2, v3
    v_mov_b32 v3, v2
    s_nop 1
    v_permlane16_swap_b32 v2, v3
    v_mfma_f32_16x16x32_bf16 v[88:91], v[64:67], a[72:75], v[88:91]
    s_nop 1
    v_max_f32 v2, v2, v3
    v_mov_b32 v3, v2
    v_mfma_f32_16x16x32_bf16 v[88:91], v[68:71], a[76:79], v[88:91]
    s_nop 1
    v_permlane32_swap_b32 v2, v3
    s_nop 1
    v_max_f32 v2, v2, v3
    v_mfma_f32_16x16x32_bf16 v[92:95], v[72:75], a[64:67], 0
    v_mov_b32 v18, 0
    v_mov_b32 v19, 0
    v_sub_f32 v96, v96, v2
    v_mfma_f32_16x16x32_bf16 v[92:95], v[76:79], a[68:71], v[92:95]
    v_sub_f32 v97, v97, v2
    v_sub_f32 v98, v98, v2
    v_sub_f32 v99, v99, v2
    v_sub_f32 v100, v100, v2
    v_mfma_f32_16x16x32_bf16 v[92:95], v[80:83], a[72:75], v[92:95]
    v_sub_f32 v101, v101, v2
    v_sub_f32 v102, v102, v2
    v_sub_f32 v103, v103, v2
    v_mfma_f32_16x16x32_bf16 v[92:95], v[84:87], a[76:79], v[92:95]
    v_sub_f32 v40, 0, v2
    v_sub_f32 v41, 0, v2
    v_sub_f32 v42, 0, v2
    v_sub_f32 v43, 0, v2
    v_mfma_f32_16x16x32_bf16 v[152:155], v[112:115], v[104:107], 0
    v_exp_f32 v96, v96
    v_mfma_f32_16x16x32_bf16 v[180:183], v[116:119], v[104:107], 0
    v_exp_f32 v97, v97
    v_exp_f32 v98, v98
    v_mfma_f32_16x16x32_bf16 v[208:211], v[120:123], v[104:107], 0
    v_exp_f32 v99, v99
    v_add_f32 v18, v18, v96
    v_add_f32 v19, v19, v97
    v_mfma_f32_16x16x32_bf16 v[236:239], v[124:127], v[104:107], 0
    v_cvt_pk_bf16_f32 v108, v96, v97
    v_exp_f32 v100, v100
    v_mfma_f32_16x16x32_bf16 a[120:123], v[128:131], v[104:107], 0
    v_exp_f32 v101, v101
    v_add_f32 v18, v18, v98
    v_add_f32 v19, v19, v99
    v_mfma_f32_16x16x32_bf16 a[148:151], v[132:135], v[104:107], 0
    v_cvt_pk_bf16_f32 v109, v98, v99
    v_exp_f32 v102, v102
    v_mfma_f32_16x16x32_bf16 a[176:179], v[136:139], v[104:107], 0
    v_exp_f32 v103, v103
    v_add_f32 v18, v18, v100
    v_add_f32 v19, v19, v101
    v_mfma_f32_16x16x32_bf16 a[204:207], v[140:143], v[104:107], 0
    v_cvt_pk_bf16_f32 v110, v100, v101
    v_add_f32 v18, v18, v102
    v_add_f32 v19, v19, v103
    v_cvt_pk_bf16_f32 v111, v102, v103
    v_mfma_f32_16x16x32_bf16 v[96:99], v[56:59], a[80:83], 0
    v_max3_f32 v2, v88, v89, v20
    v_max3_f32 v3, v90, v91, v92
    v_max3_f32 v2, v93, v94, v2
    v_mfma_f32_16x16x32_bf16 v[96:99], v[60:63], a[84:87], v[96:99]
    v_max3_f32 v2, v95, v2, v3
    v_mov_b32 v3, v2
    s_nop 1
    v_permlane16_swap_b32 v2, v3
    v_mfma_f32_16x16x32_bf16 v[96:99], v[64:67], a[88:91], v[96:99]
    s_nop 1
    v_max_f32 v2, v2, v3
    v_mov_b32 v3, v2
    v_mfma_f32_16x16x32_bf16 v[96:99], v[68:71], a[92:95], v[96:99]
    s_nop 1
    v_permlane32_swap_b32 v2, v3
    s_nop 1
    v_max_f32 v2, v2, v3
    v_mfma_f32_16x16x32_bf16 v[100:103], v[72:75], a[80:83], 0
    v_mov_b32 v20, 0
    v_mov_b32 v21, 0
    v_sub_f32 v88, v88, v2
    v_mfma_f32_16x16x32_bf16 v[100:103], v[76:79], a[84:87], v[100:103]
    v_sub_f32 v89, v89, v2
    v_sub_f32 v90, v90, v2
    v_sub_f32 v91, v91, v2
    v_sub_f32 v92, v92, v2
    v_mfma_f32_16x16x32_bf16 v[100:103], v[80:83], a[88:91], v[100:103]
    v_sub_f32 v93, v93, v2
    v_sub_f32 v94, v94, v2
    v_sub_f32 v95, v95, v2
    v_mfma_f32_16x16x32_bf16 v[100:103], v[84:87], a[92:95], v[100:103]
    v_sub_f32 v44, 0, v2
    v_sub_f32 v45, 0, v2
    v_sub_f32 v46, 0, v2
    v_sub_f32 v47, 0, v2
    v_mfma_f32_16x16x32_bf16 v[156:159], v[112:115], v[108:111], 0
    v_exp_f32 v88, v88
    v_mfma_f32_16x16x32_bf16 v[184:187], v[116:119], v[108:111], 0
    v_exp_f32 v89, v89
    v_exp_f32 v90, v90
    v_mfma_f32_16x16x32_bf16 v[212:215], v[120:123], v[108:111], 0
    v_exp_f32 v91, v91
    v_add_f32 v20, v20, v88
    v_add_f32 v21, v21, v89
    v_mfma_f32_16x16x32_bf16 v[240:243], v[124:127], v[108:111], 0
    v_cvt_pk_bf16_f32 v104, v88, v89
    v_exp_f32 v92, v92
    v_mfma_f32_16x16x32_bf16 a[124:127], v[128:131], v[108:111], 0
    v_exp_f32 v93, v93
    v_add_f32 v20, v20, v90
    v_add_f32 v21, v21, v91
    v_mfma_f32_16x16x32_bf16 a[152:155], v[132:135], v[108:111], 0
    v_cvt_pk_bf16_f32 v105, v90, v91
    v_exp_f32 v94, v94
    v_mfma_f32_16x16x32_bf16 a[180:183], v[136:139], v[108:111], 0
    v_exp_f32 v95, v95
    v_add_f32 v20, v20, v92
    v_add_f32 v21, v21, v93
    v_mfma_f32_16x16x32_bf16 a[208:211], v[140:143], v[108:111], 0
    v_cvt_pk_bf16_f32 v106, v92, v93
    v_add_f32 v20, v20, v94
    v_add_f32 v21, v21, v95
    v_cvt_pk_bf16_f32 v107, v94, v95
    s_cmp_eq_u32 s68, 0
    s_cbranch_scc0 L_bw1_3150
    s_waitcnt vmcnt(16) lgkmcnt(0)
L_bw2_3150:
    s_barrier
    s_cmp_le_u32 s21, s27
    s_cbranch_scc1 L_at_nofb_3155
    s_sub_u32 s28, s21, 1
    s_cmp_eq_u32 s28, s23
    s_cbranch_scc1 L_at_nofb_3155
    s_lshl_b32 s29, s28, 2
    s_add_u32 s29, s29, 76000
    v_mov_b32 v4, s29
    ds_read_b32 v4, v4
    s_waitcnt lgkmcnt(0)
    v_readfirstlane_b32 s29, v4
    s_nop 3
    s_cmp_lg_u32 s29, 0
    s_cbranch_scc1 L_at_fallback
L_at_nofb_3155:
    v_mfma_f32_16x16x32_bf16 v[88:91], v[56:59], a[96:99], 0
    ds_read_b128 v[56:59], v8 offset:8448
    v_max3_f32 v2, v96, v97, v22
    v_max3_f32 v3, v98, v99, v100
    v_max3_f32 v2, v101, v102, v2
    v_mfma_f32_16x16x32_bf16 v[88:91], v[60:63], a[100:103], v[88:91]
    ds_read_b128 v[60:63], v8 offset:8512
    v_max3_f32 v2, v103, v2, v3
    v_mov_b32 v3, v2
    s_nop 1
    v_permlane16_swap_b32 v2, v3
    v_mfma_f32_16x16x32_bf16 v[88:91], v[64:67], a[104:107], v[88:91]
    ds_read_b128 v[64:67], v8 offset:8576
    s_nop 1
    v_max_f32 v2, v2, v3
    v_mov_b32 v3, v2
    v_mfma_f32_16x16x32_bf16 v[88:91], v[68:71], a[108:111], v[88:91]
    ds_read_b128 v[68:71], v8 offset:8640
    s_nop 1
    v_permlane32_swap_b32 v2, v3
    s_nop 1
    v_max_f32 v2, v2, v3
    v_mfma_f32_16x16x32_bf16 v[92:95], v[72:75], a[96:99], 0
    ds_read_b128 v[72:75], v8 offset:8960
    v_mov_b32 v22, 0
    v_mov_b32 v23, 0
    v_sub_f32 v96, v96, v2
    v_mfma_f32_16x16x32_bf16 v[92:95], v[76:79], a[100:103], v[92:95]
    ds_read_b128 v[76:79], v8 offset:9024
    v_sub_f32 v97, v97, v2
    v_sub_f32 v98, v98, v2
    v_sub_f32 v99, v99, v2
    v_sub_f32 v100, v100, v2
    v_mfma_f32_16x16x32_bf16 v[92:95], v[80:83], a[104:107], v[92:95]
    ds_read_b128 v[80:83], v8 offset:9088
    v_sub_f32 v101, v101, v2
    v_sub_f32 v102, v102, v2
    v_sub_f32 v103, v103, v2
    v_mfma_f32_16x16x32_bf16 v[92:95], v[84:87], a[108:111], v[92:95]
    ds_read_b128 v[84:87], v8 offset:9152
    v_sub_f32 v48, 0, v2
    v_sub_f32 v49, 0, v2
    v_sub_f32 v50, 0, v2
    v_sub_f32 v51, 0, v2
    v_mfma_f32_16x16x32_bf16 v[160:163], v[112:115], v[104:107], 0
    v_exp_f32 v96, v96
    v_mfma_f32_16x16x32_bf16 v[188:191], v[116:119], v[104:107], 0
    v_exp_f32 v97, v97
    v_exp_f32 v98, v98
    v_mfma_f32_16x16x32_bf16 v[216:219], v[120:123], v[104:107], 0
    v_exp_f32 v99, v99
    v_add_f32 v22, v22, v96
    v_add_f32 v23, v23, v97
    v_mfma_f32_16x16x32_bf16 v[244:247], v[124:127], v[104:107], 0
    v_cvt_pk_bf16_f32 v108, v96, v97
    v_exp_f32 v100, v100
    v_mfma_f32_16x16x32_bf16 a[128:131], v[128:131], v[104:107], 0
    v_exp_f32 v101, v101
    v_add_f32 v22, v22, v98
    v_add_f32 v23, v23, v99
    v_mfma_f32_16x16x32_bf16 a[156:159], v[132:135], v[104:107], 0
    v_cvt_pk_bf16_f32 v109, v98, v99
    v_exp_f32 v102, v102
    v_mfma_f32_16x16x32_bf16 a[184:187], v[136:139], v[104:107], 0
    v_exp_f32 v103, v103
    v_add_f32 v22, v22, v100
    v_add_f32 v23, v23, v101
    v_mfma_f32_16x16x32_bf16 a[212:215], v[140:143], v[104:107], 0
    v_cvt_pk_bf16_f32 v110, v100, v101
    v_add_f32 v22, v22, v102
    v_add_f32 v23, v23, v103
    v_cvt_pk_bf16_f32 v111, v102, v103
    s_waitcnt lgkmcnt(0)
    v_mfma_f32_16x16x32_bf16 v[96:99], v[56:59], a[0:3], v[28:31]
    v_max3_f32 v2, v88, v89, v24
    v_max3_f32 v3, v90, v91, v92
    v_max3_f32 v2, v93, v94, v2
    v_mfma_f32_16x16x32_bf16 v[96:99], v[60:63], a[4:7], v[96:99]
    v_max3_f32 v2, v95, v2, v3
    v_mov_b32 v3, v2
    s_nop 1
    v_permlane16_swap_b32 v2, v3
    v_mfma_f32_16x16x32_bf16 v[96:99], v[64:67], a[8:11], v[96:99]
    s_nop 1
    v_max_f32 v2, v2, v3
    v_mov_b32 v3, v2
    v_mfma_f32_16x16x32_bf16 v[96:99], v[68:71], a[12:15], v[96:99]
    s_nop 1
    v_permlane32_swap_b32 v2, v3
    s_nop 1
    v_max_f32 v2, v2, v3
    v_mfma_f32_16x16x32_bf16 v[100:103], v[72:75], a[0:3], v[28:31]
    v_mov_b32 v24, 0
    v_mov_b32 v25, 0
    v_sub_f32 v88, v88, v2
    v_mfma_f32_16x16x32_bf16 v[100:103], v[76:79], a[4:7], v[100:103]
    v_sub_f32 v89, v89, v2
    v_sub_f32 v90, v90, v2
    v_sub_f32 v91, v91, v2
    v_sub_f32 v92, v92, v2
    v_mfma_f32_16x16x32_bf16 v[100:103], v[80:83], a[8:11], v[100:103]
    v_sub_f32 v93, v93, v2
    v_sub_f32 v94, v94, v2
    v_sub_f32 v95, v95, v2
    v_mfma_f32_16x16x32_bf16 v[100:103], v[84:87], a[12:15], v[100:103]
    v_sub_f32 v52, 0, v2
    v_sub_f32 v53, 0, v2
    v_sub_f32 v54, 0, v2
    v_sub_f32 v55, 0, v2
    v_mfma_f32_16x16x32_bf16 v[164:167], v[112:115], v[108:111], 0
    v_exp_f32 v88, v88
    v_mfma_f32_16x16x32_bf16 v[192:195], v[116:119], v[108:111], 0
    v_exp_f32 v89, v89
    v_exp_f32 v90, v90
    v_mfma_f32_16x16x32_bf16 v[220:223], v[120:123], v[108:111], 0
    v_exp_f32 v91, v91
    v_add_f32 v24, v24, v88
    v_add_f32 v25, v25, v89
    v_mfma_f32_16x16x32_bf16 v[248:251], v[124:127], v[108:111], 0
    v_cvt_pk_bf16_f32 v104, v88, v89
    v_exp_f32 v92, v92
    v_mfma_f32_16x16x32_bf16 a[132:135], v[128:131], v[108:111], 0
    v_exp_f32 v93, v93
    v_add_f32 v24, v24, v90
    v_add_f32 v25, v25, v91
    v_mfma_f32_16x16x32_bf16 a[160:163], v[132:135], v[108:111], 0
    v_cvt_pk_bf16_f32 v105, v90, v91
    v_exp_f32 v94, v94
    v_mfma_f32_16x16x32_bf16 a[188:191], v[136:139], v[108:111], 0
    v_exp_f32 v95, v95
    v_add_f32 v24, v24, v92
    v_add_f32 v25, v25, v93
    v_mfma_f32_16x16x32_bf16 a[216:219], v[140:143], v[108:111], 0
    v_cvt_pk_bf16_f32 v106, v92, v93
    v_add_f32 v24, v24, v94
    v_add_f32 v25, v25, v95
    v_cvt_pk_bf16_f32 v107, v94, v95
    s_mov_b32 s22, 0
L_at_loop:
    v_mfma_f32_16x16x32_bf16 v[88:91], v[56:59], a[16:19], v[32:35]
    v_mfma_f32_16x16x32_bf16 v[88:91], v[60:63], a[20:23], v[88:91]
    v_exp_f32 v96, v96
    v_mfma_f32_16x16x32_bf16 v[88:91], v[64:67], a[24:27], v[88:91]
    v_exp_f32 v97, v97
    v_mfma_f32_16x16x32_bf16 v[88:91], v[68:71], a[28:31], v[88:91]
    v_exp_f32 v98, v98
    v_mfma_f32_16x16x32_bf16 v[92:95], v[72:75], a[16:19], v[32:35]
    v_exp_f32 v99, v99
    v_mfma_f32_16x16x32_bf16 v[92:95], v[76:79], a[20:23], v[92:95]
    v_add_f32 v12, v12, v96
    v_add_f32 v13, v13, v97
    v_mfma_f32_16x16x32_bf16 v[92:95], v[80:83], a[24:27], v[92:95]
    v_cvt_pk_bf16_f32 v108, v96, v97
    v_mfma_f32_16x16x32_bf16 v[92:95], v[84:87], a[28:31], v[92:95]
    v_exp_f32 v100, v100
    v_mfma_f32_16x16x32_bf16 v[168:171], v[112:115], v[104:107], v[168:171]
    ds_read_b64_tr_b16 v[112:113], v9 offset:8448
    ds_read_b64_tr_b16 v[114:115], v9 offset:8960
    v_exp_f32 v101, v101
    v_mfma_f32_16x16x32_bf16 v[196:199], v[116:119], v[104:107], v[196:199]
    ds_read_b64_tr_b16 v[116:117], v9 offset:8480
    ds_read_b64_tr_b16 v[118:119], v9 offset:8992
    v_add_f32 v12, v12, v98
    v_add_f32 v13, v13, v99
    v_mfma_f32_16x16x32_bf16 v[224:227], v[120:123], v[104:107], v[224:227]
    ds_read_b64_tr_b16 v[120:121], v9 offset:8512
    ds_read_b64_tr_b16 v[122:123], v9 offset:9024
    v_cvt_pk_bf16_f32 v109, v98, v99
    v_mfma_f32_16x16x32_bf16 v[252:255], v[124:127], v[104:107], v[252:255]
    ds_read_b64_tr_b16 v[124:125], v9 offset:8544
    ds_read_b64_tr_b16 v[126:127], v9 offset:9056
    v_exp_f32 v102, v102
    v_mfma_f32_16x16x32_bf16 a[136:139], v[128:131], v[104:107], a[136:139]
    ds_read_b64_tr_b16 v[128:129], v9 offset:8576
    ds_read_b64_tr_b16 v[130:131], v9 offset:9088
    v_exp_f32 v103, v103
    v_mfma_f32_16x16x32_bf16 a[164:167], v[132:135], v[104:107], a[164:167]
    ds_read_b64_tr_b16 v[132:133], v9 offset:8608
    ds_read_b64_tr_b16 v[134:135], v9 offset:9120
    v_add_f32 v12, v12, v100
    v_add_f32 v13, v13, v101
    v_mfma_f32_16x16x32_bf16 a[192:195], v[136:139], v[104:107], a[192:195]
    ds_read_b64_tr_b16 v[136:137], v9 offset:8640
    ds_read_b64_tr_b16 v[138:139], v9 offset:9152
    v_cvt_pk_bf16_f32 v110, v100, v101
    v_add_f32 v12, v12, v102
    v_mfma_f32_16x16x32_bf16 a[220:223], v[140:143], v[104:107], a[220:223]
    ds_read_b64_tr_b16 v[140:141], v9 offset:8672
    ds_read_b64_tr_b16 v[142:143], v9 offset:9184
    v_add_f32 v13, v13, v103
    v_cvt_pk_bf16_f32 v111, v102, v103
    v_mfma_f32_16x16x32_bf16 v[96:99], v[56:59], a[32:35], v[36:39]
    v_mfma_f32_16x16x32_bf16 v[96:99], v[60:63], a[36:39], v[96:99]
    s_add_u32 s29, s34, s100
    v_exp_f32 v88, v88
    v_mfma_f32_16x16x32_bf16 v[96:99], v[64:67], a[40:43], v[96:99]
    v_exp_f32 v89, v89
    v_mfma_f32_16x16x32_bf16 v[96:99], v[68:71], a[44:47], v[96:99]
    s_bfe_u32 s28, s29, 0x20003
    v_exp_f32 v90, v90
    v_mfma_f32_16x16x32_bf16 v[100:103], v[72:75], a[32:35], v[36:39]
    v_exp_f32 v91, v91
    v_mfma_f32_16x16x32_bf16 v[100:103], v[76:79], a[36:39], v[100:103]
    s_lshl_b32 s28, s28, 16
    v_add_f32 v14, v14, v88
    v_add_f32 v15, v15, v89
    v_mfma_f32_16x16x32_bf16 v[100:103], v[80:83], a[40:43], v[100:103]
    v_cvt_pk_bf16_f32 v104, v88, v89
    v_mfma_f32_16x16x32_bf16 v[100:103], v[84:87], a[44:47], v[100:103]
    v_exp_f32 v92, v92
    s_waitcnt lgkmcnt(0)
    v_mfma_f32_16x16x32_bf16 v[144:147], v[112:115], v[108:111], v[144:147]
    s_and_b32 s29, s29, 7
    v_exp_f32 v93, v93
    v_mfma_f32_16x16x32_bf16 v[172:175], v[116:119], v[108:111], v[172:175]
    v_add_f32 v14, v14, v90
    v_add_f32 v15, v15, v91
    v_mfma_f32_16x16x32_bf16 v[200:203], v[120:123], v[108:111], v[200:203]
    s_lshl_b32 s29, s29, 11
    v_cvt_pk_bf16_f32 v105, v90, v91
    v_mfma_f32_16x16x32_bf16 v[228:231], v[124:127], v[108:111], v[228:231]
    v_exp_f32 v94, v94
    v_mfma_f32_16x16x32_bf16 a[112:115], v[128:131], v[108:111], a[112:115]
    s_add_u32 s29, s28, s29
    v_exp_f32 v95, v95
    v_mfma_f32_16x16x32_bf16 a[140:143], v[132:135], v[108:111], a[140:143]
    v_add_f32 v14, v14, v92
    v_add_f32 v15, v15, v93
    v_mfma_f32_16x16x32_bf16 a[168:171], v[136:139], v[108:111], a[168:171]
    s_lshr_b32 s28, s34, 5
    v_cvt_pk_bf16_f32 v106, v92, v93
    v_add_f32 v14, v14, v94
    v_mfma_f32_16x16x32_bf16 a[196:199], v[140:143], v[108:111], a[196:199]
    v_add_f32 v15, v15, v95
    v_cvt_pk_bf16_f32 v107, v94, v95
    v_mfma_f32_16x16x32_bf16 v[88:91], v[56:59], a[48:51], v[40:43]
    v_mfma_f32_16x16x32_bf16 v[88:91], v[60:63], a[52:55], v[88:91]
    s_lshl_b32 s28, s28, 19
    v_exp_f32 v96, v96
    v_mfma_f32_16x16x32_bf16 v[88:91], v[64:67], a[56:59], v[88:91]
    v_exp_f32 v97, v97
    v_mfma_f32_16x16x32_bf16 v[88:91], v[68:71], a[60:63], v[88:91]
    s_add_u32 s49, s28, s29
    v_exp_f32 v98, v98
    v_mfma_f32_16x16x32_bf16 v[92:95], v[72:75], a[48:51], v[40:43]
    v_exp_f32 v99, v99
    v_mfma_f32_16x16x32_bf16 v[92:95], v[76:79], a[52:55], v[92:95]
    s_add_u32 m0, s33, 0
    v_add_f32 v16, v16, v96
    v_add_f32 v17, v17, v97
    v_mfma_f32_16x16x32_bf16 v[92:95], v[80:83], a[56:59], v[92:95]
    v_cvt_pk_bf16_f32 v108, v96, v97
    v_mfma_f32_16x16x32_bf16 v[92:95], v[84:87], a[60:63], v[92:95]
    v_exp_f32 v100, v100
    v_mfma_f32_16x16x32_bf16 v[148:151], v[112:115], v[104:107], v[148:151]
    s_add_u32 s34, s34, 1
    v_exp_f32 v101, v101
    v_mfma_f32_16x16x32_bf16 v[176:179], v[116:119], v[104:107], v[176:179]
    v_add_f32 v16, v16, v98
    v_add_f32 v17, v17, v99
    v_mfma_f32_16x16x32_bf16 v[204:207], v[120:123], v[104:107], v[204:207]
    buffer_load_dwordx4 v7, s[4:7], s49 offen offset:0 nt lds
    v_cvt_pk_bf16_f32 v109, v98, v99
    v_mfma_f32_16x16x32_bf16 v[232:235], v[124:127], v[104:107], v[232:235]
    v_exp_f32 v102, v102
    v_mfma_f32_16x16x32_bf16 a[116:119], v[128:131], v[104:107], a[116:119]
    s_add_u32 m0, m0, s96
    v_exp_f32 v103, v103
    v_mfma_f32_16x16x32_bf16 a[144:147], v[132:135], v[104:107], a[144:147]
    v_add_f32 v16, v16, v100
    v_add_f32 v17, v17, v101
    v_mfma_f32_16x16x32_bf16 a[172:175], v[136:139], v[104:107], a[172:175]
    buffer_load_dwordx4 v7, s[4:7], s49 offen offset:256 nt lds
    v_cvt_pk_bf16_f32 v110, v100, v101
    v_add_f32 v16, v16, v102
    v_mfma_f32_16x16x32_bf16 a[200:203], v[140:143], v[104:107], a[200:203]
    v_add_f32 v17, v17, v103
    v_cvt_pk_bf16_f32 v111, v102, v103
    v_mfma_f32_16x16x32_bf16 v[96:99], v[56:59], a[64:67], v[44:47]
    v_mfma_f32_16x16x32_bf16 v[96:99], v[60:63], a[68:71], v[96:99]
    s_add_u32 m0, m0, s97
    v_exp_f32 v88, v88
    v_mfma_f32_16x16x32_bf16 v[96:99], v[64:67], a[72:75], v[96:99]
    v_exp_f32 v89, v89
    v_mfma_f32_16x16x32_bf16 v[96:99], v[68:71], a[76:79], v[96:99]
    buffer_load_dwordx4 v7, s[4:7], s49 offen offset:512 nt lds
    v_exp_f32 v90, v90
    v_mfma_f32_16x16x32_bf16 v[100:103], v[72:75], a[64:67], v[44:47]
    v_exp_f32 v91, v91
    v_mfma_f32_16x16x32_bf16 v[100:103], v[76:79], a[68:71], v[100:103]
    s_add_u32 m0, m0, s96
    v_add_f32 v18, v18, v88
    v_add_f32 v19, v19, v89
    v_mfma_f32_16x16x32_bf16 v[100:103], v[80:83], a[72:75], v[100:103]
    v_cvt_pk_bf16_f32 v104, v88, v89
    v_mfma_f32_16x16x32_bf16 v[100:103], v[84:87], a[76:79], v[100:103]
    v_exp_f32 v92, v92
    v_mfma_f32_16x16x32_bf16 v[152:155], v[112:115], v[108:111], v[152:155]
    buffer_load_dwordx4 v7, s[4:7], s49 offen offset:768 nt lds
    v_exp_f32 v93, v93
    v_mfma_f32_16x16x32_bf16 v[180:183], v[116:119], v[108:111], v[180:183]
    v_add_f32 v18, v18, v90
    v_add_f32 v19, v19, v91
    v_mfma_f32_16x16x32_bf16 v[208:211], v[120:123], v[108:111], v[208:211]
    s_add_u32 m0, m0, s97
    v_cvt_pk_bf16_f32 v105, v90, v91
    v_mfma_f32_16x16x32_bf16 v[236:239], v[124:127], v[108:111], v[236:239]
    v_exp_f32 v94, v94
    v_mfma_f32_16x16x32_bf16 a[120:123], v[128:131], v[108:111], a[120:123]
    buffer_load_dwordx4 v7, s[4:7], s49 offen offset:1024 nt lds
    v_exp_f32 v95, v95
    v_mfma_f32_16x16x32_bf16 a[148:151], v[132:135], v[108:111], a[148:151]
    v_add_f32 v18, v18, v92
    v_add_f32 v19, v19, v93
    v_mfma_f32_16x16x32_bf16 a[176:179], v[136:139], v[108:111], a[176:179]
    s_add_u32 m0, m0, s96
    v_cvt_pk_bf16_f32 v106, v92, v93
    v_add_f32 v18, v18, v94
    v_mfma_f32_16x16x32_bf16 a[204:207], v[140:143], v[108:111], a[204:207]
    v_add_f32 v19, v19, v95
    v_cvt_pk_bf16_f32 v107, v94, v95
    v_mfma_f32_16x16x32_bf16 v[88:91], v[56:59], a[80:83], v[48:51]
    v_mfma_f32_16x16x32_bf16 v[88:91], v[60:63], a[84:87], v[88:91]
    buffer_load_dwordx4 v7, s[4:7], s49 offen offset:1280 nt lds
    v_exp_f32 v96, v96
    v_mfma_f32_16x16x32_bf16 v[88:91], v[64:67], a[88:91], v[88:91]
    v_exp_f32 v97, v97
    v_mfma_f32_16x16x32_bf16 v[88:91], v[68:71], a[92:95], v[88:91]
    s_add_u32 m0, m0, s97
    v_exp_f32 v98, v98
    v_mfma_f32_16x16x32_bf16 v[92:95], v[72:75], a[80:83], v[48:51]
    v_exp_f32 v99, v99
    v_mfma_f32_16x16x32_bf16 v[92:95], v[76:79], a[84:87], v[92:95]
    buffer_load_dwordx4 v7, s[4:7], s49 offen offset:1536 nt lds
    v_add_f32 v20, v20, v96
    v_add_f32 v21, v21, v97
    v_mfma_f32_16x16x32_bf16 v[92:95], v[80:83], a[88:91], v[92:95]
    v_cvt_pk_bf16_f32 v108, v96, v97
    v_mfma_f32_16x16x32_bf16 v[92:95], v[84:87], a[92:95], v[92:95]
    v_exp_f32 v100, v100
    v_mfma_f32_16x16x32_bf16 v[156:159], v[112:115], v[104:107], v[156:159]
    s_add_u32 m0, m0, s96
    v_exp_f32 v101, v101
    v_mfma_f32_16x16x32_bf16 v[184:187], v[116:119], v[104:107], v[184:187]
    v_add_f32 v20, v20, v98
    v_add_f32 v21, v21, v99
    v_mfma_f32_16x16x32_bf16 v[212:215], v[120:123], v[104:107], v[212:215]
    buffer_load_dwordx4 v7, s[4:7], s49 offen offset:1792 nt lds
    v_cvt_pk_bf16_f32 v109, v98, v99
    v_mfma_f32_16x16x32_bf16 v[240:243], v[124:127], v[104:107], v[240:243]
    v_exp_f32 v102, v102
    v_mfma_f32_16x16x32_bf16 a[124:127], v[128:131], v[104:107], a[124:127]
    v_exp_f32 v103, v103
    v_mfma_f32_16x16x32_bf16 a[152:155], v[132:135], v[104:107], a[152:155]
    v_add_f32 v20, v20, v100
    v_add_f32 v21, v21, v101
    v_mfma_f32_16x16x32_bf16 a[180:183], v[136:139], v[104:107], a[180:183]
    v_cvt_pk_bf16_f32 v110, v100, v101
    v_add_f32 v20, v20, v102
    v_mfma_f32_16x16x32_bf16 a[208:211], v[140:143], v[104:107], a[208:211]
    v_add_f32 v21, v21, v103
    v_cvt_pk_bf16_f32 v111, v102, v103
    s_cmp_eq_u32 s68, 0
    s_cbranch_scc0 L_bw1_3532
    s_waitcnt vmcnt(16) lgkmcnt(0)
L_bw2_3532:
    s_barrier
    v_mfma_f32_16x16x32_bf16 v[96:99], v[56:59], a[96:99], v[52:55]
    ds_read_b128 v[56:59], v8 offset:16896
    v_mfma_f32_16x16x32_bf16 v[96:99], v[60:63], a[100:103], v[96:99]
    ds_read_b128 v[60:63], v8 offset:16960
    v_exp_f32 v88, v88
    v_mfma_f32_16x16x32_bf16 v[96:99], v[64:67], a[104:107], v[96:99]
    ds_read_b128 v[64:67], v8 offset:17024
    v_exp_f32 v89, v89
    v_mfma_f32_16x16x32_bf16 v[96:99], v[68:71], a[108:111], v[96:99]
    ds_read_b128 v[68:71], v8 offset:17088
    v_exp_f32 v90, v90
    v_mfma_f32_16x16x32_bf16 v[100:103], v[72:75], a[96:99], v[52:55]
    ds_read_b128 v[72:75], v8 offset:17408
    v_exp_f32 v91, v91
    v_mfma_f32_16x16x32_bf16 v[100:103], v[76:79], a[100:103], v[100:103]
    ds_read_b128 v[76:79], v8 offset:17472
    v_add_f32 v22, v22, v88
    v_add_f32 v23, v23, v89
    v_mfma_f32_16x16x32_bf16 v[100:103], v[80:83], a[104:107], v[100:103]
    ds_read_b128 v[80:83], v8 offset:17536
    v_cvt_pk_bf16_f32 v104, v88, v89
    v_mfma_f32_16x16x32_bf16 v[100:103], v[84:87], a[108:111], v[100:103]
    ds_read_b128 v[84:87], v8 offset:17600
    v_exp_f32 v92, v92
    v_mfma_f32_16x16x32_bf16 v[160:163], v[112:115], v[108:111], v[160:163]
    v_exp_f32 v93, v93
    v_mfma_f32_16x16x32_bf16 v[188:191], v[116:119], v[108:111], v[188:191]
    v_add_f32 v22, v22, v90
    v_add_f32 v23, v23, v91
    v_mfma_f32_16x16x32_bf16 v[216:219], v[120:123], v[108:111], v[216:219]
    v_cvt_pk_bf16_f32 v105, v90, v91
    v_mfma_f32_16x16x32_bf16 v[244:247], v[124:127], v[108:111], v[244:247]
    v_exp_f32 v94, v94
    v_mfma_f32_16x16x32_bf16 a[128:131], v[128:131], v[108:111], a[128:131]
    v_exp_f32 v95, v95
    v_mfma_f32_16x16x32_bf16 a[156:159], v[132:135], v[108:111], a[156:159]
    v_add_f32 v22, v22, v92
    v_add_f32 v23, v23, v93
    v_mfma_f32_16x16x32_bf16 a[184:187], v[136:139], v[108:111], a[184:187]
    v_cvt_pk_bf16_f32 v106, v92, v93
    v_add_f32 v22, v22, v94
    v_mfma_f32_16x16x32_bf16 a[212:215], v[140:143], v[108:111], a[212:215]
    v_add_f32 v23, v23, v95
    v_cvt_pk_bf16_f32 v107, v94, v95
    s_waitcnt lgkmcnt(0)
    v_mfma_f32_16x16x32_bf16 v[88:91], v[56:59], a[0:3], v[28:31]
    v_mfma_f32_16x16x32_bf16 v[88:91], v[60:63], a[4:7], v[88:91]
    v_exp_f32 v96, v96
    v_mfma_f32_16x16x32_bf16 v[88:91], v[64:67], a[8:11], v[88:91]
    v_exp_f32 v97, v97
    v_mfma_f32_16x16x32_bf16 v[88:91], v[68:71], a[12:15], v[88:91]
    v_exp_f32 v98, v98
    v_mfma_f32_16x16x32_bf16 v[92:95], v[72:75], a[0:3], v[28:31]
    v_exp_f32 v99, v99
    v_mfma_f32_16x16x32_bf16 v[92:95], v[76:79], a[4:7], v[92:95]
    v_add_f32 v24, v24, v96
    v_add_f32 v25, v25, v97
    v_mfma_f32_16x16x32_bf16 v[92:95], v[80:83], a[8:11], v[92:95]
    v_cvt_pk_bf16_f32 v108, v96, v97
    v_mfma_f32_16x16x32_bf16 v[92:95], v[84:87], a[12:15], v[92:95]
    v_exp_f32 v100, v100
    v_mfma_f32_16x16x32_bf16 v[164:167], v[112:115], v[104:107], v[164:167]
    v_exp_f32 v101, v101
    v_mfma_f32_16x16x32_bf16 v[192:195], v[116:119], v[104:107], v[192:195]
    v_add_f32 v24, v24, v98
    v_add_f32 v25, v25, v99
    v_mfma_f32_16x16x32_bf16 v[220:223], v[120:123], v[104:107], v[220:223]
    v_cvt_pk_bf16_f32 v109, v98, v99
    v_mfma_f32_16x16x32_bf16 v[248:251], v[124:127], v[104:107], v[248:251]
    v_exp_f32 v102, v102
    v_mfma_f32_16x16x32_bf16 a[132:135], v[128:131], v[104:107], a[132:135]
    v_exp_f32 v103, v103
    v_mfma_f32_16x16x32_bf16 a[160:163], v[132:135], v[104:107], a[160:163]
    v_add_f32 v24, v24, v100
    v_add_f32 v25, v25, v101
    v_mfma_f32_16x16x32_bf16 a[188:191], v[136:139], v[104:107], a[188:191]
    v_cvt_pk_bf16_f32 v110, v100, v101
    v_add_f32 v24, v24, v102
    v_mfma_f32_16x16x32_bf16 a[216:219], v[140:143], v[104:107], a[216:219]
    v_add_f32 v25, v25, v103
    v_cvt_pk_bf16_f32 v111, v102, v103
    v_mfma_f32_16x16x32_bf16 v[96:99], v[56:59], a[16:19], v[32:35]
    v_mfma_f32_16x16x32_bf16 v[96:99], v[60:63], a[20:23], v[96:99]
    v_exp_f32 v88, v88
    v_mfma_f32_16x16x32_bf16 v[96:99], v[64:67], a[24:27], v[96:99]
    v_exp_f32 v89, v89
    v_mfma_f32_16x16x32_bf16 v[96:99], v[68:71], a[28:31], v[96:99]
    v_exp_f32 v90, v90
    v_mfma_f32_16x16x32_bf16 v[100:103], v[72:75], a[16:19], v[32:35]
    v_exp_f32 v91, v91
    v_mfma_f32_16x16x32_bf16 v[100:103], v[76:79], a[20:23], v[100:103]
    v_add_f32 v12, v12, v88
    v_add_f32 v13, v13, v89
    v_mfma_f32_16x16x32_bf16 v[100:103], v[80:83], a[24:27], v[100:103]
    v_cvt_pk_bf16_f32 v104, v88, v89
    v_mfma_f32_16x16x32_bf16 v[100:103], v[84:87], a[28:31], v[100:103]
    v_exp_f32 v92, v92
    v_mfma_f32_16x16x32_bf16 v[168:171], v[112:115], v[108:111], v[168:171]
    ds_read_b64_tr_b16 v[112:113], v9 offset:16896
    ds_read_b64_tr_b16 v[114:115], v9 offset:17408
    v_exp_f32 v93, v93
    v_mfma_f32_16x16x32_bf16 v[196:199], v[116:119], v[108:111], v[196:199]
    ds_read_b64_tr_b16 v[116:117], v9 offset:16928
    ds_read_b64_tr_b16 v[118:119], v9 offset:17440
    v_add_f32 v12, v12, v90
    v_add_f32 v13, v13, v91
    v_mfma_f32_16x16x32_bf16 v[224:227], v[120:123], v[108:111], v[224:227]
    ds_read_b64_tr_b16 v[120:121], v9 offset:16960
    ds_read_b64_tr_b16 v[122:123], v9 offset:17472
    v_cvt_pk_bf16_f32 v105, v90, v91
    v_mfma_f32_16x16x32_bf16 v[252:255], v[124:127], v[108:111], v[252:255]
    ds_read_b64_tr_b16 v[124:125], v9 offset:16992
    ds_read_b64_tr_b16 v[126:127], v9 offset:17504
    v_exp_f32 v94, v94
    v_mfma_f32_16x16x32_bf16 a[136:139], v[128:131], v[108:111], a[136:139]
    ds_read_b64_tr_b16 v[128:129], v9 offset:17024
    ds_read_b64_tr_b16 v[130:131], v9 offset:17536
    v_exp_f32 v95, v95
    v_mfma_f32_16x16x32_bf16 a[164:167], v[132:135], v[108:111], a[164:167]
    ds_read_b64_tr_b16 v[132:133], v9 offset:17056
    ds_read_b64_tr_b16 v[134:135], v9 offset:17568
    v_add_f32 v12, v12, v92
    v_add_f32 v13, v13, v93
    v_mfma_f32_16x16x32_bf16 a[192:195], v[136:139], v[108:111], a[192:195]
    ds_read_b64_tr_b16 v[136:137], v9 offset:17088
    ds_read_b64_tr_b16 v[138:139], v9 offset:17600
    v_cvt_pk_bf16_f32 v106, v92, v93
    v_add_f32 v12, v12, v94
    v_mfma_f32_16x16x32_bf16 a[220:223], v[140:143], v[108:111], a[220:223]
    ds_read_b64_tr_b16 v[140:141], v9 offset:17120
    ds_read_b64_tr_b16 v[142:143], v9 offset:17632
    v_add_f32 v13, v13, v95
    v_cvt_pk_bf16_f32 v107, v94, v95
    v_mfma_f32_16x16x32_bf16 v[88:91], v[56:59], a[32:35], v[36:39]
    v_mfma_f32_16x16x32_bf16 v[88:91], v[60:63], a[36:39], v[88:91]
    s_add_u32 s29, s34, s100
    v_exp_f32 v96, v96
    v_mfma_f32_16x16x32_bf16 v[88:91], v[64:67], a[40:43], v[88:91]
    v_exp_f32 v97, v97
    v_mfma_f32_16x16x32_bf16 v[88:91], v[68:71], a[44:47], v[88:91]
    s_bfe_u32 s28, s29, 0x20003
    v_exp_f32 v98, v98
    v_mfma_f32_16x16x32_bf16 v[92:95], v[72:75], a[32:35], v[36:39]
    v_exp_f32 v99, v99
    v_mfma_f32_16x16x32_bf16 v[92:95], v[76:79], a[36:39], v[92:95]
    s_lshl_b32 s28, s28, 16
    v_add_f32 v14, v14, v96
    v_add_f32 v15, v15, v97
    v_mfma_f32_16x16x32_bf16 v[92:95], v[80:83], a[40:43], v[92:95]
    v_cvt_pk_bf16_f32 v108, v96, v97
    v_mfma_f32_16x16x32_bf16 v[92:95], v[84:87], a[44:47], v[92:95]
    v_exp_f32 v100, v100
    s_waitcnt lgkmcnt(0)
    v_mfma_f32_16x16x32_bf16 v[144:147], v[112:115], v[104:107], v[144:147]
    s_and_b32 s29, s29, 7
    v_exp_f32 v101, v101
    v_mfma_f32_16x16x32_bf16 v[172:175], v[116:119], v[104:107], v[172:175]
    v_add_f32 v14, v14, v98
    v_add_f32 v15, v15, v99
    v_mfma_f32_16x16x32_bf16 v[200:203], v[120:123], v[104:107], v[200:203]
    s_lshl_b32 s29, s29, 11
    v_cvt_pk_bf16_f32 v109, v98, v99
    v_mfma_f32_16x16x32_bf16 v[228:231], v[124:127], v[104:107], v[228:231]
    v_exp_f32 v102, v102
    v_mfma_f32_16x16x32_bf16 a[112:115], v[128:131], v[104:107], a[112:115]
    s_add_u32 s29, s28, s29
    v_exp_f32 v103, v103
    v_mfma_f32_16x16x32_bf16 a[140:143], v[132:135], v[104:107], a[140:143]
    v_add_f32 v14, v14, v100
    v_add_f32 v15, v15, v101
    v_mfma_f32_16x16x32_bf16 a[168:171], v[136:139], v[104:107], a[168:171]
    s_lshr_b32 s28, s34, 5
    v_cvt_pk_bf16_f32 v110, v100, v101
    v_add_f32 v14, v14, v102
    v_mfma_f32_16x16x32_bf16 a[196:199], v[140:143], v[104:107], a[196:199]
    v_add_f32 v15, v15, v103
    v_cvt_pk_bf16_f32 v111, v102, v103
    v_mfma_f32_16x16x32_bf16 v[96:99], v[56:59], a[48:51], v[40:43]
    v_mfma_f32_16x16x32_bf16 v[96:99], v[60:63], a[52:55], v[96:99]
    s_lshl_b32 s28, s28, 19
    v_exp_f32 v88, v88
    v_mfma_f32_16x16x32_bf16 v[96:99], v[64:67], a[56:59], v[96:99]
    v_exp_f32 v89, v89
    v_mfma_f32_16x16x32_bf16 v[96:99], v[68:71], a[60:63], v[96:99]
    s_add_u32 s49, s28, s29
    v_exp_f32 v90, v90
    v_mfma_f32_16x16x32_bf16 v[100:103], v[72:75], a[48:51], v[40:43]
    v_exp_f32 v91, v91
    v_mfma_f32_16x16x32_bf16 v[100:103], v[76:79], a[52:55], v[100:103]
    s_add_u32 m0, s33, 8448
    v_add_f32 v16, v16, v88
    v_add_f32 v17, v17, v89
    v_mfma_f32_16x16x32_bf16 v[100:103], v[80:83], a[56:59], v[100:103]
    v_cvt_pk_bf16_f32 v104, v88, v89
    v_mfma_f32_16x16x32_bf16 v[100:103], v[84:87], a[60:63], v[100:103]
    v_exp_f32 v92, v92
    v_mfma_f32_16x16x32_bf16 v[148:151], v[112:115], v[108:111], v[148:151]
    s_add_u32 s34, s34, 1
    v_exp_f32 v93, v93
    v_mfma_f32_16x16x32_bf16 v[176:179], v[116:119], v[108:111], v[176:179]
    v_add_f32 v16, v16, v90
    v_add_f32 v17, v17, v91
    v_mfma_f32_16x16x32_bf16 v[204:207], v[120:123], v[108:111], v[204:207]
    buffer_load_dwordx4 v7, s[4:7], s49 offen offset:0 nt lds
    v_cvt_pk_bf16_f32 v105, v90, v91
    v_mfma_f32_16x16x32_bf16 v[232:235], v[124:127], v[108:111], v[232:235]
    v_exp_f32 v94, v94
    v_mfma_f32_16x16x32_bf16 a[116:119], v[128:131], v[108:111], a[116:119]
    s_add_u32 m0, m0, s96
    v_exp_f32 v95, v95
    v_mfma_f32_16x16x32_bf16 a[144:147], v[132:135], v[108:111], a[144:147]
    v_add_f32 v16, v16, v92
    v_add_f32 v17, v17, v93
    v_mfma_f32_16x16x32_bf16 a[172:175], v[136:139], v[108:111], a[172:175]
    buffer_load_dwordx4 v7, s[4:7], s49 offen offset:256 nt lds
    v_cvt_pk_bf16_f32 v106, v92, v93
    v_add_f32 v16, v16, v94
    v_mfma_f32_16x16x32_bf16 a[200:203], v[140:143], v[108:111], a[200:203]
    v_add_f32 v17, v17, v95
    v_cvt_pk_bf16_f32 v107, v94, v95
    v_mfma_f32_16x16x32_bf16 v[88:91], v[56:59], a[64:67], v[44:47]
    v_mfma_f32_16x16x32_bf16 v[88:91], v[60:63], a[68:71], v[88:91]
    s_add_u32 m0, m0, s97
    v_exp_f32 v96, v96
    v_mfma_f32_16x16x32_bf16 v[88:91], v[64:67], a[72:75], v[88:91]
    v_exp_f32 v97, v97
    v_mfma_f32_16x16x32_bf16 v[88:91], v[68:71], a[76:79], v[88:91]
    buffer_load_dwordx4 v7, s[4:7], s49 offen offset:512 nt lds
    v_exp_f32 v98, v98
    v_mfma_f32_16x16x32_bf16 v[92:95], v[72:75], a[64:67], v[44:47]
    v_exp_f32 v99, v99
    v_mfma_f32_16x16x32_bf16 v[92:95], v[76:79], a[68:71], v[92:95]
    s_add_u32 m0, m0, s96
    v_add_f32 v18, v18, v96
    v_add_f32 v19, v19, v97
    v_mfma_f32_16x16x32_bf16 v[92:95], v[80:83], a[72:75], v[92:95]
    v_cvt_pk_bf16_f32 v108, v96, v97
    v_mfma_f32_16x16x32_bf16 v[92:95], v[84:87], a[76:79], v[92:95]
    v_exp_f32 v100, v100
    v_mfma_f32_16x16x32_bf16 v[152:155], v[112:115], v[104:107], v[152:155]
    buffer_load_dwordx4 v7, s[4:7], s49 offen offset:768 nt lds
    v_exp_f32 v101, v101
    v_mfma_f32_16x16x32_bf16 v[180:183], v[116:119], v[104:107], v[180:183]
    v_add_f32 v18, v18, v98
    v_add_f32 v19, v19, v99
    v_mfma_f32_16x16x32_bf16 v[208:211], v[120:123], v[104:107], v[208:211]
    s_add_u32 m0, m0, s97
    v_cvt_pk_bf16_f32 v109, v98, v99
    v_mfma_f32_16x16x32_bf16 v[236:239], v[124:127], v[104:107], v[236:239]
    v_exp_f32 v102, v102
    v_mfma_f32_16x16x32_bf16 a[120:123], v[128:131], v[104:107], a[120:123]
    buffer_load_dwordx4 v7, s[4:7], s49 offen offset:1024 nt lds
    v_exp_f32 v103, v103
    v_mfma_f32_16x16x32_bf16 a[148:151], v[132:135], v[104:107], a[148:151]
    v_add_f32 v18, v18, v100
    v_add_f32 v19, v19, v101
    v_mfma_f32_16x16x32_bf16 a[176:179], v[136:139], v[104:107], a[176:179]
    s_add_u32 m0, m0, s96
    v_cvt_pk_bf16_f32 v110, v100, v101
    v_add_f32 v18, v18, v102
    v_mfma_f32_16x16x32_bf16 a[204:207], v[140:143], v[104:107], a[204:207]
    v_add_f32 v19, v19, v103
    v_cvt_pk_bf16_f32 v111, v102, v103
    v_mfma_f32_16x16x32_bf16 v[96:99], v[56:59], a[80:83], v[48:51]
    v_mfma_f32_16x16x32_bf16 v[96:99], v[60:63], a[84:87], v[96:99]
    buffer_load_dwordx4 v7, s[4:7], s49 offen offset:1280 nt lds
    v_exp_f32 v88, v88
    v_mfma_f32_16x16x32_bf16 v[96:99], v[64:67], a[88:91], v[96:99]
    v_exp_f32 v89, v89
    v_mfma_f32_16x16x32_bf16 v[96:99], v[68:71], a[92:95], v[96:99]
    s_add_u32 m0, m0, s97
    v_exp_f32 v90, v90
    v_mfma_f32_16x16x32_bf16 v[100:103], v[72:75], a[80:83], v[48:51]
    v_exp_f32 v91, v91
    v_mfma_f32_16x16x32_bf16 v[100:103], v[76:79], a[84:87], v[100:103]
    buffer_load_dwordx4 v7, s[4:7], s49 offen offset:1536 nt lds
    v_add_f32 v20, v20, v88
    v_add_f32 v21, v21, v89
    v_mfma_f32_16x16x32_bf16 v[100:103], v[80:83], a[88:91], v[100:103]
    v_cvt_pk_bf16_f32 v104, v88, v89
    v_mfma_f32_16x16x32_bf16 v[100:103], v[84:87], a[92:95], v[100:103]
    v_exp_f32 v92, v92
    v_mfma_f32_16x16x32_bf16 v[156:159], v[112:115], v[108:111], v[156:159]
    s_add_u32 m0, m0, s96
    v_exp_f32 v93, v93
    v_mfma_f32_16x16x32_bf16 v[184:187], v[116:119], v[108:111], v[184:187]
    v_add_f32 v20, v20, v90
    v_add_f32 v21, v21, v91
    v_mfma_f32_16x16x32_bf16 v[212:215], v[120:123], v[108:111], v[212:215]
    buffer_load_dwordx4 v7, s[4:7], s49 offen offset:1792 nt lds
    v_cvt_pk_bf16_f32 v105, v90, v91
    v_mfma_f32_16x16x32_bf16 v[240:243], v[124:127], v[108:111], v[240:243]
    v_exp_f32 v94, v94
    v_mfma_f32_16x16x32_bf16 a[124:127], v[128:131], v[108:111], a[124:127]
    v_exp_f32 v95, v95
    v_mfma_f32_16x16x32_bf16 a[152:155], v[132:135], v[108:111], a[152:155]
    v_add_f32 v20, v20, v92
    v_add_f32 v21, v21, v93
    v_mfma_f32_16x16x32_bf16 a[180:183], v[136:139], v[108:111], a[180:183]
    v_cvt_pk_bf16_f32 v106, v92, v93
    v_add_f32 v20, v20, v94
    v_mfma_f32_16x16x32_bf16 a[208:211], v[140:143], v[108:111], a[208:211]
    v_add_f32 v21, v21, v95
    v_cvt_pk_bf16_f32 v107, v94, v95
    s_cmp_eq_u32 s68, 0
    s_cbranch_scc0 L_bw1_3841
    s_waitcnt vmcnt(16) lgkmcnt(0)
L_bw2_3841:
    s_barrier
    v_mfma_f32_16x16x32_bf16 v[88:91], v[56:59], a[96:99], v[52:55]
    ds_read_b128 v[56:59], v8 offset:25344
    v_mfma_f32_16x16x32_bf16 v[88:91], v[60:63], a[100:103], v[88:91]
    ds_read_b128 v[60:63], v8 offset:25408
    v_exp_f32 v96, v96
    v_mfma_f32_16x16x32_bf16 v[88:91], v[64:67], a[104:107], v[88:91]
    ds_read_b128 v[64:67], v8 offset:25472
    v_exp_f32 v97, v97
    v_mfma_f32_16x16x32_bf16 v[88:91], v[68:71], a[108:111], v[88:91]
    ds_read_b128 v[68:71], v8 offset:25536
    v_exp_f32 v98, v98
    v_mfma_f32_16x16x32_bf16 v[92:95], v[72:75], a[96:99], v[52:55]
    ds_read_b128 v[72:75], v8 offset:25856
    v_exp_f32 v99, v99
    v_mfma_f32_16x16x32_bf16 v[92:95], v[76:79], a[100:103], v[92:95]
    ds_read_b128 v[76:79], v8 offset:25920
    v_add_f32 v22, v22, v96
    v_add_f32 v23, v23, v97
    v_mfma_f32_16x16x32_bf16 v[92:95], v[80:83], a[104:107], v[92:95]
    ds_read_b128 v[80:83], v8 offset:25984
    v_cvt_pk_bf16_f32 v108, v96, v97
    v_mfma_f32_16x16x32_bf16 v[92:95], v[84:87], a[108:111], v[92:95]
    ds_read_b128 v[84:87], v8 offset:26048
    v_exp_f32 v100, v100
    v_mfma_f32_16x16x32_bf16 v[160:163], v[112:115], v[104:107], v[160:163]
    v_exp_f32 v101, v101
    v_mfma_f32_16x16x32_bf16 v[188:191], v[116:119], v[104:107], v[188:191]
    v_add_f32 v22, v22, v98
    v_add_f32 v23, v23, v99
    v_mfma_f32_16x16x32_bf16 v[216:219], v[120:123], v[104:107], v[216:219]
    v_cvt_pk_bf16_f32 v109, v98, v99
    v_mfma_f32_16x16x32_bf16 v[244:247], v[124:127], v[104:107], v[244:247]
    v_exp_f32 v102, v102
    v_mfma_f32_16x16x32_bf16 a[128:131], v[128:131], v[104:107], a[128:131]
    v_exp_f32 v103, v103
    v_mfma_f32_16x16x32_bf16 a[156:159], v[132:135], v[104:107], a[156:159]
    v_add_f32 v22, v22, v100
    v_add_f32 v23, v23, v101
    v_mfma_f32_16x16x32_bf16 a[184:187], v[136:139], v[104:107], a[184:187]
    v_cvt_pk_bf16_f32 v110, v100, v101
    v_add_f32 v22, v22, v102
    v_mfma_f32_16x16x32_bf16 a[212:215], v[140:143], v[104:107], a[212:215]
    v_add_f32 v23, v23, v103
    v_cvt_pk_bf16_f32 v111, v102, v103
    s_waitcnt lgkmcnt(0)
    v_mfma_f32_16x16x32_bf16 v[96:99], v[56:59], a[0:3], v[28:31]
    v_mfma_f32_16x16x32_bf16 v[96:99], v[60:63], a[4:7], v[96:99]
    v_exp_f32 v88, v88
    v_mfma_f32_16x16x32_bf16 v[96:99], v[64:67], a[8:11], v[96:99]
    v_exp_f32 v89, v89
    v_mfma_f32_16x16x32_bf16 v[96:99], v[68:71], a[12:15], v[96:99]
    v_exp_f32 v90, v90
    v_mfma_f32_16x16x32_bf16 v[100:103], v[72:75], a[0:3], v[28:31]
    v_exp_f32 v91, v91
    v_mfma_f32_16x16x32_bf16 v[100:103], v[76:79], a[4:7], v[100:103]
    v_add_f32 v24, v24, v88
    v_add_f32 v25, v25, v89
    v_mfma_f32_16x16x32_bf16 v[100:103], v[80:83], a[8:11], v[100:103]
    v_cvt_pk_bf16_f32 v104, v88, v89
    v_mfma_f32_16x16x32_bf16 v[100:103], v[84:87], a[12:15], v[100:103]
    v_exp_f32 v92, v92
    v_mfma_f32_16x16x32_bf16 v[164:167], v[112:115], v[108:111], v[164:167]
    v_exp_f32 v93, v93
    v_mfma_f32_16x16x32_bf16 v[192:195], v[116:119], v[108:111], v[192:195]
    v_add_f32 v24, v24, v90
    v_add_f32 v25, v25, v91
    v_mfma_f32_16x16x32_bf16 v[220:223], v[120:123], v[108:111], v[220:223]
    v_cvt_pk_bf16_f32 v105, v90, v91
    v_mfma_f32_16x16x32_bf16 v[248:251], v[124:127], v[108:111], v[248:251]
    v_exp_f32 v94, v94
    v_mfma_f32_16x16x32_bf16 a[132:135], v[128:131], v[108:111], a[132:135]
    v_exp_f32 v95, v95
    v_mfma_f32_16x16x32_bf16 a[160:163], v[132:135], v[108:111], a[160:163]
    v_add_f32 v24, v24, v92
    v_add_f32 v25, v25, v93
    v_mfma_f32_16x16x32_bf16 a[188:191], v[136:139], v[108:111], a[188:191]
    v_cvt_pk_bf16_f32 v106, v92, v93
    v_add_f32 v24, v24, v94
    v_mfma_f32_16x16x32_bf16 a[216:219], v[140:143], v[108:111], a[216:219]
    v_add_f32 v25, v25, v95
    v_cvt_pk_bf16_f32 v107, v94, v95
    v_mfma_f32_16x16x32_bf16 v[88:91], v[56:59], a[16:19], v[32:35]
    v_mfma_f32_16x16x32_bf16 v[88:91], v[60:63], a[20:23], v[88:91]
    v_exp_f32 v96, v96
    v_mfma_f32_16x16x32_bf16 v[88:91], v[64:67], a[24:27], v[88:91]
    v_exp_f32 v97, v97
    v_mfma_f32_16x16x32_bf16 v[88:91], v[68:71], a[28:31], v[88:91]
    v_exp_f32 v98, v98
    v_mfma_f32_16x16x32_bf16 v[92:95], v[72:75], a[16:19], v[32:35]
    v_exp_f32 v99, v99
    v_mfma_f32_16x16x32_bf16 v[92:95], v[76:79], a[20:23], v[92:95]
    v_add_f32 v12, v12, v96
    v_add_f32 v13, v13, v97
    v_mfma_f32_16x16x32_bf16 v[92:95], v[80:83], a[24:27], v[92:95]
    v_cvt_pk_bf16_f32 v108, v96, v97
    v_mfma_f32_16x16x32_bf16 v[92:95], v[84:87], a[28:31], v[92:95]
    v_exp_f32 v100, v100
    v_mfma_f32_16x16x32_bf16 v[168:171], v[112:115], v[104:107], v[168:171]
    ds_read_b64_tr_b16 v[112:113], v9 offset:25344
    ds_read_b64_tr_b16 v[114:115], v9 offset:25856
    v_exp_f32 v101, v101
    v_mfma_f32_16x16x32_bf16 v[196:199], v[116:119], v[104:107], v[196:199]
    ds_read_b64_tr_b16 v[116:117], v9 offset:25376
    ds_read_b64_tr_b16 v[118:119], v9 offset:25888
    v_add_f32 v12, v12, v98
    v_add_f32 v13, v13, v99
    v_mfma_f32_16x16x32_bf16 v[224:227], v[120:123], v[104:107], v[224:227]
    ds_read_b64_tr_b16 v[120:121], v9 offset:25408
    ds_read_b64_tr_b16 v[122:123], v9 offset:25920
    v_cvt_pk_bf16_f32 v109, v98, v99
    v_mfma_f32_16x16x32_bf16 v[252:255], v[124:127], v[104:107], v[252:255]
    ds_read_b64_tr_b16 v[124:125], v9 offset:25440
    ds_read_b64_tr_b16 v[126:127], v9 offset:25952
    v_exp_f32 v102, v102
    v_mfma_f32_16x16x32_bf16 a[136:139], v[128:131], v[104:107], a[136:139]
    ds_read_b64_tr_b16 v[128:129], v9 offset:25472
    ds_read_b64_tr_b16 v[130:131], v9 offset:25984
    v_exp_f32 v103, v103
    v_mfma_f32_16x16x32_bf16 a[164:167], v[132:135], v[104:107], a[164:167]
    ds_read_b64_tr_b16 v[132:133], v9 offset:25504
    ds_read_b64_tr_b16 v[134:135], v9 offset:26016
    v_add_f32 v12, v12, v100
    v_add_f32 v13, v13, v101
    v_mfma_f32_16x16x32_bf16 a[192:195], v[136:139], v[104:107], a[192:195]
    ds_read_b64_tr_b16 v[136:137], v9 offset:25536
    ds_read_b64_tr_b16 v[138:139], v9 offset:26048
    v_cvt_pk_bf16_f32 v110, v100, v101
    v_add_f32 v12, v12, v102
    v_mfma_f32_16x16x32_bf16 a[220:223], v[140:143], v[104:107], a[220:223]
    ds_read_b64_tr_b16 v[140:141], v9 offset:25568
    ds_read_b64_tr_b16 v[142:143], v9 offset:26080
    v_add_f32 v13, v13, v103
    v_cvt_pk_bf16_f32 v111, v102, v103
    v_mfma_f32_16x16x32_bf16 v[96:99], v[56:59], a[32:35], v[36:39]
    v_mfma_f32_16x16x32_bf16 v[96:99], v[60:63], a[36:39], v[96:99]
    s_add_u32 s29, s34, s100
    v_exp_f32 v88, v88
    v_mfma_f32_16x16x32_bf16 v[96:99], v[64:67], a[40:43], v[96:99]
    v_exp_f32 v89, v89
    v_mfma_f32_16x16x32_bf16 v[96:99], v[68:71], a[44:47], v[96:99]
    s_bfe_u32 s28, s29, 0x20003
    v_exp_f32 v90, v90
    v_mfma_f32_16x16x32_bf16 v[100:103], v[72:75], a[32:35], v[36:39]
    v_exp_f32 v91, v91
    v_mfma_f32_16x16x32_bf16 v[100:103], v[76:79], a[36:39], v[100:103]
    s_lshl_b32 s28, s28, 16
    v_add_f32 v14, v14, v88
    v_add_f32 v15, v15, v89
    v_mfma_f32_16x16x32_bf16 v[100:103], v[80:83], a[40:43], v[100:103]
    v_cvt_pk_bf16_f32 v104, v88, v89
    v_mfma_f32_16x16x32_bf16 v[100:103], v[84:87], a[44:47], v[100:103]
    v_exp_f32 v92, v92
    s_waitcnt lgkmcnt(0)
    v_mfma_f32_16x16x32_bf16 v[144:147], v[112:115], v[108:111], v[144:147]
    s_and_b32 s29, s29, 7
    v_exp_f32 v93, v93
    v_mfma_f32_16x16x32_bf16 v[172:175], v[116:119], v[108:111], v[172:175]
    v_add_f32 v14, v14, v90
    v_add_f32 v15, v15, v91
    v_mfma_f32_16x16x32_bf16 v[200:203], v[120:123], v[108:111], v[200:203]
    s_lshl_b32 s29, s29, 11
    v_cvt_pk_bf16_f32 v105, v90, v91
    v_mfma_f32_16x16x32_bf16 v[228:231], v[124:127], v[108:111], v[228:231]
    v_exp_f32 v94, v94
    v_mfma_f32_16x16x32_bf16 a[112:115], v[128:131], v[108:111], a[112:115]
    s_add_u32 s29, s28, s29
    v_exp_f32 v95, v95
    v_mfma_f32_16x16x32_bf16 a[140:143], v[132:135], v[108:111], a[140:143]
    v_add_f32 v14, v14, v92
    v_add_f32 v15, v15, v93
    v_mfma_f32_16x16x32_bf16 a[168:171], v[136:139], v[108:111], a[168:171]
    s_lshr_b32 s28, s34, 5
    v_cvt_pk_bf16_f32 v106, v92, v93
    v_add_f32 v14, v14, v94
    v_mfma_f32_16x16x32_bf16 a[196:199], v[140:143], v[108:111], a[196:199]
    v_add_f32 v15, v15, v95
    v_cvt_pk_bf16_f32 v107, v94, v95
    v_mfma_f32_16x16x32_bf16 v[88:91], v[56:59], a[48:51], v[40:43]
    v_mfma_f32_16x16x32_bf16 v[88:91], v[60:63], a[52:55], v[88:91]
    s_lshl_b32 s28, s28, 19
    v_exp_f32 v96, v96
    v_mfma_f32_16x16x32_bf16 v[88:91], v[64:67], a[56:59], v[88:91]
    v_exp_f32 v97, v97
    v_mfma_f32_16x16x32_bf16 v[88:91], v[68:71], a[60:63], v[88:91]
    s_add_u32 s49, s28, s29
    v_exp_f32 v98, v98
    v_mfma_f32_16x16x32_bf16 v[92:95], v[72:75], a[48:51], v[40:43]
    v_exp_f32 v99, v99
    v_mfma_f32_16x16x32_bf16 v[92:95], v[76:79], a[52:55], v[92:95]
    s_add_u32 m0, s33, 16896
    v_add_f32 v16, v16, v96
    v_add_f32 v17, v17, v97
    v_mfma_f32_16x16x32_bf16 v[92:95], v[80:83], a[56:59], v[92:95]
    v_cvt_pk_bf16_f32 v108, v96, v97
    v_mfma_f32_16x16x32_bf16 v[92:95], v[84:87], a[60:63], v[92:95]
    v_exp_f32 v100, v100
    v_mfma_f32_16x16x32_bf16 v[148:151], v[112:115], v[104:107], v[148:151]
    s_add_u32 s34, s34, 1
    v_exp_f32 v101, v101
    v_mfma_f32_16x16x32_bf16 v[176:179], v[116:119], v[104:107], v[176:179]
    v_add_f32 v16, v16, v98
    v_add_f32 v17, v17, v99
    v_mfma_f32_16x16x32_bf16 v[204:207], v[120:123], v[104:107], v[204:207]
    buffer_load_dwordx4 v7, s[4:7], s49 offen offset:0 nt lds
    v_cvt_pk_bf16_f32 v109, v98, v99
    v_mfma_f32_16x16x32_bf16 v[232:235], v[124:127], v[104:107], v[232:235]
    v_exp_f32 v102, v102
    v_mfma_f32_16x16x32_bf16 a[116:119], v[128:131], v[104:107], a[116:119]
    s_add_u32 m0, m0, s96
    v_exp_f32 v103, v103
    v_mfma_f32_16x16x32_bf16 a[144:147], v[132:135], v[104:107], a[144:147]
    v_add_f32 v16, v16, v100
    v_add_f32 v17, v17, v101
    v_mfma_f32_16x16x32_bf16 a[172:175], v[136:139], v[104:107], a[172:175]
    buffer_load_dwordx4 v7, s[4:7], s49 offen offset:256 nt lds
    v_cvt_pk_bf16_f32 v110, v100, v101
    v_add_f32 v16, v16, v102
    v_mfma_f32_16x16x32_bf16 a[200:203], v[140:143], v[104:107], a[200:203]
    v_add_f32 v17, v17, v103
    v_cvt_pk_bf16_f32 v111, v102, v103
    v_mfma_f32_16x16x32_bf16 v[96:99], v[56:59], a[64:67], v[44:47]
    v_mfma_f32_16x16x32_bf16 v[96:99], v[60:63], a[68:71], v[96:99]
    s_add_u32 m0, m0, s97
    v_exp_f32 v88, v88
    v_mfma_f32_16x16x32_bf16 v[96:99], v[64:67], a[72:75], v[96:99]
    v_exp_f32 v89, v89
    v_mfma_f32_16x16x32_bf16 v[96:99], v[68:71], a[76:79], v[96:99]
    buffer_load_dwordx4 v7, s[4:7], s49 offen offset:512 nt lds
    v_exp_f32 v90, v90
    v_mfma_f32_16x16x32_bf16 v[100:103], v[72:75], a[64:67], v[44:47]
    v_exp_f32 v91, v91
    v_mfma_f32_16x16x32_bf16 v[100:103], v[76:79], a[68:71], v[100:103]
    s_add_u32 m0, m0, s96
    v_add_f32 v18, v18, v88
    v_add_f32 v19, v19, v89
    v_mfma_f32_16x16x32_bf16 v[100:103], v[80:83], a[72:75], v[100:103]
    v_cvt_pk_bf16_f32 v104, v88, v89
    v_mfma_f32_16x16x32_bf16 v[100:103], v[84:87], a[76:79], v[100:103]
    v_exp_f32 v92, v92
    v_mfma_f32_16x16x32_bf16 v[152:155], v[112:115], v[108:111], v[152:155]
    buffer_load_dwordx4 v7, s[4:7], s49 offen offset:768 nt lds
    v_exp_f32 v93, v93
    v_mfma_f32_16x16x32_bf16 v[180:183], v[116:119], v[108:111], v[180:183]
    v_add_f32 v18, v18, v90
    v_add_f32 v19, v19, v91
    v_mfma_f32_16x16x32_bf16 v[208:211], v[120:123], v[108:111], v[208:211]
    s_add_u32 m0, m0, s97
    v_cvt_pk_bf16_f32 v105, v90, v91
    v_mfma_f32_16x16x32_bf16 v[236:239], v[124:127], v[108:111], v[236:239]
    v_exp_f32 v94, v94
    v_mfma_f32_16x16x32_bf16 a[120:123], v[128:131], v[108:111], a[120:123]
    buffer_load_dwordx4 v7, s[4:7], s49 offen offset:1024 nt lds
    v_exp_f32 v95, v95
    v_mfma_f32_16x16x32_bf16 a[148:151], v[132:135], v[108:111], a[148:151]
    v_add_f32 v18, v18, v92
    v_add_f32 v19, v19, v93
    v_mfma_f32_16x16x32_bf16 a[176:179], v[136:139], v[108:111], a[176:179]
    s_add_u32 m0, m0, s96
    v_cvt_pk_bf16_f32 v106, v92, v93
    v_add_f32 v18, v18, v94
    v_mfma_f32_16x16x32_bf16 a[204:207], v[140:143], v[108:111], a[204:207]
    v_add_f32 v19, v19, v95
    v_cvt_pk_bf16_f32 v107, v94, v95
    v_mfma_f32_16x16x32_bf16 v[88:91], v[56:59], a[80:83], v[48:51]
    v_mfma_f32_16x16x32_bf16 v[88:91], v[60:63], a[84:87], v[88:91]
    buffer_load_dwordx4 v7, s[4:7], s49 offen offset:1280 nt lds
    v_exp_f32 v96, v96
    v_mfma_f32_16x16x32_bf16 v[88:91], v[64:67], a[88:91], v[88:91]
    v_exp_f32 v97, v97
    v_mfma_f32_16x16x32_bf16 v[88:91], v[68:71], a[92:95], v[88:91]
    s_add_u32 m0, m0, s97
    v_exp_f32 v98, v98
    v_mfma_f32_16x16x32_bf16 v[92:95], v[72:75], a[80:83], v[48:51]
    v_exp_f32 v99, v99
    v_mfma_f32_16x16x32_bf16 v[92:95], v[76:79], a[84:87], v[92:95]
    buffer_load_dwordx4 v7, s[4:7], s49 offen offset:1536 nt lds
    v_add_f32 v20, v20, v96
    v_add_f32 v21, v21, v97
    v_mfma_f32_16x16x32_bf16 v[92:95], v[80:83], a[88:91], v[92:95]
    v_cvt_pk_bf16_f32 v108, v96, v97
    v_mfma_f32_16x16x32_bf16 v[92:95], v[84:87], a[92:95], v[92:95]
    v_exp_f32 v100, v100
    v_mfma_f32_16x16x32_bf16 v[156:159], v[112:115], v[104:107], v[156:159]
    s_add_u32 m0, m0, s96
    v_exp_f32 v101, v101
    v_mfma_f32_16x16x32_bf16 v[184:187], v[116:119], v[104:107], v[184:187]
    v_add_f32 v20, v20, v98
    v_add_f32 v21, v21, v99
    v_mfma_f32_16x16x32_bf16 v[212:215], v[120:123], v[104:107], v[212:215]
    buffer_load_dwordx4 v7, s[4:7], s49 offen offset:1792 nt lds
    v_cvt_pk_bf16_f32 v109, v98, v99
    v_mfma_f32_16x16x32_bf16 v[240:243], v[124:127], v[104:107], v[240:243]
    v_exp_f32 v102, v102
    v_mfma_f32_16x16x32_bf16 a[124:127], v[128:131], v[104:107], a[124:127]
    v_exp_f32 v103, v103
    v_mfma_f32_16x16x32_bf16 a[152:155], v[132:135], v[104:107], a[152:155]
    v_add_f32 v20, v20, v100
    v_add_f32 v21, v21, v101
    v_mfma_f32_16x16x32_bf16 a[180:183], v[136:139], v[104:107], a[180:183]
    v_cvt_pk_bf16_f32 v110, v100, v101
    v_add_f32 v20, v20, v102
    v_mfma_f32_16x16x32_bf16 a[208:211], v[140:143], v[104:107], a[208:211]
    v_add_f32 v21, v21, v103
    v_cvt_pk_bf16_f32 v111, v102, v103
    s_waitcnt vmcnt(16) lgkmcnt(0)
    s_barrier
    v_mfma_f32_16x16x32_bf16 v[96:99], v[56:59], a[96:99], v[52:55]
    ds_read_b128 v[56:59], v8 offset:0
    v_mfma_f32_16x16x32_bf16 v[96:99], v[60:63], a[100:103], v[96:99]
    ds_read_b128 v[60:63], v8 offset:64
    v_exp_f32 v88, v88
    v_mfma_f32_16x16x32_bf16 v[96:99], v[64:67], a[104:107], v[96:99]
    ds_read_b128 v[64:67], v8 offset:128
    v_exp_f32 v89, v89
    v_mfma_f32_16x16x32_bf16 v[96:99], v[68:71], a[108:111], v[96:99]
    ds_read_b128 v[68:71], v8 offset:192
    v_exp_f32 v90, v90
    v_mfma_f32_16x16x32_bf16 v[100:103], v[72:75], a[96:99], v[52:55]
    ds_read_b128 v[72:75], v8 offset:512
    v_exp_f32 v91, v91
    v_mfma_f32_16x16x32_bf16 v[100:103], v[76:79], a[100:103], v[100:103]
    ds_read_b128 v[76:79], v8 offset:576
    v_add_f32 v22, v22, v88
    v_add_f32 v23, v23, v89
    v_mfma_f32_16x16x32_bf16 v[100:103], v[80:83], a[104:107], v[100:103]
    ds_read_b128 v[80:83], v8 offset:640
    v_cvt_pk_bf16_f32 v104, v88, v89
    v_mfma_f32_16x16x32_bf16 v[100:103], v[84:87], a[108:111], v[100:103]
    ds_read_b128 v[84:87], v8 offset:704
    v_exp_f32 v92, v92
    v_mfma_f32_16x16x32_bf16 v[160:163], v[112:115], v[108:111], v[160:163]
    v_exp_f32 v93, v93
    v_mfma_f32_16x16x32_bf16 v[188:191], v[116:119], v[108:111], v[188:191]
    v_add_f32 v22, v22, v90
    v_add_f32 v23, v23, v91
    v_mfma_f32_16x16x32_bf16 v[216:219], v[120:123], v[108:111], v[216:219]
    v_cvt_pk_bf16_f32 v105, v90, v91
    v_mfma_f32_16x16x32_bf16 v[244:247], v[124:127], v[108:111], v[244:247]
    v_exp_f32 v94, v94
    v_mfma_f32_16x16x32_bf16 a[128:131], v[128:131], v[108:111], a[128:131]
    v_exp_f32 v95, v95
    v_mfma_f32_16x16x32_bf16 a[156:159], v[132:135], v[108:111], a[156:159]
    v_add_f32 v22, v22, v92
    v_add_f32 v23, v23, v93
    v_mfma_f32_16x16x32_bf16 a[184:187], v[136:139], v[108:111], a[184:187]
    v_cvt_pk_bf16_f32 v106, v92, v93
    v_add_f32 v22, v22, v94
    v_mfma_f32_16x16x32_bf16 a[212:215], v[140:143], v[108:111], a[212:215]
    v_add_f32 v23, v23, v95
    v_cvt_pk_bf16_f32 v107, v94, v95
    s_waitcnt lgkmcnt(0)
    v_mfma_f32_16x16x32_bf16 v[88:91], v[56:59], a[0:3], v[28:31]
    v_mfma_f32_16x16x32_bf16 v[88:91], v[60:63], a[4:7], v[88:91]
    v_exp_f32 v96, v96
    v_mfma_f32_16x16x32_bf16 v[88:91], v[64:67], a[8:11], v[88:91]
    v_exp_f32 v97, v97
    v_mfma_f32_16x16x32_bf16 v[88:91], v[68:71], a[12:15], v[88:91]
    v_exp_f32 v98, v98
    v_mfma_f32_16x16x32_bf16 v[92:95], v[72:75], a[0:3], v[28:31]
    v_exp_f32 v99, v99
    v_mfma_f32_16x16x32_bf16 v[92:95], v[76:79], a[4:7], v[92:95]
    v_add_f32 v24, v24, v96
    v_add_f32 v25, v25, v97
    v_mfma_f32_16x16x32_bf16 v[92:95], v[80:83], a[8:11], v[92:95]
    v_cvt_pk_bf16_f32 v108, v96, v97
    v_mfma_f32_16x16x32_bf16 v[92:95], v[84:87], a[12:15], v[92:95]
    v_exp_f32 v100, v100
    v_mfma_f32_16x16x32_bf16 v[164:167], v[112:115], v[104:107], v[164:167]
    v_exp_f32 v101, v101
    v_mfma_f32_16x16x32_bf16 v[192:195], v[116:119], v[104:107], v[192:195]
    v_add_f32 v24, v24, v98
    v_add_f32 v25, v25, v99
    v_mfma_f32_16x16x32_bf16 v[220:223], v[120:123], v[104:107], v[220:223]
    v_cvt_pk_bf16_f32 v109, v98, v99
    v_mfma_f32_16x16x32_bf16 v[248:251], v[124:127], v[104:107], v[248:251]
    v_exp_f32 v102, v102
    v_mfma_f32_16x16x32_bf16 a[132:135], v[128:131], v[104:107], a[132:135]
    v_exp_f32 v103, v103
    v_mfma_f32_16x16x32_bf16 a[160:163], v[132:135], v[104:107], a[160:163]
    v_add_f32 v24, v24, v100
    v_add_f32 v25, v25, v101
    v_mfma_f32_16x16x32_bf16 a[188:191], v[136:139], v[104:107], a[188:191]
    v_cvt_pk_bf16_f32 v110, v100, v101
    v_add_f32 v24, v24, v102
    v_mfma_f32_16x16x32_bf16 a[216:219], v[140:143], v[104:107], a[216:219]
    v_add_f32 v25, v25, v103
    v_cvt_pk_bf16_f32 v111, v102, v103
    v_mfma_f32_16x16x32_bf16 v[96:99], v[56:59], a[16:19], v[32:35]
    v_mfma_f32_16x16x32_bf16 v[96:99], v[60:63], a[20:23], v[96:99]
    v_exp_f32 v88, v88
    v_mfma_f32_16x16x32_bf16 v[96:99], v[64:67], a[24:27], v[96:99]
    v_exp_f32 v89, v89
    v_mfma_f32_16x16x32_bf16 v[96:99], v[68:71], a[28:31], v[96:99]
    v_exp_f32 v90, v90
    v_mfma_f32_16x16x32_bf16 v[100:103], v[72:75], a[16:19], v[32:35]
    v_exp_f32 v91, v91
    v_mfma_f32_16x16x32_bf16 v[100:103], v[76:79], a[20:23], v[100:103]
    v_add_f32 v12, v12, v88
    v_add_f32 v13, v13, v89
    v_mfma_f32_16x16x32_bf16 v[100:103], v[80:83], a[24:27], v[100:103]
    v_cvt_pk_bf16_f32 v104, v88, v89
    v_mfma_f32_16x16x32_bf16 v[100:103], v[84:87], a[28:31], v[100:103]
    v_exp_f32 v92, v92
    v_mfma_f32_16x16x32_bf16 v[168:171], v[112:115], v[108:111], v[168:171]
    ds_read_b64_tr_b16 v[112:113], v9 offset:0
    ds_read_b64_tr_b16 v[114:115], v9 offset:512
    v_exp_f32 v93, v93
    v_mfma_f32_16x16x32_bf16 v[196:199], v[116:119], v[108:111], v[196:199]
    ds_read_b64_tr_b16 v[116:117], v9 offset:32
    ds_read_b64_tr_b16 v[118:119], v9 offset:544
    v_add_f32 v12, v12, v90
    v_add_f32 v13, v13, v91
    v_mfma_f32_16x16x32_bf16 v[224:227], v[120:123], v[108:111], v[224:227]
    ds_read_b64_tr_b16 v[120:121], v9 offset:64
    ds_read_b64_tr_b16 v[122:123], v9 offset:576
    v_cvt_pk_bf16_f32 v105, v90, v91
    v_mfma_f32_16x16x32_bf16 v[252:255], v[124:127], v[108:111], v[252:255]
    ds_read_b64_tr_b16 v[124:125], v9 offset:96
    ds_read_b64_tr_b16 v[126:127], v9 offset:608
    v_exp_f32 v94, v94
    v_mfma_f32_16x16x32_bf16 a[136:139], v[128:131], v[108:111], a[136:139]
    ds_read_b64_tr_b16 v[128:129], v9 offset:128
    ds_read_b64_tr_b16 v[130:131], v9 offset:640
    v_exp_f32 v95, v95
    v_mfma_f32_16x16x32_bf16 a[164:167], v[132:135], v[108:111], a[164:167]
    ds_read_b64_tr_b16 v[132:133], v9 offset:160
    ds_read_b64_tr_b16 v[134:135], v9 offset:672
    v_add_f32 v12, v12, v92
    v_add_f32 v13, v13, v93
    v_mfma_f32_16x16x32_bf16 a[192:195], v[136:139], v[108:111], a[192:195]
    ds_read_b64_tr_b16 v[136:137], v9 offset:192
    ds_read_b64_tr_b16 v[138:139], v9 offset:704
    v_cvt_pk_bf16_f32 v106, v92, v93
    v_add_f32 v12, v12, v94
    v_mfma_f32_16x16x32_bf16 a[220:223], v[140:143], v[108:111], a[220:223]
    ds_read_b64_tr_b16 v[140:141], v9 offset:224
    ds_read_b64_tr_b16 v[142:143], v9 offset:736
    v_add_f32 v13, v13, v95
    v_cvt_pk_bf16_f32 v107, v94, v95
    v_mfma_f32_16x16x32_bf16 v[88:91], v[56:59], a[32:35], v[36:39]
    v_mfma_f32_16x16x32_bf16 v[88:91], v[60:63], a[36:39], v[88:91]
    s_add_u32 s29, s34, s100
    v_exp_f32 v96, v96
    v_mfma_f32_16x16x32_bf16 v[88:91], v[64:67], a[40:43], v[88:91]
    v_exp_f32 v97, v97
    v_mfma_f32_16x16x32_bf16 v[88:91], v[68:71], a[44:47], v[88:91]
    s_bfe_u32 s28, s29, 0x20003
    v_exp_f32 v98, v98
    v_mfma_f32_16x16x32_bf16 v[92:95], v[72:75], a[32:35], v[36:39]
    v_exp_f32 v99, v99
    v_mfma_f32_16x16x32_bf16 v[92:95], v[76:79], a[36:39], v[92:95]
    s_lshl_b32 s28, s28, 16
    v_add_f32 v14, v14, v96
    v_add_f32 v15, v15, v97
    v_mfma_f32_16x16x32_bf16 v[92:95], v[80:83], a[40:43], v[92:95]
    v_cvt_pk_bf16_f32 v108, v96, v97
    v_mfma_f32_16x16x32_bf16 v[92:95], v[84:87], a[44:47], v[92:95]
    v_exp_f32 v100, v100
    s_waitcnt lgkmcnt(0)
    v_mfma_f32_16x16x32_bf16 v[144:147], v[112:115], v[104:107], v[144:147]
    s_and_b32 s29, s29, 7
    v_exp_f32 v101, v101
    v_mfma_f32_16x16x32_bf16 v[172:175], v[116:119], v[104:107], v[172:175]
    v_add_f32 v14, v14, v98
    v_add_f32 v15, v15, v99
    v_mfma_f32_16x16x32_bf16 v[200:203], v[120:123], v[104:107], v[200:203]
    s_lshl_b32 s29, s29, 11
    v_cvt_pk_bf16_f32 v109, v98, v99
    v_mfma_f32_16x16x32_bf16 v[228:231], v[124:127], v[104:107], v[228:231]
    v_exp_f32 v102, v102
    v_mfma_f32_16x16x32_bf16 a[112:115], v[128:131], v[104:107], a[112:115]
    s_add_u32 s29, s28, s29
    v_exp_f32 v103, v103
    v_mfma_f32_16x16x32_bf16 a[140:143], v[132:135], v[104:107], a[140:143]
    v_add_f32 v14, v14, v100
    v_add_f32 v15, v15, v101
    v_mfma_f32_16x16x32_bf16 a[168:171], v[136:139], v[104:107], a[168:171]
    s_lshr_b32 s28, s34, 5
    v_cvt_pk_bf16_f32 v110, v100, v101
    v_add_f32 v14, v14, v102
    v_mfma_f32_16x16x32_bf16 a[196:199], v[140:143], v[104:107], a[196:199]
    v_add_f32 v15, v15, v103
    v_cvt_pk_bf16_f32 v111, v102, v103
    v_mfma_f32_16x16x32_bf16 v[96:99], v[56:59], a[48:51], v[40:43]
    v_mfma_f32_16x16x32_bf16 v[96:99], v[60:63], a[52:55], v[96:99]
    s_lshl_b32 s28, s28, 19
    v_exp_f32 v88, v88
    v_mfma_f32_16x16x32_bf16 v[96:99], v[64:67], a[56:59], v[96:99]
    v_exp_f32 v89, v89
    v_mfma_f32_16x16x32_bf16 v[96:99], v[68:71], a[60:63], v[96:99]
    s_add_u32 s49, s28, s29
    v_exp_f32 v90, v90
    v_mfma_f32_16x16x32_bf16 v[100:103], v[72:75], a[48:51], v[40:43]
    v_exp_f32 v91, v91
    v_mfma_f32_16x16x32_bf16 v[100:103], v[76:79], a[52:55], v[100:103]
    s_add_u32 m0, s33, 25344
    v_add_f32 v16, v16, v88
    v_add_f32 v17, v17, v89
    v_mfma_f32_16x16x32_bf16 v[100:103], v[80:83], a[56:59], v[100:103]
    v_cvt_pk_bf16_f32 v104, v88, v89
    v_mfma_f32_16x16x32_bf16 v[100:103], v[84:87], a[60:63], v[100:103]
    v_exp_f32 v92, v92
    v_mfma_f32_16x16x32_bf16 v[148:151], v[112:115], v[108:111], v[148:151]
    s_add_u32 s34, s34, 1
    v_exp_f32 v93, v93
    v_mfma_f32_16x16x32_bf16 v[176:179], v[116:119], v[108:111], v[176:179]
    v_add_f32 v16, v16, v90
    v_add_f32 v17, v17, v91
    v_mfma_f32_16x16x32_bf16 v[204:207], v[120:123], v[108:111], v[204:207]
    buffer_load_dwordx4 v7, s[4:7], s49 offen offset:0 nt lds
    v_cvt_pk_bf16_f32 v105, v90, v91
    v_mfma_f32_16x16x32_bf16 v[232:235], v[124:127], v[108:111], v[232:235]
    v_exp_f32 v94, v94
    v_mfma_f32_16x16x32_bf16 a[116:119], v[128:131], v[108:111], a[116:119]
    s_add_u32 m0, m0, s96
    v_exp_f32 v95, v95
    v_mfma_f32_16x16x32_bf16 a[144:147], v[132:135], v[108:111], a[144:147]
    v_add_f32 v16, v16, v92
    v_add_f32 v17, v17, v93
    v_mfma_f32_16x16x32_bf16 a[172:175], v[136:139], v[108:111], a[172:175]
    buffer_load_dwordx4 v7, s[4:7], s49 offen offset:256 nt lds
    v_cvt_pk_bf16_f32 v106, v92, v93
    v_add_f32 v16, v16, v94
    v_mfma_f32_16x16x32_bf16 a[200:203], v[140:143], v[108:111], a[200:203]
    v_add_f32 v17, v17, v95
    v_cvt_pk_bf16_f32 v107, v94, v95
    v_mfma_f32_16x16x32_bf16 v[88:91], v[56:59], a[64:67], v[44:47]
    v_mfma_f32_16x16x32_bf16 v[88:91], v[60:63], a[68:71], v[88:91]
    s_add_u32 m0, m0, s97
    v_exp_f32 v96, v96
    v_mfma_f32_16x16x32_bf16 v[88:91], v[64:67], a[72:75], v[88:91]
    v_exp_f32 v97, v97
    v_mfma_f32_16x16x32_bf16 v[88:91], v[68:71], a[76:79], v[88:91]
    buffer_load_dwordx4 v7, s[4:7], s49 offen offset:512 nt lds
    v_exp_f32 v98, v98
    v_mfma_f32_16x16x32_bf16 v[92:95], v[72:75], a[64:67], v[44:47]
    v_exp_f32 v99, v99
    v_mfma_f32_16x16x32_bf16 v[92:95], v[76:79], a[68:71], v[92:95]
    s_add_u32 m0, m0, s96
    v_add_f32 v18, v18, v96
    v_add_f32 v19, v19, v97
    v_mfma_f32_16x16x32_bf16 v[92:95], v[80:83], a[72:75], v[92:95]
    v_cvt_pk_bf16_f32 v108, v96, v97
    v_mfma_f32_16x16x32_bf16 v[92:95], v[84:87], a[76:79], v[92:95]
    v_exp_f32 v100, v100
    v_mfma_f32_16x16x32_bf16 v[152:155], v[112:115], v[104:107], v[152:155]
    buffer_load_dwordx4 v7, s[4:7], s49 offen offset:768 nt lds
    v_exp_f32 v101, v101
    v_mfma_f32_16x16x32_bf16 v[180:183], v[116:119], v[104:107], v[180:183]
    v_add_f32 v18, v18, v98
    v_add_f32 v19, v19, v99
    v_mfma_f32_16x16x32_bf16 v[208:211], v[120:123], v[104:107], v[208:211]
    s_add_u32 m0, m0, s97
    v_cvt_pk_bf16_f32 v109, v98, v99
    v_mfma_f32_16x16x32_bf16 v[236:239], v[124:127], v[104:107], v[236:239]
    v_exp_f32 v102, v102
    v_mfma_f32_16x16x32_bf16 a[120:123], v[128:131], v[104:107], a[120:123]
    buffer_load_dwordx4 v7, s[4:7], s49 offen offset:1024 nt lds
    v_exp_f32 v103, v103
    v_mfma_f32_16x16x32_bf16 a[148:151], v[132:135], v[104:107], a[148:151]
    v_add_f32 v18, v18, v100
    v_add_f32 v19, v19, v101
    v_mfma_f32_16x16x32_bf16 a[176:179], v[136:139], v[104:107], a[176:179]
    s_add_u32 m0, m0, s96
    v_cvt_pk_bf16_f32 v110, v100, v101
    v_add_f32 v18, v18, v102
    v_mfma_f32_16x16x32_bf16 a[204:207], v[140:143], v[104:107], a[204:207]
    v_add_f32 v19, v19, v103
    v_cvt_pk_bf16_f32 v111, v102, v103
    v_mfma_f32_16x16x32_bf16 v[96:99], v[56:59], a[80:83], v[48:51]
    v_mfma_f32_16x16x32_bf16 v[96:99], v[60:63], a[84:87], v[96:99]
    buffer_load_dwordx4 v7, s[4:7], s49 offen offset:1280 nt lds
    v_exp_f32 v88, v88
    v_mfma_f32_16x16x32_bf16 v[96:99], v[64:67], a[88:91], v[96:99]
    v_exp_f32 v89, v89
    v_mfma_f32_16x16x32_bf16 v[96:99], v[68:71], a[92:95], v[96:99]
    s_add_u32 m0, m0, s97
    v_exp_f32 v90, v90
    v_mfma_f32_16x16x32_bf16 v[100:103], v[72:75], a[80:83], v[48:51]
    v_exp_f32 v91, v91
    v_mfma_f32_16x16x32_bf16 v[100:103], v[76:79], a[84:87], v[100:103]
    buffer_load_dwordx4 v7, s[4:7], s49 offen offset:1536 nt lds
    v_add_f32 v20, v20, v88
    v_add_f32 v21, v21, v89
    v_mfma_f32_16x16x32_bf16 v[100:103], v[80:83], a[88:91], v[100:103]
    v_cvt_pk_bf16_f32 v104, v88, v89
    v_mfma_f32_16x16x32_bf16 v[100:103], v[84:87], a[92:95], v[100:103]
    v_exp_f32 v92, v92
    v_mfma_f32_16x16x32_bf16 v[156:159], v[112:115], v[108:111], v[156:159]
    s_add_u32 m0, m0, s96
    v_exp_f32 v93, v93
    v_mfma_f32_16x16x32_bf16 v[184:187], v[116:119], v[108:111], v[184:187]
    v_add_f32 v20, v20, v90
    v_add_f32 v21, v21, v91
    v_mfma_f32_16x16x32_bf16 v[212:215], v[120:123], v[108:111], v[212:215]
    buffer_load_dwordx4 v7, s[4:7], s49 offen offset:1792 nt lds
    v_cvt_pk_bf16_f32 v105, v90, v91
    v_mfma_f32_16x16x32_bf16 v[240:243], v[124:127], v[108:111], v[240:243]
    v_exp_f32 v94, v94
    v_mfma_f32_16x16x32_bf16 a[124:127], v[128:131], v[108:111], a[124:127]
    v_exp_f32 v95, v95
    v_mfma_f32_16x16x32_bf16 a[152:155], v[132:135], v[108:111], a[152:155]
    v_add_f32 v20, v20, v92
    v_add_f32 v21, v21, v93
    v_mfma_f32_16x16x32_bf16 a[180:183], v[136:139], v[108:111], a[180:183]
    v_cvt_pk_bf16_f32 v106, v92, v93
    v_add_f32 v20, v20, v94
    v_mfma_f32_16x16x32_bf16 a[208:211], v[140:143], v[108:111], a[208:211]
    v_add_f32 v21, v21, v95
    v_cvt_pk_bf16_f32 v107, v94, v95
    s_waitcnt vmcnt(16) lgkmcnt(0)
    s_barrier
    v_mfma_f32_16x16x32_bf16 v[88:91], v[56:59], a[96:99], v[52:55]
    ds_read_b128 v[56:59], v8 offset:8448
    v_mfma_f32_16x16x32_bf16 v[88:91], v[60:63], a[100:103], v[88:91]
    ds_read_b128 v[60:63], v8 offset:8512
    v_exp_f32 v96, v96
    v_mfma_f32_16x16x32_bf16 v[88:91], v[64:67], a[104:107], v[88:91]
    ds_read_b128 v[64:67], v8 offset:8576
    v_exp_f32 v97, v97
    v_mfma_f32_16x16x32_bf16 v[88:91], v[68:71], a[108:111], v[88:91]
    ds_read_b128 v[68:71], v8 offset:8640
    v_exp_f32 v98, v98
    v_mfma_f32_16x16x32_bf16 v[92:95], v[72:75], a[96:99], v[52:55]
    ds_read_b128 v[72:75], v8 offset:8960
    v_exp_f32 v99, v99
    v_mfma_f32_16x16x32_bf16 v[92:95], v[76:79], a[100:103], v[92:95]
    ds_read_b128 v[76:79], v8 offset:9024
    v_add_f32 v22, v22, v96
    v_add_f32 v23, v23, v97
    v_mfma_f32_16x16x32_bf16 v[92:95], v[80:83], a[104:107], v[92:95]
    ds_read_b128 v[80:83], v8 offset:9088
    v_cvt_pk_bf16_f32 v108, v96, v97
    v_mfma_f32_16x16x32_bf16 v[92:95], v[84:87], a[108:111], v[92:95]
    ds_read_b128 v[84:87], v8 offset:9152
    v_exp_f32 v100, v100
    v_mfma_f32_16x16x32_bf16 v[160:163], v[112:115], v[104:107], v[160:163]
    v_exp_f32 v101, v101
    v_mfma_f32_16x16x32_bf16 v[188:191], v[116:119], v[104:107], v[188:191]
    v_add_f32 v22, v22, v98
    v_add_f32 v23, v23, v99
    v_mfma_f32_16x16x32_bf16 v[216:219], v[120:123], v[104:107], v[216:219]
    v_cvt_pk_bf16_f32 v109, v98, v99
    v_mfma_f32_16x16x32_bf16 v[244:247], v[124:127], v[104:107], v[244:247]
    v_exp_f32 v102, v102
    v_mfma_f32_16x16x32_bf16 a[128:131], v[128:131], v[104:107], a[128:131]
    v_exp_f32 v103, v103
    v_mfma_f32_16x16x32_bf16 a[156:159], v[132:135], v[104:107], a[156:159]
    v_add_f32 v22, v22, v100
    v_add_f32 v23, v23, v101
    v_mfma_f32_16x16x32_bf16 a[184:187], v[136:139], v[104:107], a[184:187]
    v_cvt_pk_bf16_f32 v110, v100, v101
    v_add_f32 v22, v22, v102
    v_mfma_f32_16x16x32_bf16 a[212:215], v[140:143], v[104:107], a[212:215]
    v_add_f32 v23, v23, v103
    v_cvt_pk_bf16_f32 v111, v102, v103
    s_waitcnt lgkmcnt(0)
    v_mfma_f32_16x16x32_bf16 v[96:99], v[56:59], a[0:3], v[28:31]
    v_mfma_f32_16x16x32_bf16 v[96:99], v[60:63], a[4:7], v[96:99]
    v_exp_f32 v88, v88
    v_mfma_f32_16x16x32_bf16 v[96:99], v[64:67], a[8:11], v[96:99]
    v_exp_f32 v89, v89
    v_mfma_f32_16x16x32_bf16 v[96:99], v[68:71], a[12:15], v[96:99]
    v_exp_f32 v90, v90
    v_mfma_f32_16x16x32_bf16 v[100:103], v[72:75], a[0:3], v[28:31]
    v_exp_f32 v91, v91
    v_mfma_f32_16x16x32_bf16 v[100:103], v[76:79], a[4:7], v[100:103]
    v_add_f32 v24, v24, v88
    v_add_f32 v25, v25, v89
    v_mfma_f32_16x16x32_bf16 v[100:103], v[80:83], a[8:11], v[100:103]
    v_cvt_pk_bf16_f32 v104, v88, v89
    v_mfma_f32_16x16x32_bf16 v[100:103], v[84:87], a[12:15], v[100:103]
    v_exp_f32 v92, v92
    v_mfma_f32_16x16x32_bf16 v[164:167], v[112:115], v[108:111], v[164:167]
    v_exp_f32 v93, v93
    v_mfma_f32_16x16x32_bf16 v[192:195], v[116:119], v[108:111], v[192:195]
    v_add_f32 v24, v24, v90
    v_add_f32 v25, v25, v91
    v_mfma_f32_16x16x32_bf16 v[220:223], v[120:123], v[108:111], v[220:223]
    v_cvt_pk_bf16_f32 v105, v90, v91
    v_mfma_f32_16x16x32_bf16 v[248:251], v[124:127], v[108:111], v[248:251]
    v_exp_f32 v94, v94
    v_mfma_f32_16x16x32_bf16 a[132:135], v[128:131], v[108:111], a[132:135]
    v_exp_f32 v95, v95
    v_mfma_f32_16x16x32_bf16 a[160:163], v[132:135], v[108:111], a[160:163]
    v_add_f32 v24, v24, v92
    v_add_f32 v25, v25, v93
    v_mfma_f32_16x16x32_bf16 a[188:191], v[136:139], v[108:111], a[188:191]
    v_cvt_pk_bf16_f32 v106, v92, v93
    v_add_f32 v24, v24, v94
    v_mfma_f32_16x16x32_bf16 a[216:219], v[140:143], v[108:111], a[216:219]
    v_add_f32 v25, v25, v95
    v_cvt_pk_bf16_f32 v107, v94, v95
    s_add_u32 s22, s22, 1
    s_cmp_lt_u32 s22, 7
    s_cbranch_scc1 L_at_loop
    s_add_u32 s21, s21, 1
    s_mul_i32 s50, s21, s52
    s_mov_b32 s101, s21
    s_add_u32 s50, s50, s55
    s_cmp_ge_u32 s21, 2
    s_cselect_b32 s28, 0x40000000, 0
    s_add_u32 s50, s50, s28
    s_mov_b32 s82, s26
    s_mul_i32 s28, s26, s51
    s_add_u32 s50, s50, s28
    s_cmp_eq_u32 s21, 2
    s_cbranch_scc1 L_at_wt0
L_at_wt0r:
    s_cmp_lg_u32 s69, 0
    s_cbranch_scc1 L_at_atailB
    v_mfma_f32_16x16x32_bf16 v[88:91], v[56:59], a[16:19], v[32:35]
    v_mfma_f32_16x16x32_bf16 v[88:91], v[60:63], a[20:23], v[88:91]
    v_exp_f32 v96, v96
    v_mfma_f32_16x16x32_bf16 v[88:91], v[64:67], a[24:27], v[88:91]
    v_exp_f32 v97, v97
    v_mfma_f32_16x16x32_bf16 v[88:91], v[68:71], a[28:31], v[88:91]
    v_exp_f32 v98, v98
    v_mfma_f32_16x16x32_bf16 v[92:95], v[72:75], a[16:19], v[32:35]
    v_exp_f32 v99, v99
    v_mfma_f32_16x16x32_bf16 v[92:95], v[76:79], a[20:23], v[92:95]
    v_add_f32 v12, v12, v96
    v_add_f32 v13, v13, v97
    v_mfma_f32_16x16x32_bf16 v[92:95], v[80:83], a[24:27], v[92:95]
    v_cvt_pk_bf16_f32 v108, v96, v97
    v_mfma_f32_16x16x32_bf16 v[92:95], v[84:87], a[28:31], v[92:95]
    v_exp_f32 v100, v100
    v_mfma_f32_16x16x32_bf16 v[168:171], v[112:115], v[104:107], v[168:171]
    ds_read_b64_tr_b16 v[112:113], v9 offset:8448
    ds_read_b64_tr_b16 v[114:115], v9 offset:8960
    v_exp_f32 v101, v101
    v_mfma_f32_16x16x32_bf16 v[196:199], v[116:119], v[104:107], v[196:199]
    ds_read_b64_tr_b16 v[116:117], v9 offset:8480
    ds_read_b64_tr_b16 v[118:119], v9 offset:8992
    v_add_f32 v12, v12, v98
    v_add_f32 v13, v13, v99
    v_mfma_f32_16x16x32_bf16 v[224:227], v[120:123], v[104:107], v[224:227]
    ds_read_b64_tr_b16 v[120:121], v9 offset:8512
    ds_read_b64_tr_b16 v[122:123], v9 offset:9024
    v_cvt_pk_bf16_f32 v109, v98, v99
    v_mfma_f32_16x16x32_bf16 v[252:255], v[124:127], v[104:107], v[252:255]
    ds_read_b64_tr_b16 v[124:125], v9 offset:8544
    ds_read_b64_tr_b16 v[126:127], v9 offset:9056
    v_exp_f32 v102, v102
    v_mfma_f32_16x16x32_bf16 a[136:139], v[128:131], v[104:107], a[136:139]
    ds_read_b64_tr_b16 v[128:129], v9 offset:8576
    ds_read_b64_tr_b16 v[130:131], v9 offset:9088
    v_exp_f32 v103, v103
    v_mfma_f32_16x16x32_bf16 a[164:167], v[132:135], v[104:107], a[164:167]
    ds_read_b64_tr_b16 v[132:133], v9 offset:8608
    ds_read_b64_tr_b16 v[134:135], v9 offset:9120
    v_add_f32 v12, v12, v100
    v_add_f32 v13, v13, v101
    v_mfma_f32_16x16x32_bf16 a[192:195], v[136:139], v[104:107], a[192:195]
    ds_read_b64_tr_b16 v[136:137], v9 offset:8640
    ds_read_b64_tr_b16 v[138:139], v9 offset:9152
    v_cvt_pk_bf16_f32 v110, v100, v101
    v_add_f32 v12, v12, v102
    v_mfma_f32_16x16x32_bf16 a[220:223], v[140:143], v[104:107], a[220:223]
    ds_read_b64_tr_b16 v[140:141], v9 offset:8672
    ds_read_b64_tr_b16 v[142:143], v9 offset:9184
    v_add_f32 v13, v13, v103
    v_cvt_pk_bf16_f32 v111, v102, v103
    v_mfma_f32_16x16x32_bf16 v[96:99], v[56:59], a[32:35], v[36:39]
    v_mfma_f32_16x16x32_bf16 v[96:99], v[60:63], a[36:39], v[96:99]
    s_add_u32 m0, s33, 0
    v_exp_f32 v88, v88
    v_mfma_f32_16x16x32_bf16 v[96:99], v[64:67], a[40:43], v[96:99]
    v_exp_f32 v89, v89
    v_mfma_f32_16x16x32_bf16 v[96:99], v[68:71], a[44:47], v[96:99]
    s_mov_b32 s49, s50
    v_exp_f32 v90, v90
    v_mfma_f32_16x16x32_bf16 v[100:103], v[72:75], a[32:35], v[36:39]
    v_exp_f32 v91, v91
    v_mfma_f32_16x16x32_bf16 v[100:103], v[76:79], a[36:39], v[100:103]
    s_add_u32 s50, s50, s51
    v_add_f32 v14, v14, v88
    v_add_f32 v15, v15, v89
    v_mfma_f32_16x16x32_bf16 v[100:103], v[80:83], a[40:43], v[100:103]
    v_cvt_pk_bf16_f32 v104, v88, v89
    v_mfma_f32_16x16x32_bf16 v[100:103], v[84:87], a[44:47], v[100:103]
    s_add_u32 s82, s82, 1
    v_exp_f32 v92, v92
    s_waitcnt lgkmcnt(0)
    v_mfma_f32_16x16x32_bf16 v[144:147], v[112:115], v[108:111], v[144:147]
    v_exp_f32 v93, v93
    v_mfma_f32_16x16x32_bf16 v[172:175], v[116:119], v[108:111], v[172:175]
    s_cmp_eq_u32 s82, 20
    v_add_f32 v14, v14, v90
    v_add_f32 v15, v15, v91
    v_mfma_f32_16x16x32_bf16 v[200:203], v[120:123], v[108:111], v[200:203]
    v_cvt_pk_bf16_f32 v105, v90, v91
    v_mfma_f32_16x16x32_bf16 v[228:231], v[124:127], v[108:111], v[228:231]
    s_cselect_b32 s29, s83, 0
    v_exp_f32 v94, v94
    v_mfma_f32_16x16x32_bf16 a[112:115], v[128:131], v[108:111], a[112:115]
    v_exp_f32 v95, v95
    v_mfma_f32_16x16x32_bf16 a[140:143], v[132:135], v[108:111], a[140:143]
    s_sub_u32 s50, s50, s29
    v_add_f32 v14, v14, v92
    v_add_f32 v15, v15, v93
    v_mfma_f32_16x16x32_bf16 a[168:171], v[136:139], v[108:111], a[168:171]
    v_cvt_pk_bf16_f32 v106, v92, v93
    v_add_f32 v14, v14, v94
    v_mfma_f32_16x16x32_bf16 a[196:199], v[140:143], v[108:111], a[196:199]
    s_add_u32 s28, s49, s88
    v_add_f32 v15, v15, v95
    v_cvt_pk_bf16_f32 v107, v94, v95
    v_mfma_f32_16x16x32_bf16 v[88:91], v[56:59], a[48:51], v[40:43]
    v_mfma_f32_16x16x32_bf16 v[88:91], v[60:63], a[52:55], v[88:91]
    buffer_load_dwordx4 v26, s[16:19], s28 offen lds
    v_exp_f32 v96, v96
    v_mfma_f32_16x16x32_bf16 v[88:91], v[64:67], a[56:59], v[88:91]
    v_exp_f32 v97, v97
    v_mfma_f32_16x16x32_bf16 v[88:91], v[68:71], a[60:63], v[88:91]
    s_add_u32 m0, m0, s53
    v_exp_f32 v98, v98
    v_mfma_f32_16x16x32_bf16 v[92:95], v[72:75], a[48:51], v[40:43]
    v_exp_f32 v99, v99
    v_mfma_f32_16x16x32_bf16 v[92:95], v[76:79], a[52:55], v[92:95]
    s_add_u32 s28, s49, s89
    v_add_f32 v16, v16, v96
    v_add_f32 v17, v17, v97
    v_mfma_f32_16x16x32_bf16 v[92:95], v[80:83], a[56:59], v[92:95]
    v_cvt_pk_bf16_f32 v108, v96, v97
    v_mfma_f32_16x16x32_bf16 v[92:95], v[84:87], a[60:63], v[92:95]
    buffer_load_dwordx4 v26, s[16:19], s28 offen lds
    v_exp_f32 v100, v100
    v_mfma_f32_16x16x32_bf16 v[148:151], v[112:115], v[104:107], v[148:151]
    v_exp_f32 v101, v101
    v_mfma_f32_16x16x32_bf16 v[176:179], v[116:119], v[104:107], v[176:179]
    s_add_u32 m0, m0, s53
    v_add_f32 v16, v16, v98
    v_add_f32 v17, v17, v99
    v_mfma_f32_16x16x32_bf16 v[204:207], v[120:123], v[104:107], v[204:207]
    v_cvt_pk_bf16_f32 v109, v98, v99
    v_mfma_f32_16x16x32_bf16 v[232:235], v[124:127], v[104:107], v[232:235]
    s_add_u32 s28, s49, s90
    v_exp_f32 v102, v102
    v_mfma_f32_16x16x32_bf16 a[116:119], v[128:131], v[104:107], a[116:119]
    v_exp_f32 v103, v103
    v_mfma_f32_16x16x32_bf16 a[144:147], v[132:135], v[104:107], a[144:147]
    buffer_load_dwordx4 v26, s[16:19], s28 offen lds
    v_add_f32 v16, v16, v100
    v_add_f32 v17, v17, v101
    v_mfma_f32_16x16x32_bf16 a[172:175], v[136:139], v[104:107], a[172:175]
    v_cvt_pk_bf16_f32 v110, v100, v101
    v_add_f32 v16, v16, v102
    v_mfma_f32_16x16x32_bf16 a[200:203], v[140:143], v[104:107], a[200:203]
    s_add_u32 m0, m0, s53
    v_add_f32 v17, v17, v103
    v_cvt_pk_bf16_f32 v111, v102, v103
    v_mfma_f32_16x16x32_bf16 v[96:99], v[56:59], a[64:67], v[44:47]
    v_mfma_f32_16x16x32_bf16 v[96:99], v[60:63], a[68:71], v[96:99]
    s_add_u32 s28, s49, s91
    v_exp_f32 v88, v88
    v_mfma_f32_16x16x32_bf16 v[96:99], v[64:67], a[72:75], v[96:99]
    v_exp_f32 v89, v89
    v_mfma_f32_16x16x32_bf16 v[96:99], v[68:71], a[76:79], v[96:99]
    buffer_load_dwordx4 v26, s[16:19], s28 offen lds
    v_exp_f32 v90, v90
    v_mfma_f32_16x16x32_bf16 v[100:103], v[72:75], a[64:67], v[44:47]
    v_exp_f32 v91, v91
    v_mfma_f32_16x16x32_bf16 v[100:103], v[76:79], a[68:71], v[100:103]
    s_add_u32 m0, m0, s53
    v_add_f32 v18, v18, v88
    v_add_f32 v19, v19, v89
    v_mfma_f32_16x16x32_bf16 v[100:103], v[80:83], a[72:75], v[100:103]
    v_cvt_pk_bf16_f32 v104, v88, v89
    v_mfma_f32_16x16x32_bf16 v[100:103], v[84:87], a[76:79], v[100:103]
    s_add_u32 s28, s49, s92
    v_exp_f32 v92, v92
    v_mfma_f32_16x16x32_bf16 v[152:155], v[112:115], v[108:111], v[152:155]
    v_exp_f32 v93, v93
    v_mfma_f32_16x16x32_bf16 v[180:183], v[116:119], v[108:111], v[180:183]
    buffer_load_dwordx4 v26, s[16:19], s28 offen lds
    v_add_f32 v18, v18, v90
    v_add_f32 v19, v19, v91
    v_mfma_f32_16x16x32_bf16 v[208:211], v[120:123], v[108:111], v[208:211]
    v_cvt_pk_bf16_f32 v105, v90, v91
    v_mfma_f32_16x16x32_bf16 v[236:239], v[124:127], v[108:111], v[236:239]
    s_add_u32 m0, m0, s53
    v_exp_f32 v94, v94
    v_mfma_f32_16x16x32_bf16 a[120:123], v[128:131], v[108:111], a[120:123]
    v_exp_f32 v95, v95
    v_mfma_f32_16x16x32_bf16 a[148:151], v[132:135], v[108:111], a[148:151]
    s_add_u32 s28, s49, s93
    v_add_f32 v18, v18, v92
    v_add_f32 v19, v19, v93
    v_mfma_f32_16x16x32_bf16 a[176:179], v[136:139], v[108:111], a[176:179]
    v_cvt_pk_bf16_f32 v106, v92, v93
    v_add_f32 v18, v18, v94
    v_mfma_f32_16x16x32_bf16 a[204:207], v[140:143], v[108:111], a[204:207]
    buffer_load_dwordx4 v26, s[16:19], s28 offen lds
    v_add_f32 v19, v19, v95
    v_cvt_pk_bf16_f32 v107, v94, v95
    v_mfma_f32_16x16x32_bf16 v[88:91], v[56:59], a[80:83], v[48:51]
    v_mfma_f32_16x16x32_bf16 v[88:91], v[60:63], a[84:87], v[88:91]
    s_add_u32 m0, m0, s53
    v_exp_f32 v96, v96
    v_mfma_f32_16x16x32_bf16 v[88:91], v[64:67], a[88:91], v[88:91]
    v_exp_f32 v97, v97
    v_mfma_f32_16x16x32_bf16 v[88:91], v[68:71], a[92:95], v[88:91]
    s_add_u32 s28, s49, s94
    v_exp_f32 v98, v98
    v_mfma_f32_16x16x32_bf16 v[92:95], v[72:75], a[80:83], v[48:51]
    v_exp_f32 v99, v99
    v_mfma_f32_16x16x32_bf16 v[92:95], v[76:79], a[84:87], v[92:95]
    buffer_load_dwordx4 v26, s[16:19], s28 offen lds
    v_add_f32 v20, v20, v96
    v_add_f32 v21, v21, v97
    v_mfma_f32_16x16x32_bf16 v[92:95], v[80:83], a[88:91], v[92:95]
    v_cvt_pk_bf16_f32 v108, v96, v97
    v_mfma_f32_16x16x32_bf16 v[92:95], v[84:87], a[92:95], v[92:95]
    s_add_u32 m0, m0, s53
    v_exp_f32 v100, v100
    v_mfma_f32_16x16x32_bf16 v[156:159], v[112:115], v[104:107], v[156:159]
    v_exp_f32 v101, v101
    v_mfma_f32_16x16x32_bf16 v[184:187], v[116:119], v[104:107], v[184:187]
    s_add_u32 s28, s49, s95
    v_add_f32 v20, v20, v98
    v_add_f32 v21, v21, v99
    v_mfma_f32_16x16x32_bf16 v[212:215], v[120:123], v[104:107], v[212:215]
    v_cvt_pk_bf16_f32 v109, v98, v99
    v_mfma_f32_16x16x32_bf16 v[240:243], v[124:127], v[104:107], v[240:243]
    buffer_load_dwordx4 v26, s[16:19], s28 offen lds
    v_exp_f32 v102, v102
    v_mfma_f32_16x16x32_bf16 a[124:127], v[128:131], v[104:107], a[124:127]
    v_exp_f32 v103, v103
    v_mfma_f32_16x16x32_bf16 a[152:155], v[132:135], v[104:107], a[152:155]
    v_add_f32 v20, v20, v100
    v_add_f32 v21, v21, v101
    v_mfma_f32_16x16x32_bf16 a[180:183], v[136:139], v[104:107], a[180:183]
    v_cvt_pk_bf16_f32 v110, v100, v101
    v_add_f32 v20, v20, v102
    v_mfma_f32_16x16x32_bf16 a[208:211], v[140:143], v[104:107], a[208:211]
    v_add_f32 v21, v21, v103
    v_cvt_pk_bf16_f32 v111, v102, v103
    s_waitcnt vmcnt(16) lgkmcnt(0)
    s_barrier
    v_mfma_f32_16x16x32_bf16 v[96:99], v[56:59], a[96:99], v[52:55]
    ds_read_b128 v[56:59], v8 offset:16896
    v_mfma_f32_16x16x32_bf16 v[96:99], v[60:63], a[100:103], v[96:99]
    ds_read_b128 v[60:63], v8 offset:16960
    v_exp_f32 v88, v88
    v_mfma_f32_16x16x32_bf16 v[96:99], v[64:67], a[104:107], v[96:99]
    ds_read_b128 v[64:67], v8 offset:17024
    v_exp_f32 v89, v89
    v_mfma_f32_16x16x32_bf16 v[96:99], v[68:71], a[108:111], v[96:99]
    ds_read_b128 v[68:71], v8 offset:17088
    v_exp_f32 v90, v90
    v_mfma_f32_16x16x32_bf16 v[100:103], v[72:75], a[96:99], v[52:55]
    ds_read_b128 v[72:75], v8 offset:17408
    v_exp_f32 v91, v91
    v_mfma_f32_16x16x32_bf16 v[100:103], v[76:79], a[100:103], v[100:103]
    ds_read_b128 v[76:79], v8 offset:17472
    v_add_f32 v22, v22, v88
    v_add_f32 v23, v23, v89
    v_mfma_f32_16x16x32_bf16 v[100:103], v[80:83], a[104:107], v[100:103]
    ds_read_b128 v[80:83], v8 offset:17536
    v_cvt_pk_bf16_f32 v104, v88, v89
    v_mfma_f32_16x16x32_bf16 v[100:103], v[84:87], a[108:111], v[100:103]
    ds_read_b128 v[84:87], v8 offset:17600
    v_exp_f32 v92, v92
    v_mfma_f32_16x16x32_bf16 v[160:163], v[112:115], v[108:111], v[160:163]
    v_exp_f32 v93, v93
    v_mfma_f32_16x16x32_bf16 v[188:191], v[116:119], v[108:111], v[188:191]
    v_add_f32 v22, v22, v90
    v_add_f32 v23, v23, v91
    v_mfma_f32_16x16x32_bf16 v[216:219], v[120:123], v[108:111], v[216:219]
    v_cvt_pk_bf16_f32 v105, v90, v91
    v_mfma_f32_16x16x32_bf16 v[244:247], v[124:127], v[108:111], v[244:247]
    v_exp_f32 v94, v94
    v_mfma_f32_16x16x32_bf16 a[128:131], v[128:131], v[108:111], a[128:131]
    v_exp_f32 v95, v95
    v_mfma_f32_16x16x32_bf16 a[156:159], v[132:135], v[108:111], a[156:159]
    v_add_f32 v22, v22, v92
    v_add_f32 v23, v23, v93
    v_mfma_f32_16x16x32_bf16 a[184:187], v[136:139], v[108:111], a[184:187]
    v_cvt_pk_bf16_f32 v106, v92, v93
    v_add_f32 v22, v22, v94
    v_mfma_f32_16x16x32_bf16 a[212:215], v[140:143], v[108:111], a[212:215]
    v_add_f32 v23, v23, v95
    v_cvt_pk_bf16_f32 v107, v94, v95
    s_waitcnt lgkmcnt(0)
    v_mfma_f32_16x16x32_bf16 v[88:91], v[56:59], a[0:3], v[28:31]
    v_mfma_f32_16x16x32_bf16 v[88:91], v[60:63], a[4:7], v[88:91]
    v_exp_f32 v96, v96
    v_mfma_f32_16x16x32_bf16 v[88:91], v[64:67], a[8:11], v[88:91]
    v_exp_f32 v97, v97
    v_mfma_f32_16x16x32_bf16 v[88:91], v[68:71], a[12:15], v[88:91]
    v_exp_f32 v98, v98
    v_mfma_f32_16x16x32_bf16 v[92:95], v[72:75], a[0:3], v[28:31]
    v_exp_f32 v99, v99
    v_mfma_f32_16x16x32_bf16 v[92:95], v[76:79], a[4:7], v[92:95]
    v_add_f32 v24, v24, v96
    v_add_f32 v25, v25, v97
    v_mfma_f32_16x16x32_bf16 v[92:95], v[80:83], a[8:11], v[92:95]
    v_cvt_pk_bf16_f32 v108, v96, v97
    v_mfma_f32_16x16x32_bf16 v[92:95], v[84:87], a[12:15], v[92:95]
    v_exp_f32 v100, v100
    v_mfma_f32_16x16x32_bf16 v[164:167], v[112:115], v[104:107], v[164:167]
    v_exp_f32 v101, v101
    v_mfma_f32_16x16x32_bf16 v[192:195], v[116:119], v[104:107], v[192:195]
    v_add_f32 v24, v24, v98
    v_add_f32 v25, v25, v99
    v_mfma_f32_16x16x32_bf16 v[220:223], v[120:123], v[104:107], v[220:223]
    v_cvt_pk_bf16_f32 v109, v98, v99
    v_mfma_f32_16x16x32_bf16 v[248:251], v[124:127], v[104:107], v[248:251]
    v_exp_f32 v102, v102
    v_mfma_f32_16x16x32_bf16 a[132:135], v[128:131], v[104:107], a[132:135]
    v_exp_f32 v103, v103
    v_mfma_f32_16x16x32_bf16 a[160:163], v[132:135], v[104:107], a[160:163]
    v_add_f32 v24, v24, v100
    v_add_f32 v25, v25, v101
    v_mfma_f32_16x16x32_bf16 a[188:191], v[136:139], v[104:107], a[188:191]
    v_cvt_pk_bf16_f32 v110, v100, v101
    v_add_f32 v24, v24, v102
    v_mfma_f32_16x16x32_bf16 a[216:219], v[140:143], v[104:107], a[216:219]
    v_add_f32 v25, v25, v103
    v_cvt_pk_bf16_f32 v111, v102, v103
    v_mfma_f32_16x16x32_bf16 v[96:99], v[56:59], a[16:19], v[32:35]
    v_mfma_f32_16x16x32_bf16 v[96:99], v[60:63], a[20:23], v[96:99]
    v_exp_f32 v88, v88
    v_mfma_f32_16x16x32_bf16 v[96:99], v[64:67], a[24:27], v[96:99]
    v_exp_f32 v89, v89
    v_mfma_f32_16x16x32_bf16 v[96:99], v[68:71], a[28:31], v[96:99]
    v_exp_f32 v90, v90
    v_mfma_f32_16x16x32_bf16 v[100:103], v[72:75], a[16:19], v[32:35]
    v_exp_f32 v91, v91
    v_mfma_f32_16x16x32_bf16 v[100:103], v[76:79], a[20:23], v[100:103]
    v_add_f32 v12, v12, v88
    v_add_f32 v13, v13, v89
    v_mfma_f32_16x16x32_bf16 v[100:103], v[80:83], a[24:27], v[100:103]
    v_cvt_pk_bf16_f32 v104, v88, v89
    v_mfma_f32_16x16x32_bf16 v[100:103], v[84:87], a[28:31], v[100:103]
    v_exp_f32 v92, v92
    v_mfma_f32_16x16x32_bf16 v[168:171], v[112:115], v[108:111], v[168:171]
    ds_read_b64_tr_b16 v[112:113], v9 offset:16896
    ds_read_b64_tr_b16 v[114:115], v9 offset:17408
    v_exp_f32 v93, v93
    v_mfma_f32_16x16x32_bf16 v[196:199], v[116:119], v[108:111], v[196:199]
    ds_read_b64_tr_b16 v[116:117], v9 offset:16928
    ds_read_b64_tr_b16 v[118:119], v9 offset:17440
    v_add_f32 v12, v12, v90
    v_add_f32 v13, v13, v91
    v_mfma_f32_16x16x32_bf16 v[224:227], v[120:123], v[108:111], v[224:227]
    ds_read_b64_tr_b16 v[120:121], v9 offset:16960
    ds_read_b64_tr_b16 v[122:123], v9 offset:17472
    v_cvt_pk_bf16_f32 v105, v90, v91
    v_mfma_f32_16x16x32_bf16 v[252:255], v[124:127], v[108:111], v[252:255]
    ds_read_b64_tr_b16 v[124:125], v9 offset:16992
    ds_read_b64_tr_b16 v[126:127], v9 offset:17504
    v_exp_f32 v94, v94
    v_mfma_f32_16x16x32_bf16 a[136:139], v[128:131], v[108:111], a[136:139]
    ds_read_b64_tr_b16 v[128:129], v9 offset:17024
    ds_read_b64_tr_b16 v[130:131], v9 offset:17536
    v_exp_f32 v95, v95
    v_mfma_f32_16x16x32_bf16 a[164:167], v[132:135], v[108:111], a[164:167]
    ds_read_b64_tr_b16 v[132:133], v9 offset:17056
    ds_read_b64_tr_b16 v[134:135], v9 offset:17568
    v_add_f32 v12, v12, v92
    v_add_f32 v13, v13, v93
    v_mfma_f32_16x16x32_bf16 a[192:195], v[136:139], v[108:111], a[192:195]
    ds_read_b64_tr_b16 v[136:137], v9 offset:17088
    ds_read_b64_tr_b16 v[138:139], v9 offset:17600
    v_cvt_pk_bf16_f32 v106, v92, v93
    v_add_f32 v12, v12, v94
    v_mfma_f32_16x16x32_bf16 a[220:223], v[140:143], v[108:111], a[220:223]
    ds_read_b64_tr_b16 v[140:141], v9 offset:17120
    ds_read_b64_tr_b16 v[142:143], v9 offset:17632
    v_add_f32 v13, v13, v95
    v_cvt_pk_bf16_f32 v107, v94, v95
    v_mfma_f32_16x16x32_bf16 v[88:91], v[56:59], a[32:35], v[36:39]
    v_mfma_f32_16x16x32_bf16 v[88:91], v[60:63], a[36:39], v[88:91]
    s_add_u32 m0, s33, 8448
    v_exp_f32 v96, v96
    v_mfma_f32_16x16x32_bf16 v[88:91], v[64:67], a[40:43], v[88:91]
    v_exp_f32 v97, v97
    v_mfma_f32_16x16x32_bf16 v[88:91], v[68:71], a[44:47], v[88:91]
    s_mov_b32 s49, s50
    v_exp_f32 v98, v98
    v_mfma_f32_16x16x32_bf16 v[92:95], v[72:75], a[32:35], v[36:39]
    v_exp_f32 v99, v99
    v_mfma_f32_16x16x32_bf16 v[92:95], v[76:79], a[36:39], v[92:95]
    s_add_u32 s50, s50, s51
    v_add_f32 v14, v14, v96
    v_add_f32 v15, v15, v97
    v_mfma_f32_16x16x32_bf16 v[92:95], v[80:83], a[40:43], v[92:95]
    v_cvt_pk_bf16_f32 v108, v96, v97
    v_mfma_f32_16x16x32_bf16 v[92:95], v[84:87], a[44:47], v[92:95]
    s_add_u32 s82, s82, 1
    v_exp_f32 v100, v100
    s_waitcnt lgkmcnt(0)
    v_mfma_f32_16x16x32_bf16 v[144:147], v[112:115], v[104:107], v[144:147]
    v_exp_f32 v101, v101
    v_mfma_f32_16x16x32_bf16 v[172:175], v[116:119], v[104:107], v[172:175]
    s_cmp_eq_u32 s82, 20
    v_add_f32 v14, v14, v98
    v_add_f32 v15, v15, v99
    v_mfma_f32_16x16x32_bf16 v[200:203], v[120:123], v[104:107], v[200:203]
    v_cvt_pk_bf16_f32 v109, v98, v99
    v_mfma_f32_16x16x32_bf16 v[228:231], v[124:127], v[104:107], v[228:231]
    s_cselect_b32 s29, s83, 0
    v_exp_f32 v102, v102
    v_mfma_f32_16x16x32_bf16 a[112:115], v[128:131], v[104:107], a[112:115]
    v_exp_f32 v103, v103
    v_mfma_f32_16x16x32_bf16 a[140:143], v[132:135], v[104:107], a[140:143]
    s_sub_u32 s50, s50, s29
    v_add_f32 v14, v14, v100
    v_add_f32 v15, v15, v101
    v_mfma_f32_16x16x32_bf16 a[168:171], v[136:139], v[104:107], a[168:171]
    v_cvt_pk_bf16_f32 v110, v100, v101
    v_add_f32 v14, v14, v102
    v_mfma_f32_16x16x32_bf16 a[196:199], v[140:143], v[104:107], a[196:199]
    s_add_u32 s28, s49, s88
    v_add_f32 v15, v15, v103
    v_cvt_pk_bf16_f32 v111, v102, v103
    v_mfma_f32_16x16x32_bf16 v[96:99], v[56:59], a[48:51], v[40:43]
    v_mfma_f32_16x16x32_bf16 v[96:99], v[60:63], a[52:55], v[96:99]
    buffer_load_dwordx4 v26, s[16:19], s28 offen lds
    v_exp_f32 v88, v88
    v_mfma_f32_16x16x32_bf16 v[96:99], v[64:67], a[56:59], v[96:99]
    v_exp_f32 v89, v89
    v_mfma_f32_16x16x32_bf16 v[96:99], v[68:71], a[60:63], v[96:99]
    s_add_u32 m0, m0, s53
    v_exp_f32 v90, v90
    v_mfma_f32_16x16x32_bf16 v[100:103], v[72:75], a[48:51], v[40:43]
    v_exp_f32 v91, v91
    v_mfma_f32_16x16x32_bf16 v[100:103], v[76:79], a[52:55], v[100:103]
    s_add_u32 s28, s49, s89
    v_add_f32 v16, v16, v88
    v_add_f32 v17, v17, v89
    v_mfma_f32_16x16x32_bf16 v[100:103], v[80:83], a[56:59], v[100:103]
    v_cvt_pk_bf16_f32 v104, v88, v89
    v_mfma_f32_16x16x32_bf16 v[100:103], v[84:87], a[60:63], v[100:103]
    buffer_load_dwordx4 v26, s[16:19], s28 offen lds
    v_exp_f32 v92, v92
    v_mfma_f32_16x16x32_bf16 v[148:151], v[112:115], v[108:111], v[148:151]
    v_exp_f32 v93, v93
    v_mfma_f32_16x16x32_bf16 v[176:179], v[116:119], v[108:111], v[176:179]
    s_add_u32 m0, m0, s53
    v_add_f32 v16, v16, v90
    v_add_f32 v17, v17, v91
    v_mfma_f32_16x16x32_bf16 v[204:207], v[120:123], v[108:111], v[204:207]
    v_cvt_pk_bf16_f32 v105, v90, v91
    v_mfma_f32_16x16x32_bf16 v[232:235], v[124:127], v[108:111], v[232:235]
    s_add_u32 s28, s49, s90
    v_exp_f32 v94, v94
    v_mfma_f32_16x16x32_bf16 a[116:119], v[128:131], v[108:111], a[116:119]
    v_exp_f32 v95, v95
    v_mfma_f32_16x16x32_bf16 a[144:147], v[132:135], v[108:111], a[144:147]
    buffer_load_dwordx4 v26, s[16:19], s28 offen lds
    v_add_f32 v16, v16, v92
    v_add_f32 v17, v17, v93
    v_mfma_f32_16x16x32_bf16 a[172:175], v[136:139], v[108:111], a[172:175]
    v_cvt_pk_bf16_f32 v106, v92, v93
    v_add_f32 v16, v16, v94
    v_mfma_f32_16x16x32_bf16 a[200:203], v[140:143], v[108:111], a[200:203]
    s_add_u32 m0, m0, s53
    v_add_f32 v17, v17, v95
    v_cvt_pk_bf16_f32 v107, v94, v95
    v_mfma_f32_16x16x32_bf16 v[88:91], v[56:59], a[64:67], v[44:47]
    v_mfma_f32_16x16x32_bf16 v[88:91], v[60:63], a[68:71], v[88:91]
    s_add_u32 s28, s49, s91
    v_exp_f32 v96, v96
    v_mfma_f32_16x16x32_bf16 v[88:91], v[64:67], a[72:75], v[88:91]
    v_exp_f32 v97, v97
    v_mfma_f32_16x16x32_bf16 v[88:91], v[68:71], a[76:79], v[88:91]
    buffer_load_dwordx4 v26, s[16:19], s28 offen lds
    v_exp_f32 v98, v98
    v_mfma_f32_16x16x32_bf16 v[92:95], v[72:75], a[64:67], v[44:47]
    v_exp_f32 v99, v99
    v_mfma_f32_16x16x32_bf16 v[92:95], v[76:79], a[68:71], v[92:95]
    s_add_u32 m0, m0, s53
    v_add_f32 v18, v18, v96
    v_add_f32 v19, v19, v97
    v_mfma_f32_16x16x32_bf16 v[92:95], v[80:83], a[72:75], v[92:95]
    v_cvt_pk_bf16_f32 v108, v96, v97
    v_mfma_f32_16x16x32_bf16 v[92:95], v[84:87], a[76:79], v[92:95]
    s_add_u32 s28, s49, s92
    v_exp_f32 v100, v100
    v_mfma_f32_16x16x32_bf16 v[152:155], v[112:115], v[104:107], v[152:155]
    v_exp_f32 v101, v101
    v_mfma_f32_16x16x32_bf16 v[180:183], v[116:119], v[104:107], v[180:183]
    buffer_load_dwordx4 v26, s[16:19], s28 offen lds
    v_add_f32 v18, v18, v98
    v_add_f32 v19, v19, v99
    v_mfma_f32_16x16x32_bf16 v[208:211], v[120:123], v[104:107], v[208:211]
    v_cvt_pk_bf16_f32 v109, v98, v99
    v_mfma_f32_16x16x32_bf16 v[236:239], v[124:127], v[104:107], v[236:239]
    s_add_u32 m0, m0, s53
    v_exp_f32 v102, v102
    v_mfma_f32_16x16x32_bf16 a[120:123], v[128:131], v[104:107], a[120:123]
    v_exp_f32 v103, v103
    v_mfma_f32_16x16x32_bf16 a[148:151], v[132:135], v[104:107], a[148:151]
    s_add_u32 s28, s49, s93
    v_add_f32 v18, v18, v100
    v_add_f32 v19, v19, v101
    v_mfma_f32_16x16x32_bf16 a[176:179], v[136:139], v[104:107], a[176:179]
    v_cvt_pk_bf16_f32 v110, v100, v101
    v_add_f32 v18, v18, v102
    v_mfma_f32_16x16x32_bf16 a[204:207], v[140:143], v[104:107], a[204:207]
    buffer_load_dwordx4 v26, s[16:19], s28 offen lds
    v_add_f32 v19, v19, v103
    v_cvt_pk_bf16_f32 v111, v102, v103
    v_mfma_f32_16x16x32_bf16 v[96:99], v[56:59], a[80:83], v[48:51]
    v_mfma_f32_16x16x32_bf16 v[96:99], v[60:63], a[84:87], v[96:99]
    s_add_u32 m0, m0, s53
    v_exp_f32 v88, v88
    v_mfma_f32_16x16x32_bf16 v[96:99], v[64:67], a[88:91], v[96:99]
    v_exp_f32 v89, v89
    v_mfma_f32_16x16x32_bf16 v[96:99], v[68:71], a[92:95], v[96:99]
    s_add_u32 s28, s49, s94
    v_exp_f32 v90, v90
    v_mfma_f32_16x16x32_bf16 v[100:103], v[72:75], a[80:83], v[48:51]
    v_exp_f32 v91, v91
    v_mfma_f32_16x16x32_bf16 v[100:103], v[76:79], a[84:87], v[100:103]
    buffer_load_dwordx4 v26, s[16:19], s28 offen lds
    v_add_f32 v20, v20, v88
    v_add_f32 v21, v21, v89
    v_mfma_f32_16x16x32_bf16 v[100:103], v[80:83], a[88:91], v[100:103]
    v_cvt_pk_bf16_f32 v104, v88, v89
    v_mfma_f32_16x16x32_bf16 v[100:103], v[84:87], a[92:95], v[100:103]
    s_add_u32 m0, m0, s53
    v_exp_f32 v92, v92
    v_mfma_f32_16x16x32_bf16 v[156:159], v[112:115], v[108:111], v[156:159]
    v_exp_f32 v93, v93
    v_mfma_f32_16x16x32_bf16 v[184:187], v[116:119], v[108:111], v[184:187]
    s_add_u32 s28, s49, s95
    v_add_f32 v20, v20, v90
    v_add_f32 v21, v21, v91
    v_mfma_f32_16x16x32_bf16 v[212:215], v[120:123], v[108:111], v[212:215]
    v_cvt_pk_bf16_f32 v105, v90, v91
    v_mfma_f32_16x16x32_bf16 v[240:243], v[124:127], v[108:111], v[240:243]
    buffer_load_dwordx4 v26, s[16:19], s28 offen lds
    v_exp_f32 v94, v94
    v_mfma_f32_16x16x32_bf16 a[124:127], v[128:131], v[108:111], a[124:127]
    v_exp_f32 v95, v95
    v_mfma_f32_16x16x32_bf16 a[152:155], v[132:135], v[108:111], a[152:155]
    v_add_f32 v20, v20, v92
    v_add_f32 v21, v21, v93
    v_mfma_f32_16x16x32_bf16 a[180:183], v[136:139], v[108:111], a[180:183]
    v_cvt_pk_bf16_f32 v106, v92, v93
    v_add_f32 v20, v20, v94
    v_mfma_f32_16x16x32_bf16 a[208:211], v[140:143], v[108:111], a[208:211]
    v_add_f32 v21, v21, v95
    v_cvt_pk_bf16_f32 v107, v94, v95
    s_waitcnt vmcnt(16) lgkmcnt(0)
    s_barrier
    v_mfma_f32_16x16x32_bf16 v[88:91], v[56:59], a[96:99], v[52:55]
    ds_read_b128 v[56:59], v8 offset:25344
    v_mfma_f32_16x16x32_bf16 v[88:91], v[60:63], a[100:103], v[88:91]
    ds_read_b128 v[60:63], v8 offset:25408
    v_exp_f32 v96, v96
    v_mfma_f32_16x16x32_bf16 v[88:91], v[64:67], a[104:107], v[88:91]
    ds_read_b128 v[64:67], v8 offset:25472
    v_exp_f32 v97, v97
    v_mfma_f32_16x16x32_bf16 v[88:91], v[68:71], a[108:111], v[88:91]
    ds_read_b128 v[68:71], v8 offset:25536
    v_exp_f32 v98, v98
    v_mfma_f32_16x16x32_bf16 v[92:95], v[72:75], a[96:99], v[52:55]
    ds_read_b128 v[72:75], v8 offset:25856
    v_exp_f32 v99, v99
    v_mfma_f32_16x16x32_bf16 v[92:95], v[76:79], a[100:103], v[92:95]
    ds_read_b128 v[76:79], v8 offset:25920
    v_add_f32 v22, v22, v96
    v_add_f32 v23, v23, v97
    v_mfma_f32_16x16x32_bf16 v[92:95], v[80:83], a[104:107], v[92:95]
    ds_read_b128 v[80:83], v8 offset:25984
    v_cvt_pk_bf16_f32 v108, v96, v97
    v_mfma_f32_16x16x32_bf16 v[92:95], v[84:87], a[108:111], v[92:95]
    ds_read_b128 v[84:87], v8 offset:26048
    v_exp_f32 v100, v100
    v_mfma_f32_16x16x32_bf16 v[160:163], v[112:115], v[104:107], v[160:163]
    v_exp_f32 v101, v101
    v_mfma_f32_16x16x32_bf16 v[188:191], v[116:119], v[104:107], v[188:191]
    v_add_f32 v22, v22, v98
    v_add_f32 v23, v23, v99
    v_mfma_f32_16x16x32_bf16 v[216:219], v[120:123], v[104:107], v[216:219]
    v_cvt_pk_bf16_f32 v109, v98, v99
    v_mfma_f32_16x16x32_bf16 v[244:247], v[124:127], v[104:107], v[244:247]
    v_exp_f32 v102, v102
    v_mfma_f32_16x16x32_bf16 a[128:131], v[128:131], v[104:107], a[128:131]
    v_exp_f32 v103, v103
    v_mfma_f32_16x16x32_bf16 a[156:159], v[132:135], v[104:107], a[156:159]
    v_add_f32 v22, v22, v100
    v_add_f32 v23, v23, v101
    v_mfma_f32_16x16x32_bf16 a[184:187], v[136:139], v[104:107], a[184:187]
    v_cvt_pk_bf16_f32 v110, v100, v101
    v_add_f32 v22, v22, v102
    v_mfma_f32_16x16x32_bf16 a[212:215], v[140:143], v[104:107], a[212:215]
    v_add_f32 v23, v23, v103
    v_cvt_pk_bf16_f32 v111, v102, v103
    s_waitcnt lgkmcnt(0)
    v_mfma_f32_16x16x32_bf16 v[96:99], v[56:59], a[0:3], v[28:31]
    v_mfma_f32_16x16x32_bf16 v[96:99], v[60:63], a[4:7], v[96:99]
    v_exp_f32 v88, v88
    v_mfma_f32_16x16x32_bf16 v[96:99], v[64:67], a[8:11], v[96:99]
    v_exp_f32 v89, v89
    v_mfma_f32_16x16x32_bf16 v[96:99], v[68:71], a[12:15], v[96:99]
    v_exp_f32 v90, v90
    v_mfma_f32_16x16x32_bf16 v[100:103], v[72:75], a[0:3], v[28:31]
    v_exp_f32 v91, v91
    v_mfma_f32_16x16x32_bf16 v[100:103], v[76:79], a[4:7], v[100:103]
    v_add_f32 v24, v24, v88
    v_add_f32 v25, v25, v89
    v_mfma_f32_16x16x32_bf16 v[100:103], v[80:83], a[8:11], v[100:103]
    v_cvt_pk_bf16_f32 v104, v88, v89
    v_mfma_f32_16x16x32_bf16 v[100:103], v[84:87], a[12:15], v[100:103]
    v_exp_f32 v92, v92
    v_mfma_f32_16x16x32_bf16 v[164:167], v[112:115], v[108:111], v[164:167]
    v_exp_f32 v93, v93
    v_mfma_f32_16x16x32_bf16 v[192:195], v[116:119], v[108:111], v[192:195]
    v_add_f32 v24, v24, v90
    v_add_f32 v25, v25, v91
    v_mfma_f32_16x16x32_bf16 v[220:223], v[120:123], v[108:111], v[220:223]
    v_cvt_pk_bf16_f32 v105, v90, v91
    v_mfma_f32_16x16x32_bf16 v[248:251], v[124:127], v[108:111], v[248:251]
    v_exp_f32 v94, v94
    v_mfma_f32_16x16x32_bf16 a[132:135], v[128:131], v[108:111], a[132:135]
    v_exp_f32 v95, v95
    v_mfma_f32_16x16x32_bf16 a[160:163], v[132:135], v[108:111], a[160:163]
    v_add_f32 v24, v24, v92
    v_add_f32 v25, v25, v93
    v_mfma_f32_16x16x32_bf16 a[188:191], v[136:139], v[108:111], a[188:191]
    v_cvt_pk_bf16_f32 v106, v92, v93
    v_add_f32 v24, v24, v94
    v_mfma_f32_16x16x32_bf16 a[216:219], v[140:143], v[108:111], a[216:219]
    v_add_f32 v25, v25, v95
    v_cvt_pk_bf16_f32 v107, v94, v95
    v_mfma_f32_16x16x32_bf16 v[88:91], v[56:59], a[16:19], v[32:35]
    v_mfma_f32_16x16x32_bf16 v[88:91], v[60:63], a[20:23], v[88:91]
    v_exp_f32 v96, v96
    v_mfma_f32_16x16x32_bf16 v[88:91], v[64:67], a[24:27], v[88:91]
    v_exp_f32 v97, v97
    v_mfma_f32_16x16x32_bf16 v[88:91], v[68:71], a[28:31], v[88:91]
    v_exp_f32 v98, v98
    v_mfma_f32_16x16x32_bf16 v[92:95], v[72:75], a[16:19], v[32:35]
    v_exp_f32 v99, v99
    v_mfma_f32_16x16x32_bf16 v[92:95], v[76:79], a[20:23], v[92:95]
    v_add_f32 v12, v12, v96
    v_add_f32 v13, v13, v97
    v_mfma_f32_16x16x32_bf16 v[92:95], v[80:83], a[24:27], v[92:95]
    v_cvt_pk_bf16_f32 v108, v96, v97
    v_mfma_f32_16x16x32_bf16 v[92:95], v[84:87], a[28:31], v[92:95]
    v_exp_f32 v100, v100
    v_mfma_f32_16x16x32_bf16 v[168:171], v[112:115], v[104:107], v[168:171]
    ds_read_b64_tr_b16 v[112:113], v9 offset:25344
    ds_read_b64_tr_b16 v[114:115], v9 offset:25856
    v_exp_f32 v101, v101
    v_mfma_f32_16x16x32_bf16 v[196:199], v[116:119], v[104:107], v[196:199]
    ds_read_b64_tr_b16 v[116:117], v9 offset:25376
    ds_read_b64_tr_b16 v[118:119], v9 offset:25888
    v_add_f32 v12, v12, v98
    v_add_f32 v13, v13, v99
    v_mfma_f32_16x16x32_bf16 v[224:227], v[120:123], v[104:107], v[224:227]
    ds_read_b64_tr_b16 v[120:121], v9 offset:25408
    ds_read_b64_tr_b16 v[122:123], v9 offset:25920
    v_cvt_pk_bf16_f32 v109, v98, v99
    v_mfma_f32_16x16x32_bf16 v[252:255], v[124:127], v[104:107], v[252:255]
    ds_read_b64_tr_b16 v[124:125], v9 offset:25440
    ds_read_b64_tr_b16 v[126:127], v9 offset:25952
    v_exp_f32 v102, v102
    v_mfma_f32_16x16x32_bf16 a[136:139], v[128:131], v[104:107], a[136:139]
    ds_read_b64_tr_b16 v[128:129], v9 offset:25472
    ds_read_b64_tr_b16 v[130:131], v9 offset:25984
    v_exp_f32 v103, v103
    v_mfma_f32_16x16x32_bf16 a[164:167], v[132:135], v[104:107], a[164:167]
    ds_read_b64_tr_b16 v[132:133], v9 offset:25504
    ds_read_b64_tr_b16 v[134:135], v9 offset:26016
    v_add_f32 v12, v12, v100
    v_add_f32 v13, v13, v101
    v_mfma_f32_16x16x32_bf16 a[192:195], v[136:139], v[104:107], a[192:195]
    ds_read_b64_tr_b16 v[136:137], v9 offset:25536
    ds_read_b64_tr_b16 v[138:139], v9 offset:26048
    v_cvt_pk_bf16_f32 v110, v100, v101
    v_add_f32 v12, v12, v102
    v_mfma_f32_16x16x32_bf16 a[220:223], v[140:143], v[104:107], a[220:223]
    ds_read_b64_tr_b16 v[140:141], v9 offset:25568
    ds_read_b64_tr_b16 v[142:143], v9 offset:26080
    v_add_f32 v13, v13, v103
    v_cvt_pk_bf16_f32 v111, v102, v103
    v_mfma_f32_16x16x32_bf16 v[96:99], v[56:59], a[32:35], v[36:39]
    v_mfma_f32_16x16x32_bf16 v[96:99], v[60:63], a[36:39], v[96:99]
    s_add_u32 m0, s33, 16896
    v_exp_f32 v88, v88
    v_mfma_f32_16x16x32_bf16 v[96:99], v[64:67], a[40:43], v[96:99]
    v_exp_f32 v89, v89
    v_mfma_f32_16x16x32_bf16 v[96:99], v[68:71], a[44:47], v[96:99]
    s_mov_b32 s49, s50
    v_exp_f32 v90, v90
    v_mfma_f32_16x16x32_bf16 v[100:103], v[72:75], a[32:35], v[36:39]
    v_exp_f32 v91, v91
    v_mfma_f32_16x16x32_bf16 v[100:103], v[76:79], a[36:39], v[100:103]
    s_add_u32 s50, s50, s51
    v_add_f32 v14, v14, v88
    v_add_f32 v15, v15, v89
    v_mfma_f32_16x16x32_bf16 v[100:103], v[80:83], a[40:43], v[100:103]
    v_cvt_pk_bf16_f32 v104, v88, v89
    v_mfma_f32_16x16x32_bf16 v[100:103], v[84:87], a[44:47], v[100:103]
    s_add_u32 s82, s82, 1
    v_exp_f32 v92, v92
    s_waitcnt lgkmcnt(0)
    v_mfma_f32_16x16x32_bf16 v[144:147], v[112:115], v[108:111], v[144:147]
    v_exp_f32 v93, v93
    v_mfma_f32_16x16x32_bf16 v[172:175], v[116:119], v[108:111], v[172:175]
    s_cmp_eq_u32 s82, 20
    v_add_f32 v14, v14, v90
    v_add_f32 v15, v15, v91
    v_mfma_f32_16x16x32_bf16 v[200:203], v[120:123], v[108:111], v[200:203]
    v_cvt_pk_bf16_f32 v105, v90, v91
    v_mfma_f32_16x16x32_bf16 v[228:231], v[124:127], v[108:111], v[228:231]
    s_cselect_b32 s29, s83, 0
    v_exp_f32 v94, v94
    v_mfma_f32_16x16x32_bf16 a[112:115], v[128:131], v[108:111], a[112:115]
    v_exp_f32 v95, v95
    v_mfma_f32_16x16x32_bf16 a[140:143], v[132:135], v[108:111], a[140:143]
    s_sub_u32 s50, s50, s29
    v_add_f32 v14, v14, v92
    v_add_f32 v15, v15, v93
    v_mfma_f32_16x16x32_bf16 a[168:171], v[136:139], v[108:111], a[168:171]
    v_cvt_pk_bf16_f32 v106, v92, v93
    v_add_f32 v14, v14, v94
    v_mfma_f32_16x16x32_bf16 a[196:199], v[140:143], v[108:111], a[196:199]
    s_add_u32 s28, s49, s88
    v_add_f32 v15, v15, v95
    v_cvt_pk_bf16_f32 v107, v94, v95
    v_mfma_f32_16x16x32_bf16 v[88:91], v[56:59], a[48:51], v[40:43]
    v_mfma_f32_16x16x32_bf16 v[88:91], v[60:63], a[52:55], v[88:91]
    buffer_load_dwordx4 v26, s[16:19], s28 offen lds
    v_exp_f32 v96, v96
    v_mfma_f32_16x16x32_bf16 v[88:91], v[64:67], a[56:59], v[88:91]
    v_exp_f32 v97, v97
    v_mfma_f32_16x16x32_bf16 v[88:91], v[68:71], a[60:63], v[88:91]
    s_add_u32 m0, m0, s53
    v_exp_f32 v98, v98
    v_mfma_f32_16x16x32_bf16 v[92:95], v[72:75], a[48:51], v[40:43]
    v_exp_f32 v99, v99
    v_mfma_f32_16x16x32_bf16 v[92:95], v[76:79], a[52:55], v[92:95]
    s_add_u32 s28, s49, s89
    v_add_f32 v16, v16, v96
    v_add_f32 v17, v17, v97
    v_mfma_f32_16x16x32_bf16 v[92:95], v[80:83], a[56:59], v[92:95]
    v_cvt_pk_bf16_f32 v108, v96, v97
    v_mfma_f32_16x16x32_bf16 v[92:95], v[84:87], a[60:63], v[92:95]
    buffer_load_dwordx4 v26, s[16:19], s28 offen lds
    v_exp_f32 v100, v100
    v_mfma_f32_16x16x32_bf16 v[148:151], v[112:115], v[104:107], v[148:151]
    v_exp_f32 v101, v101
    v_mfma_f32_16x16x32_bf16 v[176:179], v[116:119], v[104:107], v[176:179]
    s_add_u32 m0, m0, s53
    v_add_f32 v16, v16, v98
    v_add_f32 v17, v17, v99
    v_mfma_f32_16x16x32_bf16 v[204:207], v[120:123], v[104:107], v[204:207]
    v_cvt_pk_bf16_f32 v109, v98, v99
    v_mfma_f32_16x16x32_bf16 v[232:235], v[124:127], v[104:107], v[232:235]
    s_add_u32 s28, s49, s90
    v_exp_f32 v102, v102
    v_mfma_f32_16x16x32_bf16 a[116:119], v[128:131], v[104:107], a[116:119]
    v_exp_f32 v103, v103
    v_mfma_f32_16x16x32_bf16 a[144:147], v[132:135], v[104:107], a[144:147]
    buffer_load_dwordx4 v26, s[16:19], s28 offen lds
    v_add_f32 v16, v16, v100
    v_add_f32 v17, v17, v101
    v_mfma_f32_16x16x32_bf16 a[172:175], v[136:139], v[104:107], a[172:175]
    v_cvt_pk_bf16_f32 v110, v100, v101
    v_add_f32 v16, v16, v102
    v_mfma_f32_16x16x32_bf16 a[200:203], v[140:143], v[104:107], a[200:203]
    s_add_u32 m0, m0, s53
    v_add_f32 v17, v17, v103
    v_cvt_pk_bf16_f32 v111, v102, v103
    v_mfma_f32_16x16x32_bf16 v[96:99], v[56:59], a[64:67], v[44:47]
    v_mfma_f32_16x16x32_bf16 v[96:99], v[60:63], a[68:71], v[96:99]
    s_add_u32 s28, s49, s91
    v_exp_f32 v88, v88
    v_mfma_f32_16x16x32_bf16 v[96:99], v[64:67], a[72:75], v[96:99]
    v_exp_f32 v89, v89
    v_mfma_f32_16x16x32_bf16 v[96:99], v[68:71], a[76:79], v[96:99]
    buffer_load_dwordx4 v26, s[16:19], s28 offen lds
    v_exp_f32 v90, v90
    v_mfma_f32_16x16x32_bf16 v[100:103], v[72:75], a[64:67], v[44:47]
    v_exp_f32 v91, v91
    v_mfma_f32_16x16x32_bf16 v[100:103], v[76:79], a[68:71], v[100:103]
    s_add_u32 m0, m0, s53
    v_add_f32 v18, v18, v88
    v_add_f32 v19, v19, v89
    v_mfma_f32_16x16x32_bf16 v[100:103], v[80:83], a[72:75], v[100:103]
    v_cvt_pk_bf16_f32 v104, v88, v89
    v_mfma_f32_16x16x32_bf16 v[100:103], v[84:87], a[76:79], v[100:103]
    s_add_u32 s28, s49, s92
    v_exp_f32 v92, v92
    v_mfma_f32_16x16x32_bf16 v[152:155], v[112:115], v[108:111], v[152:155]
    v_exp_f32 v93, v93
    v_mfma_f32_16x16x32_bf16 v[180:183], v[116:119], v[108:111], v[180:183]
    buffer_load_dwordx4 v26, s[16:19], s28 offen lds
    v_add_f32 v18, v18, v90
    v_add_f32 v19, v19, v91
    v_mfma_f32_16x16x32_bf16 v[208:211], v[120:123], v[108:111], v[208:211]
    v_cvt_pk_bf16_f32 v105, v90, v91
    v_mfma_f32_16x16x32_bf16 v[236:239], v[124:127], v[108:111], v[236:239]
    s_add_u32 m0, m0, s53
    v_exp_f32 v94, v94
    v_mfma_f32_16x16x32_bf16 a[120:123], v[128:131], v[108:111], a[120:123]
    v_exp_f32 v95, v95
    v_mfma_f32_16x16x32_bf16 a[148:151], v[132:135], v[108:111], a[148:151]
    s_add_u32 s28, s49, s93
    v_add_f32 v18, v18, v92
    v_add_f32 v19, v19, v93
    v_mfma_f32_16x16x32_bf16 a[176:179], v[136:139], v[108:111], a[176:179]
    v_cvt_pk_bf16_f32 v106, v92, v93
    v_add_f32 v18, v18, v94
    v_mfma_f32_16x16x32_bf16 a[204:207], v[140:143], v[108:111], a[204:207]
    buffer_load_dwordx4 v26, s[16:19], s28 offen lds
    v_add_f32 v19, v19, v95
    v_cvt_pk_bf16_f32 v107, v94, v95
    v_mfma_f32_16x16x32_bf16 v[88:91], v[56:59], a[80:83], v[48:51]
    v_mfma_f32_16x16x32_bf16 v[88:91], v[60:63], a[84:87], v[88:91]
    s_add_u32 m0, m0, s53
    v_exp_f32 v96, v96
    v_mfma_f32_16x16x32_bf16 v[88:91], v[64:67], a[88:91], v[88:91]
    v_exp_f32 v97, v97
    v_mfma_f32_16x16x32_bf16 v[88:91], v[68:71], a[92:95], v[88:91]
    s_add_u32 s28, s49, s94
    v_exp_f32 v98, v98
    v_mfma_f32_16x16x32_bf16 v[92:95], v[72:75], a[80:83], v[48:51]
    v_exp_f32 v99, v99
    v_mfma_f32_16x16x32_bf16 v[92:95], v[76:79], a[84:87], v[92:95]
    buffer_load_dwordx4 v26, s[16:19], s28 offen lds
    v_add_f32 v20, v20, v96
    v_add_f32 v21, v21, v97
    v_mfma_f32_16x16x32_bf16 v[92:95], v[80:83], a[88:91], v[92:95]
    v_cvt_pk_bf16_f32 v108, v96, v97
    v_mfma_f32_16x16x32_bf16 v[92:95], v[84:87], a[92:95], v[92:95]
    s_add_u32 m0, m0, s53
    v_exp_f32 v100, v100
    v_mfma_f32_16x16x32_bf16 v[156:159], v[112:115], v[104:107], v[156:159]
    v_exp_f32 v101, v101
    v_mfma_f32_16x16x32_bf16 v[184:187], v[116:119], v[104:107], v[184:187]
    s_add_u32 s28, s49, s95
    v_add_f32 v20, v20, v98
    v_add_f32 v21, v21, v99
    v_mfma_f32_16x16x32_bf16 v[212:215], v[120:123], v[104:107], v[212:215]
    v_cvt_pk_bf16_f32 v109, v98, v99
    v_mfma_f32_16x16x32_bf16 v[240:243], v[124:127], v[104:107], v[240:243]
    buffer_load_dwordx4 v26, s[16:19], s28 offen lds
    v_exp_f32 v102, v102
    v_mfma_f32_16x16x32_bf16 a[124:127], v[128:131], v[104:107], a[124:127]
    v_exp_f32 v103, v103
    v_mfma_f32_16x16x32_bf16 a[152:155], v[132:135], v[104:107], a[152:155]
    v_add_f32 v20, v20, v100
    v_add_f32 v21, v21, v101
    v_mfma_f32_16x16x32_bf16 a[180:183], v[136:139], v[104:107], a[180:183]
    v_cvt_pk_bf16_f32 v110, v100, v101
    v_add_f32 v20, v20, v102
    v_mfma_f32_16x16x32_bf16 a[208:211], v[140:143], v[104:107], a[208:211]
    v_add_f32 v21, v21, v103
    v_cvt_pk_bf16_f32 v111, v102, v103
    s_waitcnt vmcnt(16) lgkmcnt(0)
    s_barrier
    v_mfma_f32_16x16x32_bf16 v[96:99], v[56:59], a[96:99], v[52:55]
    s_add_u32 m0, s33, 25344
    v_mfma_f32_16x16x32_bf16 v[96:99], v[60:63], a[100:103], v[96:99]
    s_mov_b32 s49, s50
    v_exp_f32 v88, v88
    v_mfma_f32_16x16x32_bf16 v[96:99], v[64:67], a[104:107], v[96:99]
    s_add_u32 s50, s50, s51
    v_exp_f32 v89, v89
    v_mfma_f32_16x16x32_bf16 v[96:99], v[68:71], a[108:111], v[96:99]
    s_add_u32 s82, s82, 1
    v_exp_f32 v90, v90
    v_mfma_f32_16x16x32_bf16 v[100:103], v[72:75], a[96:99], v[52:55]
    s_cmp_eq_u32 s82, 20
    v_exp_f32 v91, v91
    v_mfma_f32_16x16x32_bf16 v[100:103], v[76:79], a[100:103], v[100:103]
    s_cselect_b32 s29, s83, 0
    v_add_f32 v22, v22, v88
    v_add_f32 v23, v23, v89
    v_mfma_f32_16x16x32_bf16 v[100:103], v[80:83], a[104:107], v[100:103]
    s_sub_u32 s50, s50, s29
    v_cvt_pk_bf16_f32 v104, v88, v89
    v_mfma_f32_16x16x32_bf16 v[100:103], v[84:87], a[108:111], v[100:103]
    v_exp_f32 v92, v92
    v_mfma_f32_16x16x32_bf16 v[160:163], v[112:115], v[108:111], v[160:163]
    s_add_u32 s28, s49, s88
    v_exp_f32 v93, v93
    v_mfma_f32_16x16x32_bf16 v[188:191], v[116:119], v[108:111], v[188:191]
    buffer_load_dwordx4 v26, s[16:19], s28 offen lds
    v_add_f32 v22, v22, v90
    v_add_f32 v23, v23, v91
    v_mfma_f32_16x16x32_bf16 v[216:219], v[120:123], v[108:111], v[216:219]
    s_add_u32 m0, m0, s53
    v_cvt_pk_bf16_f32 v105, v90, v91
    v_mfma_f32_16x16x32_bf16 v[244:247], v[124:127], v[108:111], v[244:247]
    s_add_u32 s28, s49, s89
    v_exp_f32 v94, v94
    v_mfma_f32_16x16x32_bf16 a[128:131], v[128:131], v[108:111], a[128:131]
    buffer_load_dwordx4 v26, s[16:19], s28 offen lds
    v_exp_f32 v95, v95
    v_mfma_f32_16x16x32_bf16 a[156:159], v[132:135], v[108:111], a[156:159]
    s_add_u32 m0, m0, s53
    v_add_f32 v22, v22, v92
    v_add_f32 v23, v23, v93
    v_mfma_f32_16x16x32_bf16 a[184:187], v[136:139], v[108:111], a[184:187]
    s_add_u32 s28, s49, s90
    v_cvt_pk_bf16_f32 v106, v92, v93
    v_add_f32 v22, v22, v94
    v_mfma_f32_16x16x32_bf16 a[212:215], v[140:143], v[108:111], a[212:215]
    buffer_load_dwordx4 v26, s[16:19], s28 offen lds
    v_add_f32 v23, v23, v95
    v_cvt_pk_bf16_f32 v107, v94, v95
    s_nop 1
    v_mfma_f32_16x16x32_bf16 v[164:167], v[112:115], v[104:107], v[164:167]
    s_add_u32 m0, m0, s53
    s_add_u32 s28, s49, s91
    v_exp_f32 v96, v96
    v_mfma_f32_16x16x32_bf16 v[192:195], v[116:119], v[104:107], v[192:195]
    buffer_load_dwordx4 v26, s[16:19], s28 offen lds
    s_add_u32 m0, m0, s53
    v_exp_f32 v97, v97
    v_exp_f32 v98, v98
    v_mfma_f32_16x16x32_bf16 v[220:223], v[120:123], v[104:107], v[220:223]
    s_add_u32 s28, s49, s92
    buffer_load_dwordx4 v26, s[16:19], s28 offen lds
    v_exp_f32 v99, v99
    v_add_f32 v24, v24, v96
    v_add_f32 v25, v25, v97
    v_mfma_f32_16x16x32_bf16 v[248:251], v[124:127], v[104:107], v[248:251]
    s_add_u32 m0, m0, s53
    v_cvt_pk_bf16_f32 v108, v96, v97
    v_exp_f32 v100, v100
    v_mfma_f32_16x16x32_bf16 a[132:135], v[128:131], v[104:107], a[132:135]
    s_add_u32 s28, s49, s93
    buffer_load_dwordx4 v26, s[16:19], s28 offen lds
    v_exp_f32 v101, v101
    v_add_f32 v24, v24, v98
    v_add_f32 v25, v25, v99
    v_mfma_f32_16x16x32_bf16 a[160:163], v[132:135], v[104:107], a[160:163]
    s_add_u32 m0, m0, s53
    s_add_u32 s28, s49, s94
    v_cvt_pk_bf16_f32 v109, v98, v99
    v_exp_f32 v102, v102
    v_mfma_f32_16x16x32_bf16 a[188:191], v[136:139], v[104:107], a[188:191]
    buffer_load_dwordx4 v26, s[16:19], s28 offen lds
    s_add_u32 m0, m0, s53
    v_exp_f32 v103, v103
    v_add_f32 v24, v24, v100
    v_add_f32 v25, v25, v101
    v_mfma_f32_16x16x32_bf16 a[216:219], v[140:143], v[104:107], a[216:219]
    s_add_u32 s28, s49, s95
    buffer_load_dwordx4 v26, s[16:19], s28 offen lds
    v_cvt_pk_bf16_f32 v110, v100, v101
    v_add_f32 v24, v24, v102
    v_add_f32 v25, v25, v103
    v_cvt_pk_bf16_f32 v111, v102, v103
    s_branch L_at_aepi
L_at_atailB:
    v_mfma_f32_16x16x32_bf16 v[88:91], v[56:59], a[16:19], v[32:35]
    v_mfma_f32_16x16x32_bf16 v[88:91], v[60:63], a[20:23], v[88:91]
    v_exp_f32 v96, v96
    v_mfma_f32_16x16x32_bf16 v[88:91], v[64:67], a[24:27], v[88:91]
    v_exp_f32 v97, v97
    v_mfma_f32_16x16x32_bf16 v[88:91], v[68:71], a[28:31], v[88:91]
    v_exp_f32 v98, v98
    v_mfma_f32_16x16x32_bf16 v[92:95], v[72:75], a[16:19], v[32:35]
    v_exp_f32 v99, v99
    v_mfma_f32_16x16x32_bf16 v[92:95], v[76:79], a[20:23], v[92:95]
    v_add_f32 v12, v12, v96
    v_add_f32 v13, v13, v97
    v_mfma_f32_16x16x32_bf16 v[92:95], v[80:83], a[24:27], v[92:95]
    v_cvt_pk_bf16_f32 v108, v96, v97
    v_mfma_f32_16x16x32_bf16 v[92:95], v[84:87], a[28:31], v[92:95]
    v_exp_f32 v100, v100
    v_mfma_f32_16x16x32_bf16 v[168:171], v[112:115], v[104:107], v[168:171]
    ds_read_b64_tr_b16 v[112:113], v9 offset:8448
    ds_read_b64_tr_b16 v[114:115], v9 offset:8960
    v_exp_f32 v101, v101
    v_mfma_f32_16x16x32_bf16 v[196:199], v[116:119], v[104:107], v[196:199]
    ds_read_b64_tr_b16 v[116:117], v9 offset:8480
    ds_read_b64_tr_b16 v[118:119], v9 offset:8992
    v_add_f32 v12, v12, v98
    v_add_f32 v13, v13, v99
    v_mfma_f32_16x16x32_bf16 v[224:227], v[120:123], v[104:107], v[224:227]
    ds_read_b64_tr_b16 v[120:121], v9 offset:8512
    ds_read_b64_tr_b16 v[122:123], v9 offset:9024
    v_cvt_pk_bf16_f32 v109, v98, v99
    v_mfma_f32_16x16x32_bf16 v[252:255], v[124:127], v[104:107], v[252:255]
    ds_read_b64_tr_b16 v[124:125], v9 offset:8544
    ds_read_b64_tr_b16 v[126:127], v9 offset:9056
    v_exp_f32 v102, v102
    v_mfma_f32_16x16x32_bf16 a[136:139], v[128:131], v[104:107], a[136:139]
    ds_read_b64_tr_b16 v[128:129], v9 offset:8576
    ds_read_b64_tr_b16 v[130:131], v9 offset:9088
    v_exp_f32 v103, v103
    v_mfma_f32_16x16x32_bf16 a[164:167], v[132:135], v[104:107], a[164:167]
    ds_read_b64_tr_b16 v[132:133], v9 offset:8608
    ds_read_b64_tr_b16 v[134:135], v9 offset:9120
    v_add_f32 v12, v12, v100
    v_add_f32 v13, v13, v101
    v_mfma_f32_16x16x32_bf16 a[192:195], v[136:139], v[104:107], a[192:195]
    ds_read_b64_tr_b16 v[136:137], v9 offset:8640
    ds_read_b64_tr_b16 v[138:139], v9 offset:9152
    v_cvt_pk_bf16_f32 v110, v100, v101
    v_add_f32 v12, v12, v102
    v_mfma_f32_16x16x32_bf16 a[220:223], v[140:143], v[104:107], a[220:223]
    ds_read_b64_tr_b16 v[140:141], v9 offset:8672
    ds_read_b64_tr_b16 v[142:143], v9 offset:9184
    v_add_f32 v13, v13, v103
    v_cvt_pk_bf16_f32 v111, v102, v103
    v_mfma_f32_16x16x32_bf16 v[96:99], v[56:59], a[32:35], v[36:39]
    v_mfma_f32_16x16x32_bf16 v[96:99], v[60:63], a[36:39], v[96:99]
    s_add_u32 s29, s34, s100
    v_exp_f32 v88, v88
    v_mfma_f32_16x16x32_bf16 v[96:99], v[64:67], a[40:43], v[96:99]
    v_exp_f32 v89, v89
    v_mfma_f32_16x16x32_bf16 v[96:99], v[68:71], a[44:47], v[96:99]
    s_bfe_u32 s28, s29, 0x20003
    v_exp_f32 v90, v90
    v_mfma_f32_16x16x32_bf16 v[100:103], v[72:75], a[32:35], v[36:39]
    v_exp_f32 v91, v91
    v_mfma_f32_16x16x32_bf16 v[100:103], v[76:79], a[36:39], v[100:103]
    s_lshl_b32 s28, s28, 16
    v_add_f32 v14, v14, v88
    v_add_f32 v15, v15, v89
    v_mfma_f32_16x16x32_bf16 v[100:103], v[80:83], a[40:43], v[100:103]
    v_cvt_pk_bf16_f32 v104, v88, v89
    v_mfma_f32_16x16x32_bf16 v[100:103], v[84:87], a[44:47], v[100:103]
    v_exp_f32 v92, v92
    s_waitcnt lgkmcnt(0)
    v_mfma_f32_16x16x32_bf16 v[144:147], v[112:115], v[108:111], v[144:147]
    s_and_b32 s29, s29, 7
    v_exp_f32 v93, v93
    v_mfma_f32_16x16x32_bf16 v[172:175], v[116:119], v[108:111], v[172:175]
    v_add_f32 v14, v14, v90
    v_add_f32 v15, v15, v91
    v_mfma_f32_16x16x32_bf16 v[200:203], v[120:123], v[108:111], v[200:203]
    s_lshl_b32 s29, s29, 11
    v_cvt_pk_bf16_f32 v105, v90, v91
    v_mfma_f32_16x16x32_bf16 v[228:231], v[124:127], v[108:111], v[228:231]
    v_exp_f32 v94, v94
    v_mfma_f32_16x16x32_bf16 a[112:115], v[128:131], v[108:111], a[112:115]
    s_add_u32 s29, s28, s29
    v_exp_f32 v95, v95
    v_mfma_f32_16x16x32_bf16 a[140:143], v[132:135], v[108:111], a[140:143]
    v_add_f32 v14, v14, v92
    v_add_f32 v15, v15, v93
    v_mfma_f32_16x16x32_bf16 a[168:171], v[136:139], v[108:111], a[168:171]
    s_lshr_b32 s28, s34, 5
    v_cvt_pk_bf16_f32 v106, v92, v93
    v_add_f32 v14, v14, v94
    v_mfma_f32_16x16x32_bf16 a[196:199], v[140:143], v[108:111], a[196:199]
    v_add_f32 v15, v15, v95
    v_cvt_pk_bf16_f32 v107, v94, v95
    v_mfma_f32_16x16x32_bf16 v[88:91], v[56:59], a[48:51], v[40:43]
    v_mfma_f32_16x16x32_bf16 v[88:91], v[60:63], a[52:55], v[88:91]
    s_lshl_b32 s28, s28, 19
    v_exp_f32 v96, v96
    v_mfma_f32_16x16x32_bf16 v[88:91], v[64:67], a[56:59], v[88:91]
    v_exp_f32 v97, v97
    v_mfma_f32_16x16x32_bf16 v[88:91], v[68:71], a[60:63], v[88:91]
    s_add_u32 s49, s28, s29
    v_exp_f32 v98, v98
    v_mfma_f32_16x16x32_bf16 v[92:95], v[72:75], a[48:51], v[40:43]
    v_exp_f32 v99, v99
    v_mfma_f32_16x16x32_bf16 v[92:95], v[76:79], a[52:55], v[92:95]
    s_add_u32 m0, s33, 0
    v_add_f32 v16, v16, v96
    v_add_f32 v17, v17, v97
    v_mfma_f32_16x16x32_bf16 v[92:95], v[80:83], a[56:59], v[92:95]
    v_cvt_pk_bf16_f32 v108, v96, v97
    v_mfma_f32_16x16x32_bf16 v[92:95], v[84:87], a[60:63], v[92:95]
    v_exp_f32 v100, v100
    v_mfma_f32_16x16x32_bf16 v[148:151], v[112:115], v[104:107], v[148:151]
    s_add_u32 s34, s34, 1
    v_exp_f32 v101, v101
    v_mfma_f32_16x16x32_bf16 v[176:179], v[116:119], v[104:107], v[176:179]
    v_add_f32 v16, v16, v98
    v_add_f32 v17, v17, v99
    v_mfma_f32_16x16x32_bf16 v[204:207], v[120:123], v[104:107], v[204:207]
    buffer_load_dwordx4 v7, s[4:7], s49 offen offset:0 nt lds
    v_cvt_pk_bf16_f32 v109, v98, v99
    v_mfma_f32_16x16x32_bf16 v[232:235], v[124:127], v[104:107], v[232:235]
    v_exp_f32 v102, v102
    v_mfma_f32_16x16x32_bf16 a[116:119], v[128:131], v[104:107], a[116:119]
    s_add_u32 m0, m0, s96
    v_exp_f32 v103, v103
    v_mfma_f32_16x16x32_bf16 a[144:147], v[132:135], v[104:107], a[144:147]
    v_add_f32 v16, v16, v100
    v_add_f32 v17, v17, v101
    v_mfma_f32_16x16x32_bf16 a[172:175], v[136:139], v[104:107], a[172:175]
    buffer_load_dwordx4 v7, s[4:7], s49 offen offset:256 nt lds
    v_cvt_pk_bf16_f32 v110, v100, v101
    v_add_f32 v16, v16, v102
    v_mfma_f32_16x16x32_bf16 a[200:203], v[140:143], v[104:107], a[200:203]
    v_add_f32 v17, v17, v103
    v_cvt_pk_bf16_f32 v111, v102, v103
    v_mfma_f32_16x16x32_bf16 v[96:99], v[56:59], a[64:67], v[44:47]
    v_mfma_f32_16x16x32_bf16 v[96:99], v[60:63], a[68:71], v[96:99]
    s_add_u32 m0, m0, s97
    v_exp_f32 v88, v88
    v_mfma_f32_16x16x32_bf16 v[96:99], v[64:67], a[72:75], v[96:99]
    v_exp_f32 v89, v89
    v_mfma_f32_16x16x32_bf16 v[96:99], v[68:71], a[76:79], v[96:99]
    buffer_load_dwordx4 v7, s[4:7], s49 offen offset:512 nt lds
    v_exp_f32 v90, v90
    v_mfma_f32_16x16x32_bf16 v[100:103], v[72:75], a[64:67], v[44:47]
    v_exp_f32 v91, v91
    v_mfma_f32_16x16x32_bf16 v[100:103], v[76:79], a[68:71], v[100:103]
    s_add_u32 m0, m0, s96
    v_add_f32 v18, v18, v88
    v_add_f32 v19, v19, v89
    v_mfma_f32_16x16x32_bf16 v[100:103], v[80:83], a[72:75], v[100:103]
    v_cvt_pk_bf16_f32 v104, v88, v89
    v_mfma_f32_16x16x32_bf16 v[100:103], v[84:87], a[76:79], v[100:103]
    v_exp_f32 v92, v92
    v_mfma_f32_16x16x32_bf16 v[152:155], v[112:115], v[108:111], v[152:155]
    buffer_load_dwordx4 v7, s[4:7], s49 offen offset:768 nt lds
    v_exp_f32 v93, v93
    v_mfma_f32_16x16x32_bf16 v[180:183], v[116:119], v[108:111], v[180:183]
    v_add_f32 v18, v18, v90
    v_add_f32 v19, v19, v91
    v_mfma_f32_16x16x32_bf16 v[208:211], v[120:123], v[108:111], v[208:211]
    s_add_u32 m0, m0, s97
    v_cvt_pk_bf16_f32 v105, v90, v91
    v_mfma_f32_16x16x32_bf16 v[236:239], v[124:127], v[108:111], v[236:239]
    v_exp_f32 v94, v94
    v_mfma_f32_16x16x32_bf16 a[120:123], v[128:131], v[108:111], a[120:123]
    buffer_load_dwordx4 v7, s[4:7], s49 offen offset:1024 nt lds
    v_exp_f32 v95, v95
    v_mfma_f32_16x16x32_bf16 a[148:151], v[132:135], v[108:111], a[148:151]
    v_add_f32 v18, v18, v92
    v_add_f32 v19, v19, v93
    v_mfma_f32_16x16x32_bf16 a[176:179], v[136:139], v[108:111], a[176:179]
    s_add_u32 m0, m0, s96
    v_cvt_pk_bf16_f32 v106, v92, v93
    v_add_f32 v18, v18, v94
    v_mfma_f32_16x16x32_bf16 a[204:207], v[140:143], v[108:111], a[204:207]
    v_add_f32 v19, v19, v95
    v_cvt_pk_bf16_f32 v107, v94, v95
    v_mfma_f32_16x16x32_bf16 v[88:91], v[56:59], a[80:83], v[48:51]
    v_mfma_f32_16x16x32_bf16 v[88:91], v[60:63], a[84:87], v[88:91]
    buffer_load_dwordx4 v7, s[4:7], s49 offen offset:1280 nt lds
    v_exp_f32 v96, v96
    v_mfma_f32_16x16x32_bf16 v[88:91], v[64:67], a[88:91], v[88:91]
    v_exp_f32 v97, v97
    v_mfma_f32_16x16x32_bf16 v[88:91], v[68:71], a[92:95], v[88:91]
    s_add_u32 m0, m0, s97
    v_exp_f32 v98, v98
    v_mfma_f32_16x16x32_bf16 v[92:95], v[72:75], a[80:83], v[48:51]
    v_exp_f32 v99, v99
    v_mfma_f32_16x16x32_bf16 v[92:95], v[76:79], a[84:87], v[92:95]
    buffer_load_dwordx4 v7, s[4:7], s49 offen offset:1536 nt lds
    v_add_f32 v20, v20, v96
    v_add_f32 v21, v21, v97
    v_mfma_f32_16x16x32_bf16 v[92:95], v[80:83], a[88:91], v[92:95]
    v_cvt_pk_bf16_f32 v108, v96, v97
    v_mfma_f32_16x16x32_bf16 v[92:95], v[84:87], a[92:95], v[92:95]
    v_exp_f32 v100, v100
    v_mfma_f32_16x16x32_bf16 v[156:159], v[112:115], v[104:107], v[156:159]
    s_add_u32 m0, m0, s96
    v_exp_f32 v101, v101
    v_mfma_f32_16x16x32_bf16 v[184:187], v[116:119], v[104:107], v[184:187]
    v_add_f32 v20, v20, v98
    v_add_f32 v21, v21, v99
    v_mfma_f32_16x16x32_bf16 v[212:215], v[120:123], v[104:107], v[212:215]
    buffer_load_dwordx4 v7, s[4:7], s49 offen offset:1792 nt lds
    v_cvt_pk_bf16_f32 v109, v98, v99
    v_mfma_f32_16x16x32_bf16 v[240:243], v[124:127], v[104:107], v[240:243]
    v_exp_f32 v102, v102
    v_mfma_f32_16x16x32_bf16 a[124:127], v[128:131], v[104:107], a[124:127]
    v_exp_f32 v103, v103
    v_mfma_f32_16x16x32_bf16 a[152:155], v[132:135], v[104:107], a[152:155]
    v_add_f32 v20, v20, v100
    v_add_f32 v21, v21, v101
    v_mfma_f32_16x16x32_bf16 a[180:183], v[136:139], v[104:107], a[180:183]
    v_cvt_pk_bf16_f32 v110, v100, v101
    v_add_f32 v20, v20, v102
    v_mfma_f32_16x16x32_bf16 a[208:211], v[140:143], v[104:107], a[208:211]
    v_add_f32 v21, v21, v103
    v_cvt_pk_bf16_f32 v111, v102, v103
    s_waitcnt vmcnt(16) lgkmcnt(0)
    s_barrier
    v_mfma_f32_16x16x32_bf16 v[96:99], v[56:59], a[96:99], v[52:55]
    ds_read_b128 v[56:59], v8 offset:16896
    v_mfma_f32_16x16x32_bf16 v[96:99], v[60:63], a[100:103], v[96:99]
    ds_read_b128 v[60:63], v8 offset:16960
    v_exp_f32 v88, v88
    v_mfma_f32_16x16x32_bf16 v[96:99], v[64:67], a[104:107], v[96:99]
    ds_read_b128 v[64:67], v8 offset:17024
    v_exp_f32 v89, v89
    v_mfma_f32_16x16x32_bf16 v[96:99], v[68:71], a[108:111], v[96:99]
    ds_read_b128 v[68:71], v8 offset:17088
    v_exp_f32 v90, v90
    v_mfma_f32_16x16x32_bf16 v[100:103], v[72:75], a[96:99], v[52:55]
    ds_read_b128 v[72:75], v8 offset:17408
    v_exp_f32 v91, v91
    v_mfma_f32_16x16x32_bf16 v[100:103], v[76:79], a[100:103], v[100:103]
    ds_read_b128 v[76:79], v8 offset:17472
    v_add_f32 v22, v22, v88
    v_add_f32 v23, v23, v89
    v_mfma_f32_16x16x32_bf16 v[100:103], v[80:83], a[104:107], v[100:103]
    ds_read_b128 v[80:83], v8 offset:17536
    v_cvt_pk_bf16_f32 v104, v88, v89
    v_mfma_f32_16x16x32_bf16 v[100:103], v[84:87], a[108:111], v[100:103]
    ds_read_b128 v[84:87], v8 offset:17600
    v_exp_f32 v92, v92
    v_mfma_f32_16x16x32_bf16 v[160:163], v[112:115], v[108:111], v[160:163]
    v_exp_f32 v93, v93
    v_mfma_f32_16x16x32_bf16 v[188:191], v[116:119], v[108:111], v[188:191]
    v_add_f32 v22, v22, v90
    v_add_f32 v23, v23, v91
    v_mfma_f32_16x16x32_bf16 v[216:219], v[120:123], v[108:111], v[216:219]
    v_cvt_pk_bf16_f32 v105, v90, v91
    v_mfma_f32_16x16x32_bf16 v[244:247], v[124:127], v[108:111], v[244:247]
    v_exp_f32 v94, v94
    v_mfma_f32_16x16x32_bf16 a[128:131], v[128:131], v[108:111], a[128:131]
    v_exp_f32 v95, v95
    v_mfma_f32_16x16x32_bf16 a[156:159], v[132:135], v[108:111], a[156:159]
    v_add_f32 v22, v22, v92
    v_add_f32 v23, v23, v93
    v_mfma_f32_16x16x32_bf16 a[184:187], v[136:139], v[108:111], a[184:187]
    v_cvt_pk_bf16_f32 v106, v92, v93
    v_add_f32 v22, v22, v94
    v_mfma_f32_16x16x32_bf16 a[212:215], v[140:143], v[108:111], a[212:215]
    v_add_f32 v23, v23, v95
    v_cvt_pk_bf16_f32 v107, v94, v95
    s_waitcnt lgkmcnt(0)
    v_mfma_f32_16x16x32_bf16 v[88:91], v[56:59], a[0:3], v[28:31]
    v_mfma_f32_16x16x32_bf16 v[88:91], v[60:63], a[4:7], v[88:91]
    v_exp_f32 v96, v96
    v_mfma_f32_16x16x32_bf16 v[88:91], v[64:67], a[8:11], v[88:91]
    v_exp_f32 v97, v97
    v_mfma_f32_16x16x32_bf16 v[88:91], v[68:71], a[12:15], v[88:91]
    v_exp_f32 v98, v98
    v_mfma_f32_16x16x32_bf16 v[92:95], v[72:75], a[0:3], v[28:31]
    v_exp_f32 v99, v99
    v_mfma_f32_16x16x32_bf16 v[92:95], v[76:79], a[4:7], v[92:95]
    v_add_f32 v24, v24, v96
    v_add_f32 v25, v25, v97
    v_mfma_f32_16x16x32_bf16 v[92:95], v[80:83], a[8:11], v[92:95]
    v_cvt_pk_bf16_f32 v108, v96, v97
    v_mfma_f32_16x16x32_bf16 v[92:95], v[84:87], a[12:15], v[92:95]
    v_exp_f32 v100, v100
    v_mfma_f32_16x16x32_bf16 v[164:167], v[112:115], v[104:107], v[164:167]
    v_exp_f32 v101, v101
    v_mfma_f32_16x16x32_bf16 v[192:195], v[116:119], v[104:107], v[192:195]
    v_add_f32 v24, v24, v98
    v_add_f32 v25, v25, v99
    v_mfma_f32_16x16x32_bf16 v[220:223], v[120:123], v[104:107], v[220:223]
    v_cvt_pk_bf16_f32 v109, v98, v99
    v_mfma_f32_16x16x32_bf16 v[248:251], v[124:127], v[104:107], v[248:251]
    v_exp_f32 v102, v102
    v_mfma_f32_16x16x32_bf16 a[132:135], v[128:131], v[104:107], a[132:135]
    v_exp_f32 v103, v103
    v_mfma_f32_16x16x32_bf16 a[160:163], v[132:135], v[104:107], a[160:163]
    v_add_f32 v24, v24, v100
    v_add_f32 v25, v25, v101
    v_mfma_f32_16x16x32_bf16 a[188:191], v[136:139], v[104:107], a[188:191]
    v_cvt_pk_bf16_f32 v110, v100, v101
    v_add_f32 v24, v24, v102
    v_mfma_f32_16x16x32_bf16 a[216:219], v[140:143], v[104:107], a[216:219]
    v_add_f32 v25, v25, v103
    v_cvt_pk_bf16_f32 v111, v102, v103
    v_mfma_f32_16x16x32_bf16 v[96:99], v[56:59], a[16:19], v[32:35]
    v_mfma_f32_16x16x32_bf16 v[96:99], v[60:63], a[20:23], v[96:99]
    v_exp_f32 v88, v88
    v_mfma_f32_16x16x32_bf16 v[96:99], v[64:67], a[24:27], v[96:99]
    v_exp_f32 v89, v89
    v_mfma_f32_16x16x32_bf16 v[96:99], v[68:71], a[28:31], v[96:99]
    v_exp_f32 v90, v90
    v_mfma_f32_16x16x32_bf16 v[100:103], v[72:75], a[16:19], v[32:35]
    v_exp_f32 v91, v91
    v_mfma_f32_16x16x32_bf16 v[100:103], v[76:79], a[20:23], v[100:103]
    v_add_f32 v12, v12, v88
    v_add_f32 v13, v13, v89
    v_mfma_f32_16x16x32_bf16 v[100:103], v[80:83], a[24:27], v[100:103]
    v_cvt_pk_bf16_f32 v104, v88, v89
    v_mfma_f32_16x16x32_bf16 v[100:103], v[84:87], a[28:31], v[100:103]
    v_exp_f32 v92, v92
    v_mfma_f32_16x16x32_bf16 v[168:171], v[112:115], v[108:111], v[168:171]
    ds_read_b64_tr_b16 v[112:113], v9 offset:16896
    ds_read_b64_tr_b16 v[114:115], v9 offset:17408
    v_exp_f32 v93, v93
    v_mfma_f32_16x16x32_bf16 v[196:199], v[116:119], v[108:111], v[196:199]
    ds_read_b64_tr_b16 v[116:117], v9 offset:16928
    ds_read_b64_tr_b16 v[118:119], v9 offset:17440
    v_add_f32 v12, v12, v90
    v_add_f32 v13, v13, v91
    v_mfma_f32_16x16x32_bf16 v[224:227], v[120:123], v[108:111], v[224:227]
    ds_read_b64_tr_b16 v[120:121], v9 offset:16960
    ds_read_b64_tr_b16 v[122:123], v9 offset:17472
    v_cvt_pk_bf16_f32 v105, v90, v91
    v_mfma_f32_16x16x32_bf16 v[252:255], v[124:127], v[108:111], v[252:255]
    ds_read_b64_tr_b16 v[124:125], v9 offset:16992
    ds_read_b64_tr_b16 v[126:127], v9 offset:17504
    v_exp_f32 v94, v94
    v_mfma_f32_16x16x32_bf16 a[136:139], v[128:131], v[108:111], a[136:139]
    ds_read_b64_tr_b16 v[128:129], v9 offset:17024
    ds_read_b64_tr_b16 v[130:131], v9 offset:17536
    v_exp_f32 v95, v95
    v_mfma_f32_16x16x32_bf16 a[164:167], v[132:135], v[108:111], a[164:167]
    ds_read_b64_tr_b16 v[132:133], v9 offset:17056
    ds_read_b64_tr_b16 v[134:135], v9 offset:17568
    v_add_f32 v12, v12, v92
    v_add_f32 v13, v13, v93
    v_mfma_f32_16x16x32_bf16 a[192:195], v[136:139], v[108:111], a[192:195]
    ds_read_b64_tr_b16 v[136:137], v9 offset:17088
    ds_read_b64_tr_b16 v[138:139], v9 offset:17600
    v_cvt_pk_bf16_f32 v106, v92, v93
    v_add_f32 v12, v12, v94
    v_mfma_f32_16x16x32_bf16 a[220:223], v[140:143], v[108:111], a[220:223]
    ds_read_b64_tr_b16 v[140:141], v9 offset:17120
    ds_read_b64_tr_b16 v[142:143], v9 offset:17632
    v_add_f32 v13, v13, v95
    v_cvt_pk_bf16_f32 v107, v94, v95
    v_mfma_f32_16x16x32_bf16 v[88:91], v[56:59], a[32:35], v[36:39]
    v_mfma_f32_16x16x32_bf16 v[88:91], v[60:63], a[36:39], v[88:91]
    s_add_u32 s29, s34, s100
    v_exp_f32 v96, v96
    v_mfma_f32_16x16x32_bf16 v[88:91], v[64:67], a[40:43], v[88:91]
    v_exp_f32 v97, v97
    v_mfma_f32_16x16x32_bf16 v[88:91], v[68:71], a[44:47], v[88:91]
    s_bfe_u32 s28, s29, 0x20003
    v_exp_f32 v98, v98
    v_mfma_f32_16x16x32_bf16 v[92:95], v[72:75], a[32:35], v[36:39]
    v_exp_f32 v99, v99
    v_mfma_f32_16x16x32_bf16 v[92:95], v[76:79], a[36:39], v[92:95]
    s_lshl_b32 s28, s28, 16
    v_add_f32 v14, v14, v96
    v_add_f32 v15, v15, v97
    v_mfma_f32_16x16x32_bf16 v[92:95], v[80:83], a[40:43], v[92:95]
    v_cvt_pk_bf16_f32 v108, v96, v97
    v_mfma_f32_16x16x32_bf16 v[92:95], v[84:87], a[44:47], v[92:95]
    v_exp_f32 v100, v100
    s_waitcnt lgkmcnt(0)
    v_mfma_f32_16x16x32_bf16 v[144:147], v[112:115], v[104:107], v[144:147]
    s_and_b32 s29, s29, 7
    v_exp_f32 v101, v101
    v_mfma_f32_16x16x32_bf16 v[172:175], v[116:119], v[104:107], v[172:175]
    v_add_f32 v14, v14, v98
    v_add_f32 v15, v15, v99
    v_mfma_f32_16x16x32_bf16 v[200:203], v[120:123], v[104:107], v[200:203]
    s_lshl_b32 s29, s29, 11
    v_cvt_pk_bf16_f32 v109, v98, v99
    v_mfma_f32_16x16x32_bf16 v[228:231], v[124:127], v[104:107], v[228:231]
    v_exp_f32 v102, v102
    v_mfma_f32_16x16x32_bf16 a[112:115], v[128:131], v[104:107], a[112:115]
    s_add_u32 s29, s28, s29
    v_exp_f32 v103, v103
    v_mfma_f32_16x16x32_bf16 a[140:143], v[132:135], v[104:107], a[140:143]
    v_add_f32 v14, v14, v100
    v_add_f32 v15, v15, v101
    v_mfma_f32_16x16x32_bf16 a[168:171], v[136:139], v[104:107], a[168:171]
    s_lshr_b32 s28, s34, 5
    v_cvt_pk_bf16_f32 v110, v100, v101
    v_add_f32 v14, v14, v102
    v_mfma_f32_16x16x32_bf16 a[196:199], v[140:143], v[104:107], a[196:199]
    v_add_f32 v15, v15, v103
    v_cvt_pk_bf16_f32 v111, v102, v103
    v_mfma_f32_16x16x32_bf16 v[96:99], v[56:59], a[48:51], v[40:43]
    v_mfma_f32_16x16x32_bf16 v[96:99], v[60:63], a[52:55], v[96:99]
    s_lshl_b32 s28, s28, 19
    v_exp_f32 v88, v88
    v_mfma_f32_16x16x32_bf16 v[96:99], v[64:67], a[56:59], v[96:99]
    v_exp_f32 v89, v89
    v_mfma_f32_16x16x32_bf16 v[96:99], v[68:71], a[60:63], v[96:99]
    s_add_u32 s49, s28, s29
    v_exp_f32 v90, v90
    v_mfma_f32_16x16x32_bf16 v[100:103], v[72:75], a[48:51], v[40:43]
    v_exp_f32 v91, v91
    v_mfma_f32_16x16x32_bf16 v[100:103], v[76:79], a[52:55], v[100:103]
    s_add_u32 m0, s33, 8448
    v_add_f32 v16, v16, v88
    v_add_f32 v17, v17, v89
    v_mfma_f32_16x16x32_bf16 v[100:103], v[80:83], a[56:59], v[100:103]
    v_cvt_pk_bf16_f32 v104, v88, v89
    v_mfma_f32_16x16x32_bf16 v[100:103], v[84:87], a[60:63], v[100:103]
    v_exp_f32 v92, v92
    v_mfma_f32_16x16x32_bf16 v[148:151], v[112:115], v[108:111], v[148:151]
    s_add_u32 s34, s34, 1
    v_exp_f32 v93, v93
    v_mfma_f32_16x16x32_bf16 v[176:179], v[116:119], v[108:111], v[176:179]
    v_add_f32 v16, v16, v90
    v_add_f32 v17, v17, v91
    v_mfma_f32_16x16x32_bf16 v[204:207], v[120:123], v[108:111], v[204:207]
    buffer_load_dwordx4 v7, s[4:7], s49 offen offset:0 nt lds
    v_cvt_pk_bf16_f32 v105, v90, v91
    v_mfma_f32_16x16x32_bf16 v[232:235], v[124:127], v[108:111], v[232:235]
    v_exp_f32 v94, v94
    v_mfma_f32_16x16x32_bf16 a[116:119], v[128:131], v[108:111], a[116:119]
    s_add_u32 m0, m0, s96
    v_exp_f32 v95, v95
    v_mfma_f32_16x16x32_bf16 a[144:147], v[132:135], v[108:111], a[144:147]
    v_add_f32 v16, v16, v92
    v_add_f32 v17, v17, v93
    v_mfma_f32_16x16x32_bf16 a[172:175], v[136:139], v[108:111], a[172:175]
    buffer_load_dwordx4 v7, s[4:7], s49 offen offset:256 nt lds
    v_cvt_pk_bf16_f32 v106, v92, v93
    v_add_f32 v16, v16, v94
    v_mfma_f32_16x16x32_bf16 a[200:203], v[140:143], v[108:111], a[200:203]
    v_add_f32 v17, v17, v95
    v_cvt_pk_bf16_f32 v107, v94, v95
    v_mfma_f32_16x16x32_bf16 v[88:91], v[56:59], a[64:67], v[44:47]
    v_mfma_f32_16x16x32_bf16 v[88:91], v[60:63], a[68:71], v[88:91]
    s_add_u32 m0, m0, s97
    v_exp_f32 v96, v96
    v_mfma_f32_16x16x32_bf16 v[88:91], v[64:67], a[72:75], v[88:91]
    v_exp_f32 v97, v97
    v_mfma_f32_16x16x32_bf16 v[88:91], v[68:71], a[76:79], v[88:91]
    buffer_load_dwordx4 v7, s[4:7], s49 offen offset:512 nt lds
    v_exp_f32 v98, v98
    v_mfma_f32_16x16x32_bf16 v[92:95], v[72:75], a[64:67], v[44:47]
    v_exp_f32 v99, v99
    v_mfma_f32_16x16x32_bf16 v[92:95], v[76:79], a[68:71], v[92:95]
    s_add_u32 m0, m0, s96
    v_add_f32 v18, v18, v96
    v_add_f32 v19, v19, v97
    v_mfma_f32_16x16x32_bf16 v[92:95], v[80:83], a[72:75], v[92:95]
    v_cvt_pk_bf16_f32 v108, v96, v97
    v_mfma_f32_16x16x32_bf16 v[92:95], v[84:87], a[76:79], v[92:95]
    v_exp_f32 v100, v100
    v_mfma_f32_16x16x32_bf16 v[152:155], v[112:115], v[104:107], v[152:155]
    buffer_load_dwordx4 v7, s[4:7], s49 offen offset:768 nt lds
    v_exp_f32 v101, v101
    v_mfma_f32_16x16x32_bf16 v[180:183], v[116:119], v[104:107], v[180:183]
    v_add_f32 v18, v18, v98
    v_add_f32 v19, v19, v99
    v_mfma_f32_16x16x32_bf16 v[208:211], v[120:123], v[104:107], v[208:211]
    s_add_u32 m0, m0, s97
    v_cvt_pk_bf16_f32 v109, v98, v99
    v_mfma_f32_16x16x32_bf16 v[236:239], v[124:127], v[104:107], v[236:239]
    v_exp_f32 v102, v102
    v_mfma_f32_16x16x32_bf16 a[120:123], v[128:131], v[104:107], a[120:123]
    buffer_load_dwordx4 v7, s[4:7], s49 offen offset:1024 nt lds
    v_exp_f32 v103, v103
    v_mfma_f32_16x16x32_bf16 a[148:151], v[132:135], v[104:107], a[148:151]
    v_add_f32 v18, v18, v100
    v_add_f32 v19, v19, v101
    v_mfma_f32_16x16x32_bf16 a[176:179], v[136:139], v[104:107], a[176:179]
    s_add_u32 m0, m0, s96
    v_cvt_pk_bf16_f32 v110, v100, v101
    v_add_f32 v18, v18, v102
    v_mfma_f32_16x16x32_bf16 a[204:207], v[140:143], v[104:107], a[204:207]
    v_add_f32 v19, v19, v103
    v_cvt_pk_bf16_f32 v111, v102, v103
    v_mfma_f32_16x16x32_bf16 v[96:99], v[56:59], a[80:83], v[48:51]
    v_mfma_f32_16x16x32_bf16 v[96:99], v[60:63], a[84:87], v[96:99]
    buffer_load_dwordx4 v7, s[4:7], s49 offen offset:1280 nt lds
    v_exp_f32 v88, v88
    v_mfma_f32_16x16x32_bf16 v[96:99], v[64:67], a[88:91], v[96:99]
    v_exp_f32 v89, v89
    v_mfma_f32_16x16x32_bf16 v[96:99], v[68:71], a[92:95], v[96:99]
    s_add_u32 m0, m0, s97
    v_exp_f32 v90, v90
    v_mfma_f32_16x16x32_bf16 v[100:103], v[72:75], a[80:83], v[48:51]
    v_exp_f32 v91, v91
    v_mfma_f32_16x16x32_bf16 v[100:103], v[76:79], a[84:87], v[100:103]
    buffer_load_dwordx4 v7, s[4:7], s49 offen offset:1536 nt lds
    v_add_f32 v20, v20, v88
    v_add_f32 v21, v21, v89
    v_mfma_f32_16x16x32_bf16 v[100:103], v[80:83], a[88:91], v[100:103]
    v_cvt_pk_bf16_f32 v104, v88, v89
    v_mfma_f32_16x16x32_bf16 v[100:103], v[84:87], a[92:95], v[100:103]
    v_exp_f32 v92, v92
    v_mfma_f32_16x16x32_bf16 v[156:159], v[112:115], v[108:111], v[156:159]
    s_add_u32 m0, m0, s96
    v_exp_f32 v93, v93
    v_mfma_f32_16x16x32_bf16 v[184:187], v[116:119], v[108:111], v[184:187]
    v_add_f32 v20, v20, v90
    v_add_f32 v21, v21, v91
    v_mfma_f32_16x16x32_bf16 v[212:215], v[120:123], v[108:111], v[212:215]
    buffer_load_dwordx4 v7, s[4:7], s49 offen offset:1792 nt lds
    v_cvt_pk_bf16_f32 v105, v90, v91
    v_mfma_f32_16x16x32_bf16 v[240:243], v[124:127], v[108:111], v[240:243]
    v_exp_f32 v94, v94
    v_mfma_f32_16x16x32_bf16 a[124:127], v[128:131], v[108:111], a[124:127]
    v_exp_f32 v95, v95
    v_mfma_f32_16x16x32_bf16 a[152:155], v[132:135], v[108:111], a[152:155]
    v_add_f32 v20, v20, v92
    v_add_f32 v21, v21, v93
    v_mfma_f32_16x16x32_bf16 a[180:183], v[136:139], v[108:111], a[180:183]
    v_cvt_pk_bf16_f32 v106, v92, v93
    v_add_f32 v20, v20, v94
    v_mfma_f32_16x16x32_bf16 a[208:211], v[140:143], v[108:111], a[208:211]
    v_add_f32 v21, v21, v95
    v_cvt_pk_bf16_f32 v107, v94, v95
    s_waitcnt vmcnt(16) lgkmcnt(0)
    s_barrier
    v_mfma_f32_16x16x32_bf16 v[88:91], v[56:59], a[96:99], v[52:55]
    ds_read_b128 v[56:59], v8 offset:25344
    v_mfma_f32_16x16x32_bf16 v[88:91], v[60:63], a[100:103], v[88:91]
    ds_read_b128 v[60:63], v8 offset:25408
    v_exp_f32 v96, v96
    v_mfma_f32_16x16x32_bf16 v[88:91], v[64:67], a[104:107], v[88:91]
    ds_read_b128 v[64:67], v8 offset:25472
    v_exp_f32 v97, v97
    v_mfma_f32_16x16x32_bf16 v[88:91], v[68:71], a[108:111], v[88:91]
    ds_read_b128 v[68:71], v8 offset:25536
    v_exp_f32 v98, v98
    v_mfma_f32_16x16x32_bf16 v[92:95], v[72:75], a[96:99], v[52:55]
    ds_read_b128 v[72:75], v8 offset:25856
    v_exp_f32 v99, v99
    v_mfma_f32_16x16x32_bf16 v[92:95], v[76:79], a[100:103], v[92:95]
    ds_read_b128 v[76:79], v8 offset:25920
    v_add_f32 v22, v22, v96
    v_add_f32 v23, v23, v97
    v_mfma_f32_16x16x32_bf16 v[92:95], v[80:83], a[104:107], v[92:95]
    ds_read_b128 v[80:83], v8 offset:25984
    v_cvt_pk_bf16_f32 v108, v96, v97
    v_mfma_f32_16x16x32_bf16 v[92:95], v[84:87], a[108:111], v[92:95]
    ds_read_b128 v[84:87], v8 offset:26048
    v_exp_f32 v100, v100
    v_mfma_f32_16x16x32_bf16 v[160:163], v[112:115], v[104:107], v[160:163]
    v_exp_f32 v101, v101
    v_mfma_f32_16x16x32_bf16 v[188:191], v[116:119], v[104:107], v[188:191]
    v_add_f32 v22, v22, v98
    v_add_f32 v23, v23, v99
    v_mfma_f32_16x16x32_bf16 v[216:219], v[120:123], v[104:107], v[216:219]
    v_cvt_pk_bf16_f32 v109, v98, v99
    v_mfma_f32_16x16x32_bf16 v[244:247], v[124:127], v[104:107], v[244:247]
    v_exp_f32 v102, v102
    v_mfma_f32_16x16x32_bf16 a[128:131], v[128:131], v[104:107], a[128:131]
    v_exp_f32 v103, v103
    v_mfma_f32_16x16x32_bf16 a[156:159], v[132:135], v[104:107], a[156:159]
    v_add_f32 v22, v22, v100
    v_add_f32 v23, v23, v101
    v_mfma_f32_16x16x32_bf16 a[184:187], v[136:139], v[104:107], a[184:187]
    v_cvt_pk_bf16_f32 v110, v100, v101
    v_add_f32 v22, v22, v102
    v_mfma_f32_16x16x32_bf16 a[212:215], v[140:143], v[104:107], a[212:215]
    v_add_f32 v23, v23, v103
    v_cvt_pk_bf16_f32 v111, v102, v103
    s_waitcnt lgkmcnt(0)
    v_mfma_f32_16x16x32_bf16 v[96:99], v[56:59], a[0:3], v[28:31]
    v_mfma_f32_16x16x32_bf16 v[96:99], v[60:63], a[4:7], v[96:99]
    v_exp_f32 v88, v88
    v_mfma_f32_16x16x32_bf16 v[96:99], v[64:67], a[8:11], v[96:99]
    v_exp_f32 v89, v89
    v_mfma_f32_16x16x32_bf16 v[96:99], v[68:71], a[12:15], v[96:99]
    v_exp_f32 v90, v90
    v_mfma_f32_16x16x32_bf16 v[100:103], v[72:75], a[0:3], v[28:31]
    v_exp_f32 v91, v91
    v_mfma_f32_16x16x32_bf16 v[100:103], v[76:79], a[4:7], v[100:103]
    v_add_f32 v24, v24, v88
    v_add_f32 v25, v25, v89
    v_mfma_f32_16x16x32_bf16 v[100:103], v[80:83], a[8:11], v[100:103]
    v_cvt_pk_bf16_f32 v104, v88, v89
    v_mfma_f32_16x16x32_bf16 v[100:103], v[84:87], a[12:15], v[100:103]
    v_exp_f32 v92, v92
    v_mfma_f32_16x16x32_bf16 v[164:167], v[112:115], v[108:111], v[164:167]
    v_exp_f32 v93, v93
    v_mfma_f32_16x16x32_bf16 v[192:195], v[116:119], v[108:111], v[192:195]
    v_add_f32 v24, v24, v90
    v_add_f32 v25, v25, v91
    v_mfma_f32_16x16x32_bf16 v[220:223], v[120:123], v[108:111], v[220:223]
    v_cvt_pk_bf16_f32 v105, v90, v91
    v_mfma_f32_16x16x32_bf16 v[248:251], v[124:127], v[108:111], v[248:251]
    v_exp_f32 v94, v94
    v_mfma_f32_16x16x32_bf16 a[132:135], v[128:131], v[108:111], a[132:135]
    v_exp_f32 v95, v95
    v_mfma_f32_16x16x32_bf16 a[160:163], v[132:135], v[108:111], a[160:163]
    v_add_f32 v24, v24, v92
    v_add_f32 v25, v25, v93
    v_mfma_f32_16x16x32_bf16 a[188:191], v[136:139], v[108:111], a[188:191]
    v_cvt_pk_bf16_f32 v106, v92, v93
    v_add_f32 v24, v24, v94
    v_mfma_f32_16x16x32_bf16 a[216:219], v[140:143], v[108:111], a[216:219]
    v_add_f32 v25, v25, v95
    v_cvt_pk_bf16_f32 v107, v94, v95
    v_mfma_f32_16x16x32_bf16 v[88:91], v[56:59], a[16:19], v[32:35]
    v_mfma_f32_16x16x32_bf16 v[88:91], v[60:63], a[20:23], v[88:91]
    v_exp_f32 v96, v96
    v_mfma_f32_16x16x32_bf16 v[88:91], v[64:67], a[24:27], v[88:91]
    v_exp_f32 v97, v97
    v_mfma_f32_16x16x32_bf16 v[88:91], v[68:71], a[28:31], v[88:91]
    v_exp_f32 v98, v98
    v_mfma_f32_16x16x32_bf16 v[92:95], v[72:75], a[16:19], v[32:35]
    v_exp_f32 v99, v99
    v_mfma_f32_16x16x32_bf16 v[92:95], v[76:79], a[20:23], v[92:95]
    v_add_f32 v12, v12, v96
    v_add_f32 v13, v13, v97
    v_mfma_f32_16x16x32_bf16 v[92:95], v[80:83], a[24:27], v[92:95]
    v_cvt_pk_bf16_f32 v108, v96, v97
    v_mfma_f32_16x16x32_bf16 v[92:95], v[84:87], a[28:31], v[92:95]
    v_exp_f32 v100, v100
    v_mfma_f32_16x16x32_bf16 v[168:171], v[112:115], v[104:107], v[168:171]
    ds_read_b64_tr_b16 v[112:113], v9 offset:25344
    ds_read_b64_tr_b16 v[114:115], v9 offset:25856
    v_exp_f32 v101, v101
    v_mfma_f32_16x16x32_bf16 v[196:199], v[116:119], v[104:107], v[196:199]
    ds_read_b64_tr_b16 v[116:117], v9 offset:25376
    ds_read_b64_tr_b16 v[118:119], v9 offset:25888
    v_add_f32 v12, v12, v98
    v_add_f32 v13, v13, v99
    v_mfma_f32_16x16x32_bf16 v[224:227], v[120:123], v[104:107], v[224:227]
    ds_read_b64_tr_b16 v[120:121], v9 offset:25408
    ds_read_b64_tr_b16 v[122:123], v9 offset:25920
    v_cvt_pk_bf16_f32 v109, v98, v99
    v_mfma_f32_16x16x32_bf16 v[252:255], v[124:127], v[104:107], v[252:255]
    ds_read_b64_tr_b16 v[124:125], v9 offset:25440
    ds_read_b64_tr_b16 v[126:127], v9 offset:25952
    v_exp_f32 v102, v102
    v_mfma_f32_16x16x32_bf16 a[136:139], v[128:131], v[104:107], a[136:139]
    ds_read_b64_tr_b16 v[128:129], v9 offset:25472
    ds_read_b64_tr_b16 v[130:131], v9 offset:25984
    v_exp_f32 v103, v103
    v_mfma_f32_16x16x32_bf16 a[164:167], v[132:135], v[104:107], a[164:167]
    ds_read_b64_tr_b16 v[132:133], v9 offset:25504
    ds_read_b64_tr_b16 v[134:135], v9 offset:26016
    v_add_f32 v12, v12, v100
    v_add_f32 v13, v13, v101
    v_mfma_f32_16x16x32_bf16 a[192:195], v[136:139], v[104:107], a[192:195]
    ds_read_b64_tr_b16 v[136:137], v9 offset:25536
    ds_read_b64_tr_b16 v[138:139], v9 offset:26048
    v_cvt_pk_bf16_f32 v110, v100, v101
    v_add_f32 v12, v12, v102
    v_mfma_f32_16x16x32_bf16 a[220:223], v[140:143], v[104:107], a[220:223]
    ds_read_b64_tr_b16 v[140:141], v9 offset:25568
    ds_read_b64_tr_b16 v[142:143], v9 offset:26080
    v_add_f32 v13, v13, v103
    v_cvt_pk_bf16_f32 v111, v102, v103
    v_mfma_f32_16x16x32_bf16 v[96:99], v[56:59], a[32:35], v[36:39]
    v_mfma_f32_16x16x32_bf16 v[96:99], v[60:63], a[36:39], v[96:99]
    s_add_u32 s29, s34, s100
    v_exp_f32 v88, v88
    v_mfma_f32_16x16x32_bf16 v[96:99], v[64:67], a[40:43], v[96:99]
    v_exp_f32 v89, v89
    v_mfma_f32_16x16x32_bf16 v[96:99], v[68:71], a[44:47], v[96:99]
    s_bfe_u32 s28, s29, 0x20003
    v_exp_f32 v90, v90
    v_mfma_f32_16x16x32_bf16 v[100:103], v[72:75], a[32:35], v[36:39]
    v_exp_f32 v91, v91
    v_mfma_f32_16x16x32_bf16 v[100:103], v[76:79], a[36:39], v[100:103]
    s_lshl_b32 s28, s28, 16
    v_add_f32 v14, v14, v88
    v_add_f32 v15, v15, v89
    v_mfma_f32_16x16x32_bf16 v[100:103], v[80:83], a[40:43], v[100:103]
    v_cvt_pk_bf16_f32 v104, v88, v89
    v_mfma_f32_16x16x32_bf16 v[100:103], v[84:87], a[44:47], v[100:103]
    v_exp_f32 v92, v92
    s_waitcnt lgkmcnt(0)
    v_mfma_f32_16x16x32_bf16 v[144:147], v[112:115], v[108:111], v[144:147]
    s_and_b32 s29, s29, 7
    v_exp_f32 v93, v93
    v_mfma_f32_16x16x32_bf16 v[172:175], v[116:119], v[108:111], v[172:175]
    v_add_f32 v14, v14, v90
    v_add_f32 v15, v15, v91
    v_mfma_f32_16x16x32_bf16 v[200:203], v[120:123], v[108:111], v[200:203]
    s_lshl_b32 s29, s29, 11
    v_cvt_pk_bf16_f32 v105, v90, v91
    v_mfma_f32_16x16x32_bf16 v[228:231], v[124:127], v[108:111], v[228:231]
    v_exp_f32 v94, v94
    v_mfma_f32_16x16x32_bf16 a[112:115], v[128:131], v[108:111], a[112:115]
    s_add_u32 s29, s28, s29
    v_exp_f32 v95, v95
    v_mfma_f32_16x16x32_bf16 a[140:143], v[132:135], v[108:111], a[140:143]
    v_add_f32 v14, v14, v92
    v_add_f32 v15, v15, v93
    v_mfma_f32_16x16x32_bf16 a[168:171], v[136:139], v[108:111], a[168:171]
    s_lshr_b32 s28, s34, 5
    v_cvt_pk_bf16_f32 v106, v92, v93
    v_add_f32 v14, v14, v94
    v_mfma_f32_16x16x32_bf16 a[196:199], v[140:143], v[108:111], a[196:199]
    v_add_f32 v15, v15, v95
    v_cvt_pk_bf16_f32 v107, v94, v95
    v_mfma_f32_16x16x32_bf16 v[88:91], v[56:59], a[48:51], v[40:43]
    v_mfma_f32_16x16x32_bf16 v[88:91], v[60:63], a[52:55], v[88:91]
    s_lshl_b32 s28, s28, 19
    v_exp_f32 v96, v96
    v_mfma_f32_16x16x32_bf16 v[88:91], v[64:67], a[56:59], v[88:91]
    v_exp_f32 v97, v97
    v_mfma_f32_16x16x32_bf16 v[88:91], v[68:71], a[60:63], v[88:91]
    s_add_u32 s49, s28, s29
    v_exp_f32 v98, v98
    v_mfma_f32_16x16x32_bf16 v[92:95], v[72:75], a[48:51], v[40:43]
    v_exp_f32 v99, v99
    v_mfma_f32_16x16x32_bf16 v[92:95], v[76:79], a[52:55], v[92:95]
    s_add_u32 m0, s33, 16896
    v_add_f32 v16, v16, v96
    v_add_f32 v17, v17, v97
    v_mfma_f32_16x16x32_bf16 v[92:95], v[80:83], a[56:59], v[92:95]
    v_cvt_pk_bf16_f32 v108, v96, v97
    v_mfma_f32_16x16x32_bf16 v[92:95], v[84:87], a[60:63], v[92:95]
    v_exp_f32 v100, v100
    v_mfma_f32_16x16x32_bf16 v[148:151], v[112:115], v[104:107], v[148:151]
    s_add_u32 s34, s34, 1
    v_exp_f32 v101, v101
    v_mfma_f32_16x16x32_bf16 v[176:179], v[116:119], v[104:107], v[176:179]
    v_add_f32 v16, v16, v98
    v_add_f32 v17, v17, v99
    v_mfma_f32_16x16x32_bf16 v[204:207], v[120:123], v[104:107], v[204:207]
    buffer_load_dwordx4 v7, s[4:7], s49 offen offset:0 nt lds
    v_cvt_pk_bf16_f32 v109, v98, v99
    v_mfma_f32_16x16x32_bf16 v[232:235], v[124:127], v[104:107], v[232:235]
    v_exp_f32 v102, v102
    v_mfma_f32_16x16x32_bf16 a[116:119], v[128:131], v[104:107], a[116:119]
    s_add_u32 m0, m0, s96
    v_exp_f32 v103, v103
    v_mfma_f32_16x16x32_bf16 a[144:147], v[132:135], v[104:107], a[144:147]
    v_add_f32 v16, v16, v100
    v_add_f32 v17, v17, v101
    v_mfma_f32_16x16x32_bf16 a[172:175], v[136:139], v[104:107], a[172:175]
    buffer_load_dwordx4 v7, s[4:7], s49 offen offset:256 nt lds
    v_cvt_pk_bf16_f32 v110, v100, v101
    v_add_f32 v16, v16, v102
    v_mfma_f32_16x16x32_bf16 a[200:203], v[140:143], v[104:107], a[200:203]
    v_add_f32 v17, v17, v103
    v_cvt_pk_bf16_f32 v111, v102, v103
    v_mfma_f32_16x16x32_bf16 v[96:99], v[56:59], a[64:67], v[44:47]
    v_mfma_f32_16x16x32_bf16 v[96:99], v[60:63], a[68:71], v[96:99]
    s_add_u32 m0, m0, s97
    v_exp_f32 v88, v88
    v_mfma_f32_16x16x32_bf16 v[96:99], v[64:67], a[72:75], v[96:99]
    v_exp_f32 v89, v89
    v_mfma_f32_16x16x32_bf16 v[96:99], v[68:71], a[76:79], v[96:99]
    buffer_load_dwordx4 v7, s[4:7], s49 offen offset:512 nt lds
    v_exp_f32 v90, v90
    v_mfma_f32_16x16x32_bf16 v[100:103], v[72:75], a[64:67], v[44:47]
    v_exp_f32 v91, v91
    v_mfma_f32_16x16x32_bf16 v[100:103], v[76:79], a[68:71], v[100:103]
    s_add_u32 m0, m0, s96
    v_add_f32 v18, v18, v88
    v_add_f32 v19, v19, v89
    v_mfma_f32_16x16x32_bf16 v[100:103], v[80:83], a[72:75], v[100:103]
    v_cvt_pk_bf16_f32 v104, v88, v89
    v_mfma_f32_16x16x32_bf16 v[100:103], v[84:87], a[76:79], v[100:103]
    v_exp_f32 v92, v92
    v_mfma_f32_16x16x32_bf16 v[152:155], v[112:115], v[108:111], v[152:155]
    buffer_load_dwordx4 v7, s[4:7], s49 offen offset:768 nt lds
    v_exp_f32 v93, v93
    v_mfma_f32_16x16x32_bf16 v[180:183], v[116:119], v[108:111], v[180:183]
    v_add_f32 v18, v18, v90
    v_add_f32 v19, v19, v91
    v_mfma_f32_16x16x32_bf16 v[208:211], v[120:123], v[108:111], v[208:211]
    s_add_u32 m0, m0, s97
    v_cvt_pk_bf16_f32 v105, v90, v91
    v_mfma_f32_16x16x32_bf16 v[236:239], v[124:127], v[108:111], v[236:239]
    v_exp_f32 v94, v94
    v_mfma_f32_16x16x32_bf16 a[120:123], v[128:131], v[108:111], a[120:123]
    buffer_load_dwordx4 v7, s[4:7], s49 offen offset:1024 nt lds
    v_exp_f32 v95, v95
    v_mfma_f32_16x16x32_bf16 a[148:151], v[132:135], v[108:111], a[148:151]
    v_add_f32 v18, v18, v92
    v_add_f32 v19, v19, v93
    v_mfma_f32_16x16x32_bf16 a[176:179], v[136:139], v[108:111], a[176:179]
    s_add_u32 m0, m0, s96
    v_cvt_pk_bf16_f32 v106, v92, v93
    v_add_f32 v18, v18, v94
    v_mfma_f32_16x16x32_bf16 a[204:207], v[140:143], v[108:111], a[204:207]
    v_add_f32 v19, v19, v95
    v_cvt_pk_bf16_f32 v107, v94, v95
    v_mfma_f32_16x16x32_bf16 v[88:91], v[56:59], a[80:83], v[48:51]
    v_mfma_f32_16x16x32_bf16 v[88:91], v[60:63], a[84:87], v[88:91]
    buffer_load_dwordx4 v7, s[4:7], s49 offen offset:1280 nt lds
    v_exp_f32 v96, v96
    v_mfma_f32_16x16x32_bf16 v[88:91], v[64:67], a[88:91], v[88:91]
    v_exp_f32 v97, v97
    v_mfma_f32_16x16x32_bf16 v[88:91], v[68:71], a[92:95], v[88:91]
    s_add_u32 m0, m0, s97
    v_exp_f32 v98, v98
    v_mfma_f32_16x16x32_bf16 v[92:95], v[72:75], a[80:83], v[48:51]
    v_exp_f32 v99, v99
    v_mfma_f32_16x16x32_bf16 v[92:95], v[76:79], a[84:87], v[92:95]
    buffer_load_dwordx4 v7, s[4:7], s49 offen offset:1536 nt lds
    v_add_f32 v20, v20, v96
    v_add_f32 v21, v21, v97
    v_mfma_f32_16x16x32_bf16 v[92:95], v[80:83], a[88:91], v[92:95]
    v_cvt_pk_bf16_f32 v108, v96, v97
    v_mfma_f32_16x16x32_bf16 v[92:95], v[84:87], a[92:95], v[92:95]
    v_exp_f32 v100, v100
    v_mfma_f32_16x16x32_bf16 v[156:159], v[112:115], v[104:107], v[156:159]
    s_add_u32 m0, m0, s96
    v_exp_f32 v101, v101
    v_mfma_f32_16x16x32_bf16 v[184:187], v[116:119], v[104:107], v[184:187]
    v_add_f32 v20, v20, v98
    v_add_f32 v21, v21, v99
    v_mfma_f32_16x16x32_bf16 v[212:215], v[120:123], v[104:107], v[212:215]
    buffer_load_dwordx4 v7, s[4:7], s49 offen offset:1792 nt lds
    v_cvt_pk_bf16_f32 v109, v98, v99
    v_mfma_f32_16x16x32_bf16 v[240:243], v[124:127], v[104:107], v[240:243]
    v_exp_f32 v102, v102
    v_mfma_f32_16x16x32_bf16 a[124:127], v[128:131], v[104:107], a[124:127]
    v_exp_f32 v103, v103
    v_mfma_f32_16x16x32_bf16 a[152:155], v[132:135], v[104:107], a[152:155]
    v_add_f32 v20, v20, v100
    v_add_f32 v21, v21, v101
    v_mfma_f32_16x16x32_bf16 a[180:183], v[136:139], v[104:107], a[180:183]
    v_cvt_pk_bf16_f32 v110, v100, v101
    v_add_f32 v20, v20, v102
    v_mfma_f32_16x16x32_bf16 a[208:211], v[140:143], v[104:107], a[208:211]
    v_add_f32 v21, v21, v103
    v_cvt_pk_bf16_f32 v111, v102, v103
    s_waitcnt vmcnt(16) lgkmcnt(0)
    s_barrier
    v_mfma_f32_16x16x32_bf16 v[96:99], v[56:59], a[96:99], v[52:55]
    ds_read_b128 v[56:59], v8 offset:0
    s_add_u32 s29, s34, s100
    v_mfma_f32_16x16x32_bf16 v[96:99], v[60:63], a[100:103], v[96:99]
    ds_read_b128 v[60:63], v8 offset:64
    s_bfe_u32 s28, s29, 0x20003
    v_exp_f32 v88, v88
    v_mfma_f32_16x16x32_bf16 v[96:99], v[64:67], a[104:107], v[96:99]
    ds_read_b128 v[64:67], v8 offset:128
    s_lshl_b32 s28, s28, 16
    v_exp_f32 v89, v89
    v_mfma_f32_16x16x32_bf16 v[96:99], v[68:71], a[108:111], v[96:99]
    ds_read_b128 v[68:71], v8 offset:192
    s_and_b32 s29, s29, 7
    v_exp_f32 v90, v90
    v_mfma_f32_16x16x32_bf16 v[100:103], v[72:75], a[96:99], v[52:55]
    ds_read_b128 v[72:75], v8 offset:512
    s_lshl_b32 s29, s29, 11
    v_exp_f32 v91, v91
    v_mfma_f32_16x16x32_bf16 v[100:103], v[76:79], a[100:103], v[100:103]
    ds_read_b128 v[76:79], v8 offset:576
    s_add_u32 s29, s28, s29
    v_add_f32 v22, v22, v88
    v_add_f32 v23, v23, v89
    v_mfma_f32_16x16x32_bf16 v[100:103], v[80:83], a[104:107], v[100:103]
    ds_read_b128 v[80:83], v8 offset:640
    s_lshr_b32 s28, s34, 5
    v_cvt_pk_bf16_f32 v104, v88, v89
    v_mfma_f32_16x16x32_bf16 v[100:103], v[84:87], a[108:111], v[100:103]
    ds_read_b128 v[84:87], v8 offset:704
    s_lshl_b32 s28, s28, 19
    v_exp_f32 v92, v92
    v_mfma_f32_16x16x32_bf16 v[160:163], v[112:115], v[108:111], v[160:163]
    s_add_u32 s49, s28, s29
    s_add_u32 m0, s33, 25344
    v_exp_f32 v93, v93
    v_mfma_f32_16x16x32_bf16 v[188:191], v[116:119], v[108:111], v[188:191]
    s_add_u32 s34, s34, 1
    v_add_f32 v22, v22, v90
    v_add_f32 v23, v23, v91
    v_mfma_f32_16x16x32_bf16 v[216:219], v[120:123], v[108:111], v[216:219]
    s_nop 0
    v_cvt_pk_bf16_f32 v105, v90, v91
    v_mfma_f32_16x16x32_bf16 v[244:247], v[124:127], v[108:111], v[244:247]
    buffer_load_dwordx4 v7, s[4:7], s49 offen offset:0 nt lds
    v_exp_f32 v94, v94
    v_mfma_f32_16x16x32_bf16 a[128:131], v[128:131], v[108:111], a[128:131]
    s_add_u32 m0, m0, s96
    v_exp_f32 v95, v95
    v_mfma_f32_16x16x32_bf16 a[156:159], v[132:135], v[108:111], a[156:159]
    s_nop 0
    v_add_f32 v22, v22, v92
    v_add_f32 v23, v23, v93
    v_mfma_f32_16x16x32_bf16 a[184:187], v[136:139], v[108:111], a[184:187]
    buffer_load_dwordx4 v7, s[4:7], s49 offen offset:256 nt lds
    v_cvt_pk_bf16_f32 v106, v92, v93
    v_add_f32 v22, v22, v94
    v_mfma_f32_16x16x32_bf16 a[212:215], v[140:143], v[108:111], a[212:215]
    s_add_u32 m0, m0, s97
    v_add_f32 v23, v23, v95
    v_cvt_pk_bf16_f32 v107, v94, v95
    s_lshl_b32 s30, s2, 2
    s_add_u32 s30, s30, s20
    s_mul_i32 s30, s30, 28672
    v_lshlrev_b32 v4, 4, v1
    buffer_load_dwordx4 a[0:3], v4, s[12:15], s30 offen offset:0
    buffer_load_dwordx4 a[4:7], v4, s[12:15], s30 offen offset:1024
    buffer_load_dwordx4 a[8:11], v4, s[12:15], s30 offen offset:2048
    buffer_load_dwordx4 a[12:15], v4, s[12:15], s30 offen offset:3072
    s_add_u32 s30, s30, 4096
    buffer_load_dwordx4 a[16:19], v4, s[12:15], s30 offen offset:0
    buffer_load_dwordx4 a[20:23], v4, s[12:15], s30 offen offset:1024
    buffer_load_dwordx4 a[24:27], v4, s[12:15], s30 offen offset:2048
    buffer_load_dwordx4 a[28:31], v4, s[12:15], s30 offen offset:3072
    s_add_u32 s30, s30, 4096
    buffer_load_dwordx4 a[32:35], v4, s[12:15], s30 offen offset:0
    buffer_load_dwordx4 a[36:39], v4, s[12:15], s30 offen offset:1024
    buffer_load_dwordx4 a[40:43], v4, s[12:15], s30 offen offset:2048
    buffer_load_dwordx4 a[44:47], v4, s[12:15], s30 offen offset:3072
    s_add_u32 s30, s30, 4096
    buffer_load_dwordx4 a[48:51], v4, s[12:15], s30 offen offset:0
    buffer_load_dwordx4 a[52:55], v4, s[12:15], s30 offen offset:1024
    buffer_load_dwordx4 a[56:59], v4, s[12:15], s30 offen offset:2048
    buffer_load_dwordx4 a[60:63], v4, s[12:15], s30 offen offset:3072
    s_add_u32 s30, s30, 4096
    buffer_load_dwordx4 a[64:67], v4, s[12:15], s30 offen offset:0
    buffer_load_dwordx4 a[68:71], v4, s[12:15], s30 offen offset:1024
    buffer_load_dwordx4 a[72:75], v4, s[12:15], s30 offen offset:2048
    buffer_load_dwordx4 a[76:79], v4, s[12:15], s30 offen offset:3072
    s_add_u32 s30, s30, 4096
    buffer_load_dwordx4 a[80:83], v4, s[12:15], s30 offen offset:0
    buffer_load_dwordx4 a[84:87], v4, s[12:15], s30 offen offset:1024
    buffer_load_dwordx4 a[88:91], v4, s[12:15], s30 offen offset:2048
    buffer_load_dwordx4 a[92:95], v4, s[12:15], s30 offen offset:3072
    s_add_u32 s30, s30, 4096
    buffer_load_dwordx4 a[96:99], v4, s[12:15], s30 offen offset:0
    buffer_load_dwordx4 a[100:103], v4, s[12:15], s30 offen offset:1024
    buffer_load_dwordx4 a[104:107], v4, s[12:15], s30 offen offset:2048
    buffer_load_dwordx4 a[108:111], v4, s[12:15], s30 offen offset:3072
    s_nop 1
    v_mfma_f32_16x16x32_bf16 v[164:167], v[112:115], v[104:107], v[164:167]
    s_nop 0
    buffer_load_dwordx4 v7, s[4:7], s49 offen offset:512 nt lds
    v_exp_f32 v96, v96
    v_mfma_f32_16x16x32_bf16 v[192:195], v[116:119], v[104:107], v[192:195]
    s_add_u32 m0, m0, s96
    s_nop 0
    v_exp_f32 v97, v97
    v_exp_f32 v98, v98
    v_mfma_f32_16x16x32_bf16 v[220:223], v[120:123], v[104:107], v[220:223]
    buffer_load_dwordx4 v7, s[4:7], s49 offen offset:768 nt lds
    s_add_u32 m0, m0, s97
    v_exp_f32 v99, v99
    v_add_f32 v24, v24, v96
    v_add_f32 v25, v25, v97
    v_mfma_f32_16x16x32_bf16 v[248:251], v[124:127], v[104:107], v[248:251]
    s_nop 0
    buffer_load_dwordx4 v7, s[4:7], s49 offen offset:1024 nt lds
    v_cvt_pk_bf16_f32 v108, v96, v97
    v_exp_f32 v100, v100
    v_mfma_f32_16x16x32_bf16 a[132:135], v[128:131], v[104:107], a[132:135]
    s_add_u32 m0, m0, s96
    s_nop 0
    buffer_load_dwordx4 v7, s[4:7], s49 offen offset:1280 nt lds
    v_exp_f32 v101, v101
    v_add_f32 v24, v24, v98
    v_add_f32 v25, v25, v99
    v_mfma_f32_16x16x32_bf16 a[160:163], v[132:135], v[104:107], a[160:163]
    s_add_u32 m0, m0, s97
    s_nop 0
    v_cvt_pk_bf16_f32 v109, v98, v99
    v_exp_f32 v102, v102
    v_mfma_f32_16x16x32_bf16 a[188:191], v[136:139], v[104:107], a[188:191]
    buffer_load_dwordx4 v7, s[4:7], s49 offen offset:1536 nt lds
    s_add_u32 m0, m0, s96
    v_exp_f32 v103, v103
    v_add_f32 v24, v24, v100
    v_add_f32 v25, v25, v101
    v_mfma_f32_16x16x32_bf16 a[216:219], v[140:143], v[104:107], a[216:219]
    s_nop 0
    buffer_load_dwordx4 v7, s[4:7], s49 offen offset:1792 nt lds
    v_cvt_pk_bf16_f32 v110, v100, v101
    v_add_f32 v24, v24, v102
    v_add_f32 v25, v25, v103
    v_cvt_pk_bf16_f32 v111, v102, v103
L_at_aepi:
    s_nop 1
    s_waitcnt lgkmcnt(0)
    v_mfma_f32_16x16x32_bf16 v[168:171], v[112:115], v[108:111], v[168:171]
    v_add_f32 v12, v12, v13
    v_add_f32 v14, v14, v15
    v_add_f32 v16, v16, v17
    v_add_f32 v18, v18, v19
    v_add_f32 v20, v20, v21
    v_add_f32 v22, v22, v23
    v_mfma_f32_16x16x32_bf16 v[196:199], v[116:119], v[108:111], v[196:199]
    v_add_f32 v24, v24, v25
    v_mov_b32 v88, v12
    v_mov_b32 v89, v14
    v_mov_b32 v90, v16
    v_mov_b32 v91, v18
    v_mov_b32 v92, v20
    v_mfma_f32_16x16x32_bf16 v[224:227], v[120:123], v[108:111], v[224:227]
    v_mov_b32 v93, v22
    v_mov_b32 v94, v24
    v_permlane16_swap_b32 v12, v88
    v_permlane16_swap_b32 v14, v89
    v_permlane16_swap_b32 v16, v90
    v_permlane16_swap_b32 v18, v91
    v_mfma_f32_16x16x32_bf16 v[252:255], v[124:127], v[108:111], v[252:255]
    v_permlane16_swap_b32 v20, v92
    v_permlane16_swap_b32 v22, v93
    v_permlane16_swap_b32 v24, v94
    v_add_f32 v12, v12, v88
    v_add_f32 v14, v14, v89
    v_add_f32 v16, v16, v90
    v_mfma_f32_16x16x32_bf16 a[136:139], v[128:131], v[108:111], a[136:139]
    v_add_f32 v18, v18, v91
    v_add_f32 v20, v20, v92
    v_add_f32 v22, v22, v93
    v_add_f32 v24, v24, v94
    v_mov_b32 v88, v12
    v_mov_b32 v89, v14
    v_mfma_f32_16x16x32_bf16 a[164:167], v[132:135], v[108:111], a[164:167]
    v_mov_b32 v90, v16
    v_mov_b32 v91, v18
    v_mov_b32 v92, v20
    v_mov_b32 v93, v22
    v_mov_b32 v94, v24
    v_permlane32_swap_b32 v12, v88
    v_mfma_f32_16x16x32_bf16 a[192:195], v[136:139], v[108:111], a[192:195]
    v_permlane32_swap_b32 v14, v89
    v_permlane32_swap_b32 v16, v90
    v_permlane32_swap_b32 v18, v91
    v_permlane32_swap_b32 v20, v92
    v_permlane32_swap_b32 v22, v93
    v_permlane32_swap_b32 v24, v94
    v_mfma_f32_16x16x32_bf16 a[220:223], v[140:143], v[108:111], a[220:223]
    v_add_f32 v12, v12, v88
    v_add_f32 v14, v14, v89
    v_add_f32 v16, v16, v90
    v_add_f32 v18, v18, v91
    v_add_f32 v20, v20, v92
    v_add_f32 v22, v22, v93
    v_add_f32 v24, v24, v94
    v_rcp_f32 v28, v12
    v_rcp_f32 v32, v14
    v_rcp_f32 v36, v16
    v_rcp_f32 v40, v18
    v_rcp_f32 v44, v20
    v_rcp_f32 v48, v22
    v_rcp_f32 v52, v24
    v_add_f32 v90, v12, v14
    v_add_f32 v91, v16, v18
    v_add_f32 v92, v20, v22
    v_add_f32 v90, v90, v24
    v_add_f32 v91, v91, v92
    v_add_f32 v90, v90, v91
    v_cmp_nge_f32 vcc, s32, v90
    v_mov_b32 v12, 0xff800000
    v_mov_b32 v14, 0xff800000
    v_mov_b32 v16, 0xff800000
    v_mov_b32 v18, 0xff800000
    v_mov_b32 v20, 0xff800000
    v_mov_b32 v22, 0xff800000
    v_mov_b32 v24, 0xff800000
    s_cmp_eq_u64 vcc, 0
    s_cbranch_scc1 L_at_noflag
    s_lshl_b32 s29, s21, 2
    s_add_u32 s29, s29, 75996
    v_mov_b32 v90, s29
    v_mov_b32 v91, 1
    ds_write_b32 v90, v91
L_at_noflag:
    s_mul_i32 s31, s21, 114688
    s_add_u32 s31, s31, s24
    s_sub_u32 s31, s31, 114688
    v_pk_mul_f32 v[144:145], v[144:145], v[28:29] op_sel_hi:[1,0]
    v_pk_mul_f32 v[146:147], v[146:147], v[28:29] op_sel_hi:[1,0]
    v_pk_mul_f32 v[148:149], v[148:149], v[32:33] op_sel_hi:[1,0]
    v_pk_mul_f32 v[150:151], v[150:151], v[32:33] op_sel_hi:[1,0]
    v_pk_mul_f32 v[152:153], v[152:153], v[36:37] op_sel_hi:[1,0]
    v_pk_mul_f32 v[154:155], v[154:155], v[36:37] op_sel_hi:[1,0]
    v_pk_mul_f32 v[156:157], v[156:157], v[40:41] op_sel_hi:[1,0]
    v_pk_mul_f32 v[158:159], v[158:159], v[40:41] op_sel_hi:[1,0]
    v_pk_mul_f32 v[160:161], v[160:161], v[44:45] op_sel_hi:[1,0]
    v_pk_mul_f32 v[162:163], v[162:163], v[44:45] op_sel_hi:[1,0]
    v_pk_mul_f32 v[164:165], v[164:165], v[48:49] op_sel_hi:[1,0]
    v_pk_mul_f32 v[166:167], v[166:167], v[48:49] op_sel_hi:[1,0]
    v_pk_mul_f32 v[168:169], v[168:169], v[52:53] op_sel_hi:[1,0]
    v_pk_mul_f32 v[170:171], v[170:171], v[52:53] op_sel_hi:[1,0]
    v_pk_mul_f32 v[172:173], v[172:173], v[28:29] op_sel_hi:[1,0]
    v_pk_mul_f32 v[174:175], v[174:175], v[28:29] op_sel_hi:[1,0]
    v_pk_mul_f32 v[176:177], v[176:177], v[32:33] op_sel_hi:[1,0]
    v_pk_mul_f32 v[178:179], v[178:179], v[32:33] op_sel_hi:[1,0]
    v_pk_mul_f32 v[180:181], v[180:181], v[36:37] op_sel_hi:[1,0]
    v_pk_mul_f32 v[182:183], v[182:183], v[36:37] op_sel_hi:[1,0]
    v_pk_mul_f32 v[184:185], v[184:185], v[40:41] op_sel_hi:[1,0]
    v_pk_mul_f32 v[186:187], v[186:187], v[40:41] op_sel_hi:[1,0]
    v_pk_mul_f32 v[188:189], v[188:189], v[44:45] op_sel_hi:[1,0]
    v_pk_mul_f32 v[190:191], v[190:191], v[44:45] op_sel_hi:[1,0]
    v_pk_mul_f32 v[192:193], v[192:193], v[48:49] op_sel_hi:[1,0]
    v_pk_mul_f32 v[194:195], v[194:195], v[48:49] op_sel_hi:[1,0]
    v_pk_mul_f32 v[196:197], v[196:197], v[52:53] op_sel_hi:[1,0]
    v_pk_mul_f32 v[198:199], v[198:199], v[52:53] op_sel_hi:[1,0]
    v_cvt_pk_bf16_f32 v88, v144, v145
    v_cvt_pk_bf16_f32 v89, v146, v147
    v_cvt_pk_bf16_f32 v90, v172, v173
    v_cvt_pk_bf16_f32 v91, v174, v175
    v_cvt_pk_bf16_f32 v92, v148, v149
    v_cvt_pk_bf16_f32 v93, v150, v151
    v_cvt_pk_bf16_f32 v94, v176, v177
    v_cvt_pk_bf16_f32 v95, v178, v179
    v_cvt_pk_bf16_f32 v96, v152, v153
    v_cvt_pk_bf16_f32 v97, v154, v155
    v_cvt_pk_bf16_f32 v98, v180, v181
    v_cvt_pk_bf16_f32 v99, v182, v183
    v_cvt_pk_bf16_f32 v100, v156, v157
    v_cvt_pk_bf16_f32 v101, v158, v159
    v_cvt_pk_bf16_f32 v102, v184, v185
    v_cvt_pk_bf16_f32 v103, v186, v187
    v_cvt_pk_bf16_f32 v104, v160, v161
    v_cvt_pk_bf16_f32 v105, v162, v163
    v_cvt_pk_bf16_f32 v106, v188, v189
    v_cvt_pk_bf16_f32 v107, v190, v191
    v_cvt_pk_bf16_f32 v108, v164, v165
    v_cvt_pk_bf16_f32 v109, v166, v167
    v_cvt_pk_bf16_f32 v110, v192, v193
    v_cvt_pk_bf16_f32 v111, v194, v195
    v_cvt_pk_bf16_f32 v112, v168, v169
    v_cvt_pk_bf16_f32 v113, v170, v171
    v_cvt_pk_bf16_f32 v114, v196, v197
    v_cvt_pk_bf16_f32 v115, v198, v199
    s_nop 1
    v_permlane16_swap_b32 v88, v90
    v_permlane16_swap_b32 v89, v91
    v_permlane16_swap_b32 v92, v94
    v_permlane16_swap_b32 v93, v95
    v_permlane16_swap_b32 v96, v98
    v_permlane16_swap_b32 v97, v99
    v_permlane16_swap_b32 v100, v102
    v_permlane16_swap_b32 v101, v103
    v_permlane16_swap_b32 v104, v106
    v_permlane16_swap_b32 v105, v107
    v_permlane16_swap_b32 v108, v110
    v_permlane16_swap_b32 v109, v111
    v_permlane16_swap_b32 v112, v114
    v_permlane16_swap_b32 v113, v115
    s_mov_b32 s28, s31
    buffer_store_dwordx4 v[88:91], v10, s[12:15], s28 offen offset:0 sc0 sc1
    s_add_u32 s28, s28, 4096
    buffer_store_dwordx4 v[92:95], v10, s[12:15], s28 offen offset:0 sc0 sc1
    s_add_u32 s28, s28, 4096
    buffer_store_dwordx4 v[96:99], v10, s[12:15], s28 offen offset:0 sc0 sc1
    s_add_u32 s28, s28, 4096
    buffer_store_dwordx4 v[100:103], v10, s[12:15], s28 offen offset:0 sc0 sc1
    s_add_u32 s28, s28, 4096
    buffer_store_dwordx4 v[104:107], v10, s[12:15], s28 offen offset:0 sc0 sc1
    s_add_u32 s28, s28, 4096
    buffer_store_dwordx4 v[108:111], v10, s[12:15], s28 offen offset:0 sc0 sc1
    s_add_u32 s28, s28, 4096
    buffer_store_dwordx4 v[112:115], v10, s[12:15], s28 offen offset:0 sc0 sc1
    v_pk_mul_f32 v[200:201], v[200:201], v[28:29] op_sel_hi:[1,0]
    v_pk_mul_f32 v[202:203], v[202:203], v[28:29] op_sel_hi:[1,0]
    v_pk_mul_f32 v[204:205], v[204:205], v[32:33] op_sel_hi:[1,0]
    v_pk_mul_f32 v[206:207], v[206:207], v[32:33] op_sel_hi:[1,0]
    v_pk_mul_f32 v[208:209], v[208:209], v[36:37] op_sel_hi:[1,0]
    v_pk_mul_f32 v[210:211], v[210:211], v[36:37] op_sel_hi:[1,0]
    v_pk_mul_f32 v[212:213], v[212:213], v[40:41] op_sel_hi:[1,0]
    v_pk_mul_f32 v[214:215], v[214:215], v[40:41] op_sel_hi:[1,0]
    v_pk_mul_f32 v[216:217], v[216:217], v[44:45] op_sel_hi:[1,0]
    v_pk_mul_f32 v[218:219], v[218:219], v[44:45] op_sel_hi:[1,0]
    v_pk_mul_f32 v[220:221], v[220:221], v[48:49] op_sel_hi:[1,0]
    v_pk_mul_f32 v[222:223], v[222:223], v[48:49] op_sel_hi:[1,0]
    v_pk_mul_f32 v[224:225], v[224:225], v[52:53] op_sel_hi:[1,0]
    v_pk_mul_f32 v[226:227], v[226:227], v[52:53] op_sel_hi:[1,0]
    v_pk_mul_f32 v[228:229], v[228:229], v[28:29] op_sel_hi:[1,0]
    v_pk_mul_f32 v[230:231], v[230:231], v[28:29] op_sel_hi:[1,0]
    v_pk_mul_f32 v[232:233], v[232:233], v[32:33] op_sel_hi:[1,0]
    v_pk_mul_f32 v[234:235], v[234:235], v[32:33] op_sel_hi:[1,0]
    v_pk_mul_f32 v[236:237], v[236:237], v[36:37] op_sel_hi:[1,0]
    v_pk_mul_f32 v[238:239], v[238:239], v[36:37] op_sel_hi:[1,0]
    v_pk_mul_f32 v[240:241], v[240:241], v[40:41] op_sel_hi:[1,0]
    v_pk_mul_f32 v[242:243], v[242:243], v[40:41] op_sel_hi:[1,0]
    v_pk_mul_f32 v[244:245], v[244:245], v[44:45] op_sel_hi:[1,0]
    v_pk_mul_f32 v[246:247], v[246:247], v[44:45] op_sel_hi:[1,0]
    v_pk_mul_f32 v[248:249], v[248:249], v[48:49] op_sel_hi:[1,0]
    v_pk_mul_f32 v[250:251], v[250:251], v[48:49] op_sel_hi:[1,0]
    v_pk_mul_f32 v[252:253], v[252:253], v[52:53] op_sel_hi:[1,0]
    v_pk_mul_f32 v[254:255], v[254:255], v[52:53] op_sel_hi:[1,0]
    v_cvt_pk_bf16_f32 v116, v200, v201
    v_cvt_pk_bf16_f32 v117, v202, v203
    v_cvt_pk_bf16_f32 v118, v228, v229
    v_cvt_pk_bf16_f32 v119, v230, v231
    v_cvt_pk_bf16_f32 v120, v204, v205
    v_cvt_pk_bf16_f32 v121, v206, v207
    v_cvt_pk_bf16_f32 v122, v232, v233
    v_cvt_pk_bf16_f32 v123, v234, v235
    v_cvt_pk_bf16_f32 v124, v208, v209
    v_cvt_pk_bf16_f32 v125, v210, v211
    v_cvt_pk_bf16_f32 v126, v236, v237
    v_cvt_pk_bf16_f32 v127, v238, v239
    v_cvt_pk_bf16_f32 v128, v212, v213
    v_cvt_pk_bf16_f32 v129, v214, v215
    v_cvt_pk_bf16_f32 v130, v240, v241
    v_cvt_pk_bf16_f32 v131, v242, v243
    v_cvt_pk_bf16_f32 v132, v216, v217
    v_cvt_pk_bf16_f32 v133, v218, v219
    v_cvt_pk_bf16_f32 v134, v244, v245
    v_cvt_pk_bf16_f32 v135, v246, v247
    v_cvt_pk_bf16_f32 v136, v220, v221
    v_cvt_pk_bf16_f32 v137, v222, v223
    v_cvt_pk_bf16_f32 v138, v248, v249
    v_cvt_pk_bf16_f32 v139, v250, v251
    v_cvt_pk_bf16_f32 v140, v224, v225
    v_cvt_pk_bf16_f32 v141, v226, v227
    v_cvt_pk_bf16_f32 v142, v252, v253
    v_cvt_pk_bf16_f32 v143, v254, v255
    s_nop 1
    v_permlane16_swap_b32 v116, v118
    v_permlane16_swap_b32 v117, v119
    v_permlane16_swap_b32 v120, v122
    v_permlane16_swap_b32 v121, v123
    v_permlane16_swap_b32 v124, v126
    v_permlane16_swap_b32 v125, v127
    v_permlane16_swap_b32 v128, v130
    v_permlane16_swap_b32 v129, v131
    v_permlane16_swap_b32 v132, v134
    v_permlane16_swap_b32 v133, v135
    v_permlane16_swap_b32 v136, v138
    v_permlane16_swap_b32 v137, v139
    v_permlane16_swap_b32 v140, v142
    v_permlane16_swap_b32 v141, v143
    s_mov_b32 s28, s31
    buffer_store_dwordx4 v[116:119], v10, s[12:15], s28 offen offset:1024 sc0 sc1
    s_add_u32 s28, s28, 4096
    buffer_store_dwordx4 v[120:123], v10, s[12:15], s28 offen offset:1024 sc0 sc1
    s_add_u32 s28, s28, 4096
    buffer_store_dwordx4 v[124:127], v10, s[12:15], s28 offen offset:1024 sc0 sc1
    s_add_u32 s28, s28, 4096
    buffer_store_dwordx4 v[128:131], v10, s[12:15], s28 offen offset:1024 sc0 sc1
    s_add_u32 s28, s28, 4096
    buffer_store_dwordx4 v[132:135], v10, s[12:15], s28 offen offset:1024 sc0 sc1
    s_add_u32 s28, s28, 4096
    buffer_store_dwordx4 v[136:139], v10, s[12:15], s28 offen offset:1024 sc0 sc1
    s_add_u32 s28, s28, 4096
    buffer_store_dwordx4 v[140:143], v10, s[12:15], s28 offen offset:1024 sc0 sc1
    v_accvgpr_read_b32 v144, a112
    v_accvgpr_read_b32 v145, a113
    v_accvgpr_read_b32 v146, a114
    v_accvgpr_read_b32 v147, a115
    v_accvgpr_read_b32 v148, a116
    v_accvgpr_read_b32 v149, a117
    v_accvgpr_read_b32 v150, a118
    v_accvgpr_read_b32 v151, a119
    v_accvgpr_read_b32 v152, a120
    v_accvgpr_read_b32 v153, a121
    v_accvgpr_read_b32 v154, a122
    v_accvgpr_read_b32 v155, a123
    v_accvgpr_read_b32 v156, a124
    v_accvgpr_read_b32 v157, a125
    v_accvgpr_read_b32 v158, a126
    v_accvgpr_read_b32 v159, a127
    v_accvgpr_read_b32 v160, a128
    v_accvgpr_read_b32 v161, a129
    v_accvgpr_read_b32 v162, a130
    v_accvgpr_read_b32 v163, a131
    v_accvgpr_read_b32 v164, a132
    v_accvgpr_read_b32 v165, a133
    v_accvgpr_read_b32 v166, a134
    v_accvgpr_read_b32 v167, a135
    v_accvgpr_read_b32 v168, a136
    v_accvgpr_read_b32 v169, a137
    v_accvgpr_read_b32 v170, a138
    v_accvgpr_read_b32 v171, a139
    v_accvgpr_read_b32 v172, a140
    v_accvgpr_read_b32 v173, a141
    v_accvgpr_read_b32 v174, a142
    v_accvgpr_read_b32 v175, a143
    v_accvgpr_read_b32 v176, a144
    v_accvgpr_read_b32 v177, a145
    v_accvgpr_read_b32 v178, a146
    v_accvgpr_read_b32 v179, a147
    v_accvgpr_read_b32 v180, a148
    v_accvgpr_read_b32 v181, a149
    v_accvgpr_read_b32 v182, a150
    v_accvgpr_read_b32 v183, a151
    v_accvgpr_read_b32 v184, a152
    v_accvgpr_read_b32 v185, a153
    v_accvgpr_read_b32 v186, a154
    v_accvgpr_read_b32 v187, a155
    v_accvgpr_read_b32 v188, a156
    v_accvgpr_read_b32 v189, a157
    v_accvgpr_read_b32 v190, a158
    v_accvgpr_read_b32 v191, a159
    v_accvgpr_read_b32 v192, a160
    v_accvgpr_read_b32 v193, a161
    v_accvgpr_read_b32 v194, a162
    v_accvgpr_read_b32 v195, a163
    v_accvgpr_read_b32 v196, a164
    v_accvgpr_read_b32 v197, a165
    v_accvgpr_read_b32 v198, a166
    v_accvgpr_read_b32 v199, a167
    v_pk_mul_f32 v[144:145], v[144:145], v[28:29] op_sel_hi:[1,0]
    v_pk_mul_f32 v[146:147], v[146:147], v[28:29] op_sel_hi:[1,0]
    v_pk_mul_f32 v[148:149], v[148:149], v[32:33] op_sel_hi:[1,0]
    v_pk_mul_f32 v[150:151], v[150:151], v[32:33] op_sel_hi:[1,0]
    v_pk_mul_f32 v[152:153], v[152:153], v[36:37] op_sel_hi:[1,0]
    v_pk_mul_f32 v[154:155], v[154:155], v[36:37] op_sel_hi:[1,0]
    v_pk_mul_f32 v[156:157], v[156:157], v[40:41] op_sel_hi:[1,0]
    v_pk_mul_f32 v[158:159], v[158:159], v[40:41] op_sel_hi:[1,0]
    v_pk_mul_f32 v[160:161], v[160:161], v[44:45] op_sel_hi:[1,0]
    v_pk_mul_f32 v[162:163], v[162:163], v[44:45] op_sel_hi:[1,0]
    v_pk_mul_f32 v[164:165], v[164:165], v[48:49] op_sel_hi:[1,0]
    v_pk_mul_f32 v[166:167], v[166:167], v[48:49] op_sel_hi:[1,0]
    v_pk_mul_f32 v[168:169], v[168:169], v[52:53] op_sel_hi:[1,0]
    v_pk_mul_f32 v[170:171], v[170:171], v[52:53] op_sel_hi:[1,0]
    v_pk_mul_f32 v[172:173], v[172:173], v[28:29] op_sel_hi:[1,0]
    v_pk_mul_f32 v[174:175], v[174:175], v[28:29] op_sel_hi:[1,0]
    v_pk_mul_f32 v[176:177], v[176:177], v[32:33] op_sel_hi:[1,0]
    v_pk_mul_f32 v[178:179], v[178:179], v[32:33] op_sel_hi:[1,0]
    v_pk_mul_f32 v[180:181], v[180:181], v[36:37] op_sel_hi:[1,0]
    v_pk_mul_f32 v[182:183], v[182:183], v[36:37] op_sel_hi:[1,0]
    v_pk_mul_f32 v[184:185], v[184:185], v[40:41] op_sel_hi:[1,0]
    v_pk_mul_f32 v[186:187], v[186:187], v[40:41] op_sel_hi:[1,0]
    v_pk_mul_f32 v[188:189], v[188:189], v[44:45] op_sel_hi:[1,0]
    v_pk_mul_f32 v[190:191], v[190:191], v[44:45] op_sel_hi:[1,0]
    v_pk_mul_f32 v[192:193], v[192:193], v[48:49] op_sel_hi:[1,0]
    v_pk_mul_f32 v[194:195], v[194:195], v[48:49] op_sel_hi:[1,0]
    v_pk_mul_f32 v[196:197], v[196:197], v[52:53] op_sel_hi:[1,0]
    v_pk_mul_f32 v[198:199], v[198:199], v[52:53] op_sel_hi:[1,0]
    v_cvt_pk_bf16_f32 v88, v144, v145
    v_cvt_pk_bf16_f32 v89, v146, v147
    v_cvt_pk_bf16_f32 v90, v172, v173
    v_cvt_pk_bf16_f32 v91, v174, v175
    v_cvt_pk_bf16_f32 v92, v148, v149
    v_cvt_pk_bf16_f32 v93, v150, v151
    v_cvt_pk_bf16_f32 v94, v176, v177
    v_cvt_pk_bf16_f32 v95, v178, v179
    v_cvt_pk_bf16_f32 v96, v152, v153
    v_cvt_pk_bf16_f32 v97, v154, v155
    v_cvt_pk_bf16_f32 v98, v180, v181
    v_cvt_pk_bf16_f32 v99, v182, v183
    v_cvt_pk_bf16_f32 v100, v156, v157
    v_cvt_pk_bf16_f32 v101, v158, v159
    v_cvt_pk_bf16_f32 v102, v184, v185
    v_cvt_pk_bf16_f32 v103, v186, v187
    v_cvt_pk_bf16_f32 v104, v160, v161
    v_cvt_pk_bf16_f32 v105, v162, v163
    v_cvt_pk_bf16_f32 v106, v188, v189
    v_cvt_pk_bf16_f32 v107, v190, v191
    v_cvt_pk_bf16_f32 v108, v164, v165
    v_cvt_pk_bf16_f32 v109, v166, v167
    v_cvt_pk_bf16_f32 v110, v192, v193
    v_cvt_pk_bf16_f32 v111, v194, v195
    v_cvt_pk_bf16_f32 v112, v168, v169
    v_cvt_pk_bf16_f32 v113, v170, v171
    v_cvt_pk_bf16_f32 v114, v196, v197
    v_cvt_pk_bf16_f32 v115, v198, v199
    s_nop 1
    v_permlane16_swap_b32 v88, v90
    v_permlane16_swap_b32 v89, v91
    v_permlane16_swap_b32 v92, v94
    v_permlane16_swap_b32 v93, v95
    v_permlane16_swap_b32 v96, v98
    v_permlane16_swap_b32 v97, v99
    v_permlane16_swap_b32 v100, v102
    v_permlane16_swap_b32 v101, v103
    v_permlane16_swap_b32 v104, v106
    v_permlane16_swap_b32 v105, v107
    v_permlane16_swap_b32 v108, v110
    v_permlane16_swap_b32 v109, v111
    v_permlane16_swap_b32 v112, v114
    v_permlane16_swap_b32 v113, v115
    s_mov_b32 s28, s31
    buffer_store_dwordx4 v[88:91], v10, s[12:15], s28 offen offset:2048 sc0 sc1
    s_add_u32 s28, s28, 4096
    buffer_store_dwordx4 v[92:95], v10, s[12:15], s28 offen offset:2048 sc0 sc1
    s_add_u32 s28, s28, 4096
    buffer_store_dwordx4 v[96:99], v10, s[12:15], s28 offen offset:2048 sc0 sc1
    s_add_u32 s28, s28, 4096
    buffer_store_dwordx4 v[100:103], v10, s[12:15], s28 offen offset:2048 sc0 sc1
    s_add_u32 s28, s28, 4096
    buffer_store_dwordx4 v[104:107], v10, s[12:15], s28 offen offset:2048 sc0 sc1
    s_add_u32 s28, s28, 4096
    buffer_store_dwordx4 v[108:111], v10, s[12:15], s28 offen offset:2048 sc0 sc1
    s_add_u32 s28, s28, 4096
    buffer_store_dwordx4 v[112:115], v10, s[12:15], s28 offen offset:2048 sc0 sc1
    v_accvgpr_read_b32 v200, a168
    v_accvgpr_read_b32 v201, a169
    v_accvgpr_read_b32 v202, a170
    v_accvgpr_read_b32 v203, a171
    v_accvgpr_read_b32 v204, a172
    v_accvgpr_read_b32 v205, a173
    v_accvgpr_read_b32 v206, a174
    v_accvgpr_read_b32 v207, a175
    v_accvgpr_read_b32 v208, a176
    v_accvgpr_read_b32 v209, a177
    v_accvgpr_read_b32 v210, a178
    v_accvgpr_read_b32 v211, a179
    v_accvgpr_read_b32 v212, a180
    v_accvgpr_read_b32 v213, a181
    v_accvgpr_read_b32 v214, a182
    v_accvgpr_read_b32 v215, a183
    v_accvgpr_read_b32 v216, a184
    v_accvgpr_read_b32 v217, a185
    v_accvgpr_read_b32 v218, a186
    v_accvgpr_read_b32 v219, a187
    v_accvgpr_read_b32 v220, a188
    v_accvgpr_read_b32 v221, a189
    v_accvgpr_read_b32 v222, a190
    v_accvgpr_read_b32 v223, a191
    v_accvgpr_read_b32 v224, a192
    v_accvgpr_read_b32 v225, a193
    v_accvgpr_read_b32 v226, a194
    v_accvgpr_read_b32 v227, a195
    v_accvgpr_read_b32 v228, a196
    v_accvgpr_read_b32 v229, a197
    v_accvgpr_read_b32 v230, a198
    v_accvgpr_read_b32 v231, a199
    v_accvgpr_read_b32 v232, a200
    v_accvgpr_read_b32 v233, a201
    v_accvgpr_read_b32 v234, a202
    v_accvgpr_read_b32 v235, a203
    v_accvgpr_read_b32 v236, a204
    v_accvgpr_read_b32 v237, a205
    v_accvgpr_read_b32 v238, a206
    v_accvgpr_read_b32 v239, a207
    v_accvgpr_read_b32 v240, a208
    v_accvgpr_read_b32 v241, a209
    v_accvgpr_read_b32 v242, a210
    v_accvgpr_read_b32 v243, a211
    v_accvgpr_read_b32 v244, a212
    v_accvgpr_read_b32 v245, a213
    v_accvgpr_read_b32 v246, a214
    v_accvgpr_read_b32 v247, a215
    v_accvgpr_read_b32 v248, a216
    v_accvgpr_read_b32 v249, a217
    v_accvgpr_read_b32 v250, a218
    v_accvgpr_read_b32 v251, a219
    v_accvgpr_read_b32 v252, a220
    v_accvgpr_read_b32 v253, a221
    v_accvgpr_read_b32 v254, a222
    v_accvgpr_read_b32 v255, a223
    v_pk_mul_f32 v[200:201], v[200:201], v[28:29] op_sel_hi:[1,0]
    v_pk_mul_f32 v[202:203], v[202:203], v[28:29] op_sel_hi:[1,0]
    v_pk_mul_f32 v[204:205], v[204:205], v[32:33] op_sel_hi:[1,0]
    v_pk_mul_f32 v[206:207], v[206:207], v[32:33] op_sel_hi:[1,0]
    v_pk_mul_f32 v[208:209], v[208:209], v[36:37] op_sel_hi:[1,0]
    v_pk_mul_f32 v[210:211], v[210:211], v[36:37] op_sel_hi:[1,0]
    v_pk_mul_f32 v[212:213], v[212:213], v[40:41] op_sel_hi:[1,0]
    v_pk_mul_f32 v[214:215], v[214:215], v[40:41] op_sel_hi:[1,0]
    v_pk_mul_f32 v[216:217], v[216:217], v[44:45] op_sel_hi:[1,0]
    v_pk_mul_f32 v[218:219], v[218:219], v[44:45] op_sel_hi:[1,0]
    v_pk_mul_f32 v[220:221], v[220:221], v[48:49] op_sel_hi:[1,0]
    v_pk_mul_f32 v[222:223], v[222:223], v[48:49] op_sel_hi:[1,0]
    v_pk_mul_f32 v[224:225], v[224:225], v[52:53] op_sel_hi:[1,0]
    v_pk_mul_f32 v[226:227], v[226:227], v[52:53] op_sel_hi:[1,0]
    v_pk_mul_f32 v[228:229], v[228:229], v[28:29] op_sel_hi:[1,0]
    v_pk_mul_f32 v[230:231], v[230:231], v[28:29] op_sel_hi:[1,0]
    v_pk_mul_f32 v[232:233], v[232:233], v[32:33] op_sel_hi:[1,0]
    v_pk_mul_f32 v[234:235], v[234:235], v[32:33] op_sel_hi:[1,0]
    v_pk_mul_f32 v[236:237], v[236:237], v[36:37] op_sel_hi:[1,0]
    v_pk_mul_f32 v[238:239], v[238:239], v[36:37] op_sel_hi:[1,0]
    v_pk_mul_f32 v[240:241], v[240:241], v[40:41] op_sel_hi:[1,0]
    v_pk_mul_f32 v[242:243], v[242:243], v[40:41] op_sel_hi:[1,0]
    v_pk_mul_f32 v[244:245], v[244:245], v[44:45] op_sel_hi:[1,0]
    v_pk_mul_f32 v[246:247], v[246:247], v[44:45] op_sel_hi:[1,0]
    v_pk_mul_f32 v[248:249], v[248:249], v[48:49] op_sel_hi:[1,0]
    v_pk_mul_f32 v[250:251], v[250:251], v[48:49] op_sel_hi:[1,0]
    v_pk_mul_f32 v[252:253], v[252:253], v[52:53] op_sel_hi:[1,0]
    v_pk_mul_f32 v[254:255], v[254:255], v[52:53] op_sel_hi:[1,0]
    v_cvt_pk_bf16_f32 v116, v200, v201
    v_cvt_pk_bf16_f32 v117, v202, v203
    v_cvt_pk_bf16_f32 v118, v228, v229
    v_cvt_pk_bf16_f32 v119, v230, v231
    v_cvt_pk_bf16_f32 v120, v204, v205
    v_cvt_pk_bf16_f32 v121, v206, v207
    v_cvt_pk_bf16_f32 v122, v232, v233
    v_cvt_pk_bf16_f32 v123, v234, v235
    v_cvt_pk_bf16_f32 v124, v208, v209
    v_cvt_pk_bf16_f32 v125, v210, v211
    v_cvt_pk_bf16_f32 v126, v236, v237
    v_cvt_pk_bf16_f32 v127, v238, v239
    v_cvt_pk_bf16_f32 v128, v212, v213
    v_cvt_pk_bf16_f32 v129, v214, v215
    v_cvt_pk_bf16_f32 v130, v240, v241
    v_cvt_pk_bf16_f32 v131, v242, v243
    v_cvt_pk_bf16_f32 v132, v216, v217
    v_cvt_pk_bf16_f32 v133, v218, v219
    v_cvt_pk_bf16_f32 v134, v244, v245
    v_cvt_pk_bf16_f32 v135, v246, v247
    v_cvt_pk_bf16_f32 v136, v220, v221
    v_cvt_pk_bf16_f32 v137, v222, v223
    v_cvt_pk_bf16_f32 v138, v248, v249
    v_cvt_pk_bf16_f32 v139, v250, v251
    v_cvt_pk_bf16_f32 v140, v224, v225
    v_cvt_pk_bf16_f32 v141, v226, v227
    v_cvt_pk_bf16_f32 v142, v252, v253
    v_cvt_pk_bf16_f32 v143, v254, v255
    s_nop 1
    v_permlane16_swap_b32 v116, v118
    v_permlane16_swap_b32 v117, v119
    v_permlane16_swap_b32 v120, v122
    v_permlane16_swap_b32 v121, v123
    v_permlane16_swap_b32 v124, v126
    v_permlane16_swap_b32 v125, v127
    v_permlane16_swap_b32 v128, v130
    v_permlane16_swap_b32 v129, v131
    v_permlane16_swap_b32 v132, v134
    v_permlane16_swap_b32 v133, v135
    v_permlane16_swap_b32 v136, v138
    v_permlane16_swap_b32 v137, v139
    v_permlane16_swap_b32 v140, v142
    v_permlane16_swap_b32 v141, v143
    s_mov_b32 s28, s31
    buffer_store_dwordx4 v[116:119], v10, s[12:15], s28 offen offset:3072 sc0 sc1
    s_add_u32 s28, s28, 4096
    buffer_store_dwordx4 v[120:123], v10, s[12:15], s28 offen offset:3072 sc0 sc1
    s_add_u32 s28, s28, 4096
    buffer_store_dwordx4 v[124:127], v10, s[12:15], s28 offen offset:3072 sc0 sc1
    s_add_u32 s28, s28, 4096
    buffer_store_dwordx4 v[128:131], v10, s[12:15], s28 offen offset:3072 sc0 sc1
    s_add_u32 s28, s28, 4096
    buffer_store_dwordx4 v[132:135], v10, s[12:15], s28 offen offset:3072 sc0 sc1
    s_add_u32 s28, s28, 4096
    buffer_store_dwordx4 v[136:139], v10, s[12:15], s28 offen offset:3072 sc0 sc1
    s_add_u32 s28, s28, 4096
    buffer_store_dwordx4 v[140:143], v10, s[12:15], s28 offen offset:3072 sc0 sc1
    s_nop 1
L_at_nowo2:
    s_mov_b32 s68, 3
    s_cmp_ge_u32 s21, 2
    s_cbranch_scc1 L_at_fin
    s_cmp_eq_u32 s69, 0
    s_cbranch_scc1 L_at_round
    s_waitcnt vmcnt(28)
    s_branch L_at_pre
L_at_fin:
    s_waitcnt lgkmcnt(0)
    s_barrier
    s_cmp_le_u32 s21, s27
    s_cbranch_scc1 L_at_nofb_7041
    s_sub_u32 s28, s21, 1
    s_cmp_eq_u32 s28, s23
    s_cbranch_scc1 L_at_nofb_7041
    s_lshl_b32 s29, s28, 2
    s_add_u32 s29, s29, 76000
    v_mov_b32 v4, s29
    ds_read_b32 v4, v4
    s_waitcnt lgkmcnt(0)
    v_readfirstlane_b32 s29, v4
    s_nop 3
    s_cmp_lg_u32 s29, 0
    s_cbranch_scc1 L_at_fallback
L_at_nofb_7041:
    s_branch L_at_end
L_bw1_455:
    s_sub_u32 s68, s68, 1
    s_waitcnt vmcnt(44) lgkmcnt(0)
    s_branch L_bw2_455
L_bw1_585:
    s_sub_u32 s68, s68, 1
    s_waitcnt vmcnt(44) lgkmcnt(0)
    s_branch L_bw2_585
L_bw1_700:
    s_sub_u32 s68, s68, 1
    s_waitcnt vmcnt(44) lgkmcnt(0)
    s_branch L_bw2_700
L_bw1_3150:
    s_sub_u32 s68, s68, 1
    s_waitcnt vmcnt(44) lgkmcnt(0)
    s_branch L_bw2_3150
L_bw1_3532:
    s_sub_u32 s68, s68, 1
    s_waitcnt vmcnt(44) lgkmcnt(0)
    s_branch L_bw2_3532
L_bw1_3841:
    s_sub_u32 s68, s68, 1
    s_waitcnt vmcnt(44) lgkmcnt(0)
    s_branch L_bw2_3841
L_at_wt0:
    s_and_b32 s28, s2, 127
    s_mul_i32 s28, s28, 40960
    s_mul_i32 s29, s20, 10240
    s_add_u32 s28, s28, s29
    v_lshlrev_b32 v4, 7, v1
    v_and_b32 v5, 15, v1
    v_lshlrev_b32 v5, 7, v5
    buffer_load_dword a250, v4, s[84:87], s28 offen
    s_add_u32 s28, s28, 8192
    buffer_load_dword a251, v5, s[84:87], s28 offen
    s_branch L_at_wt0r
L_at_fallback:
    s_sub_u32 s27, s21, 1
    s_mov_b32 s23, s27
    s_mov_b32 s25, 1
    s_mov_b32 s69, 0
    s_mov_b32 s70, 0
    s_mov_b32 s68, 0
    v_mov_b32 v12, 0xff800000
    v_mov_b32 v14, 0xff800000
    v_mov_b32 v16, 0xff800000
    v_mov_b32 v18, 0xff800000
    v_mov_b32 v20, 0xff800000
    v_mov_b32 v22, 0xff800000
    v_mov_b32 v24, 0xff800000
    s_waitcnt vmcnt(0) lgkmcnt(0)
    s_barrier
    s_branch L_at_start
L_at_maxpass:
    s_mov_b32 s25, 0
    s_waitcnt lgkmcnt(0)
    v_and_b32 v2, 15, v1
    v_lshlrev_b32 v2, 8, v2
    v_bfe_u32 v3, v1, 4, 1
    v_lshl_add_u32 v2, v3, 5, v2
    v_bfe_u32 v3, v1, 5, 1
    v_lshl_add_u32 v4, v3, 4, v2
    v_add_u32 v5, 4096, v4
    s_lshl_b32 s29, s21, 19
    s_mov_b32 s22, 0
L_at_mp:
    buffer_load_dwordx4 v[112:115], v4, s[8:11], s29 offen offset:0
    buffer_load_dwordx4 v[116:119], v4, s[8:11], s29 offen offset:64
    buffer_load_dwordx4 v[120:123], v4, s[8:11], s29 offen offset:128
    buffer_load_dwordx4 v[124:127], v4, s[8:11], s29 offen offset:192
    buffer_load_dwordx4 v[128:131], v5, s[8:11], s29 offen offset:0
    buffer_load_dwordx4 v[132:135], v5, s[8:11], s29 offen offset:64
    buffer_load_dwordx4 v[136:139], v5, s[8:11], s29 offen offset:128
    buffer_load_dwordx4 v[140:143], v5, s[8:11], s29 offen offset:192
    s_waitcnt vmcnt(0)
    v_mfma_f32_16x16x32_bf16 v[88:91], v[112:115], a[0:3], 0
    v_mfma_f32_16x16x32_bf16 v[88:91], v[116:119], a[4:7], v[88:91]
    v_mfma_f32_16x16x32_bf16 v[88:91], v[120:123], a[8:11], v[88:91]
    v_mfma_f32_16x16x32_bf16 v[88:91], v[124:127], a[12:15], v[88:91]
    v_mfma_f32_16x16x32_bf16 v[92:95], v[128:131], a[0:3], 0
    v_mfma_f32_16x16x32_bf16 v[92:95], v[132:135], a[4:7], v[92:95]
    v_mfma_f32_16x16x32_bf16 v[92:95], v[136:139], a[8:11], v[92:95]
    v_mfma_f32_16x16x32_bf16 v[92:95], v[140:143], a[12:15], v[92:95]
    s_nop 9
    v_max3_f32 v12, v88, v89, v12
    v_max3_f32 v12, v90, v91, v12
    v_max3_f32 v12, v92, v93, v12
    v_max3_f32 v12, v94, v95, v12
    s_nop 3
    v_mfma_f32_16x16x32_bf16 v[88:91], v[112:115], a[16:19], 0
    v_mfma_f32_16x16x32_bf16 v[88:91], v[116:119], a[20:23], v[88:91]
    v_mfma_f32_16x16x32_bf16 v[88:91], v[120:123], a[24:27], v[88:91]
    v_mfma_f32_16x16x32_bf16 v[88:91], v[124:127], a[28:31], v[88:91]
    v_mfma_f32_16x16x32_bf16 v[92:95], v[128:131], a[16:19], 0
    v_mfma_f32_16x16x32_bf16 v[92:95], v[132:135], a[20:23], v[92:95]
    v_mfma_f32_16x16x32_bf16 v[92:95], v[136:139], a[24:27], v[92:95]
    v_mfma_f32_16x16x32_bf16 v[92:95], v[140:143], a[28:31], v[92:95]
    s_nop 9
    v_max3_f32 v14, v88, v89, v14
    v_max3_f32 v14, v90, v91, v14
    v_max3_f32 v14, v92, v93, v14
    v_max3_f32 v14, v94, v95, v14
    s_nop 3
    v_mfma_f32_16x16x32_bf16 v[88:91], v[112:115], a[32:35], 0
    v_mfma_f32_16x16x32_bf16 v[88:91], v[116:119], a[36:39], v[88:91]
    v_mfma_f32_16x16x32_bf16 v[88:91], v[120:123], a[40:43], v[88:91]
    v_mfma_f32_16x16x32_bf16 v[88:91], v[124:127], a[44:47], v[88:91]
    v_mfma_f32_16x16x32_bf16 v[92:95], v[128:131], a[32:35], 0
    v_mfma_f32_16x16x32_bf16 v[92:95], v[132:135], a[36:39], v[92:95]
    v_mfma_f32_16x16x32_bf16 v[92:95], v[136:139], a[40:43], v[92:95]
    v_mfma_f32_16x16x32_bf16 v[92:95], v[140:143], a[44:47], v[92:95]
    s_nop 9
    v_max3_f32 v16, v88, v89, v16
    v_max3_f32 v16, v90, v91, v16
    v_max3_f32 v16, v92, v93, v16
    v_max3_f32 v16, v94, v95, v16
    s_nop 3
    v_mfma_f32_16x16x32_bf16 v[88:91], v[112:115], a[48:51], 0
    v_mfma_f32_16x16x32_bf16 v[88:91], v[116:119], a[52:55], v[88:91]
    v_mfma_f32_16x16x32_bf16 v[88:91], v[120:123], a[56:59], v[88:91]
    v_mfma_f32_16x16x32_bf16 v[88:91], v[124:127], a[60:63], v[88:91]
    v_mfma_f32_16x16x32_bf16 v[92:95], v[128:131], a[48:51], 0
    v_mfma_f32_16x16x32_bf16 v[92:95], v[132:135], a[52:55], v[92:95]
    v_mfma_f32_16x16x32_bf16 v[92:95], v[136:139], a[56:59], v[92:95]
    v_mfma_f32_16x16x32_bf16 v[92:95], v[140:143], a[60:63], v[92:95]
    s_nop 9
    v_max3_f32 v18, v88, v89, v18
    v_max3_f32 v18, v90, v91, v18
    v_max3_f32 v18, v92, v93, v18
    v_max3_f32 v18, v94, v95, v18
    s_nop 3
    v_mfma_f32_16x16x32_bf16 v[88:91], v[112:115], a[64:67], 0
    v_mfma_f32_16x16x32_bf16 v[88:91], v[116:119], a[68:71], v[88:91]
    v_mfma_f32_16x16x32_bf16 v[88:91], v[120:123], a[72:75], v[88:91]
    v_mfma_f32_16x16x32_bf16 v[88:91], v[124:127], a[76:79], v[88:91]
    v_mfma_f32_16x16x32_bf16 v[92:95], v[128:131], a[64:67], 0
    v_mfma_f32_16x16x32_bf16 v[92:95], v[132:135], a[68:71], v[92:95]
    v_mfma_f32_16x16x32_bf16 v[92:95], v[136:139], a[72:75], v[92:95]
    v_mfma_f32_16x16x32_bf16 v[92:95], v[140:143], a[76:79], v[92:95]
    s_nop 9
    v_max3_f32 v20, v88, v89, v20
    v_max3_f32 v20, v90, v91, v20
    v_max3_f32 v20, v92, v93, v20
    v_max3_f32 v20, v94, v95, v20
    s_nop 3
    v_mfma_f32_16x16x32_bf16 v[88:91], v[112:115], a[80:83], 0
    v_mfma_f32_16x16x32_bf16 v[88:91], v[116:119], a[84:87], v[88:91]
    v_mfma_f32_16x16x32_bf16 v[88:91], v[120:123], a[88:91], v[88:91]
    v_mfma_f32_16x16x32_bf16 v[88:91], v[124:127], a[92:95], v[88:91]
    v_mfma_f32_16x16x32_bf16 v[92:95], v[128:131], a[80:83], 0
    v_mfma_f32_16x16x32_bf16 v[92:95], v[132:135], a[84:87], v[92:95]
    v_mfma_f32_16x16x32_bf16 v[92:95], v[136:139], a[88:91], v[92:95]
    v_mfma_f32_16x16x32_bf16 v[92:95], v[140:143], a[92:95], v[92:95]
    s_nop 9
    v_max3_f32 v22, v88, v89, v22
    v_max3_f32 v22, v90, v91, v22
    v_max3_f32 v22, v92, v93, v22
    v_max3_f32 v22, v94, v95, v22
    s_nop 3
    v_mfma_f32_16x16x32_bf16 v[88:91], v[112:115], a[96:99], 0
    v_mfma_f32_16x16x32_bf16 v[88:91], v[116:119], a[100:103], v[88:91]
    v_mfma_f32_16x16x32_bf16 v[88:91], v[120:123], a[104:107], v[88:91]
    v_mfma_f32_16x16x32_bf16 v[88:91], v[124:127], a[108:111], v[88:91]
    v_mfma_f32_16x16x32_bf16 v[92:95], v[128:131], a[96:99], 0
    v_mfma_f32_16x16x32_bf16 v[92:95], v[132:135], a[100:103], v[92:95]
    v_mfma_f32_16x16x32_bf16 v[92:95], v[136:139], a[104:107], v[92:95]
    v_mfma_f32_16x16x32_bf16 v[92:95], v[140:143], a[108:111], v[92:95]
    s_nop 9
    v_max3_f32 v24, v88, v89, v24
    v_max3_f32 v24, v90, v91, v24
    v_max3_f32 v24, v92, v93, v24
    v_max3_f32 v24, v94, v95, v24
    s_nop 3
    s_add_u32 s29, s29, 8192
    s_add_u32 s22, s22, 1
    s_cmp_lt_u32 s22, 32
    s_cbranch_scc1 L_at_mp
    s_branch L_at_pre
L_at_end:
    s_endpgm
.globl op_kernel
.p2align 8
.type op_kernel,@function
op_kernel:
    s_cmp_ge_u32 s2, 256
    s_cbranch_scc1 L_op_end
    s_and_b32 s3, s2, 7
    s_lshl_b32 s3, s3, 5
    s_lshr_b32 s30, s2, 3
    s_add_u32 s3, s3, s30
    s_cmp_ge_u32 s3, 250
    s_cbranch_scc1 L_op_end
    s_load_dwordx2 s[36:37], s[0:1], 32
    s_load_dwordx2 s[38:39], s[0:1], 72
    s_load_dwordx2 s[40:41], s[0:1], 80
    s_load_dwordx2 s[44:45], s[0:1], 96
    v_and_b32 v1, 63, v0
    v_lshrrev_b32 v2, 6, v0
    s_nop 0
    v_readfirstlane_b32 s20, v2
    s_mul_i32 s28, s3, 13108
    s_lshr_b32 s28, s28, 16
    s_mul_i32 s22, s28, 5
    s_sub_u32 s29, s3, s22
    s_mov_b32 s61, s28
    s_cmp_ge_u32 s28, 25
    s_cselect_b32 s30, 1, 0
    s_cselect_b32 s22, 25, 0
    s_sub_u32 s28, s28, s22
    s_mul_i32 s31, s28, 9
    s_lshl_b32 s24, s20, 10
    s_add_u32 s24, s24, 58720256
    s_mul_i32 s23, s30, 29360128
    s_add_u32 s24, s24, s23
    s_add_u32 s22, s31, 0
    s_mul_i32 s23, s22, 4682
    s_lshr_b32 s23, s23, 16
    s_mul_i32 s62, s23, 1777664
    s_lshl_b32 s48, s22, 12
    s_add_u32 s48, s48, s62
    s_add_u32 s48, s48, s24
    s_add_u32 s22, s31, 1
    s_mul_i32 s23, s22, 4682
    s_lshr_b32 s23, s23, 16
    s_mul_i32 s62, s23, 1777664
    s_lshl_b32 s49, s22, 12
    s_add_u32 s49, s49, s62
    s_add_u32 s49, s49, s24
    s_add_u32 s22, s31, 2
    s_mul_i32 s23, s22, 4682
    s_lshr_b32 s23, s23, 16
    s_mul_i32 s62, s23, 1777664
    s_lshl_b32 s50, s22, 12
    s_add_u32 s50, s50, s62
    s_add_u32 s50, s50, s24
    s_add_u32 s22, s31, 3
    s_mul_i32 s23, s22, 4682
    s_lshr_b32 s23, s23, 16
    s_mul_i32 s62, s23, 1777664
    s_lshl_b32 s51, s22, 12
    s_add_u32 s51, s51, s62
    s_add_u32 s51, s51, s24
    s_add_u32 s22, s31, 4
    s_mul_i32 s23, s22, 4682
    s_lshr_b32 s23, s23, 16
    s_mul_i32 s62, s23, 1777664
    s_lshl_b32 s52, s22, 12
    s_add_u32 s52, s52, s62
    s_add_u32 s52, s52, s24
    s_add_u32 s22, s31, 5
    s_mul_i32 s23, s22, 4682
    s_lshr_b32 s23, s23, 16
    s_mul_i32 s62, s23, 1777664
    s_lshl_b32 s53, s22, 12
    s_add_u32 s53, s53, s62
    s_add_u32 s53, s53, s24
    s_add_u32 s22, s31, 6
    s_mul_i32 s23, s22, 4682
    s_lshr_b32 s23, s23, 16
    s_mul_i32 s62, s23, 1777664
    s_lshl_b32 s54, s22, 12
    s_add_u32 s54, s54, s62
    s_add_u32 s54, s54, s24
    s_add_u32 s22, s31, 7
    s_mul_i32 s23, s22, 4682
    s_lshr_b32 s23, s23, 16
    s_mul_i32 s62, s23, 1777664
    s_lshl_b32 s55, s22, 12
    s_add_u32 s55, s55, s62
    s_add_u32 s55, s55, s24
    s_add_u32 s22, s31, 8
    s_mul_i32 s23, s22, 4682
    s_lshr_b32 s23, s23, 16
    s_mul_i32 s62, s23, 1777664
    s_lshl_b32 s56, s22, 12
    s_add_u32 s56, s56, s62
    s_add_u32 s56, s56, s24
    s_cmp_ge_u32 s22, 224
    s_cselect_b32 s62, 0x40000000, 0
    s_add_u32 s56, s56, s62
    v_lshlrev_b32 v6, 4, v1
    v_lshrrev_b32 v2, 4, v1
    v_and_b32 v3, 15, v1
    v_lshlrev_b32 v4, 1, v2
    v_xor_b32 v3, v3, v4
    v_lshlrev_b32 v3, 4, v3
    v_mul_u32_u24 v4, 1280, v2
    v_add_u32 v5, v4, v3
    v_xor_b32 v3, 128, v3
    v_add_u32 v4, v4, v3
    v_add_u32 v10, 0, v5
    v_add_u32 v11, 4096, v5
    v_add_u32 v12, 8192, v4
    v_add_u32 v13, 12288, v4
    v_add_u32 v14, 20480, v5
    v_add_u32 v15, 24576, v5
    v_add_u32 v16, 28672, v4
    v_add_u32 v17, 32768, v4
    s_mul_i32 s27, s20, 40960
    s_waitcnt lgkmcnt(0)
    s_cmp_lg_u32 s30, 0
    s_cselect_b32 s8, s38, s36
    s_cselect_b32 s9, s39, s37
    s_mov_b32 s10, 5242880
    s_mov_b32 s11, 0x20000
    s_mov_b32 s4, s44
    s_mov_b32 s5, s45
    s_mov_b32 s6, 127926272
    s_mov_b32 s7, 0x20000
    s_mov_b32 s12, s40
    s_mov_b32 s13, s41
    s_mov_b32 s14, 9175040
    s_mov_b32 s15, 0x20000
    s_mul_i32 s22, s20, 40960
    s_lshl_b32 s23, s29, 8
    s_add_u32 s26, s22, s23
    s_mov_b32 s25, 0
    v_add_u32 v7, s25, v6
    s_add_u32 m0, s27, 0
    s_nop 0
    buffer_load_dwordx4 v10, s[8:11], s26 offen offset:0 lds
    buffer_load_dwordx4 v11, s[8:11], s26 offen offset:1024 lds
    buffer_load_dwordx4 v12, s[8:11], s26 offen offset:2048 lds
    buffer_load_dwordx4 v13, s[8:11], s26 offen offset:3072 lds
    s_add_u32 m0, s27, 4096
    s_nop 0
    buffer_load_dwordx4 v14, s[8:11], s26 offen offset:0 lds
    buffer_load_dwordx4 v15, s[8:11], s26 offen offset:1024 lds
    buffer_load_dwordx4 v16, s[8:11], s26 offen offset:2048 lds
    buffer_load_dwordx4 v17, s[8:11], s26 offen offset:3072 lds
    s_add_u32 s26, s26, 163840
    buffer_load_dwordx4 v[92:95], v7, s[4:7], s48 offen
    buffer_load_dwordx4 v[96:99], v7, s[4:7], s49 offen
    buffer_load_dwordx4 v[100:103], v7, s[4:7], s50 offen
    buffer_load_dwordx4 v[104:107], v7, s[4:7], s51 offen
    buffer_load_dwordx4 v[108:111], v7, s[4:7], s52 offen
    buffer_load_dwordx4 v[112:115], v7, s[4:7], s53 offen
    buffer_load_dwordx4 v[116:119], v7, s[4:7], s54 offen
    buffer_load_dwordx4 v[120:123], v7, s[4:7], s55 offen
    buffer_load_dwordx4 v[124:127], v7, s[4:7], s56 offen
    v_add_u32 v7, 57344, v7
    s_add_u32 m0, s27, 8192
    s_nop 0
    buffer_load_dwordx4 v10, s[8:11], s26 offen offset:0 lds
    buffer_load_dwordx4 v11, s[8:11], s26 offen offset:1024 lds
    buffer_load_dwordx4 v12, s[8:11], s26 offen offset:2048 lds
    buffer_load_dwordx4 v13, s[8:11], s26 offen offset:3072 lds
    s_add_u32 m0, s27, 12288
    s_nop 0
    buffer_load_dwordx4 v14, s[8:11], s26 offen offset:0 lds
    buffer_load_dwordx4 v15, s[8:11], s26 offen offset:1024 lds
    buffer_load_dwordx4 v16, s[8:11], s26 offen offset:2048 lds
    buffer_load_dwordx4 v17, s[8:11], s26 offen offset:3072 lds
    s_add_u32 s26, s26, 163840
    v_lshrrev_b32 v2, 4, v1
    v_bfe_u32 v3, v1, 2, 2
    v_lshl_add_u32 v4, v2, 3, v3
    v_lshlrev_b32 v4, 8, v4
    v_and_b32 v2, 1, v2
    v_lshl_add_u32 v3, v2, 2, v3
    v_lshl_add_u32 v4, v3, 5, v4
    v_and_b32 v3, 3, v1
    v_lshl_add_u32 v4, v3, 3, v4
    v_add_u32 v4, s27, v4
    v_xor_b32 v18, 0, v4
    v_xor_b32 v19, 32, v4
    v_xor_b32 v20, 64, v4
    v_xor_b32 v21, 96, v4
    v_xor_b32 v22, 128, v4
    v_xor_b32 v23, 160, v4
    v_xor_b32 v24, 192, v4
    v_xor_b32 v25, 224, v4
    v_add_u32 v8, s27, v6
    v_bfe_u32 v4, v1, 4, 1
    v_lshlrev_b32 v4, 5, v4
    v_and_b32 v2, 15, v1
    v_mul_u32_u24 v2, 2560, v2
    v_add_u32 v2, v2, v4
    v_bfe_u32 v4, v1, 5, 1
    v_lshl_add_u32 v9, v4, 4, v2
    s_lshl_b32 s22, s20, 11
    v_add_u32 v2, s22, v6
    v_add_u32 v3, 40960, v2
    v_add_u32 v4, 81920, v2
    v_add_u32 v5, 122880, v2
    s_mul_i32 s22, s28, 368640
    s_mul_i32 s23, s30, 1280
    s_add_u32 s22, s22, s23
    s_lshl_b32 s23, s29, 8
    s_add_u32 s24, s22, s23
    s_waitcnt vmcnt(17)
    ds_read_b64_tr_b16 v[60:61], v18 offset:0
    ds_read_b64_tr_b16 v[62:63], v18 offset:1024
    ds_read_b64_tr_b16 v[64:65], v19 offset:0
    ds_read_b64_tr_b16 v[66:67], v19 offset:1024
    ds_read_b64_tr_b16 v[68:69], v20 offset:0
    ds_read_b64_tr_b16 v[70:71], v20 offset:1024
    ds_read_b64_tr_b16 v[72:73], v21 offset:0
    ds_read_b64_tr_b16 v[74:75], v21 offset:1024
    ds_read_b64_tr_b16 v[76:77], v22 offset:0
    ds_read_b64_tr_b16 v[78:79], v22 offset:1024
    ds_read_b64_tr_b16 v[80:81], v23 offset:0
    ds_read_b64_tr_b16 v[82:83], v23 offset:1024
    ds_read_b64_tr_b16 v[84:85], v24 offset:0
    ds_read_b64_tr_b16 v[86:87], v24 offset:1024
    ds_read_b64_tr_b16 v[88:89], v25 offset:0
    ds_read_b64_tr_b16 v[90:91], v25 offset:1024
    s_waitcnt vmcnt(0) lgkmcnt(12)
    v_mfma_f32_16x16x32_bf16 a[0:3], v[60:63], v[92:95], 0
    buffer_load_dwordx4 v[128:131], v7, s[4:7], s48 offen
    v_mfma_f32_16x16x32_bf16 a[4:7], v[60:63], v[96:99], 0
    buffer_load_dwordx4 v[132:135], v7, s[4:7], s49 offen
    v_mfma_f32_16x16x32_bf16 a[8:11], v[60:63], v[100:103], 0
    buffer_load_dwordx4 v[136:139], v7, s[4:7], s50 offen
    v_mfma_f32_16x16x32_bf16 a[12:15], v[60:63], v[104:107], 0
    buffer_load_dwordx4 v[140:143], v7, s[4:7], s51 offen
    v_mfma_f32_16x16x32_bf16 a[16:19], v[60:63], v[108:111], 0
    buffer_load_dwordx4 v[144:147], v7, s[4:7], s52 offen
    v_mfma_f32_16x16x32_bf16 a[20:23], v[60:63], v[112:115], 0
    buffer_load_dwordx4 v[148:151], v7, s[4:7], s53 offen
    v_mfma_f32_16x16x32_bf16 a[24:27], v[60:63], v[116:119], 0
    buffer_load_dwordx4 v[152:155], v7, s[4:7], s54 offen
    v_mfma_f32_16x16x32_bf16 a[28:31], v[60:63], v[120:123], 0
    buffer_load_dwordx4 v[156:159], v7, s[4:7], s55 offen
    v_mfma_f32_16x16x32_bf16 a[32:35], v[60:63], v[124:127], 0
    ds_read_b64_tr_b16 v[60:61], v18 offset:8192
    ds_read_b64_tr_b16 v[62:63], v18 offset:9216
    v_mfma_f32_16x16x32_bf16 a[36:39], v[64:67], v[92:95], 0
    buffer_load_dwordx4 v[160:163], v7, s[4:7], s56 offen
    v_mfma_f32_16x16x32_bf16 a[40:43], v[64:67], v[96:99], 0
    v_add_u32 v7, 57344, v7
    v_mfma_f32_16x16x32_bf16 a[44:47], v[64:67], v[100:103], 0
    v_mfma_f32_16x16x32_bf16 a[48:51], v[64:67], v[104:107], 0
    v_mfma_f32_16x16x32_bf16 a[52:55], v[64:67], v[108:111], 0
    v_mfma_f32_16x16x32_bf16 a[56:59], v[64:67], v[112:115], 0
    v_mfma_f32_16x16x32_bf16 a[60:63], v[64:67], v[116:119], 0
    v_mfma_f32_16x16x32_bf16 a[64:67], v[64:67], v[120:123], 0
    v_mfma_f32_16x16x32_bf16 a[68:71], v[64:67], v[124:127], 0
    ds_read_b64_tr_b16 v[64:65], v19 offset:8192
    ds_read_b64_tr_b16 v[66:67], v19 offset:9216
    s_waitcnt lgkmcnt(4)
    v_mfma_f32_16x16x32_bf16 a[72:75], v[68:71], v[92:95], 0
    s_add_u32 m0, s27, 16384
    v_mfma_f32_16x16x32_bf16 a[76:79], v[68:71], v[96:99], 0
    s_nop 0
    v_mfma_f32_16x16x32_bf16 a[80:83], v[68:71], v[100:103], 0
    buffer_load_dwordx4 v10, s[8:11], s26 offen offset:0 lds
    v_mfma_f32_16x16x32_bf16 a[84:87], v[68:71], v[104:107], 0
    buffer_load_dwordx4 v11, s[8:11], s26 offen offset:1024 lds
    v_mfma_f32_16x16x32_bf16 a[88:91], v[68:71], v[108:111], 0
    buffer_load_dwordx4 v12, s[8:11], s26 offen offset:2048 lds
    v_mfma_f32_16x16x32_bf16 a[92:95], v[68:71], v[112:115], 0
    buffer_load_dwordx4 v13, s[8:11], s26 offen offset:3072 lds
    v_mfma_f32_16x16x32_bf16 a[96:99], v[68:71], v[116:119], 0
    s_add_u32 m0, s27, 20480
    v_mfma_f32_16x16x32_bf16 a[100:103], v[68:71], v[120:123], 0
    s_nop 0
    v_mfma_f32_16x16x32_bf16 a[104:107], v[68:71], v[124:127], 0
    ds_read_b64_tr_b16 v[68:69], v20 offset:8192
    ds_read_b64_tr_b16 v[70:71], v20 offset:9216
    v_mfma_f32_16x16x32_bf16 a[108:111], v[72:75], v[92:95], 0
    buffer_load_dwordx4 v14, s[8:11], s26 offen offset:0 lds
    v_mfma_f32_16x16x32_bf16 a[112:115], v[72:75], v[96:99], 0
    buffer_load_dwordx4 v15, s[8:11], s26 offen offset:1024 lds
    v_mfma_f32_16x16x32_bf16 a[116:119], v[72:75], v[100:103], 0
    buffer_load_dwordx4 v16, s[8:11], s26 offen offset:2048 lds
    v_mfma_f32_16x16x32_bf16 a[120:123], v[72:75], v[104:107], 0
    buffer_load_dwordx4 v17, s[8:11], s26 offen offset:3072 lds
    v_mfma_f32_16x16x32_bf16 a[124:127], v[72:75], v[108:111], 0
    s_add_u32 s26, s26, 163840
    v_mfma_f32_16x16x32_bf16 a[128:131], v[72:75], v[112:115], 0
    buffer_load_dwordx4 v[164:167], v7, s[4:7], s48 offen
    v_mfma_f32_16x16x32_bf16 a[132:135], v[72:75], v[116:119], 0
    buffer_load_dwordx4 v[168:171], v7, s[4:7], s49 offen
    v_mfma_f32_16x16x32_bf16 a[136:139], v[72:75], v[120:123], 0
    buffer_load_dwordx4 v[172:175], v7, s[4:7], s50 offen
    v_mfma_f32_16x16x32_bf16 a[140:143], v[72:75], v[124:127], 0
    ds_read_b64_tr_b16 v[72:73], v21 offset:8192
    ds_read_b64_tr_b16 v[74:75], v21 offset:9216
    v_mfma_f32_16x16x32_bf16 a[144:147], v[76:79], v[92:95], 0
    buffer_load_dwordx4 v[176:179], v7, s[4:7], s51 offen
    v_mfma_f32_16x16x32_bf16 a[148:151], v[76:79], v[96:99], 0
    buffer_load_dwordx4 v[180:183], v7, s[4:7], s52 offen
    v_mfma_f32_16x16x32_bf16 a[152:155], v[76:79], v[100:103], 0
    buffer_load_dwordx4 v[184:187], v7, s[4:7], s53 offen
    v_mfma_f32_16x16x32_bf16 a[156:159], v[76:79], v[104:107], 0
    buffer_load_dwordx4 v[188:191], v7, s[4:7], s54 offen
    v_mfma_f32_16x16x32_bf16 a[160:163], v[76:79], v[108:111], 0
    buffer_load_dwordx4 v[192:195], v7, s[4:7], s55 offen
    v_mfma_f32_16x16x32_bf16 a[164:167], v[76:79], v[112:115], 0
    buffer_load_dwordx4 v[196:199], v7, s[4:7], s56 offen
    v_mfma_f32_16x16x32_bf16 a[168:171], v[76:79], v[116:119], 0
    v_add_u32 v7, 57344, v7
    v_mfma_f32_16x16x32_bf16 a[172:175], v[76:79], v[120:123], 0
    v_mfma_f32_16x16x32_bf16 a[176:179], v[76:79], v[124:127], 0
    ds_read_b64_tr_b16 v[76:77], v22 offset:8192
    ds_read_b64_tr_b16 v[78:79], v22 offset:9216
    v_mfma_f32_16x16x32_bf16 a[180:183], v[80:83], v[92:95], 0
    v_mfma_f32_16x16x32_bf16 a[184:187], v[80:83], v[96:99], 0
    v_mfma_f32_16x16x32_bf16 a[188:191], v[80:83], v[100:103], 0
    v_mfma_f32_16x16x32_bf16 a[192:195], v[80:83], v[104:107], 0
    v_mfma_f32_16x16x32_bf16 a[196:199], v[80:83], v[108:111], 0
    v_mfma_f32_16x16x32_bf16 a[200:203], v[80:83], v[112:115], 0
    v_mfma_f32_16x16x32_bf16 a[204:207], v[80:83], v[116:119], 0
    v_mfma_f32_16x16x32_bf16 a[208:211], v[80:83], v[120:123], 0
    v_mfma_f32_16x16x32_bf16 a[212:215], v[80:83], v[124:127], 0
    ds_read_b64_tr_b16 v[80:81], v23 offset:8192
    ds_read_b64_tr_b16 v[82:83], v23 offset:9216
    v_mfma_f32_16x16x32_bf16 a[216:219], v[84:87], v[92:95], 0
    v_mfma_f32_16x16x32_bf16 a[220:223], v[84:87], v[96:99], 0
    v_mfma_f32_16x16x32_bf16 a[224:227], v[84:87], v[100:103], 0
    v_mfma_f32_16x16x32_bf16 a[228:231], v[84:87], v[104:107], 0
    v_mfma_f32_16x16x32_bf16 a[232:235], v[84:87], v[108:111], 0
    v_mfma_f32_16x16x32_bf16 a[236:239], v[84:87], v[112:115], 0
    v_mfma_f32_16x16x32_bf16 a[240:243], v[84:87], v[116:119], 0
    v_mfma_f32_16x16x32_bf16 a[244:247], v[84:87], v[120:123], 0
    v_mfma_f32_16x16x32_bf16 a[248:251], v[84:87], v[124:127], 0
    ds_read_b64_tr_b16 v[84:85], v24 offset:8192
    ds_read_b64_tr_b16 v[86:87], v24 offset:9216
    v_mfma_f32_16x16x32_bf16 a[252:255], v[88:91], v[92:95], 0
    v_mfma_f32_16x16x32_bf16 v[28:31], v[88:91], v[96:99], 0
    v_mfma_f32_16x16x32_bf16 v[32:35], v[88:91], v[100:103], 0
    v_mfma_f32_16x16x32_bf16 v[36:39], v[88:91], v[104:107], 0
    v_mfma_f32_16x16x32_bf16 v[40:43], v[88:91], v[108:111], 0
    v_mfma_f32_16x16x32_bf16 v[44:47], v[88:91], v[112:115], 0
    v_mfma_f32_16x16x32_bf16 v[48:51], v[88:91], v[116:119], 0
    v_mfma_f32_16x16x32_bf16 v[52:55], v[88:91], v[120:123], 0
    v_mfma_f32_16x16x32_bf16 v[56:59], v[88:91], v[124:127], 0
    ds_read_b64_tr_b16 v[88:89], v25 offset:8192
    ds_read_b64_tr_b16 v[90:91], v25 offset:9216
    s_waitcnt vmcnt(9) lgkmcnt(12)
    v_mfma_f32_16x16x32_bf16 a[0:3], v[60:63], v[128:131], a[0:3]
    v_mfma_f32_16x16x32_bf16 a[4:7], v[60:63], v[132:135], a[4:7]
    v_mfma_f32_16x16x32_bf16 a[8:11], v[60:63], v[136:139], a[8:11]
    v_mfma_f32_16x16x32_bf16 a[12:15], v[60:63], v[140:143], a[12:15]
    v_mfma_f32_16x16x32_bf16 a[16:19], v[60:63], v[144:147], a[16:19]
    v_mfma_f32_16x16x32_bf16 a[20:23], v[60:63], v[148:151], a[20:23]
    v_mfma_f32_16x16x32_bf16 a[24:27], v[60:63], v[152:155], a[24:27]
    v_mfma_f32_16x16x32_bf16 a[28:31], v[60:63], v[156:159], a[28:31]
    v_mfma_f32_16x16x32_bf16 a[32:35], v[60:63], v[160:163], a[32:35]
    ds_read_b64_tr_b16 v[60:61], v18 offset:16384
    ds_read_b64_tr_b16 v[62:63], v18 offset:17408
    v_mfma_f32_16x16x32_bf16 a[36:39], v[64:67], v[128:131], a[36:39]
    v_mfma_f32_16x16x32_bf16 a[40:43], v[64:67], v[132:135], a[40:43]
    v_mfma_f32_16x16x32_bf16 a[44:47], v[64:67], v[136:139], a[44:47]
    v_mfma_f32_16x16x32_bf16 a[48:51], v[64:67], v[140:143], a[48:51]
    v_mfma_f32_16x16x32_bf16 a[52:55], v[64:67], v[144:147], a[52:55]
    v_mfma_f32_16x16x32_bf16 a[56:59], v[64:67], v[148:151], a[56:59]
    v_mfma_f32_16x16x32_bf16 a[60:63], v[64:67], v[152:155], a[60:63]
    v_mfma_f32_16x16x32_bf16 a[64:67], v[64:67], v[156:159], a[64:67]
    v_mfma_f32_16x16x32_bf16 a[68:71], v[64:67], v[160:163], a[68:71]
    ds_read_b64_tr_b16 v[64:65], v19 offset:16384
    ds_read_b64_tr_b16 v[66:67], v19 offset:17408
    s_waitcnt lgkmcnt(4)
    v_mfma_f32_16x16x32_bf16 a[72:75], v[68:71], v[128:131], a[72:75]
    s_add_u32 m0, s27, 24576
    v_mfma_f32_16x16x32_bf16 a[76:79], v[68:71], v[132:135], a[76:79]
    s_nop 0
    v_mfma_f32_16x16x32_bf16 a[80:83], v[68:71], v[136:139], a[80:83]
    buffer_load_dwordx4 v10, s[8:11], s26 offen offset:0 lds
    v_mfma_f32_16x16x32_bf16 a[84:87], v[68:71], v[140:143], a[84:87]
    buffer_load_dwordx4 v11, s[8:11], s26 offen offset:1024 lds
    v_mfma_f32_16x16x32_bf16 a[88:91], v[68:71], v[144:147], a[88:91]
    buffer_load_dwordx4 v12, s[8:11], s26 offen offset:2048 lds
    v_mfma_f32_16x16x32_bf16 a[92:95], v[68:71], v[148:151], a[92:95]
    buffer_load_dwordx4 v13, s[8:11], s26 offen offset:3072 lds
    v_mfma_f32_16x16x32_bf16 a[96:99], v[68:71], v[152:155], a[96:99]
    s_add_u32 m0, s27, 28672
    v_mfma_f32_16x16x32_bf16 a[100:103], v[68:71], v[156:159], a[100:103]
    s_nop 0
    v_mfma_f32_16x16x32_bf16 a[104:107], v[68:71], v[160:163], a[104:107]
    ds_read_b64_tr_b16 v[68:69], v20 offset:16384
    ds_read_b64_tr_b16 v[70:71], v20 offset:17408
    v_mfma_f32_16x16x32_bf16 a[108:111], v[72:75], v[128:131], a[108:111]
    buffer_load_dwordx4 v14, s[8:11], s26 offen offset:0 lds
    v_mfma_f32_16x16x32_bf16 a[112:115], v[72:75], v[132:135], a[112:115]
    buffer_load_dwordx4 v15, s[8:11], s26 offen offset:1024 lds
    v_mfma_f32_16x16x32_bf16 a[116:119], v[72:75], v[136:139], a[116:119]
    buffer_load_dwordx4 v16, s[8:11], s26 offen offset:2048 lds
    v_mfma_f32_16x16x32_bf16 a[120:123], v[72:75], v[140:143], a[120:123]
    buffer_load_dwordx4 v17, s[8:11], s26 offen offset:3072 lds
    v_mfma_f32_16x16x32_bf16 a[124:127], v[72:75], v[144:147], a[124:127]
    s_add_u32 s26, s26, 163840
    v_mfma_f32_16x16x32_bf16 a[128:131], v[72:75], v[148:151], a[128:131]
    buffer_load_dwordx4 v[200:203], v7, s[4:7], s48 offen
    v_mfma_f32_16x16x32_bf16 a[132:135], v[72:75], v[152:155], a[132:135]
    buffer_load_dwordx4 v[204:207], v7, s[4:7], s49 offen
    v_mfma_f32_16x16x32_bf16 a[136:139], v[72:75], v[156:159], a[136:139]
    buffer_load_dwordx4 v[208:211], v7, s[4:7], s50 offen
    v_mfma_f32_16x16x32_bf16 a[140:143], v[72:75], v[160:163], a[140:143]
    ds_read_b64_tr_b16 v[72:73], v21 offset:16384
    ds_read_b64_tr_b16 v[74:75], v21 offset:17408
    v_mfma_f32_16x16x32_bf16 a[144:147], v[76:79], v[128:131], a[144:147]
    buffer_load_dwordx4 v[212:215], v7, s[4:7], s51 offen
    v_mfma_f32_16x16x32_bf16 a[148:151], v[76:79], v[132:135], a[148:151]
    buffer_load_dwordx4 v[216:219], v7, s[4:7], s52 offen
    v_mfma_f32_16x16x32_bf16 a[152:155], v[76:79], v[136:139], a[152:155]
    buffer_load_dwordx4 v[220:223], v7, s[4:7], s53 offen
    v_mfma_f32_16x16x32_bf16 a[156:159], v[76:79], v[140:143], a[156:159]
    buffer_load_dwordx4 v[224:227], v7, s[4:7], s54 offen
    v_mfma_f32_16x16x32_bf16 a[160:163], v[76:79], v[144:147], a[160:163]
    buffer_load_dwordx4 v[228:231], v7, s[4:7], s55 offen
    v_mfma_f32_16x16x32_bf16 a[164:167], v[76:79], v[148:151], a[164:167]
    buffer_load_dwordx4 v[232:235], v7, s[4:7], s56 offen
    v_mfma_f32_16x16x32_bf16 a[168:171], v[76:79], v[152:155], a[168:171]
    v_add_u32 v7, 57344, v7
    v_mfma_f32_16x16x32_bf16 a[172:175], v[76:79], v[156:159], a[172:175]
    s_add_u32 m0, s27, 0
    v_mfma_f32_16x16x32_bf16 a[176:179], v[76:79], v[160:163], a[176:179]
    ds_read_b64_tr_b16 v[76:77], v22 offset:16384
    ds_read_b64_tr_b16 v[78:79], v22 offset:17408
    v_mfma_f32_16x16x32_bf16 a[180:183], v[80:83], v[128:131], a[180:183]
    s_nop 0
    v_mfma_f32_16x16x32_bf16 a[184:187], v[80:83], v[132:135], a[184:187]
    buffer_load_dwordx4 v10, s[8:11], s26 offen offset:0 lds
    v_mfma_f32_16x16x32_bf16 a[188:191], v[80:83], v[136:139], a[188:191]
    buffer_load_dwordx4 v11, s[8:11], s26 offen offset:1024 lds
    v_mfma_f32_16x16x32_bf16 a[192:195], v[80:83], v[140:143], a[192:195]
    buffer_load_dwordx4 v12, s[8:11], s26 offen offset:2048 lds
    v_mfma_f32_16x16x32_bf16 a[196:199], v[80:83], v[144:147], a[196:199]
    buffer_load_dwordx4 v13, s[8:11], s26 offen offset:3072 lds
    v_mfma_f32_16x16x32_bf16 a[200:203], v[80:83], v[148:151], a[200:203]
    s_add_u32 m0, s27, 4096
    v_mfma_f32_16x16x32_bf16 a[204:207], v[80:83], v[152:155], a[204:207]
    s_nop 0
    v_mfma_f32_16x16x32_bf16 a[208:211], v[80:83], v[156:159], a[208:211]
    buffer_load_dwordx4 v14, s[8:11], s26 offen offset:0 lds
    v_mfma_f32_16x16x32_bf16 a[212:215], v[80:83], v[160:163], a[212:215]
    ds_read_b64_tr_b16 v[80:81], v23 offset:16384
    ds_read_b64_tr_b16 v[82:83], v23 offset:17408
    v_mfma_f32_16x16x32_bf16 a[216:219], v[84:87], v[128:131], a[216:219]
    buffer_load_dwordx4 v15, s[8:11], s26 offen offset:1024 lds
    v_mfma_f32_16x16x32_bf16 a[220:223], v[84:87], v[132:135], a[220:223]
    buffer_load_dwordx4 v16, s[8:11], s26 offen offset:2048 lds
    v_mfma_f32_16x16x32_bf16 a[224:227], v[84:87], v[136:139], a[224:227]
    buffer_load_dwordx4 v17, s[8:11], s26 offen offset:3072 lds
    v_mfma_f32_16x16x32_bf16 a[228:231], v[84:87], v[140:143], a[228:231]
    s_add_u32 s26, s26, 163840
    v_mfma_f32_16x16x32_bf16 a[232:235], v[84:87], v[144:147], a[232:235]
    v_mfma_f32_16x16x32_bf16 a[236:239], v[84:87], v[148:151], a[236:239]
    v_mfma_f32_16x16x32_bf16 a[240:243], v[84:87], v[152:155], a[240:243]
    v_mfma_f32_16x16x32_bf16 a[244:247], v[84:87], v[156:159], a[244:247]
    v_mfma_f32_16x16x32_bf16 a[248:251], v[84:87], v[160:163], a[248:251]
    ds_read_b64_tr_b16 v[84:85], v24 offset:16384
    ds_read_b64_tr_b16 v[86:87], v24 offset:17408
    v_mfma_f32_16x16x32_bf16 a[252:255], v[88:91], v[128:131], a[252:255]
    v_mfma_f32_16x16x32_bf16 v[28:31], v[88:91], v[132:135], v[28:31]
    v_mfma_f32_16x16x32_bf16 v[32:35], v[88:91], v[136:139], v[32:35]
    v_mfma_f32_16x16x32_bf16 v[36:39], v[88:91], v[140:143], v[36:39]
    v_mfma_f32_16x16x32_bf16 v[40:43], v[88:91], v[144:147], v[40:43]
    v_mfma_f32_16x16x32_bf16 v[44:47], v[88:91], v[148:151], v[44:47]
    v_mfma_f32_16x16x32_bf16 v[48:51], v[88:91], v[152:155], v[48:51]
    v_mfma_f32_16x16x32_bf16 v[52:55], v[88:91], v[156:159], v[52:55]
    v_mfma_f32_16x16x32_bf16 v[56:59], v[88:91], v[160:163], v[56:59]
    ds_read_b64_tr_b16 v[88:89], v25 offset:16384
    ds_read_b64_tr_b16 v[90:91], v25 offset:17408
    s_waitcnt vmcnt(17) lgkmcnt(12)
    v_mfma_f32_16x16x32_bf16 a[0:3], v[60:63], v[164:167], a[0:3]
    buffer_load_dwordx4 v[92:95], v7, s[4:7], s48 offen
    v_mfma_f32_16x16x32_bf16 a[4:7], v[60:63], v[168:171], a[4:7]
    buffer_load_dwordx4 v[96:99], v7, s[4:7], s49 offen
    v_mfma_f32_16x16x32_bf16 a[8:11], v[60:63], v[172:175], a[8:11]
    buffer_load_dwordx4 v[100:103], v7, s[4:7], s50 offen
    v_mfma_f32_16x16x32_bf16 a[12:15], v[60:63], v[176:179], a[12:15]
    buffer_load_dwordx4 v[104:107], v7, s[4:7], s51 offen
    v_mfma_f32_16x16x32_bf16 a[16:19], v[60:63], v[180:183], a[16:19]
    buffer_load_dwordx4 v[108:111], v7, s[4:7], s52 offen
    v_mfma_f32_16x16x32_bf16 a[20:23], v[60:63], v[184:187], a[20:23]
    buffer_load_dwordx4 v[112:115], v7, s[4:7], s53 offen
    v_mfma_f32_16x16x32_bf16 a[24:27], v[60:63], v[188:191], a[24:27]
    buffer_load_dwordx4 v[116:119], v7, s[4:7], s54 offen
    v_mfma_f32_16x16x32_bf16 a[28:31], v[60:63], v[192:195], a[28:31]
    buffer_load_dwordx4 v[120:123], v7, s[4:7], s55 offen
    v_mfma_f32_16x16x32_bf16 a[32:35], v[60:63], v[196:199], a[32:35]
    ds_read_b64_tr_b16 v[60:61], v18 offset:24576
    ds_read_b64_tr_b16 v[62:63], v18 offset:25600
    v_mfma_f32_16x16x32_bf16 a[36:39], v[64:67], v[164:167], a[36:39]
    buffer_load_dwordx4 v[124:127], v7, s[4:7], s56 offen
    v_mfma_f32_16x16x32_bf16 a[40:43], v[64:67], v[168:171], a[40:43]
    v_add_u32 v7, 57344, v7
    v_mfma_f32_16x16x32_bf16 a[44:47], v[64:67], v[172:175], a[44:47]
    v_mfma_f32_16x16x32_bf16 a[48:51], v[64:67], v[176:179], a[48:51]
    v_mfma_f32_16x16x32_bf16 a[52:55], v[64:67], v[180:183], a[52:55]
    v_mfma_f32_16x16x32_bf16 a[56:59], v[64:67], v[184:187], a[56:59]
    v_mfma_f32_16x16x32_bf16 a[60:63], v[64:67], v[188:191], a[60:63]
    v_mfma_f32_16x16x32_bf16 a[64:67], v[64:67], v[192:195], a[64:67]
    v_mfma_f32_16x16x32_bf16 a[68:71], v[64:67], v[196:199], a[68:71]
    ds_read_b64_tr_b16 v[64:65], v19 offset:24576
    ds_read_b64_tr_b16 v[66:67], v19 offset:25600
    s_waitcnt lgkmcnt(4)
    v_mfma_f32_16x16x32_bf16 a[72:75], v[68:71], v[164:167], a[72:75]
    s_add_u32 m0, s27, 8192
    v_mfma_f32_16x16x32_bf16 a[76:79], v[68:71], v[168:171], a[76:79]
    s_nop 0
    v_mfma_f32_16x16x32_bf16 a[80:83], v[68:71], v[172:175], a[80:83]
    buffer_load_dwordx4 v10, s[8:11], s26 offen offset:0 lds
    v_mfma_f32_16x16x32_bf16 a[84:87], v[68:71], v[176:179], a[84:87]
    buffer_load_dwordx4 v11, s[8:11], s26 offen offset:1024 lds
    v_mfma_f32_16x16x32_bf16 a[88:91], v[68:71], v[180:183], a[88:91]
    buffer_load_dwordx4 v12, s[8:11], s26 offen offset:2048 lds
    v_mfma_f32_16x16x32_bf16 a[92:95], v[68:71], v[184:187], a[92:95]
    buffer_load_dwordx4 v13, s[8:11], s26 offen offset:3072 lds
    v_mfma_f32_16x16x32_bf16 a[96:99], v[68:71], v[188:191], a[96:99]
    s_add_u32 m0, s27, 12288
    v_mfma_f32_16x16x32_bf16 a[100:103], v[68:71], v[192:195], a[100:103]
    s_nop 0
    v_mfma_f32_16x16x32_bf16 a[104:107], v[68:71], v[196:199], a[104:107]
    ds_read_b64_tr_b16 v[68:69], v20 offset:24576
    ds_read_b64_tr_b16 v[70:71], v20 offset:25600
    v_mfma_f32_16x16x32_bf16 a[108:111], v[72:75], v[164:167], a[108:111]
    buffer_load_dwordx4 v14, s[8:11], s26 offen offset:0 lds
    v_mfma_f32_16x16x32_bf16 a[112:115], v[72:75], v[168:171], a[112:115]
    buffer_load_dwordx4 v15, s[8:11], s26 offen offset:1024 lds
    v_mfma_f32_16x16x32_bf16 a[116:119], v[72:75], v[172:175], a[116:119]
    buffer_load_dwordx4 v16, s[8:11], s26 offen offset:2048 lds
    v_mfma_f32_16x16x32_bf16 a[120:123], v[72:75], v[176:179], a[120:123]
    buffer_load_dwordx4 v17, s[8:11], s26 offen offset:3072 lds
    v_mfma_f32_16x16x32_bf16 a[124:127], v[72:75], v[180:183], a[124:127]
    s_add_u32 s26, s26, 163840
    v_mfma_f32_16x16x32_bf16 a[128:131], v[72:75], v[184:187], a[128:131]
    buffer_load_dwordx4 v[128:131], v7, s[4:7], s48 offen
    v_mfma_f32_16x16x32_bf16 a[132:135], v[72:75], v[188:191], a[132:135]
    buffer_load_dwordx4 v[132:135], v7, s[4:7], s49 offen
    v_mfma_f32_16x16x32_bf16 a[136:139], v[72:75], v[192:195], a[136:139]
    buffer_load_dwordx4 v[136:139], v7, s[4:7], s50 offen
    v_mfma_f32_16x16x32_bf16 a[140:143], v[72:75], v[196:199], a[140:143]
    ds_read_b64_tr_b16 v[72:73], v21 offset:24576
    ds_read_b64_tr_b16 v[74:75], v21 offset:25600
    v_mfma_f32_16x16x32_bf16 a[144:147], v[76:79], v[164:167], a[144:147]
    buffer_load_dwordx4 v[140:143], v7, s[4:7], s51 offen
    v_mfma_f32_16x16x32_bf16 a[148:151], v[76:79], v[168:171], a[148:151]
    buffer_load_dwordx4 v[144:147], v7, s[4:7], s52 offen
    v_mfma_f32_16x16x32_bf16 a[152:155], v[76:79], v[172:175], a[152:155]
    buffer_load_dwordx4 v[148:151], v7, s[4:7], s53 offen
    v_mfma_f32_16x16x32_bf16 a[156:159], v[76:79], v[176:179], a[156:159]
    buffer_load_dwordx4 v[152:155], v7, s[4:7], s54 offen
    v_mfma_f32_16x16x32_bf16 a[160:163], v[76:79], v[180:183], a[160:163]
    buffer_load_dwordx4 v[156:159], v7, s[4:7], s55 offen
    v_mfma_f32_16x16x32_bf16 a[164:167], v[76:79], v[184:187], a[164:167]
    buffer_load_dwordx4 v[160:163], v7, s[4:7], s56 offen
    v_mfma_f32_16x16x32_bf16 a[168:171], v[76:79], v[188:191], a[168:171]
    v_add_u32 v7, 57344, v7
    v_mfma_f32_16x16x32_bf16 a[172:175], v[76:79], v[192:195], a[172:175]
    v_mfma_f32_16x16x32_bf16 a[176:179], v[76:79], v[196:199], a[176:179]
    ds_read_b64_tr_b16 v[76:77], v22 offset:24576
    ds_read_b64_tr_b16 v[78:79], v22 offset:25600
    v_mfma_f32_16x16x32_bf16 a[180:183], v[80:83], v[164:167], a[180:183]
    v_mfma_f32_16x16x32_bf16 a[184:187], v[80:83], v[168:171], a[184:187]
    v_mfma_f32_16x16x32_bf16 a[188:191], v[80:83], v[172:175], a[188:191]
    v_mfma_f32_16x16x32_bf16 a[192:195], v[80:83], v[176:179], a[192:195]
    v_mfma_f32_16x16x32_bf16 a[196:199], v[80:83], v[180:183], a[196:199]
    v_mfma_f32_16x16x32_bf16 a[200:203], v[80:83], v[184:187], a[200:203]
    v_mfma_f32_16x16x32_bf16 a[204:207], v[80:83], v[188:191], a[204:207]
    v_mfma_f32_16x16x32_bf16 a[208:211], v[80:83], v[192:195], a[208:211]
    v_mfma_f32_16x16x32_bf16 a[212:215], v[80:83], v[196:199], a[212:215]
    ds_read_b64_tr_b16 v[80:81], v23 offset:24576
    ds_read_b64_tr_b16 v[82:83], v23 offset:25600
    v_mfma_f32_16x16x32_bf16 a[216:219], v[84:87], v[164:167], a[216:219]
    v_mfma_f32_16x16x32_bf16 a[220:223], v[84:87], v[168:171], a[220:223]
    v_mfma_f32_16x16x32_bf16 a[224:227], v[84:87], v[172:175], a[224:227]
    v_mfma_f32_16x16x32_bf16 a[228:231], v[84:87], v[176:179], a[228:231]
    v_mfma_f32_16x16x32_bf16 a[232:235], v[84:87], v[180:183], a[232:235]
    v_mfma_f32_16x16x32_bf16 a[236:239], v[84:87], v[184:187], a[236:239]
    v_mfma_f32_16x16x32_bf16 a[240:243], v[84:87], v[188:191], a[240:243]
    v_mfma_f32_16x16x32_bf16 a[244:247], v[84:87], v[192:195], a[244:247]
    v_mfma_f32_16x16x32_bf16 a[248:251], v[84:87], v[196:199], a[248:251]
    ds_read_b64_tr_b16 v[84:85], v24 offset:24576
    ds_read_b64_tr_b16 v[86:87], v24 offset:25600
    v_mfma_f32_16x16x32_bf16 a[252:255], v[88:91], v[164:167], a[252:255]
    v_mfma_f32_16x16x32_bf16 v[28:31], v[88:91], v[168:171], v[28:31]
    v_mfma_f32_16x16x32_bf16 v[32:35], v[88:91], v[172:175], v[32:35]
    v_mfma_f32_16x16x32_bf16 v[36:39], v[88:91], v[176:179], v[36:39]
    v_mfma_f32_16x16x32_bf16 v[40:43], v[88:91], v[180:183], v[40:43]
    v_mfma_f32_16x16x32_bf16 v[44:47], v[88:91], v[184:187], v[44:47]
    v_mfma_f32_16x16x32_bf16 v[48:51], v[88:91], v[188:191], v[48:51]
    v_mfma_f32_16x16x32_bf16 v[52:55], v[88:91], v[192:195], v[52:55]
    v_mfma_f32_16x16x32_bf16 v[56:59], v[88:91], v[196:199], v[56:59]
    ds_read_b64_tr_b16 v[88:89], v25 offset:24576
    ds_read_b64_tr_b16 v[90:91], v25 offset:25600
    s_waitcnt vmcnt(26) lgkmcnt(12)
    v_mfma_f32_16x16x32_bf16 a[0:3], v[60:63], v[200:203], a[0:3]
    v_mfma_f32_16x16x32_bf16 a[4:7], v[60:63], v[204:207], a[4:7]
    v_mfma_f32_16x16x32_bf16 a[8:11], v[60:63], v[208:211], a[8:11]
    v_mfma_f32_16x16x32_bf16 a[12:15], v[60:63], v[212:215], a[12:15]
    v_mfma_f32_16x16x32_bf16 a[16:19], v[60:63], v[216:219], a[16:19]
    v_mfma_f32_16x16x32_bf16 a[20:23], v[60:63], v[220:223], a[20:23]
    v_mfma_f32_16x16x32_bf16 a[24:27], v[60:63], v[224:227], a[24:27]
    v_mfma_f32_16x16x32_bf16 a[28:31], v[60:63], v[228:231], a[28:31]
    v_mfma_f32_16x16x32_bf16 a[32:35], v[60:63], v[232:235], a[32:35]
    ds_read_b64_tr_b16 v[60:61], v18 offset:0
    ds_read_b64_tr_b16 v[62:63], v18 offset:1024
    v_mfma_f32_16x16x32_bf16 a[36:39], v[64:67], v[200:203], a[36:39]
    v_mfma_f32_16x16x32_bf16 a[40:43], v[64:67], v[204:207], a[40:43]
    v_mfma_f32_16x16x32_bf16 a[44:47], v[64:67], v[208:211], a[44:47]
    v_mfma_f32_16x16x32_bf16 a[48:51], v[64:67], v[212:215], a[48:51]
    v_mfma_f32_16x16x32_bf16 a[52:55], v[64:67], v[216:219], a[52:55]
    v_mfma_f32_16x16x32_bf16 a[56:59], v[64:67], v[220:223], a[56:59]
    v_mfma_f32_16x16x32_bf16 a[60:63], v[64:67], v[224:227], a[60:63]
    v_mfma_f32_16x16x32_bf16 a[64:67], v[64:67], v[228:231], a[64:67]
    v_mfma_f32_16x16x32_bf16 a[68:71], v[64:67], v[232:235], a[68:71]
    ds_read_b64_tr_b16 v[64:65], v19 offset:0
    ds_read_b64_tr_b16 v[66:67], v19 offset:1024
    s_waitcnt lgkmcnt(4)
    v_mfma_f32_16x16x32_bf16 a[72:75], v[68:71], v[200:203], a[72:75]
    s_add_u32 m0, s27, 16384
    v_mfma_f32_16x16x32_bf16 a[76:79], v[68:71], v[204:207], a[76:79]
    s_nop 0
    v_mfma_f32_16x16x32_bf16 a[80:83], v[68:71], v[208:211], a[80:83]
    buffer_load_dwordx4 v10, s[8:11], s26 offen offset:0 lds
    v_mfma_f32_16x16x32_bf16 a[84:87], v[68:71], v[212:215], a[84:87]
    buffer_load_dwordx4 v11, s[8:11], s26 offen offset:1024 lds
    v_mfma_f32_16x16x32_bf16 a[88:91], v[68:71], v[216:219], a[88:91]
    buffer_load_dwordx4 v12, s[8:11], s26 offen offset:2048 lds
    v_mfma_f32_16x16x32_bf16 a[92:95], v[68:71], v[220:223], a[92:95]
    buffer_load_dwordx4 v13, s[8:11], s26 offen offset:3072 lds
    v_mfma_f32_16x16x32_bf16 a[96:99], v[68:71], v[224:227], a[96:99]
    s_add_u32 m0, s27, 20480
    v_mfma_f32_16x16x32_bf16 a[100:103], v[68:71], v[228:231], a[100:103]
    s_nop 0
    v_mfma_f32_16x16x32_bf16 a[104:107], v[68:71], v[232:235], a[104:107]
    ds_read_b64_tr_b16 v[68:69], v20 offset:0
    ds_read_b64_tr_b16 v[70:71], v20 offset:1024
    v_mfma_f32_16x16x32_bf16 a[108:111], v[72:75], v[200:203], a[108:111]
    buffer_load_dwordx4 v14, s[8:11], s26 offen offset:0 lds
    v_mfma_f32_16x16x32_bf16 a[112:115], v[72:75], v[204:207], a[112:115]
    buffer_load_dwordx4 v15, s[8:11], s26 offen offset:1024 lds
    v_mfma_f32_16x16x32_bf16 a[116:119], v[72:75], v[208:211], a[116:119]
    buffer_load_dwordx4 v16, s[8:11], s26 offen offset:2048 lds
    v_mfma_f32_16x16x32_bf16 a[120:123], v[72:75], v[212:215], a[120:123]
    buffer_load_dwordx4 v17, s[8:11], s26 offen offset:3072 lds
    v_mfma_f32_16x16x32_bf16 a[124:127], v[72:75], v[216:219], a[124:127]
    s_add_u32 s26, s26, 163840
    v_mfma_f32_16x16x32_bf16 a[128:131], v[72:75], v[220:223], a[128:131]
    buffer_load_dwordx4 v[164:167], v7, s[4:7], s48 offen
    v_mfma_f32_16x16x32_bf16 a[132:135], v[72:75], v[224:227], a[132:135]
    buffer_load_dwordx4 v[168:171], v7, s[4:7], s49 offen
    v_mfma_f32_16x16x32_bf16 a[136:139], v[72:75], v[228:231], a[136:139]
    buffer_load_dwordx4 v[172:175], v7, s[4:7], s50 offen
    v_mfma_f32_16x16x32_bf16 a[140:143], v[72:75], v[232:235], a[140:143]
    ds_read_b64_tr_b16 v[72:73], v21 offset:0
    ds_read_b64_tr_b16 v[74:75], v21 offset:1024
    v_mfma_f32_16x16x32_bf16 a[144:147], v[76:79], v[200:203], a[144:147]
    buffer_load_dwordx4 v[176:179], v7, s[4:7], s51 offen
    v_mfma_f32_16x16x32_bf16 a[148:151], v[76:79], v[204:207], a[148:151]
    buffer_load_dwordx4 v[180:183], v7, s[4:7], s52 offen
    v_mfma_f32_16x16x32_bf16 a[152:155], v[76:79], v[208:211], a[152:155]
    buffer_load_dwordx4 v[184:187], v7, s[4:7], s53 offen
    v_mfma_f32_16x16x32_bf16 a[156:159], v[76:79], v[212:215], a[156:159]
    buffer_load_dwordx4 v[188:191], v7, s[4:7], s54 offen
    v_mfma_f32_16x16x32_bf16 a[160:163], v[76:79], v[216:219], a[160:163]
    buffer_load_dwordx4 v[192:195], v7, s[4:7], s55 offen
    v_mfma_f32_16x16x32_bf16 a[164:167], v[76:79], v[220:223], a[164:167]
    buffer_load_dwordx4 v[196:199], v7, s[4:7], s56 offen
    v_mfma_f32_16x16x32_bf16 a[168:171], v[76:79], v[224:227], a[168:171]
    v_add_u32 v7, 57344, v7
    v_mfma_f32_16x16x32_bf16 a[172:175], v[76:79], v[228:231], a[172:175]
    s_add_u32 m0, s27, 24576
    v_mfma_f32_16x16x32_bf16 a[176:179], v[76:79], v[232:235], a[176:179]
    ds_read_b64_tr_b16 v[76:77], v22 offset:0
    ds_read_b64_tr_b16 v[78:79], v22 offset:1024
    v_mfma_f32_16x16x32_bf16 a[180:183], v[80:83], v[200:203], a[180:183]
    s_nop 0
    v_mfma_f32_16x16x32_bf16 a[184:187], v[80:83], v[204:207], a[184:187]
    buffer_load_dwordx4 v10, s[8:11], s26 offen offset:0 lds
    v_mfma_f32_16x16x32_bf16 a[188:191], v[80:83], v[208:211], a[188:191]
    buffer_load_dwordx4 v11, s[8:11], s26 offen offset:1024 lds
    v_mfma_f32_16x16x32_bf16 a[192:195], v[80:83], v[212:215], a[192:195]
    buffer_load_dwordx4 v12, s[8:11], s26 offen offset:2048 lds
    v_mfma_f32_16x16x32_bf16 a[196:199], v[80:83], v[216:219], a[196:199]
    buffer_load_dwordx4 v13, s[8:11], s26 offen offset:3072 lds
    v_mfma_f32_16x16x32_bf16 a[200:203], v[80:83], v[220:223], a[200:203]
    s_add_u32 m0, s27, 28672
    v_mfma_f32_16x16x32_bf16 a[204:207], v[80:83], v[224:227], a[204:207]
    s_nop 0
    v_mfma_f32_16x16x32_bf16 a[208:211], v[80:83], v[228:231], a[208:211]
    buffer_load_dwordx4 v14, s[8:11], s26 offen offset:0 lds
    v_mfma_f32_16x16x32_bf16 a[212:215], v[80:83], v[232:235], a[212:215]
    ds_read_b64_tr_b16 v[80:81], v23 offset:0
    ds_read_b64_tr_b16 v[82:83], v23 offset:1024
    v_mfma_f32_16x16x32_bf16 a[216:219], v[84:87], v[200:203], a[216:219]
    buffer_load_dwordx4 v15, s[8:11], s26 offen offset:1024 lds
    v_mfma_f32_16x16x32_bf16 a[220:223], v[84:87], v[204:207], a[220:223]
    buffer_load_dwordx4 v16, s[8:11], s26 offen offset:2048 lds
    v_mfma_f32_16x16x32_bf16 a[224:227], v[84:87], v[208:211], a[224:227]
    buffer_load_dwordx4 v17, s[8:11], s26 offen offset:3072 lds
    v_mfma_f32_16x16x32_bf16 a[228:231], v[84:87], v[212:215], a[228:231]
    s_add_u32 s26, s26, 163840
    v_mfma_f32_16x16x32_bf16 a[232:235], v[84:87], v[216:219], a[232:235]
    v_mfma_f32_16x16x32_bf16 a[236:239], v[84:87], v[220:223], a[236:239]
    v_mfma_f32_16x16x32_bf16 a[240:243], v[84:87], v[224:227], a[240:243]
    v_mfma_f32_16x16x32_bf16 a[244:247], v[84:87], v[228:231], a[244:247]
    v_mfma_f32_16x16x32_bf16 a[248:251], v[84:87], v[232:235], a[248:251]
    ds_read_b64_tr_b16 v[84:85], v24 offset:0
    ds_read_b64_tr_b16 v[86:87], v24 offset:1024
    v_mfma_f32_16x16x32_bf16 a[252:255], v[88:91], v[200:203], a[252:255]
    v_mfma_f32_16x16x32_bf16 v[28:31], v[88:91], v[204:207], v[28:31]
    v_mfma_f32_16x16x32_bf16 v[32:35], v[88:91], v[208:211], v[32:35]
    v_mfma_f32_16x16x32_bf16 v[36:39], v[88:91], v[212:215], v[36:39]
    v_mfma_f32_16x16x32_bf16 v[40:43], v[88:91], v[216:219], v[40:43]
    v_mfma_f32_16x16x32_bf16 v[44:47], v[88:91], v[220:223], v[44:47]
    v_mfma_f32_16x16x32_bf16 v[48:51], v[88:91], v[224:227], v[48:51]
    v_mfma_f32_16x16x32_bf16 v[52:55], v[88:91], v[228:231], v[52:55]
    v_mfma_f32_16x16x32_bf16 v[56:59], v[88:91], v[232:235], v[56:59]
    ds_read_b64_tr_b16 v[88:89], v25 offset:0
    ds_read_b64_tr_b16 v[90:91], v25 offset:1024
    s_mov_b32 s21, 0
L_op_loop:
    s_waitcnt vmcnt(34) lgkmcnt(12)
    v_mfma_f32_16x16x32_bf16 a[0:3], v[60:63], v[92:95], a[0:3]
    buffer_load_dwordx4 v[200:203], v7, s[4:7], s48 offen
    v_mfma_f32_16x16x32_bf16 a[4:7], v[60:63], v[96:99], a[4:7]
    buffer_load_dwordx4 v[204:207], v7, s[4:7], s49 offen
    v_mfma_f32_16x16x32_bf16 a[8:11], v[60:63], v[100:103], a[8:11]
    buffer_load_dwordx4 v[208:211], v7, s[4:7], s50 offen
    v_mfma_f32_16x16x32_bf16 a[12:15], v[60:63], v[104:107], a[12:15]
    buffer_load_dwordx4 v[212:215], v7, s[4:7], s51 offen
    v_mfma_f32_16x16x32_bf16 a[16:19], v[60:63], v[108:111], a[16:19]
    buffer_load_dwordx4 v[216:219], v7, s[4:7], s52 offen
    v_mfma_f32_16x16x32_bf16 a[20:23], v[60:63], v[112:115], a[20:23]
    buffer_load_dwordx4 v[220:223], v7, s[4:7], s53 offen
    v_mfma_f32_16x16x32_bf16 a[24:27], v[60:63], v[116:119], a[24:27]
    buffer_load_dwordx4 v[224:227], v7, s[4:7], s54 offen
    v_mfma_f32_16x16x32_bf16 a[28:31], v[60:63], v[120:123], a[28:31]
    buffer_load_dwordx4 v[228:231], v7, s[4:7], s55 offen
    v_mfma_f32_16x16x32_bf16 a[32:35], v[60:63], v[124:127], a[32:35]
    ds_read_b64_tr_b16 v[60:61], v18 offset:8192
    ds_read_b64_tr_b16 v[62:63], v18 offset:9216
    v_mfma_f32_16x16x32_bf16 a[36:39], v[64:67], v[92:95], a[36:39]
    buffer_load_dwordx4 v[232:235], v7, s[4:7], s56 offen
    v_mfma_f32_16x16x32_bf16 a[40:43], v[64:67], v[96:99], a[40:43]
    v_add_u32 v7, 57344, v7
    v_mfma_f32_16x16x32_bf16 a[44:47], v[64:67], v[100:103], a[44:47]
    v_mfma_f32_16x16x32_bf16 a[48:51], v[64:67], v[104:107], a[48:51]
    v_mfma_f32_16x16x32_bf16 a[52:55], v[64:67], v[108:111], a[52:55]
    v_mfma_f32_16x16x32_bf16 a[56:59], v[64:67], v[112:115], a[56:59]
    v_mfma_f32_16x16x32_bf16 a[60:63], v[64:67], v[116:119], a[60:63]
    v_mfma_f32_16x16x32_bf16 a[64:67], v[64:67], v[120:123], a[64:67]
    v_mfma_f32_16x16x32_bf16 a[68:71], v[64:67], v[124:127], a[68:71]
    ds_read_b64_tr_b16 v[64:65], v19 offset:8192
    ds_read_b64_tr_b16 v[66:67], v19 offset:9216
    s_waitcnt lgkmcnt(4)
    v_mfma_f32_16x16x32_bf16 a[72:75], v[68:71], v[92:95], a[72:75]
    s_add_u32 m0, s27, 0
    v_mfma_f32_16x16x32_bf16 a[76:79], v[68:71], v[96:99], a[76:79]
    s_nop 0
    v_mfma_f32_16x16x32_bf16 a[80:83], v[68:71], v[100:103], a[80:83]
    buffer_load_dwordx4 v10, s[8:11], s26 offen offset:0 lds
    v_mfma_f32_16x16x32_bf16 a[84:87], v[68:71], v[104:107], a[84:87]
    buffer_load_dwordx4 v11, s[8:11], s26 offen offset:1024 lds
    v_mfma_f32_16x16x32_bf16 a[88:91], v[68:71], v[108:111], a[88:91]
    buffer_load_dwordx4 v12, s[8:11], s26 offen offset:2048 lds
    v_mfma_f32_16x16x32_bf16 a[92:95], v[68:71], v[112:115], a[92:95]
    buffer_load_dwordx4 v13, s[8:11], s26 offen offset:3072 lds
    v_mfma_f32_16x16x32_bf16 a[96:99], v[68:71], v[116:119], a[96:99]
    s_add_u32 m0, s27, 4096
    v_mfma_f32_16x16x32_bf16 a[100:103], v[68:71], v[120:123], a[100:103]
    s_nop 0
    v_mfma_f32_16x16x32_bf16 a[104:107], v[68:71], v[124:127], a[104:107]
    ds_read_b64_tr_b16 v[68:69], v20 offset:8192
    ds_read_b64_tr_b16 v[70:71], v20 offset:9216
    v_mfma_f32_16x16x32_bf16 a[108:111], v[72:75], v[92:95], a[108:111]
    buffer_load_dwordx4 v14, s[8:11], s26 offen offset:0 lds
    v_mfma_f32_16x16x32_bf16 a[112:115], v[72:75], v[96:99], a[112:115]
    buffer_load_dwordx4 v15, s[8:11], s26 offen offset:1024 lds
    v_mfma_f32_16x16x32_bf16 a[116:119], v[72:75], v[100:103], a[116:119]
    buffer_load_dwordx4 v16, s[8:11], s26 offen offset:2048 lds
    v_mfma_f32_16x16x32_bf16 a[120:123], v[72:75], v[104:107], a[120:123]
    buffer_load_dwordx4 v17, s[8:11], s26 offen offset:3072 lds
    v_mfma_f32_16x16x32_bf16 a[124:127], v[72:75], v[108:111], a[124:127]
    s_add_u32 s26, s26, 163840
    v_mfma_f32_16x16x32_bf16 a[128:131], v[72:75], v[112:115], a[128:131]
    v_mfma_f32_16x16x32_bf16 a[132:135], v[72:75], v[116:119], a[132:135]
    v_mfma_f32_16x16x32_bf16 a[136:139], v[72:75], v[120:123], a[136:139]
    v_mfma_f32_16x16x32_bf16 a[140:143], v[72:75], v[124:127], a[140:143]
    ds_read_b64_tr_b16 v[72:73], v21 offset:8192
    ds_read_b64_tr_b16 v[74:75], v21 offset:9216
    v_mfma_f32_16x16x32_bf16 a[144:147], v[76:79], v[92:95], a[144:147]
    v_mfma_f32_16x16x32_bf16 a[148:151], v[76:79], v[96:99], a[148:151]
    v_mfma_f32_16x16x32_bf16 a[152:155], v[76:79], v[100:103], a[152:155]
    v_mfma_f32_16x16x32_bf16 a[156:159], v[76:79], v[104:107], a[156:159]
    v_mfma_f32_16x16x32_bf16 a[160:163], v[76:79], v[108:111], a[160:163]
    v_mfma_f32_16x16x32_bf16 a[164:167], v[76:79], v[112:115], a[164:167]
    v_mfma_f32_16x16x32_bf16 a[168:171], v[76:79], v[116:119], a[168:171]
    v_mfma_f32_16x16x32_bf16 a[172:175], v[76:79], v[120:123], a[172:175]
    v_mfma_f32_16x16x32_bf16 a[176:179], v[76:79], v[124:127], a[176:179]
    ds_read_b64_tr_b16 v[76:77], v22 offset:8192
    ds_read_b64_tr_b16 v[78:79], v22 offset:9216
    v_mfma_f32_16x16x32_bf16 a[180:183], v[80:83], v[92:95], a[180:183]
    v_mfma_f32_16x16x32_bf16 a[184:187], v[80:83], v[96:99], a[184:187]
    v_mfma_f32_16x16x32_bf16 a[188:191], v[80:83], v[100:103], a[188:191]
    v_mfma_f32_16x16x32_bf16 a[192:195], v[80:83], v[104:107], a[192:195]
    v_mfma_f32_16x16x32_bf16 a[196:199], v[80:83], v[108:111], a[196:199]
    v_mfma_f32_16x16x32_bf16 a[200:203], v[80:83], v[112:115], a[200:203]
    v_mfma_f32_16x16x32_bf16 a[204:207], v[80:83], v[116:119], a[204:207]
    v_mfma_f32_16x16x32_bf16 a[208:211], v[80:83], v[120:123], a[208:211]
    v_mfma_f32_16x16x32_bf16 a[212:215], v[80:83], v[124:127], a[212:215]
    ds_read_b64_tr_b16 v[80:81], v23 offset:8192
    ds_read_b64_tr_b16 v[82:83], v23 offset:9216
    v_mfma_f32_16x16x32_bf16 a[216:219], v[84:87], v[92:95], a[216:219]
    v_mfma_f32_16x16x32_bf16 a[220:223], v[84:87], v[96:99], a[220:223]
    v_mfma_f32_16x16x32_bf16 a[224:227], v[84:87], v[100:103], a[224:227]
    v_mfma_f32_16x16x32_bf16 a[228:231], v[84:87], v[104:107], a[228:231]
    v_mfma_f32_16x16x32_bf16 a[232:235], v[84:87], v[108:111], a[232:235]
    v_mfma_f32_16x16x32_bf16 a[236:239], v[84:87], v[112:115], a[236:239]
    v_mfma_f32_16x16x32_bf16 a[240:243], v[84:87], v[116:119], a[240:243]
    v_mfma_f32_16x16x32_bf16 a[244:247], v[84:87], v[120:123], a[244:247]
    v_mfma_f32_16x16x32_bf16 a[248:251], v[84:87], v[124:127], a[248:251]
    ds_read_b64_tr_b16 v[84:85], v24 offset:8192
    ds_read_b64_tr_b16 v[86:87], v24 offset:9216
    v_mfma_f32_16x16x32_bf16 a[252:255], v[88:91], v[92:95], a[252:255]
    v_mfma_f32_16x16x32_bf16 v[28:31], v[88:91], v[96:99], v[28:31]
    v_mfma_f32_16x16x32_bf16 v[32:35], v[88:91], v[100:103], v[32:35]
    v_mfma_f32_16x16x32_bf16 v[36:39], v[88:91], v[104:107], v[36:39]
    v_mfma_f32_16x16x32_bf16 v[40:43], v[88:91], v[108:111], v[40:43]
    v_mfma_f32_16x16x32_bf16 v[44:47], v[88:91], v[112:115], v[44:47]
    v_mfma_f32_16x16x32_bf16 v[48:51], v[88:91], v[116:119], v[48:51]
    v_mfma_f32_16x16x32_bf16 v[52:55], v[88:91], v[120:123], v[52:55]
    v_mfma_f32_16x16x32_bf16 v[56:59], v[88:91], v[124:127], v[56:59]
    ds_read_b64_tr_b16 v[88:89], v25 offset:8192
    ds_read_b64_tr_b16 v[90:91], v25 offset:9216
    s_waitcnt vmcnt(34) lgkmcnt(12)
    v_mfma_f32_16x16x32_bf16 a[0:3], v[60:63], v[128:131], a[0:3]
    buffer_load_dwordx4 v[92:95], v7, s[4:7], s48 offen
    v_mfma_f32_16x16x32_bf16 a[4:7], v[60:63], v[132:135], a[4:7]
    buffer_load_dwordx4 v[96:99], v7, s[4:7], s49 offen
    v_mfma_f32_16x16x32_bf16 a[8:11], v[60:63], v[136:139], a[8:11]
    buffer_load_dwordx4 v[100:103], v7, s[4:7], s50 offen
    v_mfma_f32_16x16x32_bf16 a[12:15], v[60:63], v[140:143], a[12:15]
    buffer_load_dwordx4 v[104:107], v7, s[4:7], s51 offen
    v_mfma_f32_16x16x32_bf16 a[16:19], v[60:63], v[144:147], a[16:19]
    buffer_load_dwordx4 v[108:111], v7, s[4:7], s52 offen
    v_mfma_f32_16x16x32_bf16 a[20:23], v[60:63], v[148:151], a[20:23]
    buffer_load_dwordx4 v[112:115], v7, s[4:7], s53 offen
    v_mfma_f32_16x16x32_bf16 a[24:27], v[60:63], v[152:155], a[24:27]
    buffer_load_dwordx4 v[116:119], v7, s[4:7], s54 offen
    v_mfma_f32_16x16x32_bf16 a[28:31], v[60:63], v[156:159], a[28:31]
    buffer_load_dwordx4 v[120:123], v7, s[4:7], s55 offen
    v_mfma_f32_16x16x32_bf16 a[32:35], v[60:63], v[160:163], a[32:35]
    ds_read_b64_tr_b16 v[60:61], v18 offset:16384
    ds_read_b64_tr_b16 v[62:63], v18 offset:17408
    v_mfma_f32_16x16x32_bf16 a[36:39], v[64:67], v[128:131], a[36:39]
    buffer_load_dwordx4 v[124:127], v7, s[4:7], s56 offen
    v_mfma_f32_16x16x32_bf16 a[40:43], v[64:67], v[132:135], a[40:43]
    v_add_u32 v7, 57344, v7
    v_mfma_f32_16x16x32_bf16 a[44:47], v[64:67], v[136:139], a[44:47]
    v_mfma_f32_16x16x32_bf16 a[48:51], v[64:67], v[140:143], a[48:51]
    v_mfma_f32_16x16x32_bf16 a[52:55], v[64:67], v[144:147], a[52:55]
    v_mfma_f32_16x16x32_bf16 a[56:59], v[64:67], v[148:151], a[56:59]
    v_mfma_f32_16x16x32_bf16 a[60:63], v[64:67], v[152:155], a[60:63]
    v_mfma_f32_16x16x32_bf16 a[64:67], v[64:67], v[156:159], a[64:67]
    v_mfma_f32_16x16x32_bf16 a[68:71], v[64:67], v[160:163], a[68:71]
    ds_read_b64_tr_b16 v[64:65], v19 offset:16384
    ds_read_b64_tr_b16 v[66:67], v19 offset:17408
    s_waitcnt lgkmcnt(4)
    v_mfma_f32_16x16x32_bf16 a[72:75], v[68:71], v[128:131], a[72:75]
    s_add_u32 m0, s27, 8192
    v_mfma_f32_16x16x32_bf16 a[76:79], v[68:71], v[132:135], a[76:79]
    s_nop 0
    v_mfma_f32_16x16x32_bf16 a[80:83], v[68:71], v[136:139], a[80:83]
    buffer_load_dwordx4 v10, s[8:11], s26 offen offset:0 lds
    v_mfma_f32_16x16x32_bf16 a[84:87], v[68:71], v[140:143], a[84:87]
    buffer_load_dwordx4 v11, s[8:11], s26 offen offset:1024 lds
    v_mfma_f32_16x16x32_bf16 a[88:91], v[68:71], v[144:147], a[88:91]
    buffer_load_dwordx4 v12, s[8:11], s26 offen offset:2048 lds
    v_mfma_f32_16x16x32_bf16 a[92:95], v[68:71], v[148:151], a[92:95]
    buffer_load_dwordx4 v13, s[8:11], s26 offen offset:3072 lds
    v_mfma_f32_16x16x32_bf16 a[96:99], v[68:71], v[152:155], a[96:99]
    s_add_u32 m0, s27, 12288
    v_mfma_f32_16x16x32_bf16 a[100:103], v[68:71], v[156:159], a[100:103]
    s_nop 0
    v_mfma_f32_16x16x32_bf16 a[104:107], v[68:71], v[160:163], a[104:107]
    ds_read_b64_tr_b16 v[68:69], v20 offset:16384
    ds_read_b64_tr_b16 v[70:71], v20 offset:17408
    v_mfma_f32_16x16x32_bf16 a[108:111], v[72:75], v[128:131], a[108:111]
    buffer_load_dwordx4 v14, s[8:11], s26 offen offset:0 lds
    v_mfma_f32_16x16x32_bf16 a[112:115], v[72:75], v[132:135], a[112:115]
    buffer_load_dwordx4 v15, s[8:11], s26 offen offset:1024 lds
    v_mfma_f32_16x16x32_bf16 a[116:119], v[72:75], v[136:139], a[116:119]
    buffer_load_dwordx4 v16, s[8:11], s26 offen offset:2048 lds
    v_mfma_f32_16x16x32_bf16 a[120:123], v[72:75], v[140:143], a[120:123]
    buffer_load_dwordx4 v17, s[8:11], s26 offen offset:3072 lds
    v_mfma_f32_16x16x32_bf16 a[124:127], v[72:75], v[144:147], a[124:127]
    s_add_u32 s26, s26, 163840
    v_mfma_f32_16x16x32_bf16 a[128:131], v[72:75], v[148:151], a[128:131]
    v_mfma_f32_16x16x32_bf16 a[132:135], v[72:75], v[152:155], a[132:135]
    v_mfma_f32_16x16x32_bf16 a[136:139], v[72:75], v[156:159], a[136:139]
    v_mfma_f32_16x16x32_bf16 a[140:143], v[72:75], v[160:163], a[140:143]
    ds_read_b64_tr_b16 v[72:73], v21 offset:16384
    ds_read_b64_tr_b16 v[74:75], v21 offset:17408
    v_mfma_f32_16x16x32_bf16 a[144:147], v[76:79], v[128:131], a[144:147]
    v_mfma_f32_16x16x32_bf16 a[148:151], v[76:79], v[132:135], a[148:151]
    v_mfma_f32_16x16x32_bf16 a[152:155], v[76:79], v[136:139], a[152:155]
    v_mfma_f32_16x16x32_bf16 a[156:159], v[76:79], v[140:143], a[156:159]
    v_mfma_f32_16x16x32_bf16 a[160:163], v[76:79], v[144:147], a[160:163]
    v_mfma_f32_16x16x32_bf16 a[164:167], v[76:79], v[148:151], a[164:167]
    v_mfma_f32_16x16x32_bf16 a[168:171], v[76:79], v[152:155], a[168:171]
    v_mfma_f32_16x16x32_bf16 a[172:175], v[76:79], v[156:159], a[172:175]
    v_mfma_f32_16x16x32_bf16 a[176:179], v[76:79], v[160:163], a[176:179]
    ds_read_b64_tr_b16 v[76:77], v22 offset:16384
    ds_read_b64_tr_b16 v[78:79], v22 offset:17408
    v_mfma_f32_16x16x32_bf16 a[180:183], v[80:83], v[128:131], a[180:183]
    v_mfma_f32_16x16x32_bf16 a[184:187], v[80:83], v[132:135], a[184:187]
    v_mfma_f32_16x16x32_bf16 a[188:191], v[80:83], v[136:139], a[188:191]
    v_mfma_f32_16x16x32_bf16 a[192:195], v[80:83], v[140:143], a[192:195]
    v_mfma_f32_16x16x32_bf16 a[196:199], v[80:83], v[144:147], a[196:199]
    v_mfma_f32_16x16x32_bf16 a[200:203], v[80:83], v[148:151], a[200:203]
    v_mfma_f32_16x16x32_bf16 a[204:207], v[80:83], v[152:155], a[204:207]
    v_mfma_f32_16x16x32_bf16 a[208:211], v[80:83], v[156:159], a[208:211]
    v_mfma_f32_16x16x32_bf16 a[212:215], v[80:83], v[160:163], a[212:215]
    ds_read_b64_tr_b16 v[80:81], v23 offset:16384
    ds_read_b64_tr_b16 v[82:83], v23 offset:17408
    v_mfma_f32_16x16x32_bf16 a[216:219], v[84:87], v[128:131], a[216:219]
    v_mfma_f32_16x16x32_bf16 a[220:223], v[84:87], v[132:135], a[220:223]
    v_mfma_f32_16x16x32_bf16 a[224:227], v[84:87], v[136:139], a[224:227]
    v_mfma_f32_16x16x32_bf16 a[228:231], v[84:87], v[140:143], a[228:231]
    v_mfma_f32_16x16x32_bf16 a[232:235], v[84:87], v[144:147], a[232:235]
    v_mfma_f32_16x16x32_bf16 a[236:239], v[84:87], v[148:151], a[236:239]
    v_mfma_f32_16x16x32_bf16 a[240:243], v[84:87], v[152:155], a[240:243]
    v_mfma_f32_16x16x32_bf16 a[244:247], v[84:87], v[156:159], a[244:247]
    v_mfma_f32_16x16x32_bf16 a[248:251], v[84:87], v[160:163], a[248:251]
    ds_read_b64_tr_b16 v[84:85], v24 offset:16384
    ds_read_b64_tr_b16 v[86:87], v24 offset:17408
    v_mfma_f32_16x16x32_bf16 a[252:255], v[88:91], v[128:131], a[252:255]
    v_mfma_f32_16x16x32_bf16 v[28:31], v[88:91], v[132:135], v[28:31]
    v_mfma_f32_16x16x32_bf16 v[32:35], v[88:91], v[136:139], v[32:35]
    v_mfma_f32_16x16x32_bf16 v[36:39], v[88:91], v[140:143], v[36:39]
    v_mfma_f32_16x16x32_bf16 v[40:43], v[88:91], v[144:147], v[40:43]
    v_mfma_f32_16x16x32_bf16 v[44:47], v[88:91], v[148:151], v[44:47]
    v_mfma_f32_16x16x32_bf16 v[48:51], v[88:91], v[152:155], v[48:51]
    v_mfma_f32_16x16x32_bf16 v[52:55], v[88:91], v[156:159], v[52:55]
    v_mfma_f32_16x16x32_bf16 v[56:59], v[88:91], v[160:163], v[56:59]
    ds_read_b64_tr_b16 v[88:89], v25 offset:16384
    ds_read_b64_tr_b16 v[90:91], v25 offset:17408
    s_waitcnt vmcnt(34) lgkmcnt(12)
    v_mfma_f32_16x16x32_bf16 a[0:3], v[60:63], v[164:167], a[0:3]
    buffer_load_dwordx4 v[128:131], v7, s[4:7], s48 offen
    v_mfma_f32_16x16x32_bf16 a[4:7], v[60:63], v[168:171], a[4:7]
    buffer_load_dwordx4 v[132:135], v7, s[4:7], s49 offen
    v_mfma_f32_16x16x32_bf16 a[8:11], v[60:63], v[172:175], a[8:11]
    buffer_load_dwordx4 v[136:139], v7, s[4:7], s50 offen
    v_mfma_f32_16x16x32_bf16 a[12:15], v[60:63], v[176:179], a[12:15]
    buffer_load_dwordx4 v[140:143], v7, s[4:7], s51 offen
    v_mfma_f32_16x16x32_bf16 a[16:19], v[60:63], v[180:183], a[16:19]
    buffer_load_dwordx4 v[144:147], v7, s[4:7], s52 offen
    v_mfma_f32_16x16x32_bf16 a[20:23], v[60:63], v[184:187], a[20:23]
    buffer_load_dwordx4 v[148:151], v7, s[4:7], s53 offen
    v_mfma_f32_16x16x32_bf16 a[24:27], v[60:63], v[188:191], a[24:27]
    buffer_load_dwordx4 v[152:155], v7, s[4:7], s54 offen
    v_mfma_f32_16x16x32_bf16 a[28:31], v[60:63], v[192:195], a[28:31]
    buffer_load_dwordx4 v[156:159], v7, s[4:7], s55 offen
    v_mfma_f32_16x16x32_bf16 a[32:35], v[60:63], v[196:199], a[32:35]
    ds_read_b64_tr_b16 v[60:61], v18 offset:24576
    ds_read_b64_tr_b16 v[62:63], v18 offset:25600
    v_mfma_f32_16x16x32_bf16 a[36:39], v[64:67], v[164:167], a[36:39]
    buffer_load_dwordx4 v[160:163], v7, s[4:7], s56 offen
    v_mfma_f32_16x16x32_bf16 a[40:43], v[64:67], v[168:171], a[40:43]
    v_add_u32 v7, 57344, v7
    v_mfma_f32_16x16x32_bf16 a[44:47], v[64:67], v[172:175], a[44:47]
    v_mfma_f32_16x16x32_bf16 a[48:51], v[64:67], v[176:179], a[48:51]
    v_mfma_f32_16x16x32_bf16 a[52:55], v[64:67], v[180:183], a[52:55]
    v_mfma_f32_16x16x32_bf16 a[56:59], v[64:67], v[184:187], a[56:59]
    v_mfma_f32_16x16x32_bf16 a[60:63], v[64:67], v[188:191], a[60:63]
    v_mfma_f32_16x16x32_bf16 a[64:67], v[64:67], v[192:195], a[64:67]
    v_mfma_f32_16x16x32_bf16 a[68:71], v[64:67], v[196:199], a[68:71]
    ds_read_b64_tr_b16 v[64:65], v19 offset:24576
    ds_read_b64_tr_b16 v[66:67], v19 offset:25600
    s_waitcnt lgkmcnt(4)
    v_mfma_f32_16x16x32_bf16 a[72:75], v[68:71], v[164:167], a[72:75]
    s_add_u32 m0, s27, 16384
    v_mfma_f32_16x16x32_bf16 a[76:79], v[68:71], v[168:171], a[76:79]
    s_nop 0
    v_mfma_f32_16x16x32_bf16 a[80:83], v[68:71], v[172:175], a[80:83]
    buffer_load_dwordx4 v10, s[8:11], s26 offen offset:0 lds
    v_mfma_f32_16x16x32_bf16 a[84:87], v[68:71], v[176:179], a[84:87]
    buffer_load_dwordx4 v11, s[8:11], s26 offen offset:1024 lds
    v_mfma_f32_16x16x32_bf16 a[88:91], v[68:71], v[180:183], a[88:91]
    buffer_load_dwordx4 v12, s[8:11], s26 offen offset:2048 lds
    v_mfma_f32_16x16x32_bf16 a[92:95], v[68:71], v[184:187], a[92:95]
    buffer_load_dwordx4 v13, s[8:11], s26 offen offset:3072 lds
    v_mfma_f32_16x16x32_bf16 a[96:99], v[68:71], v[188:191], a[96:99]
    s_add_u32 m0, s27, 20480
    v_mfma_f32_16x16x32_bf16 a[100:103], v[68:71], v[192:195], a[100:103]
    s_nop 0
    v_mfma_f32_16x16x32_bf16 a[104:107], v[68:71], v[196:199], a[104:107]
    ds_read_b64_tr_b16 v[68:69], v20 offset:24576
    ds_read_b64_tr_b16 v[70:71], v20 offset:25600
    v_mfma_f32_16x16x32_bf16 a[108:111], v[72:75], v[164:167], a[108:111]
    buffer_load_dwordx4 v14, s[8:11], s26 offen offset:0 lds
    v_mfma_f32_16x16x32_bf16 a[112:115], v[72:75], v[168:171], a[112:115]
    buffer_load_dwordx4 v15, s[8:11], s26 offen offset:1024 lds
    v_mfma_f32_16x16x32_bf16 a[116:119], v[72:75], v[172:175], a[116:119]
    buffer_load_dwordx4 v16, s[8:11], s26 offen offset:2048 lds
    v_mfma_f32_16x16x32_bf16 a[120:123], v[72:75], v[176:179], a[120:123]
    buffer_load_dwordx4 v17, s[8:11], s26 offen offset:3072 lds
    v_mfma_f32_16x16x32_bf16 a[124:127], v[72:75], v[180:183], a[124:127]
    s_add_u32 s26, s26, 163840
    v_mfma_f32_16x16x32_bf16 a[128:131], v[72:75], v[184:187], a[128:131]
    v_mfma_f32_16x16x32_bf16 a[132:135], v[72:75], v[188:191], a[132:135]
    v_mfma_f32_16x16x32_bf16 a[136:139], v[72:75], v[192:195], a[136:139]
    v_mfma_f32_16x16x32_bf16 a[140:143], v[72:75], v[196:199], a[140:143]
    ds_read_b64_tr_b16 v[72:73], v21 offset:24576
    ds_read_b64_tr_b16 v[74:75], v21 offset:25600
    v_mfma_f32_16x16x32_bf16 a[144:147], v[76:79], v[164:167], a[144:147]
    v_mfma_f32_16x16x32_bf16 a[148:151], v[76:79], v[168:171], a[148:151]
    v_mfma_f32_16x16x32_bf16 a[152:155], v[76:79], v[172:175], a[152:155]
    v_mfma_f32_16x16x32_bf16 a[156:159], v[76:79], v[176:179], a[156:159]
    v_mfma_f32_16x16x32_bf16 a[160:163], v[76:79], v[180:183], a[160:163]
    v_mfma_f32_16x16x32_bf16 a[164:167], v[76:79], v[184:187], a[164:167]
    v_mfma_f32_16x16x32_bf16 a[168:171], v[76:79], v[188:191], a[168:171]
    v_mfma_f32_16x16x32_bf16 a[172:175], v[76:79], v[192:195], a[172:175]
    v_mfma_f32_16x16x32_bf16 a[176:179], v[76:79], v[196:199], a[176:179]
    ds_read_b64_tr_b16 v[76:77], v22 offset:24576
    ds_read_b64_tr_b16 v[78:79], v22 offset:25600
    v_mfma_f32_16x16x32_bf16 a[180:183], v[80:83], v[164:167], a[180:183]
    v_mfma_f32_16x16x32_bf16 a[184:187], v[80:83], v[168:171], a[184:187]
    v_mfma_f32_16x16x32_bf16 a[188:191], v[80:83], v[172:175], a[188:191]
    v_mfma_f32_16x16x32_bf16 a[192:195], v[80:83], v[176:179], a[192:195]
    v_mfma_f32_16x16x32_bf16 a[196:199], v[80:83], v[180:183], a[196:199]
    v_mfma_f32_16x16x32_bf16 a[200:203], v[80:83], v[184:187], a[200:203]
    v_mfma_f32_16x16x32_bf16 a[204:207], v[80:83], v[188:191], a[204:207]
    v_mfma_f32_16x16x32_bf16 a[208:211], v[80:83], v[192:195], a[208:211]
    v_mfma_f32_16x16x32_bf16 a[212:215], v[80:83], v[196:199], a[212:215]
    ds_read_b64_tr_b16 v[80:81], v23 offset:24576
    ds_read_b64_tr_b16 v[82:83], v23 offset:25600
    v_mfma_f32_16x16x32_bf16 a[216:219], v[84:87], v[164:167], a[216:219]
    v_mfma_f32_16x16x32_bf16 a[220:223], v[84:87], v[168:171], a[220:223]
    v_mfma_f32_16x16x32_bf16 a[224:227], v[84:87], v[172:175], a[224:227]
    v_mfma_f32_16x16x32_bf16 a[228:231], v[84:87], v[176:179], a[228:231]
    v_mfma_f32_16x16x32_bf16 a[232:235], v[84:87], v[180:183], a[232:235]
    v_mfma_f32_16x16x32_bf16 a[236:239], v[84:87], v[184:187], a[236:239]
    v_mfma_f32_16x16x32_bf16 a[240:243], v[84:87], v[188:191], a[240:243]
    v_mfma_f32_16x16x32_bf16 a[244:247], v[84:87], v[192:195], a[244:247]
    v_mfma_f32_16x16x32_bf16 a[248:251], v[84:87], v[196:199], a[248:251]
    ds_read_b64_tr_b16 v[84:85], v24 offset:24576
    ds_read_b64_tr_b16 v[86:87], v24 offset:25600
    v_mfma_f32_16x16x32_bf16 a[252:255], v[88:91], v[164:167], a[252:255]
    v_mfma_f32_16x16x32_bf16 v[28:31], v[88:91], v[168:171], v[28:31]
    v_mfma_f32_16x16x32_bf16 v[32:35], v[88:91], v[172:175], v[32:35]
    v_mfma_f32_16x16x32_bf16 v[36:39], v[88:91], v[176:179], v[36:39]
    v_mfma_f32_16x16x32_bf16 v[40:43], v[88:91], v[180:183], v[40:43]
    v_mfma_f32_16x16x32_bf16 v[44:47], v[88:91], v[184:187], v[44:47]
    v_mfma_f32_16x16x32_bf16 v[48:51], v[88:91], v[188:191], v[48:51]
    v_mfma_f32_16x16x32_bf16 v[52:55], v[88:91], v[192:195], v[52:55]
    v_mfma_f32_16x16x32_bf16 v[56:59], v[88:91], v[196:199], v[56:59]
    ds_read_b64_tr_b16 v[88:89], v25 offset:24576
    ds_read_b64_tr_b16 v[90:91], v25 offset:25600
    s_waitcnt vmcnt(34) lgkmcnt(12)
    v_mfma_f32_16x16x32_bf16 a[0:3], v[60:63], v[200:203], a[0:3]
    buffer_load_dwordx4 v[164:167], v7, s[4:7], s48 offen
    v_mfma_f32_16x16x32_bf16 a[4:7], v[60:63], v[204:207], a[4:7]
    buffer_load_dwordx4 v[168:171], v7, s[4:7], s49 offen
    v_mfma_f32_16x16x32_bf16 a[8:11], v[60:63], v[208:211], a[8:11]
    buffer_load_dwordx4 v[172:175], v7, s[4:7], s50 offen
    v_mfma_f32_16x16x32_bf16 a[12:15], v[60:63], v[212:215], a[12:15]
    buffer_load_dwordx4 v[176:179], v7, s[4:7], s51 offen
    v_mfma_f32_16x16x32_bf16 a[16:19], v[60:63], v[216:219], a[16:19]
    buffer_load_dwordx4 v[180:183], v7, s[4:7], s52 offen
    v_mfma_f32_16x16x32_bf16 a[20:23], v[60:63], v[220:223], a[20:23]
    buffer_load_dwordx4 v[184:187], v7, s[4:7], s53 offen
    v_mfma_f32_16x16x32_bf16 a[24:27], v[60:63], v[224:227], a[24:27]
    buffer_load_dwordx4 v[188:191], v7, s[4:7], s54 offen
    v_mfma_f32_16x16x32_bf16 a[28:31], v[60:63], v[228:231], a[28:31]
    buffer_load_dwordx4 v[192:195], v7, s[4:7], s55 offen
    v_mfma_f32_16x16x32_bf16 a[32:35], v[60:63], v[232:235], a[32:35]
    ds_read_b64_tr_b16 v[60:61], v18 offset:0
    ds_read_b64_tr_b16 v[62:63], v18 offset:1024
    v_mfma_f32_16x16x32_bf16 a[36:39], v[64:67], v[200:203], a[36:39]
    buffer_load_dwordx4 v[196:199], v7, s[4:7], s56 offen
    v_mfma_f32_16x16x32_bf16 a[40:43], v[64:67], v[204:207], a[40:43]
    v_add_u32 v7, 57344, v7
    v_mfma_f32_16x16x32_bf16 a[44:47], v[64:67], v[208:211], a[44:47]
    v_mfma_f32_16x16x32_bf16 a[48:51], v[64:67], v[212:215], a[48:51]
    v_mfma_f32_16x16x32_bf16 a[52:55], v[64:67], v[216:219], a[52:55]
    v_mfma_f32_16x16x32_bf16 a[56:59], v[64:67], v[220:223], a[56:59]
    v_mfma_f32_16x16x32_bf16 a[60:63], v[64:67], v[224:227], a[60:63]
    v_mfma_f32_16x16x32_bf16 a[64:67], v[64:67], v[228:231], a[64:67]
    v_mfma_f32_16x16x32_bf16 a[68:71], v[64:67], v[232:235], a[68:71]
    ds_read_b64_tr_b16 v[64:65], v19 offset:0
    ds_read_b64_tr_b16 v[66:67], v19 offset:1024
    s_waitcnt lgkmcnt(4)
    v_mfma_f32_16x16x32_bf16 a[72:75], v[68:71], v[200:203], a[72:75]
    s_add_u32 m0, s27, 24576
    v_mfma_f32_16x16x32_bf16 a[76:79], v[68:71], v[204:207], a[76:79]
    s_nop 0
    v_mfma_f32_16x16x32_bf16 a[80:83], v[68:71], v[208:211], a[80:83]
    buffer_load_dwordx4 v10, s[8:11], s26 offen offset:0 lds
    v_mfma_f32_16x16x32_bf16 a[84:87], v[68:71], v[212:215], a[84:87]
    buffer_load_dwordx4 v11, s[8:11], s26 offen offset:1024 lds
    v_mfma_f32_16x16x32_bf16 a[88:91], v[68:71], v[216:219], a[88:91]
    buffer_load_dwordx4 v12, s[8:11], s26 offen offset:2048 lds
    v_mfma_f32_16x16x32_bf16 a[92:95], v[68:71], v[220:223], a[92:95]
    buffer_load_dwordx4 v13, s[8:11], s26 offen offset:3072 lds
    v_mfma_f32_16x16x32_bf16 a[96:99], v[68:71], v[224:227], a[96:99]
    s_add_u32 m0, s27, 28672
    v_mfma_f32_16x16x32_bf16 a[100:103], v[68:71], v[228:231], a[100:103]
    s_nop 0
    v_mfma_f32_16x16x32_bf16 a[104:107], v[68:71], v[232:235], a[104:107]
    ds_read_b64_tr_b16 v[68:69], v20 offset:0
    ds_read_b64_tr_b16 v[70:71], v20 offset:1024
    v_mfma_f32_16x16x32_bf16 a[108:111], v[72:75], v[200:203], a[108:111]
    buffer_load_dwordx4 v14, s[8:11], s26 offen offset:0 lds
    v_mfma_f32_16x16x32_bf16 a[112:115], v[72:75], v[204:207], a[112:115]
    buffer_load_dwordx4 v15, s[8:11], s26 offen offset:1024 lds
    v_mfma_f32_16x16x32_bf16 a[116:119], v[72:75], v[208:211], a[116:119]
    buffer_load_dwordx4 v16, s[8:11], s26 offen offset:2048 lds
    v_mfma_f32_16x16x32_bf16 a[120:123], v[72:75], v[212:215], a[120:123]
    buffer_load_dwordx4 v17, s[8:11], s26 offen offset:3072 lds
    v_mfma_f32_16x16x32_bf16 a[124:127], v[72:75], v[216:219], a[124:127]
    s_add_u32 s26, s26, 163840
    v_mfma_f32_16x16x32_bf16 a[128:131], v[72:75], v[220:223], a[128:131]
    v_mfma_f32_16x16x32_bf16 a[132:135], v[72:75], v[224:227], a[132:135]
    v_mfma_f32_16x16x32_bf16 a[136:139], v[72:75], v[228:231], a[136:139]
    v_mfma_f32_16x16x32_bf16 a[140:143], v[72:75], v[232:235], a[140:143]
    ds_read_b64_tr_b16 v[72:73], v21 offset:0
    ds_read_b64_tr_b16 v[74:75], v21 offset:1024
    v_mfma_f32_16x16x32_bf16 a[144:147], v[76:79], v[200:203], a[144:147]
    v_mfma_f32_16x16x32_bf16 a[148:151], v[76:79], v[204:207], a[148:151]
    v_mfma_f32_16x16x32_bf16 a[152:155], v[76:79], v[208:211], a[152:155]
    v_mfma_f32_16x16x32_bf16 a[156:159], v[76:79], v[212:215], a[156:159]
    v_mfma_f32_16x16x32_bf16 a[160:163], v[76:79], v[216:219], a[160:163]
    v_mfma_f32_16x16x32_bf16 a[164:167], v[76:79], v[220:223], a[164:167]
    v_mfma_f32_16x16x32_bf16 a[168:171], v[76:79], v[224:227], a[168:171]
    v_mfma_f32_16x16x32_bf16 a[172:175], v[76:79], v[228:231], a[172:175]
    v_mfma_f32_16x16x32_bf16 a[176:179], v[76:79], v[232:235], a[176:179]
    ds_read_b64_tr_b16 v[76:77], v22 offset:0
    ds_read_b64_tr_b16 v[78:79], v22 offset:1024
    v_mfma_f32_16x16x32_bf16 a[180:183], v[80:83], v[200:203], a[180:183]
    v_mfma_f32_16x16x32_bf16 a[184:187], v[80:83], v[204:207], a[184:187]
    v_mfma_f32_16x16x32_bf16 a[188:191], v[80:83], v[208:211], a[188:191]
    v_mfma_f32_16x16x32_bf16 a[192:195], v[80:83], v[212:215], a[192:195]
    v_mfma_f32_16x16x32_bf16 a[196:199], v[80:83], v[216:219], a[196:199]
    v_mfma_f32_16x16x32_bf16 a[200:203], v[80:83], v[220:223], a[200:203]
    v_mfma_f32_16x16x32_bf16 a[204:207], v[80:83], v[224:227], a[204:207]
    v_mfma_f32_16x16x32_bf16 a[208:211], v[80:83], v[228:231], a[208:211]
    v_mfma_f32_16x16x32_bf16 a[212:215], v[80:83], v[232:235], a[212:215]
    ds_read_b64_tr_b16 v[80:81], v23 offset:0
    ds_read_b64_tr_b16 v[82:83], v23 offset:1024
    v_mfma_f32_16x16x32_bf16 a[216:219], v[84:87], v[200:203], a[216:219]
    v_mfma_f32_16x16x32_bf16 a[220:223], v[84:87], v[204:207], a[220:223]
    v_mfma_f32_16x16x32_bf16 a[224:227], v[84:87], v[208:211], a[224:227]
    v_mfma_f32_16x16x32_bf16 a[228:231], v[84:87], v[212:215], a[228:231]
    v_mfma_f32_16x16x32_bf16 a[232:235], v[84:87], v[216:219], a[232:235]
    v_mfma_f32_16x16x32_bf16 a[236:239], v[84:87], v[220:223], a[236:239]
    v_mfma_f32_16x16x32_bf16 a[240:243], v[84:87], v[224:227], a[240:243]
    v_mfma_f32_16x16x32_bf16 a[244:247], v[84:87], v[228:231], a[244:247]
    v_mfma_f32_16x16x32_bf16 a[248:251], v[84:87], v[232:235], a[248:251]
    ds_read_b64_tr_b16 v[84:85], v24 offset:0
    ds_read_b64_tr_b16 v[86:87], v24 offset:1024
    v_mfma_f32_16x16x32_bf16 a[252:255], v[88:91], v[200:203], a[252:255]
    v_mfma_f32_16x16x32_bf16 v[28:31], v[88:91], v[204:207], v[28:31]
    v_mfma_f32_16x16x32_bf16 v[32:35], v[88:91], v[208:211], v[32:35]
    v_mfma_f32_16x16x32_bf16 v[36:39], v[88:91], v[212:215], v[36:39]
    v_mfma_f32_16x16x32_bf16 v[40:43], v[88:91], v[216:219], v[40:43]
    v_mfma_f32_16x16x32_bf16 v[44:47], v[88:91], v[220:223], v[44:47]
    v_mfma_f32_16x16x32_bf16 v[48:51], v[88:91], v[224:227], v[48:51]
    v_mfma_f32_16x16x32_bf16 v[52:55], v[88:91], v[228:231], v[52:55]
    v_mfma_f32_16x16x32_bf16 v[56:59], v[88:91], v[232:235], v[56:59]
    ds_read_b64_tr_b16 v[88:89], v25 offset:0
    ds_read_b64_tr_b16 v[90:91], v25 offset:1024
    s_add_u32 s21, s21, 1
    s_cmp_lt_u32 s21, 6
    s_cbranch_scc1 L_op_loop
    s_waitcnt vmcnt(34) lgkmcnt(12)
    v_mfma_f32_16x16x32_bf16 a[0:3], v[60:63], v[92:95], a[0:3]
    buffer_load_dwordx4 v[200:203], v7, s[4:7], s48 offen
    v_mfma_f32_16x16x32_bf16 a[4:7], v[60:63], v[96:99], a[4:7]
    buffer_load_dwordx4 v[204:207], v7, s[4:7], s49 offen
    v_mfma_f32_16x16x32_bf16 a[8:11], v[60:63], v[100:103], a[8:11]
    buffer_load_dwordx4 v[208:211], v7, s[4:7], s50 offen
    v_mfma_f32_16x16x32_bf16 a[12:15], v[60:63], v[104:107], a[12:15]
    buffer_load_dwordx4 v[212:215], v7, s[4:7], s51 offen
    v_mfma_f32_16x16x32_bf16 a[16:19], v[60:63], v[108:111], a[16:19]
    buffer_load_dwordx4 v[216:219], v7, s[4:7], s52 offen
    v_mfma_f32_16x16x32_bf16 a[20:23], v[60:63], v[112:115], a[20:23]
    buffer_load_dwordx4 v[220:223], v7, s[4:7], s53 offen
    v_mfma_f32_16x16x32_bf16 a[24:27], v[60:63], v[116:119], a[24:27]
    buffer_load_dwordx4 v[224:227], v7, s[4:7], s54 offen
    v_mfma_f32_16x16x32_bf16 a[28:31], v[60:63], v[120:123], a[28:31]
    buffer_load_dwordx4 v[228:231], v7, s[4:7], s55 offen
    v_mfma_f32_16x16x32_bf16 a[32:35], v[60:63], v[124:127], a[32:35]
    ds_read_b64_tr_b16 v[60:61], v18 offset:8192
    ds_read_b64_tr_b16 v[62:63], v18 offset:9216
    v_mfma_f32_16x16x32_bf16 a[36:39], v[64:67], v[92:95], a[36:39]
    buffer_load_dwordx4 v[232:235], v7, s[4:7], s56 offen
    v_mfma_f32_16x16x32_bf16 a[40:43], v[64:67], v[96:99], a[40:43]
    v_add_u32 v7, 57344, v7
    v_mfma_f32_16x16x32_bf16 a[44:47], v[64:67], v[100:103], a[44:47]
    v_mfma_f32_16x16x32_bf16 a[48:51], v[64:67], v[104:107], a[48:51]
    v_mfma_f32_16x16x32_bf16 a[52:55], v[64:67], v[108:111], a[52:55]
    v_mfma_f32_16x16x32_bf16 a[56:59], v[64:67], v[112:115], a[56:59]
    v_mfma_f32_16x16x32_bf16 a[60:63], v[64:67], v[116:119], a[60:63]
    v_mfma_f32_16x16x32_bf16 a[64:67], v[64:67], v[120:123], a[64:67]
    v_mfma_f32_16x16x32_bf16 a[68:71], v[64:67], v[124:127], a[68:71]
    ds_read_b64_tr_b16 v[64:65], v19 offset:8192
    ds_read_b64_tr_b16 v[66:67], v19 offset:9216
    s_waitcnt lgkmcnt(4)
    v_mfma_f32_16x16x32_bf16 a[72:75], v[68:71], v[92:95], a[72:75]
    v_mfma_f32_16x16x32_bf16 a[76:79], v[68:71], v[96:99], a[76:79]
    v_mfma_f32_16x16x32_bf16 a[80:83], v[68:71], v[100:103], a[80:83]
    v_mfma_f32_16x16x32_bf16 a[84:87], v[68:71], v[104:107], a[84:87]
    v_mfma_f32_16x16x32_bf16 a[88:91], v[68:71], v[108:111], a[88:91]
    v_mfma_f32_16x16x32_bf16 a[92:95], v[68:71], v[112:115], a[92:95]
    v_mfma_f32_16x16x32_bf16 a[96:99], v[68:71], v[116:119], a[96:99]
    v_mfma_f32_16x16x32_bf16 a[100:103], v[68:71], v[120:123], a[100:103]
    v_mfma_f32_16x16x32_bf16 a[104:107], v[68:71], v[124:127], a[104:107]
    ds_read_b64_tr_b16 v[68:69], v20 offset:8192
    ds_read_b64_tr_b16 v[70:71], v20 offset:9216
    v_mfma_f32_16x16x32_bf16 a[108:111], v[72:75], v[92:95], a[108:111]
    v_mfma_f32_16x16x32_bf16 a[112:115], v[72:75], v[96:99], a[112:115]
    v_mfma_f32_16x16x32_bf16 a[116:119], v[72:75], v[100:103], a[116:119]
    v_mfma_f32_16x16x32_bf16 a[120:123], v[72:75], v[104:107], a[120:123]
    v_mfma_f32_16x16x32_bf16 a[124:127], v[72:75], v[108:111], a[124:127]
    v_mfma_f32_16x16x32_bf16 a[128:131], v[72:75], v[112:115], a[128:131]
    v_mfma_f32_16x16x32_bf16 a[132:135], v[72:75], v[116:119], a[132:135]
    v_mfma_f32_16x16x32_bf16 a[136:139], v[72:75], v[120:123], a[136:139]
    v_mfma_f32_16x16x32_bf16 a[140:143], v[72:75], v[124:127], a[140:143]
    ds_read_b64_tr_b16 v[72:73], v21 offset:8192
    ds_read_b64_tr_b16 v[74:75], v21 offset:9216
    v_mfma_f32_16x16x32_bf16 a[144:147], v[76:79], v[92:95], a[144:147]
    v_mfma_f32_16x16x32_bf16 a[148:151], v[76:79], v[96:99], a[148:151]
    v_mfma_f32_16x16x32_bf16 a[152:155], v[76:79], v[100:103], a[152:155]
    v_mfma_f32_16x16x32_bf16 a[156:159], v[76:79], v[104:107], a[156:159]
    v_mfma_f32_16x16x32_bf16 a[160:163], v[76:79], v[108:111], a[160:163]
    v_mfma_f32_16x16x32_bf16 a[164:167], v[76:79], v[112:115], a[164:167]
    v_mfma_f32_16x16x32_bf16 a[168:171], v[76:79], v[116:119], a[168:171]
    v_mfma_f32_16x16x32_bf16 a[172:175], v[76:79], v[120:123], a[172:175]
    v_mfma_f32_16x16x32_bf16 a[176:179], v[76:79], v[124:127], a[176:179]
    ds_read_b64_tr_b16 v[76:77], v22 offset:8192
    ds_read_b64_tr_b16 v[78:79], v22 offset:9216
    v_mfma_f32_16x16x32_bf16 a[180:183], v[80:83], v[92:95], a[180:183]
    v_mfma_f32_16x16x32_bf16 a[184:187], v[80:83], v[96:99], a[184:187]
    v_mfma_f32_16x16x32_bf16 a[188:191], v[80:83], v[100:103], a[188:191]
    v_mfma_f32_16x16x32_bf16 a[192:195], v[80:83], v[104:107], a[192:195]
    v_mfma_f32_16x16x32_bf16 a[196:199], v[80:83], v[108:111], a[196:199]
    v_mfma_f32_16x16x32_bf16 a[200:203], v[80:83], v[112:115], a[200:203]
    v_mfma_f32_16x16x32_bf16 a[204:207], v[80:83], v[116:119], a[204:207]
    v_mfma_f32_16x16x32_bf16 a[208:211], v[80:83], v[120:123], a[208:211]
    v_mfma_f32_16x16x32_bf16 a[212:215], v[80:83], v[124:127], a[212:215]
    ds_read_b64_tr_b16 v[80:81], v23 offset:8192
    ds_read_b64_tr_b16 v[82:83], v23 offset:9216
    v_mfma_f32_16x16x32_bf16 a[216:219], v[84:87], v[92:95], a[216:219]
    v_mfma_f32_16x16x32_bf16 a[220:223], v[84:87], v[96:99], a[220:223]
    v_mfma_f32_16x16x32_bf16 a[224:227], v[84:87], v[100:103], a[224:227]
    v_mfma_f32_16x16x32_bf16 a[228:231], v[84:87], v[104:107], a[228:231]
    v_mfma_f32_16x16x32_bf16 a[232:235], v[84:87], v[108:111], a[232:235]
    v_mfma_f32_16x16x32_bf16 a[236:239], v[84:87], v[112:115], a[236:239]
    v_mfma_f32_16x16x32_bf16 a[240:243], v[84:87], v[116:119], a[240:243]
    v_mfma_f32_16x16x32_bf16 a[244:247], v[84:87], v[120:123], a[244:247]
    v_mfma_f32_16x16x32_bf16 a[248:251], v[84:87], v[124:127], a[248:251]
    ds_read_b64_tr_b16 v[84:85], v24 offset:8192
    ds_read_b64_tr_b16 v[86:87], v24 offset:9216
    v_mfma_f32_16x16x32_bf16 a[252:255], v[88:91], v[92:95], a[252:255]
    v_mfma_f32_16x16x32_bf16 v[28:31], v[88:91], v[96:99], v[28:31]
    v_mfma_f32_16x16x32_bf16 v[32:35], v[88:91], v[100:103], v[32:35]
    v_mfma_f32_16x16x32_bf16 v[36:39], v[88:91], v[104:107], v[36:39]
    v_mfma_f32_16x16x32_bf16 v[40:43], v[88:91], v[108:111], v[40:43]
    v_mfma_f32_16x16x32_bf16 v[44:47], v[88:91], v[112:115], v[44:47]
    v_mfma_f32_16x16x32_bf16 v[48:51], v[88:91], v[116:119], v[48:51]
    v_mfma_f32_16x16x32_bf16 v[52:55], v[88:91], v[120:123], v[52:55]
    v_mfma_f32_16x16x32_bf16 v[56:59], v[88:91], v[124:127], v[56:59]
    ds_read_b64_tr_b16 v[88:89], v25 offset:8192
    ds_read_b64_tr_b16 v[90:91], v25 offset:9216
    s_waitcnt vmcnt(26) lgkmcnt(12)
    v_mfma_f32_16x16x32_bf16 a[0:3], v[60:63], v[128:131], a[0:3]
    v_mfma_f32_16x16x32_bf16 a[4:7], v[60:63], v[132:135], a[4:7]
    v_mfma_f32_16x16x32_bf16 a[8:11], v[60:63], v[136:139], a[8:11]
    v_mfma_f32_16x16x32_bf16 a[12:15], v[60:63], v[140:143], a[12:15]
    v_mfma_f32_16x16x32_bf16 a[16:19], v[60:63], v[144:147], a[16:19]
    v_mfma_f32_16x16x32_bf16 a[20:23], v[60:63], v[148:151], a[20:23]
    v_mfma_f32_16x16x32_bf16 a[24:27], v[60:63], v[152:155], a[24:27]
    v_mfma_f32_16x16x32_bf16 a[28:31], v[60:63], v[156:159], a[28:31]
    v_mfma_f32_16x16x32_bf16 a[32:35], v[60:63], v[160:163], a[32:35]
    ds_read_b64_tr_b16 v[60:61], v18 offset:16384
    ds_read_b64_tr_b16 v[62:63], v18 offset:17408
    v_mfma_f32_16x16x32_bf16 a[36:39], v[64:67], v[128:131], a[36:39]
    v_mfma_f32_16x16x32_bf16 a[40:43], v[64:67], v[132:135], a[40:43]
    v_mfma_f32_16x16x32_bf16 a[44:47], v[64:67], v[136:139], a[44:47]
    v_mfma_f32_16x16x32_bf16 a[48:51], v[64:67], v[140:143], a[48:51]
    v_mfma_f32_16x16x32_bf16 a[52:55], v[64:67], v[144:147], a[52:55]
    v_mfma_f32_16x16x32_bf16 a[56:59], v[64:67], v[148:151], a[56:59]
    v_mfma_f32_16x16x32_bf16 a[60:63], v[64:67], v[152:155], a[60:63]
    v_mfma_f32_16x16x32_bf16 a[64:67], v[64:67], v[156:159], a[64:67]
    v_mfma_f32_16x16x32_bf16 a[68:71], v[64:67], v[160:163], a[68:71]
    ds_read_b64_tr_b16 v[64:65], v19 offset:16384
    ds_read_b64_tr_b16 v[66:67], v19 offset:17408
    s_waitcnt lgkmcnt(4)
    v_mfma_f32_16x16x32_bf16 a[72:75], v[68:71], v[128:131], a[72:75]
    v_mfma_f32_16x16x32_bf16 a[76:79], v[68:71], v[132:135], a[76:79]
    v_mfma_f32_16x16x32_bf16 a[80:83], v[68:71], v[136:139], a[80:83]
    v_mfma_f32_16x16x32_bf16 a[84:87], v[68:71], v[140:143], a[84:87]
    v_mfma_f32_16x16x32_bf16 a[88:91], v[68:71], v[144:147], a[88:91]
    v_mfma_f32_16x16x32_bf16 a[92:95], v[68:71], v[148:151], a[92:95]
    v_mfma_f32_16x16x32_bf16 a[96:99], v[68:71], v[152:155], a[96:99]
    v_mfma_f32_16x16x32_bf16 a[100:103], v[68:71], v[156:159], a[100:103]
    v_mfma_f32_16x16x32_bf16 a[104:107], v[68:71], v[160:163], a[104:107]
    ds_read_b64_tr_b16 v[68:69], v20 offset:16384
    ds_read_b64_tr_b16 v[70:71], v20 offset:17408
    v_mfma_f32_16x16x32_bf16 a[108:111], v[72:75], v[128:131], a[108:111]
    v_mfma_f32_16x16x32_bf16 a[112:115], v[72:75], v[132:135], a[112:115]
    v_mfma_f32_16x16x32_bf16 a[116:119], v[72:75], v[136:139], a[116:119]
    v_mfma_f32_16x16x32_bf16 a[120:123], v[72:75], v[140:143], a[120:123]
    v_mfma_f32_16x16x32_bf16 a[124:127], v[72:75], v[144:147], a[124:127]
    v_mfma_f32_16x16x32_bf16 a[128:131], v[72:75], v[148:151], a[128:131]
    v_mfma_f32_16x16x32_bf16 a[132:135], v[72:75], v[152:155], a[132:135]
    v_mfma_f32_16x16x32_bf16 a[136:139], v[72:75], v[156:159], a[136:139]
    v_mfma_f32_16x16x32_bf16 a[140:143], v[72:75], v[160:163], a[140:143]
    ds_read_b64_tr_b16 v[72:73], v21 offset:16384
    ds_read_b64_tr_b16 v[74:75], v21 offset:17408
    v_mfma_f32_16x16x32_bf16 a[144:147], v[76:79], v[128:131], a[144:147]
    v_mfma_f32_16x16x32_bf16 a[148:151], v[76:79], v[132:135], a[148:151]
    v_mfma_f32_16x16x32_bf16 a[152:155], v[76:79], v[136:139], a[152:155]
    v_mfma_f32_16x16x32_bf16 a[156:159], v[76:79], v[140:143], a[156:159]
    v_mfma_f32_16x16x32_bf16 a[160:163], v[76:79], v[144:147], a[160:163]
    v_mfma_f32_16x16x32_bf16 a[164:167], v[76:79], v[148:151], a[164:167]
    v_mfma_f32_16x16x32_bf16 a[168:171], v[76:79], v[152:155], a[168:171]
    v_mfma_f32_16x16x32_bf16 a[172:175], v[76:79], v[156:159], a[172:175]
    v_mfma_f32_16x16x32_bf16 a[176:179], v[76:79], v[160:163], a[176:179]
    ds_read_b64_tr_b16 v[76:77], v22 offset:16384
    ds_read_b64_tr_b16 v[78:79], v22 offset:17408
    v_mfma_f32_16x16x32_bf16 a[180:183], v[80:83], v[128:131], a[180:183]
    v_mfma_f32_16x16x32_bf16 a[184:187], v[80:83], v[132:135], a[184:187]
    v_mfma_f32_16x16x32_bf16 a[188:191], v[80:83], v[136:139], a[188:191]
    v_mfma_f32_16x16x32_bf16 a[192:195], v[80:83], v[140:143], a[192:195]
    v_mfma_f32_16x16x32_bf16 a[196:199], v[80:83], v[144:147], a[196:199]
    v_mfma_f32_16x16x32_bf16 a[200:203], v[80:83], v[148:151], a[200:203]
    v_mfma_f32_16x16x32_bf16 a[204:207], v[80:83], v[152:155], a[204:207]
    v_mfma_f32_16x16x32_bf16 a[208:211], v[80:83], v[156:159], a[208:211]
    v_mfma_f32_16x16x32_bf16 a[212:215], v[80:83], v[160:163], a[212:215]
    ds_read_b64_tr_b16 v[80:81], v23 offset:16384
    ds_read_b64_tr_b16 v[82:83], v23 offset:17408
    v_mfma_f32_16x16x32_bf16 a[216:219], v[84:87], v[128:131], a[216:219]
    v_mfma_f32_16x16x32_bf16 a[220:223], v[84:87], v[132:135], a[220:223]
    v_mfma_f32_16x16x32_bf16 a[224:227], v[84:87], v[136:139], a[224:227]
    v_mfma_f32_16x16x32_bf16 a[228:231], v[84:87], v[140:143], a[228:231]
    v_mfma_f32_16x16x32_bf16 a[232:235], v[84:87], v[144:147], a[232:235]
    v_mfma_f32_16x16x32_bf16 a[236:239], v[84:87], v[148:151], a[236:239]
    v_mfma_f32_16x16x32_bf16 a[240:243], v[84:87], v[152:155], a[240:243]
    v_mfma_f32_16x16x32_bf16 a[244:247], v[84:87], v[156:159], a[244:247]
    v_mfma_f32_16x16x32_bf16 a[248:251], v[84:87], v[160:163], a[248:251]
    ds_read_b64_tr_b16 v[84:85], v24 offset:16384
    ds_read_b64_tr_b16 v[86:87], v24 offset:17408
    v_mfma_f32_16x16x32_bf16 a[252:255], v[88:91], v[128:131], a[252:255]
    v_mfma_f32_16x16x32_bf16 v[28:31], v[88:91], v[132:135], v[28:31]
    v_mfma_f32_16x16x32_bf16 v[32:35], v[88:91], v[136:139], v[32:35]
    v_mfma_f32_16x16x32_bf16 v[36:39], v[88:91], v[140:143], v[36:39]
    v_mfma_f32_16x16x32_bf16 v[40:43], v[88:91], v[144:147], v[40:43]
    v_mfma_f32_16x16x32_bf16 v[44:47], v[88:91], v[148:151], v[44:47]
    v_mfma_f32_16x16x32_bf16 v[48:51], v[88:91], v[152:155], v[48:51]
    v_mfma_f32_16x16x32_bf16 v[52:55], v[88:91], v[156:159], v[52:55]
    v_mfma_f32_16x16x32_bf16 v[56:59], v[88:91], v[160:163], v[56:59]
    ds_read_b64_tr_b16 v[88:89], v25 offset:16384
    ds_read_b64_tr_b16 v[90:91], v25 offset:17408
    s_waitcnt vmcnt(9) lgkmcnt(12)
    v_mfma_f32_16x16x32_bf16 a[0:3], v[60:63], v[164:167], a[0:3]
    v_mfma_f32_16x16x32_bf16 a[4:7], v[60:63], v[168:171], a[4:7]
    v_mfma_f32_16x16x32_bf16 a[8:11], v[60:63], v[172:175], a[8:11]
    v_mfma_f32_16x16x32_bf16 a[12:15], v[60:63], v[176:179], a[12:15]
    v_mfma_f32_16x16x32_bf16 a[16:19], v[60:63], v[180:183], a[16:19]
    v_mfma_f32_16x16x32_bf16 a[20:23], v[60:63], v[184:187], a[20:23]
    v_mfma_f32_16x16x32_bf16 a[24:27], v[60:63], v[188:191], a[24:27]
    v_mfma_f32_16x16x32_bf16 a[28:31], v[60:63], v[192:195], a[28:31]
    v_mfma_f32_16x16x32_bf16 a[32:35], v[60:63], v[196:199], a[32:35]
    ds_read_b64_tr_b16 v[60:61], v18 offset:24576
    ds_read_b64_tr_b16 v[62:63], v18 offset:25600
    v_mfma_f32_16x16x32_bf16 a[36:39], v[64:67], v[164:167], a[36:39]
    v_mfma_f32_16x16x32_bf16 a[40:43], v[64:67], v[168:171], a[40:43]
    v_mfma_f32_16x16x32_bf16 a[44:47], v[64:67], v[172:175], a[44:47]
    v_mfma_f32_16x16x32_bf16 a[48:51], v[64:67], v[176:179], a[48:51]
    v_mfma_f32_16x16x32_bf16 a[52:55], v[64:67], v[180:183], a[52:55]
    v_mfma_f32_16x16x32_bf16 a[56:59], v[64:67], v[184:187], a[56:59]
    v_mfma_f32_16x16x32_bf16 a[60:63], v[64:67], v[188:191], a[60:63]
    v_mfma_f32_16x16x32_bf16 a[64:67], v[64:67], v[192:195], a[64:67]
    v_mfma_f32_16x16x32_bf16 a[68:71], v[64:67], v[196:199], a[68:71]
    ds_read_b64_tr_b16 v[64:65], v19 offset:24576
    ds_read_b64_tr_b16 v[66:67], v19 offset:25600
    s_waitcnt lgkmcnt(4)
    v_mfma_f32_16x16x32_bf16 a[72:75], v[68:71], v[164:167], a[72:75]
    v_mfma_f32_16x16x32_bf16 a[76:79], v[68:71], v[168:171], a[76:79]
    v_mfma_f32_16x16x32_bf16 a[80:83], v[68:71], v[172:175], a[80:83]
    v_mfma_f32_16x16x32_bf16 a[84:87], v[68:71], v[176:179], a[84:87]
    v_mfma_f32_16x16x32_bf16 a[88:91], v[68:71], v[180:183], a[88:91]
    v_mfma_f32_16x16x32_bf16 a[92:95], v[68:71], v[184:187], a[92:95]
    v_mfma_f32_16x16x32_bf16 a[96:99], v[68:71], v[188:191], a[96:99]
    v_mfma_f32_16x16x32_bf16 a[100:103], v[68:71], v[192:195], a[100:103]
    v_mfma_f32_16x16x32_bf16 a[104:107], v[68:71], v[196:199], a[104:107]
    ds_read_b64_tr_b16 v[68:69], v20 offset:24576
    ds_read_b64_tr_b16 v[70:71], v20 offset:25600
    v_mfma_f32_16x16x32_bf16 a[108:111], v[72:75], v[164:167], a[108:111]
    v_mfma_f32_16x16x32_bf16 a[112:115], v[72:75], v[168:171], a[112:115]
    v_mfma_f32_16x16x32_bf16 a[116:119], v[72:75], v[172:175], a[116:119]
    v_mfma_f32_16x16x32_bf16 a[120:123], v[72:75], v[176:179], a[120:123]
    v_mfma_f32_16x16x32_bf16 a[124:127], v[72:75], v[180:183], a[124:127]
    v_mfma_f32_16x16x32_bf16 a[128:131], v[72:75], v[184:187], a[128:131]
    v_mfma_f32_16x16x32_bf16 a[132:135], v[72:75], v[188:191], a[132:135]
    v_mfma_f32_16x16x32_bf16 a[136:139], v[72:75], v[192:195], a[136:139]
    v_mfma_f32_16x16x32_bf16 a[140:143], v[72:75], v[196:199], a[140:143]
    ds_read_b64_tr_b16 v[72:73], v21 offset:24576
    ds_read_b64_tr_b16 v[74:75], v21 offset:25600
    v_mfma_f32_16x16x32_bf16 a[144:147], v[76:79], v[164:167], a[144:147]
    v_mfma_f32_16x16x32_bf16 a[148:151], v[76:79], v[168:171], a[148:151]
    v_mfma_f32_16x16x32_bf16 a[152:155], v[76:79], v[172:175], a[152:155]
    v_mfma_f32_16x16x32_bf16 a[156:159], v[76:79], v[176:179], a[156:159]
    v_mfma_f32_16x16x32_bf16 a[160:163], v[76:79], v[180:183], a[160:163]
    v_mfma_f32_16x16x32_bf16 a[164:167], v[76:79], v[184:187], a[164:167]
    v_mfma_f32_16x16x32_bf16 a[168:171], v[76:79], v[188:191], a[168:171]
    v_mfma_f32_16x16x32_bf16 a[172:175], v[76:79], v[192:195], a[172:175]
    v_mfma_f32_16x16x32_bf16 a[176:179], v[76:79], v[196:199], a[176:179]
    ds_read_b64_tr_b16 v[76:77], v22 offset:24576
    ds_read_b64_tr_b16 v[78:79], v22 offset:25600
    v_mfma_f32_16x16x32_bf16 a[180:183], v[80:83], v[164:167], a[180:183]
    v_mfma_f32_16x16x32_bf16 a[184:187], v[80:83], v[168:171], a[184:187]
    v_mfma_f32_16x16x32_bf16 a[188:191], v[80:83], v[172:175], a[188:191]
    v_mfma_f32_16x16x32_bf16 a[192:195], v[80:83], v[176:179], a[192:195]
    v_mfma_f32_16x16x32_bf16 a[196:199], v[80:83], v[180:183], a[196:199]
    v_mfma_f32_16x16x32_bf16 a[200:203], v[80:83], v[184:187], a[200:203]
    v_mfma_f32_16x16x32_bf16 a[204:207], v[80:83], v[188:191], a[204:207]
    v_mfma_f32_16x16x32_bf16 a[208:211], v[80:83], v[192:195], a[208:211]
    v_mfma_f32_16x16x32_bf16 a[212:215], v[80:83], v[196:199], a[212:215]
    ds_read_b64_tr_b16 v[80:81], v23 offset:24576
    ds_read_b64_tr_b16 v[82:83], v23 offset:25600
    v_mfma_f32_16x16x32_bf16 a[216:219], v[84:87], v[164:167], a[216:219]
    v_mfma_f32_16x16x32_bf16 a[220:223], v[84:87], v[168:171], a[220:223]
    v_mfma_f32_16x16x32_bf16 a[224:227], v[84:87], v[172:175], a[224:227]
    v_mfma_f32_16x16x32_bf16 a[228:231], v[84:87], v[176:179], a[228:231]
    v_mfma_f32_16x16x32_bf16 a[232:235], v[84:87], v[180:183], a[232:235]
    v_mfma_f32_16x16x32_bf16 a[236:239], v[84:87], v[184:187], a[236:239]
    v_mfma_f32_16x16x32_bf16 a[240:243], v[84:87], v[188:191], a[240:243]
    v_mfma_f32_16x16x32_bf16 a[244:247], v[84:87], v[192:195], a[244:247]
    v_mfma_f32_16x16x32_bf16 a[248:251], v[84:87], v[196:199], a[248:251]
    ds_read_b64_tr_b16 v[84:85], v24 offset:24576
    ds_read_b64_tr_b16 v[86:87], v24 offset:25600
    v_mfma_f32_16x16x32_bf16 a[252:255], v[88:91], v[164:167], a[252:255]
    v_mfma_f32_16x16x32_bf16 v[28:31], v[88:91], v[168:171], v[28:31]
    v_mfma_f32_16x16x32_bf16 v[32:35], v[88:91], v[172:175], v[32:35]
    v_mfma_f32_16x16x32_bf16 v[36:39], v[88:91], v[176:179], v[36:39]
    v_mfma_f32_16x16x32_bf16 v[40:43], v[88:91], v[180:183], v[40:43]
    v_mfma_f32_16x16x32_bf16 v[44:47], v[88:91], v[184:187], v[44:47]
    v_mfma_f32_16x16x32_bf16 v[48:51], v[88:91], v[188:191], v[48:51]
    v_mfma_f32_16x16x32_bf16 v[52:55], v[88:91], v[192:195], v[52:55]
    v_mfma_f32_16x16x32_bf16 v[56:59], v[88:91], v[196:199], v[56:59]
    ds_read_b64_tr_b16 v[88:89], v25 offset:24576
    ds_read_b64_tr_b16 v[90:91], v25 offset:25600
    s_waitcnt vmcnt(0) lgkmcnt(12)
    v_mfma_f32_16x16x32_bf16 a[0:3], v[60:63], v[200:203], a[0:3]
    v_mfma_f32_16x16x32_bf16 a[4:7], v[60:63], v[204:207], a[4:7]
    v_mfma_f32_16x16x32_bf16 a[8:11], v[60:63], v[208:211], a[8:11]
    v_mfma_f32_16x16x32_bf16 a[12:15], v[60:63], v[212:215], a[12:15]
    v_mfma_f32_16x16x32_bf16 a[16:19], v[60:63], v[216:219], a[16:19]
    v_mfma_f32_16x16x32_bf16 a[20:23], v[60:63], v[220:223], a[20:23]
    v_mfma_f32_16x16x32_bf16 a[24:27], v[60:63], v[224:227], a[24:27]
    v_mfma_f32_16x16x32_bf16 a[28:31], v[60:63], v[228:231], a[28:31]
    v_mfma_f32_16x16x32_bf16 a[32:35], v[60:63], v[232:235], a[32:35]
    v_mfma_f32_16x16x32_bf16 a[36:39], v[64:67], v[200:203], a[36:39]
    v_mfma_f32_16x16x32_bf16 a[40:43], v[64:67], v[204:207], a[40:43]
    v_mfma_f32_16x16x32_bf16 a[44:47], v[64:67], v[208:211], a[44:47]
    v_mfma_f32_16x16x32_bf16 a[48:51], v[64:67], v[212:215], a[48:51]
    v_mfma_f32_16x16x32_bf16 a[52:55], v[64:67], v[216:219], a[52:55]
    v_mfma_f32_16x16x32_bf16 a[56:59], v[64:67], v[220:223], a[56:59]
    v_mfma_f32_16x16x32_bf16 a[60:63], v[64:67], v[224:227], a[60:63]
    v_mfma_f32_16x16x32_bf16 a[64:67], v[64:67], v[228:231], a[64:67]
    v_mfma_f32_16x16x32_bf16 a[68:71], v[64:67], v[232:235], a[68:71]
    ds_write_b128 v8, a[0:3] offset:0
    s_waitcnt lgkmcnt(0)
    v_mfma_f32_16x16x32_bf16 a[72:75], v[68:71], v[200:203], a[72:75]
    ds_write_b128 v8, a[36:39] offset:1024
    v_mfma_f32_16x16x32_bf16 a[76:79], v[68:71], v[204:207], a[76:79]
    ds_write_b128 v8, a[4:7] offset:2048
    v_mfma_f32_16x16x32_bf16 a[80:83], v[68:71], v[208:211], a[80:83]
    ds_write_b128 v8, a[40:43] offset:3072
    v_mfma_f32_16x16x32_bf16 a[84:87], v[68:71], v[212:215], a[84:87]
    ds_write_b128 v8, a[8:11] offset:4096
    v_mfma_f32_16x16x32_bf16 a[88:91], v[68:71], v[216:219], a[88:91]
    ds_write_b128 v8, a[44:47] offset:5120
    v_mfma_f32_16x16x32_bf16 a[92:95], v[68:71], v[220:223], a[92:95]
    ds_write_b128 v8, a[12:15] offset:6144
    v_mfma_f32_16x16x32_bf16 a[96:99], v[68:71], v[224:227], a[96:99]
    ds_write_b128 v8, a[48:51] offset:7168
    v_mfma_f32_16x16x32_bf16 a[100:103], v[68:71], v[228:231], a[100:103]
    ds_write_b128 v8, a[16:19] offset:8192
    v_mfma_f32_16x16x32_bf16 a[104:107], v[68:71], v[232:235], a[104:107]
    ds_write_b128 v8, a[52:55] offset:9216
    v_mfma_f32_16x16x32_bf16 a[108:111], v[72:75], v[200:203], a[108:111]
    ds_write_b128 v8, a[20:23] offset:10240
    v_mfma_f32_16x16x32_bf16 a[112:115], v[72:75], v[204:207], a[112:115]
    ds_write_b128 v8, a[56:59] offset:11264
    v_mfma_f32_16x16x32_bf16 a[116:119], v[72:75], v[208:211], a[116:119]
    ds_write_b128 v8, a[24:27] offset:12288
    v_mfma_f32_16x16x32_bf16 a[120:123], v[72:75], v[212:215], a[120:123]
    ds_write_b128 v8, a[60:63] offset:13312
    v_mfma_f32_16x16x32_bf16 a[124:127], v[72:75], v[216:219], a[124:127]
    ds_write_b128 v8, a[28:31] offset:14336
    v_mfma_f32_16x16x32_bf16 a[128:131], v[72:75], v[220:223], a[128:131]
    ds_write_b128 v8, a[64:67] offset:15360
    v_mfma_f32_16x16x32_bf16 a[132:135], v[72:75], v[224:227], a[132:135]
    ds_write_b128 v8, a[32:35] offset:16384
    v_mfma_f32_16x16x32_bf16 a[136:139], v[72:75], v[228:231], a[136:139]
    ds_write_b128 v8, a[68:71] offset:17408
    v_mfma_f32_16x16x32_bf16 a[140:143], v[72:75], v[232:235], a[140:143]
    ds_write_b128 v8, a[72:75] offset:18432
    v_mfma_f32_16x16x32_bf16 a[144:147], v[76:79], v[200:203], a[144:147]
    ds_write_b128 v8, a[108:111] offset:19456
    v_mfma_f32_16x16x32_bf16 a[148:151], v[76:79], v[204:207], a[148:151]
    ds_write_b128 v8, a[76:79] offset:20480
    v_mfma_f32_16x16x32_bf16 a[152:155], v[76:79], v[208:211], a[152:155]
    ds_write_b128 v8, a[112:115] offset:21504
    v_mfma_f32_16x16x32_bf16 a[156:159], v[76:79], v[212:215], a[156:159]
    ds_write_b128 v8, a[80:83] offset:22528
    v_mfma_f32_16x16x32_bf16 a[160:163], v[76:79], v[216:219], a[160:163]
    ds_write_b128 v8, a[116:119] offset:23552
    v_mfma_f32_16x16x32_bf16 a[164:167], v[76:79], v[220:223], a[164:167]
    ds_write_b128 v8, a[84:87] offset:24576
    v_mfma_f32_16x16x32_bf16 a[168:171], v[76:79], v[224:227], a[168:171]
    ds_write_b128 v8, a[120:123] offset:25600
    v_mfma_f32_16x16x32_bf16 a[172:175], v[76:79], v[228:231], a[172:175]
    ds_write_b128 v8, a[88:91] offset:26624
    v_mfma_f32_16x16x32_bf16 a[176:179], v[76:79], v[232:235], a[176:179]
    ds_write_b128 v8, a[124:127] offset:27648
    v_mfma_f32_16x16x32_bf16 a[180:183], v[80:83], v[200:203], a[180:183]
    ds_write_b128 v8, a[92:95] offset:28672
    v_mfma_f32_16x16x32_bf16 a[184:187], v[80:83], v[204:207], a[184:187]
    ds_write_b128 v8, a[128:131] offset:29696
    v_mfma_f32_16x16x32_bf16 a[188:191], v[80:83], v[208:211], a[188:191]
    ds_write_b128 v8, a[96:99] offset:30720
    v_mfma_f32_16x16x32_bf16 a[192:195], v[80:83], v[212:215], a[192:195]
    ds_write_b128 v8, a[132:135] offset:31744
    v_mfma_f32_16x16x32_bf16 a[196:199], v[80:83], v[216:219], a[196:199]
    ds_write_b128 v8, a[100:103] offset:32768
    v_mfma_f32_16x16x32_bf16 a[200:203], v[80:83], v[220:223], a[200:203]
    ds_write_b128 v8, a[136:139] offset:33792
    v_mfma_f32_16x16x32_bf16 a[204:207], v[80:83], v[224:227], a[204:207]
    ds_write_b128 v8, a[104:107] offset:34816
    v_mfma_f32_16x16x32_bf16 a[208:211], v[80:83], v[228:231], a[208:211]
    ds_write_b128 v8, a[140:143] offset:35840
    v_mfma_f32_16x16x32_bf16 a[212:215], v[80:83], v[232:235], a[212:215]
    ds_write_b128 v8, a[144:147] offset:36864
    v_mfma_f32_16x16x32_bf16 a[216:219], v[84:87], v[200:203], a[216:219]
    ds_write_b128 v8, a[180:183] offset:37888
    v_mfma_f32_16x16x32_bf16 a[220:223], v[84:87], v[204:207], a[220:223]
    ds_write_b128 v8, a[148:151] offset:38912
    v_mfma_f32_16x16x32_bf16 a[224:227], v[84:87], v[208:211], a[224:227]
    ds_write_b128 v8, a[184:187] offset:39936
    v_mfma_f32_16x16x32_bf16 a[228:231], v[84:87], v[212:215], a[228:231]
    v_mfma_f32_16x16x32_bf16 a[232:235], v[84:87], v[216:219], a[232:235]
    v_mfma_f32_16x16x32_bf16 a[236:239], v[84:87], v[220:223], a[236:239]
    v_mfma_f32_16x16x32_bf16 a[240:243], v[84:87], v[224:227], a[240:243]
    v_mfma_f32_16x16x32_bf16 a[244:247], v[84:87], v[228:231], a[244:247]
    v_mfma_f32_16x16x32_bf16 a[248:251], v[84:87], v[232:235], a[248:251]
    v_mfma_f32_16x16x32_bf16 a[252:255], v[88:91], v[200:203], a[252:255]
    v_mfma_f32_16x16x32_bf16 v[28:31], v[88:91], v[204:207], v[28:31]
    v_mfma_f32_16x16x32_bf16 v[32:35], v[88:91], v[208:211], v[32:35]
    v_mfma_f32_16x16x32_bf16 v[36:39], v[88:91], v[212:215], v[36:39]
    v_mfma_f32_16x16x32_bf16 v[40:43], v[88:91], v[216:219], v[40:43]
    v_mfma_f32_16x16x32_bf16 v[44:47], v[88:91], v[220:223], v[44:47]
    v_mfma_f32_16x16x32_bf16 v[48:51], v[88:91], v[224:227], v[48:51]
    v_mfma_f32_16x16x32_bf16 v[52:55], v[88:91], v[228:231], v[52:55]
    v_mfma_f32_16x16x32_bf16 v[56:59], v[88:91], v[232:235], v[56:59]
    s_waitcnt lgkmcnt(0)
    s_barrier
    ds_read_b128 v[60:63], v2 offset:0
    ds_read_b128 v[64:67], v2 offset:1024
    ds_read_b128 v[68:71], v3 offset:0
    ds_read_b128 v[72:75], v3 offset:1024
    ds_read_b128 v[76:79], v4 offset:0
    ds_read_b128 v[80:83], v4 offset:1024
    ds_read_b128 v[84:87], v5 offset:0
    ds_read_b128 v[88:91], v5 offset:1024
    ds_read_b128 v[92:95], v2 offset:8192
    ds_read_b128 v[96:99], v2 offset:9216
    ds_read_b128 v[100:103], v3 offset:8192
    ds_read_b128 v[104:107], v3 offset:9216
    ds_read_b128 v[108:111], v4 offset:8192
    ds_read_b128 v[112:115], v4 offset:9216
    ds_read_b128 v[116:119], v5 offset:8192
    ds_read_b128 v[120:123], v5 offset:9216
    ds_read_b128 v[124:127], v2 offset:16384
    ds_read_b128 v[128:131], v2 offset:17408
    ds_read_b128 v[132:135], v3 offset:16384
    ds_read_b128 v[136:139], v3 offset:17408
    ds_read_b128 v[140:143], v4 offset:16384
    ds_read_b128 v[144:147], v4 offset:17408
    ds_read_b128 v[148:151], v5 offset:16384
    ds_read_b128 v[152:155], v5 offset:17408
    ds_read_b128 v[156:159], v2 offset:24576
    ds_read_b128 v[160:163], v2 offset:25600
    ds_read_b128 v[164:167], v3 offset:24576
    ds_read_b128 v[168:171], v3 offset:25600
    ds_read_b128 v[172:175], v4 offset:24576
    ds_read_b128 v[176:179], v4 offset:25600
    ds_read_b128 v[180:183], v5 offset:24576
    ds_read_b128 v[184:187], v5 offset:25600
    ds_read_b128 v[188:191], v2 offset:32768
    ds_read_b128 v[192:195], v2 offset:33792
    ds_read_b128 v[196:199], v3 offset:32768
    ds_read_b128 v[200:203], v3 offset:33792
    ds_read_b128 v[204:207], v4 offset:32768
    ds_read_b128 v[208:211], v4 offset:33792
    ds_read_b128 v[212:215], v5 offset:32768
    ds_read_b128 v[216:219], v5 offset:33792
    s_waitcnt lgkmcnt(0)
    s_barrier
    ds_write_b128 v8, a[152:155] offset:0
    v_pk_add_f32 v[60:61], v[60:61], v[68:69]
    v_pk_add_f32 v[76:77], v[76:77], v[84:85]
    v_pk_add_f32 v[62:63], v[62:63], v[70:71]
    v_pk_add_f32 v[78:79], v[78:79], v[86:87]
    v_pk_add_f32 v[64:65], v[64:65], v[72:73]
    ds_write_b128 v8, a[188:191] offset:1024
    v_pk_add_f32 v[80:81], v[80:81], v[88:89]
    v_pk_add_f32 v[66:67], v[66:67], v[74:75]
    v_pk_add_f32 v[82:83], v[82:83], v[90:91]
    v_pk_add_f32 v[60:61], v[60:61], v[76:77]
    v_pk_add_f32 v[62:63], v[62:63], v[78:79]
    ds_write_b128 v8, a[156:159] offset:2048
    v_pk_add_f32 v[64:65], v[64:65], v[80:81]
    v_pk_add_f32 v[66:67], v[66:67], v[82:83]
    v_cvt_pk_bf16_f32 v68, v60, v61
    v_cvt_pk_bf16_f32 v69, v62, v63
    v_cvt_pk_bf16_f32 v70, v64, v65
    ds_write_b128 v8, a[192:195] offset:3072
    v_cvt_pk_bf16_f32 v71, v66, v67
    s_add_u32 s22, s20, 0
    s_mul_i32 s23, s22, 7282
    s_lshr_b32 s23, s23, 16
    v_permlane16_swap_b32 v68, v70
    ds_write_b128 v8, a[160:163] offset:4096
    v_permlane16_swap_b32 v69, v71
    s_mul_i32 s62, s23, 9
    s_sub_u32 s22, s22, s62
    s_mul_i32 s62, s22, 40960
    s_lshl_b32 s23, s23, 6
    ds_write_b128 v8, a[196:199] offset:5120
    s_add_u32 s62, s62, s23
    s_add_u32 s62, s62, s24
    s_add_u32 s22, s22, s31
    s_cmp_ge_u32 s22, 224
    s_cselect_b32 s23, 0x40000000, 0
    ds_write_b128 v8, a[164:167] offset:6144
    s_add_u32 s62, s62, s23
    buffer_store_dwordx4 v[68:71], v9, s[12:15], s62 offen sc0 sc1
    v_pk_add_f32 v[92:93], v[92:93], v[100:101]
    v_pk_add_f32 v[108:109], v[108:109], v[116:117]
    v_pk_add_f32 v[94:95], v[94:95], v[102:103]
    ds_write_b128 v8, a[200:203] offset:7168
    v_pk_add_f32 v[110:111], v[110:111], v[118:119]
    v_pk_add_f32 v[96:97], v[96:97], v[104:105]
    v_pk_add_f32 v[112:113], v[112:113], v[120:121]
    v_pk_add_f32 v[98:99], v[98:99], v[106:107]
    v_pk_add_f32 v[114:115], v[114:115], v[122:123]
    ds_write_b128 v8, a[168:171] offset:8192
    v_pk_add_f32 v[92:93], v[92:93], v[108:109]
    v_pk_add_f32 v[94:95], v[94:95], v[110:111]
    v_pk_add_f32 v[96:97], v[96:97], v[112:113]
    v_pk_add_f32 v[98:99], v[98:99], v[114:115]
    v_cvt_pk_bf16_f32 v100, v92, v93
    ds_write_b128 v8, a[204:207] offset:9216
    v_cvt_pk_bf16_f32 v101, v94, v95
    v_cvt_pk_bf16_f32 v102, v96, v97
    v_cvt_pk_bf16_f32 v103, v98, v99
    s_add_u32 s22, s20, 4
    s_mul_i32 s23, s22, 7282
    ds_write_b128 v8, a[172:175] offset:10240
    s_lshr_b32 s23, s23, 16
    v_permlane16_swap_b32 v100, v102
    v_permlane16_swap_b32 v101, v103
    s_mul_i32 s62, s23, 9
    s_sub_u32 s22, s22, s62
    ds_write_b128 v8, a[208:211] offset:11264
    s_mul_i32 s62, s22, 40960
    s_lshl_b32 s23, s23, 6
    s_add_u32 s62, s62, s23
    s_add_u32 s62, s62, s24
    s_add_u32 s22, s22, s31
    ds_write_b128 v8, a[176:179] offset:12288
    s_cmp_ge_u32 s22, 224
    s_cselect_b32 s23, 0x40000000, 0
    s_add_u32 s62, s62, s23
    buffer_store_dwordx4 v[100:103], v9, s[12:15], s62 offen sc0 sc1
    v_pk_add_f32 v[124:125], v[124:125], v[132:133]
    ds_write_b128 v8, a[212:215] offset:13312
    v_pk_add_f32 v[140:141], v[140:141], v[148:149]
    v_pk_add_f32 v[126:127], v[126:127], v[134:135]
    v_pk_add_f32 v[142:143], v[142:143], v[150:151]
    v_pk_add_f32 v[128:129], v[128:129], v[136:137]
    v_pk_add_f32 v[144:145], v[144:145], v[152:153]
    ds_write_b128 v8, a[216:219] offset:14336
    v_pk_add_f32 v[130:131], v[130:131], v[138:139]
    v_pk_add_f32 v[146:147], v[146:147], v[154:155]
    v_pk_add_f32 v[124:125], v[124:125], v[140:141]
    v_pk_add_f32 v[126:127], v[126:127], v[142:143]
    v_pk_add_f32 v[128:129], v[128:129], v[144:145]
    ds_write_b128 v8, a[252:255] offset:15360
    v_pk_add_f32 v[130:131], v[130:131], v[146:147]
    v_cvt_pk_bf16_f32 v132, v124, v125
    v_cvt_pk_bf16_f32 v133, v126, v127
    v_cvt_pk_bf16_f32 v134, v128, v129
    v_cvt_pk_bf16_f32 v135, v130, v131
    ds_write_b128 v8, a[220:223] offset:16384
    s_add_u32 s22, s20, 8
    s_mul_i32 s23, s22, 7282
    s_lshr_b32 s23, s23, 16
    v_permlane16_swap_b32 v132, v134
    v_permlane16_swap_b32 v133, v135
    ds_write_b128 v8, v[28:31] offset:17408
    s_mul_i32 s62, s23, 9
    s_sub_u32 s22, s22, s62
    s_mul_i32 s62, s22, 40960
    s_lshl_b32 s23, s23, 6
    s_add_u32 s62, s62, s23
    ds_write_b128 v8, a[224:227] offset:18432
    s_add_u32 s62, s62, s24
    s_add_u32 s22, s22, s31
    s_cmp_ge_u32 s22, 224
    s_cselect_b32 s23, 0x40000000, 0
    s_add_u32 s62, s62, s23
    ds_write_b128 v8, v[32:35] offset:19456
    buffer_store_dwordx4 v[132:135], v9, s[12:15], s62 offen sc0 sc1
    v_pk_add_f32 v[156:157], v[156:157], v[164:165]
    v_pk_add_f32 v[172:173], v[172:173], v[180:181]
    v_pk_add_f32 v[158:159], v[158:159], v[166:167]
    v_pk_add_f32 v[174:175], v[174:175], v[182:183]
    ds_write_b128 v8, a[228:231] offset:20480
    v_pk_add_f32 v[160:161], v[160:161], v[168:169]
    v_pk_add_f32 v[176:177], v[176:177], v[184:185]
    v_pk_add_f32 v[162:163], v[162:163], v[170:171]
    v_pk_add_f32 v[178:179], v[178:179], v[186:187]
    v_pk_add_f32 v[156:157], v[156:157], v[172:173]
    ds_write_b128 v8, v[36:39] offset:21504
    v_pk_add_f32 v[158:159], v[158:159], v[174:175]
    v_pk_add_f32 v[160:161], v[160:161], v[176:177]
    v_pk_add_f32 v[162:163], v[162:163], v[178:179]
    v_cvt_pk_bf16_f32 v164, v156, v157
    v_cvt_pk_bf16_f32 v165, v158, v159
    ds_write_b128 v8, a[232:235] offset:22528
    v_cvt_pk_bf16_f32 v166, v160, v161
    v_cvt_pk_bf16_f32 v167, v162, v163
    s_add_u32 s22, s20, 12
    s_mul_i32 s23, s22, 7282
    s_lshr_b32 s23, s23, 16
    ds_write_b128 v8, v[40:43] offset:23552
    v_permlane16_swap_b32 v164, v166
    v_permlane16_swap_b32 v165, v167
    s_mul_i32 s62, s23, 9
    s_sub_u32 s22, s22, s62
    s_mul_i32 s62, s22, 40960
    ds_write_b128 v8, a[236:239] offset:24576
    s_lshl_b32 s23, s23, 6
    s_add_u32 s62, s62, s23
    s_add_u32 s62, s62, s24
    s_add_u32 s22, s22, s31
    s_cmp_ge_u32 s22, 224
    ds_write_b128 v8, v[44:47] offset:25600
    s_cselect_b32 s23, 0x40000000, 0
    s_add_u32 s62, s62, s23
    buffer_store_dwordx4 v[164:167], v9, s[12:15], s62 offen sc0 sc1
    v_pk_add_f32 v[188:189], v[188:189], v[196:197]
    v_pk_add_f32 v[204:205], v[204:205], v[212:213]
    ds_write_b128 v8, a[240:243] offset:26624
    v_pk_add_f32 v[190:191], v[190:191], v[198:199]
    v_pk_add_f32 v[206:207], v[206:207], v[214:215]
    v_pk_add_f32 v[192:193], v[192:193], v[200:201]
    v_pk_add_f32 v[208:209], v[208:209], v[216:217]
    v_pk_add_f32 v[194:195], v[194:195], v[202:203]
    ds_write_b128 v8, v[48:51] offset:27648
    v_pk_add_f32 v[210:211], v[210:211], v[218:219]
    v_pk_add_f32 v[188:189], v[188:189], v[204:205]
    v_pk_add_f32 v[190:191], v[190:191], v[206:207]
    v_pk_add_f32 v[192:193], v[192:193], v[208:209]
    v_pk_add_f32 v[194:195], v[194:195], v[210:211]
    ds_write_b128 v8, a[244:247] offset:28672
    v_cvt_pk_bf16_f32 v196, v188, v189
    v_cvt_pk_bf16_f32 v197, v190, v191
    v_cvt_pk_bf16_f32 v198, v192, v193
    v_cvt_pk_bf16_f32 v199, v194, v195
    s_add_u32 s22, s20, 16
    ds_write_b128 v8, v[52:55] offset:29696
    s_mul_i32 s23, s22, 7282
    s_lshr_b32 s23, s23, 16
    v_permlane16_swap_b32 v196, v198
    v_permlane16_swap_b32 v197, v199
    s_mul_i32 s62, s23, 9
    ds_write_b128 v8, a[248:251] offset:30720
    s_sub_u32 s22, s22, s62
    s_mul_i32 s62, s22, 40960
    s_lshl_b32 s23, s23, 6
    s_add_u32 s62, s62, s23
    s_add_u32 s62, s62, s24
    ds_write_b128 v8, v[56:59] offset:31744
    s_add_u32 s22, s22, s31
    s_cmp_ge_u32 s22, 224
    s_cselect_b32 s23, 0x40000000, 0
    s_add_u32 s62, s62, s23
    buffer_store_dwordx4 v[196:199], v9, s[12:15], s62 offen sc0 sc1
    s_waitcnt lgkmcnt(0)
    s_barrier
    ds_read_b128 v[60:63], v2 offset:0
    ds_read_b128 v[64:67], v2 offset:1024
    ds_read_b128 v[68:71], v3 offset:0
    ds_read_b128 v[72:75], v3 offset:1024
    ds_read_b128 v[76:79], v4 offset:0
    ds_read_b128 v[80:83], v4 offset:1024
    ds_read_b128 v[84:87], v5 offset:0
    ds_read_b128 v[88:91], v5 offset:1024
    ds_read_b128 v[92:95], v2 offset:8192
    ds_read_b128 v[96:99], v2 offset:9216
    ds_read_b128 v[100:103], v3 offset:8192
    ds_read_b128 v[104:107], v3 offset:9216
    ds_read_b128 v[108:111], v4 offset:8192
    ds_read_b128 v[112:115], v4 offset:9216
    ds_read_b128 v[116:119], v5 offset:8192
    ds_read_b128 v[120:123], v5 offset:9216
    ds_read_b128 v[124:127], v2 offset:16384
    ds_read_b128 v[128:131], v2 offset:17408
    ds_read_b128 v[132:135], v3 offset:16384
    ds_read_b128 v[136:139], v3 offset:17408
    ds_read_b128 v[140:143], v4 offset:16384
    ds_read_b128 v[144:147], v4 offset:17408
    ds_read_b128 v[148:151], v5 offset:16384
    ds_read_b128 v[152:155], v5 offset:17408
    ds_read_b128 v[156:159], v2 offset:24576
    ds_read_b128 v[160:163], v2 offset:25600
    ds_read_b128 v[164:167], v3 offset:24576
    ds_read_b128 v[168:171], v3 offset:25600
    ds_read_b128 v[172:175], v4 offset:24576
    ds_read_b128 v[176:179], v4 offset:25600
    ds_read_b128 v[180:183], v5 offset:24576
    ds_read_b128 v[184:187], v5 offset:25600
    s_waitcnt lgkmcnt(15)
    v_pk_add_f32 v[60:61], v[60:61], v[68:69]
    v_pk_add_f32 v[76:77], v[76:77], v[84:85]
    v_pk_add_f32 v[62:63], v[62:63], v[70:71]
    v_pk_add_f32 v[78:79], v[78:79], v[86:87]
    v_pk_add_f32 v[64:65], v[64:65], v[72:73]
    v_pk_add_f32 v[80:81], v[80:81], v[88:89]
    v_pk_add_f32 v[66:67], v[66:67], v[74:75]
    v_pk_add_f32 v[82:83], v[82:83], v[90:91]
    v_pk_add_f32 v[60:61], v[60:61], v[76:77]
    v_pk_add_f32 v[62:63], v[62:63], v[78:79]
    v_pk_add_f32 v[64:65], v[64:65], v[80:81]
    v_pk_add_f32 v[66:67], v[66:67], v[82:83]
    v_cvt_pk_bf16_f32 v68, v60, v61
    v_cvt_pk_bf16_f32 v69, v62, v63
    v_cvt_pk_bf16_f32 v70, v64, v65
    v_cvt_pk_bf16_f32 v71, v66, v67
    s_add_u32 s22, s20, 20
    s_mul_i32 s23, s22, 7282
    s_lshr_b32 s23, s23, 16
    v_permlane16_swap_b32 v68, v70
    v_permlane16_swap_b32 v69, v71
    s_mul_i32 s62, s23, 9
    s_sub_u32 s22, s22, s62
    s_mul_i32 s62, s22, 40960
    s_lshl_b32 s23, s23, 6
    s_add_u32 s62, s62, s23
    s_add_u32 s62, s62, s24
    s_add_u32 s22, s22, s31
    s_cmp_ge_u32 s22, 224
    s_cselect_b32 s23, 0x40000000, 0
    s_add_u32 s62, s62, s23
    buffer_store_dwordx4 v[68:71], v9, s[12:15], s62 offen sc0 sc1
    s_waitcnt lgkmcnt(15)
    v_pk_add_f32 v[92:93], v[92:93], v[100:101]
    v_pk_add_f32 v[108:109], v[108:109], v[116:117]
    v_pk_add_f32 v[94:95], v[94:95], v[102:103]
    v_pk_add_f32 v[110:111], v[110:111], v[118:119]
    v_pk_add_f32 v[96:97], v[96:97], v[104:105]
    v_pk_add_f32 v[112:113], v[112:113], v[120:121]
    v_pk_add_f32 v[98:99], v[98:99], v[106:107]
    v_pk_add_f32 v[114:115], v[114:115], v[122:123]
    v_pk_add_f32 v[92:93], v[92:93], v[108:109]
    v_pk_add_f32 v[94:95], v[94:95], v[110:111]
    v_pk_add_f32 v[96:97], v[96:97], v[112:113]
    v_pk_add_f32 v[98:99], v[98:99], v[114:115]
    v_cvt_pk_bf16_f32 v100, v92, v93
    v_cvt_pk_bf16_f32 v101, v94, v95
    v_cvt_pk_bf16_f32 v102, v96, v97
    v_cvt_pk_bf16_f32 v103, v98, v99
    s_add_u32 s22, s20, 24
    s_mul_i32 s23, s22, 7282
    s_lshr_b32 s23, s23, 16
    v_permlane16_swap_b32 v100, v102
    v_permlane16_swap_b32 v101, v103
    s_mul_i32 s62, s23, 9
    s_sub_u32 s22, s22, s62
    s_mul_i32 s62, s22, 40960
    s_lshl_b32 s23, s23, 6
    s_add_u32 s62, s62, s23
    s_add_u32 s62, s62, s24
    s_add_u32 s22, s22, s31
    s_cmp_ge_u32 s22, 224
    s_cselect_b32 s23, 0x40000000, 0
    s_add_u32 s62, s62, s23
    buffer_store_dwordx4 v[100:103], v9, s[12:15], s62 offen sc0 sc1
    s_waitcnt lgkmcnt(8)
    v_pk_add_f32 v[124:125], v[124:125], v[132:133]
    v_pk_add_f32 v[140:141], v[140:141], v[148:149]
    v_pk_add_f32 v[126:127], v[126:127], v[134:135]
    v_pk_add_f32 v[142:143], v[142:143], v[150:151]
    v_pk_add_f32 v[128:129], v[128:129], v[136:137]
    v_pk_add_f32 v[144:145], v[144:145], v[152:153]
    v_pk_add_f32 v[130:131], v[130:131], v[138:139]
    v_pk_add_f32 v[146:147], v[146:147], v[154:155]
    v_pk_add_f32 v[124:125], v[124:125], v[140:141]
    v_pk_add_f32 v[126:127], v[126:127], v[142:143]
    v_pk_add_f32 v[128:129], v[128:129], v[144:145]
    v_pk_add_f32 v[130:131], v[130:131], v[146:147]
    v_cvt_pk_bf16_f32 v132, v124, v125
    v_cvt_pk_bf16_f32 v133, v126, v127
    v_cvt_pk_bf16_f32 v134, v128, v129
    v_cvt_pk_bf16_f32 v135, v130, v131
    s_add_u32 s22, s20, 28
    s_mul_i32 s23, s22, 7282
    s_lshr_b32 s23, s23, 16
    v_permlane16_swap_b32 v132, v134
    v_permlane16_swap_b32 v133, v135
    s_mul_i32 s62, s23, 9
    s_sub_u32 s22, s22, s62
    s_mul_i32 s62, s22, 40960
    s_lshl_b32 s23, s23, 6
    s_add_u32 s62, s62, s23
    s_add_u32 s62, s62, s24
    s_add_u32 s22, s22, s31
    s_cmp_ge_u32 s22, 224
    s_cselect_b32 s23, 0x40000000, 0
    s_add_u32 s62, s62, s23
    buffer_store_dwordx4 v[132:135], v9, s[12:15], s62 offen sc0 sc1
    s_waitcnt lgkmcnt(0)
    v_pk_add_f32 v[156:157], v[156:157], v[164:165]
    v_pk_add_f32 v[172:173], v[172:173], v[180:181]
    v_pk_add_f32 v[158:159], v[158:159], v[166:167]
    v_pk_add_f32 v[174:175], v[174:175], v[182:183]
    v_pk_add_f32 v[160:161], v[160:161], v[168:169]
    v_pk_add_f32 v[176:177], v[176:177], v[184:185]
    v_pk_add_f32 v[162:163], v[162:163], v[170:171]
    v_pk_add_f32 v[178:179], v[178:179], v[186:187]
    v_pk_add_f32 v[156:157], v[156:157], v[172:173]
    v_pk_add_f32 v[158:159], v[158:159], v[174:175]
    v_pk_add_f32 v[160:161], v[160:161], v[176:177]
    v_pk_add_f32 v[162:163], v[162:163], v[178:179]
    v_cvt_pk_bf16_f32 v164, v156, v157
    v_cvt_pk_bf16_f32 v165, v158, v159
    v_cvt_pk_bf16_f32 v166, v160, v161
    v_cvt_pk_bf16_f32 v167, v162, v163
    s_add_u32 s22, s20, 32
    s_mul_i32 s23, s22, 7282
    s_lshr_b32 s23, s23, 16
    v_permlane16_swap_b32 v164, v166
    v_permlane16_swap_b32 v165, v167
    s_mul_i32 s62, s23, 9
    s_sub_u32 s22, s22, s62
    s_mul_i32 s62, s22, 40960
    s_lshl_b32 s23, s23, 6
    s_add_u32 s62, s62, s23
    s_add_u32 s62, s62, s24
    s_add_u32 s22, s22, s31
    s_cmp_ge_u32 s22, 224
    s_cselect_b32 s23, 0x40000000, 0
    s_add_u32 s62, s62, s23
    buffer_store_dwordx4 v[164:167], v9, s[12:15], s62 offen sc0 sc1
L_op_end:
    s_endpgm
L_code_end:
.section .rodata,"a"
.p2align 6
.amdhsa_kernel fused_kernel
  .amdhsa_next_free_vgpr 512
  .amdhsa_next_free_sgpr 102
  .amdhsa_accum_offset 256
  .amdhsa_group_segment_fixed_size 0
  .amdhsa_kernarg_size 104
  .amdhsa_user_sgpr_count 2
  .amdhsa_user_sgpr_kernarg_segment_ptr 1
  .amdhsa_system_sgpr_workgroup_id_x 1
.end_amdhsa_kernel
.p2align 6
.amdhsa_kernel op_kernel
  .amdhsa_next_free_vgpr 512
  .amdhsa_next_free_sgpr 102
  .amdhsa_accum_offset 256
  .amdhsa_group_segment_fixed_size 0
  .amdhsa_kernarg_size 104
  .amdhsa_user_sgpr_count 2
  .amdhsa_user_sgpr_kernarg_segment_ptr 1
  .amdhsa_system_sgpr_workgroup_id_x 1
.end_amdhsa_kernel
```

```asm
; @launch kernel=fused_kernel grid=(256,1,1) block=(256,1,1) lds=163840
; @launch kernel=op_kernel grid=(256,1,1) block=(256,1,1) lds=163840
.amdgcn_target "amdgcn-amd-amdhsa--gfx950"
.text
.globl fused_kernel
.p2align 8
.type fused_kernel,@function
fused_kernel:
    s_cmp_ge_u32 s2, 256
    s_cbranch_scc1 L_at_end
    s_and_b32 s3, s2, 7
    s_lshl_b32 s3, s3, 5
    s_lshr_b32 s36, s2, 6
    s_lshl_b32 s36, s36, 3
    s_or_b32 s3, s3, s36
    s_bfe_u32 s36, s2, 0x30003
    s_or_b32 s2, s3, s36
    s_load_dwordx8 s[36:43], s[0:1], 0
    s_load_dwordx8 s[56:63], s[0:1], 40
    s_load_dwordx2 s[44:45], s[0:1], 96
    s_load_dwordx2 s[84:85], s[0:1], 32
    s_load_dwordx2 s[86:87], s[0:1], 72
    s_getpc_b64 s[72:73]
L_pc0:
    v_lshlrev_b32 v105, 7, v0
    v_add_u32 v104, 0, v105
    v_min_u32 v104, L_code_end - L_pc0 - 4, v104
    v_mov_b32 v107, s73
    v_add_co_u32 v106, vcc, s72, v104
    v_addc_co_u32 v107, vcc, 0, v107, vcc
    global_load_dword v108, v[106:107], off
    v_add_u32 v104, 32768, v105
    v_min_u32 v104, L_code_end - L_pc0 - 4, v104
    v_mov_b32 v107, s73
    v_add_co_u32 v106, vcc, s72, v104
    v_addc_co_u32 v107, vcc, 0, v107, vcc
    global_load_dword v108, v[106:107], off
    v_add_u32 v104, 65536, v105
    v_min_u32 v104, L_code_end - L_pc0 - 4, v104
    v_mov_b32 v107, s73
    v_add_co_u32 v106, vcc, s72, v104
    v_addc_co_u32 v107, vcc, 0, v107, vcc
    global_load_dword v108, v[106:107], off
    v_and_b32 v1, 63, v0
    v_lshrrev_b32 v2, 6, v0
    s_nop 0
    v_readfirstlane_b32 s20, v2
    s_waitcnt lgkmcnt(0)
    s_and_b32 s48, s20, 1
    s_lshr_b32 s35, s20, 1
    s_cmp_ge_u32 s2, 128
    s_cselect_b32 s36, s56, s36
    s_cselect_b32 s37, s57, s37
    s_cselect_b32 s38, s58, s38
    s_cselect_b32 s39, s59, s39
    s_cselect_b32 s40, s60, s40
    s_cselect_b32 s41, s61, s41
    s_cselect_b32 s42, s62, s42
    s_cselect_b32 s43, s63, s43
    s_cselect_b32 s84, s86, s84
    s_cselect_b32 s85, s87, s85
    s_mov_b32 s86, 5242880
    s_mov_b32 s87, 0x20000
    s_and_b32 s28, s2, 127
    s_lshl_b32 s29, s28, 20
    s_lshl_b32 s30, s35, 18
    s_add_u32 s29, s29, s30
    s_add_u32 s38, s38, s29
    s_addc_u32 s39, s39, 0
    s_add_u32 s40, s40, s29
    s_addc_u32 s41, s41, 0
    s_sub_u32 s30, 0x100000, s30
    s_mov_b32 s8, s38
    s_mov_b32 s9, s39
    s_mov_b32 s10, s30
    s_mov_b32 s11, 0x20000
    s_cmp_eq_u32 s48, 0
    s_cselect_b32 s4, s38, s40
    s_cselect_b32 s5, s39, s41
    s_mov_b32 s6, s30
    s_mov_b32 s7, 0x20000
    s_cselect_b32 s16, s42, s36
    s_cselect_b32 s17, s43, s37
    s_mov_b32 s28, 5242880
    s_mov_b32 s29, 4587520
    s_cselect_b32 s18, s28, s29
    s_mov_b32 s19, 0x20000
    s_mov_b32 s28, 262144
    s_mov_b32 s29, 64
    s_cselect_b32 s51, s28, s29
    s_cselect_b32 s52, 512, 0
    s_cselect_b32 s46, 128, 64
    s_mov_b32 s28, 1056
    s_mov_b32 s29, 1024
    s_cselect_b32 s53, s28, s29
    s_mov_b32 s28, 0
    s_mov_b32 s29, 0
    s_cselect_b32 s88, s28, s29
    s_mov_b32 s28, 8192
    s_mov_b32 s29, 20480
    s_cselect_b32 s89, s28, s29
    s_mov_b32 s28, 16384
    s_mov_b32 s29, 40960
    s_cselect_b32 s90, s28, s29
    s_mov_b32 s28, 24576
    s_mov_b32 s29, 61440
    s_cselect_b32 s91, s28, s29
    s_mov_b32 s28, 65536
    s_mov_b32 s29, 81920
    s_cselect_b32 s92, s28, s29
    s_mov_b32 s28, 73728
    s_mov_b32 s29, 102400
    s_cselect_b32 s93, s28, s29
    s_mov_b32 s28, 81920
    s_mov_b32 s29, 122880
    s_cselect_b32 s94, s28, s29
    s_mov_b32 s28, 90112
    s_mov_b32 s29, 1073741824
    s_cselect_b32 s95, s28, s29
    s_and_b32 s28, s2, 7
    s_lshl_b32 s28, s28, 2
    s_add_u32 s28, s28, s35
    s_lshl_b32 s28, s28, 8
    s_bfe_u32 s29, s2, 262147
    s_lshl_b32 s29, s29, 1
    s_add_u32 s29, s29, s35
    s_mul_i32 s29, s29, 143360
    s_cmp_eq_u32 s48, 0
    s_cselect_b32 s55, s28, s29
    s_add_u32 s12, s44, 0
    s_addc_u32 s13, s45, 0
    s_mov_b32 s14, 127926272
    s_mov_b32 s15, 0x20000
    s_lshl_b32 s28, s2, 2
    s_add_u32 s28, s28, s35
    s_mul_i32 s24, s28, 57344
    s_mul_i32 s28, s48, 28672
    s_add_u32 s24, s24, s28
    s_add_u32 s24, s24, 58720256
    s_mov_b32 s23, -1
    s_mov_b32 s60, s42
    s_mov_b32 s61, s43
    s_mov_b32 s62, 5242880
    s_mov_b32 s63, 0x20000
    s_mov_b32 s27, 0
    s_mov_b32 s25, 0
    s_mov_b32 s68, 0
    s_mov_b32 s71, 0
    s_lshr_b32 s26, s2, 3
    s_lshr_b32 s28, s2, 1
    s_add_u32 s26, s26, s28
    s_and_b32 s26, s26, 3
    s_mul_i32 s26, s26, 5
    s_and_b32 s26, s26, 30
    s_mul_i32 s83, s51, 20
    s_and_b32 s69, s2, 1
    s_min_u32 s69, s69, 1
    s_bfe_u32 s3, s2, 0x10005
    s_xor_b32 s3, s3, 1
    s_and_b32 s69, s2, s3
    s_nop 0
    s_mov_b32 s70, s69
    s_mov_b32 s32, 0x4e800000
    s_mov_b32 s54, 0x3e0293ee
    s_lshl_b32 s28, s48, 1
    s_add_u32 s28, s28, s35
    s_mul_i32 s33, s28, 33792
    v_lshlrev_b32 v6, 4, v1
    v_lshrrev_b32 v2, 4, v1
    v_and_b32 v3, 15, v1
    v_lshlrev_b32 v4, 4, v3
    v_lshl_add_u32 v7, v2, 14, v4
    v_and_b32 v26, 7, v1
    v_lshlrev_b32 v26, 4, v26
    v_bfe_u32 v5, v1, 3, 1
    v_lshl_add_u32 v26, v5, 15, v26
    v_bfe_u32 v5, v1, 4, 1
    v_lshl_add_u32 v26, v5, 17, v26
    v_bfe_u32 v5, v1, 5, 1
    v_lshl_add_u32 v26, v5, 18, v26
    v_mul_u32_u24 v27, 1280, v3
    v_lshl_add_u32 v27, v2, 4, v27
    v_lshrrev_b32 v5, 4, v1
    v_and_b32 v27, 1, v5
    v_lshlrev_b32 v27, 1, v27
    v_lshrrev_b32 v5, 1, v5
    v_mul_u32_u24 v5, 3, v5
    v_xor_b32 v27, v27, v5
    v_and_b32 v5, 3, v1
    v_xor_b32 v27, v27, v5
    v_lshlrev_b32 v27, 4, v27
    v_lshrrev_b32 v5, 2, v1
    v_mul_u32_u24 v5, 1280, v5
    v_add_u32 v27, v27, v5
    s_cmp_eq_u32 s48, 0
    s_cselect_b64 vcc, -1, 0
    s_nop 1
    v_cndmask_b32 v26, v27, v26, vcc
    s_add_u32 s28, s48, 2
    s_mul_i32 s28, s28, 33792
    v_bfe_u32 v5, v1, 2, 2
    v_and_b32 v27, 1, v5
    v_lshlrev_b32 v27, 1, v27
    v_lshrrev_b32 v5, 1, v5
    v_mul_u32_u24 v5, 3, v5
    v_xor_b32 v27, v27, v5
    v_xor_b32 v27, v27, v2
    v_lshlrev_b32 v27, 4, v27
    v_lshl_add_u32 v27, v3, 6, v27
    v_add_u32 v27, s28, v27
    v_bfe_u32 v5, v1, 4, 1
    v_lshl_add_u32 v4, v5, 9, v4
    v_bfe_u32 v5, v1, 5, 1
    v_lshl_add_u32 v10, v5, 8, v4
    v_and_b32 v4, 7, v3
    v_lshlrev_b32 v8, 10, v4
    v_and_b32 v5, 1, v3
    v_lshl_add_u32 v8, v5, 4, v8
    v_bfe_u32 v5, v3, 1, 2
    v_lshl_add_u32 v8, v5, 6, v8
    v_lshrrev_b32 v5, 3, v3
    v_lshl_add_u32 v8, v5, 8, v8
    v_bfe_u32 v5, v1, 4, 1
    v_lshl_add_u32 v8, v5, 5, v8
    v_bfe_u32 v5, v1, 5, 1
    v_lshl_add_u32 v8, v5, 4, v8
    s_mul_i32 s28, s35, 33792
    v_add_u32 v8, s28, v8
    v_bfe_u32 v3, v1, 2, 2
    v_bfe_u32 v5, v1, 4, 1
    v_lshl_add_u32 v4, v5, 2, v3
    v_mul_u32_u24 v4, 1056, v4
    v_bfe_u32 v5, v1, 5, 1
    v_lshl_add_u32 v4, v5, 8, v4
    v_and_b32 v5, 3, v1
    v_lshl_add_u32 v4, v5, 3, v4
    v_add_u32 v11, s28, v4
    v_lshl_add_u32 v3, v2, 2, v3
    v_and_b32 v4, 7, v3
    v_mul_u32_u24 v4, 1056, v4
    v_lshrrev_b32 v5, 3, v3
    v_lshl_add_u32 v4, v5, 8, v4
    v_and_b32 v5, 3, v1
    v_lshl_add_u32 v4, v5, 3, v4
    s_add_u32 s28, s28, 67584
    v_add_u32 v9, s28, v4
    v_mov_b32 v12, 0xff800000
    v_mov_b32 v14, 0xff800000
    v_mov_b32 v16, 0xff800000
    v_mov_b32 v18, 0xff800000
    v_mov_b32 v20, 0xff800000
    v_mov_b32 v22, 0xff800000
    v_mov_b32 v24, 0xff800000
    v_mov_b32 v2, 0x3f803f80
    v_accvgpr_write_b32 a252, v2
    v_accvgpr_write_b32 a253, v2
    v_accvgpr_write_b32 a254, v2
    v_accvgpr_write_b32 a255, v2
    v_and_b32 v2, 3, v1
    v_lshlrev_b32 v2, 2, v2
    v_add_u32 v2, 76000, v2
    v_mov_b32 v3, 0
    ds_write_b32 v2, v3
    s_cmp_eq_u32 s48, 0
    s_mov_b32 s28, 784
    s_mov_b32 s29, 800
    s_cselect_b32 s96, s28, s29
    s_mov_b32 s28, 816
    s_cselect_b32 s97, s28, s29
    v_lshrrev_b32 v2, 1, v1
    v_lshlrev_b32 v2, 13, v2
    v_and_b32 v3, 1, v1
    v_lshl_add_u32 v2, v3, 7, v2
    v_lshlrev_b32 v3, 7, v1
    s_bfe_u32 s28, s2, 0x20003
    s_lshl_b32 s28, s28, 18
    s_and_b32 s29, s2, 7
    s_mul_i32 s29, s29, 17920
    s_cmp_eq_u32 s48, 0
    s_cselect_b64 vcc, -1, 0
    s_cselect_b32 s100, s28, s29
    s_add_u32 s100, s100, s55
    s_cmp_eq_u32 s48, 0
    s_mov_b32 s28, 1048576
    s_mov_b32 s29, 8192
    s_cselect_b32 s99, s28, s29
    v_cndmask_b32 v6, v3, v2, vcc
    s_mul_i32 s100, s2, 11
    s_lshr_b32 s28, s2, 5
    s_mul_i32 s28, s28, 7
    s_add_u32 s100, s100, s28
    s_lshl_b32 s28, s35, 4
    s_add_u32 s100, s100, s28
    s_and_b32 s100, s100, 31
L_at_start:
    s_mov_b32 s21, s27
    s_lshl_b32 s34, s27, 5
    s_add_u32 s31, s21, s70
    s_mul_i32 s50, s31, s52
    s_mov_b32 s101, s31
    s_add_u32 s50, s50, s55
    s_cmp_ge_u32 s31, 2
    s_cselect_b32 s28, 0x40000000, 0
    s_add_u32 s50, s50, s28
    s_mov_b32 s82, s26
    s_mul_i32 s28, s26, s51
    s_add_u32 s50, s50, s28
    s_add_u32 m0, s33, 0
    s_mov_b32 s49, s50
    s_add_u32 s28, s49, s88
    buffer_load_dwordx4 v26, s[16:19], s28 offen lds
    s_add_u32 m0, m0, s53
    s_add_u32 s28, s49, s89
    buffer_load_dwordx4 v26, s[16:19], s28 offen lds
    s_add_u32 m0, m0, s53
    s_add_u32 s28, s49, s90
    buffer_load_dwordx4 v26, s[16:19], s28 offen lds
    s_add_u32 m0, m0, s53
    s_add_u32 s28, s49, s91
    buffer_load_dwordx4 v26, s[16:19], s28 offen lds
    s_add_u32 m0, m0, s53
    s_add_u32 s28, s49, s92
    buffer_load_dwordx4 v26, s[16:19], s28 offen lds
    s_add_u32 m0, m0, s53
    s_add_u32 s28, s49, s93
    buffer_load_dwordx4 v26, s[16:19], s28 offen lds
    s_add_u32 m0, m0, s53
    s_add_u32 s28, s49, s94
    buffer_load_dwordx4 v26, s[16:19], s28 offen lds
    s_add_u32 m0, m0, s53
    s_add_u32 s28, s49, s95
    buffer_load_dwordx4 v26, s[16:19], s28 offen lds
    s_add_u32 m0, s33, 8448
    s_add_u32 s49, s50, s46
    s_lshl1_add_u32 s50, s51, s50
    s_add_u32 s82, s82, 2
    s_cmp_eq_u32 s82, 20
    s_cselect_b32 s29, s83, 0
    s_sub_u32 s50, s50, s29
    s_add_u32 s28, s49, s88
    buffer_load_dwordx4 v26, s[16:19], s28 offen lds
    s_add_u32 m0, m0, s53
    s_add_u32 s28, s49, s89
    buffer_load_dwordx4 v26, s[16:19], s28 offen lds
    s_add_u32 m0, m0, s53
    s_add_u32 s28, s49, s90
    buffer_load_dwordx4 v26, s[16:19], s28 offen lds
    s_add_u32 m0, m0, s53
    s_add_u32 s28, s49, s91
    buffer_load_dwordx4 v26, s[16:19], s28 offen lds
    s_add_u32 m0, m0, s53
    s_add_u32 s28, s49, s92
    buffer_load_dwordx4 v26, s[16:19], s28 offen lds
    s_add_u32 m0, m0, s53
    s_add_u32 s28, s49, s93
    buffer_load_dwordx4 v26, s[16:19], s28 offen lds
    s_add_u32 m0, m0, s53
    s_add_u32 s28, s49, s94
    buffer_load_dwordx4 v26, s[16:19], s28 offen lds
    s_add_u32 m0, m0, s53
    s_add_u32 s28, s49, s95
    buffer_load_dwordx4 v26, s[16:19], s28 offen lds
    s_add_u32 m0, s33, 16896
    s_mov_b32 s49, s50
    s_add_u32 s28, s49, s88
    buffer_load_dwordx4 v26, s[16:19], s28 offen lds
    s_add_u32 m0, m0, s53
    s_add_u32 s28, s49, s89
    buffer_load_dwordx4 v26, s[16:19], s28 offen lds
    s_add_u32 m0, m0, s53
    s_add_u32 s28, s49, s90
    buffer_load_dwordx4 v26, s[16:19], s28 offen lds
    s_add_u32 m0, m0, s53
    s_add_u32 s28, s49, s91
    buffer_load_dwordx4 v26, s[16:19], s28 offen lds
    s_add_u32 m0, m0, s53
    s_add_u32 s28, s49, s92
    buffer_load_dwordx4 v26, s[16:19], s28 offen lds
    s_add_u32 m0, m0, s53
    s_add_u32 s28, s49, s93
    buffer_load_dwordx4 v26, s[16:19], s28 offen lds
    s_add_u32 m0, m0, s53
    s_add_u32 s28, s49, s94
    buffer_load_dwordx4 v26, s[16:19], s28 offen lds
    s_add_u32 m0, m0, s53
    s_add_u32 s28, s49, s95
    buffer_load_dwordx4 v26, s[16:19], s28 offen lds
    s_add_u32 m0, s33, 25344
    s_add_u32 s49, s50, s46
    s_lshl1_add_u32 s50, s51, s50
    s_add_u32 s82, s82, 2
    s_cmp_eq_u32 s82, 20
    s_cselect_b32 s29, s83, 0
    s_sub_u32 s50, s50, s29
    s_add_u32 s28, s49, s88
    buffer_load_dwordx4 v26, s[16:19], s28 offen lds
    s_add_u32 m0, m0, s53
    s_add_u32 s28, s49, s89
    buffer_load_dwordx4 v26, s[16:19], s28 offen lds
    s_add_u32 m0, m0, s53
    s_add_u32 s28, s49, s90
    buffer_load_dwordx4 v26, s[16:19], s28 offen lds
    s_add_u32 m0, m0, s53
    s_add_u32 s28, s49, s91
    buffer_load_dwordx4 v26, s[16:19], s28 offen lds
    s_add_u32 m0, m0, s53
    s_add_u32 s28, s49, s92
    buffer_load_dwordx4 v26, s[16:19], s28 offen lds
    s_add_u32 m0, m0, s53
    s_add_u32 s28, s49, s93
    buffer_load_dwordx4 v26, s[16:19], s28 offen lds
    s_add_u32 m0, m0, s53
    s_add_u32 s28, s49, s94
    buffer_load_dwordx4 v26, s[16:19], s28 offen lds
    s_add_u32 m0, m0, s53
    s_add_u32 s28, s49, s95
    buffer_load_dwordx4 v26, s[16:19], s28 offen lds
    s_waitcnt vmcnt(16) lgkmcnt(0)
    s_barrier
L_at_round:
    ds_read_b64_tr_b16 v[112:113], v11 offset:0
    ds_read_b64_tr_b16 v[114:115], v11 offset:128
    ds_read_b64_tr_b16 v[116:117], v11 offset:512
    ds_read_b64_tr_b16 v[118:119], v11 offset:640
    ds_read_b64_tr_b16 v[120:121], v11 offset:32
    ds_read_b64_tr_b16 v[122:123], v11 offset:160
    ds_read_b64_tr_b16 v[124:125], v11 offset:544
    ds_read_b64_tr_b16 v[126:127], v11 offset:672
    ds_read_b64_tr_b16 v[128:129], v11 offset:64
    ds_read_b64_tr_b16 v[130:131], v11 offset:192
    ds_read_b64_tr_b16 v[132:133], v11 offset:576
    ds_read_b64_tr_b16 v[134:135], v11 offset:704
    ds_read_b64_tr_b16 v[136:137], v11 offset:96
    ds_read_b64_tr_b16 v[138:139], v11 offset:224
    ds_read_b64_tr_b16 v[140:141], v11 offset:608
    ds_read_b64_tr_b16 v[142:143], v11 offset:736
    ds_read_b128 v[28:31], v27 offset:0
    ds_read_b128 v[32:35], v27 offset:1024
    ds_read_b128 v[36:39], v27 offset:2048
    ds_read_b128 v[40:43], v27 offset:3072
    ds_read_b128 v[44:47], v27 offset:4096
    ds_read_b128 v[48:51], v27 offset:5120
    ds_read_b128 v[52:55], v27 offset:6144
    ds_read_b128 v[56:59], v27 offset:8448
    ds_read_b128 v[60:63], v27 offset:9472
    ds_read_b128 v[64:67], v27 offset:10496
    ds_read_b128 v[68:71], v27 offset:11520
    ds_read_b128 v[72:75], v27 offset:12544
    ds_read_b128 v[76:79], v27 offset:13568
    ds_read_b128 v[80:83], v27 offset:14592
    s_waitcnt lgkmcnt(0)
    s_waitcnt lgkmcnt(8)
    v_mfma_f32_16x16x32_bf16 v[144:147], v[112:115], v[28:31], 0
    s_add_u32 m0, s33, 0
    v_mfma_f32_16x16x32_bf16 v[144:147], v[116:119], v[56:59], v[144:147]
    s_mov_b32 s49, s50
    v_mfma_f32_16x16x32_bf16 v[148:151], v[112:115], v[32:35], 0
    v_mfma_f32_16x16x32_bf16 v[148:151], v[116:119], v[60:63], v[148:151]
    v_mfma_f32_16x16x32_bf16 v[152:155], v[112:115], v[36:39], 0
    v_mfma_f32_16x16x32_bf16 v[152:155], v[116:119], v[64:67], v[152:155]
    v_mfma_f32_16x16x32_bf16 v[156:159], v[112:115], v[40:43], 0
    s_cmp_eq_u32 s68, 0
    s_cbranch_scc0 L_bw1_453
    s_waitcnt vmcnt(16) lgkmcnt(0)
L_bw2_453:
    s_barrier
    s_cmp_le_u32 s21, s27
    s_cbranch_scc1 L_at_nofb_458
    s_sub_u32 s28, s21, 1
    s_cmp_eq_u32 s28, s23
    s_cbranch_scc1 L_at_nofb_458
    s_lshl_b32 s29, s28, 2
    s_add_u32 s29, s29, 76000
    v_mov_b32 v4, s29
    ds_read_b32 v4, v4
    s_waitcnt lgkmcnt(0)
    v_readfirstlane_b32 s29, v4
    s_nop 3
    s_cmp_lg_u32 s29, 0
    s_cbranch_scc1 L_at_fallback
L_at_nofb_458:
    v_mfma_f32_16x16x32_bf16 v[156:159], v[116:119], v[68:71], v[156:159]
    v_mfma_f32_16x16x32_bf16 v[160:163], v[112:115], v[44:47], 0
    v_mfma_f32_16x16x32_bf16 v[160:163], v[116:119], v[72:75], v[160:163]
    s_add_u32 s28, s49, s88
    buffer_load_dwordx4 v26, s[16:19], s28 offen lds
    v_mfma_f32_16x16x32_bf16 v[164:167], v[112:115], v[48:51], 0
    s_add_u32 m0, m0, s53
    v_mfma_f32_16x16x32_bf16 v[164:167], v[116:119], v[76:79], v[164:167]
    v_mfma_f32_16x16x32_bf16 v[168:171], v[112:115], v[52:55], 0
    v_mfma_f32_16x16x32_bf16 v[168:171], v[116:119], v[80:83], v[168:171]
    ds_read_b64_tr_b16 v[112:113], v11 offset:8448
    v_mfma_f32_16x16x32_bf16 v[172:175], v[120:123], v[28:31], 0
    ds_read_b64_tr_b16 v[114:115], v11 offset:8576
    v_mfma_f32_16x16x32_bf16 v[172:175], v[124:127], v[56:59], v[172:175]
    s_add_u32 s28, s49, s89
    buffer_load_dwordx4 v26, s[16:19], s28 offen lds
    v_mfma_f32_16x16x32_bf16 v[176:179], v[120:123], v[32:35], 0
    s_add_u32 m0, m0, s53
    ds_read_b64_tr_b16 v[116:117], v11 offset:8960
    v_mfma_f32_16x16x32_bf16 v[176:179], v[124:127], v[60:63], v[176:179]
    ds_read_b64_tr_b16 v[118:119], v11 offset:9088
    v_mfma_f32_16x16x32_bf16 v[180:183], v[120:123], v[36:39], 0
    v_mfma_f32_16x16x32_bf16 v[180:183], v[124:127], v[64:67], v[180:183]
    v_mfma_f32_16x16x32_bf16 v[184:187], v[120:123], v[40:43], 0
    v_mfma_f32_16x16x32_bf16 v[184:187], v[124:127], v[68:71], v[184:187]
    s_add_u32 s28, s49, s90
    buffer_load_dwordx4 v26, s[16:19], s28 offen lds
    v_mfma_f32_16x16x32_bf16 v[188:191], v[120:123], v[44:47], 0
    s_add_u32 m0, m0, s53
    v_mfma_f32_16x16x32_bf16 v[188:191], v[124:127], v[72:75], v[188:191]
    v_mfma_f32_16x16x32_bf16 v[192:195], v[120:123], v[48:51], 0
    v_mfma_f32_16x16x32_bf16 v[192:195], v[124:127], v[76:79], v[192:195]
    v_mfma_f32_16x16x32_bf16 v[196:199], v[120:123], v[52:55], 0
    v_mfma_f32_16x16x32_bf16 v[196:199], v[124:127], v[80:83], v[196:199]
    s_add_u32 s28, s49, s91
    buffer_load_dwordx4 v26, s[16:19], s28 offen lds
    v_mfma_f32_16x16x32_bf16 v[200:203], v[128:131], v[28:31], 0
    s_add_u32 m0, m0, s53
    ds_read_b64_tr_b16 v[120:121], v11 offset:8480
    v_mfma_f32_16x16x32_bf16 v[200:203], v[132:135], v[56:59], v[200:203]
    ds_read_b64_tr_b16 v[122:123], v11 offset:8608
    v_mfma_f32_16x16x32_bf16 v[204:207], v[128:131], v[32:35], 0
    ds_read_b64_tr_b16 v[124:125], v11 offset:8992
    v_mfma_f32_16x16x32_bf16 v[204:207], v[132:135], v[60:63], v[204:207]
    ds_read_b64_tr_b16 v[126:127], v11 offset:9120
    v_mfma_f32_16x16x32_bf16 v[208:211], v[128:131], v[36:39], 0
    v_mfma_f32_16x16x32_bf16 v[208:211], v[132:135], v[64:67], v[208:211]
    s_add_u32 s28, s49, s92
    buffer_load_dwordx4 v26, s[16:19], s28 offen lds
    v_mfma_f32_16x16x32_bf16 v[212:215], v[128:131], v[40:43], 0
    s_add_u32 m0, m0, s53
    v_mfma_f32_16x16x32_bf16 v[212:215], v[132:135], v[68:71], v[212:215]
    v_mfma_f32_16x16x32_bf16 v[216:219], v[128:131], v[44:47], 0
    v_mfma_f32_16x16x32_bf16 v[216:219], v[132:135], v[72:75], v[216:219]
    v_mfma_f32_16x16x32_bf16 v[220:223], v[128:131], v[48:51], 0
    v_mfma_f32_16x16x32_bf16 v[220:223], v[132:135], v[76:79], v[220:223]
    s_add_u32 s28, s49, s93
    buffer_load_dwordx4 v26, s[16:19], s28 offen lds
    v_mfma_f32_16x16x32_bf16 v[224:227], v[128:131], v[52:55], 0
    s_add_u32 m0, m0, s53
    v_mfma_f32_16x16x32_bf16 v[224:227], v[132:135], v[80:83], v[224:227]
    ds_read_b64_tr_b16 v[128:129], v11 offset:8512
    v_mfma_f32_16x16x32_bf16 v[228:231], v[136:139], v[28:31], 0
    ds_read_b64_tr_b16 v[130:131], v11 offset:8640
    v_mfma_f32_16x16x32_bf16 v[228:231], v[140:143], v[56:59], v[228:231]
    ds_read_b64_tr_b16 v[132:133], v11 offset:9024
    v_mfma_f32_16x16x32_bf16 v[232:235], v[136:139], v[32:35], 0
    ds_read_b64_tr_b16 v[134:135], v11 offset:9152
    v_mfma_f32_16x16x32_bf16 v[232:235], v[140:143], v[60:63], v[232:235]
    s_add_u32 s28, s49, s94
    buffer_load_dwordx4 v26, s[16:19], s28 offen lds
    v_mfma_f32_16x16x32_bf16 v[236:239], v[136:139], v[36:39], 0
    s_add_u32 m0, m0, s53
    v_mfma_f32_16x16x32_bf16 v[236:239], v[140:143], v[64:67], v[236:239]
    v_mfma_f32_16x16x32_bf16 v[240:243], v[136:139], v[40:43], 0
    v_mfma_f32_16x16x32_bf16 v[240:243], v[140:143], v[68:71], v[240:243]
    v_mfma_f32_16x16x32_bf16 v[244:247], v[136:139], v[44:47], 0
    v_mfma_f32_16x16x32_bf16 v[244:247], v[140:143], v[72:75], v[244:247]
    s_add_u32 s28, s49, s95
    buffer_load_dwordx4 v26, s[16:19], s28 offen lds
    v_mfma_f32_16x16x32_bf16 v[248:251], v[136:139], v[48:51], 0
    v_mfma_f32_16x16x32_bf16 v[248:251], v[140:143], v[76:79], v[248:251]
    v_mfma_f32_16x16x32_bf16 v[252:255], v[136:139], v[52:55], 0
    v_mfma_f32_16x16x32_bf16 v[252:255], v[140:143], v[80:83], v[252:255]
    ds_read_b64_tr_b16 v[136:137], v11 offset:8544
    ds_read_b64_tr_b16 v[138:139], v11 offset:8672
    ds_read_b64_tr_b16 v[140:141], v11 offset:9056
    ds_read_b64_tr_b16 v[142:143], v11 offset:9184
    s_waitcnt lgkmcnt(8)
    v_mfma_f32_16x16x32_bf16 a[112:115], v[112:115], v[28:31], 0
    s_add_u32 m0, s33, 8448
    v_mfma_f32_16x16x32_bf16 a[112:115], v[116:119], v[56:59], a[112:115]
    s_add_u32 s49, s50, s46
    v_mfma_f32_16x16x32_bf16 a[116:119], v[112:115], v[32:35], 0
    s_lshl1_add_u32 s50, s51, s50
    v_mfma_f32_16x16x32_bf16 a[116:119], v[116:119], v[60:63], a[116:119]
    s_add_u32 s82, s82, 2
    v_mfma_f32_16x16x32_bf16 a[120:123], v[112:115], v[36:39], 0
    s_cmp_eq_u32 s82, 20
    v_mfma_f32_16x16x32_bf16 a[120:123], v[116:119], v[64:67], a[120:123]
    s_cselect_b32 s29, s83, 0
    v_mfma_f32_16x16x32_bf16 a[124:127], v[112:115], v[40:43], 0
    s_sub_u32 s50, s50, s29
    s_cmp_eq_u32 s68, 0
    s_cbranch_scc0 L_bw1_576
    s_waitcnt vmcnt(8) lgkmcnt(0)
L_bw2_576:
    s_barrier
    ds_read_b128 a[0:3], v27 offset:16896
    v_mfma_f32_16x16x32_bf16 a[124:127], v[116:119], v[68:71], a[124:127]
    ds_read_b128 a[4:7], v27 offset:17920
    v_mfma_f32_16x16x32_bf16 a[128:131], v[112:115], v[44:47], 0
    ds_read_b128 a[8:11], v27 offset:18944
    v_mfma_f32_16x16x32_bf16 a[128:131], v[116:119], v[72:75], a[128:131]
    s_add_u32 s28, s49, s88
    buffer_load_dwordx4 v26, s[16:19], s28 offen lds
    v_mfma_f32_16x16x32_bf16 a[132:135], v[112:115], v[48:51], 0
    s_add_u32 m0, m0, s53
    ds_read_b128 a[12:15], v27 offset:19968
    v_mfma_f32_16x16x32_bf16 a[132:135], v[116:119], v[76:79], a[132:135]
    ds_read_b128 a[16:19], v27 offset:20992
    v_mfma_f32_16x16x32_bf16 a[136:139], v[112:115], v[52:55], 0
    ds_read_b128 a[20:23], v27 offset:22016
    v_mfma_f32_16x16x32_bf16 a[136:139], v[116:119], v[80:83], a[136:139]
    ds_read_b128 a[24:27], v27 offset:23040
    v_mfma_f32_16x16x32_bf16 a[140:143], v[120:123], v[28:31], 0
    ds_read_b128 a[28:31], v27 offset:25344
    v_mfma_f32_16x16x32_bf16 a[140:143], v[124:127], v[56:59], a[140:143]
    s_add_u32 s28, s49, s89
    buffer_load_dwordx4 v26, s[16:19], s28 offen lds
    v_mfma_f32_16x16x32_bf16 a[144:147], v[120:123], v[32:35], 0
    s_add_u32 m0, m0, s53
    ds_read_b128 a[32:35], v27 offset:26368
    v_mfma_f32_16x16x32_bf16 a[144:147], v[124:127], v[60:63], a[144:147]
    ds_read_b128 a[36:39], v27 offset:27392
    v_mfma_f32_16x16x32_bf16 a[148:151], v[120:123], v[36:39], 0
    ds_read_b128 a[40:43], v27 offset:28416
    v_mfma_f32_16x16x32_bf16 a[148:151], v[124:127], v[64:67], a[148:151]
    ds_read_b128 a[44:47], v27 offset:29440
    v_mfma_f32_16x16x32_bf16 a[152:155], v[120:123], v[40:43], 0
    ds_read_b128 a[48:51], v27 offset:30464
    v_mfma_f32_16x16x32_bf16 a[152:155], v[124:127], v[68:71], a[152:155]
    s_add_u32 s28, s49, s90
    buffer_load_dwordx4 v26, s[16:19], s28 offen lds
    v_mfma_f32_16x16x32_bf16 a[156:159], v[120:123], v[44:47], 0
    s_add_u32 m0, m0, s53
    ds_read_b128 a[52:55], v27 offset:31488
    v_mfma_f32_16x16x32_bf16 a[156:159], v[124:127], v[72:75], a[156:159]
    ds_read_b64_tr_b16 v[112:113], v11 offset:16896
    v_mfma_f32_16x16x32_bf16 a[160:163], v[120:123], v[48:51], 0
    ds_read_b64_tr_b16 v[114:115], v11 offset:17024
    v_mfma_f32_16x16x32_bf16 a[160:163], v[124:127], v[76:79], a[160:163]
    ds_read_b64_tr_b16 v[116:117], v11 offset:17408
    v_mfma_f32_16x16x32_bf16 a[164:167], v[120:123], v[52:55], 0
    ds_read_b64_tr_b16 v[118:119], v11 offset:17536
    v_mfma_f32_16x16x32_bf16 a[164:167], v[124:127], v[80:83], a[164:167]
    s_add_u32 s28, s49, s91
    buffer_load_dwordx4 v26, s[16:19], s28 offen lds
    v_mfma_f32_16x16x32_bf16 a[168:171], v[128:131], v[28:31], 0
    s_add_u32 m0, m0, s53
    ds_read_b64_tr_b16 v[120:121], v11 offset:16928
    v_mfma_f32_16x16x32_bf16 a[168:171], v[132:135], v[56:59], a[168:171]
    ds_read_b64_tr_b16 v[122:123], v11 offset:17056
    v_mfma_f32_16x16x32_bf16 a[172:175], v[128:131], v[32:35], 0
    ds_read_b64_tr_b16 v[124:125], v11 offset:17440
    v_mfma_f32_16x16x32_bf16 a[172:175], v[132:135], v[60:63], a[172:175]
    ds_read_b64_tr_b16 v[126:127], v11 offset:17568
    v_mfma_f32_16x16x32_bf16 a[176:179], v[128:131], v[36:39], 0
    v_mfma_f32_16x16x32_bf16 a[176:179], v[132:135], v[64:67], a[176:179]
    s_add_u32 s28, s49, s92
    buffer_load_dwordx4 v26, s[16:19], s28 offen lds
    v_mfma_f32_16x16x32_bf16 a[180:183], v[128:131], v[40:43], 0
    s_add_u32 m0, m0, s53
    v_mfma_f32_16x16x32_bf16 a[180:183], v[132:135], v[68:71], a[180:183]
    v_mfma_f32_16x16x32_bf16 a[184:187], v[128:131], v[44:47], 0
    v_mfma_f32_16x16x32_bf16 a[184:187], v[132:135], v[72:75], a[184:187]
    v_mfma_f32_16x16x32_bf16 a[188:191], v[128:131], v[48:51], 0
    v_mfma_f32_16x16x32_bf16 a[188:191], v[132:135], v[76:79], a[188:191]
    s_add_u32 s28, s49, s93
    buffer_load_dwordx4 v26, s[16:19], s28 offen lds
    v_mfma_f32_16x16x32_bf16 a[192:195], v[128:131], v[52:55], 0
    s_add_u32 m0, m0, s53
    v_mfma_f32_16x16x32_bf16 a[192:195], v[132:135], v[80:83], a[192:195]
    ds_read_b64_tr_b16 v[128:129], v11 offset:16960
    v_mfma_f32_16x16x32_bf16 a[196:199], v[136:139], v[28:31], 0
    ds_read_b64_tr_b16 v[130:131], v11 offset:17088
    v_mfma_f32_16x16x32_bf16 a[196:199], v[140:143], v[56:59], a[196:199]
    ds_read_b64_tr_b16 v[132:133], v11 offset:17472
    v_mfma_f32_16x16x32_bf16 a[200:203], v[136:139], v[32:35], 0
    ds_read_b64_tr_b16 v[134:135], v11 offset:17600
    v_mfma_f32_16x16x32_bf16 a[200:203], v[140:143], v[60:63], a[200:203]
    s_add_u32 s28, s49, s94
    buffer_load_dwordx4 v26, s[16:19], s28 offen lds
    v_mfma_f32_16x16x32_bf16 a[204:207], v[136:139], v[36:39], 0
    s_add_u32 m0, m0, s53
    v_mfma_f32_16x16x32_bf16 a[204:207], v[140:143], v[64:67], a[204:207]
    v_mfma_f32_16x16x32_bf16 a[208:211], v[136:139], v[40:43], 0
    v_mfma_f32_16x16x32_bf16 a[208:211], v[140:143], v[68:71], a[208:211]
    v_mfma_f32_16x16x32_bf16 a[212:215], v[136:139], v[44:47], 0
    v_mfma_f32_16x16x32_bf16 a[212:215], v[140:143], v[72:75], a[212:215]
    s_add_u32 s28, s49, s95
    buffer_load_dwordx4 v26, s[16:19], s28 offen lds
    v_mfma_f32_16x16x32_bf16 a[216:219], v[136:139], v[48:51], 0
    v_mfma_f32_16x16x32_bf16 a[216:219], v[140:143], v[76:79], a[216:219]
    v_mfma_f32_16x16x32_bf16 a[220:223], v[136:139], v[52:55], 0
    v_mfma_f32_16x16x32_bf16 a[220:223], v[140:143], v[80:83], a[220:223]
    ds_read_b64_tr_b16 v[136:137], v11 offset:16992
    ds_read_b64_tr_b16 v[138:139], v11 offset:17120
    ds_read_b64_tr_b16 v[140:141], v11 offset:17504
    ds_read_b64_tr_b16 v[142:143], v11 offset:17632
    s_waitcnt lgkmcnt(8)
    v_mfma_f32_16x16x32_bf16 v[144:147], v[112:115], a[0:3], v[144:147]
    s_add_u32 m0, s33, 16896
    v_mfma_f32_16x16x32_bf16 v[144:147], v[116:119], a[28:31], v[144:147]
    s_mov_b32 s49, s50
    v_mfma_f32_16x16x32_bf16 v[148:151], v[112:115], a[4:7], v[148:151]
    v_mfma_f32_16x16x32_bf16 v[148:151], v[116:119], a[32:35], v[148:151]
    v_mfma_f32_16x16x32_bf16 v[152:155], v[112:115], a[8:11], v[152:155]
    v_mfma_f32_16x16x32_bf16 v[152:155], v[116:119], a[36:39], v[152:155]
    v_mfma_f32_16x16x32_bf16 v[156:159], v[112:115], a[12:15], v[156:159]
    s_cmp_eq_u32 s68, 0
    s_cbranch_scc0 L_bw1_693
    s_waitcnt vmcnt(16) lgkmcnt(0)
L_bw2_693:
    s_barrier
    v_mfma_f32_16x16x32_bf16 v[156:159], v[116:119], a[40:43], v[156:159]
    v_mfma_f32_16x16x32_bf16 v[160:163], v[112:115], a[16:19], v[160:163]
    v_mfma_f32_16x16x32_bf16 v[160:163], v[116:119], a[44:47], v[160:163]
    s_add_u32 s28, s49, s88
    buffer_load_dwordx4 v26, s[16:19], s28 offen lds
    v_mfma_f32_16x16x32_bf16 v[164:167], v[112:115], a[20:23], v[164:167]
    s_add_u32 m0, m0, s53
    v_mfma_f32_16x16x32_bf16 v[164:167], v[116:119], a[48:51], v[164:167]
    v_mfma_f32_16x16x32_bf16 v[168:171], v[112:115], a[24:27], v[168:171]
    v_mfma_f32_16x16x32_bf16 v[168:171], v[116:119], a[52:55], v[168:171]
    ds_read_b64_tr_b16 v[112:113], v11 offset:25344
    v_mfma_f32_16x16x32_bf16 v[172:175], v[120:123], a[0:3], v[172:175]
    ds_read_b64_tr_b16 v[114:115], v11 offset:25472
    v_mfma_f32_16x16x32_bf16 v[172:175], v[124:127], a[28:31], v[172:175]
    s_add_u32 s28, s49, s89
    buffer_load_dwordx4 v26, s[16:19], s28 offen lds
    v_mfma_f32_16x16x32_bf16 v[176:179], v[120:123], a[4:7], v[176:179]
    s_add_u32 m0, m0, s53
    ds_read_b64_tr_b16 v[116:117], v11 offset:25856
    v_mfma_f32_16x16x32_bf16 v[176:179], v[124:127], a[32:35], v[176:179]
    ds_read_b64_tr_b16 v[118:119], v11 offset:25984
    v_mfma_f32_16x16x32_bf16 v[180:183], v[120:123], a[8:11], v[180:183]
    v_mfma_f32_16x16x32_bf16 v[180:183], v[124:127], a[36:39], v[180:183]
    v_mfma_f32_16x16x32_bf16 v[184:187], v[120:123], a[12:15], v[184:187]
    v_mfma_f32_16x16x32_bf16 v[184:187], v[124:127], a[40:43], v[184:187]
    s_add_u32 s28, s49, s90
    buffer_load_dwordx4 v26, s[16:19], s28 offen lds
    v_mfma_f32_16x16x32_bf16 v[188:191], v[120:123], a[16:19], v[188:191]
    s_add_u32 m0, m0, s53
    v_mfma_f32_16x16x32_bf16 v[188:191], v[124:127], a[44:47], v[188:191]
    v_mfma_f32_16x16x32_bf16 v[192:195], v[120:123], a[20:23], v[192:195]
    v_mfma_f32_16x16x32_bf16 v[192:195], v[124:127], a[48:51], v[192:195]
    v_mfma_f32_16x16x32_bf16 v[196:199], v[120:123], a[24:27], v[196:199]
    v_mfma_f32_16x16x32_bf16 v[196:199], v[124:127], a[52:55], v[196:199]
    s_add_u32 s28, s49, s91
    buffer_load_dwordx4 v26, s[16:19], s28 offen lds
    v_mfma_f32_16x16x32_bf16 v[200:203], v[128:131], a[0:3], v[200:203]
    s_add_u32 m0, m0, s53
    ds_read_b64_tr_b16 v[120:121], v11 offset:25376
    v_mfma_f32_16x16x32_bf16 v[200:203], v[132:135], a[28:31], v[200:203]
    ds_read_b64_tr_b16 v[122:123], v11 offset:25504
    v_mfma_f32_16x16x32_bf16 v[204:207], v[128:131], a[4:7], v[204:207]
    ds_read_b64_tr_b16 v[124:125], v11 offset:25888
    v_mfma_f32_16x16x32_bf16 v[204:207], v[132:135], a[32:35], v[204:207]
    ds_read_b64_tr_b16 v[126:127], v11 offset:26016
    v_mfma_f32_16x16x32_bf16 v[208:211], v[128:131], a[8:11], v[208:211]
    v_mfma_f32_16x16x32_bf16 v[208:211], v[132:135], a[36:39], v[208:211]
    s_add_u32 s28, s49, s92
    buffer_load_dwordx4 v26, s[16:19], s28 offen lds
    v_mfma_f32_16x16x32_bf16 v[212:215], v[128:131], a[12:15], v[212:215]
    s_add_u32 m0, m0, s53
    v_mfma_f32_16x16x32_bf16 v[212:215], v[132:135], a[40:43], v[212:215]
    v_mfma_f32_16x16x32_bf16 v[216:219], v[128:131], a[16:19], v[216:219]
    v_mfma_f32_16x16x32_bf16 v[216:219], v[132:135], a[44:47], v[216:219]
    v_mfma_f32_16x16x32_bf16 v[220:223], v[128:131], a[20:23], v[220:223]
    v_mfma_f32_16x16x32_bf16 v[220:223], v[132:135], a[48:51], v[220:223]
    s_add_u32 s28, s49, s93
    buffer_load_dwordx4 v26, s[16:19], s28 offen lds
    v_mfma_f32_16x16x32_bf16 v[224:227], v[128:131], a[24:27], v[224:227]
    s_add_u32 m0, m0, s53
    v_mfma_f32_16x16x32_bf16 v[224:227], v[132:135], a[52:55], v[224:227]
    ds_read_b64_tr_b16 v[128:129], v11 offset:25408
    v_mfma_f32_16x16x32_bf16 v[228:231], v[136:139], a[0:3], v[228:231]
    ds_read_b64_tr_b16 v[130:131], v11 offset:25536
    v_mfma_f32_16x16x32_bf16 v[228:231], v[140:143], a[28:31], v[228:231]
    ds_read_b64_tr_b16 v[132:133], v11 offset:25920
    v_mfma_f32_16x16x32_bf16 v[232:235], v[136:139], a[4:7], v[232:235]
    ds_read_b64_tr_b16 v[134:135], v11 offset:26048
    v_mfma_f32_16x16x32_bf16 v[232:235], v[140:143], a[32:35], v[232:235]
    s_add_u32 s28, s49, s94
    buffer_load_dwordx4 v26, s[16:19], s28 offen lds
    v_mfma_f32_16x16x32_bf16 v[236:239], v[136:139], a[8:11], v[236:239]
    s_add_u32 m0, m0, s53
    v_mfma_f32_16x16x32_bf16 v[236:239], v[140:143], a[36:39], v[236:239]
    v_mfma_f32_16x16x32_bf16 v[240:243], v[136:139], a[12:15], v[240:243]
    v_mfma_f32_16x16x32_bf16 v[240:243], v[140:143], a[40:43], v[240:243]
    v_mfma_f32_16x16x32_bf16 v[244:247], v[136:139], a[16:19], v[244:247]
    v_mfma_f32_16x16x32_bf16 v[244:247], v[140:143], a[44:47], v[244:247]
    s_add_u32 s28, s49, s95
    buffer_load_dwordx4 v26, s[16:19], s28 offen lds
    v_mfma_f32_16x16x32_bf16 v[248:251], v[136:139], a[20:23], v[248:251]
    v_mfma_f32_16x16x32_bf16 v[248:251], v[140:143], a[48:51], v[248:251]
    v_mfma_f32_16x16x32_bf16 v[252:255], v[136:139], a[24:27], v[252:255]
    v_mfma_f32_16x16x32_bf16 v[252:255], v[140:143], a[52:55], v[252:255]
    ds_read_b64_tr_b16 v[136:137], v11 offset:25440
    ds_read_b64_tr_b16 v[138:139], v11 offset:25568
    ds_read_b64_tr_b16 v[140:141], v11 offset:25952
    ds_read_b64_tr_b16 v[142:143], v11 offset:26080
    s_waitcnt lgkmcnt(8)
    v_mfma_f32_16x16x32_bf16 a[112:115], v[112:115], a[0:3], a[112:115]
    s_add_u32 m0, s33, 25344
    v_mfma_f32_16x16x32_bf16 a[112:115], v[116:119], a[28:31], a[112:115]
    s_add_u32 s49, s50, s46
    v_mfma_f32_16x16x32_bf16 a[116:119], v[112:115], a[4:7], a[116:119]
    s_lshl1_add_u32 s50, s51, s50
    v_mfma_f32_16x16x32_bf16 a[116:119], v[116:119], a[32:35], a[116:119]
    s_add_u32 s82, s82, 2
    v_mfma_f32_16x16x32_bf16 a[120:123], v[112:115], a[8:11], a[120:123]
    s_cmp_eq_u32 s82, 20
    v_mfma_f32_16x16x32_bf16 a[120:123], v[116:119], a[36:39], a[120:123]
    s_cselect_b32 s29, s83, 0
    v_mfma_f32_16x16x32_bf16 a[124:127], v[112:115], a[12:15], a[124:127]
    s_sub_u32 s50, s50, s29
    s_waitcnt vmcnt(8) lgkmcnt(0)
    s_barrier
    ds_read_b128 v[28:31], v27 offset:0
    v_mfma_f32_16x16x32_bf16 a[124:127], v[116:119], a[40:43], a[124:127]
    ds_read_b128 v[32:35], v27 offset:1024
    v_mfma_f32_16x16x32_bf16 a[128:131], v[112:115], a[16:19], a[128:131]
    ds_read_b128 v[36:39], v27 offset:2048
    v_mfma_f32_16x16x32_bf16 a[128:131], v[116:119], a[44:47], a[128:131]
    s_add_u32 s28, s49, s88
    buffer_load_dwordx4 v26, s[16:19], s28 offen lds
    v_mfma_f32_16x16x32_bf16 a[132:135], v[112:115], a[20:23], a[132:135]
    s_add_u32 m0, m0, s53
    ds_read_b128 v[40:43], v27 offset:3072
    v_mfma_f32_16x16x32_bf16 a[132:135], v[116:119], a[48:51], a[132:135]
    ds_read_b128 v[44:47], v27 offset:4096
    v_mfma_f32_16x16x32_bf16 a[136:139], v[112:115], a[24:27], a[136:139]
    ds_read_b128 v[48:51], v27 offset:5120
    v_mfma_f32_16x16x32_bf16 a[136:139], v[116:119], a[52:55], a[136:139]
    ds_read_b128 v[52:55], v27 offset:6144
    v_mfma_f32_16x16x32_bf16 a[140:143], v[120:123], a[0:3], a[140:143]
    ds_read_b128 v[56:59], v27 offset:8448
    v_mfma_f32_16x16x32_bf16 a[140:143], v[124:127], a[28:31], a[140:143]
    s_add_u32 s28, s49, s89
    buffer_load_dwordx4 v26, s[16:19], s28 offen lds
    v_mfma_f32_16x16x32_bf16 a[144:147], v[120:123], a[4:7], a[144:147]
    s_add_u32 m0, m0, s53
    ds_read_b128 v[60:63], v27 offset:9472
    v_mfma_f32_16x16x32_bf16 a[144:147], v[124:127], a[32:35], a[144:147]
    ds_read_b128 v[64:67], v27 offset:10496
    v_mfma_f32_16x16x32_bf16 a[148:151], v[120:123], a[8:11], a[148:151]
    ds_read_b128 v[68:71], v27 offset:11520
    v_mfma_f32_16x16x32_bf16 a[148:151], v[124:127], a[36:39], a[148:151]
    ds_read_b128 v[72:75], v27 offset:12544
    v_mfma_f32_16x16x32_bf16 a[152:155], v[120:123], a[12:15], a[152:155]
    ds_read_b128 v[76:79], v27 offset:13568
    v_mfma_f32_16x16x32_bf16 a[152:155], v[124:127], a[40:43], a[152:155]
    s_add_u32 s28, s49, s90
    buffer_load_dwordx4 v26, s[16:19], s28 offen lds
    v_mfma_f32_16x16x32_bf16 a[156:159], v[120:123], a[16:19], a[156:159]
    s_add_u32 m0, m0, s53
    ds_read_b128 v[80:83], v27 offset:14592
    v_mfma_f32_16x16x32_bf16 a[156:159], v[124:127], a[44:47], a[156:159]
    ds_read_b64_tr_b16 v[112:113], v11 offset:0
    v_mfma_f32_16x16x32_bf16 a[160:163], v[120:123], a[20:23], a[160:163]
    ds_read_b64_tr_b16 v[114:115], v11 offset:128
    v_mfma_f32_16x16x32_bf16 a[160:163], v[124:127], a[48:51], a[160:163]
    ds_read_b64_tr_b16 v[116:117], v11 offset:512
    v_mfma_f32_16x16x32_bf16 a[164:167], v[120:123], a[24:27], a[164:167]
    ds_read_b64_tr_b16 v[118:119], v11 offset:640
    v_mfma_f32_16x16x32_bf16 a[164:167], v[124:127], a[52:55], a[164:167]
    s_add_u32 s28, s49, s91
    buffer_load_dwordx4 v26, s[16:19], s28 offen lds
    v_mfma_f32_16x16x32_bf16 a[168:171], v[128:131], a[0:3], a[168:171]
    s_add_u32 m0, m0, s53
    ds_read_b64_tr_b16 v[120:121], v11 offset:32
    v_mfma_f32_16x16x32_bf16 a[168:171], v[132:135], a[28:31], a[168:171]
    ds_read_b64_tr_b16 v[122:123], v11 offset:160
    v_mfma_f32_16x16x32_bf16 a[172:175], v[128:131], a[4:7], a[172:175]
    ds_read_b64_tr_b16 v[124:125], v11 offset:544
    v_mfma_f32_16x16x32_bf16 a[172:175], v[132:135], a[32:35], a[172:175]
    ds_read_b64_tr_b16 v[126:127], v11 offset:672
    v_mfma_f32_16x16x32_bf16 a[176:179], v[128:131], a[8:11], a[176:179]
    v_mfma_f32_16x16x32_bf16 a[176:179], v[132:135], a[36:39], a[176:179]
    s_add_u32 s28, s49, s92
    buffer_load_dwordx4 v26, s[16:19], s28 offen lds
    v_mfma_f32_16x16x32_bf16 a[180:183], v[128:131], a[12:15], a[180:183]
    s_add_u32 m0, m0, s53
    v_mfma_f32_16x16x32_bf16 a[180:183], v[132:135], a[40:43], a[180:183]
    v_mfma_f32_16x16x32_bf16 a[184:187], v[128:131], a[16:19], a[184:187]
    v_mfma_f32_16x16x32_bf16 a[184:187], v[132:135], a[44:47], a[184:187]
    v_mfma_f32_16x16x32_bf16 a[188:191], v[128:131], a[20:23], a[188:191]
    v_mfma_f32_16x16x32_bf16 a[188:191], v[132:135], a[48:51], a[188:191]
    s_add_u32 s28, s49, s93
    buffer_load_dwordx4 v26, s[16:19], s28 offen lds
    v_mfma_f32_16x16x32_bf16 a[192:195], v[128:131], a[24:27], a[192:195]
    s_add_u32 m0, m0, s53
    v_mfma_f32_16x16x32_bf16 a[192:195], v[132:135], a[52:55], a[192:195]
    ds_read_b64_tr_b16 v[128:129], v11 offset:64
    v_mfma_f32_16x16x32_bf16 a[196:199], v[136:139], a[0:3], a[196:199]
    ds_read_b64_tr_b16 v[130:131], v11 offset:192
    v_mfma_f32_16x16x32_bf16 a[196:199], v[140:143], a[28:31], a[196:199]
    ds_read_b64_tr_b16 v[132:133], v11 offset:576
    v_mfma_f32_16x16x32_bf16 a[200:203], v[136:139], a[4:7], a[200:203]
    ds_read_b64_tr_b16 v[134:135], v11 offset:704
    v_mfma_f32_16x16x32_bf16 a[200:203], v[140:143], a[32:35], a[200:203]
    s_add_u32 s28, s49, s94
    buffer_load_dwordx4 v26, s[16:19], s28 offen lds
    v_mfma_f32_16x16x32_bf16 a[204:207], v[136:139], a[8:11], a[204:207]
    s_add_u32 m0, m0, s53
    v_mfma_f32_16x16x32_bf16 a[204:207], v[140:143], a[36:39], a[204:207]
    v_mfma_f32_16x16x32_bf16 a[208:211], v[136:139], a[12:15], a[208:211]
    v_mfma_f32_16x16x32_bf16 a[208:211], v[140:143], a[40:43], a[208:211]
    v_mfma_f32_16x16x32_bf16 a[212:215], v[136:139], a[16:19], a[212:215]
    v_mfma_f32_16x16x32_bf16 a[212:215], v[140:143], a[44:47], a[212:215]
    s_add_u32 s28, s49, s95
    buffer_load_dwordx4 v26, s[16:19], s28 offen lds
    v_mfma_f32_16x16x32_bf16 a[216:219], v[136:139], a[20:23], a[216:219]
    v_mfma_f32_16x16x32_bf16 a[216:219], v[140:143], a[48:51], a[216:219]
    v_mfma_f32_16x16x32_bf16 a[220:223], v[136:139], a[24:27], a[220:223]
    v_mfma_f32_16x16x32_bf16 a[220:223], v[140:143], a[52:55], a[220:223]
    ds_read_b64_tr_b16 v[136:137], v11 offset:96
    ds_read_b64_tr_b16 v[138:139], v11 offset:224
    ds_read_b64_tr_b16 v[140:141], v11 offset:608
    ds_read_b64_tr_b16 v[142:143], v11 offset:736
    s_mov_b32 s22, 0
L_at_qploop:
    s_waitcnt lgkmcnt(8)
    v_mfma_f32_16x16x32_bf16 v[144:147], v[112:115], v[28:31], v[144:147]
    s_add_u32 m0, s33, 0
    v_mfma_f32_16x16x32_bf16 v[144:147], v[116:119], v[56:59], v[144:147]
    s_mov_b32 s49, s50
    v_mfma_f32_16x16x32_bf16 v[148:151], v[112:115], v[32:35], v[148:151]
    v_mfma_f32_16x16x32_bf16 v[148:151], v[116:119], v[60:63], v[148:151]
    v_mfma_f32_16x16x32_bf16 v[152:155], v[112:115], v[36:39], v[152:155]
    v_mfma_f32_16x16x32_bf16 v[152:155], v[116:119], v[64:67], v[152:155]
    v_mfma_f32_16x16x32_bf16 v[156:159], v[112:115], v[40:43], v[156:159]
    s_waitcnt vmcnt(16) lgkmcnt(0)
    s_barrier
    v_mfma_f32_16x16x32_bf16 v[156:159], v[116:119], v[68:71], v[156:159]
    v_mfma_f32_16x16x32_bf16 v[160:163], v[112:115], v[44:47], v[160:163]
    v_mfma_f32_16x16x32_bf16 v[160:163], v[116:119], v[72:75], v[160:163]
    s_add_u32 s28, s49, s88
    buffer_load_dwordx4 v26, s[16:19], s28 offen lds
    v_mfma_f32_16x16x32_bf16 v[164:167], v[112:115], v[48:51], v[164:167]
    s_add_u32 m0, m0, s53
    v_mfma_f32_16x16x32_bf16 v[164:167], v[116:119], v[76:79], v[164:167]
    v_mfma_f32_16x16x32_bf16 v[168:171], v[112:115], v[52:55], v[168:171]
    v_mfma_f32_16x16x32_bf16 v[168:171], v[116:119], v[80:83], v[168:171]
    ds_read_b64_tr_b16 v[112:113], v11 offset:8448
    v_mfma_f32_16x16x32_bf16 v[172:175], v[120:123], v[28:31], v[172:175]
    ds_read_b64_tr_b16 v[114:115], v11 offset:8576
    v_mfma_f32_16x16x32_bf16 v[172:175], v[124:127], v[56:59], v[172:175]
    s_add_u32 s28, s49, s89
    buffer_load_dwordx4 v26, s[16:19], s28 offen lds
    v_mfma_f32_16x16x32_bf16 v[176:179], v[120:123], v[32:35], v[176:179]
    s_add_u32 m0, m0, s53
    ds_read_b64_tr_b16 v[116:117], v11 offset:8960
    v_mfma_f32_16x16x32_bf16 v[176:179], v[124:127], v[60:63], v[176:179]
    ds_read_b64_tr_b16 v[118:119], v11 offset:9088
    v_mfma_f32_16x16x32_bf16 v[180:183], v[120:123], v[36:39], v[180:183]
    v_mfma_f32_16x16x32_bf16 v[180:183], v[124:127], v[64:67], v[180:183]
    v_mfma_f32_16x16x32_bf16 v[184:187], v[120:123], v[40:43], v[184:187]
    v_mfma_f32_16x16x32_bf16 v[184:187], v[124:127], v[68:71], v[184:187]
    s_add_u32 s28, s49, s90
    buffer_load_dwordx4 v26, s[16:19], s28 offen lds
    v_mfma_f32_16x16x32_bf16 v[188:191], v[120:123], v[44:47], v[188:191]
    s_add_u32 m0, m0, s53
    v_mfma_f32_16x16x32_bf16 v[188:191], v[124:127], v[72:75], v[188:191]
    v_mfma_f32_16x16x32_bf16 v[192:195], v[120:123], v[48:51], v[192:195]
    v_mfma_f32_16x16x32_bf16 v[192:195], v[124:127], v[76:79], v[192:195]
    v_mfma_f32_16x16x32_bf16 v[196:199], v[120:123], v[52:55], v[196:199]
    v_mfma_f32_16x16x32_bf16 v[196:199], v[124:127], v[80:83], v[196:199]
    s_add_u32 s28, s49, s91
    buffer_load_dwordx4 v26, s[16:19], s28 offen lds
    v_mfma_f32_16x16x32_bf16 v[200:203], v[128:131], v[28:31], v[200:203]
    s_add_u32 m0, m0, s53
    ds_read_b64_tr_b16 v[120:121], v11 offset:8480
    v_mfma_f32_16x16x32_bf16 v[200:203], v[132:135], v[56:59], v[200:203]
    ds_read_b64_tr_b16 v[122:123], v11 offset:8608
    v_mfma_f32_16x16x32_bf16 v[204:207], v[128:131], v[32:35], v[204:207]
    ds_read_b64_tr_b16 v[124:125], v11 offset:8992
    v_mfma_f32_16x16x32_bf16 v[204:207], v[132:135], v[60:63], v[204:207]
    ds_read_b64_tr_b16 v[126:127], v11 offset:9120
    v_mfma_f32_16x16x32_bf16 v[208:211], v[128:131], v[36:39], v[208:211]
    v_mfma_f32_16x16x32_bf16 v[208:211], v[132:135], v[64:67], v[208:211]
    s_add_u32 s28, s49, s92
    buffer_load_dwordx4 v26, s[16:19], s28 offen lds
    v_mfma_f32_16x16x32_bf16 v[212:215], v[128:131], v[40:43], v[212:215]
    s_add_u32 m0, m0, s53
    v_mfma_f32_16x16x32_bf16 v[212:215], v[132:135], v[68:71], v[212:215]
    v_mfma_f32_16x16x32_bf16 v[216:219], v[128:131], v[44:47], v[216:219]
    v_mfma_f32_16x16x32_bf16 v[216:219], v[132:135], v[72:75], v[216:219]
    v_mfma_f32_16x16x32_bf16 v[220:223], v[128:131], v[48:51], v[220:223]
    v_mfma_f32_16x16x32_bf16 v[220:223], v[132:135], v[76:79], v[220:223]
    s_add_u32 s28, s49, s93
    buffer_load_dwordx4 v26, s[16:19], s28 offen lds
    v_mfma_f32_16x16x32_bf16 v[224:227], v[128:131], v[52:55], v[224:227]
    s_add_u32 m0, m0, s53
    v_mfma_f32_16x16x32_bf16 v[224:227], v[132:135], v[80:83], v[224:227]
    ds_read_b64_tr_b16 v[128:129], v11 offset:8512
    v_mfma_f32_16x16x32_bf16 v[228:231], v[136:139], v[28:31], v[228:231]
    ds_read_b64_tr_b16 v[130:131], v11 offset:8640
    v_mfma_f32_16x16x32_bf16 v[228:231], v[140:143], v[56:59], v[228:231]
    ds_read_b64_tr_b16 v[132:133], v11 offset:9024
    v_mfma_f32_16x16x32_bf16 v[232:235], v[136:139], v[32:35], v[232:235]
    ds_read_b64_tr_b16 v[134:135], v11 offset:9152
    v_mfma_f32_16x16x32_bf16 v[232:235], v[140:143], v[60:63], v[232:235]
    s_add_u32 s28, s49, s94
    buffer_load_dwordx4 v26, s[16:19], s28 offen lds
    v_mfma_f32_16x16x32_bf16 v[236:239], v[136:139], v[36:39], v[236:239]
    s_add_u32 m0, m0, s53
    v_mfma_f32_16x16x32_bf16 v[236:239], v[140:143], v[64:67], v[236:239]
    v_mfma_f32_16x16x32_bf16 v[240:243], v[136:139], v[40:43], v[240:243]
    v_mfma_f32_16x16x32_bf16 v[240:243], v[140:143], v[68:71], v[240:243]
    v_mfma_f32_16x16x32_bf16 v[244:247], v[136:139], v[44:47], v[244:247]
    v_mfma_f32_16x16x32_bf16 v[244:247], v[140:143], v[72:75], v[244:247]
    s_add_u32 s28, s49, s95
    buffer_load_dwordx4 v26, s[16:19], s28 offen lds
    v_mfma_f32_16x16x32_bf16 v[248:251], v[136:139], v[48:51], v[248:251]
    v_mfma_f32_16x16x32_bf16 v[248:251], v[140:143], v[76:79], v[248:251]
    v_mfma_f32_16x16x32_bf16 v[252:255], v[136:139], v[52:55], v[252:255]
    v_mfma_f32_16x16x32_bf16 v[252:255], v[140:143], v[80:83], v[252:255]
    ds_read_b64_tr_b16 v[136:137], v11 offset:8544
    ds_read_b64_tr_b16 v[138:139], v11 offset:8672
    ds_read_b64_tr_b16 v[140:141], v11 offset:9056
    ds_read_b64_tr_b16 v[142:143], v11 offset:9184
    s_waitcnt lgkmcnt(8)
    v_mfma_f32_16x16x32_bf16 a[112:115], v[112:115], v[28:31], a[112:115]
    s_add_u32 m0, s33, 8448
    v_mfma_f32_16x16x32_bf16 a[112:115], v[116:119], v[56:59], a[112:115]
    s_add_u32 s49, s50, s46
    v_mfma_f32_16x16x32_bf16 a[116:119], v[112:115], v[32:35], a[116:119]
    s_lshl1_add_u32 s50, s51, s50
    v_mfma_f32_16x16x32_bf16 a[116:119], v[116:119], v[60:63], a[116:119]
    s_add_u32 s82, s82, 2
    v_mfma_f32_16x16x32_bf16 a[120:123], v[112:115], v[36:39], a[120:123]
    s_cmp_eq_u32 s82, 20
    v_mfma_f32_16x16x32_bf16 a[120:123], v[116:119], v[64:67], a[120:123]
    s_cselect_b32 s29, s83, 0
    v_mfma_f32_16x16x32_bf16 a[124:127], v[112:115], v[40:43], a[124:127]
    s_sub_u32 s50, s50, s29
    s_waitcnt vmcnt(8) lgkmcnt(0)
    s_barrier
    ds_read_b128 a[0:3], v27 offset:16896
    v_mfma_f32_16x16x32_bf16 a[124:127], v[116:119], v[68:71], a[124:127]
    ds_read_b128 a[4:7], v27 offset:17920
    v_mfma_f32_16x16x32_bf16 a[128:131], v[112:115], v[44:47], a[128:131]
    ds_read_b128 a[8:11], v27 offset:18944
    v_mfma_f32_16x16x32_bf16 a[128:131], v[116:119], v[72:75], a[128:131]
    s_add_u32 s28, s49, s88
    buffer_load_dwordx4 v26, s[16:19], s28 offen lds
    v_mfma_f32_16x16x32_bf16 a[132:135], v[112:115], v[48:51], a[132:135]
    s_add_u32 m0, m0, s53
    ds_read_b128 a[12:15], v27 offset:19968
    v_mfma_f32_16x16x32_bf16 a[132:135], v[116:119], v[76:79], a[132:135]
    ds_read_b128 a[16:19], v27 offset:20992
    v_mfma_f32_16x16x32_bf16 a[136:139], v[112:115], v[52:55], a[136:139]
    ds_read_b128 a[20:23], v27 offset:22016
    v_mfma_f32_16x16x32_bf16 a[136:139], v[116:119], v[80:83], a[136:139]
    ds_read_b128 a[24:27], v27 offset:23040
    v_mfma_f32_16x16x32_bf16 a[140:143], v[120:123], v[28:31], a[140:143]
    ds_read_b128 a[28:31], v27 offset:25344
    v_mfma_f32_16x16x32_bf16 a[140:143], v[124:127], v[56:59], a[140:143]
    s_add_u32 s28, s49, s89
    buffer_load_dwordx4 v26, s[16:19], s28 offen lds
    v_mfma_f32_16x16x32_bf16 a[144:147], v[120:123], v[32:35], a[144:147]
    s_add_u32 m0, m0, s53
    ds_read_b128 a[32:35], v27 offset:26368
    v_mfma_f32_16x16x32_bf16 a[144:147], v[124:127], v[60:63], a[144:147]
    ds_read_b128 a[36:39], v27 offset:27392
    v_mfma_f32_16x16x32_bf16 a[148:151], v[120:123], v[36:39], a[148:151]
    ds_read_b128 a[40:43], v27 offset:28416
    v_mfma_f32_16x16x32_bf16 a[148:151], v[124:127], v[64:67], a[148:151]
    ds_read_b128 a[44:47], v27 offset:29440
    v_mfma_f32_16x16x32_bf16 a[152:155], v[120:123], v[40:43], a[152:155]
    ds_read_b128 a[48:51], v27 offset:30464
    v_mfma_f32_16x16x32_bf16 a[152:155], v[124:127], v[68:71], a[152:155]
    s_add_u32 s28, s49, s90
    buffer_load_dwordx4 v26, s[16:19], s28 offen lds
    v_mfma_f32_16x16x32_bf16 a[156:159], v[120:123], v[44:47], a[156:159]
    s_add_u32 m0, m0, s53
    ds_read_b128 a[52:55], v27 offset:31488
    v_mfma_f32_16x16x32_bf16 a[156:159], v[124:127], v[72:75], a[156:159]
    ds_read_b64_tr_b16 v[112:113], v11 offset:16896
    v_mfma_f32_16x16x32_bf16 a[160:163], v[120:123], v[48:51], a[160:163]
    ds_read_b64_tr_b16 v[114:115], v11 offset:17024
    v_mfma_f32_16x16x32_bf16 a[160:163], v[124:127], v[76:79], a[160:163]
    ds_read_b64_tr_b16 v[116:117], v11 offset:17408
    v_mfma_f32_16x16x32_bf16 a[164:167], v[120:123], v[52:55], a[164:167]
    ds_read_b64_tr_b16 v[118:119], v11 offset:17536
    v_mfma_f32_16x16x32_bf16 a[164:167], v[124:127], v[80:83], a[164:167]
    s_add_u32 s28, s49, s91
    buffer_load_dwordx4 v26, s[16:19], s28 offen lds
    v_mfma_f32_16x16x32_bf16 a[168:171], v[128:131], v[28:31], a[168:171]
    s_add_u32 m0, m0, s53
    ds_read_b64_tr_b16 v[120:121], v11 offset:16928
    v_mfma_f32_16x16x32_bf16 a[168:171], v[132:135], v[56:59], a[168:171]
    ds_read_b64_tr_b16 v[122:123], v11 offset:17056
    v_mfma_f32_16x16x32_bf16 a[172:175], v[128:131], v[32:35], a[172:175]
    ds_read_b64_tr_b16 v[124:125], v11 offset:17440
    v_mfma_f32_16x16x32_bf16 a[172:175], v[132:135], v[60:63], a[172:175]
    ds_read_b64_tr_b16 v[126:127], v11 offset:17568
    v_mfma_f32_16x16x32_bf16 a[176:179], v[128:131], v[36:39], a[176:179]
    v_mfma_f32_16x16x32_bf16 a[176:179], v[132:135], v[64:67], a[176:179]
    s_add_u32 s28, s49, s92
    buffer_load_dwordx4 v26, s[16:19], s28 offen lds
    v_mfma_f32_16x16x32_bf16 a[180:183], v[128:131], v[40:43], a[180:183]
    s_add_u32 m0, m0, s53
    v_mfma_f32_16x16x32_bf16 a[180:183], v[132:135], v[68:71], a[180:183]
    v_mfma_f32_16x16x32_bf16 a[184:187], v[128:131], v[44:47], a[184:187]
    v_mfma_f32_16x16x32_bf16 a[184:187], v[132:135], v[72:75], a[184:187]
    v_mfma_f32_16x16x32_bf16 a[188:191], v[128:131], v[48:51], a[188:191]
    v_mfma_f32_16x16x32_bf16 a[188:191], v[132:135], v[76:79], a[188:191]
    s_add_u32 s28, s49, s93
    buffer_load_dwordx4 v26, s[16:19], s28 offen lds
    v_mfma_f32_16x16x32_bf16 a[192:195], v[128:131], v[52:55], a[192:195]
    s_add_u32 m0, m0, s53
    v_mfma_f32_16x16x32_bf16 a[192:195], v[132:135], v[80:83], a[192:195]
    ds_read_b64_tr_b16 v[128:129], v11 offset:16960
    v_mfma_f32_16x16x32_bf16 a[196:199], v[136:139], v[28:31], a[196:199]
    ds_read_b64_tr_b16 v[130:131], v11 offset:17088
    v_mfma_f32_16x16x32_bf16 a[196:199], v[140:143], v[56:59], a[196:199]
    ds_read_b64_tr_b16 v[132:133], v11 offset:17472
    v_mfma_f32_16x16x32_bf16 a[200:203], v[136:139], v[32:35], a[200:203]
    ds_read_b64_tr_b16 v[134:135], v11 offset:17600
    v_mfma_f32_16x16x32_bf16 a[200:203], v[140:143], v[60:63], a[200:203]
    s_add_u32 s28, s49, s94
    buffer_load_dwordx4 v26, s[16:19], s28 offen lds
    v_mfma_f32_16x16x32_bf16 a[204:207], v[136:139], v[36:39], a[204:207]
    s_add_u32 m0, m0, s53
    v_mfma_f32_16x16x32_bf16 a[204:207], v[140:143], v[64:67], a[204:207]
    v_mfma_f32_16x16x32_bf16 a[208:211], v[136:139], v[40:43], a[208:211]
    v_mfma_f32_16x16x32_bf16 a[208:211], v[140:143], v[68:71], a[208:211]
    v_mfma_f32_16x16x32_bf16 a[212:215], v[136:139], v[44:47], a[212:215]
    v_mfma_f32_16x16x32_bf16 a[212:215], v[140:143], v[72:75], a[212:215]
    s_add_u32 s28, s49, s95
    buffer_load_dwordx4 v26, s[16:19], s28 offen lds
    v_mfma_f32_16x16x32_bf16 a[216:219], v[136:139], v[48:51], a[216:219]
    v_mfma_f32_16x16x32_bf16 a[216:219], v[140:143], v[76:79], a[216:219]
    v_mfma_f32_16x16x32_bf16 a[220:223], v[136:139], v[52:55], a[220:223]
    v_mfma_f32_16x16x32_bf16 a[220:223], v[140:143], v[80:83], a[220:223]
    ds_read_b64_tr_b16 v[136:137], v11 offset:16992
    ds_read_b64_tr_b16 v[138:139], v11 offset:17120
    ds_read_b64_tr_b16 v[140:141], v11 offset:17504
    ds_read_b64_tr_b16 v[142:143], v11 offset:17632
    s_waitcnt lgkmcnt(8)
    v_mfma_f32_16x16x32_bf16 v[144:147], v[112:115], a[0:3], v[144:147]
    s_add_u32 m0, s33, 16896
    v_mfma_f32_16x16x32_bf16 v[144:147], v[116:119], a[28:31], v[144:147]
    s_mov_b32 s49, s50
    v_mfma_f32_16x16x32_bf16 v[148:151], v[112:115], a[4:7], v[148:151]
    v_mfma_f32_16x16x32_bf16 v[148:151], v[116:119], a[32:35], v[148:151]
    v_mfma_f32_16x16x32_bf16 v[152:155], v[112:115], a[8:11], v[152:155]
    v_mfma_f32_16x16x32_bf16 v[152:155], v[116:119], a[36:39], v[152:155]
    v_mfma_f32_16x16x32_bf16 v[156:159], v[112:115], a[12:15], v[156:159]
    s_waitcnt vmcnt(16) lgkmcnt(0)
    s_barrier
    v_mfma_f32_16x16x32_bf16 v[156:159], v[116:119], a[40:43], v[156:159]
    v_mfma_f32_16x16x32_bf16 v[160:163], v[112:115], a[16:19], v[160:163]
    v_mfma_f32_16x16x32_bf16 v[160:163], v[116:119], a[44:47], v[160:163]
    s_add_u32 s28, s49, s88
    buffer_load_dwordx4 v26, s[16:19], s28 offen lds
    v_mfma_f32_16x16x32_bf16 v[164:167], v[112:115], a[20:23], v[164:167]
    s_add_u32 m0, m0, s53
    v_mfma_f32_16x16x32_bf16 v[164:167], v[116:119], a[48:51], v[164:167]
    v_mfma_f32_16x16x32_bf16 v[168:171], v[112:115], a[24:27], v[168:171]
    v_mfma_f32_16x16x32_bf16 v[168:171], v[116:119], a[52:55], v[168:171]
    ds_read_b64_tr_b16 v[112:113], v11 offset:25344
    v_mfma_f32_16x16x32_bf16 v[172:175], v[120:123], a[0:3], v[172:175]
    ds_read_b64_tr_b16 v[114:115], v11 offset:25472
    v_mfma_f32_16x16x32_bf16 v[172:175], v[124:127], a[28:31], v[172:175]
    s_add_u32 s28, s49, s89
    buffer_load_dwordx4 v26, s[16:19], s28 offen lds
    v_mfma_f32_16x16x32_bf16 v[176:179], v[120:123], a[4:7], v[176:179]
    s_add_u32 m0, m0, s53
    ds_read_b64_tr_b16 v[116:117], v11 offset:25856
    v_mfma_f32_16x16x32_bf16 v[176:179], v[124:127], a[32:35], v[176:179]
    ds_read_b64_tr_b16 v[118:119], v11 offset:25984
    v_mfma_f32_16x16x32_bf16 v[180:183], v[120:123], a[8:11], v[180:183]
    v_mfma_f32_16x16x32_bf16 v[180:183], v[124:127], a[36:39], v[180:183]
    v_mfma_f32_16x16x32_bf16 v[184:187], v[120:123], a[12:15], v[184:187]
    v_mfma_f32_16x16x32_bf16 v[184:187], v[124:127], a[40:43], v[184:187]
    s_add_u32 s28, s49, s90
    buffer_load_dwordx4 v26, s[16:19], s28 offen lds
    v_mfma_f32_16x16x32_bf16 v[188:191], v[120:123], a[16:19], v[188:191]
    s_add_u32 m0, m0, s53
    v_mfma_f32_16x16x32_bf16 v[188:191], v[124:127], a[44:47], v[188:191]
    v_mfma_f32_16x16x32_bf16 v[192:195], v[120:123], a[20:23], v[192:195]
    v_mfma_f32_16x16x32_bf16 v[192:195], v[124:127], a[48:51], v[192:195]
    v_mfma_f32_16x16x32_bf16 v[196:199], v[120:123], a[24:27], v[196:199]
    v_mfma_f32_16x16x32_bf16 v[196:199], v[124:127], a[52:55], v[196:199]
    s_add_u32 s28, s49, s91
    buffer_load_dwordx4 v26, s[16:19], s28 offen lds
    v_mfma_f32_16x16x32_bf16 v[200:203], v[128:131], a[0:3], v[200:203]
    s_add_u32 m0, m0, s53
    ds_read_b64_tr_b16 v[120:121], v11 offset:25376
    v_mfma_f32_16x16x32_bf16 v[200:203], v[132:135], a[28:31], v[200:203]
    ds_read_b64_tr_b16 v[122:123], v11 offset:25504
    v_mfma_f32_16x16x32_bf16 v[204:207], v[128:131], a[4:7], v[204:207]
    ds_read_b64_tr_b16 v[124:125], v11 offset:25888
    v_mfma_f32_16x16x32_bf16 v[204:207], v[132:135], a[32:35], v[204:207]
    ds_read_b64_tr_b16 v[126:127], v11 offset:26016
    v_mfma_f32_16x16x32_bf16 v[208:211], v[128:131], a[8:11], v[208:211]
    v_mfma_f32_16x16x32_bf16 v[208:211], v[132:135], a[36:39], v[208:211]
    s_add_u32 s28, s49, s92
    buffer_load_dwordx4 v26, s[16:19], s28 offen lds
    v_mfma_f32_16x16x32_bf16 v[212:215], v[128:131], a[12:15], v[212:215]
    s_add_u32 m0, m0, s53
    v_mfma_f32_16x16x32_bf16 v[212:215], v[132:135], a[40:43], v[212:215]
    v_mfma_f32_16x16x32_bf16 v[216:219], v[128:131], a[16:19], v[216:219]
    v_mfma_f32_16x16x32_bf16 v[216:219], v[132:135], a[44:47], v[216:219]
    v_mfma_f32_16x16x32_bf16 v[220:223], v[128:131], a[20:23], v[220:223]
    v_mfma_f32_16x16x32_bf16 v[220:223], v[132:135], a[48:51], v[220:223]
    s_add_u32 s28, s49, s93
    buffer_load_dwordx4 v26, s[16:19], s28 offen lds
    v_mfma_f32_16x16x32_bf16 v[224:227], v[128:131], a[24:27], v[224:227]
    s_add_u32 m0, m0, s53
    v_mfma_f32_16x16x32_bf16 v[224:227], v[132:135], a[52:55], v[224:227]
    ds_read_b64_tr_b16 v[128:129], v11 offset:25408
    v_mfma_f32_16x16x32_bf16 v[228:231], v[136:139], a[0:3], v[228:231]
    ds_read_b64_tr_b16 v[130:131], v11 offset:25536
    v_mfma_f32_16x16x32_bf16 v[228:231], v[140:143], a[28:31], v[228:231]
    ds_read_b64_tr_b16 v[132:133], v11 offset:25920
    v_mfma_f32_16x16x32_bf16 v[232:235], v[136:139], a[4:7], v[232:235]
    ds_read_b64_tr_b16 v[134:135], v11 offset:26048
    v_mfma_f32_16x16x32_bf16 v[232:235], v[140:143], a[32:35], v[232:235]
    s_add_u32 s28, s49, s94
    buffer_load_dwordx4 v26, s[16:19], s28 offen lds
    v_mfma_f32_16x16x32_bf16 v[236:239], v[136:139], a[8:11], v[236:239]
    s_add_u32 m0, m0, s53
    v_mfma_f32_16x16x32_bf16 v[236:239], v[140:143], a[36:39], v[236:239]
    v_mfma_f32_16x16x32_bf16 v[240:243], v[136:139], a[12:15], v[240:243]
    v_mfma_f32_16x16x32_bf16 v[240:243], v[140:143], a[40:43], v[240:243]
    v_mfma_f32_16x16x32_bf16 v[244:247], v[136:139], a[16:19], v[244:247]
    v_mfma_f32_16x16x32_bf16 v[244:247], v[140:143], a[44:47], v[244:247]
    s_add_u32 s28, s49, s95
    buffer_load_dwordx4 v26, s[16:19], s28 offen lds
    v_mfma_f32_16x16x32_bf16 v[248:251], v[136:139], a[20:23], v[248:251]
    v_mfma_f32_16x16x32_bf16 v[248:251], v[140:143], a[48:51], v[248:251]
    v_mfma_f32_16x16x32_bf16 v[252:255], v[136:139], a[24:27], v[252:255]
    v_mfma_f32_16x16x32_bf16 v[252:255], v[140:143], a[52:55], v[252:255]
    ds_read_b64_tr_b16 v[136:137], v11 offset:25440
    ds_read_b64_tr_b16 v[138:139], v11 offset:25568
    ds_read_b64_tr_b16 v[140:141], v11 offset:25952
    ds_read_b64_tr_b16 v[142:143], v11 offset:26080
    s_waitcnt lgkmcnt(8)
    v_mfma_f32_16x16x32_bf16 a[112:115], v[112:115], a[0:3], a[112:115]
    s_add_u32 m0, s33, 25344
    v_mfma_f32_16x16x32_bf16 a[112:115], v[116:119], a[28:31], a[112:115]
    s_add_u32 s49, s50, s46
    v_mfma_f32_16x16x32_bf16 a[116:119], v[112:115], a[4:7], a[116:119]
    s_lshl1_add_u32 s50, s51, s50
    v_mfma_f32_16x16x32_bf16 a[116:119], v[116:119], a[32:35], a[116:119]
    s_add_u32 s82, s82, 2
    v_mfma_f32_16x16x32_bf16 a[120:123], v[112:115], a[8:11], a[120:123]
    s_cmp_eq_u32 s82, 20
    v_mfma_f32_16x16x32_bf16 a[120:123], v[116:119], a[36:39], a[120:123]
    s_cselect_b32 s29, s83, 0
    v_mfma_f32_16x16x32_bf16 a[124:127], v[112:115], a[12:15], a[124:127]
    s_sub_u32 s50, s50, s29
    s_waitcnt vmcnt(8) lgkmcnt(0)
    s_barrier
    ds_read_b128 v[28:31], v27 offset:0
    v_mfma_f32_16x16x32_bf16 a[124:127], v[116:119], a[40:43], a[124:127]
    ds_read_b128 v[32:35], v27 offset:1024
    v_mfma_f32_16x16x32_bf16 a[128:131], v[112:115], a[16:19], a[128:131]
    ds_read_b128 v[36:39], v27 offset:2048
    v_mfma_f32_16x16x32_bf16 a[128:131], v[116:119], a[44:47], a[128:131]
    s_add_u32 s28, s49, s88
    buffer_load_dwordx4 v26, s[16:19], s28 offen lds
    v_mfma_f32_16x16x32_bf16 a[132:135], v[112:115], a[20:23], a[132:135]
    s_add_u32 m0, m0, s53
    ds_read_b128 v[40:43], v27 offset:3072
    v_mfma_f32_16x16x32_bf16 a[132:135], v[116:119], a[48:51], a[132:135]
    ds_read_b128 v[44:47], v27 offset:4096
    v_mfma_f32_16x16x32_bf16 a[136:139], v[112:115], a[24:27], a[136:139]
    ds_read_b128 v[48:51], v27 offset:5120
    v_mfma_f32_16x16x32_bf16 a[136:139], v[116:119], a[52:55], a[136:139]
    ds_read_b128 v[52:55], v27 offset:6144
    v_mfma_f32_16x16x32_bf16 a[140:143], v[120:123], a[0:3], a[140:143]
    ds_read_b128 v[56:59], v27 offset:8448
    v_mfma_f32_16x16x32_bf16 a[140:143], v[124:127], a[28:31], a[140:143]
    s_add_u32 s28, s49, s89
    buffer_load_dwordx4 v26, s[16:19], s28 offen lds
    v_mfma_f32_16x16x32_bf16 a[144:147], v[120:123], a[4:7], a[144:147]
    s_add_u32 m0, m0, s53
    ds_read_b128 v[60:63], v27 offset:9472
    v_mfma_f32_16x16x32_bf16 a[144:147], v[124:127], a[32:35], a[144:147]
    ds_read_b128 v[64:67], v27 offset:10496
    v_mfma_f32_16x16x32_bf16 a[148:151], v[120:123], a[8:11], a[148:151]
    ds_read_b128 v[68:71], v27 offset:11520
    v_mfma_f32_16x16x32_bf16 a[148:151], v[124:127], a[36:39], a[148:151]
    ds_read_b128 v[72:75], v27 offset:12544
    v_mfma_f32_16x16x32_bf16 a[152:155], v[120:123], a[12:15], a[152:155]
    ds_read_b128 v[76:79], v27 offset:13568
    v_mfma_f32_16x16x32_bf16 a[152:155], v[124:127], a[40:43], a[152:155]
    s_add_u32 s28, s49, s90
    buffer_load_dwordx4 v26, s[16:19], s28 offen lds
    v_mfma_f32_16x16x32_bf16 a[156:159], v[120:123], a[16:19], a[156:159]
    s_add_u32 m0, m0, s53
    ds_read_b128 v[80:83], v27 offset:14592
    v_mfma_f32_16x16x32_bf16 a[156:159], v[124:127], a[44:47], a[156:159]
    ds_read_b64_tr_b16 v[112:113], v11 offset:0
    v_mfma_f32_16x16x32_bf16 a[160:163], v[120:123], a[20:23], a[160:163]
    ds_read_b64_tr_b16 v[114:115], v11 offset:128
    v_mfma_f32_16x16x32_bf16 a[160:163], v[124:127], a[48:51], a[160:163]
    ds_read_b64_tr_b16 v[116:117], v11 offset:512
    v_mfma_f32_16x16x32_bf16 a[164:167], v[120:123], a[24:27], a[164:167]
    ds_read_b64_tr_b16 v[118:119], v11 offset:640
    v_mfma_f32_16x16x32_bf16 a[164:167], v[124:127], a[52:55], a[164:167]
    s_add_u32 s28, s49, s91
    buffer_load_dwordx4 v26, s[16:19], s28 offen lds
    v_mfma_f32_16x16x32_bf16 a[168:171], v[128:131], a[0:3], a[168:171]
    s_add_u32 m0, m0, s53
    ds_read_b64_tr_b16 v[120:121], v11 offset:32
    v_mfma_f32_16x16x32_bf16 a[168:171], v[132:135], a[28:31], a[168:171]
    ds_read_b64_tr_b16 v[122:123], v11 offset:160
    v_mfma_f32_16x16x32_bf16 a[172:175], v[128:131], a[4:7], a[172:175]
    ds_read_b64_tr_b16 v[124:125], v11 offset:544
    v_mfma_f32_16x16x32_bf16 a[172:175], v[132:135], a[32:35], a[172:175]
    ds_read_b64_tr_b16 v[126:127], v11 offset:672
    v_mfma_f32_16x16x32_bf16 a[176:179], v[128:131], a[8:11], a[176:179]
    v_mfma_f32_16x16x32_bf16 a[176:179], v[132:135], a[36:39], a[176:179]
    s_add_u32 s28, s49, s92
    buffer_load_dwordx4 v26, s[16:19], s28 offen lds
    v_mfma_f32_16x16x32_bf16 a[180:183], v[128:131], a[12:15], a[180:183]
    s_add_u32 m0, m0, s53
    v_mfma_f32_16x16x32_bf16 a[180:183], v[132:135], a[40:43], a[180:183]
    v_mfma_f32_16x16x32_bf16 a[184:187], v[128:131], a[16:19], a[184:187]
    v_mfma_f32_16x16x32_bf16 a[184:187], v[132:135], a[44:47], a[184:187]
    v_mfma_f32_16x16x32_bf16 a[188:191], v[128:131], a[20:23], a[188:191]
    v_mfma_f32_16x16x32_bf16 a[188:191], v[132:135], a[48:51], a[188:191]
    s_add_u32 s28, s49, s93
    buffer_load_dwordx4 v26, s[16:19], s28 offen lds
    v_mfma_f32_16x16x32_bf16 a[192:195], v[128:131], a[24:27], a[192:195]
    s_add_u32 m0, m0, s53
    v_mfma_f32_16x16x32_bf16 a[192:195], v[132:135], a[52:55], a[192:195]
    ds_read_b64_tr_b16 v[128:129], v11 offset:64
    v_mfma_f32_16x16x32_bf16 a[196:199], v[136:139], a[0:3], a[196:199]
    ds_read_b64_tr_b16 v[130:131], v11 offset:192
    v_mfma_f32_16x16x32_bf16 a[196:199], v[140:143], a[28:31], a[196:199]
    ds_read_b64_tr_b16 v[132:133], v11 offset:576
    v_mfma_f32_16x16x32_bf16 a[200:203], v[136:139], a[4:7], a[200:203]
    ds_read_b64_tr_b16 v[134:135], v11 offset:704
    v_mfma_f32_16x16x32_bf16 a[200:203], v[140:143], a[32:35], a[200:203]
    s_add_u32 s28, s49, s94
    buffer_load_dwordx4 v26, s[16:19], s28 offen lds
    v_mfma_f32_16x16x32_bf16 a[204:207], v[136:139], a[8:11], a[204:207]
    s_add_u32 m0, m0, s53
    v_mfma_f32_16x16x32_bf16 a[204:207], v[140:143], a[36:39], a[204:207]
    v_mfma_f32_16x16x32_bf16 a[208:211], v[136:139], a[12:15], a[208:211]
    v_mfma_f32_16x16x32_bf16 a[208:211], v[140:143], a[40:43], a[208:211]
    v_mfma_f32_16x16x32_bf16 a[212:215], v[136:139], a[16:19], a[212:215]
    v_mfma_f32_16x16x32_bf16 a[212:215], v[140:143], a[44:47], a[212:215]
    s_add_u32 s28, s49, s95
    buffer_load_dwordx4 v26, s[16:19], s28 offen lds
    v_mfma_f32_16x16x32_bf16 a[216:219], v[136:139], a[20:23], a[216:219]
    v_mfma_f32_16x16x32_bf16 a[216:219], v[140:143], a[48:51], a[216:219]
    v_mfma_f32_16x16x32_bf16 a[220:223], v[136:139], a[24:27], a[220:223]
    v_mfma_f32_16x16x32_bf16 a[220:223], v[140:143], a[52:55], a[220:223]
    ds_read_b64_tr_b16 v[136:137], v11 offset:96
    ds_read_b64_tr_b16 v[138:139], v11 offset:224
    ds_read_b64_tr_b16 v[140:141], v11 offset:608
    ds_read_b64_tr_b16 v[142:143], v11 offset:736
    s_add_u32 s22, s22, 1
    s_cmp_lt_u32 s22, 3
    s_cbranch_scc1 L_at_qploop
    s_cmp_lg_u32 s70, 0
    s_cbranch_scc1 L_at_qptailB
    s_waitcnt lgkmcnt(8)
    v_mfma_f32_16x16x32_bf16 v[144:147], v[112:115], v[28:31], v[144:147]
    s_add_u32 s29, s34, s100
    v_mfma_f32_16x16x32_bf16 v[144:147], v[116:119], v[56:59], v[144:147]
    s_bfe_u32 s28, s29, 0x20003
    v_mfma_f32_16x16x32_bf16 v[148:151], v[112:115], v[32:35], v[148:151]
    s_lshl_b32 s28, s28, 16
    v_mfma_f32_16x16x32_bf16 v[148:151], v[116:119], v[60:63], v[148:151]
    s_and_b32 s29, s29, 7
    v_mfma_f32_16x16x32_bf16 v[152:155], v[112:115], v[36:39], v[152:155]
    s_lshl_b32 s29, s29, 11
    v_mfma_f32_16x16x32_bf16 v[152:155], v[116:119], v[64:67], v[152:155]
    s_add_u32 s29, s28, s29
    v_mfma_f32_16x16x32_bf16 v[156:159], v[112:115], v[40:43], v[156:159]
    s_lshr_b32 s28, s34, 5
    s_waitcnt vmcnt(16) lgkmcnt(0)
    s_barrier
    v_mfma_f32_16x16x32_bf16 v[156:159], v[116:119], v[68:71], v[156:159]
    s_lshl_b32 s28, s28, 19
    v_mfma_f32_16x16x32_bf16 v[160:163], v[112:115], v[44:47], v[160:163]
    s_add_u32 s49, s28, s29
    v_mfma_f32_16x16x32_bf16 v[160:163], v[116:119], v[72:75], v[160:163]
    s_add_u32 m0, s33, 0
    v_mfma_f32_16x16x32_bf16 v[164:167], v[112:115], v[48:51], v[164:167]
    s_add_u32 s34, s34, 1
    v_mfma_f32_16x16x32_bf16 v[164:167], v[116:119], v[76:79], v[164:167]
    buffer_load_dwordx4 v7, s[4:7], s49 offen offset:0 nt lds
    v_mfma_f32_16x16x32_bf16 v[168:171], v[112:115], v[52:55], v[168:171]
    s_add_u32 m0, m0, s96
    v_mfma_f32_16x16x32_bf16 v[168:171], v[116:119], v[80:83], v[168:171]
    ds_read_b64_tr_b16 v[112:113], v11 offset:8448
    v_mfma_f32_16x16x32_bf16 v[172:175], v[120:123], v[28:31], v[172:175]
    ds_read_b64_tr_b16 v[114:115], v11 offset:8576
    v_mfma_f32_16x16x32_bf16 v[172:175], v[124:127], v[56:59], v[172:175]
    buffer_load_dwordx4 v7, s[4:7], s49 offen offset:256 nt lds
    v_mfma_f32_16x16x32_bf16 v[176:179], v[120:123], v[32:35], v[176:179]
    s_add_u32 m0, m0, s97
    ds_read_b64_tr_b16 v[116:117], v11 offset:8960
    v_mfma_f32_16x16x32_bf16 v[176:179], v[124:127], v[60:63], v[176:179]
    ds_read_b64_tr_b16 v[118:119], v11 offset:9088
    v_mfma_f32_16x16x32_bf16 v[180:183], v[120:123], v[36:39], v[180:183]
    v_mfma_f32_16x16x32_bf16 v[180:183], v[124:127], v[64:67], v[180:183]
    v_mfma_f32_16x16x32_bf16 v[184:187], v[120:123], v[40:43], v[184:187]
    v_mfma_f32_16x16x32_bf16 v[184:187], v[124:127], v[68:71], v[184:187]
    buffer_load_dwordx4 v7, s[4:7], s49 offen offset:512 nt lds
    v_mfma_f32_16x16x32_bf16 v[188:191], v[120:123], v[44:47], v[188:191]
    s_add_u32 m0, m0, s96
    v_mfma_f32_16x16x32_bf16 v[188:191], v[124:127], v[72:75], v[188:191]
    v_mfma_f32_16x16x32_bf16 v[192:195], v[120:123], v[48:51], v[192:195]
    v_mfma_f32_16x16x32_bf16 v[192:195], v[124:127], v[76:79], v[192:195]
    v_mfma_f32_16x16x32_bf16 v[196:199], v[120:123], v[52:55], v[196:199]
    v_mfma_f32_16x16x32_bf16 v[196:199], v[124:127], v[80:83], v[196:199]
    buffer_load_dwordx4 v7, s[4:7], s49 offen offset:768 nt lds
    v_mfma_f32_16x16x32_bf16 v[200:203], v[128:131], v[28:31], v[200:203]
    s_add_u32 m0, m0, s97
    ds_read_b64_tr_b16 v[120:121], v11 offset:8480
    v_mfma_f32_16x16x32_bf16 v[200:203], v[132:135], v[56:59], v[200:203]
    ds_read_b64_tr_b16 v[122:123], v11 offset:8608
    v_mfma_f32_16x16x32_bf16 v[204:207], v[128:131], v[32:35], v[204:207]
    ds_read_b64_tr_b16 v[124:125], v11 offset:8992
    v_mfma_f32_16x16x32_bf16 v[204:207], v[132:135], v[60:63], v[204:207]
    ds_read_b64_tr_b16 v[126:127], v11 offset:9120
    v_mfma_f32_16x16x32_bf16 v[208:211], v[128:131], v[36:39], v[208:211]
    v_mfma_f32_16x16x32_bf16 v[208:211], v[132:135], v[64:67], v[208:211]
    buffer_load_dwordx4 v7, s[4:7], s49 offen offset:1024 nt lds
    v_mfma_f32_16x16x32_bf16 v[212:215], v[128:131], v[40:43], v[212:215]
    s_add_u32 m0, m0, s96
    v_mfma_f32_16x16x32_bf16 v[212:215], v[132:135], v[68:71], v[212:215]
    v_mfma_f32_16x16x32_bf16 v[216:219], v[128:131], v[44:47], v[216:219]
    v_mfma_f32_16x16x32_bf16 v[216:219], v[132:135], v[72:75], v[216:219]
    v_mfma_f32_16x16x32_bf16 v[220:223], v[128:131], v[48:51], v[220:223]
    v_mfma_f32_16x16x32_bf16 v[220:223], v[132:135], v[76:79], v[220:223]
    buffer_load_dwordx4 v7, s[4:7], s49 offen offset:1280 nt lds
    v_mfma_f32_16x16x32_bf16 v[224:227], v[128:131], v[52:55], v[224:227]
    s_add_u32 m0, m0, s97
    v_mfma_f32_16x16x32_bf16 v[224:227], v[132:135], v[80:83], v[224:227]
    ds_read_b64_tr_b16 v[128:129], v11 offset:8512
    v_mfma_f32_16x16x32_bf16 v[228:231], v[136:139], v[28:31], v[228:231]
    ds_read_b64_tr_b16 v[130:131], v11 offset:8640
    v_mfma_f32_16x16x32_bf16 v[228:231], v[140:143], v[56:59], v[228:231]
    ds_read_b64_tr_b16 v[132:133], v11 offset:9024
    v_mfma_f32_16x16x32_bf16 v[232:235], v[136:139], v[32:35], v[232:235]
    ds_read_b64_tr_b16 v[134:135], v11 offset:9152
    v_mfma_f32_16x16x32_bf16 v[232:235], v[140:143], v[60:63], v[232:235]
    buffer_load_dwordx4 v7, s[4:7], s49 offen offset:1536 nt lds
    v_mfma_f32_16x16x32_bf16 v[236:239], v[136:139], v[36:39], v[236:239]
    s_add_u32 m0, m0, s96
    v_mfma_f32_16x16x32_bf16 v[236:239], v[140:143], v[64:67], v[236:239]
    v_mfma_f32_16x16x32_bf16 v[240:243], v[136:139], v[40:43], v[240:243]
    v_mfma_f32_16x16x32_bf16 v[240:243], v[140:143], v[68:71], v[240:243]
    v_mfma_f32_16x16x32_bf16 v[244:247], v[136:139], v[44:47], v[244:247]
    v_mfma_f32_16x16x32_bf16 v[244:247], v[140:143], v[72:75], v[244:247]
    buffer_load_dwordx4 v7, s[4:7], s49 offen offset:1792 nt lds
    v_mfma_f32_16x16x32_bf16 v[248:251], v[136:139], v[48:51], v[248:251]
    v_mfma_f32_16x16x32_bf16 v[248:251], v[140:143], v[76:79], v[248:251]
    v_mfma_f32_16x16x32_bf16 v[252:255], v[136:139], v[52:55], v[252:255]
    v_mfma_f32_16x16x32_bf16 v[252:255], v[140:143], v[80:83], v[252:255]
    ds_read_b64_tr_b16 v[136:137], v11 offset:8544
    ds_read_b64_tr_b16 v[138:139], v11 offset:8672
    ds_read_b64_tr_b16 v[140:141], v11 offset:9056
    ds_read_b64_tr_b16 v[142:143], v11 offset:9184
    s_waitcnt lgkmcnt(8)
    v_mfma_f32_16x16x32_bf16 a[112:115], v[112:115], v[28:31], a[112:115]
    s_add_u32 s29, s34, s100
    v_mfma_f32_16x16x32_bf16 a[112:115], v[116:119], v[56:59], a[112:115]
    s_bfe_u32 s28, s29, 0x20003
    v_mfma_f32_16x16x32_bf16 a[116:119], v[112:115], v[32:35], a[116:119]
    s_lshl_b32 s28, s28, 16
    v_mfma_f32_16x16x32_bf16 a[116:119], v[116:119], v[60:63], a[116:119]
    s_and_b32 s29, s29, 7
    v_mfma_f32_16x16x32_bf16 a[120:123], v[112:115], v[36:39], a[120:123]
    s_lshl_b32 s29, s29, 11
    v_mfma_f32_16x16x32_bf16 a[120:123], v[116:119], v[64:67], a[120:123]
    s_add_u32 s29, s28, s29
    v_mfma_f32_16x16x32_bf16 a[124:127], v[112:115], v[40:43], a[124:127]
    s_lshr_b32 s28, s34, 5
    s_waitcnt vmcnt(8) lgkmcnt(0)
    s_barrier
    ds_read_b128 a[0:3], v27 offset:16896
    v_mfma_f32_16x16x32_bf16 a[124:127], v[116:119], v[68:71], a[124:127]
    s_lshl_b32 s28, s28, 19
    ds_read_b128 a[4:7], v27 offset:17920
    v_mfma_f32_16x16x32_bf16 a[128:131], v[112:115], v[44:47], a[128:131]
    s_add_u32 s49, s28, s29
    ds_read_b128 a[8:11], v27 offset:18944
    v_mfma_f32_16x16x32_bf16 a[128:131], v[116:119], v[72:75], a[128:131]
    s_add_u32 m0, s33, 8448
    ds_read_b128 a[12:15], v27 offset:19968
    v_mfma_f32_16x16x32_bf16 a[132:135], v[112:115], v[48:51], a[132:135]
    s_add_u32 s34, s34, 1
    ds_read_b128 a[16:19], v27 offset:20992
    v_mfma_f32_16x16x32_bf16 a[132:135], v[116:119], v[76:79], a[132:135]
    buffer_load_dwordx4 v7, s[4:7], s49 offen offset:0 nt lds
    v_mfma_f32_16x16x32_bf16 a[136:139], v[112:115], v[52:55], a[136:139]
    s_add_u32 m0, m0, s96
    ds_read_b128 a[20:23], v27 offset:22016
    v_mfma_f32_16x16x32_bf16 a[136:139], v[116:119], v[80:83], a[136:139]
    ds_read_b128 a[24:27], v27 offset:23040
    v_mfma_f32_16x16x32_bf16 a[140:143], v[120:123], v[28:31], a[140:143]
    ds_read_b128 a[28:31], v27 offset:25344
    v_mfma_f32_16x16x32_bf16 a[140:143], v[124:127], v[56:59], a[140:143]
    buffer_load_dwordx4 v7, s[4:7], s49 offen offset:256 nt lds
    v_mfma_f32_16x16x32_bf16 a[144:147], v[120:123], v[32:35], a[144:147]
    s_add_u32 m0, m0, s97
    ds_read_b128 a[32:35], v27 offset:26368
    v_mfma_f32_16x16x32_bf16 a[144:147], v[124:127], v[60:63], a[144:147]
    ds_read_b128 a[36:39], v27 offset:27392
    v_mfma_f32_16x16x32_bf16 a[148:151], v[120:123], v[36:39], a[148:151]
    ds_read_b128 a[40:43], v27 offset:28416
    v_mfma_f32_16x16x32_bf16 a[148:151], v[124:127], v[64:67], a[148:151]
    ds_read_b128 a[44:47], v27 offset:29440
    v_mfma_f32_16x16x32_bf16 a[152:155], v[120:123], v[40:43], a[152:155]
    ds_read_b128 a[48:51], v27 offset:30464
    v_mfma_f32_16x16x32_bf16 a[152:155], v[124:127], v[68:71], a[152:155]
    buffer_load_dwordx4 v7, s[4:7], s49 offen offset:512 nt lds
    v_mfma_f32_16x16x32_bf16 a[156:159], v[120:123], v[44:47], a[156:159]
    s_add_u32 m0, m0, s96
    ds_read_b128 a[52:55], v27 offset:31488
    v_mfma_f32_16x16x32_bf16 a[156:159], v[124:127], v[72:75], a[156:159]
    ds_read_b64_tr_b16 v[112:113], v11 offset:16896
    v_mfma_f32_16x16x32_bf16 a[160:163], v[120:123], v[48:51], a[160:163]
    ds_read_b64_tr_b16 v[114:115], v11 offset:17024
    v_mfma_f32_16x16x32_bf16 a[160:163], v[124:127], v[76:79], a[160:163]
    ds_read_b64_tr_b16 v[116:117], v11 offset:17408
    v_mfma_f32_16x16x32_bf16 a[164:167], v[120:123], v[52:55], a[164:167]
    ds_read_b64_tr_b16 v[118:119], v11 offset:17536
    v_mfma_f32_16x16x32_bf16 a[164:167], v[124:127], v[80:83], a[164:167]
    buffer_load_dwordx4 v7, s[4:7], s49 offen offset:768 nt lds
    v_mfma_f32_16x16x32_bf16 a[168:171], v[128:131], v[28:31], a[168:171]
    s_add_u32 m0, m0, s97
    ds_read_b64_tr_b16 v[120:121], v11 offset:16928
    v_mfma_f32_16x16x32_bf16 a[168:171], v[132:135], v[56:59], a[168:171]
    ds_read_b64_tr_b16 v[122:123], v11 offset:17056
    v_mfma_f32_16x16x32_bf16 a[172:175], v[128:131], v[32:35], a[172:175]
    ds_read_b64_tr_b16 v[124:125], v11 offset:17440
    v_mfma_f32_16x16x32_bf16 a[172:175], v[132:135], v[60:63], a[172:175]
    ds_read_b64_tr_b16 v[126:127], v11 offset:17568
    v_mfma_f32_16x16x32_bf16 a[176:179], v[128:131], v[36:39], a[176:179]
    v_mfma_f32_16x16x32_bf16 a[176:179], v[132:135], v[64:67], a[176:179]
    buffer_load_dwordx4 v7, s[4:7], s49 offen offset:1024 nt lds
    v_mfma_f32_16x16x32_bf16 a[180:183], v[128:131], v[40:43], a[180:183]
    s_add_u32 m0, m0, s96
    v_mfma_f32_16x16x32_bf16 a[180:183], v[132:135], v[68:71], a[180:183]
    v_mfma_f32_16x16x32_bf16 a[184:187], v[128:131], v[44:47], a[184:187]
    v_mfma_f32_16x16x32_bf16 a[184:187], v[132:135], v[72:75], a[184:187]
    v_mfma_f32_16x16x32_bf16 a[188:191], v[128:131], v[48:51], a[188:191]
    v_mfma_f32_16x16x32_bf16 a[188:191], v[132:135], v[76:79], a[188:191]
    buffer_load_dwordx4 v7, s[4:7], s49 offen offset:1280 nt lds
    v_mfma_f32_16x16x32_bf16 a[192:195], v[128:131], v[52:55], a[192:195]
    s_add_u32 m0, m0, s97
    v_mfma_f32_16x16x32_bf16 a[192:195], v[132:135], v[80:83], a[192:195]
    ds_read_b64_tr_b16 v[128:129], v11 offset:16960
    v_mfma_f32_16x16x32_bf16 a[196:199], v[136:139], v[28:31], a[196:199]
    ds_read_b64_tr_b16 v[130:131], v11 offset:17088
    v_mfma_f32_16x16x32_bf16 a[196:199], v[140:143], v[56:59], a[196:199]
    ds_read_b64_tr_b16 v[132:133], v11 offset:17472
    v_mfma_f32_16x16x32_bf16 a[200:203], v[136:139], v[32:35], a[200:203]
    ds_read_b64_tr_b16 v[134:135], v11 offset:17600
    v_mfma_f32_16x16x32_bf16 a[200:203], v[140:143], v[60:63], a[200:203]
    buffer_load_dwordx4 v7, s[4:7], s49 offen offset:1536 nt lds
    v_mfma_f32_16x16x32_bf16 a[204:207], v[136:139], v[36:39], a[204:207]
    s_add_u32 m0, m0, s96
    v_mfma_f32_16x16x32_bf16 a[204:207], v[140:143], v[64:67], a[204:207]
    v_mfma_f32_16x16x32_bf16 a[208:211], v[136:139], v[40:43], a[208:211]
    v_mfma_f32_16x16x32_bf16 a[208:211], v[140:143], v[68:71], a[208:211]
    v_mfma_f32_16x16x32_bf16 a[212:215], v[136:139], v[44:47], a[212:215]
    v_mfma_f32_16x16x32_bf16 a[212:215], v[140:143], v[72:75], a[212:215]
    buffer_load_dwordx4 v7, s[4:7], s49 offen offset:1792 nt lds
    v_mfma_f32_16x16x32_bf16 a[216:219], v[136:139], v[48:51], a[216:219]
    v_mfma_f32_16x16x32_bf16 a[216:219], v[140:143], v[76:79], a[216:219]
    v_mfma_f32_16x16x32_bf16 a[220:223], v[136:139], v[52:55], a[220:223]
    v_mfma_f32_16x16x32_bf16 a[220:223], v[140:143], v[80:83], a[220:223]
    ds_read_b64_tr_b16 v[136:137], v11 offset:16992
    ds_read_b64_tr_b16 v[138:139], v11 offset:17120
    ds_read_b64_tr_b16 v[140:141], v11 offset:17504
    ds_read_b64_tr_b16 v[142:143], v11 offset:17632
    s_waitcnt lgkmcnt(8)
    v_mfma_f32_16x16x32_bf16 v[144:147], v[112:115], a[0:3], v[144:147]
    s_add_u32 s29, s34, s100
    v_mfma_f32_16x16x32_bf16 v[144:147], v[116:119], a[28:31], v[144:147]
    s_bfe_u32 s28, s29, 0x20003
    v_mfma_f32_16x16x32_bf16 v[148:151], v[112:115], a[4:7], v[148:151]
    s_lshl_b32 s28, s28, 16
    v_mfma_f32_16x16x32_bf16 v[148:151], v[116:119], a[32:35], v[148:151]
    s_and_b32 s29, s29, 7
    v_mfma_f32_16x16x32_bf16 v[152:155], v[112:115], a[8:11], v[152:155]
    s_lshl_b32 s29, s29, 11
    v_mfma_f32_16x16x32_bf16 v[152:155], v[116:119], a[36:39], v[152:155]
    s_add_u32 s29, s28, s29
    v_mfma_f32_16x16x32_bf16 v[156:159], v[112:115], a[12:15], v[156:159]
    s_lshr_b32 s28, s34, 5
    s_waitcnt vmcnt(16) lgkmcnt(0)
    s_barrier
    v_mfma_f32_16x16x32_bf16 v[156:159], v[116:119], a[40:43], v[156:159]
    s_lshl_b32 s28, s28, 19
    v_mfma_f32_16x16x32_bf16 v[160:163], v[112:115], a[16:19], v[160:163]
    s_add_u32 s49, s28, s29
    v_mfma_f32_16x16x32_bf16 v[160:163], v[116:119], a[44:47], v[160:163]
    s_add_u32 m0, s33, 16896
    v_mfma_f32_16x16x32_bf16 v[164:167], v[112:115], a[20:23], v[164:167]
    s_add_u32 s34, s34, 1
    v_mfma_f32_16x16x32_bf16 v[164:167], v[116:119], a[48:51], v[164:167]
    buffer_load_dwordx4 v7, s[4:7], s49 offen offset:0 nt lds
    v_mfma_f32_16x16x32_bf16 v[168:171], v[112:115], a[24:27], v[168:171]
    s_add_u32 m0, m0, s96
    v_mfma_f32_16x16x32_bf16 v[168:171], v[116:119], a[52:55], v[168:171]
    ds_read_b64_tr_b16 v[112:113], v11 offset:25344
    v_mfma_f32_16x16x32_bf16 v[172:175], v[120:123], a[0:3], v[172:175]
    ds_read_b64_tr_b16 v[114:115], v11 offset:25472
    v_mfma_f32_16x16x32_bf16 v[172:175], v[124:127], a[28:31], v[172:175]
    buffer_load_dwordx4 v7, s[4:7], s49 offen offset:256 nt lds
    v_mfma_f32_16x16x32_bf16 v[176:179], v[120:123], a[4:7], v[176:179]
    s_add_u32 m0, m0, s97
    ds_read_b64_tr_b16 v[116:117], v11 offset:25856
    v_mfma_f32_16x16x32_bf16 v[176:179], v[124:127], a[32:35], v[176:179]
    ds_read_b64_tr_b16 v[118:119], v11 offset:25984
    v_mfma_f32_16x16x32_bf16 v[180:183], v[120:123], a[8:11], v[180:183]
    v_mfma_f32_16x16x32_bf16 v[180:183], v[124:127], a[36:39], v[180:183]
    v_mfma_f32_16x16x32_bf16 v[184:187], v[120:123], a[12:15], v[184:187]
    v_mfma_f32_16x16x32_bf16 v[184:187], v[124:127], a[40:43], v[184:187]
    buffer_load_dwordx4 v7, s[4:7], s49 offen offset:512 nt lds
    v_mfma_f32_16x16x32_bf16 v[188:191], v[120:123], a[16:19], v[188:191]
    s_add_u32 m0, m0, s96
    v_mfma_f32_16x16x32_bf16 v[188:191], v[124:127], a[44:47], v[188:191]
    v_mfma_f32_16x16x32_bf16 v[192:195], v[120:123], a[20:23], v[192:195]
    v_mfma_f32_16x16x32_bf16 v[192:195], v[124:127], a[48:51], v[192:195]
    v_mfma_f32_16x16x32_bf16 v[196:199], v[120:123], a[24:27], v[196:199]
    v_mfma_f32_16x16x32_bf16 v[196:199], v[124:127], a[52:55], v[196:199]
    buffer_load_dwordx4 v7, s[4:7], s49 offen offset:768 nt lds
    v_mfma_f32_16x16x32_bf16 v[200:203], v[128:131], a[0:3], v[200:203]
    s_add_u32 m0, m0, s97
    ds_read_b64_tr_b16 v[120:121], v11 offset:25376
    v_mfma_f32_16x16x32_bf16 v[200:203], v[132:135], a[28:31], v[200:203]
    ds_read_b64_tr_b16 v[122:123], v11 offset:25504
    v_mfma_f32_16x16x32_bf16 v[204:207], v[128:131], a[4:7], v[204:207]
    ds_read_b64_tr_b16 v[124:125], v11 offset:25888
    v_mfma_f32_16x16x32_bf16 v[204:207], v[132:135], a[32:35], v[204:207]
    ds_read_b64_tr_b16 v[126:127], v11 offset:26016
    v_mfma_f32_16x16x32_bf16 v[208:211], v[128:131], a[8:11], v[208:211]
    v_mfma_f32_16x16x32_bf16 v[208:211], v[132:135], a[36:39], v[208:211]
    buffer_load_dwordx4 v7, s[4:7], s49 offen offset:1024 nt lds
    v_mfma_f32_16x16x32_bf16 v[212:215], v[128:131], a[12:15], v[212:215]
    s_add_u32 m0, m0, s96
    v_mfma_f32_16x16x32_bf16 v[212:215], v[132:135], a[40:43], v[212:215]
    v_mfma_f32_16x16x32_bf16 v[216:219], v[128:131], a[16:19], v[216:219]
    v_mfma_f32_16x16x32_bf16 v[216:219], v[132:135], a[44:47], v[216:219]
    v_mfma_f32_16x16x32_bf16 v[220:223], v[128:131], a[20:23], v[220:223]
    v_mfma_f32_16x16x32_bf16 v[220:223], v[132:135], a[48:51], v[220:223]
    buffer_load_dwordx4 v7, s[4:7], s49 offen offset:1280 nt lds
    v_mfma_f32_16x16x32_bf16 v[224:227], v[128:131], a[24:27], v[224:227]
    s_add_u32 m0, m0, s97
    v_mfma_f32_16x16x32_bf16 v[224:227], v[132:135], a[52:55], v[224:227]
    ds_read_b64_tr_b16 v[128:129], v11 offset:25408
    v_mfma_f32_16x16x32_bf16 v[228:231], v[136:139], a[0:3], v[228:231]
    ds_read_b64_tr_b16 v[130:131], v11 offset:25536
    v_mfma_f32_16x16x32_bf16 v[228:231], v[140:143], a[28:31], v[228:231]
    ds_read_b64_tr_b16 v[132:133], v11 offset:25920
    v_mfma_f32_16x16x32_bf16 v[232:235], v[136:139], a[4:7], v[232:235]
    ds_read_b64_tr_b16 v[134:135], v11 offset:26048
    v_mfma_f32_16x16x32_bf16 v[232:235], v[140:143], a[32:35], v[232:235]
    buffer_load_dwordx4 v7, s[4:7], s49 offen offset:1536 nt lds
    v_mfma_f32_16x16x32_bf16 v[236:239], v[136:139], a[8:11], v[236:239]
    s_add_u32 m0, m0, s96
    v_mfma_f32_16x16x32_bf16 v[236:239], v[140:143], a[36:39], v[236:239]
    v_mfma_f32_16x16x32_bf16 v[240:243], v[136:139], a[12:15], v[240:243]
    v_mfma_f32_16x16x32_bf16 v[240:243], v[140:143], a[40:43], v[240:243]
    v_mfma_f32_16x16x32_bf16 v[244:247], v[136:139], a[16:19], v[244:247]
    v_mfma_f32_16x16x32_bf16 v[244:247], v[140:143], a[44:47], v[244:247]
    buffer_load_dwordx4 v7, s[4:7], s49 offen offset:1792 nt lds
    v_mfma_f32_16x16x32_bf16 v[248:251], v[136:139], a[20:23], v[248:251]
    v_mfma_f32_16x16x32_bf16 v[248:251], v[140:143], a[48:51], v[248:251]
    v_mfma_f32_16x16x32_bf16 v[252:255], v[136:139], a[24:27], v[252:255]
    v_mfma_f32_16x16x32_bf16 v[252:255], v[140:143], a[52:55], v[252:255]
    ds_read_b64_tr_b16 v[136:137], v11 offset:25440
    ds_read_b64_tr_b16 v[138:139], v11 offset:25568
    ds_read_b64_tr_b16 v[140:141], v11 offset:25952
    ds_read_b64_tr_b16 v[142:143], v11 offset:26080
    s_waitcnt lgkmcnt(8)
    v_mfma_f32_16x16x32_bf16 a[112:115], v[112:115], a[0:3], a[112:115]
    s_add_u32 s29, s34, s100
    v_mfma_f32_16x16x32_bf16 a[112:115], v[116:119], a[28:31], a[112:115]
    s_bfe_u32 s28, s29, 0x20003
    v_mfma_f32_16x16x32_bf16 a[116:119], v[112:115], a[4:7], a[116:119]
    s_lshl_b32 s28, s28, 16
    v_mfma_f32_16x16x32_bf16 a[116:119], v[116:119], a[32:35], a[116:119]
    s_and_b32 s29, s29, 7
    v_mfma_f32_16x16x32_bf16 a[120:123], v[112:115], a[8:11], a[120:123]
    s_lshl_b32 s29, s29, 11
    v_mfma_f32_16x16x32_bf16 a[120:123], v[116:119], a[36:39], a[120:123]
    s_add_u32 s29, s28, s29
    v_mfma_f32_16x16x32_bf16 a[124:127], v[112:115], a[12:15], a[124:127]
    s_lshr_b32 s28, s34, 5
    s_waitcnt vmcnt(16) lgkmcnt(0)
    s_barrier
    ds_read_b128 v[56:59], v8 offset:0
    v_mfma_f32_16x16x32_bf16 a[124:127], v[116:119], a[40:43], a[124:127]
    s_lshl_b32 s28, s28, 19
    ds_read_b128 v[60:63], v8 offset:64
    v_mfma_f32_16x16x32_bf16 a[128:131], v[112:115], a[16:19], a[128:131]
    s_add_u32 s49, s28, s29
    ds_read_b128 v[64:67], v8 offset:128
    v_mfma_f32_16x16x32_bf16 a[128:131], v[116:119], a[44:47], a[128:131]
    s_add_u32 m0, s33, 25344
    ds_read_b128 v[68:71], v8 offset:192
    v_mfma_f32_16x16x32_bf16 a[132:135], v[112:115], a[20:23], a[132:135]
    s_add_u32 s34, s34, 1
    ds_read_b128 v[72:75], v8 offset:512
    v_mfma_f32_16x16x32_bf16 a[132:135], v[116:119], a[48:51], a[132:135]
    buffer_load_dwordx4 v7, s[4:7], s49 offen offset:0 nt lds
    v_mfma_f32_16x16x32_bf16 a[136:139], v[112:115], a[24:27], a[136:139]
    s_add_u32 m0, m0, s96
    ds_read_b128 v[76:79], v8 offset:576
    v_mfma_f32_16x16x32_bf16 a[136:139], v[116:119], a[52:55], a[136:139]
    ds_read_b128 v[80:83], v8 offset:640
    v_mfma_f32_16x16x32_bf16 a[140:143], v[120:123], a[0:3], a[140:143]
    ds_read_b128 v[84:87], v8 offset:704
    v_mfma_f32_16x16x32_bf16 a[140:143], v[124:127], a[28:31], a[140:143]
    buffer_load_dwordx4 v7, s[4:7], s49 offen offset:256 nt lds
    v_mfma_f32_16x16x32_bf16 a[144:147], v[120:123], a[4:7], a[144:147]
    s_add_u32 m0, m0, s97
    v_mfma_f32_16x16x32_bf16 a[144:147], v[124:127], a[32:35], a[144:147]
    v_mfma_f32_16x16x32_bf16 a[148:151], v[120:123], a[8:11], a[148:151]
    v_mfma_f32_16x16x32_bf16 a[148:151], v[124:127], a[36:39], a[148:151]
    v_mfma_f32_16x16x32_bf16 a[152:155], v[120:123], a[12:15], a[152:155]
    v_mfma_f32_16x16x32_bf16 a[152:155], v[124:127], a[40:43], a[152:155]
    buffer_load_dwordx4 v7, s[4:7], s49 offen offset:512 nt lds
    v_mfma_f32_16x16x32_bf16 a[156:159], v[120:123], a[16:19], a[156:159]
    s_add_u32 m0, m0, s96
    v_mfma_f32_16x16x32_bf16 a[156:159], v[124:127], a[44:47], a[156:159]
    v_mfma_f32_16x16x32_bf16 a[160:163], v[120:123], a[20:23], a[160:163]
    v_mfma_f32_16x16x32_bf16 a[160:163], v[124:127], a[48:51], a[160:163]
    v_mfma_f32_16x16x32_bf16 a[164:167], v[120:123], a[24:27], a[164:167]
    v_mfma_f32_16x16x32_bf16 a[164:167], v[124:127], a[52:55], a[164:167]
    buffer_load_dwordx4 v7, s[4:7], s49 offen offset:768 nt lds
    v_mfma_f32_16x16x32_bf16 a[168:171], v[128:131], a[0:3], a[168:171]
    s_add_u32 m0, m0, s97
    v_mfma_f32_16x16x32_bf16 a[168:171], v[132:135], a[28:31], a[168:171]
    v_mfma_f32_16x16x32_bf16 a[172:175], v[128:131], a[4:7], a[172:175]
    v_mfma_f32_16x16x32_bf16 a[172:175], v[132:135], a[32:35], a[172:175]
    v_mfma_f32_16x16x32_bf16 a[176:179], v[128:131], a[8:11], a[176:179]
    v_mfma_f32_16x16x32_bf16 a[176:179], v[132:135], a[36:39], a[176:179]
    buffer_load_dwordx4 v7, s[4:7], s49 offen offset:1024 nt lds
    v_mfma_f32_16x16x32_bf16 a[180:183], v[128:131], a[12:15], a[180:183]
    s_add_u32 m0, m0, s96
    v_mfma_f32_16x16x32_bf16 a[180:183], v[132:135], a[40:43], a[180:183]
    v_mfma_f32_16x16x32_bf16 a[184:187], v[128:131], a[16:19], a[184:187]
    v_mfma_f32_16x16x32_bf16 a[184:187], v[132:135], a[44:47], a[184:187]
    v_mfma_f32_16x16x32_bf16 a[188:191], v[128:131], a[20:23], a[188:191]
    v_mfma_f32_16x16x32_bf16 a[188:191], v[132:135], a[48:51], a[188:191]
    buffer_load_dwordx4 v7, s[4:7], s49 offen offset:1280 nt lds
    v_mfma_f32_16x16x32_bf16 a[192:195], v[128:131], a[24:27], a[192:195]
    s_add_u32 m0, m0, s97
    v_mfma_f32_16x16x32_bf16 a[192:195], v[132:135], a[52:55], a[192:195]
    v_mfma_f32_16x16x32_bf16 a[196:199], v[136:139], a[0:3], a[196:199]
    v_mfma_f32_16x16x32_bf16 a[196:199], v[140:143], a[28:31], a[196:199]
    v_mfma_f32_16x16x32_bf16 a[200:203], v[136:139], a[4:7], a[200:203]
    v_mfma_f32_16x16x32_bf16 a[200:203], v[140:143], a[32:35], a[200:203]
    buffer_load_dwordx4 v7, s[4:7], s49 offen offset:1536 nt lds
    v_mfma_f32_16x16x32_bf16 a[204:207], v[136:139], a[8:11], a[204:207]
    s_add_u32 m0, m0, s96
    v_mfma_f32_16x16x32_bf16 a[204:207], v[140:143], a[36:39], a[204:207]
    v_mfma_f32_16x16x32_bf16 a[208:211], v[136:139], a[12:15], a[208:211]
    v_mfma_f32_16x16x32_bf16 a[208:211], v[140:143], a[40:43], a[208:211]
    v_mfma_f32_16x16x32_bf16 a[212:215], v[136:139], a[16:19], a[212:215]
    v_mfma_f32_16x16x32_bf16 a[212:215], v[140:143], a[44:47], a[212:215]
    buffer_load_dwordx4 v7, s[4:7], s49 offen offset:1792 nt lds
    v_mfma_f32_16x16x32_bf16 a[216:219], v[136:139], a[20:23], a[216:219]
    v_mfma_f32_16x16x32_bf16 a[216:219], v[140:143], a[48:51], a[216:219]
    v_mfma_f32_16x16x32_bf16 a[220:223], v[136:139], a[24:27], a[220:223]
    v_mfma_f32_16x16x32_bf16 a[220:223], v[140:143], a[52:55], a[220:223]
    s_branch L_at_qpepi
L_at_qptailB:
    s_mul_i32 s50, s21, s52
    s_mov_b32 s101, s21
    s_add_u32 s50, s50, s55
    s_cmp_ge_u32 s21, 2
    s_cselect_b32 s28, 0x40000000, 0
    s_add_u32 s50, s50, s28
    s_mov_b32 s82, s26
    s_mul_i32 s28, s26, s51
    s_add_u32 s50, s50, s28
    s_waitcnt lgkmcnt(8)
    v_mfma_f32_16x16x32_bf16 v[144:147], v[112:115], v[28:31], v[144:147]
    s_add_u32 m0, s33, 0
    v_mfma_f32_16x16x32_bf16 v[144:147], v[116:119], v[56:59], v[144:147]
    s_mov_b32 s49, s50
    v_mfma_f32_16x16x32_bf16 v[148:151], v[112:115], v[32:35], v[148:151]
    v_mfma_f32_16x16x32_bf16 v[148:151], v[116:119], v[60:63], v[148:151]
    v_mfma_f32_16x16x32_bf16 v[152:155], v[112:115], v[36:39], v[152:155]
    v_mfma_f32_16x16x32_bf16 v[152:155], v[116:119], v[64:67], v[152:155]
    v_mfma_f32_16x16x32_bf16 v[156:159], v[112:115], v[40:43], v[156:159]
    s_waitcnt vmcnt(16) lgkmcnt(0)
    s_barrier
    v_mfma_f32_16x16x32_bf16 v[156:159], v[116:119], v[68:71], v[156:159]
    v_mfma_f32_16x16x32_bf16 v[160:163], v[112:115], v[44:47], v[160:163]
    v_mfma_f32_16x16x32_bf16 v[160:163], v[116:119], v[72:75], v[160:163]
    s_add_u32 s28, s49, s88
    buffer_load_dwordx4 v26, s[16:19], s28 offen lds
    v_mfma_f32_16x16x32_bf16 v[164:167], v[112:115], v[48:51], v[164:167]
    s_add_u32 m0, m0, s53
    v_mfma_f32_16x16x32_bf16 v[164:167], v[116:119], v[76:79], v[164:167]
    v_mfma_f32_16x16x32_bf16 v[168:171], v[112:115], v[52:55], v[168:171]
    v_mfma_f32_16x16x32_bf16 v[168:171], v[116:119], v[80:83], v[168:171]
    ds_read_b64_tr_b16 v[112:113], v11 offset:8448
    v_mfma_f32_16x16x32_bf16 v[172:175], v[120:123], v[28:31], v[172:175]
    ds_read_b64_tr_b16 v[114:115], v11 offset:8576
    v_mfma_f32_16x16x32_bf16 v[172:175], v[124:127], v[56:59], v[172:175]
    s_add_u32 s28, s49, s89
    buffer_load_dwordx4 v26, s[16:19], s28 offen lds
    v_mfma_f32_16x16x32_bf16 v[176:179], v[120:123], v[32:35], v[176:179]
    s_add_u32 m0, m0, s53
    ds_read_b64_tr_b16 v[116:117], v11 offset:8960
    v_mfma_f32_16x16x32_bf16 v[176:179], v[124:127], v[60:63], v[176:179]
    ds_read_b64_tr_b16 v[118:119], v11 offset:9088
    v_mfma_f32_16x16x32_bf16 v[180:183], v[120:123], v[36:39], v[180:183]
    v_mfma_f32_16x16x32_bf16 v[180:183], v[124:127], v[64:67], v[180:183]
    v_mfma_f32_16x16x32_bf16 v[184:187], v[120:123], v[40:43], v[184:187]
    v_mfma_f32_16x16x32_bf16 v[184:187], v[124:127], v[68:71], v[184:187]
    s_add_u32 s28, s49, s90
    buffer_load_dwordx4 v26, s[16:19], s28 offen lds
    v_mfma_f32_16x16x32_bf16 v[188:191], v[120:123], v[44:47], v[188:191]
    s_add_u32 m0, m0, s53
    v_mfma_f32_16x16x32_bf16 v[188:191], v[124:127], v[72:75], v[188:191]
    v_mfma_f32_16x16x32_bf16 v[192:195], v[120:123], v[48:51], v[192:195]
    v_mfma_f32_16x16x32_bf16 v[192:195], v[124:127], v[76:79], v[192:195]
    v_mfma_f32_16x16x32_bf16 v[196:199], v[120:123], v[52:55], v[196:199]
    v_mfma_f32_16x16x32_bf16 v[196:199], v[124:127], v[80:83], v[196:199]
    s_add_u32 s28, s49, s91
    buffer_load_dwordx4 v26, s[16:19], s28 offen lds
    v_mfma_f32_16x16x32_bf16 v[200:203], v[128:131], v[28:31], v[200:203]
    s_add_u32 m0, m0, s53
    ds_read_b64_tr_b16 v[120:121], v11 offset:8480
    v_mfma_f32_16x16x32_bf16 v[200:203], v[132:135], v[56:59], v[200:203]
    ds_read_b64_tr_b16 v[122:123], v11 offset:8608
    v_mfma_f32_16x16x32_bf16 v[204:207], v[128:131], v[32:35], v[204:207]
    ds_read_b64_tr_b16 v[124:125], v11 offset:8992
    v_mfma_f32_16x16x32_bf16 v[204:207], v[132:135], v[60:63], v[204:207]
    ds_read_b64_tr_b16 v[126:127], v11 offset:9120
    v_mfma_f32_16x16x32_bf16 v[208:211], v[128:131], v[36:39], v[208:211]
    v_mfma_f32_16x16x32_bf16 v[208:211], v[132:135], v[64:67], v[208:211]
    s_add_u32 s28, s49, s92
    buffer_load_dwordx4 v26, s[16:19], s28 offen lds
    v_mfma_f32_16x16x32_bf16 v[212:215], v[128:131], v[40:43], v[212:215]
    s_add_u32 m0, m0, s53
    v_mfma_f32_16x16x32_bf16 v[212:215], v[132:135], v[68:71], v[212:215]
    v_mfma_f32_16x16x32_bf16 v[216:219], v[128:131], v[44:47], v[216:219]
    v_mfma_f32_16x16x32_bf16 v[216:219], v[132:135], v[72:75], v[216:219]
    v_mfma_f32_16x16x32_bf16 v[220:223], v[128:131], v[48:51], v[220:223]
    v_mfma_f32_16x16x32_bf16 v[220:223], v[132:135], v[76:79], v[220:223]
    s_add_u32 s28, s49, s93
    buffer_load_dwordx4 v26, s[16:19], s28 offen lds
    v_mfma_f32_16x16x32_bf16 v[224:227], v[128:131], v[52:55], v[224:227]
    s_add_u32 m0, m0, s53
    v_mfma_f32_16x16x32_bf16 v[224:227], v[132:135], v[80:83], v[224:227]
    ds_read_b64_tr_b16 v[128:129], v11 offset:8512
    v_mfma_f32_16x16x32_bf16 v[228:231], v[136:139], v[28:31], v[228:231]
    ds_read_b64_tr_b16 v[130:131], v11 offset:8640
    v_mfma_f32_16x16x32_bf16 v[228:231], v[140:143], v[56:59], v[228:231]
    ds_read_b64_tr_b16 v[132:133], v11 offset:9024
    v_mfma_f32_16x16x32_bf16 v[232:235], v[136:139], v[32:35], v[232:235]
    ds_read_b64_tr_b16 v[134:135], v11 offset:9152
    v_mfma_f32_16x16x32_bf16 v[232:235], v[140:143], v[60:63], v[232:235]
    s_add_u32 s28, s49, s94
    buffer_load_dwordx4 v26, s[16:19], s28 offen lds
    v_mfma_f32_16x16x32_bf16 v[236:239], v[136:139], v[36:39], v[236:239]
    s_add_u32 m0, m0, s53
    v_mfma_f32_16x16x32_bf16 v[236:239], v[140:143], v[64:67], v[236:239]
    v_mfma_f32_16x16x32_bf16 v[240:243], v[136:139], v[40:43], v[240:243]
    v_mfma_f32_16x16x32_bf16 v[240:243], v[140:143], v[68:71], v[240:243]
    v_mfma_f32_16x16x32_bf16 v[244:247], v[136:139], v[44:47], v[244:247]
    v_mfma_f32_16x16x32_bf16 v[244:247], v[140:143], v[72:75], v[244:247]
    s_add_u32 s28, s49, s95
    buffer_load_dwordx4 v26, s[16:19], s28 offen lds
    v_mfma_f32_16x16x32_bf16 v[248:251], v[136:139], v[48:51], v[248:251]
    v_mfma_f32_16x16x32_bf16 v[248:251], v[140:143], v[76:79], v[248:251]
    v_mfma_f32_16x16x32_bf16 v[252:255], v[136:139], v[52:55], v[252:255]
    v_mfma_f32_16x16x32_bf16 v[252:255], v[140:143], v[80:83], v[252:255]
    ds_read_b64_tr_b16 v[136:137], v11 offset:8544
    ds_read_b64_tr_b16 v[138:139], v11 offset:8672
    ds_read_b64_tr_b16 v[140:141], v11 offset:9056
    ds_read_b64_tr_b16 v[142:143], v11 offset:9184
    s_waitcnt lgkmcnt(8)
    v_mfma_f32_16x16x32_bf16 a[112:115], v[112:115], v[28:31], a[112:115]
    s_add_u32 m0, s33, 8448
    v_mfma_f32_16x16x32_bf16 a[112:115], v[116:119], v[56:59], a[112:115]
    s_add_u32 s49, s50, s46
    v_mfma_f32_16x16x32_bf16 a[116:119], v[112:115], v[32:35], a[116:119]
    s_lshl1_add_u32 s50, s51, s50
    v_mfma_f32_16x16x32_bf16 a[116:119], v[116:119], v[60:63], a[116:119]
    s_add_u32 s82, s82, 2
    v_mfma_f32_16x16x32_bf16 a[120:123], v[112:115], v[36:39], a[120:123]
    s_cmp_eq_u32 s82, 20
    v_mfma_f32_16x16x32_bf16 a[120:123], v[116:119], v[64:67], a[120:123]
    s_cselect_b32 s29, s83, 0
    v_mfma_f32_16x16x32_bf16 a[124:127], v[112:115], v[40:43], a[124:127]
    s_sub_u32 s50, s50, s29
    s_waitcnt vmcnt(8) lgkmcnt(0)
    s_barrier
    ds_read_b128 a[0:3], v27 offset:16896
    v_mfma_f32_16x16x32_bf16 a[124:127], v[116:119], v[68:71], a[124:127]
    ds_read_b128 a[4:7], v27 offset:17920
    v_mfma_f32_16x16x32_bf16 a[128:131], v[112:115], v[44:47], a[128:131]
    ds_read_b128 a[8:11], v27 offset:18944
    v_mfma_f32_16x16x32_bf16 a[128:131], v[116:119], v[72:75], a[128:131]
    s_add_u32 s28, s49, s88
    buffer_load_dwordx4 v26, s[16:19], s28 offen lds
    v_mfma_f32_16x16x32_bf16 a[132:135], v[112:115], v[48:51], a[132:135]
    s_add_u32 m0, m0, s53
    ds_read_b128 a[12:15], v27 offset:19968
    v_mfma_f32_16x16x32_bf16 a[132:135], v[116:119], v[76:79], a[132:135]
    ds_read_b128 a[16:19], v27 offset:20992
    v_mfma_f32_16x16x32_bf16 a[136:139], v[112:115], v[52:55], a[136:139]
    ds_read_b128 a[20:23], v27 offset:22016
    v_mfma_f32_16x16x32_bf16 a[136:139], v[116:119], v[80:83], a[136:139]
    ds_read_b128 a[24:27], v27 offset:23040
    v_mfma_f32_16x16x32_bf16 a[140:143], v[120:123], v[28:31], a[140:143]
    ds_read_b128 a[28:31], v27 offset:25344
    v_mfma_f32_16x16x32_bf16 a[140:143], v[124:127], v[56:59], a[140:143]
    s_add_u32 s28, s49, s89
    buffer_load_dwordx4 v26, s[16:19], s28 offen lds
    v_mfma_f32_16x16x32_bf16 a[144:147], v[120:123], v[32:35], a[144:147]
    s_add_u32 m0, m0, s53
    ds_read_b128 a[32:35], v27 offset:26368
    v_mfma_f32_16x16x32_bf16 a[144:147], v[124:127], v[60:63], a[144:147]
    ds_read_b128 a[36:39], v27 offset:27392
    v_mfma_f32_16x16x32_bf16 a[148:151], v[120:123], v[36:39], a[148:151]
    ds_read_b128 a[40:43], v27 offset:28416
    v_mfma_f32_16x16x32_bf16 a[148:151], v[124:127], v[64:67], a[148:151]
    ds_read_b128 a[44:47], v27 offset:29440
    v_mfma_f32_16x16x32_bf16 a[152:155], v[120:123], v[40:43], a[152:155]
    ds_read_b128 a[48:51], v27 offset:30464
    v_mfma_f32_16x16x32_bf16 a[152:155], v[124:127], v[68:71], a[152:155]
    s_add_u32 s28, s49, s90
    buffer_load_dwordx4 v26, s[16:19], s28 offen lds
    v_mfma_f32_16x16x32_bf16 a[156:159], v[120:123], v[44:47], a[156:159]
    s_add_u32 m0, m0, s53
    ds_read_b128 a[52:55], v27 offset:31488
    v_mfma_f32_16x16x32_bf16 a[156:159], v[124:127], v[72:75], a[156:159]
    ds_read_b64_tr_b16 v[112:113], v11 offset:16896
    v_mfma_f32_16x16x32_bf16 a[160:163], v[120:123], v[48:51], a[160:163]
    ds_read_b64_tr_b16 v[114:115], v11 offset:17024
    v_mfma_f32_16x16x32_bf16 a[160:163], v[124:127], v[76:79], a[160:163]
    ds_read_b64_tr_b16 v[116:117], v11 offset:17408
    v_mfma_f32_16x16x32_bf16 a[164:167], v[120:123], v[52:55], a[164:167]
    ds_read_b64_tr_b16 v[118:119], v11 offset:17536
    v_mfma_f32_16x16x32_bf16 a[164:167], v[124:127], v[80:83], a[164:167]
    s_add_u32 s28, s49, s91
    buffer_load_dwordx4 v26, s[16:19], s28 offen lds
    v_mfma_f32_16x16x32_bf16 a[168:171], v[128:131], v[28:31], a[168:171]
    s_add_u32 m0, m0, s53
    ds_read_b64_tr_b16 v[120:121], v11 offset:16928
    v_mfma_f32_16x16x32_bf16 a[168:171], v[132:135], v[56:59], a[168:171]
    ds_read_b64_tr_b16 v[122:123], v11 offset:17056
    v_mfma_f32_16x16x32_bf16 a[172:175], v[128:131], v[32:35], a[172:175]
    ds_read_b64_tr_b16 v[124:125], v11 offset:17440
    v_mfma_f32_16x16x32_bf16 a[172:175], v[132:135], v[60:63], a[172:175]
    ds_read_b64_tr_b16 v[126:127], v11 offset:17568
    v_mfma_f32_16x16x32_bf16 a[176:179], v[128:131], v[36:39], a[176:179]
    v_mfma_f32_16x16x32_bf16 a[176:179], v[132:135], v[64:67], a[176:179]
    s_add_u32 s28, s49, s92
    buffer_load_dwordx4 v26, s[16:19], s28 offen lds
    v_mfma_f32_16x16x32_bf16 a[180:183], v[128:131], v[40:43], a[180:183]
    s_add_u32 m0, m0, s53
    v_mfma_f32_16x16x32_bf16 a[180:183], v[132:135], v[68:71], a[180:183]
    v_mfma_f32_16x16x32_bf16 a[184:187], v[128:131], v[44:47], a[184:187]
    v_mfma_f32_16x16x32_bf16 a[184:187], v[132:135], v[72:75], a[184:187]
    v_mfma_f32_16x16x32_bf16 a[188:191], v[128:131], v[48:51], a[188:191]
    v_mfma_f32_16x16x32_bf16 a[188:191], v[132:135], v[76:79], a[188:191]
    s_add_u32 s28, s49, s93
    buffer_load_dwordx4 v26, s[16:19], s28 offen lds
    v_mfma_f32_16x16x32_bf16 a[192:195], v[128:131], v[52:55], a[192:195]
    s_add_u32 m0, m0, s53
    v_mfma_f32_16x16x32_bf16 a[192:195], v[132:135], v[80:83], a[192:195]
    ds_read_b64_tr_b16 v[128:129], v11 offset:16960
    v_mfma_f32_16x16x32_bf16 a[196:199], v[136:139], v[28:31], a[196:199]
    ds_read_b64_tr_b16 v[130:131], v11 offset:17088
    v_mfma_f32_16x16x32_bf16 a[196:199], v[140:143], v[56:59], a[196:199]
    ds_read_b64_tr_b16 v[132:133], v11 offset:17472
    v_mfma_f32_16x16x32_bf16 a[200:203], v[136:139], v[32:35], a[200:203]
    ds_read_b64_tr_b16 v[134:135], v11 offset:17600
    v_mfma_f32_16x16x32_bf16 a[200:203], v[140:143], v[60:63], a[200:203]
    s_add_u32 s28, s49, s94
    buffer_load_dwordx4 v26, s[16:19], s28 offen lds
    v_mfma_f32_16x16x32_bf16 a[204:207], v[136:139], v[36:39], a[204:207]
    s_add_u32 m0, m0, s53
    v_mfma_f32_16x16x32_bf16 a[204:207], v[140:143], v[64:67], a[204:207]
    v_mfma_f32_16x16x32_bf16 a[208:211], v[136:139], v[40:43], a[208:211]
    v_mfma_f32_16x16x32_bf16 a[208:211], v[140:143], v[68:71], a[208:211]
    v_mfma_f32_16x16x32_bf16 a[212:215], v[136:139], v[44:47], a[212:215]
    v_mfma_f32_16x16x32_bf16 a[212:215], v[140:143], v[72:75], a[212:215]
    s_add_u32 s28, s49, s95
    buffer_load_dwordx4 v26, s[16:19], s28 offen lds
    v_mfma_f32_16x16x32_bf16 a[216:219], v[136:139], v[48:51], a[216:219]
    v_mfma_f32_16x16x32_bf16 a[216:219], v[140:143], v[76:79], a[216:219]
    v_mfma_f32_16x16x32_bf16 a[220:223], v[136:139], v[52:55], a[220:223]
    v_mfma_f32_16x16x32_bf16 a[220:223], v[140:143], v[80:83], a[220:223]
    ds_read_b64_tr_b16 v[136:137], v11 offset:16992
    ds_read_b64_tr_b16 v[138:139], v11 offset:17120
    ds_read_b64_tr_b16 v[140:141], v11 offset:17504
    ds_read_b64_tr_b16 v[142:143], v11 offset:17632
    s_waitcnt lgkmcnt(8)
    v_mfma_f32_16x16x32_bf16 v[144:147], v[112:115], a[0:3], v[144:147]
    s_add_u32 m0, s33, 16896
    v_mfma_f32_16x16x32_bf16 v[144:147], v[116:119], a[28:31], v[144:147]
    s_mov_b32 s49, s50
    v_mfma_f32_16x16x32_bf16 v[148:151], v[112:115], a[4:7], v[148:151]
    v_mfma_f32_16x16x32_bf16 v[148:151], v[116:119], a[32:35], v[148:151]
    v_mfma_f32_16x16x32_bf16 v[152:155], v[112:115], a[8:11], v[152:155]
    v_mfma_f32_16x16x32_bf16 v[152:155], v[116:119], a[36:39], v[152:155]
    v_mfma_f32_16x16x32_bf16 v[156:159], v[112:115], a[12:15], v[156:159]
    s_waitcnt vmcnt(16) lgkmcnt(0)
    s_barrier
    v_mfma_f32_16x16x32_bf16 v[156:159], v[116:119], a[40:43], v[156:159]
    v_mfma_f32_16x16x32_bf16 v[160:163], v[112:115], a[16:19], v[160:163]
    v_mfma_f32_16x16x32_bf16 v[160:163], v[116:119], a[44:47], v[160:163]
    s_add_u32 s28, s49, s88
    buffer_load_dwordx4 v26, s[16:19], s28 offen lds
    v_mfma_f32_16x16x32_bf16 v[164:167], v[112:115], a[20:23], v[164:167]
    s_add_u32 m0, m0, s53
    v_mfma_f32_16x16x32_bf16 v[164:167], v[116:119], a[48:51], v[164:167]
    v_mfma_f32_16x16x32_bf16 v[168:171], v[112:115], a[24:27], v[168:171]
    v_mfma_f32_16x16x32_bf16 v[168:171], v[116:119], a[52:55], v[168:171]
    ds_read_b64_tr_b16 v[112:113], v11 offset:25344
    v_mfma_f32_16x16x32_bf16 v[172:175], v[120:123], a[0:3], v[172:175]
    ds_read_b64_tr_b16 v[114:115], v11 offset:25472
    v_mfma_f32_16x16x32_bf16 v[172:175], v[124:127], a[28:31], v[172:175]
    s_add_u32 s28, s49, s89
    buffer_load_dwordx4 v26, s[16:19], s28 offen lds
    v_mfma_f32_16x16x32_bf16 v[176:179], v[120:123], a[4:7], v[176:179]
    s_add_u32 m0, m0, s53
    ds_read_b64_tr_b16 v[116:117], v11 offset:25856
    v_mfma_f32_16x16x32_bf16 v[176:179], v[124:127], a[32:35], v[176:179]
    ds_read_b64_tr_b16 v[118:119], v11 offset:25984
    v_mfma_f32_16x16x32_bf16 v[180:183], v[120:123], a[8:11], v[180:183]
    v_mfma_f32_16x16x32_bf16 v[180:183], v[124:127], a[36:39], v[180:183]
    v_mfma_f32_16x16x32_bf16 v[184:187], v[120:123], a[12:15], v[184:187]
    v_mfma_f32_16x16x32_bf16 v[184:187], v[124:127], a[40:43], v[184:187]
    s_add_u32 s28, s49, s90
    buffer_load_dwordx4 v26, s[16:19], s28 offen lds
    v_mfma_f32_16x16x32_bf16 v[188:191], v[120:123], a[16:19], v[188:191]
    s_add_u32 m0, m0, s53
    v_mfma_f32_16x16x32_bf16 v[188:191], v[124:127], a[44:47], v[188:191]
    v_mfma_f32_16x16x32_bf16 v[192:195], v[120:123], a[20:23], v[192:195]
    v_mfma_f32_16x16x32_bf16 v[192:195], v[124:127], a[48:51], v[192:195]
    v_mfma_f32_16x16x32_bf16 v[196:199], v[120:123], a[24:27], v[196:199]
    v_mfma_f32_16x16x32_bf16 v[196:199], v[124:127], a[52:55], v[196:199]
    s_add_u32 s28, s49, s91
    buffer_load_dwordx4 v26, s[16:19], s28 offen lds
    v_mfma_f32_16x16x32_bf16 v[200:203], v[128:131], a[0:3], v[200:203]
    s_add_u32 m0, m0, s53
    ds_read_b64_tr_b16 v[120:121], v11 offset:25376
    v_mfma_f32_16x16x32_bf16 v[200:203], v[132:135], a[28:31], v[200:203]
    ds_read_b64_tr_b16 v[122:123], v11 offset:25504
    v_mfma_f32_16x16x32_bf16 v[204:207], v[128:131], a[4:7], v[204:207]
    ds_read_b64_tr_b16 v[124:125], v11 offset:25888
    v_mfma_f32_16x16x32_bf16 v[204:207], v[132:135], a[32:35], v[204:207]
    ds_read_b64_tr_b16 v[126:127], v11 offset:26016
    v_mfma_f32_16x16x32_bf16 v[208:211], v[128:131], a[8:11], v[208:211]
    v_mfma_f32_16x16x32_bf16 v[208:211], v[132:135], a[36:39], v[208:211]
    s_add_u32 s28, s49, s92
    buffer_load_dwordx4 v26, s[16:19], s28 offen lds
    v_mfma_f32_16x16x32_bf16 v[212:215], v[128:131], a[12:15], v[212:215]
    s_add_u32 m0, m0, s53
    v_mfma_f32_16x16x32_bf16 v[212:215], v[132:135], a[40:43], v[212:215]
    v_mfma_f32_16x16x32_bf16 v[216:219], v[128:131], a[16:19], v[216:219]
    v_mfma_f32_16x16x32_bf16 v[216:219], v[132:135], a[44:47], v[216:219]
    v_mfma_f32_16x16x32_bf16 v[220:223], v[128:131], a[20:23], v[220:223]
    v_mfma_f32_16x16x32_bf16 v[220:223], v[132:135], a[48:51], v[220:223]
    s_add_u32 s28, s49, s93
    buffer_load_dwordx4 v26, s[16:19], s28 offen lds
    v_mfma_f32_16x16x32_bf16 v[224:227], v[128:131], a[24:27], v[224:227]
    s_add_u32 m0, m0, s53
    v_mfma_f32_16x16x32_bf16 v[224:227], v[132:135], a[52:55], v[224:227]
    ds_read_b64_tr_b16 v[128:129], v11 offset:25408
    v_mfma_f32_16x16x32_bf16 v[228:231], v[136:139], a[0:3], v[228:231]
    ds_read_b64_tr_b16 v[130:131], v11 offset:25536
    v_mfma_f32_16x16x32_bf16 v[228:231], v[140:143], a[28:31], v[228:231]
    ds_read_b64_tr_b16 v[132:133], v11 offset:25920
    v_mfma_f32_16x16x32_bf16 v[232:235], v[136:139], a[4:7], v[232:235]
    ds_read_b64_tr_b16 v[134:135], v11 offset:26048
    v_mfma_f32_16x16x32_bf16 v[232:235], v[140:143], a[32:35], v[232:235]
    s_add_u32 s28, s49, s94
    buffer_load_dwordx4 v26, s[16:19], s28 offen lds
    v_mfma_f32_16x16x32_bf16 v[236:239], v[136:139], a[8:11], v[236:239]
    s_add_u32 m0, m0, s53
    v_mfma_f32_16x16x32_bf16 v[236:239], v[140:143], a[36:39], v[236:239]
    v_mfma_f32_16x16x32_bf16 v[240:243], v[136:139], a[12:15], v[240:243]
    v_mfma_f32_16x16x32_bf16 v[240:243], v[140:143], a[40:43], v[240:243]
    v_mfma_f32_16x16x32_bf16 v[244:247], v[136:139], a[16:19], v[244:247]
    v_mfma_f32_16x16x32_bf16 v[244:247], v[140:143], a[44:47], v[244:247]
    s_add_u32 s28, s49, s95
    buffer_load_dwordx4 v26, s[16:19], s28 offen lds
    v_mfma_f32_16x16x32_bf16 v[248:251], v[136:139], a[20:23], v[248:251]
    v_mfma_f32_16x16x32_bf16 v[248:251], v[140:143], a[48:51], v[248:251]
    v_mfma_f32_16x16x32_bf16 v[252:255], v[136:139], a[24:27], v[252:255]
    v_mfma_f32_16x16x32_bf16 v[252:255], v[140:143], a[52:55], v[252:255]
    ds_read_b64_tr_b16 v[136:137], v11 offset:25440
    ds_read_b64_tr_b16 v[138:139], v11 offset:25568
    ds_read_b64_tr_b16 v[140:141], v11 offset:25952
    ds_read_b64_tr_b16 v[142:143], v11 offset:26080
    s_waitcnt lgkmcnt(8)
    v_mfma_f32_16x16x32_bf16 a[112:115], v[112:115], a[0:3], a[112:115]
    s_add_u32 m0, s33, 25344
    v_mfma_f32_16x16x32_bf16 a[112:115], v[116:119], a[28:31], a[112:115]
    s_add_u32 s49, s50, s46
    v_mfma_f32_16x16x32_bf16 a[116:119], v[112:115], a[4:7], a[116:119]
    s_lshl1_add_u32 s50, s51, s50
    v_mfma_f32_16x16x32_bf16 a[116:119], v[116:119], a[32:35], a[116:119]
    s_add_u32 s82, s82, 2
    v_mfma_f32_16x16x32_bf16 a[120:123], v[112:115], a[8:11], a[120:123]
    s_cmp_eq_u32 s82, 20
    v_mfma_f32_16x16x32_bf16 a[120:123], v[116:119], a[36:39], a[120:123]
    s_cselect_b32 s29, s83, 0
    v_mfma_f32_16x16x32_bf16 a[124:127], v[112:115], a[12:15], a[124:127]
    s_sub_u32 s50, s50, s29
    s_waitcnt vmcnt(8) lgkmcnt(0)
    s_barrier
    v_mfma_f32_16x16x32_bf16 a[124:127], v[116:119], a[40:43], a[124:127]
    v_mfma_f32_16x16x32_bf16 a[128:131], v[112:115], a[16:19], a[128:131]
    v_mfma_f32_16x16x32_bf16 a[128:131], v[116:119], a[44:47], a[128:131]
    s_add_u32 s28, s49, s88
    buffer_load_dwordx4 v26, s[16:19], s28 offen lds
    v_mfma_f32_16x16x32_bf16 a[132:135], v[112:115], a[20:23], a[132:135]
    s_add_u32 m0, m0, s53
    v_mfma_f32_16x16x32_bf16 a[132:135], v[116:119], a[48:51], a[132:135]
    v_mfma_f32_16x16x32_bf16 a[136:139], v[112:115], a[24:27], a[136:139]
    v_mfma_f32_16x16x32_bf16 a[136:139], v[116:119], a[52:55], a[136:139]
    v_mfma_f32_16x16x32_bf16 a[140:143], v[120:123], a[0:3], a[140:143]
    v_mfma_f32_16x16x32_bf16 a[140:143], v[124:127], a[28:31], a[140:143]
    s_add_u32 s28, s49, s89
    buffer_load_dwordx4 v26, s[16:19], s28 offen lds
    v_mfma_f32_16x16x32_bf16 a[144:147], v[120:123], a[4:7], a[144:147]
    s_add_u32 m0, m0, s53
    v_mfma_f32_16x16x32_bf16 a[144:147], v[124:127], a[32:35], a[144:147]
    v_mfma_f32_16x16x32_bf16 a[148:151], v[120:123], a[8:11], a[148:151]
    v_mfma_f32_16x16x32_bf16 a[148:151], v[124:127], a[36:39], a[148:151]
    v_mfma_f32_16x16x32_bf16 a[152:155], v[120:123], a[12:15], a[152:155]
    v_mfma_f32_16x16x32_bf16 a[152:155], v[124:127], a[40:43], a[152:155]
    s_add_u32 s28, s49, s90
    buffer_load_dwordx4 v26, s[16:19], s28 offen lds
    v_mfma_f32_16x16x32_bf16 a[156:159], v[120:123], a[16:19], a[156:159]
    s_add_u32 m0, m0, s53
    v_mfma_f32_16x16x32_bf16 a[156:159], v[124:127], a[44:47], a[156:159]
    v_mfma_f32_16x16x32_bf16 a[160:163], v[120:123], a[20:23], a[160:163]
    v_mfma_f32_16x16x32_bf16 a[160:163], v[124:127], a[48:51], a[160:163]
    v_mfma_f32_16x16x32_bf16 a[164:167], v[120:123], a[24:27], a[164:167]
    v_mfma_f32_16x16x32_bf16 a[164:167], v[124:127], a[52:55], a[164:167]
    s_add_u32 s28, s49, s91
    buffer_load_dwordx4 v26, s[16:19], s28 offen lds
    v_mfma_f32_16x16x32_bf16 a[168:171], v[128:131], a[0:3], a[168:171]
    s_add_u32 m0, m0, s53
    v_mfma_f32_16x16x32_bf16 a[168:171], v[132:135], a[28:31], a[168:171]
    v_mfma_f32_16x16x32_bf16 a[172:175], v[128:131], a[4:7], a[172:175]
    v_mfma_f32_16x16x32_bf16 a[172:175], v[132:135], a[32:35], a[172:175]
    v_mfma_f32_16x16x32_bf16 a[176:179], v[128:131], a[8:11], a[176:179]
    v_mfma_f32_16x16x32_bf16 a[176:179], v[132:135], a[36:39], a[176:179]
    s_add_u32 s28, s49, s92
    buffer_load_dwordx4 v26, s[16:19], s28 offen lds
    v_mfma_f32_16x16x32_bf16 a[180:183], v[128:131], a[12:15], a[180:183]
    s_add_u32 m0, m0, s53
    v_mfma_f32_16x16x32_bf16 a[180:183], v[132:135], a[40:43], a[180:183]
    v_mfma_f32_16x16x32_bf16 a[184:187], v[128:131], a[16:19], a[184:187]
    v_mfma_f32_16x16x32_bf16 a[184:187], v[132:135], a[44:47], a[184:187]
    v_mfma_f32_16x16x32_bf16 a[188:191], v[128:131], a[20:23], a[188:191]
    v_mfma_f32_16x16x32_bf16 a[188:191], v[132:135], a[48:51], a[188:191]
    s_add_u32 s28, s49, s93
    buffer_load_dwordx4 v26, s[16:19], s28 offen lds
    v_mfma_f32_16x16x32_bf16 a[192:195], v[128:131], a[24:27], a[192:195]
    s_add_u32 m0, m0, s53
    v_mfma_f32_16x16x32_bf16 a[192:195], v[132:135], a[52:55], a[192:195]
    v_mfma_f32_16x16x32_bf16 a[196:199], v[136:139], a[0:3], a[196:199]
    v_mfma_f32_16x16x32_bf16 a[196:199], v[140:143], a[28:31], a[196:199]
    v_mfma_f32_16x16x32_bf16 a[200:203], v[136:139], a[4:7], a[200:203]
    v_mfma_f32_16x16x32_bf16 a[200:203], v[140:143], a[32:35], a[200:203]
    s_add_u32 s28, s49, s94
    buffer_load_dwordx4 v26, s[16:19], s28 offen lds
    v_mfma_f32_16x16x32_bf16 a[204:207], v[136:139], a[8:11], a[204:207]
    s_add_u32 m0, m0, s53
    v_mfma_f32_16x16x32_bf16 a[204:207], v[140:143], a[36:39], a[204:207]
    v_mfma_f32_16x16x32_bf16 a[208:211], v[136:139], a[12:15], a[208:211]
    v_mfma_f32_16x16x32_bf16 a[208:211], v[140:143], a[40:43], a[208:211]
    v_mfma_f32_16x16x32_bf16 a[212:215], v[136:139], a[16:19], a[212:215]
    v_mfma_f32_16x16x32_bf16 a[212:215], v[140:143], a[44:47], a[212:215]
    s_add_u32 s28, s49, s95
    buffer_load_dwordx4 v26, s[16:19], s28 offen lds
    v_mfma_f32_16x16x32_bf16 a[216:219], v[136:139], a[20:23], a[216:219]
    v_mfma_f32_16x16x32_bf16 a[216:219], v[140:143], a[48:51], a[216:219]
    v_mfma_f32_16x16x32_bf16 a[220:223], v[136:139], a[24:27], a[220:223]
    v_mfma_f32_16x16x32_bf16 a[220:223], v[140:143], a[52:55], a[220:223]
L_at_qpepi:
    v_mov_b32 v4, s54
    v_mov_b32 v5, s54
    s_nop 6
    v_pk_mul_f32 v[144:145], v[144:145], v[4:5]
    v_pk_mul_f32 v[146:147], v[146:147], v[4:5]
    v_pk_mul_f32 v[148:149], v[148:149], v[4:5]
    v_pk_mul_f32 v[150:151], v[150:151], v[4:5]
    v_pk_mul_f32 v[152:153], v[152:153], v[4:5]
    v_pk_mul_f32 v[154:155], v[154:155], v[4:5]
    v_pk_mul_f32 v[156:157], v[156:157], v[4:5]
    v_pk_mul_f32 v[158:159], v[158:159], v[4:5]
    v_pk_mul_f32 v[160:161], v[160:161], v[4:5]
    v_pk_mul_f32 v[162:163], v[162:163], v[4:5]
    v_pk_mul_f32 v[164:165], v[164:165], v[4:5]
    v_pk_mul_f32 v[166:167], v[166:167], v[4:5]
    v_pk_mul_f32 v[168:169], v[168:169], v[4:5]
    v_pk_mul_f32 v[170:171], v[170:171], v[4:5]
    v_pk_mul_f32 v[172:173], v[172:173], v[4:5]
    v_pk_mul_f32 v[174:175], v[174:175], v[4:5]
    v_pk_mul_f32 v[176:177], v[176:177], v[4:5]
    v_pk_mul_f32 v[178:179], v[178:179], v[4:5]
    v_pk_mul_f32 v[180:181], v[180:181], v[4:5]
    v_pk_mul_f32 v[182:183], v[182:183], v[4:5]
    v_pk_mul_f32 v[184:185], v[184:185], v[4:5]
    v_pk_mul_f32 v[186:187], v[186:187], v[4:5]
    v_pk_mul_f32 v[188:189], v[188:189], v[4:5]
    v_pk_mul_f32 v[190:191], v[190:191], v[4:5]
    v_pk_mul_f32 v[192:193], v[192:193], v[4:5]
    v_pk_mul_f32 v[194:195], v[194:195], v[4:5]
    v_pk_mul_f32 v[196:197], v[196:197], v[4:5]
    v_pk_mul_f32 v[198:199], v[198:199], v[4:5]
    v_cvt_pk_bf16_f32 v88, v144, v145
    v_cvt_pk_bf16_f32 v89, v146, v147
    v_cvt_pk_bf16_f32 v90, v172, v173
    v_cvt_pk_bf16_f32 v91, v174, v175
    v_cvt_pk_bf16_f32 v92, v148, v149
    v_cvt_pk_bf16_f32 v93, v150, v151
    v_cvt_pk_bf16_f32 v94, v176, v177
    v_cvt_pk_bf16_f32 v95, v178, v179
    v_cvt_pk_bf16_f32 v96, v152, v153
    v_cvt_pk_bf16_f32 v97, v154, v155
    v_cvt_pk_bf16_f32 v98, v180, v181
    v_cvt_pk_bf16_f32 v99, v182, v183
    v_cvt_pk_bf16_f32 v100, v156, v157
    v_cvt_pk_bf16_f32 v101, v158, v159
    v_cvt_pk_bf16_f32 v102, v184, v185
    v_cvt_pk_bf16_f32 v103, v186, v187
    v_cvt_pk_bf16_f32 v104, v160, v161
    v_cvt_pk_bf16_f32 v105, v162, v163
    v_cvt_pk_bf16_f32 v106, v188, v189
    v_cvt_pk_bf16_f32 v107, v190, v191
    v_cvt_pk_bf16_f32 v108, v164, v165
    v_cvt_pk_bf16_f32 v109, v166, v167
    v_cvt_pk_bf16_f32 v110, v192, v193
    v_cvt_pk_bf16_f32 v111, v194, v195
    v_cvt_pk_bf16_f32 v112, v168, v169
    v_cvt_pk_bf16_f32 v113, v170, v171
    v_cvt_pk_bf16_f32 v114, v196, v197
    v_cvt_pk_bf16_f32 v115, v198, v199
    s_nop 1
    v_permlane16_swap_b32 v88, v90
    v_permlane16_swap_b32 v89, v91
    v_permlane16_swap_b32 v92, v94
    v_permlane16_swap_b32 v93, v95
    v_permlane16_swap_b32 v96, v98
    v_permlane16_swap_b32 v97, v99
    v_permlane16_swap_b32 v100, v102
    v_permlane16_swap_b32 v101, v103
    v_permlane16_swap_b32 v104, v106
    v_permlane16_swap_b32 v105, v107
    v_permlane16_swap_b32 v108, v110
    v_permlane16_swap_b32 v109, v111
    v_permlane16_swap_b32 v112, v114
    v_permlane16_swap_b32 v113, v115
    v_accvgpr_write_b32 a0, v88
    v_accvgpr_write_b32 a1, v89
    v_accvgpr_write_b32 a2, v90
    v_accvgpr_write_b32 a3, v91
    v_accvgpr_write_b32 a16, v92
    v_accvgpr_write_b32 a17, v93
    v_accvgpr_write_b32 a18, v94
    v_accvgpr_write_b32 a19, v95
    v_accvgpr_write_b32 a32, v96
    v_accvgpr_write_b32 a33, v97
    v_accvgpr_write_b32 a34, v98
    v_accvgpr_write_b32 a35, v99
    v_accvgpr_write_b32 a48, v100
    v_accvgpr_write_b32 a49, v101
    v_accvgpr_write_b32 a50, v102
    v_accvgpr_write_b32 a51, v103
    v_accvgpr_write_b32 a64, v104
    v_accvgpr_write_b32 a65, v105
    v_accvgpr_write_b32 a66, v106
    v_accvgpr_write_b32 a67, v107
    v_accvgpr_write_b32 a80, v108
    v_accvgpr_write_b32 a81, v109
    v_accvgpr_write_b32 a82, v110
    v_accvgpr_write_b32 a83, v111
    v_accvgpr_write_b32 a96, v112
    v_accvgpr_write_b32 a97, v113
    v_accvgpr_write_b32 a98, v114
    v_accvgpr_write_b32 a99, v115
    v_pk_mul_f32 v[200:201], v[200:201], v[4:5]
    v_pk_mul_f32 v[202:203], v[202:203], v[4:5]
    v_pk_mul_f32 v[204:205], v[204:205], v[4:5]
    v_pk_mul_f32 v[206:207], v[206:207], v[4:5]
    v_pk_mul_f32 v[208:209], v[208:209], v[4:5]
    v_pk_mul_f32 v[210:211], v[210:211], v[4:5]
    v_pk_mul_f32 v[212:213], v[212:213], v[4:5]
    v_pk_mul_f32 v[214:215], v[214:215], v[4:5]
    v_pk_mul_f32 v[216:217], v[216:217], v[4:5]
    v_pk_mul_f32 v[218:219], v[218:219], v[4:5]
    v_pk_mul_f32 v[220:221], v[220:221], v[4:5]
    v_pk_mul_f32 v[222:223], v[222:223], v[4:5]
    v_pk_mul_f32 v[224:225], v[224:225], v[4:5]
    v_pk_mul_f32 v[226:227], v[226:227], v[4:5]
    v_pk_mul_f32 v[228:229], v[228:229], v[4:5]
    v_pk_mul_f32 v[230:231], v[230:231], v[4:5]
    v_pk_mul_f32 v[232:233], v[232:233], v[4:5]
    v_pk_mul_f32 v[234:235], v[234:235], v[4:5]
    v_pk_mul_f32 v[236:237], v[236:237], v[4:5]
    v_pk_mul_f32 v[238:239], v[238:239], v[4:5]
    v_pk_mul_f32 v[240:241], v[240:241], v[4:5]
    v_pk_mul_f32 v[242:243], v[242:243], v[4:5]
    v_pk_mul_f32 v[244:245], v[244:245], v[4:5]
    v_pk_mul_f32 v[246:247], v[246:247], v[4:5]
    v_pk_mul_f32 v[248:249], v[248:249], v[4:5]
    v_pk_mul_f32 v[250:251], v[250:251], v[4:5]
    v_pk_mul_f32 v[252:253], v[252:253], v[4:5]
    v_pk_mul_f32 v[254:255], v[254:255], v[4:5]
    v_cvt_pk_bf16_f32 v116, v200, v201
    v_cvt_pk_bf16_f32 v117, v202, v203
    v_cvt_pk_bf16_f32 v118, v228, v229
    v_cvt_pk_bf16_f32 v119, v230, v231
    v_cvt_pk_bf16_f32 v120, v204, v205
    v_cvt_pk_bf16_f32 v121, v206, v207
    v_cvt_pk_bf16_f32 v122, v232, v233
    v_cvt_pk_bf16_f32 v123, v234, v235
    v_cvt_pk_bf16_f32 v124, v208, v209
    v_cvt_pk_bf16_f32 v125, v210, v211
    v_cvt_pk_bf16_f32 v126, v236, v237
    v_cvt_pk_bf16_f32 v127, v238, v239
    v_cvt_pk_bf16_f32 v128, v212, v213
    v_cvt_pk_bf16_f32 v129, v214, v215
    v_cvt_pk_bf16_f32 v130, v240, v241
    v_cvt_pk_bf16_f32 v131, v242, v243
    v_cvt_pk_bf16_f32 v132, v216, v217
    v_cvt_pk_bf16_f32 v133, v218, v219
    v_cvt_pk_bf16_f32 v134, v244, v245
    v_cvt_pk_bf16_f32 v135, v246, v247
    v_cvt_pk_bf16_f32 v136, v220, v221
    v_cvt_pk_bf16_f32 v137, v222, v223
    v_cvt_pk_bf16_f32 v138, v248, v249
    v_cvt_pk_bf16_f32 v139, v250, v251
    v_cvt_pk_bf16_f32 v140, v224, v225
    v_cvt_pk_bf16_f32 v141, v226, v227
    v_cvt_pk_bf16_f32 v142, v252, v253
    v_cvt_pk_bf16_f32 v143, v254, v255
    s_nop 1
    v_permlane16_swap_b32 v116, v118
    v_permlane16_swap_b32 v117, v119
    v_permlane16_swap_b32 v120, v122
    v_permlane16_swap_b32 v121, v123
    v_permlane16_swap_b32 v124, v126
    v_permlane16_swap_b32 v125, v127
    v_permlane16_swap_b32 v128, v130
    v_permlane16_swap_b32 v129, v131
    v_permlane16_swap_b32 v132, v134
    v_permlane16_swap_b32 v133, v135
    v_permlane16_swap_b32 v136, v138
    v_permlane16_swap_b32 v137, v139
    v_permlane16_swap_b32 v140, v142
    v_permlane16_swap_b32 v141, v143
    v_accvgpr_write_b32 a4, v116
    v_accvgpr_write_b32 a5, v117
    v_accvgpr_write_b32 a6, v118
    v_accvgpr_write_b32 a7, v119
    v_accvgpr_write_b32 a20, v120
    v_accvgpr_write_b32 a21, v121
    v_accvgpr_write_b32 a22, v122
    v_accvgpr_write_b32 a23, v123
    v_accvgpr_write_b32 a36, v124
    v_accvgpr_write_b32 a37, v125
    v_accvgpr_write_b32 a38, v126
    v_accvgpr_write_b32 a39, v127
    v_accvgpr_write_b32 a52, v128
    v_accvgpr_write_b32 a53, v129
    v_accvgpr_write_b32 a54, v130
    v_accvgpr_write_b32 a55, v131
    v_accvgpr_write_b32 a68, v132
    v_accvgpr_write_b32 a69, v133
    v_accvgpr_write_b32 a70, v134
    v_accvgpr_write_b32 a71, v135
    v_accvgpr_write_b32 a84, v136
    v_accvgpr_write_b32 a85, v137
    v_accvgpr_write_b32 a86, v138
    v_accvgpr_write_b32 a87, v139
    v_accvgpr_write_b32 a100, v140
    v_accvgpr_write_b32 a101, v141
    v_accvgpr_write_b32 a102, v142
    v_accvgpr_write_b32 a103, v143
    v_accvgpr_read_b32 v144, a112
    v_accvgpr_read_b32 v145, a113
    v_accvgpr_read_b32 v146, a114
    v_accvgpr_read_b32 v147, a115
    v_accvgpr_read_b32 v148, a116
    v_accvgpr_read_b32 v149, a117
    v_accvgpr_read_b32 v150, a118
    v_accvgpr_read_b32 v151, a119
    v_accvgpr_read_b32 v152, a120
    v_accvgpr_read_b32 v153, a121
    v_accvgpr_read_b32 v154, a122
    v_accvgpr_read_b32 v155, a123
    v_accvgpr_read_b32 v156, a124
    v_accvgpr_read_b32 v157, a125
    v_accvgpr_read_b32 v158, a126
    v_accvgpr_read_b32 v159, a127
    v_accvgpr_read_b32 v160, a128
    v_accvgpr_read_b32 v161, a129
    v_accvgpr_read_b32 v162, a130
    v_accvgpr_read_b32 v163, a131
    v_accvgpr_read_b32 v164, a132
    v_accvgpr_read_b32 v165, a133
    v_accvgpr_read_b32 v166, a134
    v_accvgpr_read_b32 v167, a135
    v_accvgpr_read_b32 v168, a136
    v_accvgpr_read_b32 v169, a137
    v_accvgpr_read_b32 v170, a138
    v_accvgpr_read_b32 v171, a139
    v_accvgpr_read_b32 v172, a140
    v_accvgpr_read_b32 v173, a141
    v_accvgpr_read_b32 v174, a142
    v_accvgpr_read_b32 v175, a143
    v_accvgpr_read_b32 v176, a144
    v_accvgpr_read_b32 v177, a145
    v_accvgpr_read_b32 v178, a146
    v_accvgpr_read_b32 v179, a147
    v_accvgpr_read_b32 v180, a148
    v_accvgpr_read_b32 v181, a149
    v_accvgpr_read_b32 v182, a150
    v_accvgpr_read_b32 v183, a151
    v_accvgpr_read_b32 v184, a152
    v_accvgpr_read_b32 v185, a153
    v_accvgpr_read_b32 v186, a154
    v_accvgpr_read_b32 v187, a155
    v_accvgpr_read_b32 v188, a156
    v_accvgpr_read_b32 v189, a157
    v_accvgpr_read_b32 v190, a158
    v_accvgpr_read_b32 v191, a159
    v_accvgpr_read_b32 v192, a160
    v_accvgpr_read_b32 v193, a161
    v_accvgpr_read_b32 v194, a162
    v_accvgpr_read_b32 v195, a163
    v_accvgpr_read_b32 v196, a164
    v_accvgpr_read_b32 v197, a165
    v_accvgpr_read_b32 v198, a166
    v_accvgpr_read_b32 v199, a167
    v_pk_mul_f32 v[144:145], v[144:145], v[4:5]
    v_pk_mul_f32 v[146:147], v[146:147], v[4:5]
    v_pk_mul_f32 v[148:149], v[148:149], v[4:5]
    v_pk_mul_f32 v[150:151], v[150:151], v[4:5]
    v_pk_mul_f32 v[152:153], v[152:153], v[4:5]
    v_pk_mul_f32 v[154:155], v[154:155], v[4:5]
    v_pk_mul_f32 v[156:157], v[156:157], v[4:5]
    v_pk_mul_f32 v[158:159], v[158:159], v[4:5]
    v_pk_mul_f32 v[160:161], v[160:161], v[4:5]
    v_pk_mul_f32 v[162:163], v[162:163], v[4:5]
    v_pk_mul_f32 v[164:165], v[164:165], v[4:5]
    v_pk_mul_f32 v[166:167], v[166:167], v[4:5]
    v_pk_mul_f32 v[168:169], v[168:169], v[4:5]
    v_pk_mul_f32 v[170:171], v[170:171], v[4:5]
    v_pk_mul_f32 v[172:173], v[172:173], v[4:5]
    v_pk_mul_f32 v[174:175], v[174:175], v[4:5]
    v_pk_mul_f32 v[176:177], v[176:177], v[4:5]
    v_pk_mul_f32 v[178:179], v[178:179], v[4:5]
    v_pk_mul_f32 v[180:181], v[180:181], v[4:5]
    v_pk_mul_f32 v[182:183], v[182:183], v[4:5]
    v_pk_mul_f32 v[184:185], v[184:185], v[4:5]
    v_pk_mul_f32 v[186:187], v[186:187], v[4:5]
    v_pk_mul_f32 v[188:189], v[188:189], v[4:5]
    v_pk_mul_f32 v[190:191], v[190:191], v[4:5]
    v_pk_mul_f32 v[192:193], v[192:193], v[4:5]
    v_pk_mul_f32 v[194:195], v[194:195], v[4:5]
    v_pk_mul_f32 v[196:197], v[196:197], v[4:5]
    v_pk_mul_f32 v[198:199], v[198:199], v[4:5]
    v_cvt_pk_bf16_f32 v88, v144, v145
    v_cvt_pk_bf16_f32 v89, v146, v147
    v_cvt_pk_bf16_f32 v90, v172, v173
    v_cvt_pk_bf16_f32 v91, v174, v175
    v_cvt_pk_bf16_f32 v92, v148, v149
    v_cvt_pk_bf16_f32 v93, v150, v151
    v_cvt_pk_bf16_f32 v94, v176, v177
    v_cvt_pk_bf16_f32 v95, v178, v179
    v_cvt_pk_bf16_f32 v96, v152, v153
    v_cvt_pk_bf16_f32 v97, v154, v155
    v_cvt_pk_bf16_f32 v98, v180, v181
    v_cvt_pk_bf16_f32 v99, v182, v183
    v_cvt_pk_bf16_f32 v100, v156, v157
    v_cvt_pk_bf16_f32 v101, v158, v159
    v_cvt_pk_bf16_f32 v102, v184, v185
    v_cvt_pk_bf16_f32 v103, v186, v187
    v_cvt_pk_bf16_f32 v104, v160, v161
    v_cvt_pk_bf16_f32 v105, v162, v163
    v_cvt_pk_bf16_f32 v106, v188, v189
    v_cvt_pk_bf16_f32 v107, v190, v191
    v_cvt_pk_bf16_f32 v108, v164, v165
    v_cvt_pk_bf16_f32 v109, v166, v167
    v_cvt_pk_bf16_f32 v110, v192, v193
    v_cvt_pk_bf16_f32 v111, v194, v195
    v_cvt_pk_bf16_f32 v112, v168, v169
    v_cvt_pk_bf16_f32 v113, v170, v171
    v_cvt_pk_bf16_f32 v114, v196, v197
    v_cvt_pk_bf16_f32 v115, v198, v199
    s_nop 1
    v_permlane16_swap_b32 v88, v90
    v_permlane16_swap_b32 v89, v91
    v_permlane16_swap_b32 v92, v94
    v_permlane16_swap_b32 v93, v95
    v_permlane16_swap_b32 v96, v98
    v_permlane16_swap_b32 v97, v99
    v_permlane16_swap_b32 v100, v102
    v_permlane16_swap_b32 v101, v103
    v_permlane16_swap_b32 v104, v106
    v_permlane16_swap_b32 v105, v107
    v_permlane16_swap_b32 v108, v110
    v_permlane16_swap_b32 v109, v111
    v_permlane16_swap_b32 v112, v114
    v_permlane16_swap_b32 v113, v115
    v_accvgpr_write_b32 a8, v88
    v_accvgpr_write_b32 a9, v89
    v_accvgpr_write_b32 a10, v90
    v_accvgpr_write_b32 a11, v91
    v_accvgpr_write_b32 a24, v92
    v_accvgpr_write_b32 a25, v93
    v_accvgpr_write_b32 a26, v94
    v_accvgpr_write_b32 a27, v95
    v_accvgpr_write_b32 a40, v96
    v_accvgpr_write_b32 a41, v97
    v_accvgpr_write_b32 a42, v98
    v_accvgpr_write_b32 a43, v99
    v_accvgpr_write_b32 a56, v100
    v_accvgpr_write_b32 a57, v101
    v_accvgpr_write_b32 a58, v102
    v_accvgpr_write_b32 a59, v103
    v_accvgpr_write_b32 a72, v104
    v_accvgpr_write_b32 a73, v105
    v_accvgpr_write_b32 a74, v106
    v_accvgpr_write_b32 a75, v107
    v_accvgpr_write_b32 a88, v108
    v_accvgpr_write_b32 a89, v109
    v_accvgpr_write_b32 a90, v110
    v_accvgpr_write_b32 a91, v111
    v_accvgpr_write_b32 a104, v112
    v_accvgpr_write_b32 a105, v113
    v_accvgpr_write_b32 a106, v114
    v_accvgpr_write_b32 a107, v115
    v_accvgpr_read_b32 v200, a168
    v_accvgpr_read_b32 v201, a169
    v_accvgpr_read_b32 v202, a170
    v_accvgpr_read_b32 v203, a171
    v_accvgpr_read_b32 v204, a172
    v_accvgpr_read_b32 v205, a173
    v_accvgpr_read_b32 v206, a174
    v_accvgpr_read_b32 v207, a175
    v_accvgpr_read_b32 v208, a176
    v_accvgpr_read_b32 v209, a177
    v_accvgpr_read_b32 v210, a178
    v_accvgpr_read_b32 v211, a179
    v_accvgpr_read_b32 v212, a180
    v_accvgpr_read_b32 v213, a181
    v_accvgpr_read_b32 v214, a182
    v_accvgpr_read_b32 v215, a183
    v_accvgpr_read_b32 v216, a184
    v_accvgpr_read_b32 v217, a185
    v_accvgpr_read_b32 v218, a186
    v_accvgpr_read_b32 v219, a187
    v_accvgpr_read_b32 v220, a188
    v_accvgpr_read_b32 v221, a189
    v_accvgpr_read_b32 v222, a190
    v_accvgpr_read_b32 v223, a191
    v_accvgpr_read_b32 v224, a192
    v_accvgpr_read_b32 v225, a193
    v_accvgpr_read_b32 v226, a194
    v_accvgpr_read_b32 v227, a195
    v_accvgpr_read_b32 v228, a196
    v_accvgpr_read_b32 v229, a197
    v_accvgpr_read_b32 v230, a198
    v_accvgpr_read_b32 v231, a199
    v_accvgpr_read_b32 v232, a200
    v_accvgpr_read_b32 v233, a201
    v_accvgpr_read_b32 v234, a202
    v_accvgpr_read_b32 v235, a203
    v_accvgpr_read_b32 v236, a204
    v_accvgpr_read_b32 v237, a205
    v_accvgpr_read_b32 v238, a206
    v_accvgpr_read_b32 v239, a207
    v_accvgpr_read_b32 v240, a208
    v_accvgpr_read_b32 v241, a209
    v_accvgpr_read_b32 v242, a210
    v_accvgpr_read_b32 v243, a211
    v_accvgpr_read_b32 v244, a212
    v_accvgpr_read_b32 v245, a213
    v_accvgpr_read_b32 v246, a214
    v_accvgpr_read_b32 v247, a215
    v_accvgpr_read_b32 v248, a216
    v_accvgpr_read_b32 v249, a217
    v_accvgpr_read_b32 v250, a218
    v_accvgpr_read_b32 v251, a219
    v_accvgpr_read_b32 v252, a220
    v_accvgpr_read_b32 v253, a221
    v_accvgpr_read_b32 v254, a222
    v_accvgpr_read_b32 v255, a223
    v_pk_mul_f32 v[200:201], v[200:201], v[4:5]
    v_pk_mul_f32 v[202:203], v[202:203], v[4:5]
    v_pk_mul_f32 v[204:205], v[204:205], v[4:5]
    v_pk_mul_f32 v[206:207], v[206:207], v[4:5]
    v_pk_mul_f32 v[208:209], v[208:209], v[4:5]
    v_pk_mul_f32 v[210:211], v[210:211], v[4:5]
    v_pk_mul_f32 v[212:213], v[212:213], v[4:5]
    v_pk_mul_f32 v[214:215], v[214:215], v[4:5]
    v_pk_mul_f32 v[216:217], v[216:217], v[4:5]
    v_pk_mul_f32 v[218:219], v[218:219], v[4:5]
    v_pk_mul_f32 v[220:221], v[220:221], v[4:5]
    v_pk_mul_f32 v[222:223], v[222:223], v[4:5]
    v_pk_mul_f32 v[224:225], v[224:225], v[4:5]
    v_pk_mul_f32 v[226:227], v[226:227], v[4:5]
    v_pk_mul_f32 v[228:229], v[228:229], v[4:5]
    v_pk_mul_f32 v[230:231], v[230:231], v[4:5]
    v_pk_mul_f32 v[232:233], v[232:233], v[4:5]
    v_pk_mul_f32 v[234:235], v[234:235], v[4:5]
    v_pk_mul_f32 v[236:237], v[236:237], v[4:5]
    v_pk_mul_f32 v[238:239], v[238:239], v[4:5]
    v_pk_mul_f32 v[240:241], v[240:241], v[4:5]
    v_pk_mul_f32 v[242:243], v[242:243], v[4:5]
    v_pk_mul_f32 v[244:245], v[244:245], v[4:5]
    v_pk_mul_f32 v[246:247], v[246:247], v[4:5]
    v_pk_mul_f32 v[248:249], v[248:249], v[4:5]
    v_pk_mul_f32 v[250:251], v[250:251], v[4:5]
    v_pk_mul_f32 v[252:253], v[252:253], v[4:5]
    v_pk_mul_f32 v[254:255], v[254:255], v[4:5]
    v_cvt_pk_bf16_f32 v116, v200, v201
    v_cvt_pk_bf16_f32 v117, v202, v203
    v_cvt_pk_bf16_f32 v118, v228, v229
    v_cvt_pk_bf16_f32 v119, v230, v231
    v_cvt_pk_bf16_f32 v120, v204, v205
    v_cvt_pk_bf16_f32 v121, v206, v207
    v_cvt_pk_bf16_f32 v122, v232, v233
    v_cvt_pk_bf16_f32 v123, v234, v235
    v_cvt_pk_bf16_f32 v124, v208, v209
    v_cvt_pk_bf16_f32 v125, v210, v211
    v_cvt_pk_bf16_f32 v126, v236, v237
    v_cvt_pk_bf16_f32 v127, v238, v239
    v_cvt_pk_bf16_f32 v128, v212, v213
    v_cvt_pk_bf16_f32 v129, v214, v215
    v_cvt_pk_bf16_f32 v130, v240, v241
    v_cvt_pk_bf16_f32 v131, v242, v243
    v_cvt_pk_bf16_f32 v132, v216, v217
    v_cvt_pk_bf16_f32 v133, v218, v219
    v_cvt_pk_bf16_f32 v134, v244, v245
    v_cvt_pk_bf16_f32 v135, v246, v247
    v_cvt_pk_bf16_f32 v136, v220, v221
    v_cvt_pk_bf16_f32 v137, v222, v223
    v_cvt_pk_bf16_f32 v138, v248, v249
    v_cvt_pk_bf16_f32 v139, v250, v251
    v_cvt_pk_bf16_f32 v140, v224, v225
    v_cvt_pk_bf16_f32 v141, v226, v227
    v_cvt_pk_bf16_f32 v142, v252, v253
    v_cvt_pk_bf16_f32 v143, v254, v255
    s_nop 1
    v_permlane16_swap_b32 v116, v118
    v_permlane16_swap_b32 v117, v119
    v_permlane16_swap_b32 v120, v122
    v_permlane16_swap_b32 v121, v123
    v_permlane16_swap_b32 v124, v126
    v_permlane16_swap_b32 v125, v127
    v_permlane16_swap_b32 v128, v130
    v_permlane16_swap_b32 v129, v131
    v_permlane16_swap_b32 v132, v134
    v_permlane16_swap_b32 v133, v135
    v_permlane16_swap_b32 v136, v138
    v_permlane16_swap_b32 v137, v139
    v_permlane16_swap_b32 v140, v142
    v_permlane16_swap_b32 v141, v143
    v_accvgpr_write_b32 a12, v116
    v_accvgpr_write_b32 a13, v117
    v_accvgpr_write_b32 a14, v118
    v_accvgpr_write_b32 a15, v119
    v_accvgpr_write_b32 a28, v120
    v_accvgpr_write_b32 a29, v121
    v_accvgpr_write_b32 a30, v122
    v_accvgpr_write_b32 a31, v123
    v_accvgpr_write_b32 a44, v124
    v_accvgpr_write_b32 a45, v125
    v_accvgpr_write_b32 a46, v126
    v_accvgpr_write_b32 a47, v127
    v_accvgpr_write_b32 a60, v128
    v_accvgpr_write_b32 a61, v129
    v_accvgpr_write_b32 a62, v130
    v_accvgpr_write_b32 a63, v131
    v_accvgpr_write_b32 a76, v132
    v_accvgpr_write_b32 a77, v133
    v_accvgpr_write_b32 a78, v134
    v_accvgpr_write_b32 a79, v135
    v_accvgpr_write_b32 a92, v136
    v_accvgpr_write_b32 a93, v137
    v_accvgpr_write_b32 a94, v138
    v_accvgpr_write_b32 a95, v139
    v_accvgpr_write_b32 a108, v140
    v_accvgpr_write_b32 a109, v141
    v_accvgpr_write_b32 a110, v142
    v_accvgpr_write_b32 a111, v143
    s_cmp_eq_u32 s70, 0
    s_cbranch_scc1 L_at_nostash
    s_mov_b32 s70, 0
    s_lshl_b32 s30, s2, 2
    s_add_u32 s30, s30, s20
    s_mul_i32 s30, s30, 28672
    v_lshlrev_b32 v4, 4, v1
    buffer_store_dwordx4 a[0:3], v4, s[12:15], s30 offen offset:0
    buffer_store_dwordx4 a[4:7], v4, s[12:15], s30 offen offset:1024
    buffer_store_dwordx4 a[8:11], v4, s[12:15], s30 offen offset:2048
    buffer_store_dwordx4 a[12:15], v4, s[12:15], s30 offen offset:3072
    s_add_u32 s30, s30, 4096
    buffer_store_dwordx4 a[16:19], v4, s[12:15], s30 offen offset:0
    buffer_store_dwordx4 a[20:23], v4, s[12:15], s30 offen offset:1024
    buffer_store_dwordx4 a[24:27], v4, s[12:15], s30 offen offset:2048
    buffer_store_dwordx4 a[28:31], v4, s[12:15], s30 offen offset:3072
    s_add_u32 s30, s30, 4096
    buffer_store_dwordx4 a[32:35], v4, s[12:15], s30 offen offset:0
    buffer_store_dwordx4 a[36:39], v4, s[12:15], s30 offen offset:1024
    buffer_store_dwordx4 a[40:43], v4, s[12:15], s30 offen offset:2048
    buffer_store_dwordx4 a[44:47], v4, s[12:15], s30 offen offset:3072
    s_add_u32 s30, s30, 4096
    buffer_store_dwordx4 a[48:51], v4, s[12:15], s30 offen offset:0
    buffer_store_dwordx4 a[52:55], v4, s[12:15], s30 offen offset:1024
    buffer_store_dwordx4 a[56:59], v4, s[12:15], s30 offen offset:2048
    buffer_store_dwordx4 a[60:63], v4, s[12:15], s30 offen offset:3072
    s_add_u32 s30, s30, 4096
    buffer_store_dwordx4 a[64:67], v4, s[12:15], s30 offen offset:0
    buffer_store_dwordx4 a[68:71], v4, s[12:15], s30 offen offset:1024
    buffer_store_dwordx4 a[72:75], v4, s[12:15], s30 offen offset:2048
    buffer_store_dwordx4 a[76:79], v4, s[12:15], s30 offen offset:3072
    s_add_u32 s30, s30, 4096
    buffer_store_dwordx4 a[80:83], v4, s[12:15], s30 offen offset:0
    buffer_store_dwordx4 a[84:87], v4, s[12:15], s30 offen offset:1024
    buffer_store_dwordx4 a[88:91], v4, s[12:15], s30 offen offset:2048
    buffer_store_dwordx4 a[92:95], v4, s[12:15], s30 offen offset:3072
    s_add_u32 s30, s30, 4096
    buffer_store_dwordx4 a[96:99], v4, s[12:15], s30 offen offset:0
    buffer_store_dwordx4 a[100:103], v4, s[12:15], s30 offen offset:1024
    buffer_store_dwordx4 a[104:107], v4, s[12:15], s30 offen offset:2048
    buffer_store_dwordx4 a[108:111], v4, s[12:15], s30 offen offset:3072
    s_mov_b32 s68, 3
    s_branch L_at_round
L_at_nostash:
    s_cmp_lg_u32 s25, 0
    s_cbranch_scc1 L_at_maxpass
L_at_pre:
L_at_nowo1:
    s_waitcnt lgkmcnt(0)
    v_mfma_f32_16x16x32_bf16 v[88:91], v[56:59], a[0:3], 0
    v_mov_b32 v168, 0
    v_mov_b32 v169, 0
    v_mfma_f32_16x16x32_bf16 v[88:91], v[60:63], a[4:7], v[88:91]
    v_mov_b32 v170, 0
    v_mov_b32 v171, 0
    v_mfma_f32_16x16x32_bf16 v[88:91], v[64:67], a[8:11], v[88:91]
    v_mov_b32 v196, 0
    v_mov_b32 v197, 0
    v_mfma_f32_16x16x32_bf16 v[88:91], v[68:71], a[12:15], v[88:91]
    v_mov_b32 v198, 0
    v_mov_b32 v199, 0
    v_mfma_f32_16x16x32_bf16 v[92:95], v[84:87], a[12:15], 0
    v_mov_b32 v224, 0
    v_mov_b32 v225, 0
    v_mfma_f32_16x16x32_bf16 v[92:95], v[80:83], a[8:11], v[92:95]
    v_mov_b32 v226, 0
    v_mov_b32 v227, 0
    v_mfma_f32_16x16x32_bf16 v[92:95], v[76:79], a[4:7], v[92:95]
    v_mov_b32 v252, 0
    v_mov_b32 v253, 0
    v_mfma_f32_16x16x32_bf16 v[92:95], v[72:75], a[0:3], v[92:95]
    v_mov_b32 v254, 0
    v_mov_b32 v255, 0
    v_accvgpr_write_b32 a136, 0
    v_accvgpr_write_b32 a137, 0
    v_accvgpr_write_b32 a138, 0
    v_accvgpr_write_b32 a139, 0
    v_accvgpr_write_b32 a164, 0
    v_accvgpr_write_b32 a165, 0
    v_accvgpr_write_b32 a166, 0
    v_accvgpr_write_b32 a167, 0
    v_accvgpr_write_b32 a192, 0
    v_accvgpr_write_b32 a193, 0
    v_accvgpr_write_b32 a194, 0
    v_accvgpr_write_b32 a195, 0
    v_accvgpr_write_b32 a220, 0
    v_accvgpr_write_b32 a221, 0
    v_accvgpr_write_b32 a222, 0
    v_accvgpr_write_b32 a223, 0
    v_mfma_f32_16x16x32_bf16 v[96:99], v[56:59], a[16:19], 0
    v_max3_f32 v2, v88, v89, v12
    v_max3_f32 v3, v90, v91, v92
    v_max3_f32 v2, v93, v94, v2
    v_mfma_f32_16x16x32_bf16 v[96:99], v[60:63], a[20:23], v[96:99]
    v_max3_f32 v2, v95, v2, v3
    v_mov_b32 v3, v2
    s_nop 1
    v_permlane16_swap_b32 v2, v3
    v_mfma_f32_16x16x32_bf16 v[96:99], v[64:67], a[24:27], v[96:99]
    s_nop 1
    v_max_f32 v2, v2, v3
    v_mov_b32 v3, v2
    v_mfma_f32_16x16x32_bf16 v[96:99], v[68:71], a[28:31], v[96:99]
    s_nop 1
    v_permlane32_swap_b32 v2, v3
    s_nop 1
    v_max_f32 v2, v2, v3
    v_mfma_f32_16x16x32_bf16 v[100:103], v[84:87], a[28:31], 0
    v_mov_b32 v12, 0
    v_mov_b32 v13, 0
    v_sub_f32 v88, v88, v2
    v_mfma_f32_16x16x32_bf16 v[100:103], v[80:83], a[24:27], v[100:103]
    v_sub_f32 v89, v89, v2
    v_sub_f32 v90, v90, v2
    v_sub_f32 v91, v91, v2
    v_sub_f32 v92, v92, v2
    v_mfma_f32_16x16x32_bf16 v[100:103], v[76:79], a[20:23], v[100:103]
    v_sub_f32 v93, v93, v2
    v_sub_f32 v94, v94, v2
    v_sub_f32 v95, v95, v2
    v_mfma_f32_16x16x32_bf16 v[100:103], v[72:75], a[16:19], v[100:103]
    v_sub_f32 v28, 0, v2
    v_sub_f32 v29, 0, v2
    v_sub_f32 v30, 0, v2
    v_sub_f32 v31, 0, v2
    ds_read_b64_tr_b16 v[112:113], v9 offset:0
    ds_read_b64_tr_b16 v[114:115], v9 offset:512
    v_exp_f32 v88, v88
    ds_read_b64_tr_b16 v[116:117], v9 offset:32
    ds_read_b64_tr_b16 v[118:119], v9 offset:544
    v_exp_f32 v89, v89
    v_exp_f32 v90, v90
    ds_read_b64_tr_b16 v[120:121], v9 offset:64
    ds_read_b64_tr_b16 v[122:123], v9 offset:576
    v_exp_f32 v91, v91
    v_add_f32 v12, v12, v88
    v_add_f32 v13, v13, v89
    ds_read_b64_tr_b16 v[124:125], v9 offset:96
    ds_read_b64_tr_b16 v[126:127], v9 offset:608
    v_cvt_pk_bf16_f32 v104, v88, v89
    v_exp_f32 v92, v92
    ds_read_b64_tr_b16 v[128:129], v9 offset:128
    ds_read_b64_tr_b16 v[130:131], v9 offset:640
    v_exp_f32 v93, v93
    v_add_f32 v12, v12, v90
    v_add_f32 v13, v13, v91
    ds_read_b64_tr_b16 v[132:133], v9 offset:160
    ds_read_b64_tr_b16 v[134:135], v9 offset:672
    v_cvt_pk_bf16_f32 v105, v90, v91
    v_exp_f32 v94, v94
    ds_read_b64_tr_b16 v[136:137], v9 offset:192
    ds_read_b64_tr_b16 v[138:139], v9 offset:704
    v_exp_f32 v95, v95
    v_add_f32 v12, v12, v92
    v_add_f32 v13, v13, v93
    ds_read_b64_tr_b16 v[140:141], v9 offset:224
    ds_read_b64_tr_b16 v[142:143], v9 offset:736
    v_cvt_pk_bf16_f32 v106, v92, v93
    v_add_f32 v12, v12, v94
    v_add_f32 v13, v13, v95
    v_cvt_pk_bf16_f32 v107, v94, v95
    v_mfma_f32_16x16x32_bf16 v[88:91], v[56:59], a[32:35], 0
    v_max3_f32 v2, v96, v97, v14
    v_max3_f32 v3, v98, v99, v100
    v_max3_f32 v2, v101, v102, v2
    v_mfma_f32_16x16x32_bf16 v[88:91], v[60:63], a[36:39], v[88:91]
    v_max3_f32 v2, v103, v2, v3
    v_mov_b32 v3, v2
    s_nop 1
    v_permlane16_swap_b32 v2, v3
    v_mfma_f32_16x16x32_bf16 v[88:91], v[64:67], a[40:43], v[88:91]
    s_nop 1
    v_max_f32 v2, v2, v3
    v_mov_b32 v3, v2
    v_mfma_f32_16x16x32_bf16 v[88:91], v[68:71], a[44:47], v[88:91]
    s_nop 1
    v_permlane32_swap_b32 v2, v3
    s_nop 1
    v_max_f32 v2, v2, v3
    v_mfma_f32_16x16x32_bf16 v[92:95], v[84:87], a[44:47], 0
    v_mov_b32 v14, 0
    v_mov_b32 v15, 0
    v_sub_f32 v96, v96, v2
    v_mfma_f32_16x16x32_bf16 v[92:95], v[80:83], a[40:43], v[92:95]
    v_sub_f32 v97, v97, v2
    v_sub_f32 v98, v98, v2
    v_sub_f32 v99, v99, v2
    v_sub_f32 v100, v100, v2
    v_mfma_f32_16x16x32_bf16 v[92:95], v[76:79], a[36:39], v[92:95]
    v_sub_f32 v101, v101, v2
    v_sub_f32 v102, v102, v2
    v_sub_f32 v103, v103, v2
    v_mfma_f32_16x16x32_bf16 v[92:95], v[72:75], a[32:35], v[92:95]
    v_sub_f32 v32, 0, v2
    v_sub_f32 v33, 0, v2
    v_sub_f32 v34, 0, v2
    v_sub_f32 v35, 0, v2
    s_waitcnt lgkmcnt(0)
    v_mfma_f32_16x16x32_bf16 v[144:147], v[112:115], v[104:107], 0
    v_exp_f32 v96, v96
    v_mfma_f32_16x16x32_bf16 v[172:175], v[116:119], v[104:107], 0
    v_exp_f32 v97, v97
    v_exp_f32 v98, v98
    v_mfma_f32_16x16x32_bf16 v[200:203], v[120:123], v[104:107], 0
    v_exp_f32 v99, v99
    v_add_f32 v14, v14, v96
    v_add_f32 v15, v15, v97
    v_mfma_f32_16x16x32_bf16 v[228:231], v[124:127], v[104:107], 0
    v_cvt_pk_bf16_f32 v108, v96, v97
    v_exp_f32 v100, v100
    v_mfma_f32_16x16x32_bf16 a[112:115], v[128:131], v[104:107], 0
    v_exp_f32 v101, v101
    v_add_f32 v14, v14, v98
    v_add_f32 v15, v15, v99
    v_mfma_f32_16x16x32_bf16 a[140:143], v[132:135], v[104:107], 0
    v_cvt_pk_bf16_f32 v109, v98, v99
    v_exp_f32 v102, v102
    v_mfma_f32_16x16x32_bf16 a[168:171], v[136:139], v[104:107], 0
    v_exp_f32 v103, v103
    v_add_f32 v14, v14, v100
    v_add_f32 v15, v15, v101
    v_mfma_f32_16x16x32_bf16 a[196:199], v[140:143], v[104:107], 0
    v_cvt_pk_bf16_f32 v110, v100, v101
    v_add_f32 v14, v14, v102
    v_add_f32 v15, v15, v103
    v_cvt_pk_bf16_f32 v111, v102, v103
    v_mfma_f32_16x16x32_bf16 v[96:99], v[56:59], a[48:51], 0
    v_max3_f32 v2, v88, v89, v16
    v_max3_f32 v3, v90, v91, v92
    v_max3_f32 v2, v93, v94, v2
    v_mfma_f32_16x16x32_bf16 v[96:99], v[60:63], a[52:55], v[96:99]
    v_max3_f32 v2, v95, v2, v3
    v_mov_b32 v3, v2
    s_nop 1
    v_permlane16_swap_b32 v2, v3
    v_mfma_f32_16x16x32_bf16 v[96:99], v[64:67], a[56:59], v[96:99]
    s_nop 1
    v_max_f32 v2, v2, v3
    v_mov_b32 v3, v2
    v_mfma_f32_16x16x32_bf16 v[96:99], v[68:71], a[60:63], v[96:99]
    s_nop 1
    v_permlane32_swap_b32 v2, v3
    s_nop 1
    v_max_f32 v2, v2, v3
    v_mfma_f32_16x16x32_bf16 v[100:103], v[84:87], a[60:63], 0
    v_mov_b32 v16, 0
    v_mov_b32 v17, 0
    v_sub_f32 v88, v88, v2
    v_mfma_f32_16x16x32_bf16 v[100:103], v[80:83], a[56:59], v[100:103]
    v_sub_f32 v89, v89, v2
    v_sub_f32 v90, v90, v2
    v_sub_f32 v91, v91, v2
    v_sub_f32 v92, v92, v2
    v_mfma_f32_16x16x32_bf16 v[100:103], v[76:79], a[52:55], v[100:103]
    v_sub_f32 v93, v93, v2
    v_sub_f32 v94, v94, v2
    v_sub_f32 v95, v95, v2
    v_mfma_f32_16x16x32_bf16 v[100:103], v[72:75], a[48:51], v[100:103]
    v_sub_f32 v36, 0, v2
    v_sub_f32 v37, 0, v2
    v_sub_f32 v38, 0, v2
    v_sub_f32 v39, 0, v2
    v_mfma_f32_16x16x32_bf16 v[148:151], v[112:115], v[108:111], 0
    v_exp_f32 v88, v88
    v_mfma_f32_16x16x32_bf16 v[176:179], v[116:119], v[108:111], 0
    v_exp_f32 v89, v89
    v_exp_f32 v90, v90
    v_mfma_f32_16x16x32_bf16 v[204:207], v[120:123], v[108:111], 0
    v_exp_f32 v91, v91
    v_add_f32 v16, v16, v88
    v_add_f32 v17, v17, v89
    v_mfma_f32_16x16x32_bf16 v[232:235], v[124:127], v[108:111], 0
    v_cvt_pk_bf16_f32 v104, v88, v89
    v_exp_f32 v92, v92
    v_mfma_f32_16x16x32_bf16 a[116:119], v[128:131], v[108:111], 0
    v_exp_f32 v93, v93
    v_add_f32 v16, v16, v90
    v_add_f32 v17, v17, v91
    v_mfma_f32_16x16x32_bf16 a[144:147], v[132:135], v[108:111], 0
    v_cvt_pk_bf16_f32 v105, v90, v91
    v_exp_f32 v94, v94
    v_mfma_f32_16x16x32_bf16 a[172:175], v[136:139], v[108:111], 0
    v_exp_f32 v95, v95
    v_add_f32 v16, v16, v92
    v_add_f32 v17, v17, v93
    v_mfma_f32_16x16x32_bf16 a[200:203], v[140:143], v[108:111], 0
    v_cvt_pk_bf16_f32 v106, v92, v93
    v_add_f32 v16, v16, v94
    v_add_f32 v17, v17, v95
    v_cvt_pk_bf16_f32 v107, v94, v95
    v_mfma_f32_16x16x32_bf16 v[88:91], v[56:59], a[64:67], 0
    v_max3_f32 v2, v96, v97, v18
    v_max3_f32 v3, v98, v99, v100
    v_max3_f32 v2, v101, v102, v2
    v_mfma_f32_16x16x32_bf16 v[88:91], v[60:63], a[68:71], v[88:91]
    v_max3_f32 v2, v103, v2, v3
    v_mov_b32 v3, v2
    s_nop 1
    v_permlane16_swap_b32 v2, v3
    v_mfma_f32_16x16x32_bf16 v[88:91], v[64:67], a[72:75], v[88:91]
    s_nop 1
    v_max_f32 v2, v2, v3
    v_mov_b32 v3, v2
    v_mfma_f32_16x16x32_bf16 v[88:91], v[68:71], a[76:79], v[88:91]
    s_nop 1
    v_permlane32_swap_b32 v2, v3
    s_nop 1
    v_max_f32 v2, v2, v3
    v_mfma_f32_16x16x32_bf16 v[92:95], v[84:87], a[76:79], 0
    v_mov_b32 v18, 0
    v_mov_b32 v19, 0
    v_sub_f32 v96, v96, v2
    v_mfma_f32_16x16x32_bf16 v[92:95], v[80:83], a[72:75], v[92:95]
    v_sub_f32 v97, v97, v2
    v_sub_f32 v98, v98, v2
    v_sub_f32 v99, v99, v2
    v_sub_f32 v100, v100, v2
    v_mfma_f32_16x16x32_bf16 v[92:95], v[76:79], a[68:71], v[92:95]
    v_sub_f32 v101, v101, v2
    v_sub_f32 v102, v102, v2
    v_sub_f32 v103, v103, v2
    v_mfma_f32_16x16x32_bf16 v[92:95], v[72:75], a[64:67], v[92:95]
    v_sub_f32 v40, 0, v2
    v_sub_f32 v41, 0, v2
    v_sub_f32 v42, 0, v2
    v_sub_f32 v43, 0, v2
    v_mfma_f32_16x16x32_bf16 v[152:155], v[112:115], v[104:107], 0
    v_exp_f32 v96, v96
    v_mfma_f32_16x16x32_bf16 v[180:183], v[116:119], v[104:107], 0
    v_exp_f32 v97, v97
    v_exp_f32 v98, v98
    v_mfma_f32_16x16x32_bf16 v[208:211], v[120:123], v[104:107], 0
    v_exp_f32 v99, v99
    v_add_f32 v18, v18, v96
    v_add_f32 v19, v19, v97
    v_mfma_f32_16x16x32_bf16 v[236:239], v[124:127], v[104:107], 0
    v_cvt_pk_bf16_f32 v108, v96, v97
    v_exp_f32 v100, v100
    v_mfma_f32_16x16x32_bf16 a[120:123], v[128:131], v[104:107], 0
    v_exp_f32 v101, v101
    v_add_f32 v18, v18, v98
    v_add_f32 v19, v19, v99
    v_mfma_f32_16x16x32_bf16 a[148:151], v[132:135], v[104:107], 0
    v_cvt_pk_bf16_f32 v109, v98, v99
    v_exp_f32 v102, v102
    v_mfma_f32_16x16x32_bf16 a[176:179], v[136:139], v[104:107], 0
    v_exp_f32 v103, v103
    v_add_f32 v18, v18, v100
    v_add_f32 v19, v19, v101
    v_mfma_f32_16x16x32_bf16 a[204:207], v[140:143], v[104:107], 0
    v_cvt_pk_bf16_f32 v110, v100, v101
    v_add_f32 v18, v18, v102
    v_add_f32 v19, v19, v103
    v_cvt_pk_bf16_f32 v111, v102, v103
    v_mfma_f32_16x16x32_bf16 v[96:99], v[56:59], a[80:83], 0
    v_max3_f32 v2, v88, v89, v20
    v_max3_f32 v3, v90, v91, v92
    v_max3_f32 v2, v93, v94, v2
    v_mfma_f32_16x16x32_bf16 v[96:99], v[60:63], a[84:87], v[96:99]
    v_max3_f32 v2, v95, v2, v3
    v_mov_b32 v3, v2
    s_nop 1
    v_permlane16_swap_b32 v2, v3
    v_mfma_f32_16x16x32_bf16 v[96:99], v[64:67], a[88:91], v[96:99]
    s_nop 1
    v_max_f32 v2, v2, v3
    v_mov_b32 v3, v2
    v_mfma_f32_16x16x32_bf16 v[96:99], v[68:71], a[92:95], v[96:99]
    s_nop 1
    v_permlane32_swap_b32 v2, v3
    s_nop 1
    v_max_f32 v2, v2, v3
    v_mfma_f32_16x16x32_bf16 v[100:103], v[84:87], a[92:95], 0
    v_mov_b32 v20, 0
    v_mov_b32 v21, 0
    v_sub_f32 v88, v88, v2
    v_mfma_f32_16x16x32_bf16 v[100:103], v[80:83], a[88:91], v[100:103]
    v_sub_f32 v89, v89, v2
    v_sub_f32 v90, v90, v2
    v_sub_f32 v91, v91, v2
    v_sub_f32 v92, v92, v2
    v_mfma_f32_16x16x32_bf16 v[100:103], v[76:79], a[84:87], v[100:103]
    v_sub_f32 v93, v93, v2
    v_sub_f32 v94, v94, v2
    v_sub_f32 v95, v95, v2
    v_mfma_f32_16x16x32_bf16 v[100:103], v[72:75], a[80:83], v[100:103]
    v_sub_f32 v44, 0, v2
    v_sub_f32 v45, 0, v2
    v_sub_f32 v46, 0, v2
    v_sub_f32 v47, 0, v2
    v_mfma_f32_16x16x32_bf16 v[156:159], v[112:115], v[108:111], 0
    v_exp_f32 v88, v88
    v_mfma_f32_16x16x32_bf16 v[184:187], v[116:119], v[108:111], 0
    v_exp_f32 v89, v89
    v_exp_f32 v90, v90
    v_mfma_f32_16x16x32_bf16 v[212:215], v[120:123], v[108:111], 0
    v_exp_f32 v91, v91
    v_add_f32 v20, v20, v88
    v_add_f32 v21, v21, v89
    v_mfma_f32_16x16x32_bf16 v[240:243], v[124:127], v[108:111], 0
    v_cvt_pk_bf16_f32 v104, v88, v89
    v_exp_f32 v92, v92
    v_mfma_f32_16x16x32_bf16 a[124:127], v[128:131], v[108:111], 0
    v_exp_f32 v93, v93
    v_add_f32 v20, v20, v90
    v_add_f32 v21, v21, v91
    v_mfma_f32_16x16x32_bf16 a[152:155], v[132:135], v[108:111], 0
    v_cvt_pk_bf16_f32 v105, v90, v91
    v_exp_f32 v94, v94
    v_mfma_f32_16x16x32_bf16 a[180:183], v[136:139], v[108:111], 0
    v_exp_f32 v95, v95
    v_add_f32 v20, v20, v92
    v_add_f32 v21, v21, v93
    v_mfma_f32_16x16x32_bf16 a[208:211], v[140:143], v[108:111], 0
    v_cvt_pk_bf16_f32 v106, v92, v93
    v_add_f32 v20, v20, v94
    v_add_f32 v21, v21, v95
    v_cvt_pk_bf16_f32 v107, v94, v95
    s_cmp_eq_u32 s68, 0
    s_cbranch_scc0 L_bw1_3109
    s_waitcnt vmcnt(16) lgkmcnt(0)
L_bw2_3109:
    s_barrier
    s_cmp_le_u32 s21, s27
    s_cbranch_scc1 L_at_nofb_3114
    s_sub_u32 s28, s21, 1
    s_cmp_eq_u32 s28, s23
    s_cbranch_scc1 L_at_nofb_3114
    s_lshl_b32 s29, s28, 2
    s_add_u32 s29, s29, 76000
    v_mov_b32 v4, s29
    ds_read_b32 v4, v4
    s_waitcnt lgkmcnt(0)
    v_readfirstlane_b32 s29, v4
    s_nop 3
    s_cmp_lg_u32 s29, 0
    s_cbranch_scc1 L_at_fallback
L_at_nofb_3114:
    v_mfma_f32_16x16x32_bf16 v[88:91], v[56:59], a[96:99], 0
    ds_read_b128 v[56:59], v8 offset:8448
    v_max3_f32 v2, v96, v97, v22
    v_max3_f32 v3, v98, v99, v100
    v_max3_f32 v2, v101, v102, v2
    v_mfma_f32_16x16x32_bf16 v[88:91], v[60:63], a[100:103], v[88:91]
    ds_read_b128 v[60:63], v8 offset:8512
    v_max3_f32 v2, v103, v2, v3
    v_mov_b32 v3, v2
    s_nop 1
    v_permlane16_swap_b32 v2, v3
    v_mfma_f32_16x16x32_bf16 v[88:91], v[64:67], a[104:107], v[88:91]
    ds_read_b128 v[64:67], v8 offset:8576
    s_nop 1
    v_max_f32 v2, v2, v3
    v_mov_b32 v3, v2
    v_mfma_f32_16x16x32_bf16 v[88:91], v[68:71], a[108:111], v[88:91]
    ds_read_b128 v[68:71], v8 offset:8640
    s_nop 1
    v_permlane32_swap_b32 v2, v3
    s_nop 1
    v_max_f32 v2, v2, v3
    v_mfma_f32_16x16x32_bf16 v[92:95], v[84:87], a[108:111], 0
    ds_read_b128 v[84:87], v8 offset:9152
    v_mov_b32 v22, 0
    v_mov_b32 v23, 0
    v_sub_f32 v96, v96, v2
    v_mfma_f32_16x16x32_bf16 v[92:95], v[80:83], a[104:107], v[92:95]
    ds_read_b128 v[80:83], v8 offset:9088
    v_sub_f32 v97, v97, v2
    v_sub_f32 v98, v98, v2
    v_sub_f32 v99, v99, v2
    v_sub_f32 v100, v100, v2
    v_mfma_f32_16x16x32_bf16 v[92:95], v[76:79], a[100:103], v[92:95]
    ds_read_b128 v[76:79], v8 offset:9024
    v_sub_f32 v101, v101, v2
    v_sub_f32 v102, v102, v2
    v_sub_f32 v103, v103, v2
    v_mfma_f32_16x16x32_bf16 v[92:95], v[72:75], a[96:99], v[92:95]
    ds_read_b128 v[72:75], v8 offset:8960
    v_sub_f32 v48, 0, v2
    v_sub_f32 v49, 0, v2
    v_sub_f32 v50, 0, v2
    v_sub_f32 v51, 0, v2
    v_mfma_f32_16x16x32_bf16 v[160:163], v[112:115], v[104:107], 0
    v_exp_f32 v96, v96
    v_mfma_f32_16x16x32_bf16 v[188:191], v[116:119], v[104:107], 0
    v_exp_f32 v97, v97
    v_exp_f32 v98, v98
    v_mfma_f32_16x16x32_bf16 v[216:219], v[120:123], v[104:107], 0
    v_exp_f32 v99, v99
    v_add_f32 v22, v22, v96
    v_add_f32 v23, v23, v97
    v_mfma_f32_16x16x32_bf16 v[244:247], v[124:127], v[104:107], 0
    v_cvt_pk_bf16_f32 v108, v96, v97
    v_exp_f32 v100, v100
    v_mfma_f32_16x16x32_bf16 a[128:131], v[128:131], v[104:107], 0
    v_exp_f32 v101, v101
    v_add_f32 v22, v22, v98
    v_add_f32 v23, v23, v99
    v_mfma_f32_16x16x32_bf16 a[156:159], v[132:135], v[104:107], 0
    v_cvt_pk_bf16_f32 v109, v98, v99
    v_exp_f32 v102, v102
    v_mfma_f32_16x16x32_bf16 a[184:187], v[136:139], v[104:107], 0
    v_exp_f32 v103, v103
    v_add_f32 v22, v22, v100
    v_add_f32 v23, v23, v101
    v_mfma_f32_16x16x32_bf16 a[212:215], v[140:143], v[104:107], 0
    v_cvt_pk_bf16_f32 v110, v100, v101
    v_add_f32 v22, v22, v102
    v_add_f32 v23, v23, v103
    v_cvt_pk_bf16_f32 v111, v102, v103
    s_waitcnt lgkmcnt(0)
    v_mfma_f32_16x16x32_bf16 v[96:99], v[56:59], a[0:3], v[28:31]
    v_max3_f32 v2, v88, v89, v24
    v_max3_f32 v3, v90, v91, v92
    v_max3_f32 v2, v93, v94, v2
    v_mfma_f32_16x16x32_bf16 v[96:99], v[60:63], a[4:7], v[96:99]
    v_max3_f32 v2, v95, v2, v3
    v_mov_b32 v3, v2
    s_nop 1
    v_permlane16_swap_b32 v2, v3
    v_mfma_f32_16x16x32_bf16 v[96:99], v[64:67], a[8:11], v[96:99]
    s_nop 1
    v_max_f32 v2, v2, v3
    v_mov_b32 v3, v2
    v_mfma_f32_16x16x32_bf16 v[96:99], v[68:71], a[12:15], v[96:99]
    s_nop 1
    v_permlane32_swap_b32 v2, v3
    s_nop 1
    v_max_f32 v2, v2, v3
    v_mfma_f32_16x16x32_bf16 v[100:103], v[84:87], a[12:15], v[28:31]
    v_mov_b32 v24, 0
    v_mov_b32 v25, 0
    v_sub_f32 v88, v88, v2
    v_mfma_f32_16x16x32_bf16 v[100:103], v[80:83], a[8:11], v[100:103]
    v_sub_f32 v89, v89, v2
    v_sub_f32 v90, v90, v2
    v_sub_f32 v91, v91, v2
    v_sub_f32 v92, v92, v2
    v_mfma_f32_16x16x32_bf16 v[100:103], v[76:79], a[4:7], v[100:103]
    v_sub_f32 v93, v93, v2
    v_sub_f32 v94, v94, v2
    v_sub_f32 v95, v95, v2
    v_mfma_f32_16x16x32_bf16 v[100:103], v[72:75], a[0:3], v[100:103]
    v_sub_f32 v52, 0, v2
    v_sub_f32 v53, 0, v2
    v_sub_f32 v54, 0, v2
    v_sub_f32 v55, 0, v2
    v_mfma_f32_16x16x32_bf16 v[164:167], v[112:115], v[108:111], 0
    v_exp_f32 v88, v88
    v_mfma_f32_16x16x32_bf16 v[192:195], v[116:119], v[108:111], 0
    v_exp_f32 v89, v89
    v_exp_f32 v90, v90
    v_mfma_f32_16x16x32_bf16 v[220:223], v[120:123], v[108:111], 0
    v_exp_f32 v91, v91
    v_add_f32 v24, v24, v88
    v_add_f32 v25, v25, v89
    v_mfma_f32_16x16x32_bf16 v[248:251], v[124:127], v[108:111], 0
    v_cvt_pk_bf16_f32 v104, v88, v89
    v_exp_f32 v92, v92
    v_mfma_f32_16x16x32_bf16 a[132:135], v[128:131], v[108:111], 0
    v_exp_f32 v93, v93
    v_add_f32 v24, v24, v90
    v_add_f32 v25, v25, v91
    v_mfma_f32_16x16x32_bf16 a[160:163], v[132:135], v[108:111], 0
    v_cvt_pk_bf16_f32 v105, v90, v91
    v_exp_f32 v94, v94
    v_mfma_f32_16x16x32_bf16 a[188:191], v[136:139], v[108:111], 0
    v_exp_f32 v95, v95
    v_add_f32 v24, v24, v92
    v_add_f32 v25, v25, v93
    v_mfma_f32_16x16x32_bf16 a[216:219], v[140:143], v[108:111], 0
    v_cvt_pk_bf16_f32 v106, v92, v93
    v_add_f32 v24, v24, v94
    v_add_f32 v25, v25, v95
    v_cvt_pk_bf16_f32 v107, v94, v95
    s_mov_b32 s22, 0
L_at_loop:
    v_mfma_f32_16x16x32_bf16 v[88:91], v[56:59], a[16:19], v[32:35]
    v_mfma_f32_16x16x32_bf16 v[88:91], v[60:63], a[20:23], v[88:91]
    v_exp_f32 v96, v96
    v_mfma_f32_16x16x32_bf16 v[88:91], v[64:67], a[24:27], v[88:91]
    v_exp_f32 v97, v97
    v_mfma_f32_16x16x32_bf16 v[88:91], v[68:71], a[28:31], v[88:91]
    v_exp_f32 v98, v98
    v_mfma_f32_16x16x32_bf16 v[92:95], v[84:87], a[28:31], v[32:35]
    v_exp_f32 v99, v99
    v_mfma_f32_16x16x32_bf16 v[92:95], v[80:83], a[24:27], v[92:95]
    v_add_f32 v12, v12, v96
    v_add_f32 v13, v13, v97
    v_mfma_f32_16x16x32_bf16 v[92:95], v[76:79], a[20:23], v[92:95]
    v_cvt_pk_bf16_f32 v108, v96, v97
    v_mfma_f32_16x16x32_bf16 v[92:95], v[72:75], a[16:19], v[92:95]
    v_exp_f32 v100, v100
    v_mfma_f32_16x16x32_bf16 v[168:171], v[112:115], v[104:107], v[168:171]
    ds_read_b64_tr_b16 v[112:113], v9 offset:8448
    ds_read_b64_tr_b16 v[114:115], v9 offset:8960
    v_exp_f32 v101, v101
    v_mfma_f32_16x16x32_bf16 v[196:199], v[116:119], v[104:107], v[196:199]
    ds_read_b64_tr_b16 v[116:117], v9 offset:8480
    ds_read_b64_tr_b16 v[118:119], v9 offset:8992
    v_add_f32 v12, v12, v98
    v_add_f32 v13, v13, v99
    v_mfma_f32_16x16x32_bf16 v[224:227], v[120:123], v[104:107], v[224:227]
    ds_read_b64_tr_b16 v[120:121], v9 offset:8512
    ds_read_b64_tr_b16 v[122:123], v9 offset:9024
    v_cvt_pk_bf16_f32 v109, v98, v99
    v_mfma_f32_16x16x32_bf16 v[252:255], v[124:127], v[104:107], v[252:255]
    ds_read_b64_tr_b16 v[124:125], v9 offset:8544
    ds_read_b64_tr_b16 v[126:127], v9 offset:9056
    v_exp_f32 v102, v102
    v_mfma_f32_16x16x32_bf16 a[136:139], v[128:131], v[104:107], a[136:139]
    ds_read_b64_tr_b16 v[128:129], v9 offset:8576
    ds_read_b64_tr_b16 v[130:131], v9 offset:9088
    v_exp_f32 v103, v103
    v_mfma_f32_16x16x32_bf16 a[164:167], v[132:135], v[104:107], a[164:167]
    ds_read_b64_tr_b16 v[132:133], v9 offset:8608
    ds_read_b64_tr_b16 v[134:135], v9 offset:9120
    v_add_f32 v12, v12, v100
    v_add_f32 v13, v13, v101
    v_mfma_f32_16x16x32_bf16 a[192:195], v[136:139], v[104:107], a[192:195]
    ds_read_b64_tr_b16 v[136:137], v9 offset:8640
    ds_read_b64_tr_b16 v[138:139], v9 offset:9152
    v_cvt_pk_bf16_f32 v110, v100, v101
    v_add_f32 v12, v12, v102
    v_mfma_f32_16x16x32_bf16 a[220:223], v[140:143], v[104:107], a[220:223]
    ds_read_b64_tr_b16 v[140:141], v9 offset:8672
    ds_read_b64_tr_b16 v[142:143], v9 offset:9184
    v_add_f32 v13, v13, v103
    v_cvt_pk_bf16_f32 v111, v102, v103
    v_mfma_f32_16x16x32_bf16 v[96:99], v[56:59], a[32:35], v[36:39]
    v_mfma_f32_16x16x32_bf16 v[96:99], v[60:63], a[36:39], v[96:99]
    s_add_u32 s29, s34, s100
    v_exp_f32 v88, v88
    v_mfma_f32_16x16x32_bf16 v[96:99], v[64:67], a[40:43], v[96:99]
    v_exp_f32 v89, v89
    v_mfma_f32_16x16x32_bf16 v[96:99], v[68:71], a[44:47], v[96:99]
    s_bfe_u32 s28, s29, 0x20003
    v_exp_f32 v90, v90
    v_mfma_f32_16x16x32_bf16 v[100:103], v[84:87], a[44:47], v[36:39]
    v_exp_f32 v91, v91
    v_mfma_f32_16x16x32_bf16 v[100:103], v[80:83], a[40:43], v[100:103]
    s_lshl_b32 s28, s28, 16
    v_add_f32 v14, v14, v88
    v_add_f32 v15, v15, v89
    v_mfma_f32_16x16x32_bf16 v[100:103], v[76:79], a[36:39], v[100:103]
    v_cvt_pk_bf16_f32 v104, v88, v89
    v_mfma_f32_16x16x32_bf16 v[100:103], v[72:75], a[32:35], v[100:103]
    v_exp_f32 v92, v92
    s_waitcnt lgkmcnt(0)
    v_mfma_f32_16x16x32_bf16 v[144:147], v[112:115], v[108:111], v[144:147]
    s_and_b32 s29, s29, 7
    v_exp_f32 v93, v93
    v_mfma_f32_16x16x32_bf16 v[172:175], v[116:119], v[108:111], v[172:175]
    v_add_f32 v14, v14, v90
    v_add_f32 v15, v15, v91
    v_mfma_f32_16x16x32_bf16 v[200:203], v[120:123], v[108:111], v[200:203]
    s_lshl_b32 s29, s29, 11
    v_cvt_pk_bf16_f32 v105, v90, v91
    v_mfma_f32_16x16x32_bf16 v[228:231], v[124:127], v[108:111], v[228:231]
    v_exp_f32 v94, v94
    v_mfma_f32_16x16x32_bf16 a[112:115], v[128:131], v[108:111], a[112:115]
    s_add_u32 s29, s28, s29
    v_exp_f32 v95, v95
    v_mfma_f32_16x16x32_bf16 a[140:143], v[132:135], v[108:111], a[140:143]
    v_add_f32 v14, v14, v92
    v_add_f32 v15, v15, v93
    v_mfma_f32_16x16x32_bf16 a[168:171], v[136:139], v[108:111], a[168:171]
    s_lshr_b32 s28, s34, 5
    v_cvt_pk_bf16_f32 v106, v92, v93
    v_add_f32 v14, v14, v94
    v_mfma_f32_16x16x32_bf16 a[196:199], v[140:143], v[108:111], a[196:199]
    v_add_f32 v15, v15, v95
    v_cvt_pk_bf16_f32 v107, v94, v95
    v_mfma_f32_16x16x32_bf16 v[88:91], v[56:59], a[48:51], v[40:43]
    v_mfma_f32_16x16x32_bf16 v[88:91], v[60:63], a[52:55], v[88:91]
    s_lshl_b32 s28, s28, 19
    v_exp_f32 v96, v96
    v_mfma_f32_16x16x32_bf16 v[88:91], v[64:67], a[56:59], v[88:91]
    v_exp_f32 v97, v97
    v_mfma_f32_16x16x32_bf16 v[88:91], v[68:71], a[60:63], v[88:91]
    s_add_u32 s49, s28, s29
    v_exp_f32 v98, v98
    v_mfma_f32_16x16x32_bf16 v[92:95], v[84:87], a[60:63], v[40:43]
    v_exp_f32 v99, v99
    v_mfma_f32_16x16x32_bf16 v[92:95], v[80:83], a[56:59], v[92:95]
    s_add_u32 m0, s33, 0
    v_add_f32 v16, v16, v96
    v_add_f32 v17, v17, v97
    v_mfma_f32_16x16x32_bf16 v[92:95], v[76:79], a[52:55], v[92:95]
    v_cvt_pk_bf16_f32 v108, v96, v97
    v_mfma_f32_16x16x32_bf16 v[92:95], v[72:75], a[48:51], v[92:95]
    v_exp_f32 v100, v100
    v_mfma_f32_16x16x32_bf16 v[148:151], v[112:115], v[104:107], v[148:151]
    s_add_u32 s34, s34, 1
    v_exp_f32 v101, v101
    v_mfma_f32_16x16x32_bf16 v[176:179], v[116:119], v[104:107], v[176:179]
    v_add_f32 v16, v16, v98
    v_add_f32 v17, v17, v99
    v_mfma_f32_16x16x32_bf16 v[204:207], v[120:123], v[104:107], v[204:207]
    buffer_load_dwordx4 v7, s[4:7], s49 offen offset:0 nt lds
    v_cvt_pk_bf16_f32 v109, v98, v99
    v_mfma_f32_16x16x32_bf16 v[232:235], v[124:127], v[104:107], v[232:235]
    v_exp_f32 v102, v102
    v_mfma_f32_16x16x32_bf16 a[116:119], v[128:131], v[104:107], a[116:119]
    s_add_u32 m0, m0, s96
    v_exp_f32 v103, v103
    v_mfma_f32_16x16x32_bf16 a[144:147], v[132:135], v[104:107], a[144:147]
    v_add_f32 v16, v16, v100
    v_add_f32 v17, v17, v101
    v_mfma_f32_16x16x32_bf16 a[172:175], v[136:139], v[104:107], a[172:175]
    buffer_load_dwordx4 v7, s[4:7], s49 offen offset:256 nt lds
    v_cvt_pk_bf16_f32 v110, v100, v101
    v_add_f32 v16, v16, v102
    v_mfma_f32_16x16x32_bf16 a[200:203], v[140:143], v[104:107], a[200:203]
    v_add_f32 v17, v17, v103
    v_cvt_pk_bf16_f32 v111, v102, v103
    v_mfma_f32_16x16x32_bf16 v[96:99], v[56:59], a[64:67], v[44:47]
    v_mfma_f32_16x16x32_bf16 v[96:99], v[60:63], a[68:71], v[96:99]
    s_add_u32 m0, m0, s97
    v_exp_f32 v88, v88
    v_mfma_f32_16x16x32_bf16 v[96:99], v[64:67], a[72:75], v[96:99]
    v_exp_f32 v89, v89
    v_mfma_f32_16x16x32_bf16 v[96:99], v[68:71], a[76:79], v[96:99]
    buffer_load_dwordx4 v7, s[4:7], s49 offen offset:512 nt lds
    v_exp_f32 v90, v90
    v_mfma_f32_16x16x32_bf16 v[100:103], v[84:87], a[76:79], v[44:47]
    v_exp_f32 v91, v91
    v_mfma_f32_16x16x32_bf16 v[100:103], v[80:83], a[72:75], v[100:103]
    s_add_u32 m0, m0, s96
    v_add_f32 v18, v18, v88
    v_add_f32 v19, v19, v89
    v_mfma_f32_16x16x32_bf16 v[100:103], v[76:79], a[68:71], v[100:103]
    v_cvt_pk_bf16_f32 v104, v88, v89
    v_mfma_f32_16x16x32_bf16 v[100:103], v[72:75], a[64:67], v[100:103]
    v_exp_f32 v92, v92
    v_mfma_f32_16x16x32_bf16 v[152:155], v[112:115], v[108:111], v[152:155]
    buffer_load_dwordx4 v7, s[4:7], s49 offen offset:768 nt lds
    v_exp_f32 v93, v93
    v_mfma_f32_16x16x32_bf16 v[180:183], v[116:119], v[108:111], v[180:183]
    v_add_f32 v18, v18, v90
    v_add_f32 v19, v19, v91
    v_mfma_f32_16x16x32_bf16 v[208:211], v[120:123], v[108:111], v[208:211]
    s_add_u32 m0, m0, s97
    v_cvt_pk_bf16_f32 v105, v90, v91
    v_mfma_f32_16x16x32_bf16 v[236:239], v[124:127], v[108:111], v[236:239]
    v_exp_f32 v94, v94
    v_mfma_f32_16x16x32_bf16 a[120:123], v[128:131], v[108:111], a[120:123]
    buffer_load_dwordx4 v7, s[4:7], s49 offen offset:1024 nt lds
    v_exp_f32 v95, v95
    v_mfma_f32_16x16x32_bf16 a[148:151], v[132:135], v[108:111], a[148:151]
    v_add_f32 v18, v18, v92
    v_add_f32 v19, v19, v93
    v_mfma_f32_16x16x32_bf16 a[176:179], v[136:139], v[108:111], a[176:179]
    s_add_u32 m0, m0, s96
    v_cvt_pk_bf16_f32 v106, v92, v93
    v_add_f32 v18, v18, v94
    v_mfma_f32_16x16x32_bf16 a[204:207], v[140:143], v[108:111], a[204:207]
    v_add_f32 v19, v19, v95
    v_cvt_pk_bf16_f32 v107, v94, v95
    v_mfma_f32_16x16x32_bf16 v[88:91], v[56:59], a[80:83], v[48:51]
    v_mfma_f32_16x16x32_bf16 v[88:91], v[60:63], a[84:87], v[88:91]
    buffer_load_dwordx4 v7, s[4:7], s49 offen offset:1280 nt lds
    v_exp_f32 v96, v96
    v_mfma_f32_16x16x32_bf16 v[88:91], v[64:67], a[88:91], v[88:91]
    v_exp_f32 v97, v97
    v_mfma_f32_16x16x32_bf16 v[88:91], v[68:71], a[92:95], v[88:91]
    s_add_u32 m0, m0, s97
    v_exp_f32 v98, v98
    v_mfma_f32_16x16x32_bf16 v[92:95], v[84:87], a[92:95], v[48:51]
    v_exp_f32 v99, v99
    v_mfma_f32_16x16x32_bf16 v[92:95], v[80:83], a[88:91], v[92:95]
    buffer_load_dwordx4 v7, s[4:7], s49 offen offset:1536 nt lds
    v_add_f32 v20, v20, v96
    v_add_f32 v21, v21, v97
    v_mfma_f32_16x16x32_bf16 v[92:95], v[76:79], a[84:87], v[92:95]
    v_cvt_pk_bf16_f32 v108, v96, v97
    v_mfma_f32_16x16x32_bf16 v[92:95], v[72:75], a[80:83], v[92:95]
    v_exp_f32 v100, v100
    v_mfma_f32_16x16x32_bf16 v[156:159], v[112:115], v[104:107], v[156:159]
    s_add_u32 m0, m0, s96
    v_exp_f32 v101, v101
    v_mfma_f32_16x16x32_bf16 v[184:187], v[116:119], v[104:107], v[184:187]
    v_add_f32 v20, v20, v98
    v_add_f32 v21, v21, v99
    v_mfma_f32_16x16x32_bf16 v[212:215], v[120:123], v[104:107], v[212:215]
    buffer_load_dwordx4 v7, s[4:7], s49 offen offset:1792 nt lds
    v_cvt_pk_bf16_f32 v109, v98, v99
    v_mfma_f32_16x16x32_bf16 v[240:243], v[124:127], v[104:107], v[240:243]
    v_exp_f32 v102, v102
    v_mfma_f32_16x16x32_bf16 a[124:127], v[128:131], v[104:107], a[124:127]
    v_exp_f32 v103, v103
    v_mfma_f32_16x16x32_bf16 a[152:155], v[132:135], v[104:107], a[152:155]
    v_add_f32 v20, v20, v100
    v_add_f32 v21, v21, v101
    v_mfma_f32_16x16x32_bf16 a[180:183], v[136:139], v[104:107], a[180:183]
    v_cvt_pk_bf16_f32 v110, v100, v101
    v_add_f32 v20, v20, v102
    v_mfma_f32_16x16x32_bf16 a[208:211], v[140:143], v[104:107], a[208:211]
    v_add_f32 v21, v21, v103
    v_cvt_pk_bf16_f32 v111, v102, v103
    s_cmp_eq_u32 s68, 0
    s_cbranch_scc0 L_bw1_3491
    s_waitcnt vmcnt(16) lgkmcnt(0)
L_bw2_3491:
    s_barrier
    v_mfma_f32_16x16x32_bf16 v[96:99], v[56:59], a[96:99], v[52:55]
    ds_read_b128 v[56:59], v8 offset:16896
    v_mfma_f32_16x16x32_bf16 v[96:99], v[60:63], a[100:103], v[96:99]
    ds_read_b128 v[60:63], v8 offset:16960
    v_exp_f32 v88, v88
    v_mfma_f32_16x16x32_bf16 v[96:99], v[64:67], a[104:107], v[96:99]
    ds_read_b128 v[64:67], v8 offset:17024
    v_exp_f32 v89, v89
    v_mfma_f32_16x16x32_bf16 v[96:99], v[68:71], a[108:111], v[96:99]
    ds_read_b128 v[68:71], v8 offset:17088
    v_exp_f32 v90, v90
    v_mfma_f32_16x16x32_bf16 v[100:103], v[84:87], a[108:111], v[52:55]
    ds_read_b128 v[84:87], v8 offset:17600
    v_exp_f32 v91, v91
    v_mfma_f32_16x16x32_bf16 v[100:103], v[80:83], a[104:107], v[100:103]
    ds_read_b128 v[80:83], v8 offset:17536
    v_add_f32 v22, v22, v88
    v_add_f32 v23, v23, v89
    v_mfma_f32_16x16x32_bf16 v[100:103], v[76:79], a[100:103], v[100:103]
    ds_read_b128 v[76:79], v8 offset:17472
    v_cvt_pk_bf16_f32 v104, v88, v89
    v_mfma_f32_16x16x32_bf16 v[100:103], v[72:75], a[96:99], v[100:103]
    ds_read_b128 v[72:75], v8 offset:17408
    v_exp_f32 v92, v92
    v_mfma_f32_16x16x32_bf16 v[160:163], v[112:115], v[108:111], v[160:163]
    v_exp_f32 v93, v93
    v_mfma_f32_16x16x32_bf16 v[188:191], v[116:119], v[108:111], v[188:191]
    v_add_f32 v22, v22, v90
    v_add_f32 v23, v23, v91
    v_mfma_f32_16x16x32_bf16 v[216:219], v[120:123], v[108:111], v[216:219]
    v_cvt_pk_bf16_f32 v105, v90, v91
    v_mfma_f32_16x16x32_bf16 v[244:247], v[124:127], v[108:111], v[244:247]
    v_exp_f32 v94, v94
    v_mfma_f32_16x16x32_bf16 a[128:131], v[128:131], v[108:111], a[128:131]
    v_exp_f32 v95, v95
    v_mfma_f32_16x16x32_bf16 a[156:159], v[132:135], v[108:111], a[156:159]
    v_add_f32 v22, v22, v92
    v_add_f32 v23, v23, v93
    v_mfma_f32_16x16x32_bf16 a[184:187], v[136:139], v[108:111], a[184:187]
    v_cvt_pk_bf16_f32 v106, v92, v93
    v_add_f32 v22, v22, v94
    v_mfma_f32_16x16x32_bf16 a[212:215], v[140:143], v[108:111], a[212:215]
    v_add_f32 v23, v23, v95
    v_cvt_pk_bf16_f32 v107, v94, v95
    s_waitcnt lgkmcnt(0)
    v_mfma_f32_16x16x32_bf16 v[88:91], v[56:59], a[0:3], v[28:31]
    v_mfma_f32_16x16x32_bf16 v[88:91], v[60:63], a[4:7], v[88:91]
    v_exp_f32 v96, v96
    v_mfma_f32_16x16x32_bf16 v[88:91], v[64:67], a[8:11], v[88:91]
    v_exp_f32 v97, v97
    v_mfma_f32_16x16x32_bf16 v[88:91], v[68:71], a[12:15], v[88:91]
    v_exp_f32 v98, v98
    v_mfma_f32_16x16x32_bf16 v[92:95], v[84:87], a[12:15], v[28:31]
    v_exp_f32 v99, v99
    v_mfma_f32_16x16x32_bf16 v[92:95], v[80:83], a[8:11], v[92:95]
    v_add_f32 v24, v24, v96
    v_add_f32 v25, v25, v97
    v_mfma_f32_16x16x32_bf16 v[92:95], v[76:79], a[4:7], v[92:95]
    v_cvt_pk_bf16_f32 v108, v96, v97
    v_mfma_f32_16x16x32_bf16 v[92:95], v[72:75], a[0:3], v[92:95]
    v_exp_f32 v100, v100
    v_mfma_f32_16x16x32_bf16 v[164:167], v[112:115], v[104:107], v[164:167]
    v_exp_f32 v101, v101
    v_mfma_f32_16x16x32_bf16 v[192:195], v[116:119], v[104:107], v[192:195]
    v_add_f32 v24, v24, v98
    v_add_f32 v25, v25, v99
    v_mfma_f32_16x16x32_bf16 v[220:223], v[120:123], v[104:107], v[220:223]
    v_cvt_pk_bf16_f32 v109, v98, v99
    v_mfma_f32_16x16x32_bf16 v[248:251], v[124:127], v[104:107], v[248:251]
    v_exp_f32 v102, v102
    v_mfma_f32_16x16x32_bf16 a[132:135], v[128:131], v[104:107], a[132:135]
    v_exp_f32 v103, v103
    v_mfma_f32_16x16x32_bf16 a[160:163], v[132:135], v[104:107], a[160:163]
    v_add_f32 v24, v24, v100
    v_add_f32 v25, v25, v101
    v_mfma_f32_16x16x32_bf16 a[188:191], v[136:139], v[104:107], a[188:191]
    v_cvt_pk_bf16_f32 v110, v100, v101
    v_add_f32 v24, v24, v102
    v_mfma_f32_16x16x32_bf16 a[216:219], v[140:143], v[104:107], a[216:219]
    v_add_f32 v25, v25, v103
    v_cvt_pk_bf16_f32 v111, v102, v103
    v_mfma_f32_16x16x32_bf16 v[96:99], v[56:59], a[16:19], v[32:35]
    v_mfma_f32_16x16x32_bf16 v[96:99], v[60:63], a[20:23], v[96:99]
    v_exp_f32 v88, v88
    v_mfma_f32_16x16x32_bf16 v[96:99], v[64:67], a[24:27], v[96:99]
    v_exp_f32 v89, v89
    v_mfma_f32_16x16x32_bf16 v[96:99], v[68:71], a[28:31], v[96:99]
    v_exp_f32 v90, v90
    v_mfma_f32_16x16x32_bf16 v[100:103], v[84:87], a[28:31], v[32:35]
    v_exp_f32 v91, v91
    v_mfma_f32_16x16x32_bf16 v[100:103], v[80:83], a[24:27], v[100:103]
    v_add_f32 v12, v12, v88
    v_add_f32 v13, v13, v89
    v_mfma_f32_16x16x32_bf16 v[100:103], v[76:79], a[20:23], v[100:103]
    v_cvt_pk_bf16_f32 v104, v88, v89
    v_mfma_f32_16x16x32_bf16 v[100:103], v[72:75], a[16:19], v[100:103]
    v_exp_f32 v92, v92
    v_mfma_f32_16x16x32_bf16 v[168:171], v[112:115], v[108:111], v[168:171]
    ds_read_b64_tr_b16 v[112:113], v9 offset:16896
    ds_read_b64_tr_b16 v[114:115], v9 offset:17408
    v_exp_f32 v93, v93
    v_mfma_f32_16x16x32_bf16 v[196:199], v[116:119], v[108:111], v[196:199]
    ds_read_b64_tr_b16 v[116:117], v9 offset:16928
    ds_read_b64_tr_b16 v[118:119], v9 offset:17440
    v_add_f32 v12, v12, v90
    v_add_f32 v13, v13, v91
    v_mfma_f32_16x16x32_bf16 v[224:227], v[120:123], v[108:111], v[224:227]
    ds_read_b64_tr_b16 v[120:121], v9 offset:16960
    ds_read_b64_tr_b16 v[122:123], v9 offset:17472
    v_cvt_pk_bf16_f32 v105, v90, v91
    v_mfma_f32_16x16x32_bf16 v[252:255], v[124:127], v[108:111], v[252:255]
    ds_read_b64_tr_b16 v[124:125], v9 offset:16992
    ds_read_b64_tr_b16 v[126:127], v9 offset:17504
    v_exp_f32 v94, v94
    v_mfma_f32_16x16x32_bf16 a[136:139], v[128:131], v[108:111], a[136:139]
    ds_read_b64_tr_b16 v[128:129], v9 offset:17024
    ds_read_b64_tr_b16 v[130:131], v9 offset:17536
    v_exp_f32 v95, v95
    v_mfma_f32_16x16x32_bf16 a[164:167], v[132:135], v[108:111], a[164:167]
    ds_read_b64_tr_b16 v[132:133], v9 offset:17056
    ds_read_b64_tr_b16 v[134:135], v9 offset:17568
    v_add_f32 v12, v12, v92
    v_add_f32 v13, v13, v93
    v_mfma_f32_16x16x32_bf16 a[192:195], v[136:139], v[108:111], a[192:195]
    ds_read_b64_tr_b16 v[136:137], v9 offset:17088
    ds_read_b64_tr_b16 v[138:139], v9 offset:17600
    v_cvt_pk_bf16_f32 v106, v92, v93
    v_add_f32 v12, v12, v94
    v_mfma_f32_16x16x32_bf16 a[220:223], v[140:143], v[108:111], a[220:223]
    ds_read_b64_tr_b16 v[140:141], v9 offset:17120
    ds_read_b64_tr_b16 v[142:143], v9 offset:17632
    v_add_f32 v13, v13, v95
    v_cvt_pk_bf16_f32 v107, v94, v95
    v_mfma_f32_16x16x32_bf16 v[88:91], v[56:59], a[32:35], v[36:39]
    v_mfma_f32_16x16x32_bf16 v[88:91], v[60:63], a[36:39], v[88:91]
    s_add_u32 s29, s34, s100
    v_exp_f32 v96, v96
    v_mfma_f32_16x16x32_bf16 v[88:91], v[64:67], a[40:43], v[88:91]
    v_exp_f32 v97, v97
    v_mfma_f32_16x16x32_bf16 v[88:91], v[68:71], a[44:47], v[88:91]
    s_bfe_u32 s28, s29, 0x20003
    v_exp_f32 v98, v98
    v_mfma_f32_16x16x32_bf16 v[92:95], v[84:87], a[44:47], v[36:39]
    v_exp_f32 v99, v99
    v_mfma_f32_16x16x32_bf16 v[92:95], v[80:83], a[40:43], v[92:95]
    s_lshl_b32 s28, s28, 16
    v_add_f32 v14, v14, v96
    v_add_f32 v15, v15, v97
    v_mfma_f32_16x16x32_bf16 v[92:95], v[76:79], a[36:39], v[92:95]
    v_cvt_pk_bf16_f32 v108, v96, v97
    v_mfma_f32_16x16x32_bf16 v[92:95], v[72:75], a[32:35], v[92:95]
    v_exp_f32 v100, v100
    s_waitcnt lgkmcnt(0)
    v_mfma_f32_16x16x32_bf16 v[144:147], v[112:115], v[104:107], v[144:147]
    s_and_b32 s29, s29, 7
    v_exp_f32 v101, v101
    v_mfma_f32_16x16x32_bf16 v[172:175], v[116:119], v[104:107], v[172:175]
    v_add_f32 v14, v14, v98
    v_add_f32 v15, v15, v99
    v_mfma_f32_16x16x32_bf16 v[200:203], v[120:123], v[104:107], v[200:203]
    s_lshl_b32 s29, s29, 11
    v_cvt_pk_bf16_f32 v109, v98, v99
    v_mfma_f32_16x16x32_bf16 v[228:231], v[124:127], v[104:107], v[228:231]
    v_exp_f32 v102, v102
    v_mfma_f32_16x16x32_bf16 a[112:115], v[128:131], v[104:107], a[112:115]
    s_add_u32 s29, s28, s29
    v_exp_f32 v103, v103
    v_mfma_f32_16x16x32_bf16 a[140:143], v[132:135], v[104:107], a[140:143]
    v_add_f32 v14, v14, v100
    v_add_f32 v15, v15, v101
    v_mfma_f32_16x16x32_bf16 a[168:171], v[136:139], v[104:107], a[168:171]
    s_lshr_b32 s28, s34, 5
    v_cvt_pk_bf16_f32 v110, v100, v101
    v_add_f32 v14, v14, v102
    v_mfma_f32_16x16x32_bf16 a[196:199], v[140:143], v[104:107], a[196:199]
    v_add_f32 v15, v15, v103
    v_cvt_pk_bf16_f32 v111, v102, v103
    v_mfma_f32_16x16x32_bf16 v[96:99], v[56:59], a[48:51], v[40:43]
    v_mfma_f32_16x16x32_bf16 v[96:99], v[60:63], a[52:55], v[96:99]
    s_lshl_b32 s28, s28, 19
    v_exp_f32 v88, v88
    v_mfma_f32_16x16x32_bf16 v[96:99], v[64:67], a[56:59], v[96:99]
    v_exp_f32 v89, v89
    v_mfma_f32_16x16x32_bf16 v[96:99], v[68:71], a[60:63], v[96:99]
    s_add_u32 s49, s28, s29
    v_exp_f32 v90, v90
    v_mfma_f32_16x16x32_bf16 v[100:103], v[84:87], a[60:63], v[40:43]
    v_exp_f32 v91, v91
    v_mfma_f32_16x16x32_bf16 v[100:103], v[80:83], a[56:59], v[100:103]
    s_add_u32 m0, s33, 8448
    v_add_f32 v16, v16, v88
    v_add_f32 v17, v17, v89
    v_mfma_f32_16x16x32_bf16 v[100:103], v[76:79], a[52:55], v[100:103]
    v_cvt_pk_bf16_f32 v104, v88, v89
    v_mfma_f32_16x16x32_bf16 v[100:103], v[72:75], a[48:51], v[100:103]
    v_exp_f32 v92, v92
    v_mfma_f32_16x16x32_bf16 v[148:151], v[112:115], v[108:111], v[148:151]
    s_add_u32 s34, s34, 1
    v_exp_f32 v93, v93
    v_mfma_f32_16x16x32_bf16 v[176:179], v[116:119], v[108:111], v[176:179]
    v_add_f32 v16, v16, v90
    v_add_f32 v17, v17, v91
    v_mfma_f32_16x16x32_bf16 v[204:207], v[120:123], v[108:111], v[204:207]
    buffer_load_dwordx4 v7, s[4:7], s49 offen offset:0 nt lds
    v_cvt_pk_bf16_f32 v105, v90, v91
    v_mfma_f32_16x16x32_bf16 v[232:235], v[124:127], v[108:111], v[232:235]
    v_exp_f32 v94, v94
    v_mfma_f32_16x16x32_bf16 a[116:119], v[128:131], v[108:111], a[116:119]
    s_add_u32 m0, m0, s96
    v_exp_f32 v95, v95
    v_mfma_f32_16x16x32_bf16 a[144:147], v[132:135], v[108:111], a[144:147]
    v_add_f32 v16, v16, v92
    v_add_f32 v17, v17, v93
    v_mfma_f32_16x16x32_bf16 a[172:175], v[136:139], v[108:111], a[172:175]
    buffer_load_dwordx4 v7, s[4:7], s49 offen offset:256 nt lds
    v_cvt_pk_bf16_f32 v106, v92, v93
    v_add_f32 v16, v16, v94
    v_mfma_f32_16x16x32_bf16 a[200:203], v[140:143], v[108:111], a[200:203]
    v_add_f32 v17, v17, v95
    v_cvt_pk_bf16_f32 v107, v94, v95
    v_mfma_f32_16x16x32_bf16 v[88:91], v[56:59], a[64:67], v[44:47]
    v_mfma_f32_16x16x32_bf16 v[88:91], v[60:63], a[68:71], v[88:91]
    s_add_u32 m0, m0, s97
    v_exp_f32 v96, v96
    v_mfma_f32_16x16x32_bf16 v[88:91], v[64:67], a[72:75], v[88:91]
    v_exp_f32 v97, v97
    v_mfma_f32_16x16x32_bf16 v[88:91], v[68:71], a[76:79], v[88:91]
    buffer_load_dwordx4 v7, s[4:7], s49 offen offset:512 nt lds
    v_exp_f32 v98, v98
    v_mfma_f32_16x16x32_bf16 v[92:95], v[84:87], a[76:79], v[44:47]
    v_exp_f32 v99, v99
    v_mfma_f32_16x16x32_bf16 v[92:95], v[80:83], a[72:75], v[92:95]
    s_add_u32 m0, m0, s96
    v_add_f32 v18, v18, v96
    v_add_f32 v19, v19, v97
    v_mfma_f32_16x16x32_bf16 v[92:95], v[76:79], a[68:71], v[92:95]
    v_cvt_pk_bf16_f32 v108, v96, v97
    v_mfma_f32_16x16x32_bf16 v[92:95], v[72:75], a[64:67], v[92:95]
    v_exp_f32 v100, v100
    v_mfma_f32_16x16x32_bf16 v[152:155], v[112:115], v[104:107], v[152:155]
    buffer_load_dwordx4 v7, s[4:7], s49 offen offset:768 nt lds
    v_exp_f32 v101, v101
    v_mfma_f32_16x16x32_bf16 v[180:183], v[116:119], v[104:107], v[180:183]
    v_add_f32 v18, v18, v98
    v_add_f32 v19, v19, v99
    v_mfma_f32_16x16x32_bf16 v[208:211], v[120:123], v[104:107], v[208:211]
    s_add_u32 m0, m0, s97
    v_cvt_pk_bf16_f32 v109, v98, v99
    v_mfma_f32_16x16x32_bf16 v[236:239], v[124:127], v[104:107], v[236:239]
    v_exp_f32 v102, v102
    v_mfma_f32_16x16x32_bf16 a[120:123], v[128:131], v[104:107], a[120:123]
    buffer_load_dwordx4 v7, s[4:7], s49 offen offset:1024 nt lds
    v_exp_f32 v103, v103
    v_mfma_f32_16x16x32_bf16 a[148:151], v[132:135], v[104:107], a[148:151]
    v_add_f32 v18, v18, v100
    v_add_f32 v19, v19, v101
    v_mfma_f32_16x16x32_bf16 a[176:179], v[136:139], v[104:107], a[176:179]
    s_add_u32 m0, m0, s96
    v_cvt_pk_bf16_f32 v110, v100, v101
    v_add_f32 v18, v18, v102
    v_mfma_f32_16x16x32_bf16 a[204:207], v[140:143], v[104:107], a[204:207]
    v_add_f32 v19, v19, v103
    v_cvt_pk_bf16_f32 v111, v102, v103
    v_mfma_f32_16x16x32_bf16 v[96:99], v[56:59], a[80:83], v[48:51]
    v_mfma_f32_16x16x32_bf16 v[96:99], v[60:63], a[84:87], v[96:99]
    buffer_load_dwordx4 v7, s[4:7], s49 offen offset:1280 nt lds
    v_exp_f32 v88, v88
    v_mfma_f32_16x16x32_bf16 v[96:99], v[64:67], a[88:91], v[96:99]
    v_exp_f32 v89, v89
    v_mfma_f32_16x16x32_bf16 v[96:99], v[68:71], a[92:95], v[96:99]
    s_add_u32 m0, m0, s97
    v_exp_f32 v90, v90
    v_mfma_f32_16x16x32_bf16 v[100:103], v[84:87], a[92:95], v[48:51]
    v_exp_f32 v91, v91
    v_mfma_f32_16x16x32_bf16 v[100:103], v[80:83], a[88:91], v[100:103]
    buffer_load_dwordx4 v7, s[4:7], s49 offen offset:1536 nt lds
    v_add_f32 v20, v20, v88
    v_add_f32 v21, v21, v89
    v_mfma_f32_16x16x32_bf16 v[100:103], v[76:79], a[84:87], v[100:103]
    v_cvt_pk_bf16_f32 v104, v88, v89
    v_mfma_f32_16x16x32_bf16 v[100:103], v[72:75], a[80:83], v[100:103]
    v_exp_f32 v92, v92
    v_mfma_f32_16x16x32_bf16 v[156:159], v[112:115], v[108:111], v[156:159]
    s_add_u32 m0, m0, s96
    v_exp_f32 v93, v93
    v_mfma_f32_16x16x32_bf16 v[184:187], v[116:119], v[108:111], v[184:187]
    v_add_f32 v20, v20, v90
    v_add_f32 v21, v21, v91
    v_mfma_f32_16x16x32_bf16 v[212:215], v[120:123], v[108:111], v[212:215]
    buffer_load_dwordx4 v7, s[4:7], s49 offen offset:1792 nt lds
    v_cvt_pk_bf16_f32 v105, v90, v91
    v_mfma_f32_16x16x32_bf16 v[240:243], v[124:127], v[108:111], v[240:243]
    v_exp_f32 v94, v94
    v_mfma_f32_16x16x32_bf16 a[124:127], v[128:131], v[108:111], a[124:127]
    v_exp_f32 v95, v95
    v_mfma_f32_16x16x32_bf16 a[152:155], v[132:135], v[108:111], a[152:155]
    v_add_f32 v20, v20, v92
    v_add_f32 v21, v21, v93
    v_mfma_f32_16x16x32_bf16 a[180:183], v[136:139], v[108:111], a[180:183]
    v_cvt_pk_bf16_f32 v106, v92, v93
    v_add_f32 v20, v20, v94
    v_mfma_f32_16x16x32_bf16 a[208:211], v[140:143], v[108:111], a[208:211]
    v_add_f32 v21, v21, v95
    v_cvt_pk_bf16_f32 v107, v94, v95
    s_cmp_eq_u32 s68, 0
    s_cbranch_scc0 L_bw1_3800
    s_waitcnt vmcnt(16) lgkmcnt(0)
L_bw2_3800:
    s_barrier
    v_mfma_f32_16x16x32_bf16 v[88:91], v[56:59], a[96:99], v[52:55]
    ds_read_b128 v[56:59], v8 offset:25344
    v_mfma_f32_16x16x32_bf16 v[88:91], v[60:63], a[100:103], v[88:91]
    ds_read_b128 v[60:63], v8 offset:25408
    v_exp_f32 v96, v96
    v_mfma_f32_16x16x32_bf16 v[88:91], v[64:67], a[104:107], v[88:91]
    ds_read_b128 v[64:67], v8 offset:25472
    v_exp_f32 v97, v97
    v_mfma_f32_16x16x32_bf16 v[88:91], v[68:71], a[108:111], v[88:91]
    ds_read_b128 v[68:71], v8 offset:25536
    v_exp_f32 v98, v98
    v_mfma_f32_16x16x32_bf16 v[92:95], v[84:87], a[108:111], v[52:55]
    ds_read_b128 v[84:87], v8 offset:26048
    v_exp_f32 v99, v99
    v_mfma_f32_16x16x32_bf16 v[92:95], v[80:83], a[104:107], v[92:95]
    ds_read_b128 v[80:83], v8 offset:25984
    v_add_f32 v22, v22, v96
    v_add_f32 v23, v23, v97
    v_mfma_f32_16x16x32_bf16 v[92:95], v[76:79], a[100:103], v[92:95]
    ds_read_b128 v[76:79], v8 offset:25920
    v_cvt_pk_bf16_f32 v108, v96, v97
    v_mfma_f32_16x16x32_bf16 v[92:95], v[72:75], a[96:99], v[92:95]
    ds_read_b128 v[72:75], v8 offset:25856
    v_exp_f32 v100, v100
    v_mfma_f32_16x16x32_bf16 v[160:163], v[112:115], v[104:107], v[160:163]
    v_exp_f32 v101, v101
    v_mfma_f32_16x16x32_bf16 v[188:191], v[116:119], v[104:107], v[188:191]
    v_add_f32 v22, v22, v98
    v_add_f32 v23, v23, v99
    v_mfma_f32_16x16x32_bf16 v[216:219], v[120:123], v[104:107], v[216:219]
    v_cvt_pk_bf16_f32 v109, v98, v99
    v_mfma_f32_16x16x32_bf16 v[244:247], v[124:127], v[104:107], v[244:247]
    v_exp_f32 v102, v102
    v_mfma_f32_16x16x32_bf16 a[128:131], v[128:131], v[104:107], a[128:131]
    v_exp_f32 v103, v103
    v_mfma_f32_16x16x32_bf16 a[156:159], v[132:135], v[104:107], a[156:159]
    v_add_f32 v22, v22, v100
    v_add_f32 v23, v23, v101
    v_mfma_f32_16x16x32_bf16 a[184:187], v[136:139], v[104:107], a[184:187]
    v_cvt_pk_bf16_f32 v110, v100, v101
    v_add_f32 v22, v22, v102
    v_mfma_f32_16x16x32_bf16 a[212:215], v[140:143], v[104:107], a[212:215]
    v_add_f32 v23, v23, v103
    v_cvt_pk_bf16_f32 v111, v102, v103
    s_waitcnt lgkmcnt(0)
    v_mfma_f32_16x16x32_bf16 v[96:99], v[56:59], a[0:3], v[28:31]
    v_mfma_f32_16x16x32_bf16 v[96:99], v[60:63], a[4:7], v[96:99]
    v_exp_f32 v88, v88
    v_mfma_f32_16x16x32_bf16 v[96:99], v[64:67], a[8:11], v[96:99]
    v_exp_f32 v89, v89
    v_mfma_f32_16x16x32_bf16 v[96:99], v[68:71], a[12:15], v[96:99]
    v_exp_f32 v90, v90
    v_mfma_f32_16x16x32_bf16 v[100:103], v[84:87], a[12:15], v[28:31]
    v_exp_f32 v91, v91
    v_mfma_f32_16x16x32_bf16 v[100:103], v[80:83], a[8:11], v[100:103]
    v_add_f32 v24, v24, v88
    v_add_f32 v25, v25, v89
    v_mfma_f32_16x16x32_bf16 v[100:103], v[76:79], a[4:7], v[100:103]
    v_cvt_pk_bf16_f32 v104, v88, v89
    v_mfma_f32_16x16x32_bf16 v[100:103], v[72:75], a[0:3], v[100:103]
    v_exp_f32 v92, v92
    v_mfma_f32_16x16x32_bf16 v[164:167], v[112:115], v[108:111], v[164:167]
    v_exp_f32 v93, v93
    v_mfma_f32_16x16x32_bf16 v[192:195], v[116:119], v[108:111], v[192:195]
    v_add_f32 v24, v24, v90
    v_add_f32 v25, v25, v91
    v_mfma_f32_16x16x32_bf16 v[220:223], v[120:123], v[108:111], v[220:223]
    v_cvt_pk_bf16_f32 v105, v90, v91
    v_mfma_f32_16x16x32_bf16 v[248:251], v[124:127], v[108:111], v[248:251]
    v_exp_f32 v94, v94
    v_mfma_f32_16x16x32_bf16 a[132:135], v[128:131], v[108:111], a[132:135]
    v_exp_f32 v95, v95
    v_mfma_f32_16x16x32_bf16 a[160:163], v[132:135], v[108:111], a[160:163]
    v_add_f32 v24, v24, v92
    v_add_f32 v25, v25, v93
    v_mfma_f32_16x16x32_bf16 a[188:191], v[136:139], v[108:111], a[188:191]
    v_cvt_pk_bf16_f32 v106, v92, v93
    v_add_f32 v24, v24, v94
    v_mfma_f32_16x16x32_bf16 a[216:219], v[140:143], v[108:111], a[216:219]
    v_add_f32 v25, v25, v95
    v_cvt_pk_bf16_f32 v107, v94, v95
    v_mfma_f32_16x16x32_bf16 v[88:91], v[56:59], a[16:19], v[32:35]
    v_mfma_f32_16x16x32_bf16 v[88:91], v[60:63], a[20:23], v[88:91]
    v_exp_f32 v96, v96
    v_mfma_f32_16x16x32_bf16 v[88:91], v[64:67], a[24:27], v[88:91]
    v_exp_f32 v97, v97
    v_mfma_f32_16x16x32_bf16 v[88:91], v[68:71], a[28:31], v[88:91]
    v_exp_f32 v98, v98
    v_mfma_f32_16x16x32_bf16 v[92:95], v[84:87], a[28:31], v[32:35]
    v_exp_f32 v99, v99
    v_mfma_f32_16x16x32_bf16 v[92:95], v[80:83], a[24:27], v[92:95]
    v_add_f32 v12, v12, v96
    v_add_f32 v13, v13, v97
    v_mfma_f32_16x16x32_bf16 v[92:95], v[76:79], a[20:23], v[92:95]
    v_cvt_pk_bf16_f32 v108, v96, v97
    v_mfma_f32_16x16x32_bf16 v[92:95], v[72:75], a[16:19], v[92:95]
    v_exp_f32 v100, v100
    v_mfma_f32_16x16x32_bf16 v[168:171], v[112:115], v[104:107], v[168:171]
    ds_read_b64_tr_b16 v[112:113], v9 offset:25344
    ds_read_b64_tr_b16 v[114:115], v9 offset:25856
    v_exp_f32 v101, v101
    v_mfma_f32_16x16x32_bf16 v[196:199], v[116:119], v[104:107], v[196:199]
    ds_read_b64_tr_b16 v[116:117], v9 offset:25376
    ds_read_b64_tr_b16 v[118:119], v9 offset:25888
    v_add_f32 v12, v12, v98
    v_add_f32 v13, v13, v99
    v_mfma_f32_16x16x32_bf16 v[224:227], v[120:123], v[104:107], v[224:227]
    ds_read_b64_tr_b16 v[120:121], v9 offset:25408
    ds_read_b64_tr_b16 v[122:123], v9 offset:25920
    v_cvt_pk_bf16_f32 v109, v98, v99
    v_mfma_f32_16x16x32_bf16 v[252:255], v[124:127], v[104:107], v[252:255]
    ds_read_b64_tr_b16 v[124:125], v9 offset:25440
    ds_read_b64_tr_b16 v[126:127], v9 offset:25952
    v_exp_f32 v102, v102
    v_mfma_f32_16x16x32_bf16 a[136:139], v[128:131], v[104:107], a[136:139]
    ds_read_b64_tr_b16 v[128:129], v9 offset:25472
    ds_read_b64_tr_b16 v[130:131], v9 offset:25984
    v_exp_f32 v103, v103
    v_mfma_f32_16x16x32_bf16 a[164:167], v[132:135], v[104:107], a[164:167]
    ds_read_b64_tr_b16 v[132:133], v9 offset:25504
    ds_read_b64_tr_b16 v[134:135], v9 offset:26016
    v_add_f32 v12, v12, v100
    v_add_f32 v13, v13, v101
    v_mfma_f32_16x16x32_bf16 a[192:195], v[136:139], v[104:107], a[192:195]
    ds_read_b64_tr_b16 v[136:137], v9 offset:25536
    ds_read_b64_tr_b16 v[138:139], v9 offset:26048
    v_cvt_pk_bf16_f32 v110, v100, v101
    v_add_f32 v12, v12, v102
    v_mfma_f32_16x16x32_bf16 a[220:223], v[140:143], v[104:107], a[220:223]
    ds_read_b64_tr_b16 v[140:141], v9 offset:25568
    ds_read_b64_tr_b16 v[142:143], v9 offset:26080
    v_add_f32 v13, v13, v103
    v_cvt_pk_bf16_f32 v111, v102, v103
    v_mfma_f32_16x16x32_bf16 v[96:99], v[56:59], a[32:35], v[36:39]
    v_mfma_f32_16x16x32_bf16 v[96:99], v[60:63], a[36:39], v[96:99]
    s_add_u32 s29, s34, s100
    v_exp_f32 v88, v88
    v_mfma_f32_16x16x32_bf16 v[96:99], v[64:67], a[40:43], v[96:99]
    v_exp_f32 v89, v89
    v_mfma_f32_16x16x32_bf16 v[96:99], v[68:71], a[44:47], v[96:99]
    s_bfe_u32 s28, s29, 0x20003
    v_exp_f32 v90, v90
    v_mfma_f32_16x16x32_bf16 v[100:103], v[84:87], a[44:47], v[36:39]
    v_exp_f32 v91, v91
    v_mfma_f32_16x16x32_bf16 v[100:103], v[80:83], a[40:43], v[100:103]
    s_lshl_b32 s28, s28, 16
    v_add_f32 v14, v14, v88
    v_add_f32 v15, v15, v89
    v_mfma_f32_16x16x32_bf16 v[100:103], v[76:79], a[36:39], v[100:103]
    v_cvt_pk_bf16_f32 v104, v88, v89
    v_mfma_f32_16x16x32_bf16 v[100:103], v[72:75], a[32:35], v[100:103]
    v_exp_f32 v92, v92
    s_waitcnt lgkmcnt(0)
    v_mfma_f32_16x16x32_bf16 v[144:147], v[112:115], v[108:111], v[144:147]
    s_and_b32 s29, s29, 7
    v_exp_f32 v93, v93
    v_mfma_f32_16x16x32_bf16 v[172:175], v[116:119], v[108:111], v[172:175]
    v_add_f32 v14, v14, v90
    v_add_f32 v15, v15, v91
    v_mfma_f32_16x16x32_bf16 v[200:203], v[120:123], v[108:111], v[200:203]
    s_lshl_b32 s29, s29, 11
    v_cvt_pk_bf16_f32 v105, v90, v91
    v_mfma_f32_16x16x32_bf16 v[228:231], v[124:127], v[108:111], v[228:231]
    v_exp_f32 v94, v94
    v_mfma_f32_16x16x32_bf16 a[112:115], v[128:131], v[108:111], a[112:115]
    s_add_u32 s29, s28, s29
    v_exp_f32 v95, v95
    v_mfma_f32_16x16x32_bf16 a[140:143], v[132:135], v[108:111], a[140:143]
    v_add_f32 v14, v14, v92
    v_add_f32 v15, v15, v93
    v_mfma_f32_16x16x32_bf16 a[168:171], v[136:139], v[108:111], a[168:171]
    s_lshr_b32 s28, s34, 5
    v_cvt_pk_bf16_f32 v106, v92, v93
    v_add_f32 v14, v14, v94
    v_mfma_f32_16x16x32_bf16 a[196:199], v[140:143], v[108:111], a[196:199]
    v_add_f32 v15, v15, v95
    v_cvt_pk_bf16_f32 v107, v94, v95
    v_mfma_f32_16x16x32_bf16 v[88:91], v[56:59], a[48:51], v[40:43]
    v_mfma_f32_16x16x32_bf16 v[88:91], v[60:63], a[52:55], v[88:91]
    s_lshl_b32 s28, s28, 19
    v_exp_f32 v96, v96
    v_mfma_f32_16x16x32_bf16 v[88:91], v[64:67], a[56:59], v[88:91]
    v_exp_f32 v97, v97
    v_mfma_f32_16x16x32_bf16 v[88:91], v[68:71], a[60:63], v[88:91]
    s_add_u32 s49, s28, s29
    v_exp_f32 v98, v98
    v_mfma_f32_16x16x32_bf16 v[92:95], v[84:87], a[60:63], v[40:43]
    v_exp_f32 v99, v99
    v_mfma_f32_16x16x32_bf16 v[92:95], v[80:83], a[56:59], v[92:95]
    s_add_u32 m0, s33, 16896
    v_add_f32 v16, v16, v96
    v_add_f32 v17, v17, v97
    v_mfma_f32_16x16x32_bf16 v[92:95], v[76:79], a[52:55], v[92:95]
    v_cvt_pk_bf16_f32 v108, v96, v97
    v_mfma_f32_16x16x32_bf16 v[92:95], v[72:75], a[48:51], v[92:95]
    v_exp_f32 v100, v100
    v_mfma_f32_16x16x32_bf16 v[148:151], v[112:115], v[104:107], v[148:151]
    s_add_u32 s34, s34, 1
    v_exp_f32 v101, v101
    v_mfma_f32_16x16x32_bf16 v[176:179], v[116:119], v[104:107], v[176:179]
    v_add_f32 v16, v16, v98
    v_add_f32 v17, v17, v99
    v_mfma_f32_16x16x32_bf16 v[204:207], v[120:123], v[104:107], v[204:207]
    buffer_load_dwordx4 v7, s[4:7], s49 offen offset:0 nt lds
    v_cvt_pk_bf16_f32 v109, v98, v99
    v_mfma_f32_16x16x32_bf16 v[232:235], v[124:127], v[104:107], v[232:235]
    v_exp_f32 v102, v102
    v_mfma_f32_16x16x32_bf16 a[116:119], v[128:131], v[104:107], a[116:119]
    s_add_u32 m0, m0, s96
    v_exp_f32 v103, v103
    v_mfma_f32_16x16x32_bf16 a[144:147], v[132:135], v[104:107], a[144:147]
    v_add_f32 v16, v16, v100
    v_add_f32 v17, v17, v101
    v_mfma_f32_16x16x32_bf16 a[172:175], v[136:139], v[104:107], a[172:175]
    buffer_load_dwordx4 v7, s[4:7], s49 offen offset:256 nt lds
    v_cvt_pk_bf16_f32 v110, v100, v101
    v_add_f32 v16, v16, v102
    v_mfma_f32_16x16x32_bf16 a[200:203], v[140:143], v[104:107], a[200:203]
    v_add_f32 v17, v17, v103
    v_cvt_pk_bf16_f32 v111, v102, v103
    v_mfma_f32_16x16x32_bf16 v[96:99], v[56:59], a[64:67], v[44:47]
    v_mfma_f32_16x16x32_bf16 v[96:99], v[60:63], a[68:71], v[96:99]
    s_add_u32 m0, m0, s97
    v_exp_f32 v88, v88
    v_mfma_f32_16x16x32_bf16 v[96:99], v[64:67], a[72:75], v[96:99]
    v_exp_f32 v89, v89
    v_mfma_f32_16x16x32_bf16 v[96:99], v[68:71], a[76:79], v[96:99]
    buffer_load_dwordx4 v7, s[4:7], s49 offen offset:512 nt lds
    v_exp_f32 v90, v90
    v_mfma_f32_16x16x32_bf16 v[100:103], v[84:87], a[76:79], v[44:47]
    v_exp_f32 v91, v91
    v_mfma_f32_16x16x32_bf16 v[100:103], v[80:83], a[72:75], v[100:103]
    s_add_u32 m0, m0, s96
    v_add_f32 v18, v18, v88
    v_add_f32 v19, v19, v89
    v_mfma_f32_16x16x32_bf16 v[100:103], v[76:79], a[68:71], v[100:103]
    v_cvt_pk_bf16_f32 v104, v88, v89
    v_mfma_f32_16x16x32_bf16 v[100:103], v[72:75], a[64:67], v[100:103]
    v_exp_f32 v92, v92
    v_mfma_f32_16x16x32_bf16 v[152:155], v[112:115], v[108:111], v[152:155]
    buffer_load_dwordx4 v7, s[4:7], s49 offen offset:768 nt lds
    v_exp_f32 v93, v93
    v_mfma_f32_16x16x32_bf16 v[180:183], v[116:119], v[108:111], v[180:183]
    v_add_f32 v18, v18, v90
    v_add_f32 v19, v19, v91
    v_mfma_f32_16x16x32_bf16 v[208:211], v[120:123], v[108:111], v[208:211]
    s_add_u32 m0, m0, s97
    v_cvt_pk_bf16_f32 v105, v90, v91
    v_mfma_f32_16x16x32_bf16 v[236:239], v[124:127], v[108:111], v[236:239]
    v_exp_f32 v94, v94
    v_mfma_f32_16x16x32_bf16 a[120:123], v[128:131], v[108:111], a[120:123]
    buffer_load_dwordx4 v7, s[4:7], s49 offen offset:1024 nt lds
    v_exp_f32 v95, v95
    v_mfma_f32_16x16x32_bf16 a[148:151], v[132:135], v[108:111], a[148:151]
    v_add_f32 v18, v18, v92
    v_add_f32 v19, v19, v93
    v_mfma_f32_16x16x32_bf16 a[176:179], v[136:139], v[108:111], a[176:179]
    s_add_u32 m0, m0, s96
    v_cvt_pk_bf16_f32 v106, v92, v93
    v_add_f32 v18, v18, v94
    v_mfma_f32_16x16x32_bf16 a[204:207], v[140:143], v[108:111], a[204:207]
    v_add_f32 v19, v19, v95
    v_cvt_pk_bf16_f32 v107, v94, v95
    v_mfma_f32_16x16x32_bf16 v[88:91], v[56:59], a[80:83], v[48:51]
    v_mfma_f32_16x16x32_bf16 v[88:91], v[60:63], a[84:87], v[88:91]
    buffer_load_dwordx4 v7, s[4:7], s49 offen offset:1280 nt lds
    v_exp_f32 v96, v96
    v_mfma_f32_16x16x32_bf16 v[88:91], v[64:67], a[88:91], v[88:91]
    v_exp_f32 v97, v97
    v_mfma_f32_16x16x32_bf16 v[88:91], v[68:71], a[92:95], v[88:91]
    s_add_u32 m0, m0, s97
    v_exp_f32 v98, v98
    v_mfma_f32_16x16x32_bf16 v[92:95], v[84:87], a[92:95], v[48:51]
    v_exp_f32 v99, v99
    v_mfma_f32_16x16x32_bf16 v[92:95], v[80:83], a[88:91], v[92:95]
    buffer_load_dwordx4 v7, s[4:7], s49 offen offset:1536 nt lds
    v_add_f32 v20, v20, v96
    v_add_f32 v21, v21, v97
    v_mfma_f32_16x16x32_bf16 v[92:95], v[76:79], a[84:87], v[92:95]
    v_cvt_pk_bf16_f32 v108, v96, v97
    v_mfma_f32_16x16x32_bf16 v[92:95], v[72:75], a[80:83], v[92:95]
    v_exp_f32 v100, v100
    v_mfma_f32_16x16x32_bf16 v[156:159], v[112:115], v[104:107], v[156:159]
    s_add_u32 m0, m0, s96
    v_exp_f32 v101, v101
    v_mfma_f32_16x16x32_bf16 v[184:187], v[116:119], v[104:107], v[184:187]
    v_add_f32 v20, v20, v98
    v_add_f32 v21, v21, v99
    v_mfma_f32_16x16x32_bf16 v[212:215], v[120:123], v[104:107], v[212:215]
    buffer_load_dwordx4 v7, s[4:7], s49 offen offset:1792 nt lds
    v_cvt_pk_bf16_f32 v109, v98, v99
    v_mfma_f32_16x16x32_bf16 v[240:243], v[124:127], v[104:107], v[240:243]
    v_exp_f32 v102, v102
    v_mfma_f32_16x16x32_bf16 a[124:127], v[128:131], v[104:107], a[124:127]
    v_exp_f32 v103, v103
    v_mfma_f32_16x16x32_bf16 a[152:155], v[132:135], v[104:107], a[152:155]
    v_add_f32 v20, v20, v100
    v_add_f32 v21, v21, v101
    v_mfma_f32_16x16x32_bf16 a[180:183], v[136:139], v[104:107], a[180:183]
    v_cvt_pk_bf16_f32 v110, v100, v101
    v_add_f32 v20, v20, v102
    v_mfma_f32_16x16x32_bf16 a[208:211], v[140:143], v[104:107], a[208:211]
    v_add_f32 v21, v21, v103
    v_cvt_pk_bf16_f32 v111, v102, v103
    s_waitcnt vmcnt(16) lgkmcnt(0)
    s_barrier
    v_mfma_f32_16x16x32_bf16 v[96:99], v[56:59], a[96:99], v[52:55]
    ds_read_b128 v[56:59], v8 offset:0
    v_mfma_f32_16x16x32_bf16 v[96:99], v[60:63], a[100:103], v[96:99]
    ds_read_b128 v[60:63], v8 offset:64
    v_exp_f32 v88, v88
    v_mfma_f32_16x16x32_bf16 v[96:99], v[64:67], a[104:107], v[96:99]
    ds_read_b128 v[64:67], v8 offset:128
    v_exp_f32 v89, v89
    v_mfma_f32_16x16x32_bf16 v[96:99], v[68:71], a[108:111], v[96:99]
    ds_read_b128 v[68:71], v8 offset:192
    v_exp_f32 v90, v90
    v_mfma_f32_16x16x32_bf16 v[100:103], v[84:87], a[108:111], v[52:55]
    ds_read_b128 v[84:87], v8 offset:704
    v_exp_f32 v91, v91
    v_mfma_f32_16x16x32_bf16 v[100:103], v[80:83], a[104:107], v[100:103]
    ds_read_b128 v[80:83], v8 offset:640
    v_add_f32 v22, v22, v88
    v_add_f32 v23, v23, v89
    v_mfma_f32_16x16x32_bf16 v[100:103], v[76:79], a[100:103], v[100:103]
    ds_read_b128 v[76:79], v8 offset:576
    v_cvt_pk_bf16_f32 v104, v88, v89
    v_mfma_f32_16x16x32_bf16 v[100:103], v[72:75], a[96:99], v[100:103]
    ds_read_b128 v[72:75], v8 offset:512
    v_exp_f32 v92, v92
    v_mfma_f32_16x16x32_bf16 v[160:163], v[112:115], v[108:111], v[160:163]
    v_exp_f32 v93, v93
    v_mfma_f32_16x16x32_bf16 v[188:191], v[116:119], v[108:111], v[188:191]
    v_add_f32 v22, v22, v90
    v_add_f32 v23, v23, v91
    v_mfma_f32_16x16x32_bf16 v[216:219], v[120:123], v[108:111], v[216:219]
    v_cvt_pk_bf16_f32 v105, v90, v91
    v_mfma_f32_16x16x32_bf16 v[244:247], v[124:127], v[108:111], v[244:247]
    v_exp_f32 v94, v94
    v_mfma_f32_16x16x32_bf16 a[128:131], v[128:131], v[108:111], a[128:131]
    v_exp_f32 v95, v95
    v_mfma_f32_16x16x32_bf16 a[156:159], v[132:135], v[108:111], a[156:159]
    v_add_f32 v22, v22, v92
    v_add_f32 v23, v23, v93
    v_mfma_f32_16x16x32_bf16 a[184:187], v[136:139], v[108:111], a[184:187]
    v_cvt_pk_bf16_f32 v106, v92, v93
    v_add_f32 v22, v22, v94
    v_mfma_f32_16x16x32_bf16 a[212:215], v[140:143], v[108:111], a[212:215]
    v_add_f32 v23, v23, v95
    v_cvt_pk_bf16_f32 v107, v94, v95
    s_waitcnt lgkmcnt(0)
    v_mfma_f32_16x16x32_bf16 v[88:91], v[56:59], a[0:3], v[28:31]
    v_mfma_f32_16x16x32_bf16 v[88:91], v[60:63], a[4:7], v[88:91]
    v_exp_f32 v96, v96
    v_mfma_f32_16x16x32_bf16 v[88:91], v[64:67], a[8:11], v[88:91]
    v_exp_f32 v97, v97
    v_mfma_f32_16x16x32_bf16 v[88:91], v[68:71], a[12:15], v[88:91]
    v_exp_f32 v98, v98
    v_mfma_f32_16x16x32_bf16 v[92:95], v[84:87], a[12:15], v[28:31]
    v_exp_f32 v99, v99
    v_mfma_f32_16x16x32_bf16 v[92:95], v[80:83], a[8:11], v[92:95]
    v_add_f32 v24, v24, v96
    v_add_f32 v25, v25, v97
    v_mfma_f32_16x16x32_bf16 v[92:95], v[76:79], a[4:7], v[92:95]
    v_cvt_pk_bf16_f32 v108, v96, v97
    v_mfma_f32_16x16x32_bf16 v[92:95], v[72:75], a[0:3], v[92:95]
    v_exp_f32 v100, v100
    v_mfma_f32_16x16x32_bf16 v[164:167], v[112:115], v[104:107], v[164:167]
    v_exp_f32 v101, v101
    v_mfma_f32_16x16x32_bf16 v[192:195], v[116:119], v[104:107], v[192:195]
    v_add_f32 v24, v24, v98
    v_add_f32 v25, v25, v99
    v_mfma_f32_16x16x32_bf16 v[220:223], v[120:123], v[104:107], v[220:223]
    v_cvt_pk_bf16_f32 v109, v98, v99
    v_mfma_f32_16x16x32_bf16 v[248:251], v[124:127], v[104:107], v[248:251]
    v_exp_f32 v102, v102
    v_mfma_f32_16x16x32_bf16 a[132:135], v[128:131], v[104:107], a[132:135]
    v_exp_f32 v103, v103
    v_mfma_f32_16x16x32_bf16 a[160:163], v[132:135], v[104:107], a[160:163]
    v_add_f32 v24, v24, v100
    v_add_f32 v25, v25, v101
    v_mfma_f32_16x16x32_bf16 a[188:191], v[136:139], v[104:107], a[188:191]
    v_cvt_pk_bf16_f32 v110, v100, v101
    v_add_f32 v24, v24, v102
    v_mfma_f32_16x16x32_bf16 a[216:219], v[140:143], v[104:107], a[216:219]
    v_add_f32 v25, v25, v103
    v_cvt_pk_bf16_f32 v111, v102, v103
    v_mfma_f32_16x16x32_bf16 v[96:99], v[56:59], a[16:19], v[32:35]
    v_mfma_f32_16x16x32_bf16 v[96:99], v[60:63], a[20:23], v[96:99]
    v_exp_f32 v88, v88
    v_mfma_f32_16x16x32_bf16 v[96:99], v[64:67], a[24:27], v[96:99]
    v_exp_f32 v89, v89
    v_mfma_f32_16x16x32_bf16 v[96:99], v[68:71], a[28:31], v[96:99]
    v_exp_f32 v90, v90
    v_mfma_f32_16x16x32_bf16 v[100:103], v[84:87], a[28:31], v[32:35]
    v_exp_f32 v91, v91
    v_mfma_f32_16x16x32_bf16 v[100:103], v[80:83], a[24:27], v[100:103]
    v_add_f32 v12, v12, v88
    v_add_f32 v13, v13, v89
    v_mfma_f32_16x16x32_bf16 v[100:103], v[76:79], a[20:23], v[100:103]
    v_cvt_pk_bf16_f32 v104, v88, v89
    v_mfma_f32_16x16x32_bf16 v[100:103], v[72:75], a[16:19], v[100:103]
    v_exp_f32 v92, v92
    v_mfma_f32_16x16x32_bf16 v[168:171], v[112:115], v[108:111], v[168:171]
    ds_read_b64_tr_b16 v[112:113], v9 offset:0
    ds_read_b64_tr_b16 v[114:115], v9 offset:512
    v_exp_f32 v93, v93
    v_mfma_f32_16x16x32_bf16 v[196:199], v[116:119], v[108:111], v[196:199]
    ds_read_b64_tr_b16 v[116:117], v9 offset:32
    ds_read_b64_tr_b16 v[118:119], v9 offset:544
    v_add_f32 v12, v12, v90
    v_add_f32 v13, v13, v91
    v_mfma_f32_16x16x32_bf16 v[224:227], v[120:123], v[108:111], v[224:227]
    ds_read_b64_tr_b16 v[120:121], v9 offset:64
    ds_read_b64_tr_b16 v[122:123], v9 offset:576
    v_cvt_pk_bf16_f32 v105, v90, v91
    v_mfma_f32_16x16x32_bf16 v[252:255], v[124:127], v[108:111], v[252:255]
    ds_read_b64_tr_b16 v[124:125], v9 offset:96
    ds_read_b64_tr_b16 v[126:127], v9 offset:608
    v_exp_f32 v94, v94
    v_mfma_f32_16x16x32_bf16 a[136:139], v[128:131], v[108:111], a[136:139]
    ds_read_b64_tr_b16 v[128:129], v9 offset:128
    ds_read_b64_tr_b16 v[130:131], v9 offset:640
    v_exp_f32 v95, v95
    v_mfma_f32_16x16x32_bf16 a[164:167], v[132:135], v[108:111], a[164:167]
    ds_read_b64_tr_b16 v[132:133], v9 offset:160
    ds_read_b64_tr_b16 v[134:135], v9 offset:672
    v_add_f32 v12, v12, v92
    v_add_f32 v13, v13, v93
    v_mfma_f32_16x16x32_bf16 a[192:195], v[136:139], v[108:111], a[192:195]
    ds_read_b64_tr_b16 v[136:137], v9 offset:192
    ds_read_b64_tr_b16 v[138:139], v9 offset:704
    v_cvt_pk_bf16_f32 v106, v92, v93
    v_add_f32 v12, v12, v94
    v_mfma_f32_16x16x32_bf16 a[220:223], v[140:143], v[108:111], a[220:223]
    ds_read_b64_tr_b16 v[140:141], v9 offset:224
    ds_read_b64_tr_b16 v[142:143], v9 offset:736
    v_add_f32 v13, v13, v95
    v_cvt_pk_bf16_f32 v107, v94, v95
    v_mfma_f32_16x16x32_bf16 v[88:91], v[56:59], a[32:35], v[36:39]
    v_mfma_f32_16x16x32_bf16 v[88:91], v[60:63], a[36:39], v[88:91]
    s_add_u32 s29, s34, s100
    v_exp_f32 v96, v96
    v_mfma_f32_16x16x32_bf16 v[88:91], v[64:67], a[40:43], v[88:91]
    v_exp_f32 v97, v97
    v_mfma_f32_16x16x32_bf16 v[88:91], v[68:71], a[44:47], v[88:91]
    s_bfe_u32 s28, s29, 0x20003
    v_exp_f32 v98, v98
    v_mfma_f32_16x16x32_bf16 v[92:95], v[84:87], a[44:47], v[36:39]
    v_exp_f32 v99, v99
    v_mfma_f32_16x16x32_bf16 v[92:95], v[80:83], a[40:43], v[92:95]
    s_lshl_b32 s28, s28, 16
    v_add_f32 v14, v14, v96
    v_add_f32 v15, v15, v97
    v_mfma_f32_16x16x32_bf16 v[92:95], v[76:79], a[36:39], v[92:95]
    v_cvt_pk_bf16_f32 v108, v96, v97
    v_mfma_f32_16x16x32_bf16 v[92:95], v[72:75], a[32:35], v[92:95]
    v_exp_f32 v100, v100
    s_waitcnt lgkmcnt(0)
    v_mfma_f32_16x16x32_bf16 v[144:147], v[112:115], v[104:107], v[144:147]
    s_and_b32 s29, s29, 7
    v_exp_f32 v101, v101
    v_mfma_f32_16x16x32_bf16 v[172:175], v[116:119], v[104:107], v[172:175]
    v_add_f32 v14, v14, v98
    v_add_f32 v15, v15, v99
    v_mfma_f32_16x16x32_bf16 v[200:203], v[120:123], v[104:107], v[200:203]
    s_lshl_b32 s29, s29, 11
    v_cvt_pk_bf16_f32 v109, v98, v99
    v_mfma_f32_16x16x32_bf16 v[228:231], v[124:127], v[104:107], v[228:231]
    v_exp_f32 v102, v102
    v_mfma_f32_16x16x32_bf16 a[112:115], v[128:131], v[104:107], a[112:115]
    s_add_u32 s29, s28, s29
    v_exp_f32 v103, v103
    v_mfma_f32_16x16x32_bf16 a[140:143], v[132:135], v[104:107], a[140:143]
    v_add_f32 v14, v14, v100
    v_add_f32 v15, v15, v101
    v_mfma_f32_16x16x32_bf16 a[168:171], v[136:139], v[104:107], a[168:171]
    s_lshr_b32 s28, s34, 5
    v_cvt_pk_bf16_f32 v110, v100, v101
    v_add_f32 v14, v14, v102
    v_mfma_f32_16x16x32_bf16 a[196:199], v[140:143], v[104:107], a[196:199]
    v_add_f32 v15, v15, v103
    v_cvt_pk_bf16_f32 v111, v102, v103
    v_mfma_f32_16x16x32_bf16 v[96:99], v[56:59], a[48:51], v[40:43]
    v_mfma_f32_16x16x32_bf16 v[96:99], v[60:63], a[52:55], v[96:99]
    s_lshl_b32 s28, s28, 19
    v_exp_f32 v88, v88
    v_mfma_f32_16x16x32_bf16 v[96:99], v[64:67], a[56:59], v[96:99]
    v_exp_f32 v89, v89
    v_mfma_f32_16x16x32_bf16 v[96:99], v[68:71], a[60:63], v[96:99]
    s_add_u32 s49, s28, s29
    v_exp_f32 v90, v90
    v_mfma_f32_16x16x32_bf16 v[100:103], v[84:87], a[60:63], v[40:43]
    v_exp_f32 v91, v91
    v_mfma_f32_16x16x32_bf16 v[100:103], v[80:83], a[56:59], v[100:103]
    s_add_u32 m0, s33, 25344
    v_add_f32 v16, v16, v88
    v_add_f32 v17, v17, v89
    v_mfma_f32_16x16x32_bf16 v[100:103], v[76:79], a[52:55], v[100:103]
    v_cvt_pk_bf16_f32 v104, v88, v89
    v_mfma_f32_16x16x32_bf16 v[100:103], v[72:75], a[48:51], v[100:103]
    v_exp_f32 v92, v92
    v_mfma_f32_16x16x32_bf16 v[148:151], v[112:115], v[108:111], v[148:151]
    s_add_u32 s34, s34, 1
    v_exp_f32 v93, v93
    v_mfma_f32_16x16x32_bf16 v[176:179], v[116:119], v[108:111], v[176:179]
    v_add_f32 v16, v16, v90
    v_add_f32 v17, v17, v91
    v_mfma_f32_16x16x32_bf16 v[204:207], v[120:123], v[108:111], v[204:207]
    buffer_load_dwordx4 v7, s[4:7], s49 offen offset:0 nt lds
    v_cvt_pk_bf16_f32 v105, v90, v91
    v_mfma_f32_16x16x32_bf16 v[232:235], v[124:127], v[108:111], v[232:235]
    v_exp_f32 v94, v94
    v_mfma_f32_16x16x32_bf16 a[116:119], v[128:131], v[108:111], a[116:119]
    s_add_u32 m0, m0, s96
    v_exp_f32 v95, v95
    v_mfma_f32_16x16x32_bf16 a[144:147], v[132:135], v[108:111], a[144:147]
    v_add_f32 v16, v16, v92
    v_add_f32 v17, v17, v93
    v_mfma_f32_16x16x32_bf16 a[172:175], v[136:139], v[108:111], a[172:175]
    buffer_load_dwordx4 v7, s[4:7], s49 offen offset:256 nt lds
    v_cvt_pk_bf16_f32 v106, v92, v93
    v_add_f32 v16, v16, v94
    v_mfma_f32_16x16x32_bf16 a[200:203], v[140:143], v[108:111], a[200:203]
    v_add_f32 v17, v17, v95
    v_cvt_pk_bf16_f32 v107, v94, v95
    v_mfma_f32_16x16x32_bf16 v[88:91], v[56:59], a[64:67], v[44:47]
    v_mfma_f32_16x16x32_bf16 v[88:91], v[60:63], a[68:71], v[88:91]
    s_add_u32 m0, m0, s97
    v_exp_f32 v96, v96
    v_mfma_f32_16x16x32_bf16 v[88:91], v[64:67], a[72:75], v[88:91]
    v_exp_f32 v97, v97
    v_mfma_f32_16x16x32_bf16 v[88:91], v[68:71], a[76:79], v[88:91]
    buffer_load_dwordx4 v7, s[4:7], s49 offen offset:512 nt lds
    v_exp_f32 v98, v98
    v_mfma_f32_16x16x32_bf16 v[92:95], v[84:87], a[76:79], v[44:47]
    v_exp_f32 v99, v99
    v_mfma_f32_16x16x32_bf16 v[92:95], v[80:83], a[72:75], v[92:95]
    s_add_u32 m0, m0, s96
    v_add_f32 v18, v18, v96
    v_add_f32 v19, v19, v97
    v_mfma_f32_16x16x32_bf16 v[92:95], v[76:79], a[68:71], v[92:95]
    v_cvt_pk_bf16_f32 v108, v96, v97
    v_mfma_f32_16x16x32_bf16 v[92:95], v[72:75], a[64:67], v[92:95]
    v_exp_f32 v100, v100
    v_mfma_f32_16x16x32_bf16 v[152:155], v[112:115], v[104:107], v[152:155]
    buffer_load_dwordx4 v7, s[4:7], s49 offen offset:768 nt lds
    v_exp_f32 v101, v101
    v_mfma_f32_16x16x32_bf16 v[180:183], v[116:119], v[104:107], v[180:183]
    v_add_f32 v18, v18, v98
    v_add_f32 v19, v19, v99
    v_mfma_f32_16x16x32_bf16 v[208:211], v[120:123], v[104:107], v[208:211]
    s_add_u32 m0, m0, s97
    v_cvt_pk_bf16_f32 v109, v98, v99
    v_mfma_f32_16x16x32_bf16 v[236:239], v[124:127], v[104:107], v[236:239]
    v_exp_f32 v102, v102
    v_mfma_f32_16x16x32_bf16 a[120:123], v[128:131], v[104:107], a[120:123]
    buffer_load_dwordx4 v7, s[4:7], s49 offen offset:1024 nt lds
    v_exp_f32 v103, v103
    v_mfma_f32_16x16x32_bf16 a[148:151], v[132:135], v[104:107], a[148:151]
    v_add_f32 v18, v18, v100
    v_add_f32 v19, v19, v101
    v_mfma_f32_16x16x32_bf16 a[176:179], v[136:139], v[104:107], a[176:179]
    s_add_u32 m0, m0, s96
    v_cvt_pk_bf16_f32 v110, v100, v101
    v_add_f32 v18, v18, v102
    v_mfma_f32_16x16x32_bf16 a[204:207], v[140:143], v[104:107], a[204:207]
    v_add_f32 v19, v19, v103
    v_cvt_pk_bf16_f32 v111, v102, v103
    v_mfma_f32_16x16x32_bf16 v[96:99], v[56:59], a[80:83], v[48:51]
    v_mfma_f32_16x16x32_bf16 v[96:99], v[60:63], a[84:87], v[96:99]
    buffer_load_dwordx4 v7, s[4:7], s49 offen offset:1280 nt lds
    v_exp_f32 v88, v88
    v_mfma_f32_16x16x32_bf16 v[96:99], v[64:67], a[88:91], v[96:99]
    v_exp_f32 v89, v89
    v_mfma_f32_16x16x32_bf16 v[96:99], v[68:71], a[92:95], v[96:99]
    s_add_u32 m0, m0, s97
    v_exp_f32 v90, v90
    v_mfma_f32_16x16x32_bf16 v[100:103], v[84:87], a[92:95], v[48:51]
    v_exp_f32 v91, v91
    v_mfma_f32_16x16x32_bf16 v[100:103], v[80:83], a[88:91], v[100:103]
    buffer_load_dwordx4 v7, s[4:7], s49 offen offset:1536 nt lds
    v_add_f32 v20, v20, v88
    v_add_f32 v21, v21, v89
    v_mfma_f32_16x16x32_bf16 v[100:103], v[76:79], a[84:87], v[100:103]
    v_cvt_pk_bf16_f32 v104, v88, v89
    v_mfma_f32_16x16x32_bf16 v[100:103], v[72:75], a[80:83], v[100:103]
    v_exp_f32 v92, v92
    v_mfma_f32_16x16x32_bf16 v[156:159], v[112:115], v[108:111], v[156:159]
    s_add_u32 m0, m0, s96
    v_exp_f32 v93, v93
    v_mfma_f32_16x16x32_bf16 v[184:187], v[116:119], v[108:111], v[184:187]
    v_add_f32 v20, v20, v90
    v_add_f32 v21, v21, v91
    v_mfma_f32_16x16x32_bf16 v[212:215], v[120:123], v[108:111], v[212:215]
    buffer_load_dwordx4 v7, s[4:7], s49 offen offset:1792 nt lds
    v_cvt_pk_bf16_f32 v105, v90, v91
    v_mfma_f32_16x16x32_bf16 v[240:243], v[124:127], v[108:111], v[240:243]
    v_exp_f32 v94, v94
    v_mfma_f32_16x16x32_bf16 a[124:127], v[128:131], v[108:111], a[124:127]
    v_exp_f32 v95, v95
    v_mfma_f32_16x16x32_bf16 a[152:155], v[132:135], v[108:111], a[152:155]
    v_add_f32 v20, v20, v92
    v_add_f32 v21, v21, v93
    v_mfma_f32_16x16x32_bf16 a[180:183], v[136:139], v[108:111], a[180:183]
    v_cvt_pk_bf16_f32 v106, v92, v93
    v_add_f32 v20, v20, v94
    v_mfma_f32_16x16x32_bf16 a[208:211], v[140:143], v[108:111], a[208:211]
    v_add_f32 v21, v21, v95
    v_cvt_pk_bf16_f32 v107, v94, v95
    s_waitcnt vmcnt(16) lgkmcnt(0)
    s_barrier
    v_mfma_f32_16x16x32_bf16 v[88:91], v[56:59], a[96:99], v[52:55]
    ds_read_b128 v[56:59], v8 offset:8448
    v_mfma_f32_16x16x32_bf16 v[88:91], v[60:63], a[100:103], v[88:91]
    ds_read_b128 v[60:63], v8 offset:8512
    v_exp_f32 v96, v96
    v_mfma_f32_16x16x32_bf16 v[88:91], v[64:67], a[104:107], v[88:91]
    ds_read_b128 v[64:67], v8 offset:8576
    v_exp_f32 v97, v97
    v_mfma_f32_16x16x32_bf16 v[88:91], v[68:71], a[108:111], v[88:91]
    ds_read_b128 v[68:71], v8 offset:8640
    v_exp_f32 v98, v98
    v_mfma_f32_16x16x32_bf16 v[92:95], v[84:87], a[108:111], v[52:55]
    ds_read_b128 v[84:87], v8 offset:9152
    v_exp_f32 v99, v99
    v_mfma_f32_16x16x32_bf16 v[92:95], v[80:83], a[104:107], v[92:95]
    ds_read_b128 v[80:83], v8 offset:9088
    v_add_f32 v22, v22, v96
    v_add_f32 v23, v23, v97
    v_mfma_f32_16x16x32_bf16 v[92:95], v[76:79], a[100:103], v[92:95]
    ds_read_b128 v[76:79], v8 offset:9024
    v_cvt_pk_bf16_f32 v108, v96, v97
    v_mfma_f32_16x16x32_bf16 v[92:95], v[72:75], a[96:99], v[92:95]
    ds_read_b128 v[72:75], v8 offset:8960
    v_exp_f32 v100, v100
    v_mfma_f32_16x16x32_bf16 v[160:163], v[112:115], v[104:107], v[160:163]
    v_exp_f32 v101, v101
    v_mfma_f32_16x16x32_bf16 v[188:191], v[116:119], v[104:107], v[188:191]
    v_add_f32 v22, v22, v98
    v_add_f32 v23, v23, v99
    v_mfma_f32_16x16x32_bf16 v[216:219], v[120:123], v[104:107], v[216:219]
    v_cvt_pk_bf16_f32 v109, v98, v99
    v_mfma_f32_16x16x32_bf16 v[244:247], v[124:127], v[104:107], v[244:247]
    v_exp_f32 v102, v102
    v_mfma_f32_16x16x32_bf16 a[128:131], v[128:131], v[104:107], a[128:131]
    v_exp_f32 v103, v103
    v_mfma_f32_16x16x32_bf16 a[156:159], v[132:135], v[104:107], a[156:159]
    v_add_f32 v22, v22, v100
    v_add_f32 v23, v23, v101
    v_mfma_f32_16x16x32_bf16 a[184:187], v[136:139], v[104:107], a[184:187]
    v_cvt_pk_bf16_f32 v110, v100, v101
    v_add_f32 v22, v22, v102
    v_mfma_f32_16x16x32_bf16 a[212:215], v[140:143], v[104:107], a[212:215]
    v_add_f32 v23, v23, v103
    v_cvt_pk_bf16_f32 v111, v102, v103
    s_waitcnt lgkmcnt(0)
    v_mfma_f32_16x16x32_bf16 v[96:99], v[56:59], a[0:3], v[28:31]
    v_mfma_f32_16x16x32_bf16 v[96:99], v[60:63], a[4:7], v[96:99]
    v_exp_f32 v88, v88
    v_mfma_f32_16x16x32_bf16 v[96:99], v[64:67], a[8:11], v[96:99]
    v_exp_f32 v89, v89
    v_mfma_f32_16x16x32_bf16 v[96:99], v[68:71], a[12:15], v[96:99]
    v_exp_f32 v90, v90
    v_mfma_f32_16x16x32_bf16 v[100:103], v[84:87], a[12:15], v[28:31]
    v_exp_f32 v91, v91
    v_mfma_f32_16x16x32_bf16 v[100:103], v[80:83], a[8:11], v[100:103]
    v_add_f32 v24, v24, v88
    v_add_f32 v25, v25, v89
    v_mfma_f32_16x16x32_bf16 v[100:103], v[76:79], a[4:7], v[100:103]
    v_cvt_pk_bf16_f32 v104, v88, v89
    v_mfma_f32_16x16x32_bf16 v[100:103], v[72:75], a[0:3], v[100:103]
    v_exp_f32 v92, v92
    v_mfma_f32_16x16x32_bf16 v[164:167], v[112:115], v[108:111], v[164:167]
    v_exp_f32 v93, v93
    v_mfma_f32_16x16x32_bf16 v[192:195], v[116:119], v[108:111], v[192:195]
    v_add_f32 v24, v24, v90
    v_add_f32 v25, v25, v91
    v_mfma_f32_16x16x32_bf16 v[220:223], v[120:123], v[108:111], v[220:223]
    v_cvt_pk_bf16_f32 v105, v90, v91
    v_mfma_f32_16x16x32_bf16 v[248:251], v[124:127], v[108:111], v[248:251]
    v_exp_f32 v94, v94
    v_mfma_f32_16x16x32_bf16 a[132:135], v[128:131], v[108:111], a[132:135]
    v_exp_f32 v95, v95
    v_mfma_f32_16x16x32_bf16 a[160:163], v[132:135], v[108:111], a[160:163]
    v_add_f32 v24, v24, v92
    v_add_f32 v25, v25, v93
    v_mfma_f32_16x16x32_bf16 a[188:191], v[136:139], v[108:111], a[188:191]
    v_cvt_pk_bf16_f32 v106, v92, v93
    v_add_f32 v24, v24, v94
    v_mfma_f32_16x16x32_bf16 a[216:219], v[140:143], v[108:111], a[216:219]
    v_add_f32 v25, v25, v95
    v_cvt_pk_bf16_f32 v107, v94, v95
    s_add_u32 s22, s22, 1
    s_cmp_lt_u32 s22, 7
    s_cbranch_scc1 L_at_loop
    s_add_u32 s21, s21, 1
    s_mul_i32 s50, s21, s52
    s_mov_b32 s101, s21
    s_add_u32 s50, s50, s55
    s_cmp_ge_u32 s21, 2
    s_cselect_b32 s28, 0x40000000, 0
    s_add_u32 s50, s50, s28
    s_mov_b32 s82, s26
    s_mul_i32 s28, s26, s51
    s_add_u32 s50, s50, s28
    s_cmp_eq_u32 s21, 2
    s_cbranch_scc1 L_at_wt0
L_at_wt0r:
    s_cmp_lg_u32 s69, 0
    s_cbranch_scc1 L_at_atailB
    v_mfma_f32_16x16x32_bf16 v[88:91], v[56:59], a[16:19], v[32:35]
    v_mfma_f32_16x16x32_bf16 v[88:91], v[60:63], a[20:23], v[88:91]
    v_exp_f32 v96, v96
    v_mfma_f32_16x16x32_bf16 v[88:91], v[64:67], a[24:27], v[88:91]
    v_exp_f32 v97, v97
    v_mfma_f32_16x16x32_bf16 v[88:91], v[68:71], a[28:31], v[88:91]
    v_exp_f32 v98, v98
    v_mfma_f32_16x16x32_bf16 v[92:95], v[84:87], a[28:31], v[32:35]
    v_exp_f32 v99, v99
    v_mfma_f32_16x16x32_bf16 v[92:95], v[80:83], a[24:27], v[92:95]
    v_add_f32 v12, v12, v96
    v_add_f32 v13, v13, v97
    v_mfma_f32_16x16x32_bf16 v[92:95], v[76:79], a[20:23], v[92:95]
    v_cvt_pk_bf16_f32 v108, v96, v97
    v_mfma_f32_16x16x32_bf16 v[92:95], v[72:75], a[16:19], v[92:95]
    v_exp_f32 v100, v100
    v_mfma_f32_16x16x32_bf16 v[168:171], v[112:115], v[104:107], v[168:171]
    ds_read_b64_tr_b16 v[112:113], v9 offset:8448
    ds_read_b64_tr_b16 v[114:115], v9 offset:8960
    v_exp_f32 v101, v101
    v_mfma_f32_16x16x32_bf16 v[196:199], v[116:119], v[104:107], v[196:199]
    ds_read_b64_tr_b16 v[116:117], v9 offset:8480
    ds_read_b64_tr_b16 v[118:119], v9 offset:8992
    v_add_f32 v12, v12, v98
    v_add_f32 v13, v13, v99
    v_mfma_f32_16x16x32_bf16 v[224:227], v[120:123], v[104:107], v[224:227]
    ds_read_b64_tr_b16 v[120:121], v9 offset:8512
    ds_read_b64_tr_b16 v[122:123], v9 offset:9024
    v_cvt_pk_bf16_f32 v109, v98, v99
    v_mfma_f32_16x16x32_bf16 v[252:255], v[124:127], v[104:107], v[252:255]
    ds_read_b64_tr_b16 v[124:125], v9 offset:8544
    ds_read_b64_tr_b16 v[126:127], v9 offset:9056
    v_exp_f32 v102, v102
    v_mfma_f32_16x16x32_bf16 a[136:139], v[128:131], v[104:107], a[136:139]
    ds_read_b64_tr_b16 v[128:129], v9 offset:8576
    ds_read_b64_tr_b16 v[130:131], v9 offset:9088
    v_exp_f32 v103, v103
    v_mfma_f32_16x16x32_bf16 a[164:167], v[132:135], v[104:107], a[164:167]
    ds_read_b64_tr_b16 v[132:133], v9 offset:8608
    ds_read_b64_tr_b16 v[134:135], v9 offset:9120
    v_add_f32 v12, v12, v100
    v_add_f32 v13, v13, v101
    v_mfma_f32_16x16x32_bf16 a[192:195], v[136:139], v[104:107], a[192:195]
    ds_read_b64_tr_b16 v[136:137], v9 offset:8640
    ds_read_b64_tr_b16 v[138:139], v9 offset:9152
    v_cvt_pk_bf16_f32 v110, v100, v101
    v_add_f32 v12, v12, v102
    v_mfma_f32_16x16x32_bf16 a[220:223], v[140:143], v[104:107], a[220:223]
    ds_read_b64_tr_b16 v[140:141], v9 offset:8672
    ds_read_b64_tr_b16 v[142:143], v9 offset:9184
    v_add_f32 v13, v13, v103
    v_cvt_pk_bf16_f32 v111, v102, v103
    v_mfma_f32_16x16x32_bf16 v[96:99], v[56:59], a[32:35], v[36:39]
    v_mfma_f32_16x16x32_bf16 v[96:99], v[60:63], a[36:39], v[96:99]
    s_add_u32 m0, s33, 0
    v_exp_f32 v88, v88
    v_mfma_f32_16x16x32_bf16 v[96:99], v[64:67], a[40:43], v[96:99]
    v_exp_f32 v89, v89
    v_mfma_f32_16x16x32_bf16 v[96:99], v[68:71], a[44:47], v[96:99]
    s_mov_b32 s49, s50
    v_exp_f32 v90, v90
    v_mfma_f32_16x16x32_bf16 v[100:103], v[84:87], a[44:47], v[36:39]
    v_exp_f32 v91, v91
    v_mfma_f32_16x16x32_bf16 v[100:103], v[80:83], a[40:43], v[100:103]
    s_add_u32 s28, s49, s88
    v_add_f32 v14, v14, v88
    v_add_f32 v15, v15, v89
    v_mfma_f32_16x16x32_bf16 v[100:103], v[76:79], a[36:39], v[100:103]
    v_cvt_pk_bf16_f32 v104, v88, v89
    v_mfma_f32_16x16x32_bf16 v[100:103], v[72:75], a[32:35], v[100:103]
    v_exp_f32 v92, v92
    s_waitcnt lgkmcnt(0)
    v_mfma_f32_16x16x32_bf16 v[144:147], v[112:115], v[108:111], v[144:147]
    buffer_load_dwordx4 v26, s[16:19], s28 offen lds
    v_exp_f32 v93, v93
    v_mfma_f32_16x16x32_bf16 v[172:175], v[116:119], v[108:111], v[172:175]
    v_add_f32 v14, v14, v90
    v_add_f32 v15, v15, v91
    v_mfma_f32_16x16x32_bf16 v[200:203], v[120:123], v[108:111], v[200:203]
    s_add_u32 m0, m0, s53
    v_cvt_pk_bf16_f32 v105, v90, v91
    v_mfma_f32_16x16x32_bf16 v[228:231], v[124:127], v[108:111], v[228:231]
    v_exp_f32 v94, v94
    v_mfma_f32_16x16x32_bf16 a[112:115], v[128:131], v[108:111], a[112:115]
    s_add_u32 s28, s49, s89
    v_exp_f32 v95, v95
    v_mfma_f32_16x16x32_bf16 a[140:143], v[132:135], v[108:111], a[140:143]
    v_add_f32 v14, v14, v92
    v_add_f32 v15, v15, v93
    v_mfma_f32_16x16x32_bf16 a[168:171], v[136:139], v[108:111], a[168:171]
    buffer_load_dwordx4 v26, s[16:19], s28 offen lds
    v_cvt_pk_bf16_f32 v106, v92, v93
    v_add_f32 v14, v14, v94
    v_mfma_f32_16x16x32_bf16 a[196:199], v[140:143], v[108:111], a[196:199]
    v_add_f32 v15, v15, v95
    v_cvt_pk_bf16_f32 v107, v94, v95
    v_mfma_f32_16x16x32_bf16 v[88:91], v[56:59], a[48:51], v[40:43]
    v_mfma_f32_16x16x32_bf16 v[88:91], v[60:63], a[52:55], v[88:91]
    s_add_u32 m0, m0, s53
    v_exp_f32 v96, v96
    v_mfma_f32_16x16x32_bf16 v[88:91], v[64:67], a[56:59], v[88:91]
    v_exp_f32 v97, v97
    v_mfma_f32_16x16x32_bf16 v[88:91], v[68:71], a[60:63], v[88:91]
    s_add_u32 s28, s49, s90
    v_exp_f32 v98, v98
    v_mfma_f32_16x16x32_bf16 v[92:95], v[84:87], a[60:63], v[40:43]
    v_exp_f32 v99, v99
    v_mfma_f32_16x16x32_bf16 v[92:95], v[80:83], a[56:59], v[92:95]
    buffer_load_dwordx4 v26, s[16:19], s28 offen lds
    v_add_f32 v16, v16, v96
    v_add_f32 v17, v17, v97
    v_mfma_f32_16x16x32_bf16 v[92:95], v[76:79], a[52:55], v[92:95]
    v_cvt_pk_bf16_f32 v108, v96, v97
    v_mfma_f32_16x16x32_bf16 v[92:95], v[72:75], a[48:51], v[92:95]
    v_exp_f32 v100, v100
    v_mfma_f32_16x16x32_bf16 v[148:151], v[112:115], v[104:107], v[148:151]
    s_add_u32 m0, m0, s53
    v_exp_f32 v101, v101
    v_mfma_f32_16x16x32_bf16 v[176:179], v[116:119], v[104:107], v[176:179]
    v_add_f32 v16, v16, v98
    v_add_f32 v17, v17, v99
    v_mfma_f32_16x16x32_bf16 v[204:207], v[120:123], v[104:107], v[204:207]
    s_add_u32 s28, s49, s91
    v_cvt_pk_bf16_f32 v109, v98, v99
    v_mfma_f32_16x16x32_bf16 v[232:235], v[124:127], v[104:107], v[232:235]
    v_exp_f32 v102, v102
    v_mfma_f32_16x16x32_bf16 a[116:119], v[128:131], v[104:107], a[116:119]
    buffer_load_dwordx4 v26, s[16:19], s28 offen lds
    v_exp_f32 v103, v103
    v_mfma_f32_16x16x32_bf16 a[144:147], v[132:135], v[104:107], a[144:147]
    v_add_f32 v16, v16, v100
    v_add_f32 v17, v17, v101
    v_mfma_f32_16x16x32_bf16 a[172:175], v[136:139], v[104:107], a[172:175]
    s_add_u32 m0, m0, s53
    v_cvt_pk_bf16_f32 v110, v100, v101
    v_add_f32 v16, v16, v102
    v_mfma_f32_16x16x32_bf16 a[200:203], v[140:143], v[104:107], a[200:203]
    v_add_f32 v17, v17, v103
    v_cvt_pk_bf16_f32 v111, v102, v103
    v_mfma_f32_16x16x32_bf16 v[96:99], v[56:59], a[64:67], v[44:47]
    v_mfma_f32_16x16x32_bf16 v[96:99], v[60:63], a[68:71], v[96:99]
    s_add_u32 s28, s49, s92
    v_exp_f32 v88, v88
    v_mfma_f32_16x16x32_bf16 v[96:99], v[64:67], a[72:75], v[96:99]
    v_exp_f32 v89, v89
    v_mfma_f32_16x16x32_bf16 v[96:99], v[68:71], a[76:79], v[96:99]
    buffer_load_dwordx4 v26, s[16:19], s28 offen lds
    v_exp_f32 v90, v90
    v_mfma_f32_16x16x32_bf16 v[100:103], v[84:87], a[76:79], v[44:47]
    v_exp_f32 v91, v91
    v_mfma_f32_16x16x32_bf16 v[100:103], v[80:83], a[72:75], v[100:103]
    s_add_u32 m0, m0, s53
    v_add_f32 v18, v18, v88
    v_add_f32 v19, v19, v89
    v_mfma_f32_16x16x32_bf16 v[100:103], v[76:79], a[68:71], v[100:103]
    v_cvt_pk_bf16_f32 v104, v88, v89
    v_mfma_f32_16x16x32_bf16 v[100:103], v[72:75], a[64:67], v[100:103]
    v_exp_f32 v92, v92
    v_mfma_f32_16x16x32_bf16 v[152:155], v[112:115], v[108:111], v[152:155]
    s_add_u32 s28, s49, s93
    v_exp_f32 v93, v93
    v_mfma_f32_16x16x32_bf16 v[180:183], v[116:119], v[108:111], v[180:183]
    v_add_f32 v18, v18, v90
    v_add_f32 v19, v19, v91
    v_mfma_f32_16x16x32_bf16 v[208:211], v[120:123], v[108:111], v[208:211]
    buffer_load_dwordx4 v26, s[16:19], s28 offen lds
    v_cvt_pk_bf16_f32 v105, v90, v91
    v_mfma_f32_16x16x32_bf16 v[236:239], v[124:127], v[108:111], v[236:239]
    v_exp_f32 v94, v94
    v_mfma_f32_16x16x32_bf16 a[120:123], v[128:131], v[108:111], a[120:123]
    s_add_u32 m0, m0, s53
    v_exp_f32 v95, v95
    v_mfma_f32_16x16x32_bf16 a[148:151], v[132:135], v[108:111], a[148:151]
    v_add_f32 v18, v18, v92
    v_add_f32 v19, v19, v93
    v_mfma_f32_16x16x32_bf16 a[176:179], v[136:139], v[108:111], a[176:179]
    s_add_u32 s28, s49, s94
    v_cvt_pk_bf16_f32 v106, v92, v93
    v_add_f32 v18, v18, v94
    v_mfma_f32_16x16x32_bf16 a[204:207], v[140:143], v[108:111], a[204:207]
    v_add_f32 v19, v19, v95
    v_cvt_pk_bf16_f32 v107, v94, v95
    v_mfma_f32_16x16x32_bf16 v[88:91], v[56:59], a[80:83], v[48:51]
    v_mfma_f32_16x16x32_bf16 v[88:91], v[60:63], a[84:87], v[88:91]
    buffer_load_dwordx4 v26, s[16:19], s28 offen lds
    v_exp_f32 v96, v96
    v_mfma_f32_16x16x32_bf16 v[88:91], v[64:67], a[88:91], v[88:91]
    v_exp_f32 v97, v97
    v_mfma_f32_16x16x32_bf16 v[88:91], v[68:71], a[92:95], v[88:91]
    s_add_u32 m0, m0, s53
    v_exp_f32 v98, v98
    v_mfma_f32_16x16x32_bf16 v[92:95], v[84:87], a[92:95], v[48:51]
    v_exp_f32 v99, v99
    v_mfma_f32_16x16x32_bf16 v[92:95], v[80:83], a[88:91], v[92:95]
    s_add_u32 s28, s49, s95
    v_add_f32 v20, v20, v96
    v_add_f32 v21, v21, v97
    v_mfma_f32_16x16x32_bf16 v[92:95], v[76:79], a[84:87], v[92:95]
    v_cvt_pk_bf16_f32 v108, v96, v97
    v_mfma_f32_16x16x32_bf16 v[92:95], v[72:75], a[80:83], v[92:95]
    v_exp_f32 v100, v100
    v_mfma_f32_16x16x32_bf16 v[156:159], v[112:115], v[104:107], v[156:159]
    buffer_load_dwordx4 v26, s[16:19], s28 offen lds
    v_exp_f32 v101, v101
    v_mfma_f32_16x16x32_bf16 v[184:187], v[116:119], v[104:107], v[184:187]
    v_add_f32 v20, v20, v98
    v_add_f32 v21, v21, v99
    v_mfma_f32_16x16x32_bf16 v[212:215], v[120:123], v[104:107], v[212:215]
    v_cvt_pk_bf16_f32 v109, v98, v99
    v_mfma_f32_16x16x32_bf16 v[240:243], v[124:127], v[104:107], v[240:243]
    v_exp_f32 v102, v102
    v_mfma_f32_16x16x32_bf16 a[124:127], v[128:131], v[104:107], a[124:127]
    v_exp_f32 v103, v103
    v_mfma_f32_16x16x32_bf16 a[152:155], v[132:135], v[104:107], a[152:155]
    v_add_f32 v20, v20, v100
    v_add_f32 v21, v21, v101
    v_mfma_f32_16x16x32_bf16 a[180:183], v[136:139], v[104:107], a[180:183]
    v_cvt_pk_bf16_f32 v110, v100, v101
    v_add_f32 v20, v20, v102
    v_mfma_f32_16x16x32_bf16 a[208:211], v[140:143], v[104:107], a[208:211]
    v_add_f32 v21, v21, v103
    v_cvt_pk_bf16_f32 v111, v102, v103
    s_waitcnt vmcnt(16) lgkmcnt(0)
    s_barrier
    v_mfma_f32_16x16x32_bf16 v[96:99], v[56:59], a[96:99], v[52:55]
    ds_read_b128 v[56:59], v8 offset:16896
    v_mfma_f32_16x16x32_bf16 v[96:99], v[60:63], a[100:103], v[96:99]
    ds_read_b128 v[60:63], v8 offset:16960
    v_exp_f32 v88, v88
    v_mfma_f32_16x16x32_bf16 v[96:99], v[64:67], a[104:107], v[96:99]
    ds_read_b128 v[64:67], v8 offset:17024
    v_exp_f32 v89, v89
    v_mfma_f32_16x16x32_bf16 v[96:99], v[68:71], a[108:111], v[96:99]
    ds_read_b128 v[68:71], v8 offset:17088
    v_exp_f32 v90, v90
    v_mfma_f32_16x16x32_bf16 v[100:103], v[84:87], a[108:111], v[52:55]
    ds_read_b128 v[84:87], v8 offset:17600
    v_exp_f32 v91, v91
    v_mfma_f32_16x16x32_bf16 v[100:103], v[80:83], a[104:107], v[100:103]
    ds_read_b128 v[80:83], v8 offset:17536
    v_add_f32 v22, v22, v88
    v_add_f32 v23, v23, v89
    v_mfma_f32_16x16x32_bf16 v[100:103], v[76:79], a[100:103], v[100:103]
    ds_read_b128 v[76:79], v8 offset:17472
    v_cvt_pk_bf16_f32 v104, v88, v89
    v_mfma_f32_16x16x32_bf16 v[100:103], v[72:75], a[96:99], v[100:103]
    ds_read_b128 v[72:75], v8 offset:17408
    v_exp_f32 v92, v92
    v_mfma_f32_16x16x32_bf16 v[160:163], v[112:115], v[108:111], v[160:163]
    v_exp_f32 v93, v93
    v_mfma_f32_16x16x32_bf16 v[188:191], v[116:119], v[108:111], v[188:191]
    v_add_f32 v22, v22, v90
    v_add_f32 v23, v23, v91
    v_mfma_f32_16x16x32_bf16 v[216:219], v[120:123], v[108:111], v[216:219]
    v_cvt_pk_bf16_f32 v105, v90, v91
    v_mfma_f32_16x16x32_bf16 v[244:247], v[124:127], v[108:111], v[244:247]
    v_exp_f32 v94, v94
    v_mfma_f32_16x16x32_bf16 a[128:131], v[128:131], v[108:111], a[128:131]
    v_exp_f32 v95, v95
    v_mfma_f32_16x16x32_bf16 a[156:159], v[132:135], v[108:111], a[156:159]
    v_add_f32 v22, v22, v92
    v_add_f32 v23, v23, v93
    v_mfma_f32_16x16x32_bf16 a[184:187], v[136:139], v[108:111], a[184:187]
    v_cvt_pk_bf16_f32 v106, v92, v93
    v_add_f32 v22, v22, v94
    v_mfma_f32_16x16x32_bf16 a[212:215], v[140:143], v[108:111], a[212:215]
    v_add_f32 v23, v23, v95
    v_cvt_pk_bf16_f32 v107, v94, v95
    s_waitcnt lgkmcnt(0)
    v_mfma_f32_16x16x32_bf16 v[88:91], v[56:59], a[0:3], v[28:31]
    v_mfma_f32_16x16x32_bf16 v[88:91], v[60:63], a[4:7], v[88:91]
    v_exp_f32 v96, v96
    v_mfma_f32_16x16x32_bf16 v[88:91], v[64:67], a[8:11], v[88:91]
    v_exp_f32 v97, v97
    v_mfma_f32_16x16x32_bf16 v[88:91], v[68:71], a[12:15], v[88:91]
    v_exp_f32 v98, v98
    v_mfma_f32_16x16x32_bf16 v[92:95], v[84:87], a[12:15], v[28:31]
    v_exp_f32 v99, v99
    v_mfma_f32_16x16x32_bf16 v[92:95], v[80:83], a[8:11], v[92:95]
    v_add_f32 v24, v24, v96
    v_add_f32 v25, v25, v97
    v_mfma_f32_16x16x32_bf16 v[92:95], v[76:79], a[4:7], v[92:95]
    v_cvt_pk_bf16_f32 v108, v96, v97
    v_mfma_f32_16x16x32_bf16 v[92:95], v[72:75], a[0:3], v[92:95]
    v_exp_f32 v100, v100
    v_mfma_f32_16x16x32_bf16 v[164:167], v[112:115], v[104:107], v[164:167]
    v_exp_f32 v101, v101
    v_mfma_f32_16x16x32_bf16 v[192:195], v[116:119], v[104:107], v[192:195]
    v_add_f32 v24, v24, v98
    v_add_f32 v25, v25, v99
    v_mfma_f32_16x16x32_bf16 v[220:223], v[120:123], v[104:107], v[220:223]
    v_cvt_pk_bf16_f32 v109, v98, v99
    v_mfma_f32_16x16x32_bf16 v[248:251], v[124:127], v[104:107], v[248:251]
    v_exp_f32 v102, v102
    v_mfma_f32_16x16x32_bf16 a[132:135], v[128:131], v[104:107], a[132:135]
    v_exp_f32 v103, v103
    v_mfma_f32_16x16x32_bf16 a[160:163], v[132:135], v[104:107], a[160:163]
    v_add_f32 v24, v24, v100
    v_add_f32 v25, v25, v101
    v_mfma_f32_16x16x32_bf16 a[188:191], v[136:139], v[104:107], a[188:191]
    v_cvt_pk_bf16_f32 v110, v100, v101
    v_add_f32 v24, v24, v102
    v_mfma_f32_16x16x32_bf16 a[216:219], v[140:143], v[104:107], a[216:219]
    v_add_f32 v25, v25, v103
    v_cvt_pk_bf16_f32 v111, v102, v103
    v_mfma_f32_16x16x32_bf16 v[96:99], v[56:59], a[16:19], v[32:35]
    v_mfma_f32_16x16x32_bf16 v[96:99], v[60:63], a[20:23], v[96:99]
    v_exp_f32 v88, v88
    v_mfma_f32_16x16x32_bf16 v[96:99], v[64:67], a[24:27], v[96:99]
    v_exp_f32 v89, v89
    v_mfma_f32_16x16x32_bf16 v[96:99], v[68:71], a[28:31], v[96:99]
    v_exp_f32 v90, v90
    v_mfma_f32_16x16x32_bf16 v[100:103], v[84:87], a[28:31], v[32:35]
    v_exp_f32 v91, v91
    v_mfma_f32_16x16x32_bf16 v[100:103], v[80:83], a[24:27], v[100:103]
    v_add_f32 v12, v12, v88
    v_add_f32 v13, v13, v89
    v_mfma_f32_16x16x32_bf16 v[100:103], v[76:79], a[20:23], v[100:103]
    v_cvt_pk_bf16_f32 v104, v88, v89
    v_mfma_f32_16x16x32_bf16 v[100:103], v[72:75], a[16:19], v[100:103]
    v_exp_f32 v92, v92
    v_mfma_f32_16x16x32_bf16 v[168:171], v[112:115], v[108:111], v[168:171]
    ds_read_b64_tr_b16 v[112:113], v9 offset:16896
    ds_read_b64_tr_b16 v[114:115], v9 offset:17408
    v_exp_f32 v93, v93
    v_mfma_f32_16x16x32_bf16 v[196:199], v[116:119], v[108:111], v[196:199]
    ds_read_b64_tr_b16 v[116:117], v9 offset:16928
    ds_read_b64_tr_b16 v[118:119], v9 offset:17440
    v_add_f32 v12, v12, v90
    v_add_f32 v13, v13, v91
    v_mfma_f32_16x16x32_bf16 v[224:227], v[120:123], v[108:111], v[224:227]
    ds_read_b64_tr_b16 v[120:121], v9 offset:16960
    ds_read_b64_tr_b16 v[122:123], v9 offset:17472
    v_cvt_pk_bf16_f32 v105, v90, v91
    v_mfma_f32_16x16x32_bf16 v[252:255], v[124:127], v[108:111], v[252:255]
    ds_read_b64_tr_b16 v[124:125], v9 offset:16992
    ds_read_b64_tr_b16 v[126:127], v9 offset:17504
    v_exp_f32 v94, v94
    v_mfma_f32_16x16x32_bf16 a[136:139], v[128:131], v[108:111], a[136:139]
    ds_read_b64_tr_b16 v[128:129], v9 offset:17024
    ds_read_b64_tr_b16 v[130:131], v9 offset:17536
    v_exp_f32 v95, v95
    v_mfma_f32_16x16x32_bf16 a[164:167], v[132:135], v[108:111], a[164:167]
    ds_read_b64_tr_b16 v[132:133], v9 offset:17056
    ds_read_b64_tr_b16 v[134:135], v9 offset:17568
    v_add_f32 v12, v12, v92
    v_add_f32 v13, v13, v93
    v_mfma_f32_16x16x32_bf16 a[192:195], v[136:139], v[108:111], a[192:195]
    ds_read_b64_tr_b16 v[136:137], v9 offset:17088
    ds_read_b64_tr_b16 v[138:139], v9 offset:17600
    v_cvt_pk_bf16_f32 v106, v92, v93
    v_add_f32 v12, v12, v94
    v_mfma_f32_16x16x32_bf16 a[220:223], v[140:143], v[108:111], a[220:223]
    ds_read_b64_tr_b16 v[140:141], v9 offset:17120
    ds_read_b64_tr_b16 v[142:143], v9 offset:17632
    v_add_f32 v13, v13, v95
    v_cvt_pk_bf16_f32 v107, v94, v95
    v_mfma_f32_16x16x32_bf16 v[88:91], v[56:59], a[32:35], v[36:39]
    v_mfma_f32_16x16x32_bf16 v[88:91], v[60:63], a[36:39], v[88:91]
    s_add_u32 m0, s33, 8448
    v_exp_f32 v96, v96
    v_mfma_f32_16x16x32_bf16 v[88:91], v[64:67], a[40:43], v[88:91]
    v_exp_f32 v97, v97
    v_mfma_f32_16x16x32_bf16 v[88:91], v[68:71], a[44:47], v[88:91]
    s_add_u32 s49, s50, s46
    v_exp_f32 v98, v98
    v_mfma_f32_16x16x32_bf16 v[92:95], v[84:87], a[44:47], v[36:39]
    v_exp_f32 v99, v99
    v_mfma_f32_16x16x32_bf16 v[92:95], v[80:83], a[40:43], v[92:95]
    s_lshl1_add_u32 s50, s51, s50
    v_add_f32 v14, v14, v96
    v_add_f32 v15, v15, v97
    v_mfma_f32_16x16x32_bf16 v[92:95], v[76:79], a[36:39], v[92:95]
    v_cvt_pk_bf16_f32 v108, v96, v97
    v_mfma_f32_16x16x32_bf16 v[92:95], v[72:75], a[32:35], v[92:95]
    s_add_u32 s82, s82, 2
    v_exp_f32 v100, v100
    s_waitcnt lgkmcnt(0)
    v_mfma_f32_16x16x32_bf16 v[144:147], v[112:115], v[104:107], v[144:147]
    v_exp_f32 v101, v101
    v_mfma_f32_16x16x32_bf16 v[172:175], v[116:119], v[104:107], v[172:175]
    s_cmp_eq_u32 s82, 20
    v_add_f32 v14, v14, v98
    v_add_f32 v15, v15, v99
    v_mfma_f32_16x16x32_bf16 v[200:203], v[120:123], v[104:107], v[200:203]
    v_cvt_pk_bf16_f32 v109, v98, v99
    v_mfma_f32_16x16x32_bf16 v[228:231], v[124:127], v[104:107], v[228:231]
    s_cselect_b32 s29, s83, 0
    v_exp_f32 v102, v102
    v_mfma_f32_16x16x32_bf16 a[112:115], v[128:131], v[104:107], a[112:115]
    v_exp_f32 v103, v103
    v_mfma_f32_16x16x32_bf16 a[140:143], v[132:135], v[104:107], a[140:143]
    s_sub_u32 s50, s50, s29
    v_add_f32 v14, v14, v100
    v_add_f32 v15, v15, v101
    v_mfma_f32_16x16x32_bf16 a[168:171], v[136:139], v[104:107], a[168:171]
    v_cvt_pk_bf16_f32 v110, v100, v101
    v_add_f32 v14, v14, v102
    v_mfma_f32_16x16x32_bf16 a[196:199], v[140:143], v[104:107], a[196:199]
    s_add_u32 s28, s49, s88
    v_add_f32 v15, v15, v103
    v_cvt_pk_bf16_f32 v111, v102, v103
    v_mfma_f32_16x16x32_bf16 v[96:99], v[56:59], a[48:51], v[40:43]
    v_mfma_f32_16x16x32_bf16 v[96:99], v[60:63], a[52:55], v[96:99]
    buffer_load_dwordx4 v26, s[16:19], s28 offen lds
    v_exp_f32 v88, v88
    v_mfma_f32_16x16x32_bf16 v[96:99], v[64:67], a[56:59], v[96:99]
    v_exp_f32 v89, v89
    v_mfma_f32_16x16x32_bf16 v[96:99], v[68:71], a[60:63], v[96:99]
    s_add_u32 m0, m0, s53
    v_exp_f32 v90, v90
    v_mfma_f32_16x16x32_bf16 v[100:103], v[84:87], a[60:63], v[40:43]
    v_exp_f32 v91, v91
    v_mfma_f32_16x16x32_bf16 v[100:103], v[80:83], a[56:59], v[100:103]
    s_add_u32 s28, s49, s89
    v_add_f32 v16, v16, v88
    v_add_f32 v17, v17, v89
    v_mfma_f32_16x16x32_bf16 v[100:103], v[76:79], a[52:55], v[100:103]
    v_cvt_pk_bf16_f32 v104, v88, v89
    v_mfma_f32_16x16x32_bf16 v[100:103], v[72:75], a[48:51], v[100:103]
    buffer_load_dwordx4 v26, s[16:19], s28 offen lds
    v_exp_f32 v92, v92
    v_mfma_f32_16x16x32_bf16 v[148:151], v[112:115], v[108:111], v[148:151]
    v_exp_f32 v93, v93
    v_mfma_f32_16x16x32_bf16 v[176:179], v[116:119], v[108:111], v[176:179]
    s_add_u32 m0, m0, s53
    v_add_f32 v16, v16, v90
    v_add_f32 v17, v17, v91
    v_mfma_f32_16x16x32_bf16 v[204:207], v[120:123], v[108:111], v[204:207]
    v_cvt_pk_bf16_f32 v105, v90, v91
    v_mfma_f32_16x16x32_bf16 v[232:235], v[124:127], v[108:111], v[232:235]
    s_add_u32 s28, s49, s90
    v_exp_f32 v94, v94
    v_mfma_f32_16x16x32_bf16 a[116:119], v[128:131], v[108:111], a[116:119]
    v_exp_f32 v95, v95
    v_mfma_f32_16x16x32_bf16 a[144:147], v[132:135], v[108:111], a[144:147]
    buffer_load_dwordx4 v26, s[16:19], s28 offen lds
    v_add_f32 v16, v16, v92
    v_add_f32 v17, v17, v93
    v_mfma_f32_16x16x32_bf16 a[172:175], v[136:139], v[108:111], a[172:175]
    v_cvt_pk_bf16_f32 v106, v92, v93
    v_add_f32 v16, v16, v94
    v_mfma_f32_16x16x32_bf16 a[200:203], v[140:143], v[108:111], a[200:203]
    s_add_u32 m0, m0, s53
    v_add_f32 v17, v17, v95
    v_cvt_pk_bf16_f32 v107, v94, v95
    v_mfma_f32_16x16x32_bf16 v[88:91], v[56:59], a[64:67], v[44:47]
    v_mfma_f32_16x16x32_bf16 v[88:91], v[60:63], a[68:71], v[88:91]
    s_add_u32 s28, s49, s91
    v_exp_f32 v96, v96
    v_mfma_f32_16x16x32_bf16 v[88:91], v[64:67], a[72:75], v[88:91]
    v_exp_f32 v97, v97
    v_mfma_f32_16x16x32_bf16 v[88:91], v[68:71], a[76:79], v[88:91]
    buffer_load_dwordx4 v26, s[16:19], s28 offen lds
    v_exp_f32 v98, v98
    v_mfma_f32_16x16x32_bf16 v[92:95], v[84:87], a[76:79], v[44:47]
    v_exp_f32 v99, v99
    v_mfma_f32_16x16x32_bf16 v[92:95], v[80:83], a[72:75], v[92:95]
    s_add_u32 m0, m0, s53
    v_add_f32 v18, v18, v96
    v_add_f32 v19, v19, v97
    v_mfma_f32_16x16x32_bf16 v[92:95], v[76:79], a[68:71], v[92:95]
    v_cvt_pk_bf16_f32 v108, v96, v97
    v_mfma_f32_16x16x32_bf16 v[92:95], v[72:75], a[64:67], v[92:95]
    s_add_u32 s28, s49, s92
    v_exp_f32 v100, v100
    v_mfma_f32_16x16x32_bf16 v[152:155], v[112:115], v[104:107], v[152:155]
    v_exp_f32 v101, v101
    v_mfma_f32_16x16x32_bf16 v[180:183], v[116:119], v[104:107], v[180:183]
    buffer_load_dwordx4 v26, s[16:19], s28 offen lds
    v_add_f32 v18, v18, v98
    v_add_f32 v19, v19, v99
    v_mfma_f32_16x16x32_bf16 v[208:211], v[120:123], v[104:107], v[208:211]
    v_cvt_pk_bf16_f32 v109, v98, v99
    v_mfma_f32_16x16x32_bf16 v[236:239], v[124:127], v[104:107], v[236:239]
    s_add_u32 m0, m0, s53
    v_exp_f32 v102, v102
    v_mfma_f32_16x16x32_bf16 a[120:123], v[128:131], v[104:107], a[120:123]
    v_exp_f32 v103, v103
    v_mfma_f32_16x16x32_bf16 a[148:151], v[132:135], v[104:107], a[148:151]
    s_add_u32 s28, s49, s93
    v_add_f32 v18, v18, v100
    v_add_f32 v19, v19, v101
    v_mfma_f32_16x16x32_bf16 a[176:179], v[136:139], v[104:107], a[176:179]
    v_cvt_pk_bf16_f32 v110, v100, v101
    v_add_f32 v18, v18, v102
    v_mfma_f32_16x16x32_bf16 a[204:207], v[140:143], v[104:107], a[204:207]
    buffer_load_dwordx4 v26, s[16:19], s28 offen lds
    v_add_f32 v19, v19, v103
    v_cvt_pk_bf16_f32 v111, v102, v103
    v_mfma_f32_16x16x32_bf16 v[96:99], v[56:59], a[80:83], v[48:51]
    v_mfma_f32_16x16x32_bf16 v[96:99], v[60:63], a[84:87], v[96:99]
    s_add_u32 m0, m0, s53
    v_exp_f32 v88, v88
    v_mfma_f32_16x16x32_bf16 v[96:99], v[64:67], a[88:91], v[96:99]
    v_exp_f32 v89, v89
    v_mfma_f32_16x16x32_bf16 v[96:99], v[68:71], a[92:95], v[96:99]
    s_add_u32 s28, s49, s94
    v_exp_f32 v90, v90
    v_mfma_f32_16x16x32_bf16 v[100:103], v[84:87], a[92:95], v[48:51]
    v_exp_f32 v91, v91
    v_mfma_f32_16x16x32_bf16 v[100:103], v[80:83], a[88:91], v[100:103]
    buffer_load_dwordx4 v26, s[16:19], s28 offen lds
    v_add_f32 v20, v20, v88
    v_add_f32 v21, v21, v89
    v_mfma_f32_16x16x32_bf16 v[100:103], v[76:79], a[84:87], v[100:103]
    v_cvt_pk_bf16_f32 v104, v88, v89
    v_mfma_f32_16x16x32_bf16 v[100:103], v[72:75], a[80:83], v[100:103]
    s_add_u32 m0, m0, s53
    v_exp_f32 v92, v92
    v_mfma_f32_16x16x32_bf16 v[156:159], v[112:115], v[108:111], v[156:159]
    v_exp_f32 v93, v93
    v_mfma_f32_16x16x32_bf16 v[184:187], v[116:119], v[108:111], v[184:187]
    s_add_u32 s28, s49, s95
    v_add_f32 v20, v20, v90
    v_add_f32 v21, v21, v91
    v_mfma_f32_16x16x32_bf16 v[212:215], v[120:123], v[108:111], v[212:215]
    v_cvt_pk_bf16_f32 v105, v90, v91
    v_mfma_f32_16x16x32_bf16 v[240:243], v[124:127], v[108:111], v[240:243]
    buffer_load_dwordx4 v26, s[16:19], s28 offen lds
    v_exp_f32 v94, v94
    v_mfma_f32_16x16x32_bf16 a[124:127], v[128:131], v[108:111], a[124:127]
    v_exp_f32 v95, v95
    v_mfma_f32_16x16x32_bf16 a[152:155], v[132:135], v[108:111], a[152:155]
    v_add_f32 v20, v20, v92
    v_add_f32 v21, v21, v93
    v_mfma_f32_16x16x32_bf16 a[180:183], v[136:139], v[108:111], a[180:183]
    v_cvt_pk_bf16_f32 v106, v92, v93
    v_add_f32 v20, v20, v94
    v_mfma_f32_16x16x32_bf16 a[208:211], v[140:143], v[108:111], a[208:211]
    v_add_f32 v21, v21, v95
    v_cvt_pk_bf16_f32 v107, v94, v95
    s_waitcnt vmcnt(16) lgkmcnt(0)
    s_barrier
    v_mfma_f32_16x16x32_bf16 v[88:91], v[56:59], a[96:99], v[52:55]
    ds_read_b128 v[56:59], v8 offset:25344
    v_mfma_f32_16x16x32_bf16 v[88:91], v[60:63], a[100:103], v[88:91]
    ds_read_b128 v[60:63], v8 offset:25408
    v_exp_f32 v96, v96
    v_mfma_f32_16x16x32_bf16 v[88:91], v[64:67], a[104:107], v[88:91]
    ds_read_b128 v[64:67], v8 offset:25472
    v_exp_f32 v97, v97
    v_mfma_f32_16x16x32_bf16 v[88:91], v[68:71], a[108:111], v[88:91]
    ds_read_b128 v[68:71], v8 offset:25536
    v_exp_f32 v98, v98
    v_mfma_f32_16x16x32_bf16 v[92:95], v[84:87], a[108:111], v[52:55]
    ds_read_b128 v[84:87], v8 offset:26048
    v_exp_f32 v99, v99
    v_mfma_f32_16x16x32_bf16 v[92:95], v[80:83], a[104:107], v[92:95]
    ds_read_b128 v[80:83], v8 offset:25984
    v_add_f32 v22, v22, v96
    v_add_f32 v23, v23, v97
    v_mfma_f32_16x16x32_bf16 v[92:95], v[76:79], a[100:103], v[92:95]
    ds_read_b128 v[76:79], v8 offset:25920
    v_cvt_pk_bf16_f32 v108, v96, v97
    v_mfma_f32_16x16x32_bf16 v[92:95], v[72:75], a[96:99], v[92:95]
    ds_read_b128 v[72:75], v8 offset:25856
    v_exp_f32 v100, v100
    v_mfma_f32_16x16x32_bf16 v[160:163], v[112:115], v[104:107], v[160:163]
    v_exp_f32 v101, v101
    v_mfma_f32_16x16x32_bf16 v[188:191], v[116:119], v[104:107], v[188:191]
    v_add_f32 v22, v22, v98
    v_add_f32 v23, v23, v99
    v_mfma_f32_16x16x32_bf16 v[216:219], v[120:123], v[104:107], v[216:219]
    v_cvt_pk_bf16_f32 v109, v98, v99
    v_mfma_f32_16x16x32_bf16 v[244:247], v[124:127], v[104:107], v[244:247]
    v_exp_f32 v102, v102
    v_mfma_f32_16x16x32_bf16 a[128:131], v[128:131], v[104:107], a[128:131]
    v_exp_f32 v103, v103
    v_mfma_f32_16x16x32_bf16 a[156:159], v[132:135], v[104:107], a[156:159]
    v_add_f32 v22, v22, v100
    v_add_f32 v23, v23, v101
    v_mfma_f32_16x16x32_bf16 a[184:187], v[136:139], v[104:107], a[184:187]
    v_cvt_pk_bf16_f32 v110, v100, v101
    v_add_f32 v22, v22, v102
    v_mfma_f32_16x16x32_bf16 a[212:215], v[140:143], v[104:107], a[212:215]
    v_add_f32 v23, v23, v103
    v_cvt_pk_bf16_f32 v111, v102, v103
    s_waitcnt lgkmcnt(0)
    v_mfma_f32_16x16x32_bf16 v[96:99], v[56:59], a[0:3], v[28:31]
    v_mfma_f32_16x16x32_bf16 v[96:99], v[60:63], a[4:7], v[96:99]
    v_exp_f32 v88, v88
    v_mfma_f32_16x16x32_bf16 v[96:99], v[64:67], a[8:11], v[96:99]
    v_exp_f32 v89, v89
    v_mfma_f32_16x16x32_bf16 v[96:99], v[68:71], a[12:15], v[96:99]
    v_exp_f32 v90, v90
    v_mfma_f32_16x16x32_bf16 v[100:103], v[84:87], a[12:15], v[28:31]
    v_exp_f32 v91, v91
    v_mfma_f32_16x16x32_bf16 v[100:103], v[80:83], a[8:11], v[100:103]
    v_add_f32 v24, v24, v88
    v_add_f32 v25, v25, v89
    v_mfma_f32_16x16x32_bf16 v[100:103], v[76:79], a[4:7], v[100:103]
    v_cvt_pk_bf16_f32 v104, v88, v89
    v_mfma_f32_16x16x32_bf16 v[100:103], v[72:75], a[0:3], v[100:103]
    v_exp_f32 v92, v92
    v_mfma_f32_16x16x32_bf16 v[164:167], v[112:115], v[108:111], v[164:167]
    v_exp_f32 v93, v93
    v_mfma_f32_16x16x32_bf16 v[192:195], v[116:119], v[108:111], v[192:195]
    v_add_f32 v24, v24, v90
    v_add_f32 v25, v25, v91
    v_mfma_f32_16x16x32_bf16 v[220:223], v[120:123], v[108:111], v[220:223]
    v_cvt_pk_bf16_f32 v105, v90, v91
    v_mfma_f32_16x16x32_bf16 v[248:251], v[124:127], v[108:111], v[248:251]
    v_exp_f32 v94, v94
    v_mfma_f32_16x16x32_bf16 a[132:135], v[128:131], v[108:111], a[132:135]
    v_exp_f32 v95, v95
    v_mfma_f32_16x16x32_bf16 a[160:163], v[132:135], v[108:111], a[160:163]
    v_add_f32 v24, v24, v92
    v_add_f32 v25, v25, v93
    v_mfma_f32_16x16x32_bf16 a[188:191], v[136:139], v[108:111], a[188:191]
    v_cvt_pk_bf16_f32 v106, v92, v93
    v_add_f32 v24, v24, v94
    v_mfma_f32_16x16x32_bf16 a[216:219], v[140:143], v[108:111], a[216:219]
    v_add_f32 v25, v25, v95
    v_cvt_pk_bf16_f32 v107, v94, v95
    v_mfma_f32_16x16x32_bf16 v[88:91], v[56:59], a[16:19], v[32:35]
    v_mfma_f32_16x16x32_bf16 v[88:91], v[60:63], a[20:23], v[88:91]
    v_exp_f32 v96, v96
    v_mfma_f32_16x16x32_bf16 v[88:91], v[64:67], a[24:27], v[88:91]
    v_exp_f32 v97, v97
    v_mfma_f32_16x16x32_bf16 v[88:91], v[68:71], a[28:31], v[88:91]
    v_exp_f32 v98, v98
    v_mfma_f32_16x16x32_bf16 v[92:95], v[84:87], a[28:31], v[32:35]
    v_exp_f32 v99, v99
    v_mfma_f32_16x16x32_bf16 v[92:95], v[80:83], a[24:27], v[92:95]
    v_add_f32 v12, v12, v96
    v_add_f32 v13, v13, v97
    v_mfma_f32_16x16x32_bf16 v[92:95], v[76:79], a[20:23], v[92:95]
    v_cvt_pk_bf16_f32 v108, v96, v97
    v_mfma_f32_16x16x32_bf16 v[92:95], v[72:75], a[16:19], v[92:95]
    v_exp_f32 v100, v100
    v_mfma_f32_16x16x32_bf16 v[168:171], v[112:115], v[104:107], v[168:171]
    ds_read_b64_tr_b16 v[112:113], v9 offset:25344
    ds_read_b64_tr_b16 v[114:115], v9 offset:25856
    v_exp_f32 v101, v101
    v_mfma_f32_16x16x32_bf16 v[196:199], v[116:119], v[104:107], v[196:199]
    ds_read_b64_tr_b16 v[116:117], v9 offset:25376
    ds_read_b64_tr_b16 v[118:119], v9 offset:25888
    v_add_f32 v12, v12, v98
    v_add_f32 v13, v13, v99
    v_mfma_f32_16x16x32_bf16 v[224:227], v[120:123], v[104:107], v[224:227]
    ds_read_b64_tr_b16 v[120:121], v9 offset:25408
    ds_read_b64_tr_b16 v[122:123], v9 offset:25920
    v_cvt_pk_bf16_f32 v109, v98, v99
    v_mfma_f32_16x16x32_bf16 v[252:255], v[124:127], v[104:107], v[252:255]
    ds_read_b64_tr_b16 v[124:125], v9 offset:25440
    ds_read_b64_tr_b16 v[126:127], v9 offset:25952
    v_exp_f32 v102, v102
    v_mfma_f32_16x16x32_bf16 a[136:139], v[128:131], v[104:107], a[136:139]
    ds_read_b64_tr_b16 v[128:129], v9 offset:25472
    ds_read_b64_tr_b16 v[130:131], v9 offset:25984
    v_exp_f32 v103, v103
    v_mfma_f32_16x16x32_bf16 a[164:167], v[132:135], v[104:107], a[164:167]
    ds_read_b64_tr_b16 v[132:133], v9 offset:25504
    ds_read_b64_tr_b16 v[134:135], v9 offset:26016
    v_add_f32 v12, v12, v100
    v_add_f32 v13, v13, v101
    v_mfma_f32_16x16x32_bf16 a[192:195], v[136:139], v[104:107], a[192:195]
    ds_read_b64_tr_b16 v[136:137], v9 offset:25536
    ds_read_b64_tr_b16 v[138:139], v9 offset:26048
    v_cvt_pk_bf16_f32 v110, v100, v101
    v_add_f32 v12, v12, v102
    v_mfma_f32_16x16x32_bf16 a[220:223], v[140:143], v[104:107], a[220:223]
    ds_read_b64_tr_b16 v[140:141], v9 offset:25568
    ds_read_b64_tr_b16 v[142:143], v9 offset:26080
    v_add_f32 v13, v13, v103
    v_cvt_pk_bf16_f32 v111, v102, v103
    v_mfma_f32_16x16x32_bf16 v[96:99], v[56:59], a[32:35], v[36:39]
    v_mfma_f32_16x16x32_bf16 v[96:99], v[60:63], a[36:39], v[96:99]
    s_add_u32 m0, s33, 16896
    v_exp_f32 v88, v88
    v_mfma_f32_16x16x32_bf16 v[96:99], v[64:67], a[40:43], v[96:99]
    v_exp_f32 v89, v89
    v_mfma_f32_16x16x32_bf16 v[96:99], v[68:71], a[44:47], v[96:99]
    s_mov_b32 s49, s50
    v_exp_f32 v90, v90
    v_mfma_f32_16x16x32_bf16 v[100:103], v[84:87], a[44:47], v[36:39]
    v_exp_f32 v91, v91
    v_mfma_f32_16x16x32_bf16 v[100:103], v[80:83], a[40:43], v[100:103]
    s_add_u32 s28, s49, s88
    v_add_f32 v14, v14, v88
    v_add_f32 v15, v15, v89
    v_mfma_f32_16x16x32_bf16 v[100:103], v[76:79], a[36:39], v[100:103]
    v_cvt_pk_bf16_f32 v104, v88, v89
    v_mfma_f32_16x16x32_bf16 v[100:103], v[72:75], a[32:35], v[100:103]
    v_exp_f32 v92, v92
    s_waitcnt lgkmcnt(0)
    v_mfma_f32_16x16x32_bf16 v[144:147], v[112:115], v[108:111], v[144:147]
    buffer_load_dwordx4 v26, s[16:19], s28 offen lds
    v_exp_f32 v93, v93
    v_mfma_f32_16x16x32_bf16 v[172:175], v[116:119], v[108:111], v[172:175]
    v_add_f32 v14, v14, v90
    v_add_f32 v15, v15, v91
    v_mfma_f32_16x16x32_bf16 v[200:203], v[120:123], v[108:111], v[200:203]
    s_add_u32 m0, m0, s53
    v_cvt_pk_bf16_f32 v105, v90, v91
    v_mfma_f32_16x16x32_bf16 v[228:231], v[124:127], v[108:111], v[228:231]
    v_exp_f32 v94, v94
    v_mfma_f32_16x16x32_bf16 a[112:115], v[128:131], v[108:111], a[112:115]
    s_add_u32 s28, s49, s89
    v_exp_f32 v95, v95
    v_mfma_f32_16x16x32_bf16 a[140:143], v[132:135], v[108:111], a[140:143]
    v_add_f32 v14, v14, v92
    v_add_f32 v15, v15, v93
    v_mfma_f32_16x16x32_bf16 a[168:171], v[136:139], v[108:111], a[168:171]
    buffer_load_dwordx4 v26, s[16:19], s28 offen lds
    v_cvt_pk_bf16_f32 v106, v92, v93
    v_add_f32 v14, v14, v94
    v_mfma_f32_16x16x32_bf16 a[196:199], v[140:143], v[108:111], a[196:199]
    v_add_f32 v15, v15, v95
    v_cvt_pk_bf16_f32 v107, v94, v95
    v_mfma_f32_16x16x32_bf16 v[88:91], v[56:59], a[48:51], v[40:43]
    v_mfma_f32_16x16x32_bf16 v[88:91], v[60:63], a[52:55], v[88:91]
    s_add_u32 m0, m0, s53
    v_exp_f32 v96, v96
    v_mfma_f32_16x16x32_bf16 v[88:91], v[64:67], a[56:59], v[88:91]
    v_exp_f32 v97, v97
    v_mfma_f32_16x16x32_bf16 v[88:91], v[68:71], a[60:63], v[88:91]
    s_add_u32 s28, s49, s90
    v_exp_f32 v98, v98
    v_mfma_f32_16x16x32_bf16 v[92:95], v[84:87], a[60:63], v[40:43]
    v_exp_f32 v99, v99
    v_mfma_f32_16x16x32_bf16 v[92:95], v[80:83], a[56:59], v[92:95]
    buffer_load_dwordx4 v26, s[16:19], s28 offen lds
    v_add_f32 v16, v16, v96
    v_add_f32 v17, v17, v97
    v_mfma_f32_16x16x32_bf16 v[92:95], v[76:79], a[52:55], v[92:95]
    v_cvt_pk_bf16_f32 v108, v96, v97
    v_mfma_f32_16x16x32_bf16 v[92:95], v[72:75], a[48:51], v[92:95]
    v_exp_f32 v100, v100
    v_mfma_f32_16x16x32_bf16 v[148:151], v[112:115], v[104:107], v[148:151]
    s_add_u32 m0, m0, s53
    v_exp_f32 v101, v101
    v_mfma_f32_16x16x32_bf16 v[176:179], v[116:119], v[104:107], v[176:179]
    v_add_f32 v16, v16, v98
    v_add_f32 v17, v17, v99
    v_mfma_f32_16x16x32_bf16 v[204:207], v[120:123], v[104:107], v[204:207]
    s_add_u32 s28, s49, s91
    v_cvt_pk_bf16_f32 v109, v98, v99
    v_mfma_f32_16x16x32_bf16 v[232:235], v[124:127], v[104:107], v[232:235]
    v_exp_f32 v102, v102
    v_mfma_f32_16x16x32_bf16 a[116:119], v[128:131], v[104:107], a[116:119]
    buffer_load_dwordx4 v26, s[16:19], s28 offen lds
    v_exp_f32 v103, v103
    v_mfma_f32_16x16x32_bf16 a[144:147], v[132:135], v[104:107], a[144:147]
    v_add_f32 v16, v16, v100
    v_add_f32 v17, v17, v101
    v_mfma_f32_16x16x32_bf16 a[172:175], v[136:139], v[104:107], a[172:175]
    s_add_u32 m0, m0, s53
    v_cvt_pk_bf16_f32 v110, v100, v101
    v_add_f32 v16, v16, v102
    v_mfma_f32_16x16x32_bf16 a[200:203], v[140:143], v[104:107], a[200:203]
    v_add_f32 v17, v17, v103
    v_cvt_pk_bf16_f32 v111, v102, v103
    v_mfma_f32_16x16x32_bf16 v[96:99], v[56:59], a[64:67], v[44:47]
    v_mfma_f32_16x16x32_bf16 v[96:99], v[60:63], a[68:71], v[96:99]
    s_add_u32 s28, s49, s92
    v_exp_f32 v88, v88
    v_mfma_f32_16x16x32_bf16 v[96:99], v[64:67], a[72:75], v[96:99]
    v_exp_f32 v89, v89
    v_mfma_f32_16x16x32_bf16 v[96:99], v[68:71], a[76:79], v[96:99]
    buffer_load_dwordx4 v26, s[16:19], s28 offen lds
    v_exp_f32 v90, v90
    v_mfma_f32_16x16x32_bf16 v[100:103], v[84:87], a[76:79], v[44:47]
    v_exp_f32 v91, v91
    v_mfma_f32_16x16x32_bf16 v[100:103], v[80:83], a[72:75], v[100:103]
    s_add_u32 m0, m0, s53
    v_add_f32 v18, v18, v88
    v_add_f32 v19, v19, v89
    v_mfma_f32_16x16x32_bf16 v[100:103], v[76:79], a[68:71], v[100:103]
    v_cvt_pk_bf16_f32 v104, v88, v89
    v_mfma_f32_16x16x32_bf16 v[100:103], v[72:75], a[64:67], v[100:103]
    v_exp_f32 v92, v92
    v_mfma_f32_16x16x32_bf16 v[152:155], v[112:115], v[108:111], v[152:155]
    s_add_u32 s28, s49, s93
    v_exp_f32 v93, v93
    v_mfma_f32_16x16x32_bf16 v[180:183], v[116:119], v[108:111], v[180:183]
    v_add_f32 v18, v18, v90
    v_add_f32 v19, v19, v91
    v_mfma_f32_16x16x32_bf16 v[208:211], v[120:123], v[108:111], v[208:211]
    buffer_load_dwordx4 v26, s[16:19], s28 offen lds
    v_cvt_pk_bf16_f32 v105, v90, v91
    v_mfma_f32_16x16x32_bf16 v[236:239], v[124:127], v[108:111], v[236:239]
    v_exp_f32 v94, v94
    v_mfma_f32_16x16x32_bf16 a[120:123], v[128:131], v[108:111], a[120:123]
    s_add_u32 m0, m0, s53
    v_exp_f32 v95, v95
    v_mfma_f32_16x16x32_bf16 a[148:151], v[132:135], v[108:111], a[148:151]
    v_add_f32 v18, v18, v92
    v_add_f32 v19, v19, v93
    v_mfma_f32_16x16x32_bf16 a[176:179], v[136:139], v[108:111], a[176:179]
    s_add_u32 s28, s49, s94
    v_cvt_pk_bf16_f32 v106, v92, v93
    v_add_f32 v18, v18, v94
    v_mfma_f32_16x16x32_bf16 a[204:207], v[140:143], v[108:111], a[204:207]
    v_add_f32 v19, v19, v95
    v_cvt_pk_bf16_f32 v107, v94, v95
    v_mfma_f32_16x16x32_bf16 v[88:91], v[56:59], a[80:83], v[48:51]
    v_mfma_f32_16x16x32_bf16 v[88:91], v[60:63], a[84:87], v[88:91]
    buffer_load_dwordx4 v26, s[16:19], s28 offen lds
    v_exp_f32 v96, v96
    v_mfma_f32_16x16x32_bf16 v[88:91], v[64:67], a[88:91], v[88:91]
    v_exp_f32 v97, v97
    v_mfma_f32_16x16x32_bf16 v[88:91], v[68:71], a[92:95], v[88:91]
    s_add_u32 m0, m0, s53
    v_exp_f32 v98, v98
    v_mfma_f32_16x16x32_bf16 v[92:95], v[84:87], a[92:95], v[48:51]
    v_exp_f32 v99, v99
    v_mfma_f32_16x16x32_bf16 v[92:95], v[80:83], a[88:91], v[92:95]
    s_add_u32 s28, s49, s95
    v_add_f32 v20, v20, v96
    v_add_f32 v21, v21, v97
    v_mfma_f32_16x16x32_bf16 v[92:95], v[76:79], a[84:87], v[92:95]
    v_cvt_pk_bf16_f32 v108, v96, v97
    v_mfma_f32_16x16x32_bf16 v[92:95], v[72:75], a[80:83], v[92:95]
    v_exp_f32 v100, v100
    v_mfma_f32_16x16x32_bf16 v[156:159], v[112:115], v[104:107], v[156:159]
    buffer_load_dwordx4 v26, s[16:19], s28 offen lds
    v_exp_f32 v101, v101
    v_mfma_f32_16x16x32_bf16 v[184:187], v[116:119], v[104:107], v[184:187]
    v_add_f32 v20, v20, v98
    v_add_f32 v21, v21, v99
    v_mfma_f32_16x16x32_bf16 v[212:215], v[120:123], v[104:107], v[212:215]
    v_cvt_pk_bf16_f32 v109, v98, v99
    v_mfma_f32_16x16x32_bf16 v[240:243], v[124:127], v[104:107], v[240:243]
    v_exp_f32 v102, v102
    v_mfma_f32_16x16x32_bf16 a[124:127], v[128:131], v[104:107], a[124:127]
    v_exp_f32 v103, v103
    v_mfma_f32_16x16x32_bf16 a[152:155], v[132:135], v[104:107], a[152:155]
    v_add_f32 v20, v20, v100
    v_add_f32 v21, v21, v101
    v_mfma_f32_16x16x32_bf16 a[180:183], v[136:139], v[104:107], a[180:183]
    v_cvt_pk_bf16_f32 v110, v100, v101
    v_add_f32 v20, v20, v102
    v_mfma_f32_16x16x32_bf16 a[208:211], v[140:143], v[104:107], a[208:211]
    v_add_f32 v21, v21, v103
    v_cvt_pk_bf16_f32 v111, v102, v103
    s_waitcnt vmcnt(8) lgkmcnt(0)
    s_barrier
    v_mfma_f32_16x16x32_bf16 v[96:99], v[56:59], a[96:99], v[52:55]
    s_add_u32 m0, s33, 25344
    v_mfma_f32_16x16x32_bf16 v[96:99], v[60:63], a[100:103], v[96:99]
    s_add_u32 s49, s50, s46
    v_exp_f32 v88, v88
    v_mfma_f32_16x16x32_bf16 v[96:99], v[64:67], a[104:107], v[96:99]
    s_lshl1_add_u32 s50, s51, s50
    v_exp_f32 v89, v89
    v_mfma_f32_16x16x32_bf16 v[96:99], v[68:71], a[108:111], v[96:99]
    s_add_u32 s82, s82, 2
    v_exp_f32 v90, v90
    v_mfma_f32_16x16x32_bf16 v[100:103], v[84:87], a[108:111], v[52:55]
    s_cmp_eq_u32 s82, 20
    v_exp_f32 v91, v91
    v_mfma_f32_16x16x32_bf16 v[100:103], v[80:83], a[104:107], v[100:103]
    s_cselect_b32 s29, s83, 0
    v_add_f32 v22, v22, v88
    v_add_f32 v23, v23, v89
    v_mfma_f32_16x16x32_bf16 v[100:103], v[76:79], a[100:103], v[100:103]
    s_sub_u32 s50, s50, s29
    v_cvt_pk_bf16_f32 v104, v88, v89
    v_mfma_f32_16x16x32_bf16 v[100:103], v[72:75], a[96:99], v[100:103]
    v_exp_f32 v92, v92
    v_mfma_f32_16x16x32_bf16 v[160:163], v[112:115], v[108:111], v[160:163]
    s_add_u32 s28, s49, s88
    v_exp_f32 v93, v93
    v_mfma_f32_16x16x32_bf16 v[188:191], v[116:119], v[108:111], v[188:191]
    buffer_load_dwordx4 v26, s[16:19], s28 offen lds
    v_add_f32 v22, v22, v90
    v_add_f32 v23, v23, v91
    v_mfma_f32_16x16x32_bf16 v[216:219], v[120:123], v[108:111], v[216:219]
    s_add_u32 m0, m0, s53
    v_cvt_pk_bf16_f32 v105, v90, v91
    v_mfma_f32_16x16x32_bf16 v[244:247], v[124:127], v[108:111], v[244:247]
    s_add_u32 s28, s49, s89
    v_exp_f32 v94, v94
    v_mfma_f32_16x16x32_bf16 a[128:131], v[128:131], v[108:111], a[128:131]
    buffer_load_dwordx4 v26, s[16:19], s28 offen lds
    v_exp_f32 v95, v95
    v_mfma_f32_16x16x32_bf16 a[156:159], v[132:135], v[108:111], a[156:159]
    s_add_u32 m0, m0, s53
    v_add_f32 v22, v22, v92
    v_add_f32 v23, v23, v93
    v_mfma_f32_16x16x32_bf16 a[184:187], v[136:139], v[108:111], a[184:187]
    s_add_u32 s28, s49, s90
    v_cvt_pk_bf16_f32 v106, v92, v93
    v_add_f32 v22, v22, v94
    v_mfma_f32_16x16x32_bf16 a[212:215], v[140:143], v[108:111], a[212:215]
    buffer_load_dwordx4 v26, s[16:19], s28 offen lds
    v_add_f32 v23, v23, v95
    v_cvt_pk_bf16_f32 v107, v94, v95
    s_nop 1
    v_mfma_f32_16x16x32_bf16 v[164:167], v[112:115], v[104:107], v[164:167]
    s_add_u32 m0, m0, s53
    s_add_u32 s28, s49, s91
    v_exp_f32 v96, v96
    v_mfma_f32_16x16x32_bf16 v[192:195], v[116:119], v[104:107], v[192:195]
    buffer_load_dwordx4 v26, s[16:19], s28 offen lds
    s_add_u32 m0, m0, s53
    v_exp_f32 v97, v97
    v_exp_f32 v98, v98
    v_mfma_f32_16x16x32_bf16 v[220:223], v[120:123], v[104:107], v[220:223]
    s_add_u32 s28, s49, s92
    buffer_load_dwordx4 v26, s[16:19], s28 offen lds
    v_exp_f32 v99, v99
    v_add_f32 v24, v24, v96
    v_add_f32 v25, v25, v97
    v_mfma_f32_16x16x32_bf16 v[248:251], v[124:127], v[104:107], v[248:251]
    s_add_u32 m0, m0, s53
    v_cvt_pk_bf16_f32 v108, v96, v97
    v_exp_f32 v100, v100
    v_mfma_f32_16x16x32_bf16 a[132:135], v[128:131], v[104:107], a[132:135]
    s_add_u32 s28, s49, s93
    buffer_load_dwordx4 v26, s[16:19], s28 offen lds
    v_exp_f32 v101, v101
    v_add_f32 v24, v24, v98
    v_add_f32 v25, v25, v99
    v_mfma_f32_16x16x32_bf16 a[160:163], v[132:135], v[104:107], a[160:163]
    s_add_u32 m0, m0, s53
    s_add_u32 s28, s49, s94
    v_cvt_pk_bf16_f32 v109, v98, v99
    v_exp_f32 v102, v102
    v_mfma_f32_16x16x32_bf16 a[188:191], v[136:139], v[104:107], a[188:191]
    buffer_load_dwordx4 v26, s[16:19], s28 offen lds
    s_add_u32 m0, m0, s53
    v_exp_f32 v103, v103
    v_add_f32 v24, v24, v100
    v_add_f32 v25, v25, v101
    v_mfma_f32_16x16x32_bf16 a[216:219], v[140:143], v[104:107], a[216:219]
    s_add_u32 s28, s49, s95
    buffer_load_dwordx4 v26, s[16:19], s28 offen lds
    v_cvt_pk_bf16_f32 v110, v100, v101
    v_add_f32 v24, v24, v102
    v_add_f32 v25, v25, v103
    v_cvt_pk_bf16_f32 v111, v102, v103
    s_branch L_at_aepi
L_at_atailB:
    v_mfma_f32_16x16x32_bf16 v[88:91], v[56:59], a[16:19], v[32:35]
    v_mfma_f32_16x16x32_bf16 v[88:91], v[60:63], a[20:23], v[88:91]
    v_exp_f32 v96, v96
    v_mfma_f32_16x16x32_bf16 v[88:91], v[64:67], a[24:27], v[88:91]
    v_exp_f32 v97, v97
    v_mfma_f32_16x16x32_bf16 v[88:91], v[68:71], a[28:31], v[88:91]
    v_exp_f32 v98, v98
    v_mfma_f32_16x16x32_bf16 v[92:95], v[84:87], a[28:31], v[32:35]
    v_exp_f32 v99, v99
    v_mfma_f32_16x16x32_bf16 v[92:95], v[80:83], a[24:27], v[92:95]
    v_add_f32 v12, v12, v96
    v_add_f32 v13, v13, v97
    v_mfma_f32_16x16x32_bf16 v[92:95], v[76:79], a[20:23], v[92:95]
    v_cvt_pk_bf16_f32 v108, v96, v97
    v_mfma_f32_16x16x32_bf16 v[92:95], v[72:75], a[16:19], v[92:95]
    v_exp_f32 v100, v100
    v_mfma_f32_16x16x32_bf16 v[168:171], v[112:115], v[104:107], v[168:171]
    ds_read_b64_tr_b16 v[112:113], v9 offset:8448
    ds_read_b64_tr_b16 v[114:115], v9 offset:8960
    v_exp_f32 v101, v101
    v_mfma_f32_16x16x32_bf16 v[196:199], v[116:119], v[104:107], v[196:199]
    ds_read_b64_tr_b16 v[116:117], v9 offset:8480
    ds_read_b64_tr_b16 v[118:119], v9 offset:8992
    v_add_f32 v12, v12, v98
    v_add_f32 v13, v13, v99
    v_mfma_f32_16x16x32_bf16 v[224:227], v[120:123], v[104:107], v[224:227]
    ds_read_b64_tr_b16 v[120:121], v9 offset:8512
    ds_read_b64_tr_b16 v[122:123], v9 offset:9024
    v_cvt_pk_bf16_f32 v109, v98, v99
    v_mfma_f32_16x16x32_bf16 v[252:255], v[124:127], v[104:107], v[252:255]
    ds_read_b64_tr_b16 v[124:125], v9 offset:8544
    ds_read_b64_tr_b16 v[126:127], v9 offset:9056
    v_exp_f32 v102, v102
    v_mfma_f32_16x16x32_bf16 a[136:139], v[128:131], v[104:107], a[136:139]
    ds_read_b64_tr_b16 v[128:129], v9 offset:8576
    ds_read_b64_tr_b16 v[130:131], v9 offset:9088
    v_exp_f32 v103, v103
    v_mfma_f32_16x16x32_bf16 a[164:167], v[132:135], v[104:107], a[164:167]
    ds_read_b64_tr_b16 v[132:133], v9 offset:8608
    ds_read_b64_tr_b16 v[134:135], v9 offset:9120
    v_add_f32 v12, v12, v100
    v_add_f32 v13, v13, v101
    v_mfma_f32_16x16x32_bf16 a[192:195], v[136:139], v[104:107], a[192:195]
    ds_read_b64_tr_b16 v[136:137], v9 offset:8640
    ds_read_b64_tr_b16 v[138:139], v9 offset:9152
    v_cvt_pk_bf16_f32 v110, v100, v101
    v_add_f32 v12, v12, v102
    v_mfma_f32_16x16x32_bf16 a[220:223], v[140:143], v[104:107], a[220:223]
    ds_read_b64_tr_b16 v[140:141], v9 offset:8672
    ds_read_b64_tr_b16 v[142:143], v9 offset:9184
    v_add_f32 v13, v13, v103
    v_cvt_pk_bf16_f32 v111, v102, v103
    v_mfma_f32_16x16x32_bf16 v[96:99], v[56:59], a[32:35], v[36:39]
    v_mfma_f32_16x16x32_bf16 v[96:99], v[60:63], a[36:39], v[96:99]
    s_add_u32 s29, s34, s100
    v_exp_f32 v88, v88
    v_mfma_f32_16x16x32_bf16 v[96:99], v[64:67], a[40:43], v[96:99]
    v_exp_f32 v89, v89
    v_mfma_f32_16x16x32_bf16 v[96:99], v[68:71], a[44:47], v[96:99]
    s_bfe_u32 s28, s29, 0x20003
    v_exp_f32 v90, v90
    v_mfma_f32_16x16x32_bf16 v[100:103], v[84:87], a[44:47], v[36:39]
    v_exp_f32 v91, v91
    v_mfma_f32_16x16x32_bf16 v[100:103], v[80:83], a[40:43], v[100:103]
    s_lshl_b32 s28, s28, 16
    v_add_f32 v14, v14, v88
    v_add_f32 v15, v15, v89
    v_mfma_f32_16x16x32_bf16 v[100:103], v[76:79], a[36:39], v[100:103]
    v_cvt_pk_bf16_f32 v104, v88, v89
    v_mfma_f32_16x16x32_bf16 v[100:103], v[72:75], a[32:35], v[100:103]
    v_exp_f32 v92, v92
    s_waitcnt lgkmcnt(0)
    v_mfma_f32_16x16x32_bf16 v[144:147], v[112:115], v[108:111], v[144:147]
    s_and_b32 s29, s29, 7
    v_exp_f32 v93, v93
    v_mfma_f32_16x16x32_bf16 v[172:175], v[116:119], v[108:111], v[172:175]
    v_add_f32 v14, v14, v90
    v_add_f32 v15, v15, v91
    v_mfma_f32_16x16x32_bf16 v[200:203], v[120:123], v[108:111], v[200:203]
    s_lshl_b32 s29, s29, 11
    v_cvt_pk_bf16_f32 v105, v90, v91
    v_mfma_f32_16x16x32_bf16 v[228:231], v[124:127], v[108:111], v[228:231]
    v_exp_f32 v94, v94
    v_mfma_f32_16x16x32_bf16 a[112:115], v[128:131], v[108:111], a[112:115]
    s_add_u32 s29, s28, s29
    v_exp_f32 v95, v95
    v_mfma_f32_16x16x32_bf16 a[140:143], v[132:135], v[108:111], a[140:143]
    v_add_f32 v14, v14, v92
    v_add_f32 v15, v15, v93
    v_mfma_f32_16x16x32_bf16 a[168:171], v[136:139], v[108:111], a[168:171]
    s_lshr_b32 s28, s34, 5
    v_cvt_pk_bf16_f32 v106, v92, v93
    v_add_f32 v14, v14, v94
    v_mfma_f32_16x16x32_bf16 a[196:199], v[140:143], v[108:111], a[196:199]
    v_add_f32 v15, v15, v95
    v_cvt_pk_bf16_f32 v107, v94, v95
    v_mfma_f32_16x16x32_bf16 v[88:91], v[56:59], a[48:51], v[40:43]
    v_mfma_f32_16x16x32_bf16 v[88:91], v[60:63], a[52:55], v[88:91]
    s_lshl_b32 s28, s28, 19
    v_exp_f32 v96, v96
    v_mfma_f32_16x16x32_bf16 v[88:91], v[64:67], a[56:59], v[88:91]
    v_exp_f32 v97, v97
    v_mfma_f32_16x16x32_bf16 v[88:91], v[68:71], a[60:63], v[88:91]
    s_add_u32 s49, s28, s29
    v_exp_f32 v98, v98
    v_mfma_f32_16x16x32_bf16 v[92:95], v[84:87], a[60:63], v[40:43]
    v_exp_f32 v99, v99
    v_mfma_f32_16x16x32_bf16 v[92:95], v[80:83], a[56:59], v[92:95]
    s_add_u32 m0, s33, 0
    v_add_f32 v16, v16, v96
    v_add_f32 v17, v17, v97
    v_mfma_f32_16x16x32_bf16 v[92:95], v[76:79], a[52:55], v[92:95]
    v_cvt_pk_bf16_f32 v108, v96, v97
    v_mfma_f32_16x16x32_bf16 v[92:95], v[72:75], a[48:51], v[92:95]
    v_exp_f32 v100, v100
    v_mfma_f32_16x16x32_bf16 v[148:151], v[112:115], v[104:107], v[148:151]
    s_add_u32 s34, s34, 1
    v_exp_f32 v101, v101
    v_mfma_f32_16x16x32_bf16 v[176:179], v[116:119], v[104:107], v[176:179]
    v_add_f32 v16, v16, v98
    v_add_f32 v17, v17, v99
    v_mfma_f32_16x16x32_bf16 v[204:207], v[120:123], v[104:107], v[204:207]
    buffer_load_dwordx4 v7, s[4:7], s49 offen offset:0 nt lds
    v_cvt_pk_bf16_f32 v109, v98, v99
    v_mfma_f32_16x16x32_bf16 v[232:235], v[124:127], v[104:107], v[232:235]
    v_exp_f32 v102, v102
    v_mfma_f32_16x16x32_bf16 a[116:119], v[128:131], v[104:107], a[116:119]
    s_add_u32 m0, m0, s96
    v_exp_f32 v103, v103
    v_mfma_f32_16x16x32_bf16 a[144:147], v[132:135], v[104:107], a[144:147]
    v_add_f32 v16, v16, v100
    v_add_f32 v17, v17, v101
    v_mfma_f32_16x16x32_bf16 a[172:175], v[136:139], v[104:107], a[172:175]
    buffer_load_dwordx4 v7, s[4:7], s49 offen offset:256 nt lds
    v_cvt_pk_bf16_f32 v110, v100, v101
    v_add_f32 v16, v16, v102
    v_mfma_f32_16x16x32_bf16 a[200:203], v[140:143], v[104:107], a[200:203]
    v_add_f32 v17, v17, v103
    v_cvt_pk_bf16_f32 v111, v102, v103
    v_mfma_f32_16x16x32_bf16 v[96:99], v[56:59], a[64:67], v[44:47]
    v_mfma_f32_16x16x32_bf16 v[96:99], v[60:63], a[68:71], v[96:99]
    s_add_u32 m0, m0, s97
    v_exp_f32 v88, v88
    v_mfma_f32_16x16x32_bf16 v[96:99], v[64:67], a[72:75], v[96:99]
    v_exp_f32 v89, v89
    v_mfma_f32_16x16x32_bf16 v[96:99], v[68:71], a[76:79], v[96:99]
    buffer_load_dwordx4 v7, s[4:7], s49 offen offset:512 nt lds
    v_exp_f32 v90, v90
    v_mfma_f32_16x16x32_bf16 v[100:103], v[84:87], a[76:79], v[44:47]
    v_exp_f32 v91, v91
    v_mfma_f32_16x16x32_bf16 v[100:103], v[80:83], a[72:75], v[100:103]
    s_add_u32 m0, m0, s96
    v_add_f32 v18, v18, v88
    v_add_f32 v19, v19, v89
    v_mfma_f32_16x16x32_bf16 v[100:103], v[76:79], a[68:71], v[100:103]
    v_cvt_pk_bf16_f32 v104, v88, v89
    v_mfma_f32_16x16x32_bf16 v[100:103], v[72:75], a[64:67], v[100:103]
    v_exp_f32 v92, v92
    v_mfma_f32_16x16x32_bf16 v[152:155], v[112:115], v[108:111], v[152:155]
    buffer_load_dwordx4 v7, s[4:7], s49 offen offset:768 nt lds
    v_exp_f32 v93, v93
    v_mfma_f32_16x16x32_bf16 v[180:183], v[116:119], v[108:111], v[180:183]
    v_add_f32 v18, v18, v90
    v_add_f32 v19, v19, v91
    v_mfma_f32_16x16x32_bf16 v[208:211], v[120:123], v[108:111], v[208:211]
    s_add_u32 m0, m0, s97
    v_cvt_pk_bf16_f32 v105, v90, v91
    v_mfma_f32_16x16x32_bf16 v[236:239], v[124:127], v[108:111], v[236:239]
    v_exp_f32 v94, v94
    v_mfma_f32_16x16x32_bf16 a[120:123], v[128:131], v[108:111], a[120:123]
    buffer_load_dwordx4 v7, s[4:7], s49 offen offset:1024 nt lds
    v_exp_f32 v95, v95
    v_mfma_f32_16x16x32_bf16 a[148:151], v[132:135], v[108:111], a[148:151]
    v_add_f32 v18, v18, v92
    v_add_f32 v19, v19, v93
    v_mfma_f32_16x16x32_bf16 a[176:179], v[136:139], v[108:111], a[176:179]
    s_add_u32 m0, m0, s96
    v_cvt_pk_bf16_f32 v106, v92, v93
    v_add_f32 v18, v18, v94
    v_mfma_f32_16x16x32_bf16 a[204:207], v[140:143], v[108:111], a[204:207]
    v_add_f32 v19, v19, v95
    v_cvt_pk_bf16_f32 v107, v94, v95
    v_mfma_f32_16x16x32_bf16 v[88:91], v[56:59], a[80:83], v[48:51]
    v_mfma_f32_16x16x32_bf16 v[88:91], v[60:63], a[84:87], v[88:91]
    buffer_load_dwordx4 v7, s[4:7], s49 offen offset:1280 nt lds
    v_exp_f32 v96, v96
    v_mfma_f32_16x16x32_bf16 v[88:91], v[64:67], a[88:91], v[88:91]
    v_exp_f32 v97, v97
    v_mfma_f32_16x16x32_bf16 v[88:91], v[68:71], a[92:95], v[88:91]
    s_add_u32 m0, m0, s97
    v_exp_f32 v98, v98
    v_mfma_f32_16x16x32_bf16 v[92:95], v[84:87], a[92:95], v[48:51]
    v_exp_f32 v99, v99
    v_mfma_f32_16x16x32_bf16 v[92:95], v[80:83], a[88:91], v[92:95]
    buffer_load_dwordx4 v7, s[4:7], s49 offen offset:1536 nt lds
    v_add_f32 v20, v20, v96
    v_add_f32 v21, v21, v97
    v_mfma_f32_16x16x32_bf16 v[92:95], v[76:79], a[84:87], v[92:95]
    v_cvt_pk_bf16_f32 v108, v96, v97
    v_mfma_f32_16x16x32_bf16 v[92:95], v[72:75], a[80:83], v[92:95]
    v_exp_f32 v100, v100
    v_mfma_f32_16x16x32_bf16 v[156:159], v[112:115], v[104:107], v[156:159]
    s_add_u32 m0, m0, s96
    v_exp_f32 v101, v101
    v_mfma_f32_16x16x32_bf16 v[184:187], v[116:119], v[104:107], v[184:187]
    v_add_f32 v20, v20, v98
    v_add_f32 v21, v21, v99
    v_mfma_f32_16x16x32_bf16 v[212:215], v[120:123], v[104:107], v[212:215]
    buffer_load_dwordx4 v7, s[4:7], s49 offen offset:1792 nt lds
    v_cvt_pk_bf16_f32 v109, v98, v99
    v_mfma_f32_16x16x32_bf16 v[240:243], v[124:127], v[104:107], v[240:243]
    v_exp_f32 v102, v102
    v_mfma_f32_16x16x32_bf16 a[124:127], v[128:131], v[104:107], a[124:127]
    v_exp_f32 v103, v103
    v_mfma_f32_16x16x32_bf16 a[152:155], v[132:135], v[104:107], a[152:155]
    v_add_f32 v20, v20, v100
    v_add_f32 v21, v21, v101
    v_mfma_f32_16x16x32_bf16 a[180:183], v[136:139], v[104:107], a[180:183]
    v_cvt_pk_bf16_f32 v110, v100, v101
    v_add_f32 v20, v20, v102
    v_mfma_f32_16x16x32_bf16 a[208:211], v[140:143], v[104:107], a[208:211]
    v_add_f32 v21, v21, v103
    v_cvt_pk_bf16_f32 v111, v102, v103
    s_waitcnt vmcnt(16) lgkmcnt(0)
    s_barrier
    v_mfma_f32_16x16x32_bf16 v[96:99], v[56:59], a[96:99], v[52:55]
    ds_read_b128 v[56:59], v8 offset:16896
    v_mfma_f32_16x16x32_bf16 v[96:99], v[60:63], a[100:103], v[96:99]
    ds_read_b128 v[60:63], v8 offset:16960
    v_exp_f32 v88, v88
    v_mfma_f32_16x16x32_bf16 v[96:99], v[64:67], a[104:107], v[96:99]
    ds_read_b128 v[64:67], v8 offset:17024
    v_exp_f32 v89, v89
    v_mfma_f32_16x16x32_bf16 v[96:99], v[68:71], a[108:111], v[96:99]
    ds_read_b128 v[68:71], v8 offset:17088
    v_exp_f32 v90, v90
    v_mfma_f32_16x16x32_bf16 v[100:103], v[84:87], a[108:111], v[52:55]
    ds_read_b128 v[84:87], v8 offset:17600
    v_exp_f32 v91, v91
    v_mfma_f32_16x16x32_bf16 v[100:103], v[80:83], a[104:107], v[100:103]
    ds_read_b128 v[80:83], v8 offset:17536
    v_add_f32 v22, v22, v88
    v_add_f32 v23, v23, v89
    v_mfma_f32_16x16x32_bf16 v[100:103], v[76:79], a[100:103], v[100:103]
    ds_read_b128 v[76:79], v8 offset:17472
    v_cvt_pk_bf16_f32 v104, v88, v89
    v_mfma_f32_16x16x32_bf16 v[100:103], v[72:75], a[96:99], v[100:103]
    ds_read_b128 v[72:75], v8 offset:17408
    v_exp_f32 v92, v92
    v_mfma_f32_16x16x32_bf16 v[160:163], v[112:115], v[108:111], v[160:163]
    v_exp_f32 v93, v93
    v_mfma_f32_16x16x32_bf16 v[188:191], v[116:119], v[108:111], v[188:191]
    v_add_f32 v22, v22, v90
    v_add_f32 v23, v23, v91
    v_mfma_f32_16x16x32_bf16 v[216:219], v[120:123], v[108:111], v[216:219]
    v_cvt_pk_bf16_f32 v105, v90, v91
    v_mfma_f32_16x16x32_bf16 v[244:247], v[124:127], v[108:111], v[244:247]
    v_exp_f32 v94, v94
    v_mfma_f32_16x16x32_bf16 a[128:131], v[128:131], v[108:111], a[128:131]
    v_exp_f32 v95, v95
    v_mfma_f32_16x16x32_bf16 a[156:159], v[132:135], v[108:111], a[156:159]
    v_add_f32 v22, v22, v92
    v_add_f32 v23, v23, v93
    v_mfma_f32_16x16x32_bf16 a[184:187], v[136:139], v[108:111], a[184:187]
    v_cvt_pk_bf16_f32 v106, v92, v93
    v_add_f32 v22, v22, v94
    v_mfma_f32_16x16x32_bf16 a[212:215], v[140:143], v[108:111], a[212:215]
    v_add_f32 v23, v23, v95
    v_cvt_pk_bf16_f32 v107, v94, v95
    s_waitcnt lgkmcnt(0)
    v_mfma_f32_16x16x32_bf16 v[88:91], v[56:59], a[0:3], v[28:31]
    v_mfma_f32_16x16x32_bf16 v[88:91], v[60:63], a[4:7], v[88:91]
    v_exp_f32 v96, v96
    v_mfma_f32_16x16x32_bf16 v[88:91], v[64:67], a[8:11], v[88:91]
    v_exp_f32 v97, v97
    v_mfma_f32_16x16x32_bf16 v[88:91], v[68:71], a[12:15], v[88:91]
    v_exp_f32 v98, v98
    v_mfma_f32_16x16x32_bf16 v[92:95], v[84:87], a[12:15], v[28:31]
    v_exp_f32 v99, v99
    v_mfma_f32_16x16x32_bf16 v[92:95], v[80:83], a[8:11], v[92:95]
    v_add_f32 v24, v24, v96
    v_add_f32 v25, v25, v97
    v_mfma_f32_16x16x32_bf16 v[92:95], v[76:79], a[4:7], v[92:95]
    v_cvt_pk_bf16_f32 v108, v96, v97
    v_mfma_f32_16x16x32_bf16 v[92:95], v[72:75], a[0:3], v[92:95]
    v_exp_f32 v100, v100
    v_mfma_f32_16x16x32_bf16 v[164:167], v[112:115], v[104:107], v[164:167]
    v_exp_f32 v101, v101
    v_mfma_f32_16x16x32_bf16 v[192:195], v[116:119], v[104:107], v[192:195]
    v_add_f32 v24, v24, v98
    v_add_f32 v25, v25, v99
    v_mfma_f32_16x16x32_bf16 v[220:223], v[120:123], v[104:107], v[220:223]
    v_cvt_pk_bf16_f32 v109, v98, v99
    v_mfma_f32_16x16x32_bf16 v[248:251], v[124:127], v[104:107], v[248:251]
    v_exp_f32 v102, v102
    v_mfma_f32_16x16x32_bf16 a[132:135], v[128:131], v[104:107], a[132:135]
    v_exp_f32 v103, v103
    v_mfma_f32_16x16x32_bf16 a[160:163], v[132:135], v[104:107], a[160:163]
    v_add_f32 v24, v24, v100
    v_add_f32 v25, v25, v101
    v_mfma_f32_16x16x32_bf16 a[188:191], v[136:139], v[104:107], a[188:191]
    v_cvt_pk_bf16_f32 v110, v100, v101
    v_add_f32 v24, v24, v102
    v_mfma_f32_16x16x32_bf16 a[216:219], v[140:143], v[104:107], a[216:219]
    v_add_f32 v25, v25, v103
    v_cvt_pk_bf16_f32 v111, v102, v103
    v_mfma_f32_16x16x32_bf16 v[96:99], v[56:59], a[16:19], v[32:35]
    v_mfma_f32_16x16x32_bf16 v[96:99], v[60:63], a[20:23], v[96:99]
    v_exp_f32 v88, v88
    v_mfma_f32_16x16x32_bf16 v[96:99], v[64:67], a[24:27], v[96:99]
    v_exp_f32 v89, v89
    v_mfma_f32_16x16x32_bf16 v[96:99], v[68:71], a[28:31], v[96:99]
    v_exp_f32 v90, v90
    v_mfma_f32_16x16x32_bf16 v[100:103], v[84:87], a[28:31], v[32:35]
    v_exp_f32 v91, v91
    v_mfma_f32_16x16x32_bf16 v[100:103], v[80:83], a[24:27], v[100:103]
    v_add_f32 v12, v12, v88
    v_add_f32 v13, v13, v89
    v_mfma_f32_16x16x32_bf16 v[100:103], v[76:79], a[20:23], v[100:103]
    v_cvt_pk_bf16_f32 v104, v88, v89
    v_mfma_f32_16x16x32_bf16 v[100:103], v[72:75], a[16:19], v[100:103]
    v_exp_f32 v92, v92
    v_mfma_f32_16x16x32_bf16 v[168:171], v[112:115], v[108:111], v[168:171]
    ds_read_b64_tr_b16 v[112:113], v9 offset:16896
    ds_read_b64_tr_b16 v[114:115], v9 offset:17408
    v_exp_f32 v93, v93
    v_mfma_f32_16x16x32_bf16 v[196:199], v[116:119], v[108:111], v[196:199]
    ds_read_b64_tr_b16 v[116:117], v9 offset:16928
    ds_read_b64_tr_b16 v[118:119], v9 offset:17440
    v_add_f32 v12, v12, v90
    v_add_f32 v13, v13, v91
    v_mfma_f32_16x16x32_bf16 v[224:227], v[120:123], v[108:111], v[224:227]
    ds_read_b64_tr_b16 v[120:121], v9 offset:16960
    ds_read_b64_tr_b16 v[122:123], v9 offset:17472
    v_cvt_pk_bf16_f32 v105, v90, v91
    v_mfma_f32_16x16x32_bf16 v[252:255], v[124:127], v[108:111], v[252:255]
    ds_read_b64_tr_b16 v[124:125], v9 offset:16992
    ds_read_b64_tr_b16 v[126:127], v9 offset:17504
    v_exp_f32 v94, v94
    v_mfma_f32_16x16x32_bf16 a[136:139], v[128:131], v[108:111], a[136:139]
    ds_read_b64_tr_b16 v[128:129], v9 offset:17024
    ds_read_b64_tr_b16 v[130:131], v9 offset:17536
    v_exp_f32 v95, v95
    v_mfma_f32_16x16x32_bf16 a[164:167], v[132:135], v[108:111], a[164:167]
    ds_read_b64_tr_b16 v[132:133], v9 offset:17056
    ds_read_b64_tr_b16 v[134:135], v9 offset:17568
    v_add_f32 v12, v12, v92
    v_add_f32 v13, v13, v93
    v_mfma_f32_16x16x32_bf16 a[192:195], v[136:139], v[108:111], a[192:195]
    ds_read_b64_tr_b16 v[136:137], v9 offset:17088
    ds_read_b64_tr_b16 v[138:139], v9 offset:17600
    v_cvt_pk_bf16_f32 v106, v92, v93
    v_add_f32 v12, v12, v94
    v_mfma_f32_16x16x32_bf16 a[220:223], v[140:143], v[108:111], a[220:223]
    ds_read_b64_tr_b16 v[140:141], v9 offset:17120
    ds_read_b64_tr_b16 v[142:143], v9 offset:17632
    v_add_f32 v13, v13, v95
    v_cvt_pk_bf16_f32 v107, v94, v95
    v_mfma_f32_16x16x32_bf16 v[88:91], v[56:59], a[32:35], v[36:39]
    v_mfma_f32_16x16x32_bf16 v[88:91], v[60:63], a[36:39], v[88:91]
    s_add_u32 s29, s34, s100
    v_exp_f32 v96, v96
    v_mfma_f32_16x16x32_bf16 v[88:91], v[64:67], a[40:43], v[88:91]
    v_exp_f32 v97, v97
    v_mfma_f32_16x16x32_bf16 v[88:91], v[68:71], a[44:47], v[88:91]
    s_bfe_u32 s28, s29, 0x20003
    v_exp_f32 v98, v98
    v_mfma_f32_16x16x32_bf16 v[92:95], v[84:87], a[44:47], v[36:39]
    v_exp_f32 v99, v99
    v_mfma_f32_16x16x32_bf16 v[92:95], v[80:83], a[40:43], v[92:95]
    s_lshl_b32 s28, s28, 16
    v_add_f32 v14, v14, v96
    v_add_f32 v15, v15, v97
    v_mfma_f32_16x16x32_bf16 v[92:95], v[76:79], a[36:39], v[92:95]
    v_cvt_pk_bf16_f32 v108, v96, v97
    v_mfma_f32_16x16x32_bf16 v[92:95], v[72:75], a[32:35], v[92:95]
    v_exp_f32 v100, v100
    s_waitcnt lgkmcnt(0)
    v_mfma_f32_16x16x32_bf16 v[144:147], v[112:115], v[104:107], v[144:147]
    s_and_b32 s29, s29, 7
    v_exp_f32 v101, v101
    v_mfma_f32_16x16x32_bf16 v[172:175], v[116:119], v[104:107], v[172:175]
    v_add_f32 v14, v14, v98
    v_add_f32 v15, v15, v99
    v_mfma_f32_16x16x32_bf16 v[200:203], v[120:123], v[104:107], v[200:203]
    s_lshl_b32 s29, s29, 11
    v_cvt_pk_bf16_f32 v109, v98, v99
    v_mfma_f32_16x16x32_bf16 v[228:231], v[124:127], v[104:107], v[228:231]
    v_exp_f32 v102, v102
    v_mfma_f32_16x16x32_bf16 a[112:115], v[128:131], v[104:107], a[112:115]
    s_add_u32 s29, s28, s29
    v_exp_f32 v103, v103
    v_mfma_f32_16x16x32_bf16 a[140:143], v[132:135], v[104:107], a[140:143]
    v_add_f32 v14, v14, v100
    v_add_f32 v15, v15, v101
    v_mfma_f32_16x16x32_bf16 a[168:171], v[136:139], v[104:107], a[168:171]
    s_lshr_b32 s28, s34, 5
    v_cvt_pk_bf16_f32 v110, v100, v101
    v_add_f32 v14, v14, v102
    v_mfma_f32_16x16x32_bf16 a[196:199], v[140:143], v[104:107], a[196:199]
    v_add_f32 v15, v15, v103
    v_cvt_pk_bf16_f32 v111, v102, v103
    v_mfma_f32_16x16x32_bf16 v[96:99], v[56:59], a[48:51], v[40:43]
    v_mfma_f32_16x16x32_bf16 v[96:99], v[60:63], a[52:55], v[96:99]
    s_lshl_b32 s28, s28, 19
    v_exp_f32 v88, v88
    v_mfma_f32_16x16x32_bf16 v[96:99], v[64:67], a[56:59], v[96:99]
    v_exp_f32 v89, v89
    v_mfma_f32_16x16x32_bf16 v[96:99], v[68:71], a[60:63], v[96:99]
    s_add_u32 s49, s28, s29
    v_exp_f32 v90, v90
    v_mfma_f32_16x16x32_bf16 v[100:103], v[84:87], a[60:63], v[40:43]
    v_exp_f32 v91, v91
    v_mfma_f32_16x16x32_bf16 v[100:103], v[80:83], a[56:59], v[100:103]
    s_add_u32 m0, s33, 8448
    v_add_f32 v16, v16, v88
    v_add_f32 v17, v17, v89
    v_mfma_f32_16x16x32_bf16 v[100:103], v[76:79], a[52:55], v[100:103]
    v_cvt_pk_bf16_f32 v104, v88, v89
    v_mfma_f32_16x16x32_bf16 v[100:103], v[72:75], a[48:51], v[100:103]
    v_exp_f32 v92, v92
    v_mfma_f32_16x16x32_bf16 v[148:151], v[112:115], v[108:111], v[148:151]
    s_add_u32 s34, s34, 1
    v_exp_f32 v93, v93
    v_mfma_f32_16x16x32_bf16 v[176:179], v[116:119], v[108:111], v[176:179]
    v_add_f32 v16, v16, v90
    v_add_f32 v17, v17, v91
    v_mfma_f32_16x16x32_bf16 v[204:207], v[120:123], v[108:111], v[204:207]
    buffer_load_dwordx4 v7, s[4:7], s49 offen offset:0 nt lds
    v_cvt_pk_bf16_f32 v105, v90, v91
    v_mfma_f32_16x16x32_bf16 v[232:235], v[124:127], v[108:111], v[232:235]
    v_exp_f32 v94, v94
    v_mfma_f32_16x16x32_bf16 a[116:119], v[128:131], v[108:111], a[116:119]
    s_add_u32 m0, m0, s96
    v_exp_f32 v95, v95
    v_mfma_f32_16x16x32_bf16 a[144:147], v[132:135], v[108:111], a[144:147]
    v_add_f32 v16, v16, v92
    v_add_f32 v17, v17, v93
    v_mfma_f32_16x16x32_bf16 a[172:175], v[136:139], v[108:111], a[172:175]
    buffer_load_dwordx4 v7, s[4:7], s49 offen offset:256 nt lds
    v_cvt_pk_bf16_f32 v106, v92, v93
    v_add_f32 v16, v16, v94
    v_mfma_f32_16x16x32_bf16 a[200:203], v[140:143], v[108:111], a[200:203]
    v_add_f32 v17, v17, v95
    v_cvt_pk_bf16_f32 v107, v94, v95
    v_mfma_f32_16x16x32_bf16 v[88:91], v[56:59], a[64:67], v[44:47]
    v_mfma_f32_16x16x32_bf16 v[88:91], v[60:63], a[68:71], v[88:91]
    s_add_u32 m0, m0, s97
    v_exp_f32 v96, v96
    v_mfma_f32_16x16x32_bf16 v[88:91], v[64:67], a[72:75], v[88:91]
    v_exp_f32 v97, v97
    v_mfma_f32_16x16x32_bf16 v[88:91], v[68:71], a[76:79], v[88:91]
    buffer_load_dwordx4 v7, s[4:7], s49 offen offset:512 nt lds
    v_exp_f32 v98, v98
    v_mfma_f32_16x16x32_bf16 v[92:95], v[84:87], a[76:79], v[44:47]
    v_exp_f32 v99, v99
    v_mfma_f32_16x16x32_bf16 v[92:95], v[80:83], a[72:75], v[92:95]
    s_add_u32 m0, m0, s96
    v_add_f32 v18, v18, v96
    v_add_f32 v19, v19, v97
    v_mfma_f32_16x16x32_bf16 v[92:95], v[76:79], a[68:71], v[92:95]
    v_cvt_pk_bf16_f32 v108, v96, v97
    v_mfma_f32_16x16x32_bf16 v[92:95], v[72:75], a[64:67], v[92:95]
    v_exp_f32 v100, v100
    v_mfma_f32_16x16x32_bf16 v[152:155], v[112:115], v[104:107], v[152:155]
    buffer_load_dwordx4 v7, s[4:7], s49 offen offset:768 nt lds
    v_exp_f32 v101, v101
    v_mfma_f32_16x16x32_bf16 v[180:183], v[116:119], v[104:107], v[180:183]
    v_add_f32 v18, v18, v98
    v_add_f32 v19, v19, v99
    v_mfma_f32_16x16x32_bf16 v[208:211], v[120:123], v[104:107], v[208:211]
    s_add_u32 m0, m0, s97
    v_cvt_pk_bf16_f32 v109, v98, v99
    v_mfma_f32_16x16x32_bf16 v[236:239], v[124:127], v[104:107], v[236:239]
    v_exp_f32 v102, v102
    v_mfma_f32_16x16x32_bf16 a[120:123], v[128:131], v[104:107], a[120:123]
    buffer_load_dwordx4 v7, s[4:7], s49 offen offset:1024 nt lds
    v_exp_f32 v103, v103
    v_mfma_f32_16x16x32_bf16 a[148:151], v[132:135], v[104:107], a[148:151]
    v_add_f32 v18, v18, v100
    v_add_f32 v19, v19, v101
    v_mfma_f32_16x16x32_bf16 a[176:179], v[136:139], v[104:107], a[176:179]
    s_add_u32 m0, m0, s96
    v_cvt_pk_bf16_f32 v110, v100, v101
    v_add_f32 v18, v18, v102
    v_mfma_f32_16x16x32_bf16 a[204:207], v[140:143], v[104:107], a[204:207]
    v_add_f32 v19, v19, v103
    v_cvt_pk_bf16_f32 v111, v102, v103
    v_mfma_f32_16x16x32_bf16 v[96:99], v[56:59], a[80:83], v[48:51]
    v_mfma_f32_16x16x32_bf16 v[96:99], v[60:63], a[84:87], v[96:99]
    buffer_load_dwordx4 v7, s[4:7], s49 offen offset:1280 nt lds
    v_exp_f32 v88, v88
    v_mfma_f32_16x16x32_bf16 v[96:99], v[64:67], a[88:91], v[96:99]
    v_exp_f32 v89, v89
    v_mfma_f32_16x16x32_bf16 v[96:99], v[68:71], a[92:95], v[96:99]
    s_add_u32 m0, m0, s97
    v_exp_f32 v90, v90
    v_mfma_f32_16x16x32_bf16 v[100:103], v[84:87], a[92:95], v[48:51]
    v_exp_f32 v91, v91
    v_mfma_f32_16x16x32_bf16 v[100:103], v[80:83], a[88:91], v[100:103]
    buffer_load_dwordx4 v7, s[4:7], s49 offen offset:1536 nt lds
    v_add_f32 v20, v20, v88
    v_add_f32 v21, v21, v89
    v_mfma_f32_16x16x32_bf16 v[100:103], v[76:79], a[84:87], v[100:103]
    v_cvt_pk_bf16_f32 v104, v88, v89
    v_mfma_f32_16x16x32_bf16 v[100:103], v[72:75], a[80:83], v[100:103]
    v_exp_f32 v92, v92
    v_mfma_f32_16x16x32_bf16 v[156:159], v[112:115], v[108:111], v[156:159]
    s_add_u32 m0, m0, s96
    v_exp_f32 v93, v93
    v_mfma_f32_16x16x32_bf16 v[184:187], v[116:119], v[108:111], v[184:187]
    v_add_f32 v20, v20, v90
    v_add_f32 v21, v21, v91
    v_mfma_f32_16x16x32_bf16 v[212:215], v[120:123], v[108:111], v[212:215]
    buffer_load_dwordx4 v7, s[4:7], s49 offen offset:1792 nt lds
    v_cvt_pk_bf16_f32 v105, v90, v91
    v_mfma_f32_16x16x32_bf16 v[240:243], v[124:127], v[108:111], v[240:243]
    v_exp_f32 v94, v94
    v_mfma_f32_16x16x32_bf16 a[124:127], v[128:131], v[108:111], a[124:127]
    v_exp_f32 v95, v95
    v_mfma_f32_16x16x32_bf16 a[152:155], v[132:135], v[108:111], a[152:155]
    v_add_f32 v20, v20, v92
    v_add_f32 v21, v21, v93
    v_mfma_f32_16x16x32_bf16 a[180:183], v[136:139], v[108:111], a[180:183]
    v_cvt_pk_bf16_f32 v106, v92, v93
    v_add_f32 v20, v20, v94
    v_mfma_f32_16x16x32_bf16 a[208:211], v[140:143], v[108:111], a[208:211]
    v_add_f32 v21, v21, v95
    v_cvt_pk_bf16_f32 v107, v94, v95
    s_waitcnt vmcnt(16) lgkmcnt(0)
    s_barrier
    v_mfma_f32_16x16x32_bf16 v[88:91], v[56:59], a[96:99], v[52:55]
    ds_read_b128 v[56:59], v8 offset:25344
    v_mfma_f32_16x16x32_bf16 v[88:91], v[60:63], a[100:103], v[88:91]
    ds_read_b128 v[60:63], v8 offset:25408
    v_exp_f32 v96, v96
    v_mfma_f32_16x16x32_bf16 v[88:91], v[64:67], a[104:107], v[88:91]
    ds_read_b128 v[64:67], v8 offset:25472
    v_exp_f32 v97, v97
    v_mfma_f32_16x16x32_bf16 v[88:91], v[68:71], a[108:111], v[88:91]
    ds_read_b128 v[68:71], v8 offset:25536
    v_exp_f32 v98, v98
    v_mfma_f32_16x16x32_bf16 v[92:95], v[84:87], a[108:111], v[52:55]
    ds_read_b128 v[84:87], v8 offset:26048
    v_exp_f32 v99, v99
    v_mfma_f32_16x16x32_bf16 v[92:95], v[80:83], a[104:107], v[92:95]
    ds_read_b128 v[80:83], v8 offset:25984
    v_add_f32 v22, v22, v96
    v_add_f32 v23, v23, v97
    v_mfma_f32_16x16x32_bf16 v[92:95], v[76:79], a[100:103], v[92:95]
    ds_read_b128 v[76:79], v8 offset:25920
    v_cvt_pk_bf16_f32 v108, v96, v97
    v_mfma_f32_16x16x32_bf16 v[92:95], v[72:75], a[96:99], v[92:95]
    ds_read_b128 v[72:75], v8 offset:25856
    v_exp_f32 v100, v100
    v_mfma_f32_16x16x32_bf16 v[160:163], v[112:115], v[104:107], v[160:163]
    v_exp_f32 v101, v101
    v_mfma_f32_16x16x32_bf16 v[188:191], v[116:119], v[104:107], v[188:191]
    v_add_f32 v22, v22, v98
    v_add_f32 v23, v23, v99
    v_mfma_f32_16x16x32_bf16 v[216:219], v[120:123], v[104:107], v[216:219]
    v_cvt_pk_bf16_f32 v109, v98, v99
    v_mfma_f32_16x16x32_bf16 v[244:247], v[124:127], v[104:107], v[244:247]
    v_exp_f32 v102, v102
    v_mfma_f32_16x16x32_bf16 a[128:131], v[128:131], v[104:107], a[128:131]
    v_exp_f32 v103, v103
    v_mfma_f32_16x16x32_bf16 a[156:159], v[132:135], v[104:107], a[156:159]
    v_add_f32 v22, v22, v100
    v_add_f32 v23, v23, v101
    v_mfma_f32_16x16x32_bf16 a[184:187], v[136:139], v[104:107], a[184:187]
    v_cvt_pk_bf16_f32 v110, v100, v101
    v_add_f32 v22, v22, v102
    v_mfma_f32_16x16x32_bf16 a[212:215], v[140:143], v[104:107], a[212:215]
    v_add_f32 v23, v23, v103
    v_cvt_pk_bf16_f32 v111, v102, v103
    s_waitcnt lgkmcnt(0)
    v_mfma_f32_16x16x32_bf16 v[96:99], v[56:59], a[0:3], v[28:31]
    v_mfma_f32_16x16x32_bf16 v[96:99], v[60:63], a[4:7], v[96:99]
    v_exp_f32 v88, v88
    v_mfma_f32_16x16x32_bf16 v[96:99], v[64:67], a[8:11], v[96:99]
    v_exp_f32 v89, v89
    v_mfma_f32_16x16x32_bf16 v[96:99], v[68:71], a[12:15], v[96:99]
    v_exp_f32 v90, v90
    v_mfma_f32_16x16x32_bf16 v[100:103], v[84:87], a[12:15], v[28:31]
    v_exp_f32 v91, v91
    v_mfma_f32_16x16x32_bf16 v[100:103], v[80:83], a[8:11], v[100:103]
    v_add_f32 v24, v24, v88
    v_add_f32 v25, v25, v89
    v_mfma_f32_16x16x32_bf16 v[100:103], v[76:79], a[4:7], v[100:103]
    v_cvt_pk_bf16_f32 v104, v88, v89
    v_mfma_f32_16x16x32_bf16 v[100:103], v[72:75], a[0:3], v[100:103]
    v_exp_f32 v92, v92
    v_mfma_f32_16x16x32_bf16 v[164:167], v[112:115], v[108:111], v[164:167]
    v_exp_f32 v93, v93
    v_mfma_f32_16x16x32_bf16 v[192:195], v[116:119], v[108:111], v[192:195]
    v_add_f32 v24, v24, v90
    v_add_f32 v25, v25, v91
    v_mfma_f32_16x16x32_bf16 v[220:223], v[120:123], v[108:111], v[220:223]
    v_cvt_pk_bf16_f32 v105, v90, v91
    v_mfma_f32_16x16x32_bf16 v[248:251], v[124:127], v[108:111], v[248:251]
    v_exp_f32 v94, v94
    v_mfma_f32_16x16x32_bf16 a[132:135], v[128:131], v[108:111], a[132:135]
    v_exp_f32 v95, v95
    v_mfma_f32_16x16x32_bf16 a[160:163], v[132:135], v[108:111], a[160:163]
    v_add_f32 v24, v24, v92
    v_add_f32 v25, v25, v93
    v_mfma_f32_16x16x32_bf16 a[188:191], v[136:139], v[108:111], a[188:191]
    v_cvt_pk_bf16_f32 v106, v92, v93
    v_add_f32 v24, v24, v94
    v_mfma_f32_16x16x32_bf16 a[216:219], v[140:143], v[108:111], a[216:219]
    v_add_f32 v25, v25, v95
    v_cvt_pk_bf16_f32 v107, v94, v95
    v_mfma_f32_16x16x32_bf16 v[88:91], v[56:59], a[16:19], v[32:35]
    v_mfma_f32_16x16x32_bf16 v[88:91], v[60:63], a[20:23], v[88:91]
    v_exp_f32 v96, v96
    v_mfma_f32_16x16x32_bf16 v[88:91], v[64:67], a[24:27], v[88:91]
    v_exp_f32 v97, v97
    v_mfma_f32_16x16x32_bf16 v[88:91], v[68:71], a[28:31], v[88:91]
    v_exp_f32 v98, v98
    v_mfma_f32_16x16x32_bf16 v[92:95], v[84:87], a[28:31], v[32:35]
    v_exp_f32 v99, v99
    v_mfma_f32_16x16x32_bf16 v[92:95], v[80:83], a[24:27], v[92:95]
    v_add_f32 v12, v12, v96
    v_add_f32 v13, v13, v97
    v_mfma_f32_16x16x32_bf16 v[92:95], v[76:79], a[20:23], v[92:95]
    v_cvt_pk_bf16_f32 v108, v96, v97
    v_mfma_f32_16x16x32_bf16 v[92:95], v[72:75], a[16:19], v[92:95]
    v_exp_f32 v100, v100
    v_mfma_f32_16x16x32_bf16 v[168:171], v[112:115], v[104:107], v[168:171]
    ds_read_b64_tr_b16 v[112:113], v9 offset:25344
    ds_read_b64_tr_b16 v[114:115], v9 offset:25856
    v_exp_f32 v101, v101
    v_mfma_f32_16x16x32_bf16 v[196:199], v[116:119], v[104:107], v[196:199]
    ds_read_b64_tr_b16 v[116:117], v9 offset:25376
    ds_read_b64_tr_b16 v[118:119], v9 offset:25888
    v_add_f32 v12, v12, v98
    v_add_f32 v13, v13, v99
    v_mfma_f32_16x16x32_bf16 v[224:227], v[120:123], v[104:107], v[224:227]
    ds_read_b64_tr_b16 v[120:121], v9 offset:25408
    ds_read_b64_tr_b16 v[122:123], v9 offset:25920
    v_cvt_pk_bf16_f32 v109, v98, v99
    v_mfma_f32_16x16x32_bf16 v[252:255], v[124:127], v[104:107], v[252:255]
    ds_read_b64_tr_b16 v[124:125], v9 offset:25440
    ds_read_b64_tr_b16 v[126:127], v9 offset:25952
    v_exp_f32 v102, v102
    v_mfma_f32_16x16x32_bf16 a[136:139], v[128:131], v[104:107], a[136:139]
    ds_read_b64_tr_b16 v[128:129], v9 offset:25472
    ds_read_b64_tr_b16 v[130:131], v9 offset:25984
    v_exp_f32 v103, v103
    v_mfma_f32_16x16x32_bf16 a[164:167], v[132:135], v[104:107], a[164:167]
    ds_read_b64_tr_b16 v[132:133], v9 offset:25504
    ds_read_b64_tr_b16 v[134:135], v9 offset:26016
    v_add_f32 v12, v12, v100
    v_add_f32 v13, v13, v101
    v_mfma_f32_16x16x32_bf16 a[192:195], v[136:139], v[104:107], a[192:195]
    ds_read_b64_tr_b16 v[136:137], v9 offset:25536
    ds_read_b64_tr_b16 v[138:139], v9 offset:26048
    v_cvt_pk_bf16_f32 v110, v100, v101
    v_add_f32 v12, v12, v102
    v_mfma_f32_16x16x32_bf16 a[220:223], v[140:143], v[104:107], a[220:223]
    ds_read_b64_tr_b16 v[140:141], v9 offset:25568
    ds_read_b64_tr_b16 v[142:143], v9 offset:26080
    v_add_f32 v13, v13, v103
    v_cvt_pk_bf16_f32 v111, v102, v103
    v_mfma_f32_16x16x32_bf16 v[96:99], v[56:59], a[32:35], v[36:39]
    v_mfma_f32_16x16x32_bf16 v[96:99], v[60:63], a[36:39], v[96:99]
    s_add_u32 s29, s34, s100
    v_exp_f32 v88, v88
    v_mfma_f32_16x16x32_bf16 v[96:99], v[64:67], a[40:43], v[96:99]
    v_exp_f32 v89, v89
    v_mfma_f32_16x16x32_bf16 v[96:99], v[68:71], a[44:47], v[96:99]
    s_bfe_u32 s28, s29, 0x20003
    v_exp_f32 v90, v90
    v_mfma_f32_16x16x32_bf16 v[100:103], v[84:87], a[44:47], v[36:39]
    v_exp_f32 v91, v91
    v_mfma_f32_16x16x32_bf16 v[100:103], v[80:83], a[40:43], v[100:103]
    s_lshl_b32 s28, s28, 16
    v_add_f32 v14, v14, v88
    v_add_f32 v15, v15, v89
    v_mfma_f32_16x16x32_bf16 v[100:103], v[76:79], a[36:39], v[100:103]
    v_cvt_pk_bf16_f32 v104, v88, v89
    v_mfma_f32_16x16x32_bf16 v[100:103], v[72:75], a[32:35], v[100:103]
    v_exp_f32 v92, v92
    s_waitcnt lgkmcnt(0)
    v_mfma_f32_16x16x32_bf16 v[144:147], v[112:115], v[108:111], v[144:147]
    s_and_b32 s29, s29, 7
    v_exp_f32 v93, v93
    v_mfma_f32_16x16x32_bf16 v[172:175], v[116:119], v[108:111], v[172:175]
    v_add_f32 v14, v14, v90
    v_add_f32 v15, v15, v91
    v_mfma_f32_16x16x32_bf16 v[200:203], v[120:123], v[108:111], v[200:203]
    s_lshl_b32 s29, s29, 11
    v_cvt_pk_bf16_f32 v105, v90, v91
    v_mfma_f32_16x16x32_bf16 v[228:231], v[124:127], v[108:111], v[228:231]
    v_exp_f32 v94, v94
    v_mfma_f32_16x16x32_bf16 a[112:115], v[128:131], v[108:111], a[112:115]
    s_add_u32 s29, s28, s29
    v_exp_f32 v95, v95
    v_mfma_f32_16x16x32_bf16 a[140:143], v[132:135], v[108:111], a[140:143]
    v_add_f32 v14, v14, v92
    v_add_f32 v15, v15, v93
    v_mfma_f32_16x16x32_bf16 a[168:171], v[136:139], v[108:111], a[168:171]
    s_lshr_b32 s28, s34, 5
    v_cvt_pk_bf16_f32 v106, v92, v93
    v_add_f32 v14, v14, v94
    v_mfma_f32_16x16x32_bf16 a[196:199], v[140:143], v[108:111], a[196:199]
    v_add_f32 v15, v15, v95
    v_cvt_pk_bf16_f32 v107, v94, v95
    v_mfma_f32_16x16x32_bf16 v[88:91], v[56:59], a[48:51], v[40:43]
    v_mfma_f32_16x16x32_bf16 v[88:91], v[60:63], a[52:55], v[88:91]
    s_lshl_b32 s28, s28, 19
    v_exp_f32 v96, v96
    v_mfma_f32_16x16x32_bf16 v[88:91], v[64:67], a[56:59], v[88:91]
    v_exp_f32 v97, v97
    v_mfma_f32_16x16x32_bf16 v[88:91], v[68:71], a[60:63], v[88:91]
    s_add_u32 s49, s28, s29
    v_exp_f32 v98, v98
    v_mfma_f32_16x16x32_bf16 v[92:95], v[84:87], a[60:63], v[40:43]
    v_exp_f32 v99, v99
    v_mfma_f32_16x16x32_bf16 v[92:95], v[80:83], a[56:59], v[92:95]
    s_add_u32 m0, s33, 16896
    v_add_f32 v16, v16, v96
    v_add_f32 v17, v17, v97
    v_mfma_f32_16x16x32_bf16 v[92:95], v[76:79], a[52:55], v[92:95]
    v_cvt_pk_bf16_f32 v108, v96, v97
    v_mfma_f32_16x16x32_bf16 v[92:95], v[72:75], a[48:51], v[92:95]
    v_exp_f32 v100, v100
    v_mfma_f32_16x16x32_bf16 v[148:151], v[112:115], v[104:107], v[148:151]
    s_add_u32 s34, s34, 1
    v_exp_f32 v101, v101
    v_mfma_f32_16x16x32_bf16 v[176:179], v[116:119], v[104:107], v[176:179]
    v_add_f32 v16, v16, v98
    v_add_f32 v17, v17, v99
    v_mfma_f32_16x16x32_bf16 v[204:207], v[120:123], v[104:107], v[204:207]
    buffer_load_dwordx4 v7, s[4:7], s49 offen offset:0 nt lds
    v_cvt_pk_bf16_f32 v109, v98, v99
    v_mfma_f32_16x16x32_bf16 v[232:235], v[124:127], v[104:107], v[232:235]
    v_exp_f32 v102, v102
    v_mfma_f32_16x16x32_bf16 a[116:119], v[128:131], v[104:107], a[116:119]
    s_add_u32 m0, m0, s96
    v_exp_f32 v103, v103
    v_mfma_f32_16x16x32_bf16 a[144:147], v[132:135], v[104:107], a[144:147]
    v_add_f32 v16, v16, v100
    v_add_f32 v17, v17, v101
    v_mfma_f32_16x16x32_bf16 a[172:175], v[136:139], v[104:107], a[172:175]
    buffer_load_dwordx4 v7, s[4:7], s49 offen offset:256 nt lds
    v_cvt_pk_bf16_f32 v110, v100, v101
    v_add_f32 v16, v16, v102
    v_mfma_f32_16x16x32_bf16 a[200:203], v[140:143], v[104:107], a[200:203]
    v_add_f32 v17, v17, v103
    v_cvt_pk_bf16_f32 v111, v102, v103
    v_mfma_f32_16x16x32_bf16 v[96:99], v[56:59], a[64:67], v[44:47]
    v_mfma_f32_16x16x32_bf16 v[96:99], v[60:63], a[68:71], v[96:99]
    s_add_u32 m0, m0, s97
    v_exp_f32 v88, v88
    v_mfma_f32_16x16x32_bf16 v[96:99], v[64:67], a[72:75], v[96:99]
    v_exp_f32 v89, v89
    v_mfma_f32_16x16x32_bf16 v[96:99], v[68:71], a[76:79], v[96:99]
    buffer_load_dwordx4 v7, s[4:7], s49 offen offset:512 nt lds
    v_exp_f32 v90, v90
    v_mfma_f32_16x16x32_bf16 v[100:103], v[84:87], a[76:79], v[44:47]
    v_exp_f32 v91, v91
    v_mfma_f32_16x16x32_bf16 v[100:103], v[80:83], a[72:75], v[100:103]
    s_add_u32 m0, m0, s96
    v_add_f32 v18, v18, v88
    v_add_f32 v19, v19, v89
    v_mfma_f32_16x16x32_bf16 v[100:103], v[76:79], a[68:71], v[100:103]
    v_cvt_pk_bf16_f32 v104, v88, v89
    v_mfma_f32_16x16x32_bf16 v[100:103], v[72:75], a[64:67], v[100:103]
    v_exp_f32 v92, v92
    v_mfma_f32_16x16x32_bf16 v[152:155], v[112:115], v[108:111], v[152:155]
    buffer_load_dwordx4 v7, s[4:7], s49 offen offset:768 nt lds
    v_exp_f32 v93, v93
    v_mfma_f32_16x16x32_bf16 v[180:183], v[116:119], v[108:111], v[180:183]
    v_add_f32 v18, v18, v90
    v_add_f32 v19, v19, v91
    v_mfma_f32_16x16x32_bf16 v[208:211], v[120:123], v[108:111], v[208:211]
    s_add_u32 m0, m0, s97
    v_cvt_pk_bf16_f32 v105, v90, v91
    v_mfma_f32_16x16x32_bf16 v[236:239], v[124:127], v[108:111], v[236:239]
    v_exp_f32 v94, v94
    v_mfma_f32_16x16x32_bf16 a[120:123], v[128:131], v[108:111], a[120:123]
    buffer_load_dwordx4 v7, s[4:7], s49 offen offset:1024 nt lds
    v_exp_f32 v95, v95
    v_mfma_f32_16x16x32_bf16 a[148:151], v[132:135], v[108:111], a[148:151]
    v_add_f32 v18, v18, v92
    v_add_f32 v19, v19, v93
    v_mfma_f32_16x16x32_bf16 a[176:179], v[136:139], v[108:111], a[176:179]
    s_add_u32 m0, m0, s96
    v_cvt_pk_bf16_f32 v106, v92, v93
    v_add_f32 v18, v18, v94
    v_mfma_f32_16x16x32_bf16 a[204:207], v[140:143], v[108:111], a[204:207]
    v_add_f32 v19, v19, v95
    v_cvt_pk_bf16_f32 v107, v94, v95
    v_mfma_f32_16x16x32_bf16 v[88:91], v[56:59], a[80:83], v[48:51]
    v_mfma_f32_16x16x32_bf16 v[88:91], v[60:63], a[84:87], v[88:91]
    buffer_load_dwordx4 v7, s[4:7], s49 offen offset:1280 nt lds
    v_exp_f32 v96, v96
    v_mfma_f32_16x16x32_bf16 v[88:91], v[64:67], a[88:91], v[88:91]
    v_exp_f32 v97, v97
    v_mfma_f32_16x16x32_bf16 v[88:91], v[68:71], a[92:95], v[88:91]
    s_add_u32 m0, m0, s97
    v_exp_f32 v98, v98
    v_mfma_f32_16x16x32_bf16 v[92:95], v[84:87], a[92:95], v[48:51]
    v_exp_f32 v99, v99
    v_mfma_f32_16x16x32_bf16 v[92:95], v[80:83], a[88:91], v[92:95]
    buffer_load_dwordx4 v7, s[4:7], s49 offen offset:1536 nt lds
    v_add_f32 v20, v20, v96
    v_add_f32 v21, v21, v97
    v_mfma_f32_16x16x32_bf16 v[92:95], v[76:79], a[84:87], v[92:95]
    v_cvt_pk_bf16_f32 v108, v96, v97
    v_mfma_f32_16x16x32_bf16 v[92:95], v[72:75], a[80:83], v[92:95]
    v_exp_f32 v100, v100
    v_mfma_f32_16x16x32_bf16 v[156:159], v[112:115], v[104:107], v[156:159]
    s_add_u32 m0, m0, s96
    v_exp_f32 v101, v101
    v_mfma_f32_16x16x32_bf16 v[184:187], v[116:119], v[104:107], v[184:187]
    v_add_f32 v20, v20, v98
    v_add_f32 v21, v21, v99
    v_mfma_f32_16x16x32_bf16 v[212:215], v[120:123], v[104:107], v[212:215]
    buffer_load_dwordx4 v7, s[4:7], s49 offen offset:1792 nt lds
    v_cvt_pk_bf16_f32 v109, v98, v99
    v_mfma_f32_16x16x32_bf16 v[240:243], v[124:127], v[104:107], v[240:243]
    v_exp_f32 v102, v102
    v_mfma_f32_16x16x32_bf16 a[124:127], v[128:131], v[104:107], a[124:127]
    v_exp_f32 v103, v103
    v_mfma_f32_16x16x32_bf16 a[152:155], v[132:135], v[104:107], a[152:155]
    v_add_f32 v20, v20, v100
    v_add_f32 v21, v21, v101
    v_mfma_f32_16x16x32_bf16 a[180:183], v[136:139], v[104:107], a[180:183]
    v_cvt_pk_bf16_f32 v110, v100, v101
    v_add_f32 v20, v20, v102
    v_mfma_f32_16x16x32_bf16 a[208:211], v[140:143], v[104:107], a[208:211]
    v_add_f32 v21, v21, v103
    v_cvt_pk_bf16_f32 v111, v102, v103
    s_waitcnt vmcnt(16) lgkmcnt(0)
    s_barrier
    v_mfma_f32_16x16x32_bf16 v[96:99], v[56:59], a[96:99], v[52:55]
    ds_read_b128 v[56:59], v8 offset:0
    s_add_u32 s29, s34, s100
    v_mfma_f32_16x16x32_bf16 v[96:99], v[60:63], a[100:103], v[96:99]
    ds_read_b128 v[60:63], v8 offset:64
    s_bfe_u32 s28, s29, 0x20003
    v_exp_f32 v88, v88
    v_mfma_f32_16x16x32_bf16 v[96:99], v[64:67], a[104:107], v[96:99]
    ds_read_b128 v[64:67], v8 offset:128
    s_lshl_b32 s28, s28, 16
    v_exp_f32 v89, v89
    v_mfma_f32_16x16x32_bf16 v[96:99], v[68:71], a[108:111], v[96:99]
    ds_read_b128 v[68:71], v8 offset:192
    s_and_b32 s29, s29, 7
    v_exp_f32 v90, v90
    v_mfma_f32_16x16x32_bf16 v[100:103], v[84:87], a[108:111], v[52:55]
    ds_read_b128 v[84:87], v8 offset:704
    s_lshl_b32 s29, s29, 11
    v_exp_f32 v91, v91
    v_mfma_f32_16x16x32_bf16 v[100:103], v[80:83], a[104:107], v[100:103]
    ds_read_b128 v[80:83], v8 offset:640
    s_add_u32 s29, s28, s29
    v_add_f32 v22, v22, v88
    v_add_f32 v23, v23, v89
    v_mfma_f32_16x16x32_bf16 v[100:103], v[76:79], a[100:103], v[100:103]
    ds_read_b128 v[76:79], v8 offset:576
    s_lshr_b32 s28, s34, 5
    v_cvt_pk_bf16_f32 v104, v88, v89
    v_mfma_f32_16x16x32_bf16 v[100:103], v[72:75], a[96:99], v[100:103]
    ds_read_b128 v[72:75], v8 offset:512
    s_lshl_b32 s28, s28, 19
    v_exp_f32 v92, v92
    v_mfma_f32_16x16x32_bf16 v[160:163], v[112:115], v[108:111], v[160:163]
    s_add_u32 s49, s28, s29
    s_add_u32 m0, s33, 25344
    v_exp_f32 v93, v93
    v_mfma_f32_16x16x32_bf16 v[188:191], v[116:119], v[108:111], v[188:191]
    s_add_u32 s34, s34, 1
    v_add_f32 v22, v22, v90
    v_add_f32 v23, v23, v91
    v_mfma_f32_16x16x32_bf16 v[216:219], v[120:123], v[108:111], v[216:219]
    s_nop 0
    v_cvt_pk_bf16_f32 v105, v90, v91
    v_mfma_f32_16x16x32_bf16 v[244:247], v[124:127], v[108:111], v[244:247]
    buffer_load_dwordx4 v7, s[4:7], s49 offen offset:0 nt lds
    v_exp_f32 v94, v94
    v_mfma_f32_16x16x32_bf16 a[128:131], v[128:131], v[108:111], a[128:131]
    s_add_u32 m0, m0, s96
    v_exp_f32 v95, v95
    v_mfma_f32_16x16x32_bf16 a[156:159], v[132:135], v[108:111], a[156:159]
    s_nop 0
    v_add_f32 v22, v22, v92
    v_add_f32 v23, v23, v93
    v_mfma_f32_16x16x32_bf16 a[184:187], v[136:139], v[108:111], a[184:187]
    buffer_load_dwordx4 v7, s[4:7], s49 offen offset:256 nt lds
    v_cvt_pk_bf16_f32 v106, v92, v93
    v_add_f32 v22, v22, v94
    v_mfma_f32_16x16x32_bf16 a[212:215], v[140:143], v[108:111], a[212:215]
    s_add_u32 m0, m0, s97
    v_add_f32 v23, v23, v95
    v_cvt_pk_bf16_f32 v107, v94, v95
    s_lshl_b32 s30, s2, 2
    s_add_u32 s30, s30, s20
    s_mul_i32 s30, s30, 28672
    v_lshlrev_b32 v4, 4, v1
    buffer_load_dwordx4 a[0:3], v4, s[12:15], s30 offen offset:0
    buffer_load_dwordx4 a[4:7], v4, s[12:15], s30 offen offset:1024
    buffer_load_dwordx4 a[8:11], v4, s[12:15], s30 offen offset:2048
    buffer_load_dwordx4 a[12:15], v4, s[12:15], s30 offen offset:3072
    s_add_u32 s30, s30, 4096
    buffer_load_dwordx4 a[16:19], v4, s[12:15], s30 offen offset:0
    buffer_load_dwordx4 a[20:23], v4, s[12:15], s30 offen offset:1024
    buffer_load_dwordx4 a[24:27], v4, s[12:15], s30 offen offset:2048
    buffer_load_dwordx4 a[28:31], v4, s[12:15], s30 offen offset:3072
    s_add_u32 s30, s30, 4096
    buffer_load_dwordx4 a[32:35], v4, s[12:15], s30 offen offset:0
    buffer_load_dwordx4 a[36:39], v4, s[12:15], s30 offen offset:1024
    buffer_load_dwordx4 a[40:43], v4, s[12:15], s30 offen offset:2048
    buffer_load_dwordx4 a[44:47], v4, s[12:15], s30 offen offset:3072
    s_add_u32 s30, s30, 4096
    buffer_load_dwordx4 a[48:51], v4, s[12:15], s30 offen offset:0
    buffer_load_dwordx4 a[52:55], v4, s[12:15], s30 offen offset:1024
    buffer_load_dwordx4 a[56:59], v4, s[12:15], s30 offen offset:2048
    buffer_load_dwordx4 a[60:63], v4, s[12:15], s30 offen offset:3072
    s_add_u32 s30, s30, 4096
    buffer_load_dwordx4 a[64:67], v4, s[12:15], s30 offen offset:0
    buffer_load_dwordx4 a[68:71], v4, s[12:15], s30 offen offset:1024
    buffer_load_dwordx4 a[72:75], v4, s[12:15], s30 offen offset:2048
    buffer_load_dwordx4 a[76:79], v4, s[12:15], s30 offen offset:3072
    s_add_u32 s30, s30, 4096
    buffer_load_dwordx4 a[80:83], v4, s[12:15], s30 offen offset:0
    buffer_load_dwordx4 a[84:87], v4, s[12:15], s30 offen offset:1024
    buffer_load_dwordx4 a[88:91], v4, s[12:15], s30 offen offset:2048
    buffer_load_dwordx4 a[92:95], v4, s[12:15], s30 offen offset:3072
    s_add_u32 s30, s30, 4096
    buffer_load_dwordx4 a[96:99], v4, s[12:15], s30 offen offset:0
    buffer_load_dwordx4 a[100:103], v4, s[12:15], s30 offen offset:1024
    buffer_load_dwordx4 a[104:107], v4, s[12:15], s30 offen offset:2048
    buffer_load_dwordx4 a[108:111], v4, s[12:15], s30 offen offset:3072
    s_nop 1
    v_mfma_f32_16x16x32_bf16 v[164:167], v[112:115], v[104:107], v[164:167]
    s_nop 0
    buffer_load_dwordx4 v7, s[4:7], s49 offen offset:512 nt lds
    v_exp_f32 v96, v96
    v_mfma_f32_16x16x32_bf16 v[192:195], v[116:119], v[104:107], v[192:195]
    s_add_u32 m0, m0, s96
    s_nop 0
    v_exp_f32 v97, v97
    v_exp_f32 v98, v98
    v_mfma_f32_16x16x32_bf16 v[220:223], v[120:123], v[104:107], v[220:223]
    buffer_load_dwordx4 v7, s[4:7], s49 offen offset:768 nt lds
    s_add_u32 m0, m0, s97
    v_exp_f32 v99, v99
    v_add_f32 v24, v24, v96
    v_add_f32 v25, v25, v97
    v_mfma_f32_16x16x32_bf16 v[248:251], v[124:127], v[104:107], v[248:251]
    s_nop 0
    buffer_load_dwordx4 v7, s[4:7], s49 offen offset:1024 nt lds
    v_cvt_pk_bf16_f32 v108, v96, v97
    v_exp_f32 v100, v100
    v_mfma_f32_16x16x32_bf16 a[132:135], v[128:131], v[104:107], a[132:135]
    s_add_u32 m0, m0, s96
    s_nop 0
    buffer_load_dwordx4 v7, s[4:7], s49 offen offset:1280 nt lds
    v_exp_f32 v101, v101
    v_add_f32 v24, v24, v98
    v_add_f32 v25, v25, v99
    v_mfma_f32_16x16x32_bf16 a[160:163], v[132:135], v[104:107], a[160:163]
    s_add_u32 m0, m0, s97
    s_nop 0
    v_cvt_pk_bf16_f32 v109, v98, v99
    v_exp_f32 v102, v102
    v_mfma_f32_16x16x32_bf16 a[188:191], v[136:139], v[104:107], a[188:191]
    buffer_load_dwordx4 v7, s[4:7], s49 offen offset:1536 nt lds
    s_add_u32 m0, m0, s96
    v_exp_f32 v103, v103
    v_add_f32 v24, v24, v100
    v_add_f32 v25, v25, v101
    v_mfma_f32_16x16x32_bf16 a[216:219], v[140:143], v[104:107], a[216:219]
    s_nop 0
    buffer_load_dwordx4 v7, s[4:7], s49 offen offset:1792 nt lds
    v_cvt_pk_bf16_f32 v110, v100, v101
    v_add_f32 v24, v24, v102
    v_add_f32 v25, v25, v103
    v_cvt_pk_bf16_f32 v111, v102, v103
L_at_aepi:
    s_nop 1
    s_waitcnt lgkmcnt(0)
    v_mfma_f32_16x16x32_bf16 v[168:171], v[112:115], v[108:111], v[168:171]
    v_add_f32 v12, v12, v13
    v_add_f32 v14, v14, v15
    v_add_f32 v16, v16, v17
    v_add_f32 v18, v18, v19
    v_add_f32 v20, v20, v21
    v_add_f32 v22, v22, v23
    v_mfma_f32_16x16x32_bf16 v[196:199], v[116:119], v[108:111], v[196:199]
    v_add_f32 v24, v24, v25
    v_mov_b32 v88, v12
    v_mov_b32 v89, v14
    v_mov_b32 v90, v16
    v_mov_b32 v91, v18
    v_mov_b32 v92, v20
    v_mfma_f32_16x16x32_bf16 v[224:227], v[120:123], v[108:111], v[224:227]
    v_mov_b32 v93, v22
    v_mov_b32 v94, v24
    v_permlane16_swap_b32 v12, v88
    v_permlane16_swap_b32 v14, v89
    v_permlane16_swap_b32 v16, v90
    v_permlane16_swap_b32 v18, v91
    v_mfma_f32_16x16x32_bf16 v[252:255], v[124:127], v[108:111], v[252:255]
    v_permlane16_swap_b32 v20, v92
    v_permlane16_swap_b32 v22, v93
    v_permlane16_swap_b32 v24, v94
    v_add_f32 v12, v12, v88
    v_add_f32 v14, v14, v89
    v_add_f32 v16, v16, v90
    v_mfma_f32_16x16x32_bf16 a[136:139], v[128:131], v[108:111], a[136:139]
    v_add_f32 v18, v18, v91
    v_add_f32 v20, v20, v92
    v_add_f32 v22, v22, v93
    v_add_f32 v24, v24, v94
    v_mov_b32 v88, v12
    v_mov_b32 v89, v14
    v_mfma_f32_16x16x32_bf16 a[164:167], v[132:135], v[108:111], a[164:167]
    v_mov_b32 v90, v16
    v_mov_b32 v91, v18
    v_mov_b32 v92, v20
    v_mov_b32 v93, v22
    v_mov_b32 v94, v24
    v_permlane32_swap_b32 v12, v88
    v_mfma_f32_16x16x32_bf16 a[192:195], v[136:139], v[108:111], a[192:195]
    v_permlane32_swap_b32 v14, v89
    v_permlane32_swap_b32 v16, v90
    v_permlane32_swap_b32 v18, v91
    v_permlane32_swap_b32 v20, v92
    v_permlane32_swap_b32 v22, v93
    v_permlane32_swap_b32 v24, v94
    v_mfma_f32_16x16x32_bf16 a[220:223], v[140:143], v[108:111], a[220:223]
    v_add_f32 v12, v12, v88
    v_add_f32 v14, v14, v89
    v_add_f32 v16, v16, v90
    v_add_f32 v18, v18, v91
    v_add_f32 v20, v20, v92
    v_add_f32 v22, v22, v93
    v_add_f32 v24, v24, v94
    v_rcp_f32 v28, v12
    v_rcp_f32 v32, v14
    v_rcp_f32 v36, v16
    v_rcp_f32 v40, v18
    v_rcp_f32 v44, v20
    v_rcp_f32 v48, v22
    v_rcp_f32 v52, v24
    v_add_f32 v90, v12, v14
    v_add_f32 v91, v16, v18
    v_add_f32 v92, v20, v22
    v_add_f32 v90, v90, v24
    v_add_f32 v91, v91, v92
    v_add_f32 v90, v90, v91
    v_cmp_nge_f32 vcc, s32, v90
    v_mov_b32 v12, 0xff800000
    v_mov_b32 v14, 0xff800000
    v_mov_b32 v16, 0xff800000
    v_mov_b32 v18, 0xff800000
    v_mov_b32 v20, 0xff800000
    v_mov_b32 v22, 0xff800000
    v_mov_b32 v24, 0xff800000
    s_cmp_eq_u64 vcc, 0
    s_cbranch_scc1 L_at_noflag
    s_lshl_b32 s29, s21, 2
    s_add_u32 s29, s29, 75996
    v_mov_b32 v90, s29
    v_mov_b32 v91, 1
    ds_write_b32 v90, v91
L_at_noflag:
    s_mul_i32 s31, s21, 114688
    s_add_u32 s31, s31, s24
    s_sub_u32 s31, s31, 114688
    v_pk_mul_f32 v[144:145], v[144:145], v[28:29] op_sel_hi:[1,0]
    v_pk_mul_f32 v[146:147], v[146:147], v[28:29] op_sel_hi:[1,0]
    v_pk_mul_f32 v[148:149], v[148:149], v[32:33] op_sel_hi:[1,0]
    v_pk_mul_f32 v[150:151], v[150:151], v[32:33] op_sel_hi:[1,0]
    v_pk_mul_f32 v[152:153], v[152:153], v[36:37] op_sel_hi:[1,0]
    v_pk_mul_f32 v[154:155], v[154:155], v[36:37] op_sel_hi:[1,0]
    v_pk_mul_f32 v[156:157], v[156:157], v[40:41] op_sel_hi:[1,0]
    v_pk_mul_f32 v[158:159], v[158:159], v[40:41] op_sel_hi:[1,0]
    v_pk_mul_f32 v[160:161], v[160:161], v[44:45] op_sel_hi:[1,0]
    v_pk_mul_f32 v[162:163], v[162:163], v[44:45] op_sel_hi:[1,0]
    v_pk_mul_f32 v[164:165], v[164:165], v[48:49] op_sel_hi:[1,0]
    v_pk_mul_f32 v[166:167], v[166:167], v[48:49] op_sel_hi:[1,0]
    v_pk_mul_f32 v[168:169], v[168:169], v[52:53] op_sel_hi:[1,0]
    v_pk_mul_f32 v[170:171], v[170:171], v[52:53] op_sel_hi:[1,0]
    v_pk_mul_f32 v[172:173], v[172:173], v[28:29] op_sel_hi:[1,0]
    v_pk_mul_f32 v[174:175], v[174:175], v[28:29] op_sel_hi:[1,0]
    v_pk_mul_f32 v[176:177], v[176:177], v[32:33] op_sel_hi:[1,0]
    v_pk_mul_f32 v[178:179], v[178:179], v[32:33] op_sel_hi:[1,0]
    v_pk_mul_f32 v[180:181], v[180:181], v[36:37] op_sel_hi:[1,0]
    v_pk_mul_f32 v[182:183], v[182:183], v[36:37] op_sel_hi:[1,0]
    v_pk_mul_f32 v[184:185], v[184:185], v[40:41] op_sel_hi:[1,0]
    v_pk_mul_f32 v[186:187], v[186:187], v[40:41] op_sel_hi:[1,0]
    v_pk_mul_f32 v[188:189], v[188:189], v[44:45] op_sel_hi:[1,0]
    v_pk_mul_f32 v[190:191], v[190:191], v[44:45] op_sel_hi:[1,0]
    v_pk_mul_f32 v[192:193], v[192:193], v[48:49] op_sel_hi:[1,0]
    v_pk_mul_f32 v[194:195], v[194:195], v[48:49] op_sel_hi:[1,0]
    v_pk_mul_f32 v[196:197], v[196:197], v[52:53] op_sel_hi:[1,0]
    v_pk_mul_f32 v[198:199], v[198:199], v[52:53] op_sel_hi:[1,0]
    v_cvt_pk_bf16_f32 v88, v144, v145
    v_cvt_pk_bf16_f32 v89, v146, v147
    v_cvt_pk_bf16_f32 v90, v172, v173
    v_cvt_pk_bf16_f32 v91, v174, v175
    v_cvt_pk_bf16_f32 v92, v148, v149
    v_cvt_pk_bf16_f32 v93, v150, v151
    v_cvt_pk_bf16_f32 v94, v176, v177
    v_cvt_pk_bf16_f32 v95, v178, v179
    v_cvt_pk_bf16_f32 v96, v152, v153
    v_cvt_pk_bf16_f32 v97, v154, v155
    v_cvt_pk_bf16_f32 v98, v180, v181
    v_cvt_pk_bf16_f32 v99, v182, v183
    v_cvt_pk_bf16_f32 v100, v156, v157
    v_cvt_pk_bf16_f32 v101, v158, v159
    v_cvt_pk_bf16_f32 v102, v184, v185
    v_cvt_pk_bf16_f32 v103, v186, v187
    v_cvt_pk_bf16_f32 v104, v160, v161
    v_cvt_pk_bf16_f32 v105, v162, v163
    v_cvt_pk_bf16_f32 v106, v188, v189
    v_cvt_pk_bf16_f32 v107, v190, v191
    v_cvt_pk_bf16_f32 v108, v164, v165
    v_cvt_pk_bf16_f32 v109, v166, v167
    v_cvt_pk_bf16_f32 v110, v192, v193
    v_cvt_pk_bf16_f32 v111, v194, v195
    v_cvt_pk_bf16_f32 v112, v168, v169
    v_cvt_pk_bf16_f32 v113, v170, v171
    v_cvt_pk_bf16_f32 v114, v196, v197
    v_cvt_pk_bf16_f32 v115, v198, v199
    s_nop 1
    v_permlane16_swap_b32 v88, v90
    v_permlane16_swap_b32 v89, v91
    v_permlane16_swap_b32 v92, v94
    v_permlane16_swap_b32 v93, v95
    v_permlane16_swap_b32 v96, v98
    v_permlane16_swap_b32 v97, v99
    v_permlane16_swap_b32 v100, v102
    v_permlane16_swap_b32 v101, v103
    v_permlane16_swap_b32 v104, v106
    v_permlane16_swap_b32 v105, v107
    v_permlane16_swap_b32 v108, v110
    v_permlane16_swap_b32 v109, v111
    v_permlane16_swap_b32 v112, v114
    v_permlane16_swap_b32 v113, v115
    s_mov_b32 s28, s31
    buffer_store_dwordx4 v[88:91], v10, s[12:15], s28 offen offset:0 sc0 sc1
    s_add_u32 s28, s28, 4096
    buffer_store_dwordx4 v[92:95], v10, s[12:15], s28 offen offset:0 sc0 sc1
    s_add_u32 s28, s28, 4096
    buffer_store_dwordx4 v[96:99], v10, s[12:15], s28 offen offset:0 sc0 sc1
    s_add_u32 s28, s28, 4096
    buffer_store_dwordx4 v[100:103], v10, s[12:15], s28 offen offset:0 sc0 sc1
    s_add_u32 s28, s28, 4096
    buffer_store_dwordx4 v[104:107], v10, s[12:15], s28 offen offset:0 sc0 sc1
    s_add_u32 s28, s28, 4096
    buffer_store_dwordx4 v[108:111], v10, s[12:15], s28 offen offset:0 sc0 sc1
    s_add_u32 s28, s28, 4096
    buffer_store_dwordx4 v[112:115], v10, s[12:15], s28 offen offset:0 sc0 sc1
    v_pk_mul_f32 v[200:201], v[200:201], v[28:29] op_sel_hi:[1,0]
    v_pk_mul_f32 v[202:203], v[202:203], v[28:29] op_sel_hi:[1,0]
    v_pk_mul_f32 v[204:205], v[204:205], v[32:33] op_sel_hi:[1,0]
    v_pk_mul_f32 v[206:207], v[206:207], v[32:33] op_sel_hi:[1,0]
    v_pk_mul_f32 v[208:209], v[208:209], v[36:37] op_sel_hi:[1,0]
    v_pk_mul_f32 v[210:211], v[210:211], v[36:37] op_sel_hi:[1,0]
    v_pk_mul_f32 v[212:213], v[212:213], v[40:41] op_sel_hi:[1,0]
    v_pk_mul_f32 v[214:215], v[214:215], v[40:41] op_sel_hi:[1,0]
    v_pk_mul_f32 v[216:217], v[216:217], v[44:45] op_sel_hi:[1,0]
    v_pk_mul_f32 v[218:219], v[218:219], v[44:45] op_sel_hi:[1,0]
    v_pk_mul_f32 v[220:221], v[220:221], v[48:49] op_sel_hi:[1,0]
    v_pk_mul_f32 v[222:223], v[222:223], v[48:49] op_sel_hi:[1,0]
    v_pk_mul_f32 v[224:225], v[224:225], v[52:53] op_sel_hi:[1,0]
    v_pk_mul_f32 v[226:227], v[226:227], v[52:53] op_sel_hi:[1,0]
    v_pk_mul_f32 v[228:229], v[228:229], v[28:29] op_sel_hi:[1,0]
    v_pk_mul_f32 v[230:231], v[230:231], v[28:29] op_sel_hi:[1,0]
    v_pk_mul_f32 v[232:233], v[232:233], v[32:33] op_sel_hi:[1,0]
    v_pk_mul_f32 v[234:235], v[234:235], v[32:33] op_sel_hi:[1,0]
    v_pk_mul_f32 v[236:237], v[236:237], v[36:37] op_sel_hi:[1,0]
    v_pk_mul_f32 v[238:239], v[238:239], v[36:37] op_sel_hi:[1,0]
    v_pk_mul_f32 v[240:241], v[240:241], v[40:41] op_sel_hi:[1,0]
    v_pk_mul_f32 v[242:243], v[242:243], v[40:41] op_sel_hi:[1,0]
    v_pk_mul_f32 v[244:245], v[244:245], v[44:45] op_sel_hi:[1,0]
    v_pk_mul_f32 v[246:247], v[246:247], v[44:45] op_sel_hi:[1,0]
    v_pk_mul_f32 v[248:249], v[248:249], v[48:49] op_sel_hi:[1,0]
    v_pk_mul_f32 v[250:251], v[250:251], v[48:49] op_sel_hi:[1,0]
    v_pk_mul_f32 v[252:253], v[252:253], v[52:53] op_sel_hi:[1,0]
    v_pk_mul_f32 v[254:255], v[254:255], v[52:53] op_sel_hi:[1,0]
    v_cvt_pk_bf16_f32 v116, v200, v201
    v_cvt_pk_bf16_f32 v117, v202, v203
    v_cvt_pk_bf16_f32 v118, v228, v229
    v_cvt_pk_bf16_f32 v119, v230, v231
    v_cvt_pk_bf16_f32 v120, v204, v205
    v_cvt_pk_bf16_f32 v121, v206, v207
    v_cvt_pk_bf16_f32 v122, v232, v233
    v_cvt_pk_bf16_f32 v123, v234, v235
    v_cvt_pk_bf16_f32 v124, v208, v209
    v_cvt_pk_bf16_f32 v125, v210, v211
    v_cvt_pk_bf16_f32 v126, v236, v237
    v_cvt_pk_bf16_f32 v127, v238, v239
    v_cvt_pk_bf16_f32 v128, v212, v213
    v_cvt_pk_bf16_f32 v129, v214, v215
    v_cvt_pk_bf16_f32 v130, v240, v241
    v_cvt_pk_bf16_f32 v131, v242, v243
    v_cvt_pk_bf16_f32 v132, v216, v217
    v_cvt_pk_bf16_f32 v133, v218, v219
    v_cvt_pk_bf16_f32 v134, v244, v245
    v_cvt_pk_bf16_f32 v135, v246, v247
    v_cvt_pk_bf16_f32 v136, v220, v221
    v_cvt_pk_bf16_f32 v137, v222, v223
    v_cvt_pk_bf16_f32 v138, v248, v249
    v_cvt_pk_bf16_f32 v139, v250, v251
    v_cvt_pk_bf16_f32 v140, v224, v225
    v_cvt_pk_bf16_f32 v141, v226, v227
    v_cvt_pk_bf16_f32 v142, v252, v253
    v_cvt_pk_bf16_f32 v143, v254, v255
    s_nop 1
    v_permlane16_swap_b32 v116, v118
    v_permlane16_swap_b32 v117, v119
    v_permlane16_swap_b32 v120, v122
    v_permlane16_swap_b32 v121, v123
    v_permlane16_swap_b32 v124, v126
    v_permlane16_swap_b32 v125, v127
    v_permlane16_swap_b32 v128, v130
    v_permlane16_swap_b32 v129, v131
    v_permlane16_swap_b32 v132, v134
    v_permlane16_swap_b32 v133, v135
    v_permlane16_swap_b32 v136, v138
    v_permlane16_swap_b32 v137, v139
    v_permlane16_swap_b32 v140, v142
    v_permlane16_swap_b32 v141, v143
    s_mov_b32 s28, s31
    buffer_store_dwordx4 v[116:119], v10, s[12:15], s28 offen offset:1024 sc0 sc1
    s_add_u32 s28, s28, 4096
    buffer_store_dwordx4 v[120:123], v10, s[12:15], s28 offen offset:1024 sc0 sc1
    s_add_u32 s28, s28, 4096
    buffer_store_dwordx4 v[124:127], v10, s[12:15], s28 offen offset:1024 sc0 sc1
    s_add_u32 s28, s28, 4096
    buffer_store_dwordx4 v[128:131], v10, s[12:15], s28 offen offset:1024 sc0 sc1
    s_add_u32 s28, s28, 4096
    buffer_store_dwordx4 v[132:135], v10, s[12:15], s28 offen offset:1024 sc0 sc1
    s_add_u32 s28, s28, 4096
    buffer_store_dwordx4 v[136:139], v10, s[12:15], s28 offen offset:1024 sc0 sc1
    s_add_u32 s28, s28, 4096
    buffer_store_dwordx4 v[140:143], v10, s[12:15], s28 offen offset:1024 sc0 sc1
    v_accvgpr_read_b32 v144, a112
    v_accvgpr_read_b32 v145, a113
    v_accvgpr_read_b32 v146, a114
    v_accvgpr_read_b32 v147, a115
    v_accvgpr_read_b32 v148, a116
    v_accvgpr_read_b32 v149, a117
    v_accvgpr_read_b32 v150, a118
    v_accvgpr_read_b32 v151, a119
    v_accvgpr_read_b32 v152, a120
    v_accvgpr_read_b32 v153, a121
    v_accvgpr_read_b32 v154, a122
    v_accvgpr_read_b32 v155, a123
    v_accvgpr_read_b32 v156, a124
    v_accvgpr_read_b32 v157, a125
    v_accvgpr_read_b32 v158, a126
    v_accvgpr_read_b32 v159, a127
    v_accvgpr_read_b32 v160, a128
    v_accvgpr_read_b32 v161, a129
    v_accvgpr_read_b32 v162, a130
    v_accvgpr_read_b32 v163, a131
    v_accvgpr_read_b32 v164, a132
    v_accvgpr_read_b32 v165, a133
    v_accvgpr_read_b32 v166, a134
    v_accvgpr_read_b32 v167, a135
    v_accvgpr_read_b32 v168, a136
    v_accvgpr_read_b32 v169, a137
    v_accvgpr_read_b32 v170, a138
    v_accvgpr_read_b32 v171, a139
    v_accvgpr_read_b32 v172, a140
    v_accvgpr_read_b32 v173, a141
    v_accvgpr_read_b32 v174, a142
    v_accvgpr_read_b32 v175, a143
    v_accvgpr_read_b32 v176, a144
    v_accvgpr_read_b32 v177, a145
    v_accvgpr_read_b32 v178, a146
    v_accvgpr_read_b32 v179, a147
    v_accvgpr_read_b32 v180, a148
    v_accvgpr_read_b32 v181, a149
    v_accvgpr_read_b32 v182, a150
    v_accvgpr_read_b32 v183, a151
    v_accvgpr_read_b32 v184, a152
    v_accvgpr_read_b32 v185, a153
    v_accvgpr_read_b32 v186, a154
    v_accvgpr_read_b32 v187, a155
    v_accvgpr_read_b32 v188, a156
    v_accvgpr_read_b32 v189, a157
    v_accvgpr_read_b32 v190, a158
    v_accvgpr_read_b32 v191, a159
    v_accvgpr_read_b32 v192, a160
    v_accvgpr_read_b32 v193, a161
    v_accvgpr_read_b32 v194, a162
    v_accvgpr_read_b32 v195, a163
    v_accvgpr_read_b32 v196, a164
    v_accvgpr_read_b32 v197, a165
    v_accvgpr_read_b32 v198, a166
    v_accvgpr_read_b32 v199, a167
    v_pk_mul_f32 v[144:145], v[144:145], v[28:29] op_sel_hi:[1,0]
    v_pk_mul_f32 v[146:147], v[146:147], v[28:29] op_sel_hi:[1,0]
    v_pk_mul_f32 v[148:149], v[148:149], v[32:33] op_sel_hi:[1,0]
    v_pk_mul_f32 v[150:151], v[150:151], v[32:33] op_sel_hi:[1,0]
    v_pk_mul_f32 v[152:153], v[152:153], v[36:37] op_sel_hi:[1,0]
    v_pk_mul_f32 v[154:155], v[154:155], v[36:37] op_sel_hi:[1,0]
    v_pk_mul_f32 v[156:157], v[156:157], v[40:41] op_sel_hi:[1,0]
    v_pk_mul_f32 v[158:159], v[158:159], v[40:41] op_sel_hi:[1,0]
    v_pk_mul_f32 v[160:161], v[160:161], v[44:45] op_sel_hi:[1,0]
    v_pk_mul_f32 v[162:163], v[162:163], v[44:45] op_sel_hi:[1,0]
    v_pk_mul_f32 v[164:165], v[164:165], v[48:49] op_sel_hi:[1,0]
    v_pk_mul_f32 v[166:167], v[166:167], v[48:49] op_sel_hi:[1,0]
    v_pk_mul_f32 v[168:169], v[168:169], v[52:53] op_sel_hi:[1,0]
    v_pk_mul_f32 v[170:171], v[170:171], v[52:53] op_sel_hi:[1,0]
    v_pk_mul_f32 v[172:173], v[172:173], v[28:29] op_sel_hi:[1,0]
    v_pk_mul_f32 v[174:175], v[174:175], v[28:29] op_sel_hi:[1,0]
    v_pk_mul_f32 v[176:177], v[176:177], v[32:33] op_sel_hi:[1,0]
    v_pk_mul_f32 v[178:179], v[178:179], v[32:33] op_sel_hi:[1,0]
    v_pk_mul_f32 v[180:181], v[180:181], v[36:37] op_sel_hi:[1,0]
    v_pk_mul_f32 v[182:183], v[182:183], v[36:37] op_sel_hi:[1,0]
    v_pk_mul_f32 v[184:185], v[184:185], v[40:41] op_sel_hi:[1,0]
    v_pk_mul_f32 v[186:187], v[186:187], v[40:41] op_sel_hi:[1,0]
    v_pk_mul_f32 v[188:189], v[188:189], v[44:45] op_sel_hi:[1,0]
    v_pk_mul_f32 v[190:191], v[190:191], v[44:45] op_sel_hi:[1,0]
    v_pk_mul_f32 v[192:193], v[192:193], v[48:49] op_sel_hi:[1,0]
    v_pk_mul_f32 v[194:195], v[194:195], v[48:49] op_sel_hi:[1,0]
    v_pk_mul_f32 v[196:197], v[196:197], v[52:53] op_sel_hi:[1,0]
    v_pk_mul_f32 v[198:199], v[198:199], v[52:53] op_sel_hi:[1,0]
    v_cvt_pk_bf16_f32 v88, v144, v145
    v_cvt_pk_bf16_f32 v89, v146, v147
    v_cvt_pk_bf16_f32 v90, v172, v173
    v_cvt_pk_bf16_f32 v91, v174, v175
    v_cvt_pk_bf16_f32 v92, v148, v149
    v_cvt_pk_bf16_f32 v93, v150, v151
    v_cvt_pk_bf16_f32 v94, v176, v177
    v_cvt_pk_bf16_f32 v95, v178, v179
    v_cvt_pk_bf16_f32 v96, v152, v153
    v_cvt_pk_bf16_f32 v97, v154, v155
    v_cvt_pk_bf16_f32 v98, v180, v181
    v_cvt_pk_bf16_f32 v99, v182, v183
    v_cvt_pk_bf16_f32 v100, v156, v157
    v_cvt_pk_bf16_f32 v101, v158, v159
    v_cvt_pk_bf16_f32 v102, v184, v185
    v_cvt_pk_bf16_f32 v103, v186, v187
    v_cvt_pk_bf16_f32 v104, v160, v161
    v_cvt_pk_bf16_f32 v105, v162, v163
    v_cvt_pk_bf16_f32 v106, v188, v189
    v_cvt_pk_bf16_f32 v107, v190, v191
    v_cvt_pk_bf16_f32 v108, v164, v165
    v_cvt_pk_bf16_f32 v109, v166, v167
    v_cvt_pk_bf16_f32 v110, v192, v193
    v_cvt_pk_bf16_f32 v111, v194, v195
    v_cvt_pk_bf16_f32 v112, v168, v169
    v_cvt_pk_bf16_f32 v113, v170, v171
    v_cvt_pk_bf16_f32 v114, v196, v197
    v_cvt_pk_bf16_f32 v115, v198, v199
    s_nop 1
    v_permlane16_swap_b32 v88, v90
    v_permlane16_swap_b32 v89, v91
    v_permlane16_swap_b32 v92, v94
    v_permlane16_swap_b32 v93, v95
    v_permlane16_swap_b32 v96, v98
    v_permlane16_swap_b32 v97, v99
    v_permlane16_swap_b32 v100, v102
    v_permlane16_swap_b32 v101, v103
    v_permlane16_swap_b32 v104, v106
    v_permlane16_swap_b32 v105, v107
    v_permlane16_swap_b32 v108, v110
    v_permlane16_swap_b32 v109, v111
    v_permlane16_swap_b32 v112, v114
    v_permlane16_swap_b32 v113, v115
    s_mov_b32 s28, s31
    buffer_store_dwordx4 v[88:91], v10, s[12:15], s28 offen offset:2048 sc0 sc1
    s_add_u32 s28, s28, 4096
    buffer_store_dwordx4 v[92:95], v10, s[12:15], s28 offen offset:2048 sc0 sc1
    s_add_u32 s28, s28, 4096
    buffer_store_dwordx4 v[96:99], v10, s[12:15], s28 offen offset:2048 sc0 sc1
    s_add_u32 s28, s28, 4096
    buffer_store_dwordx4 v[100:103], v10, s[12:15], s28 offen offset:2048 sc0 sc1
    s_add_u32 s28, s28, 4096
    buffer_store_dwordx4 v[104:107], v10, s[12:15], s28 offen offset:2048 sc0 sc1
    s_add_u32 s28, s28, 4096
    buffer_store_dwordx4 v[108:111], v10, s[12:15], s28 offen offset:2048 sc0 sc1
    s_add_u32 s28, s28, 4096
    buffer_store_dwordx4 v[112:115], v10, s[12:15], s28 offen offset:2048 sc0 sc1
    v_accvgpr_read_b32 v200, a168
    v_accvgpr_read_b32 v201, a169
    v_accvgpr_read_b32 v202, a170
    v_accvgpr_read_b32 v203, a171
    v_accvgpr_read_b32 v204, a172
    v_accvgpr_read_b32 v205, a173
    v_accvgpr_read_b32 v206, a174
    v_accvgpr_read_b32 v207, a175
    v_accvgpr_read_b32 v208, a176
    v_accvgpr_read_b32 v209, a177
    v_accvgpr_read_b32 v210, a178
    v_accvgpr_read_b32 v211, a179
    v_accvgpr_read_b32 v212, a180
    v_accvgpr_read_b32 v213, a181
    v_accvgpr_read_b32 v214, a182
    v_accvgpr_read_b32 v215, a183
    v_accvgpr_read_b32 v216, a184
    v_accvgpr_read_b32 v217, a185
    v_accvgpr_read_b32 v218, a186
    v_accvgpr_read_b32 v219, a187
    v_accvgpr_read_b32 v220, a188
    v_accvgpr_read_b32 v221, a189
    v_accvgpr_read_b32 v222, a190
    v_accvgpr_read_b32 v223, a191
    v_accvgpr_read_b32 v224, a192
    v_accvgpr_read_b32 v225, a193
    v_accvgpr_read_b32 v226, a194
    v_accvgpr_read_b32 v227, a195
    v_accvgpr_read_b32 v228, a196
    v_accvgpr_read_b32 v229, a197
    v_accvgpr_read_b32 v230, a198
    v_accvgpr_read_b32 v231, a199
    v_accvgpr_read_b32 v232, a200
    v_accvgpr_read_b32 v233, a201
    v_accvgpr_read_b32 v234, a202
    v_accvgpr_read_b32 v235, a203
    v_accvgpr_read_b32 v236, a204
    v_accvgpr_read_b32 v237, a205
    v_accvgpr_read_b32 v238, a206
    v_accvgpr_read_b32 v239, a207
    v_accvgpr_read_b32 v240, a208
    v_accvgpr_read_b32 v241, a209
    v_accvgpr_read_b32 v242, a210
    v_accvgpr_read_b32 v243, a211
    v_accvgpr_read_b32 v244, a212
    v_accvgpr_read_b32 v245, a213
    v_accvgpr_read_b32 v246, a214
    v_accvgpr_read_b32 v247, a215
    v_accvgpr_read_b32 v248, a216
    v_accvgpr_read_b32 v249, a217
    v_accvgpr_read_b32 v250, a218
    v_accvgpr_read_b32 v251, a219
    v_accvgpr_read_b32 v252, a220
    v_accvgpr_read_b32 v253, a221
    v_accvgpr_read_b32 v254, a222
    v_accvgpr_read_b32 v255, a223
    v_pk_mul_f32 v[200:201], v[200:201], v[28:29] op_sel_hi:[1,0]
    v_pk_mul_f32 v[202:203], v[202:203], v[28:29] op_sel_hi:[1,0]
    v_pk_mul_f32 v[204:205], v[204:205], v[32:33] op_sel_hi:[1,0]
    v_pk_mul_f32 v[206:207], v[206:207], v[32:33] op_sel_hi:[1,0]
    v_pk_mul_f32 v[208:209], v[208:209], v[36:37] op_sel_hi:[1,0]
    v_pk_mul_f32 v[210:211], v[210:211], v[36:37] op_sel_hi:[1,0]
    v_pk_mul_f32 v[212:213], v[212:213], v[40:41] op_sel_hi:[1,0]
    v_pk_mul_f32 v[214:215], v[214:215], v[40:41] op_sel_hi:[1,0]
    v_pk_mul_f32 v[216:217], v[216:217], v[44:45] op_sel_hi:[1,0]
    v_pk_mul_f32 v[218:219], v[218:219], v[44:45] op_sel_hi:[1,0]
    v_pk_mul_f32 v[220:221], v[220:221], v[48:49] op_sel_hi:[1,0]
    v_pk_mul_f32 v[222:223], v[222:223], v[48:49] op_sel_hi:[1,0]
    v_pk_mul_f32 v[224:225], v[224:225], v[52:53] op_sel_hi:[1,0]
    v_pk_mul_f32 v[226:227], v[226:227], v[52:53] op_sel_hi:[1,0]
    v_pk_mul_f32 v[228:229], v[228:229], v[28:29] op_sel_hi:[1,0]
    v_pk_mul_f32 v[230:231], v[230:231], v[28:29] op_sel_hi:[1,0]
    v_pk_mul_f32 v[232:233], v[232:233], v[32:33] op_sel_hi:[1,0]
    v_pk_mul_f32 v[234:235], v[234:235], v[32:33] op_sel_hi:[1,0]
    v_pk_mul_f32 v[236:237], v[236:237], v[36:37] op_sel_hi:[1,0]
    v_pk_mul_f32 v[238:239], v[238:239], v[36:37] op_sel_hi:[1,0]
    v_pk_mul_f32 v[240:241], v[240:241], v[40:41] op_sel_hi:[1,0]
    v_pk_mul_f32 v[242:243], v[242:243], v[40:41] op_sel_hi:[1,0]
    v_pk_mul_f32 v[244:245], v[244:245], v[44:45] op_sel_hi:[1,0]
    v_pk_mul_f32 v[246:247], v[246:247], v[44:45] op_sel_hi:[1,0]
    v_pk_mul_f32 v[248:249], v[248:249], v[48:49] op_sel_hi:[1,0]
    v_pk_mul_f32 v[250:251], v[250:251], v[48:49] op_sel_hi:[1,0]
    v_pk_mul_f32 v[252:253], v[252:253], v[52:53] op_sel_hi:[1,0]
    v_pk_mul_f32 v[254:255], v[254:255], v[52:53] op_sel_hi:[1,0]
    v_cvt_pk_bf16_f32 v116, v200, v201
    v_cvt_pk_bf16_f32 v117, v202, v203
    v_cvt_pk_bf16_f32 v118, v228, v229
    v_cvt_pk_bf16_f32 v119, v230, v231
    v_cvt_pk_bf16_f32 v120, v204, v205
    v_cvt_pk_bf16_f32 v121, v206, v207
    v_cvt_pk_bf16_f32 v122, v232, v233
    v_cvt_pk_bf16_f32 v123, v234, v235
    v_cvt_pk_bf16_f32 v124, v208, v209
    v_cvt_pk_bf16_f32 v125, v210, v211
    v_cvt_pk_bf16_f32 v126, v236, v237
    v_cvt_pk_bf16_f32 v127, v238, v239
    v_cvt_pk_bf16_f32 v128, v212, v213
    v_cvt_pk_bf16_f32 v129, v214, v215
    v_cvt_pk_bf16_f32 v130, v240, v241
    v_cvt_pk_bf16_f32 v131, v242, v243
    v_cvt_pk_bf16_f32 v132, v216, v217
    v_cvt_pk_bf16_f32 v133, v218, v219
    v_cvt_pk_bf16_f32 v134, v244, v245
    v_cvt_pk_bf16_f32 v135, v246, v247
    v_cvt_pk_bf16_f32 v136, v220, v221
    v_cvt_pk_bf16_f32 v137, v222, v223
    v_cvt_pk_bf16_f32 v138, v248, v249
    v_cvt_pk_bf16_f32 v139, v250, v251
    v_cvt_pk_bf16_f32 v140, v224, v225
    v_cvt_pk_bf16_f32 v141, v226, v227
    v_cvt_pk_bf16_f32 v142, v252, v253
    v_cvt_pk_bf16_f32 v143, v254, v255
    s_nop 1
    v_permlane16_swap_b32 v116, v118
    v_permlane16_swap_b32 v117, v119
    v_permlane16_swap_b32 v120, v122
    v_permlane16_swap_b32 v121, v123
    v_permlane16_swap_b32 v124, v126
    v_permlane16_swap_b32 v125, v127
    v_permlane16_swap_b32 v128, v130
    v_permlane16_swap_b32 v129, v131
    v_permlane16_swap_b32 v132, v134
    v_permlane16_swap_b32 v133, v135
    v_permlane16_swap_b32 v136, v138
    v_permlane16_swap_b32 v137, v139
    v_permlane16_swap_b32 v140, v142
    v_permlane16_swap_b32 v141, v143
    s_mov_b32 s28, s31
    buffer_store_dwordx4 v[116:119], v10, s[12:15], s28 offen offset:3072 sc0 sc1
    s_add_u32 s28, s28, 4096
    buffer_store_dwordx4 v[120:123], v10, s[12:15], s28 offen offset:3072 sc0 sc1
    s_add_u32 s28, s28, 4096
    buffer_store_dwordx4 v[124:127], v10, s[12:15], s28 offen offset:3072 sc0 sc1
    s_add_u32 s28, s28, 4096
    buffer_store_dwordx4 v[128:131], v10, s[12:15], s28 offen offset:3072 sc0 sc1
    s_add_u32 s28, s28, 4096
    buffer_store_dwordx4 v[132:135], v10, s[12:15], s28 offen offset:3072 sc0 sc1
    s_add_u32 s28, s28, 4096
    buffer_store_dwordx4 v[136:139], v10, s[12:15], s28 offen offset:3072 sc0 sc1
    s_add_u32 s28, s28, 4096
    buffer_store_dwordx4 v[140:143], v10, s[12:15], s28 offen offset:3072 sc0 sc1
    s_nop 1
L_at_nowo2:
    s_mov_b32 s68, 3
    s_cmp_ge_u32 s21, 2
    s_cbranch_scc1 L_at_fin
    s_cmp_eq_u32 s69, 0
    s_cbranch_scc1 L_at_round
    s_waitcnt vmcnt(28)
    s_branch L_at_pre
L_at_fin:
    s_waitcnt lgkmcnt(0)
    s_barrier
    s_cmp_le_u32 s21, s27
    s_cbranch_scc1 L_at_nofb_6990
    s_sub_u32 s28, s21, 1
    s_cmp_eq_u32 s28, s23
    s_cbranch_scc1 L_at_nofb_6990
    s_lshl_b32 s29, s28, 2
    s_add_u32 s29, s29, 76000
    v_mov_b32 v4, s29
    ds_read_b32 v4, v4
    s_waitcnt lgkmcnt(0)
    v_readfirstlane_b32 s29, v4
    s_nop 3
    s_cmp_lg_u32 s29, 0
    s_cbranch_scc1 L_at_fallback
L_at_nofb_6990:
    s_branch L_at_end
L_bw1_453:
    s_sub_u32 s68, s68, 1
    s_waitcnt vmcnt(44) lgkmcnt(0)
    s_branch L_bw2_453
L_bw1_576:
    s_sub_u32 s68, s68, 1
    s_waitcnt vmcnt(36) lgkmcnt(0)
    s_branch L_bw2_576
L_bw1_693:
    s_sub_u32 s68, s68, 1
    s_waitcnt vmcnt(44) lgkmcnt(0)
    s_branch L_bw2_693
L_bw1_3109:
    s_sub_u32 s68, s68, 1
    s_waitcnt vmcnt(44) lgkmcnt(0)
    s_branch L_bw2_3109
L_bw1_3491:
    s_sub_u32 s68, s68, 1
    s_waitcnt vmcnt(44) lgkmcnt(0)
    s_branch L_bw2_3491
L_bw1_3800:
    s_sub_u32 s68, s68, 1
    s_waitcnt vmcnt(44) lgkmcnt(0)
    s_branch L_bw2_3800
L_at_wt0:
    s_and_b32 s28, s2, 127
    s_mul_i32 s28, s28, 40960
    s_mul_i32 s29, s20, 10240
    s_add_u32 s28, s28, s29
    v_lshlrev_b32 v4, 7, v1
    v_and_b32 v5, 15, v1
    v_lshlrev_b32 v5, 7, v5
    buffer_load_dword a250, v4, s[84:87], s28 offen
    s_add_u32 s28, s28, 8192
    buffer_load_dword a251, v5, s[84:87], s28 offen
    s_branch L_at_wt0r
L_at_fallback:
    s_sub_u32 s27, s21, 1
    s_mov_b32 s23, s27
    s_mov_b32 s25, 1
    s_mov_b32 s69, 0
    s_mov_b32 s70, 0
    s_mov_b32 s68, 0
    v_mov_b32 v12, 0xff800000
    v_mov_b32 v14, 0xff800000
    v_mov_b32 v16, 0xff800000
    v_mov_b32 v18, 0xff800000
    v_mov_b32 v20, 0xff800000
    v_mov_b32 v22, 0xff800000
    v_mov_b32 v24, 0xff800000
    s_waitcnt vmcnt(0) lgkmcnt(0)
    s_barrier
    s_branch L_at_start
L_at_maxpass:
    s_mov_b32 s25, 0
    s_waitcnt lgkmcnt(0)
    v_and_b32 v2, 15, v1
    v_lshlrev_b32 v2, 8, v2
    v_bfe_u32 v3, v1, 4, 1
    v_lshl_add_u32 v2, v3, 5, v2
    v_bfe_u32 v3, v1, 5, 1
    v_lshl_add_u32 v4, v3, 4, v2
    v_add_u32 v5, 4096, v4
    s_lshl_b32 s29, s21, 19
    s_mov_b32 s22, 0
L_at_mp:
    buffer_load_dwordx4 v[112:115], v4, s[8:11], s29 offen offset:0
    buffer_load_dwordx4 v[116:119], v4, s[8:11], s29 offen offset:64
    buffer_load_dwordx4 v[120:123], v4, s[8:11], s29 offen offset:128
    buffer_load_dwordx4 v[124:127], v4, s[8:11], s29 offen offset:192
    buffer_load_dwordx4 v[128:131], v5, s[8:11], s29 offen offset:0
    buffer_load_dwordx4 v[132:135], v5, s[8:11], s29 offen offset:64
    buffer_load_dwordx4 v[136:139], v5, s[8:11], s29 offen offset:128
    buffer_load_dwordx4 v[140:143], v5, s[8:11], s29 offen offset:192
    s_waitcnt vmcnt(0)
    v_mfma_f32_16x16x32_bf16 v[88:91], v[112:115], a[0:3], 0
    v_mfma_f32_16x16x32_bf16 v[88:91], v[116:119], a[4:7], v[88:91]
    v_mfma_f32_16x16x32_bf16 v[88:91], v[120:123], a[8:11], v[88:91]
    v_mfma_f32_16x16x32_bf16 v[88:91], v[124:127], a[12:15], v[88:91]
    v_mfma_f32_16x16x32_bf16 v[92:95], v[128:131], a[0:3], 0
    v_mfma_f32_16x16x32_bf16 v[92:95], v[132:135], a[4:7], v[92:95]
    v_mfma_f32_16x16x32_bf16 v[92:95], v[136:139], a[8:11], v[92:95]
    v_mfma_f32_16x16x32_bf16 v[92:95], v[140:143], a[12:15], v[92:95]
    s_nop 9
    v_max3_f32 v12, v88, v89, v12
    v_max3_f32 v12, v90, v91, v12
    v_max3_f32 v12, v92, v93, v12
    v_max3_f32 v12, v94, v95, v12
    s_nop 3
    v_mfma_f32_16x16x32_bf16 v[88:91], v[112:115], a[16:19], 0
    v_mfma_f32_16x16x32_bf16 v[88:91], v[116:119], a[20:23], v[88:91]
    v_mfma_f32_16x16x32_bf16 v[88:91], v[120:123], a[24:27], v[88:91]
    v_mfma_f32_16x16x32_bf16 v[88:91], v[124:127], a[28:31], v[88:91]
    v_mfma_f32_16x16x32_bf16 v[92:95], v[128:131], a[16:19], 0
    v_mfma_f32_16x16x32_bf16 v[92:95], v[132:135], a[20:23], v[92:95]
    v_mfma_f32_16x16x32_bf16 v[92:95], v[136:139], a[24:27], v[92:95]
    v_mfma_f32_16x16x32_bf16 v[92:95], v[140:143], a[28:31], v[92:95]
    s_nop 9
    v_max3_f32 v14, v88, v89, v14
    v_max3_f32 v14, v90, v91, v14
    v_max3_f32 v14, v92, v93, v14
    v_max3_f32 v14, v94, v95, v14
    s_nop 3
    v_mfma_f32_16x16x32_bf16 v[88:91], v[112:115], a[32:35], 0
    v_mfma_f32_16x16x32_bf16 v[88:91], v[116:119], a[36:39], v[88:91]
    v_mfma_f32_16x16x32_bf16 v[88:91], v[120:123], a[40:43], v[88:91]
    v_mfma_f32_16x16x32_bf16 v[88:91], v[124:127], a[44:47], v[88:91]
    v_mfma_f32_16x16x32_bf16 v[92:95], v[128:131], a[32:35], 0
    v_mfma_f32_16x16x32_bf16 v[92:95], v[132:135], a[36:39], v[92:95]
    v_mfma_f32_16x16x32_bf16 v[92:95], v[136:139], a[40:43], v[92:95]
    v_mfma_f32_16x16x32_bf16 v[92:95], v[140:143], a[44:47], v[92:95]
    s_nop 9
    v_max3_f32 v16, v88, v89, v16
    v_max3_f32 v16, v90, v91, v16
    v_max3_f32 v16, v92, v93, v16
    v_max3_f32 v16, v94, v95, v16
    s_nop 3
    v_mfma_f32_16x16x32_bf16 v[88:91], v[112:115], a[48:51], 0
    v_mfma_f32_16x16x32_bf16 v[88:91], v[116:119], a[52:55], v[88:91]
    v_mfma_f32_16x16x32_bf16 v[88:91], v[120:123], a[56:59], v[88:91]
    v_mfma_f32_16x16x32_bf16 v[88:91], v[124:127], a[60:63], v[88:91]
    v_mfma_f32_16x16x32_bf16 v[92:95], v[128:131], a[48:51], 0
    v_mfma_f32_16x16x32_bf16 v[92:95], v[132:135], a[52:55], v[92:95]
    v_mfma_f32_16x16x32_bf16 v[92:95], v[136:139], a[56:59], v[92:95]
    v_mfma_f32_16x16x32_bf16 v[92:95], v[140:143], a[60:63], v[92:95]
    s_nop 9
    v_max3_f32 v18, v88, v89, v18
    v_max3_f32 v18, v90, v91, v18
    v_max3_f32 v18, v92, v93, v18
    v_max3_f32 v18, v94, v95, v18
    s_nop 3
    v_mfma_f32_16x16x32_bf16 v[88:91], v[112:115], a[64:67], 0
    v_mfma_f32_16x16x32_bf16 v[88:91], v[116:119], a[68:71], v[88:91]
    v_mfma_f32_16x16x32_bf16 v[88:91], v[120:123], a[72:75], v[88:91]
    v_mfma_f32_16x16x32_bf16 v[88:91], v[124:127], a[76:79], v[88:91]
    v_mfma_f32_16x16x32_bf16 v[92:95], v[128:131], a[64:67], 0
    v_mfma_f32_16x16x32_bf16 v[92:95], v[132:135], a[68:71], v[92:95]
    v_mfma_f32_16x16x32_bf16 v[92:95], v[136:139], a[72:75], v[92:95]
    v_mfma_f32_16x16x32_bf16 v[92:95], v[140:143], a[76:79], v[92:95]
    s_nop 9
    v_max3_f32 v20, v88, v89, v20
    v_max3_f32 v20, v90, v91, v20
    v_max3_f32 v20, v92, v93, v20
    v_max3_f32 v20, v94, v95, v20
    s_nop 3
    v_mfma_f32_16x16x32_bf16 v[88:91], v[112:115], a[80:83], 0
    v_mfma_f32_16x16x32_bf16 v[88:91], v[116:119], a[84:87], v[88:91]
    v_mfma_f32_16x16x32_bf16 v[88:91], v[120:123], a[88:91], v[88:91]
    v_mfma_f32_16x16x32_bf16 v[88:91], v[124:127], a[92:95], v[88:91]
    v_mfma_f32_16x16x32_bf16 v[92:95], v[128:131], a[80:83], 0
    v_mfma_f32_16x16x32_bf16 v[92:95], v[132:135], a[84:87], v[92:95]
    v_mfma_f32_16x16x32_bf16 v[92:95], v[136:139], a[88:91], v[92:95]
    v_mfma_f32_16x16x32_bf16 v[92:95], v[140:143], a[92:95], v[92:95]
    s_nop 9
    v_max3_f32 v22, v88, v89, v22
    v_max3_f32 v22, v90, v91, v22
    v_max3_f32 v22, v92, v93, v22
    v_max3_f32 v22, v94, v95, v22
    s_nop 3
    v_mfma_f32_16x16x32_bf16 v[88:91], v[112:115], a[96:99], 0
    v_mfma_f32_16x16x32_bf16 v[88:91], v[116:119], a[100:103], v[88:91]
    v_mfma_f32_16x16x32_bf16 v[88:91], v[120:123], a[104:107], v[88:91]
    v_mfma_f32_16x16x32_bf16 v[88:91], v[124:127], a[108:111], v[88:91]
    v_mfma_f32_16x16x32_bf16 v[92:95], v[128:131], a[96:99], 0
    v_mfma_f32_16x16x32_bf16 v[92:95], v[132:135], a[100:103], v[92:95]
    v_mfma_f32_16x16x32_bf16 v[92:95], v[136:139], a[104:107], v[92:95]
    v_mfma_f32_16x16x32_bf16 v[92:95], v[140:143], a[108:111], v[92:95]
    s_nop 9
    v_max3_f32 v24, v88, v89, v24
    v_max3_f32 v24, v90, v91, v24
    v_max3_f32 v24, v92, v93, v24
    v_max3_f32 v24, v94, v95, v24
    s_nop 3
    s_add_u32 s29, s29, 8192
    s_add_u32 s22, s22, 1
    s_cmp_lt_u32 s22, 32
    s_cbranch_scc1 L_at_mp
    s_branch L_at_pre
L_at_end:
    s_endpgm
.globl op_kernel
.p2align 8
.type op_kernel,@function
op_kernel:
    s_cmp_ge_u32 s2, 256
    s_cbranch_scc1 L_op_end
    s_and_b32 s3, s2, 7
    s_lshl_b32 s3, s3, 5
    s_lshr_b32 s30, s2, 3
    s_add_u32 s3, s3, s30
    s_cmp_ge_u32 s3, 250
    s_cbranch_scc1 L_op_end
    s_load_dwordx2 s[36:37], s[0:1], 32
    s_load_dwordx2 s[38:39], s[0:1], 72
    s_load_dwordx2 s[40:41], s[0:1], 80
    s_load_dwordx2 s[44:45], s[0:1], 96
    v_and_b32 v1, 63, v0
    v_lshrrev_b32 v2, 6, v0
    s_nop 0
    v_readfirstlane_b32 s20, v2
    s_mul_i32 s28, s3, 13108
    s_lshr_b32 s28, s28, 16
    s_mul_i32 s22, s28, 5
    s_sub_u32 s29, s3, s22
    s_mov_b32 s61, s28
    s_cmp_ge_u32 s28, 25
    s_cselect_b32 s30, 1, 0
    s_cselect_b32 s22, 25, 0
    s_sub_u32 s28, s28, s22
    s_mul_i32 s31, s28, 9
    s_lshl_b32 s24, s20, 10
    s_add_u32 s24, s24, 58720256
    s_mul_i32 s23, s30, 29360128
    s_add_u32 s24, s24, s23
    s_add_u32 s22, s31, 0
    s_mul_i32 s23, s22, 4682
    s_lshr_b32 s23, s23, 16
    s_mul_i32 s62, s23, 1777664
    s_lshl_b32 s48, s22, 12
    s_add_u32 s48, s48, s62
    s_add_u32 s48, s48, s24
    s_add_u32 s22, s31, 1
    s_mul_i32 s23, s22, 4682
    s_lshr_b32 s23, s23, 16
    s_mul_i32 s62, s23, 1777664
    s_lshl_b32 s49, s22, 12
    s_add_u32 s49, s49, s62
    s_add_u32 s49, s49, s24
    s_add_u32 s22, s31, 2
    s_mul_i32 s23, s22, 4682
    s_lshr_b32 s23, s23, 16
    s_mul_i32 s62, s23, 1777664
    s_lshl_b32 s50, s22, 12
    s_add_u32 s50, s50, s62
    s_add_u32 s50, s50, s24
    s_add_u32 s22, s31, 3
    s_mul_i32 s23, s22, 4682
    s_lshr_b32 s23, s23, 16
    s_mul_i32 s62, s23, 1777664
    s_lshl_b32 s51, s22, 12
    s_add_u32 s51, s51, s62
    s_add_u32 s51, s51, s24
    s_add_u32 s22, s31, 4
    s_mul_i32 s23, s22, 4682
    s_lshr_b32 s23, s23, 16
    s_mul_i32 s62, s23, 1777664
    s_lshl_b32 s52, s22, 12
    s_add_u32 s52, s52, s62
    s_add_u32 s52, s52, s24
    s_add_u32 s22, s31, 5
    s_mul_i32 s23, s22, 4682
    s_lshr_b32 s23, s23, 16
    s_mul_i32 s62, s23, 1777664
    s_lshl_b32 s53, s22, 12
    s_add_u32 s53, s53, s62
    s_add_u32 s53, s53, s24
    s_add_u32 s22, s31, 6
    s_mul_i32 s23, s22, 4682
    s_lshr_b32 s23, s23, 16
    s_mul_i32 s62, s23, 1777664
    s_lshl_b32 s54, s22, 12
    s_add_u32 s54, s54, s62
    s_add_u32 s54, s54, s24
    s_add_u32 s22, s31, 7
    s_mul_i32 s23, s22, 4682
    s_lshr_b32 s23, s23, 16
    s_mul_i32 s62, s23, 1777664
    s_lshl_b32 s55, s22, 12
    s_add_u32 s55, s55, s62
    s_add_u32 s55, s55, s24
    s_add_u32 s22, s31, 8
    s_mul_i32 s23, s22, 4682
    s_lshr_b32 s23, s23, 16
    s_mul_i32 s62, s23, 1777664
    s_lshl_b32 s56, s22, 12
    s_add_u32 s56, s56, s62
    s_add_u32 s56, s56, s24
    s_cmp_ge_u32 s22, 224
    s_cselect_b32 s62, 0x40000000, 0
    s_add_u32 s56, s56, s62
    v_lshlrev_b32 v6, 4, v1
    v_lshrrev_b32 v2, 4, v1
    v_and_b32 v3, 15, v1
    v_lshlrev_b32 v4, 1, v2
    v_xor_b32 v3, v3, v4
    v_lshlrev_b32 v3, 4, v3
    v_mul_u32_u24 v4, 1280, v2
    v_add_u32 v5, v4, v3
    v_xor_b32 v3, 128, v3
    v_add_u32 v4, v4, v3
    v_add_u32 v10, 0, v5
    v_add_u32 v11, 4096, v5
    v_add_u32 v12, 8192, v4
    v_add_u32 v13, 12288, v4
    v_add_u32 v14, 20480, v5
    v_add_u32 v15, 24576, v5
    v_add_u32 v16, 28672, v4
    v_add_u32 v17, 32768, v4
    s_mul_i32 s27, s20, 40960
    s_waitcnt lgkmcnt(0)
    s_cmp_lg_u32 s30, 0
    s_cselect_b32 s8, s38, s36
    s_cselect_b32 s9, s39, s37
    s_mov_b32 s10, 5242880
    s_mov_b32 s11, 0x20000
    s_mov_b32 s4, s44
    s_mov_b32 s5, s45
    s_mov_b32 s6, 127926272
    s_mov_b32 s7, 0x20000
    s_mov_b32 s12, s40
    s_mov_b32 s13, s41
    s_mov_b32 s14, 9175040
    s_mov_b32 s15, 0x20000
    s_mul_i32 s22, s20, 40960
    s_lshl_b32 s23, s29, 8
    s_add_u32 s26, s22, s23
    s_mov_b32 s25, 0
    v_add_u32 v7, s25, v6
    s_add_u32 m0, s27, 0
    s_nop 0
    buffer_load_dwordx4 v10, s[8:11], s26 offen offset:0 lds
    buffer_load_dwordx4 v11, s[8:11], s26 offen offset:1024 lds
    buffer_load_dwordx4 v12, s[8:11], s26 offen offset:2048 lds
    buffer_load_dwordx4 v13, s[8:11], s26 offen offset:3072 lds
    s_add_u32 m0, s27, 4096
    s_nop 0
    buffer_load_dwordx4 v14, s[8:11], s26 offen offset:0 lds
    buffer_load_dwordx4 v15, s[8:11], s26 offen offset:1024 lds
    buffer_load_dwordx4 v16, s[8:11], s26 offen offset:2048 lds
    buffer_load_dwordx4 v17, s[8:11], s26 offen offset:3072 lds
    s_add_u32 s26, s26, 163840
    buffer_load_dwordx4 v[92:95], v7, s[4:7], s48 offen
    buffer_load_dwordx4 v[96:99], v7, s[4:7], s49 offen
    buffer_load_dwordx4 v[100:103], v7, s[4:7], s50 offen
    buffer_load_dwordx4 v[104:107], v7, s[4:7], s51 offen
    buffer_load_dwordx4 v[108:111], v7, s[4:7], s52 offen
    buffer_load_dwordx4 v[112:115], v7, s[4:7], s53 offen
    buffer_load_dwordx4 v[116:119], v7, s[4:7], s54 offen
    buffer_load_dwordx4 v[120:123], v7, s[4:7], s55 offen
    buffer_load_dwordx4 v[124:127], v7, s[4:7], s56 offen
    v_add_u32 v7, 57344, v7
    s_add_u32 m0, s27, 8192
    s_nop 0
    buffer_load_dwordx4 v10, s[8:11], s26 offen offset:0 lds
    buffer_load_dwordx4 v11, s[8:11], s26 offen offset:1024 lds
    buffer_load_dwordx4 v12, s[8:11], s26 offen offset:2048 lds
    buffer_load_dwordx4 v13, s[8:11], s26 offen offset:3072 lds
    s_add_u32 m0, s27, 12288
    s_nop 0
    buffer_load_dwordx4 v14, s[8:11], s26 offen offset:0 lds
    buffer_load_dwordx4 v15, s[8:11], s26 offen offset:1024 lds
    buffer_load_dwordx4 v16, s[8:11], s26 offen offset:2048 lds
    buffer_load_dwordx4 v17, s[8:11], s26 offen offset:3072 lds
    s_add_u32 s26, s26, 163840
    v_lshrrev_b32 v2, 4, v1
    v_bfe_u32 v3, v1, 2, 2
    v_lshl_add_u32 v4, v2, 3, v3
    v_lshlrev_b32 v4, 8, v4
    v_and_b32 v2, 1, v2
    v_lshl_add_u32 v3, v2, 2, v3
    v_lshl_add_u32 v4, v3, 5, v4
    v_and_b32 v3, 3, v1
    v_lshl_add_u32 v4, v3, 3, v4
    v_add_u32 v4, s27, v4
    v_xor_b32 v18, 0, v4
    v_xor_b32 v19, 32, v4
    v_xor_b32 v20, 64, v4
    v_xor_b32 v21, 96, v4
    v_xor_b32 v22, 128, v4
    v_xor_b32 v23, 160, v4
    v_xor_b32 v24, 192, v4
    v_xor_b32 v25, 224, v4
    v_add_u32 v8, s27, v6
    v_bfe_u32 v4, v1, 4, 1
    v_lshlrev_b32 v4, 5, v4
    v_and_b32 v2, 15, v1
    v_mul_u32_u24 v2, 2560, v2
    v_add_u32 v2, v2, v4
    v_bfe_u32 v4, v1, 5, 1
    v_lshl_add_u32 v9, v4, 4, v2
    s_lshl_b32 s22, s20, 11
    v_add_u32 v2, s22, v6
    v_add_u32 v3, 40960, v2
    v_add_u32 v4, 81920, v2
    v_add_u32 v5, 122880, v2
    s_mul_i32 s22, s28, 368640
    s_mul_i32 s23, s30, 1280
    s_add_u32 s22, s22, s23
    s_lshl_b32 s23, s29, 8
    s_add_u32 s24, s22, s23
    s_waitcnt vmcnt(17)
    ds_read_b64_tr_b16 v[60:61], v18 offset:0
    ds_read_b64_tr_b16 v[62:63], v18 offset:1024
    ds_read_b64_tr_b16 v[64:65], v19 offset:0
    ds_read_b64_tr_b16 v[66:67], v19 offset:1024
    ds_read_b64_tr_b16 v[68:69], v20 offset:0
    ds_read_b64_tr_b16 v[70:71], v20 offset:1024
    ds_read_b64_tr_b16 v[72:73], v21 offset:0
    ds_read_b64_tr_b16 v[74:75], v21 offset:1024
    ds_read_b64_tr_b16 v[76:77], v22 offset:0
    ds_read_b64_tr_b16 v[78:79], v22 offset:1024
    ds_read_b64_tr_b16 v[80:81], v23 offset:0
    ds_read_b64_tr_b16 v[82:83], v23 offset:1024
    ds_read_b64_tr_b16 v[84:85], v24 offset:0
    ds_read_b64_tr_b16 v[86:87], v24 offset:1024
    ds_read_b64_tr_b16 v[88:89], v25 offset:0
    ds_read_b64_tr_b16 v[90:91], v25 offset:1024
    s_waitcnt vmcnt(0) lgkmcnt(12)
    v_mfma_f32_16x16x32_bf16 a[0:3], v[60:63], v[92:95], 0
    buffer_load_dwordx4 v[128:131], v7, s[4:7], s48 offen
    v_mfma_f32_16x16x32_bf16 a[4:7], v[60:63], v[96:99], 0
    buffer_load_dwordx4 v[132:135], v7, s[4:7], s49 offen
    v_mfma_f32_16x16x32_bf16 a[8:11], v[60:63], v[100:103], 0
    buffer_load_dwordx4 v[136:139], v7, s[4:7], s50 offen
    v_mfma_f32_16x16x32_bf16 a[12:15], v[60:63], v[104:107], 0
    buffer_load_dwordx4 v[140:143], v7, s[4:7], s51 offen
    v_mfma_f32_16x16x32_bf16 a[16:19], v[60:63], v[108:111], 0
    buffer_load_dwordx4 v[144:147], v7, s[4:7], s52 offen
    v_mfma_f32_16x16x32_bf16 a[20:23], v[60:63], v[112:115], 0
    buffer_load_dwordx4 v[148:151], v7, s[4:7], s53 offen
    v_mfma_f32_16x16x32_bf16 a[24:27], v[60:63], v[116:119], 0
    buffer_load_dwordx4 v[152:155], v7, s[4:7], s54 offen
    v_mfma_f32_16x16x32_bf16 a[28:31], v[60:63], v[120:123], 0
    buffer_load_dwordx4 v[156:159], v7, s[4:7], s55 offen
    v_mfma_f32_16x16x32_bf16 a[32:35], v[60:63], v[124:127], 0
    ds_read_b64_tr_b16 v[60:61], v18 offset:8192
    ds_read_b64_tr_b16 v[62:63], v18 offset:9216
    v_mfma_f32_16x16x32_bf16 a[36:39], v[64:67], v[92:95], 0
    buffer_load_dwordx4 v[160:163], v7, s[4:7], s56 offen
    v_mfma_f32_16x16x32_bf16 a[40:43], v[64:67], v[96:99], 0
    v_add_u32 v7, 57344, v7
    v_mfma_f32_16x16x32_bf16 a[44:47], v[64:67], v[100:103], 0
    s_add_u32 m0, s27, 16384
    v_mfma_f32_16x16x32_bf16 a[48:51], v[64:67], v[104:107], 0
    s_nop 0
    v_mfma_f32_16x16x32_bf16 a[52:55], v[64:67], v[108:111], 0
    buffer_load_dwordx4 v10, s[8:11], s26 offen offset:0 lds
    v_mfma_f32_16x16x32_bf16 a[56:59], v[64:67], v[112:115], 0
    buffer_load_dwordx4 v11, s[8:11], s26 offen offset:1024 lds
    v_mfma_f32_16x16x32_bf16 a[60:63], v[64:67], v[116:119], 0
    buffer_load_dwordx4 v12, s[8:11], s26 offen offset:2048 lds
    v_mfma_f32_16x16x32_bf16 a[64:67], v[64:67], v[120:123], 0
    buffer_load_dwordx4 v13, s[8:11], s26 offen offset:3072 lds
    v_mfma_f32_16x16x32_bf16 a[68:71], v[64:67], v[124:127], 0
    ds_read_b64_tr_b16 v[64:65], v19 offset:8192
    ds_read_b64_tr_b16 v[66:67], v19 offset:9216
    s_waitcnt lgkmcnt(4)
    v_mfma_f32_16x16x32_bf16 a[72:75], v[68:71], v[92:95], 0
    s_add_u32 m0, s27, 20480
    v_mfma_f32_16x16x32_bf16 a[76:79], v[68:71], v[96:99], 0
    s_nop 0
    v_mfma_f32_16x16x32_bf16 a[80:83], v[68:71], v[100:103], 0
    buffer_load_dwordx4 v14, s[8:11], s26 offen offset:0 lds
    v_mfma_f32_16x16x32_bf16 a[84:87], v[68:71], v[104:107], 0
    buffer_load_dwordx4 v15, s[8:11], s26 offen offset:1024 lds
    v_mfma_f32_16x16x32_bf16 a[88:91], v[68:71], v[108:111], 0
    buffer_load_dwordx4 v16, s[8:11], s26 offen offset:2048 lds
    v_mfma_f32_16x16x32_bf16 a[92:95], v[68:71], v[112:115], 0
    buffer_load_dwordx4 v17, s[8:11], s26 offen offset:3072 lds
    v_mfma_f32_16x16x32_bf16 a[96:99], v[68:71], v[116:119], 0
    s_add_u32 s26, s26, 163840
    v_mfma_f32_16x16x32_bf16 a[100:103], v[68:71], v[120:123], 0
    s_add_u32 m0, s27, 24576
    v_mfma_f32_16x16x32_bf16 a[104:107], v[68:71], v[124:127], 0
    ds_read_b64_tr_b16 v[68:69], v20 offset:8192
    ds_read_b64_tr_b16 v[70:71], v20 offset:9216
    v_mfma_f32_16x16x32_bf16 a[108:111], v[72:75], v[92:95], 0
    s_nop 0
    v_mfma_f32_16x16x32_bf16 a[112:115], v[72:75], v[96:99], 0
    buffer_load_dwordx4 v10, s[8:11], s26 offen offset:0 lds
    v_mfma_f32_16x16x32_bf16 a[116:119], v[72:75], v[100:103], 0
    buffer_load_dwordx4 v11, s[8:11], s26 offen offset:1024 lds
    v_mfma_f32_16x16x32_bf16 a[120:123], v[72:75], v[104:107], 0
    buffer_load_dwordx4 v12, s[8:11], s26 offen offset:2048 lds
    v_mfma_f32_16x16x32_bf16 a[124:127], v[72:75], v[108:111], 0
    buffer_load_dwordx4 v13, s[8:11], s26 offen offset:3072 lds
    v_mfma_f32_16x16x32_bf16 a[128:131], v[72:75], v[112:115], 0
    s_add_u32 m0, s27, 28672
    v_mfma_f32_16x16x32_bf16 a[132:135], v[72:75], v[116:119], 0
    s_nop 0
    v_mfma_f32_16x16x32_bf16 a[136:139], v[72:75], v[120:123], 0
    buffer_load_dwordx4 v14, s[8:11], s26 offen offset:0 lds
    v_mfma_f32_16x16x32_bf16 a[140:143], v[72:75], v[124:127], 0
    ds_read_b64_tr_b16 v[72:73], v21 offset:8192
    ds_read_b64_tr_b16 v[74:75], v21 offset:9216
    v_mfma_f32_16x16x32_bf16 a[144:147], v[76:79], v[92:95], 0
    buffer_load_dwordx4 v15, s[8:11], s26 offen offset:1024 lds
    v_mfma_f32_16x16x32_bf16 a[148:151], v[76:79], v[96:99], 0
    buffer_load_dwordx4 v16, s[8:11], s26 offen offset:2048 lds
    v_mfma_f32_16x16x32_bf16 a[152:155], v[76:79], v[100:103], 0
    buffer_load_dwordx4 v17, s[8:11], s26 offen offset:3072 lds
    v_mfma_f32_16x16x32_bf16 a[156:159], v[76:79], v[104:107], 0
    s_add_u32 s26, s26, 163840
    v_mfma_f32_16x16x32_bf16 a[160:163], v[76:79], v[108:111], 0
    buffer_load_dwordx4 v[164:167], v7, s[4:7], s48 offen
    v_mfma_f32_16x16x32_bf16 a[164:167], v[76:79], v[112:115], 0
    buffer_load_dwordx4 v[168:171], v7, s[4:7], s49 offen
    v_mfma_f32_16x16x32_bf16 a[168:171], v[76:79], v[116:119], 0
    buffer_load_dwordx4 v[172:175], v7, s[4:7], s50 offen
    v_mfma_f32_16x16x32_bf16 a[172:175], v[76:79], v[120:123], 0
    buffer_load_dwordx4 v[176:179], v7, s[4:7], s51 offen
    v_mfma_f32_16x16x32_bf16 a[176:179], v[76:79], v[124:127], 0
    ds_read_b64_tr_b16 v[76:77], v22 offset:8192
    ds_read_b64_tr_b16 v[78:79], v22 offset:9216
    v_mfma_f32_16x16x32_bf16 a[180:183], v[80:83], v[92:95], 0
    buffer_load_dwordx4 v[180:183], v7, s[4:7], s52 offen
    v_mfma_f32_16x16x32_bf16 a[184:187], v[80:83], v[96:99], 0
    buffer_load_dwordx4 v[184:187], v7, s[4:7], s53 offen
    v_mfma_f32_16x16x32_bf16 a[188:191], v[80:83], v[100:103], 0
    buffer_load_dwordx4 v[188:191], v7, s[4:7], s54 offen
    v_mfma_f32_16x16x32_bf16 a[192:195], v[80:83], v[104:107], 0
    buffer_load_dwordx4 v[192:195], v7, s[4:7], s55 offen
    v_mfma_f32_16x16x32_bf16 a[196:199], v[80:83], v[108:111], 0
    buffer_load_dwordx4 v[196:199], v7, s[4:7], s56 offen
    v_mfma_f32_16x16x32_bf16 a[200:203], v[80:83], v[112:115], 0
    v_add_u32 v7, 57344, v7
    v_mfma_f32_16x16x32_bf16 a[204:207], v[80:83], v[116:119], 0
    buffer_load_dwordx4 v[200:203], v7, s[4:7], s48 offen
    v_mfma_f32_16x16x32_bf16 a[208:211], v[80:83], v[120:123], 0
    buffer_load_dwordx4 v[204:207], v7, s[4:7], s49 offen
    v_mfma_f32_16x16x32_bf16 a[212:215], v[80:83], v[124:127], 0
    ds_read_b64_tr_b16 v[80:81], v23 offset:8192
    ds_read_b64_tr_b16 v[82:83], v23 offset:9216
    v_mfma_f32_16x16x32_bf16 a[216:219], v[84:87], v[92:95], 0
    buffer_load_dwordx4 v[208:211], v7, s[4:7], s50 offen
    v_mfma_f32_16x16x32_bf16 a[220:223], v[84:87], v[96:99], 0
    buffer_load_dwordx4 v[212:215], v7, s[4:7], s51 offen
    v_mfma_f32_16x16x32_bf16 a[224:227], v[84:87], v[100:103], 0
    buffer_load_dwordx4 v[216:219], v7, s[4:7], s52 offen
    v_mfma_f32_16x16x32_bf16 a[228:231], v[84:87], v[104:107], 0
    buffer_load_dwordx4 v[220:223], v7, s[4:7], s53 offen
    v_mfma_f32_16x16x32_bf16 a[232:235], v[84:87], v[108:111], 0
    buffer_load_dwordx4 v[224:227], v7, s[4:7], s54 offen
    v_mfma_f32_16x16x32_bf16 a[236:239], v[84:87], v[112:115], 0
    buffer_load_dwordx4 v[228:231], v7, s[4:7], s55 offen
    v_mfma_f32_16x16x32_bf16 a[240:243], v[84:87], v[116:119], 0
    buffer_load_dwordx4 v[232:235], v7, s[4:7], s56 offen
    v_mfma_f32_16x16x32_bf16 a[244:247], v[84:87], v[120:123], 0
    v_add_u32 v7, 57344, v7
    v_mfma_f32_16x16x32_bf16 a[248:251], v[84:87], v[124:127], 0
    ds_read_b64_tr_b16 v[84:85], v24 offset:8192
    ds_read_b64_tr_b16 v[86:87], v24 offset:9216
    v_mfma_f32_16x16x32_bf16 a[252:255], v[88:91], v[92:95], 0
    v_mfma_f32_16x16x32_bf16 v[28:31], v[88:91], v[96:99], 0
    v_mfma_f32_16x16x32_bf16 v[32:35], v[88:91], v[100:103], 0
    v_mfma_f32_16x16x32_bf16 v[36:39], v[88:91], v[104:107], 0
    v_mfma_f32_16x16x32_bf16 v[40:43], v[88:91], v[108:111], 0
    v_mfma_f32_16x16x32_bf16 v[44:47], v[88:91], v[112:115], 0
    v_mfma_f32_16x16x32_bf16 v[48:51], v[88:91], v[116:119], 0
    v_mfma_f32_16x16x32_bf16 v[52:55], v[88:91], v[120:123], 0
    v_mfma_f32_16x16x32_bf16 v[56:59], v[88:91], v[124:127], 0
    ds_read_b64_tr_b16 v[88:89], v25 offset:8192
    ds_read_b64_tr_b16 v[90:91], v25 offset:9216
    s_waitcnt vmcnt(34) lgkmcnt(12)
    v_mfma_f32_16x16x32_bf16 a[0:3], v[60:63], v[128:131], a[0:3]
    v_mfma_f32_16x16x32_bf16 a[4:7], v[60:63], v[132:135], a[4:7]
    v_mfma_f32_16x16x32_bf16 a[8:11], v[60:63], v[136:139], a[8:11]
    v_mfma_f32_16x16x32_bf16 a[12:15], v[60:63], v[140:143], a[12:15]
    v_mfma_f32_16x16x32_bf16 a[16:19], v[60:63], v[144:147], a[16:19]
    v_mfma_f32_16x16x32_bf16 a[20:23], v[60:63], v[148:151], a[20:23]
    v_mfma_f32_16x16x32_bf16 a[24:27], v[60:63], v[152:155], a[24:27]
    v_mfma_f32_16x16x32_bf16 a[28:31], v[60:63], v[156:159], a[28:31]
    v_mfma_f32_16x16x32_bf16 a[32:35], v[60:63], v[160:163], a[32:35]
    v_mfma_f32_16x16x32_bf16 a[36:39], v[64:67], v[128:131], a[36:39]
    v_mfma_f32_16x16x32_bf16 a[40:43], v[64:67], v[132:135], a[40:43]
    v_mfma_f32_16x16x32_bf16 a[44:47], v[64:67], v[136:139], a[44:47]
    v_mfma_f32_16x16x32_bf16 a[48:51], v[64:67], v[140:143], a[48:51]
    v_mfma_f32_16x16x32_bf16 a[52:55], v[64:67], v[144:147], a[52:55]
    v_mfma_f32_16x16x32_bf16 a[56:59], v[64:67], v[148:151], a[56:59]
    v_mfma_f32_16x16x32_bf16 a[60:63], v[64:67], v[152:155], a[60:63]
    v_mfma_f32_16x16x32_bf16 a[64:67], v[64:67], v[156:159], a[64:67]
    v_mfma_f32_16x16x32_bf16 a[68:71], v[64:67], v[160:163], a[68:71]
    s_waitcnt vmcnt(18)
    ds_read_b64_tr_b16 v[60:61], v18 offset:16384
    ds_read_b64_tr_b16 v[62:63], v18 offset:17408
    ds_read_b64_tr_b16 v[64:65], v18 offset:24576
    ds_read_b64_tr_b16 v[66:67], v18 offset:25600
    s_waitcnt lgkmcnt(4)
    v_mfma_f32_16x16x32_bf16 a[72:75], v[68:71], v[128:131], a[72:75]
    s_add_u32 m0, s27, 0
    v_mfma_f32_16x16x32_bf16 a[76:79], v[68:71], v[132:135], a[76:79]
    s_nop 0
    v_mfma_f32_16x16x32_bf16 a[80:83], v[68:71], v[136:139], a[80:83]
    buffer_load_dwordx4 v10, s[8:11], s26 offen offset:0 lds
    v_mfma_f32_16x16x32_bf16 a[84:87], v[68:71], v[140:143], a[84:87]
    buffer_load_dwordx4 v11, s[8:11], s26 offen offset:1024 lds
    v_mfma_f32_16x16x32_bf16 a[88:91], v[68:71], v[144:147], a[88:91]
    buffer_load_dwordx4 v12, s[8:11], s26 offen offset:2048 lds
    v_mfma_f32_16x16x32_bf16 a[92:95], v[68:71], v[148:151], a[92:95]
    buffer_load_dwordx4 v13, s[8:11], s26 offen offset:3072 lds
    v_mfma_f32_16x16x32_bf16 a[96:99], v[68:71], v[152:155], a[96:99]
    s_add_u32 m0, s27, 4096
    v_mfma_f32_16x16x32_bf16 a[100:103], v[68:71], v[156:159], a[100:103]
    s_nop 0
    v_mfma_f32_16x16x32_bf16 a[104:107], v[68:71], v[160:163], a[104:107]
    buffer_load_dwordx4 v14, s[8:11], s26 offen offset:0 lds
    v_mfma_f32_16x16x32_bf16 a[108:111], v[72:75], v[128:131], a[108:111]
    buffer_load_dwordx4 v15, s[8:11], s26 offen offset:1024 lds
    v_mfma_f32_16x16x32_bf16 a[112:115], v[72:75], v[132:135], a[112:115]
    buffer_load_dwordx4 v16, s[8:11], s26 offen offset:2048 lds
    v_mfma_f32_16x16x32_bf16 a[116:119], v[72:75], v[136:139], a[116:119]
    buffer_load_dwordx4 v17, s[8:11], s26 offen offset:3072 lds
    v_mfma_f32_16x16x32_bf16 a[120:123], v[72:75], v[140:143], a[120:123]
    s_add_u32 s26, s26, 163840
    v_mfma_f32_16x16x32_bf16 a[124:127], v[72:75], v[144:147], a[124:127]
    s_add_u32 m0, s27, 8192
    v_mfma_f32_16x16x32_bf16 a[128:131], v[72:75], v[148:151], a[128:131]
    s_nop 0
    v_mfma_f32_16x16x32_bf16 a[132:135], v[72:75], v[152:155], a[132:135]
    buffer_load_dwordx4 v10, s[8:11], s26 offen offset:0 lds
    v_mfma_f32_16x16x32_bf16 a[136:139], v[72:75], v[156:159], a[136:139]
    buffer_load_dwordx4 v11, s[8:11], s26 offen offset:1024 lds
    v_mfma_f32_16x16x32_bf16 a[140:143], v[72:75], v[160:163], a[140:143]
    ds_read_b64_tr_b16 v[68:69], v19 offset:16384
    ds_read_b64_tr_b16 v[70:71], v19 offset:17408
    ds_read_b64_tr_b16 v[72:73], v19 offset:24576
    ds_read_b64_tr_b16 v[74:75], v19 offset:25600
    v_mfma_f32_16x16x32_bf16 a[144:147], v[76:79], v[128:131], a[144:147]
    buffer_load_dwordx4 v12, s[8:11], s26 offen offset:2048 lds
    v_mfma_f32_16x16x32_bf16 a[148:151], v[76:79], v[132:135], a[148:151]
    buffer_load_dwordx4 v13, s[8:11], s26 offen offset:3072 lds
    v_mfma_f32_16x16x32_bf16 a[152:155], v[76:79], v[136:139], a[152:155]
    s_add_u32 m0, s27, 12288
    v_mfma_f32_16x16x32_bf16 a[156:159], v[76:79], v[140:143], a[156:159]
    s_nop 0
    v_mfma_f32_16x16x32_bf16 a[160:163], v[76:79], v[144:147], a[160:163]
    buffer_load_dwordx4 v14, s[8:11], s26 offen offset:0 lds
    v_mfma_f32_16x16x32_bf16 a[164:167], v[76:79], v[148:151], a[164:167]
    buffer_load_dwordx4 v15, s[8:11], s26 offen offset:1024 lds
    v_mfma_f32_16x16x32_bf16 a[168:171], v[76:79], v[152:155], a[168:171]
    buffer_load_dwordx4 v16, s[8:11], s26 offen offset:2048 lds
    v_mfma_f32_16x16x32_bf16 a[172:175], v[76:79], v[156:159], a[172:175]
    buffer_load_dwordx4 v17, s[8:11], s26 offen offset:3072 lds
    v_mfma_f32_16x16x32_bf16 a[176:179], v[76:79], v[160:163], a[176:179]
    s_add_u32 s26, s26, 163840
    v_mfma_f32_16x16x32_bf16 a[180:183], v[80:83], v[128:131], a[180:183]
    v_mfma_f32_16x16x32_bf16 a[184:187], v[80:83], v[132:135], a[184:187]
    v_mfma_f32_16x16x32_bf16 a[188:191], v[80:83], v[136:139], a[188:191]
    v_mfma_f32_16x16x32_bf16 a[192:195], v[80:83], v[140:143], a[192:195]
    v_mfma_f32_16x16x32_bf16 a[196:199], v[80:83], v[144:147], a[196:199]
    v_mfma_f32_16x16x32_bf16 a[200:203], v[80:83], v[148:151], a[200:203]
    v_mfma_f32_16x16x32_bf16 a[204:207], v[80:83], v[152:155], a[204:207]
    v_mfma_f32_16x16x32_bf16 a[208:211], v[80:83], v[156:159], a[208:211]
    v_mfma_f32_16x16x32_bf16 a[212:215], v[80:83], v[160:163], a[212:215]
    ds_read_b64_tr_b16 v[76:77], v20 offset:16384
    ds_read_b64_tr_b16 v[78:79], v20 offset:17408
    ds_read_b64_tr_b16 v[80:81], v20 offset:24576
    ds_read_b64_tr_b16 v[82:83], v20 offset:25600
    v_mfma_f32_16x16x32_bf16 a[216:219], v[84:87], v[128:131], a[216:219]
    v_mfma_f32_16x16x32_bf16 a[220:223], v[84:87], v[132:135], a[220:223]
    v_mfma_f32_16x16x32_bf16 a[224:227], v[84:87], v[136:139], a[224:227]
    v_mfma_f32_16x16x32_bf16 a[228:231], v[84:87], v[140:143], a[228:231]
    v_mfma_f32_16x16x32_bf16 a[232:235], v[84:87], v[144:147], a[232:235]
    v_mfma_f32_16x16x32_bf16 a[236:239], v[84:87], v[148:151], a[236:239]
    v_mfma_f32_16x16x32_bf16 a[240:243], v[84:87], v[152:155], a[240:243]
    v_mfma_f32_16x16x32_bf16 a[244:247], v[84:87], v[156:159], a[244:247]
    v_mfma_f32_16x16x32_bf16 a[248:251], v[84:87], v[160:163], a[248:251]
    v_mfma_f32_16x16x32_bf16 a[252:255], v[88:91], v[128:131], a[252:255]
    v_mfma_f32_16x16x32_bf16 v[28:31], v[88:91], v[132:135], v[28:31]
    v_mfma_f32_16x16x32_bf16 v[32:35], v[88:91], v[136:139], v[32:35]
    v_mfma_f32_16x16x32_bf16 v[36:39], v[88:91], v[140:143], v[36:39]
    v_mfma_f32_16x16x32_bf16 v[40:43], v[88:91], v[144:147], v[40:43]
    v_mfma_f32_16x16x32_bf16 v[44:47], v[88:91], v[148:151], v[44:47]
    v_mfma_f32_16x16x32_bf16 v[48:51], v[88:91], v[152:155], v[48:51]
    v_mfma_f32_16x16x32_bf16 v[52:55], v[88:91], v[156:159], v[52:55]
    v_mfma_f32_16x16x32_bf16 v[56:59], v[88:91], v[160:163], v[56:59]
    ds_read_b64_tr_b16 v[84:85], v21 offset:16384
    ds_read_b64_tr_b16 v[86:87], v21 offset:17408
    ds_read_b64_tr_b16 v[88:89], v21 offset:24576
    ds_read_b64_tr_b16 v[90:91], v21 offset:25600
    s_waitcnt vmcnt(16) lgkmcnt(12)
    v_mfma_f32_16x16x32_bf16 a[0:3], v[60:63], v[164:167], a[0:3]
    buffer_load_dwordx4 v[92:95], v7, s[4:7], s48 offen
    v_mfma_f32_16x16x32_bf16 a[0:3], v[64:67], v[200:203], a[0:3]
    buffer_load_dwordx4 v[96:99], v7, s[4:7], s49 offen
    v_mfma_f32_16x16x32_bf16 a[4:7], v[60:63], v[168:171], a[4:7]
    buffer_load_dwordx4 v[100:103], v7, s[4:7], s50 offen
    v_mfma_f32_16x16x32_bf16 a[4:7], v[64:67], v[204:207], a[4:7]
    buffer_load_dwordx4 v[104:107], v7, s[4:7], s51 offen
    v_mfma_f32_16x16x32_bf16 a[8:11], v[60:63], v[172:175], a[8:11]
    buffer_load_dwordx4 v[108:111], v7, s[4:7], s52 offen
    v_mfma_f32_16x16x32_bf16 a[8:11], v[64:67], v[208:211], a[8:11]
    buffer_load_dwordx4 v[112:115], v7, s[4:7], s53 offen
    v_mfma_f32_16x16x32_bf16 a[12:15], v[60:63], v[176:179], a[12:15]
    buffer_load_dwordx4 v[116:119], v7, s[4:7], s54 offen
    v_mfma_f32_16x16x32_bf16 a[12:15], v[64:67], v[212:215], a[12:15]
    buffer_load_dwordx4 v[120:123], v7, s[4:7], s55 offen
    v_mfma_f32_16x16x32_bf16 a[16:19], v[60:63], v[180:183], a[16:19]
    buffer_load_dwordx4 v[124:127], v7, s[4:7], s56 offen
    v_mfma_f32_16x16x32_bf16 a[16:19], v[64:67], v[216:219], a[16:19]
    v_add_u32 v7, 57344, v7
    v_mfma_f32_16x16x32_bf16 a[20:23], v[60:63], v[184:187], a[20:23]
    buffer_load_dwordx4 v[128:131], v7, s[4:7], s48 offen
    v_mfma_f32_16x16x32_bf16 a[20:23], v[64:67], v[220:223], a[20:23]
    buffer_load_dwordx4 v[132:135], v7, s[4:7], s49 offen
    v_mfma_f32_16x16x32_bf16 a[24:27], v[60:63], v[188:191], a[24:27]
    buffer_load_dwordx4 v[136:139], v7, s[4:7], s50 offen
    v_mfma_f32_16x16x32_bf16 a[24:27], v[64:67], v[224:227], a[24:27]
    buffer_load_dwordx4 v[140:143], v7, s[4:7], s51 offen
    v_mfma_f32_16x16x32_bf16 a[28:31], v[60:63], v[192:195], a[28:31]
    buffer_load_dwordx4 v[144:147], v7, s[4:7], s52 offen
    v_mfma_f32_16x16x32_bf16 a[28:31], v[64:67], v[228:231], a[28:31]
    buffer_load_dwordx4 v[148:151], v7, s[4:7], s53 offen
    v_mfma_f32_16x16x32_bf16 a[32:35], v[60:63], v[196:199], a[32:35]
    buffer_load_dwordx4 v[152:155], v7, s[4:7], s54 offen
    v_mfma_f32_16x16x32_bf16 a[32:35], v[64:67], v[232:235], a[32:35]
    ds_read_b64_tr_b16 v[60:61], v22 offset:16384
    ds_read_b64_tr_b16 v[62:63], v22 offset:17408
    ds_read_b64_tr_b16 v[64:65], v22 offset:24576
    ds_read_b64_tr_b16 v[66:67], v22 offset:25600
    s_waitcnt lgkmcnt(12)
    v_mfma_f32_16x16x32_bf16 a[36:39], v[68:71], v[164:167], a[36:39]
    buffer_load_dwordx4 v[156:159], v7, s[4:7], s55 offen
    v_mfma_f32_16x16x32_bf16 a[36:39], v[72:75], v[200:203], a[36:39]
    buffer_load_dwordx4 v[160:163], v7, s[4:7], s56 offen
    v_mfma_f32_16x16x32_bf16 a[40:43], v[68:71], v[168:171], a[40:43]
    v_add_u32 v7, 57344, v7
    v_mfma_f32_16x16x32_bf16 a[40:43], v[72:75], v[204:207], a[40:43]
    v_mfma_f32_16x16x32_bf16 a[44:47], v[68:71], v[172:175], a[44:47]
    v_mfma_f32_16x16x32_bf16 a[44:47], v[72:75], v[208:211], a[44:47]
    v_mfma_f32_16x16x32_bf16 a[48:51], v[68:71], v[176:179], a[48:51]
    v_mfma_f32_16x16x32_bf16 a[48:51], v[72:75], v[212:215], a[48:51]
    v_mfma_f32_16x16x32_bf16 a[52:55], v[68:71], v[180:183], a[52:55]
    v_mfma_f32_16x16x32_bf16 a[52:55], v[72:75], v[216:219], a[52:55]
    v_mfma_f32_16x16x32_bf16 a[56:59], v[68:71], v[184:187], a[56:59]
    v_mfma_f32_16x16x32_bf16 a[56:59], v[72:75], v[220:223], a[56:59]
    v_mfma_f32_16x16x32_bf16 a[60:63], v[68:71], v[188:191], a[60:63]
    v_mfma_f32_16x16x32_bf16 a[60:63], v[72:75], v[224:227], a[60:63]
    v_mfma_f32_16x16x32_bf16 a[64:67], v[68:71], v[192:195], a[64:67]
    v_mfma_f32_16x16x32_bf16 a[64:67], v[72:75], v[228:231], a[64:67]
    v_mfma_f32_16x16x32_bf16 a[68:71], v[68:71], v[196:199], a[68:71]
    v_mfma_f32_16x16x32_bf16 a[68:71], v[72:75], v[232:235], a[68:71]
    ds_read_b64_tr_b16 v[68:69], v23 offset:16384
    ds_read_b64_tr_b16 v[70:71], v23 offset:17408
    ds_read_b64_tr_b16 v[72:73], v23 offset:24576
    ds_read_b64_tr_b16 v[74:75], v23 offset:25600
    s_waitcnt lgkmcnt(12)
    v_mfma_f32_16x16x32_bf16 a[72:75], v[76:79], v[164:167], a[72:75]
    v_mfma_f32_16x16x32_bf16 a[72:75], v[80:83], v[200:203], a[72:75]
    v_mfma_f32_16x16x32_bf16 a[76:79], v[76:79], v[168:171], a[76:79]
    v_mfma_f32_16x16x32_bf16 a[76:79], v[80:83], v[204:207], a[76:79]
    v_mfma_f32_16x16x32_bf16 a[80:83], v[76:79], v[172:175], a[80:83]
    v_mfma_f32_16x16x32_bf16 a[80:83], v[80:83], v[208:211], a[80:83]
    v_mfma_f32_16x16x32_bf16 a[84:87], v[76:79], v[176:179], a[84:87]
    v_mfma_f32_16x16x32_bf16 a[84:87], v[80:83], v[212:215], a[84:87]
    v_mfma_f32_16x16x32_bf16 a[88:91], v[76:79], v[180:183], a[88:91]
    v_mfma_f32_16x16x32_bf16 a[88:91], v[80:83], v[216:219], a[88:91]
    v_mfma_f32_16x16x32_bf16 a[92:95], v[76:79], v[184:187], a[92:95]
    v_mfma_f32_16x16x32_bf16 a[92:95], v[80:83], v[220:223], a[92:95]
    v_mfma_f32_16x16x32_bf16 a[96:99], v[76:79], v[188:191], a[96:99]
    v_mfma_f32_16x16x32_bf16 a[96:99], v[80:83], v[224:227], a[96:99]
    v_mfma_f32_16x16x32_bf16 a[100:103], v[76:79], v[192:195], a[100:103]
    v_mfma_f32_16x16x32_bf16 a[100:103], v[80:83], v[228:231], a[100:103]
    v_mfma_f32_16x16x32_bf16 a[104:107], v[76:79], v[196:199], a[104:107]
    v_mfma_f32_16x16x32_bf16 a[104:107], v[80:83], v[232:235], a[104:107]
    ds_read_b64_tr_b16 v[76:77], v24 offset:16384
    ds_read_b64_tr_b16 v[78:79], v24 offset:17408
    ds_read_b64_tr_b16 v[80:81], v24 offset:24576
    ds_read_b64_tr_b16 v[82:83], v24 offset:25600
    s_waitcnt lgkmcnt(12)
    v_mfma_f32_16x16x32_bf16 a[108:111], v[84:87], v[164:167], a[108:111]
    v_mfma_f32_16x16x32_bf16 a[108:111], v[88:91], v[200:203], a[108:111]
    v_mfma_f32_16x16x32_bf16 a[112:115], v[84:87], v[168:171], a[112:115]
    v_mfma_f32_16x16x32_bf16 a[112:115], v[88:91], v[204:207], a[112:115]
    v_mfma_f32_16x16x32_bf16 a[116:119], v[84:87], v[172:175], a[116:119]
    v_mfma_f32_16x16x32_bf16 a[116:119], v[88:91], v[208:211], a[116:119]
    v_mfma_f32_16x16x32_bf16 a[120:123], v[84:87], v[176:179], a[120:123]
    v_mfma_f32_16x16x32_bf16 a[120:123], v[88:91], v[212:215], a[120:123]
    v_mfma_f32_16x16x32_bf16 a[124:127], v[84:87], v[180:183], a[124:127]
    v_mfma_f32_16x16x32_bf16 a[124:127], v[88:91], v[216:219], a[124:127]
    v_mfma_f32_16x16x32_bf16 a[128:131], v[84:87], v[184:187], a[128:131]
    v_mfma_f32_16x16x32_bf16 a[128:131], v[88:91], v[220:223], a[128:131]
    v_mfma_f32_16x16x32_bf16 a[132:135], v[84:87], v[188:191], a[132:135]
    v_mfma_f32_16x16x32_bf16 a[132:135], v[88:91], v[224:227], a[132:135]
    v_mfma_f32_16x16x32_bf16 a[136:139], v[84:87], v[192:195], a[136:139]
    v_mfma_f32_16x16x32_bf16 a[136:139], v[88:91], v[228:231], a[136:139]
    v_mfma_f32_16x16x32_bf16 a[140:143], v[84:87], v[196:199], a[140:143]
    v_mfma_f32_16x16x32_bf16 a[140:143], v[88:91], v[232:235], a[140:143]
    ds_read_b64_tr_b16 v[84:85], v25 offset:16384
    ds_read_b64_tr_b16 v[86:87], v25 offset:17408
    ds_read_b64_tr_b16 v[88:89], v25 offset:24576
    ds_read_b64_tr_b16 v[90:91], v25 offset:25600
    s_waitcnt lgkmcnt(12)
    v_mfma_f32_16x16x32_bf16 a[144:147], v[60:63], v[164:167], a[144:147]
    v_mfma_f32_16x16x32_bf16 a[144:147], v[64:67], v[200:203], a[144:147]
    v_mfma_f32_16x16x32_bf16 a[148:151], v[60:63], v[168:171], a[148:151]
    v_mfma_f32_16x16x32_bf16 a[148:151], v[64:67], v[204:207], a[148:151]
    v_mfma_f32_16x16x32_bf16 a[152:155], v[60:63], v[172:175], a[152:155]
    v_mfma_f32_16x16x32_bf16 a[152:155], v[64:67], v[208:211], a[152:155]
    v_mfma_f32_16x16x32_bf16 a[156:159], v[60:63], v[176:179], a[156:159]
    v_mfma_f32_16x16x32_bf16 a[156:159], v[64:67], v[212:215], a[156:159]
    v_mfma_f32_16x16x32_bf16 a[160:163], v[60:63], v[180:183], a[160:163]
    v_mfma_f32_16x16x32_bf16 a[160:163], v[64:67], v[216:219], a[160:163]
    v_mfma_f32_16x16x32_bf16 a[164:167], v[60:63], v[184:187], a[164:167]
    v_mfma_f32_16x16x32_bf16 a[164:167], v[64:67], v[220:223], a[164:167]
    v_mfma_f32_16x16x32_bf16 a[168:171], v[60:63], v[188:191], a[168:171]
    v_mfma_f32_16x16x32_bf16 a[168:171], v[64:67], v[224:227], a[168:171]
    v_mfma_f32_16x16x32_bf16 a[172:175], v[60:63], v[192:195], a[172:175]
    v_mfma_f32_16x16x32_bf16 a[172:175], v[64:67], v[228:231], a[172:175]
    v_mfma_f32_16x16x32_bf16 a[176:179], v[60:63], v[196:199], a[176:179]
    v_mfma_f32_16x16x32_bf16 a[176:179], v[64:67], v[232:235], a[176:179]
    s_waitcnt vmcnt(18)
    ds_read_b64_tr_b16 v[60:61], v18 offset:0
    ds_read_b64_tr_b16 v[62:63], v18 offset:1024
    ds_read_b64_tr_b16 v[64:65], v18 offset:8192
    ds_read_b64_tr_b16 v[66:67], v18 offset:9216
    s_waitcnt lgkmcnt(4)
    v_mfma_f32_16x16x32_bf16 a[180:183], v[68:71], v[164:167], a[180:183]
    s_add_u32 m0, s27, 16384
    v_mfma_f32_16x16x32_bf16 a[180:183], v[72:75], v[200:203], a[180:183]
    s_nop 0
    v_mfma_f32_16x16x32_bf16 a[184:187], v[68:71], v[168:171], a[184:187]
    buffer_load_dwordx4 v10, s[8:11], s26 offen offset:0 lds
    v_mfma_f32_16x16x32_bf16 a[184:187], v[72:75], v[204:207], a[184:187]
    buffer_load_dwordx4 v11, s[8:11], s26 offen offset:1024 lds
    v_mfma_f32_16x16x32_bf16 a[188:191], v[68:71], v[172:175], a[188:191]
    buffer_load_dwordx4 v12, s[8:11], s26 offen offset:2048 lds
    v_mfma_f32_16x16x32_bf16 a[188:191], v[72:75], v[208:211], a[188:191]
    buffer_load_dwordx4 v13, s[8:11], s26 offen offset:3072 lds
    v_mfma_f32_16x16x32_bf16 a[192:195], v[68:71], v[176:179], a[192:195]
    s_add_u32 m0, s27, 20480
    v_mfma_f32_16x16x32_bf16 a[192:195], v[72:75], v[212:215], a[192:195]
    s_nop 0
    v_mfma_f32_16x16x32_bf16 a[196:199], v[68:71], v[180:183], a[196:199]
    buffer_load_dwordx4 v14, s[8:11], s26 offen offset:0 lds
    v_mfma_f32_16x16x32_bf16 a[196:199], v[72:75], v[216:219], a[196:199]
    buffer_load_dwordx4 v15, s[8:11], s26 offen offset:1024 lds
    v_mfma_f32_16x16x32_bf16 a[200:203], v[68:71], v[184:187], a[200:203]
    buffer_load_dwordx4 v16, s[8:11], s26 offen offset:2048 lds
    v_mfma_f32_16x16x32_bf16 a[200:203], v[72:75], v[220:223], a[200:203]
    buffer_load_dwordx4 v17, s[8:11], s26 offen offset:3072 lds
    v_mfma_f32_16x16x32_bf16 a[204:207], v[68:71], v[188:191], a[204:207]
    s_add_u32 s26, s26, 163840
    v_mfma_f32_16x16x32_bf16 a[204:207], v[72:75], v[224:227], a[204:207]
    s_add_u32 m0, s27, 24576
    v_mfma_f32_16x16x32_bf16 a[208:211], v[68:71], v[192:195], a[208:211]
    s_nop 0
    v_mfma_f32_16x16x32_bf16 a[208:211], v[72:75], v[228:231], a[208:211]
    buffer_load_dwordx4 v10, s[8:11], s26 offen offset:0 lds
    v_mfma_f32_16x16x32_bf16 a[212:215], v[68:71], v[196:199], a[212:215]
    buffer_load_dwordx4 v11, s[8:11], s26 offen offset:1024 lds
    v_mfma_f32_16x16x32_bf16 a[212:215], v[72:75], v[232:235], a[212:215]
    ds_read_b64_tr_b16 v[68:69], v19 offset:0
    ds_read_b64_tr_b16 v[70:71], v19 offset:1024
    ds_read_b64_tr_b16 v[72:73], v19 offset:8192
    ds_read_b64_tr_b16 v[74:75], v19 offset:9216
    s_waitcnt lgkmcnt(12)
    v_mfma_f32_16x16x32_bf16 a[216:219], v[76:79], v[164:167], a[216:219]
    buffer_load_dwordx4 v12, s[8:11], s26 offen offset:2048 lds
    v_mfma_f32_16x16x32_bf16 a[216:219], v[80:83], v[200:203], a[216:219]
    buffer_load_dwordx4 v13, s[8:11], s26 offen offset:3072 lds
    v_mfma_f32_16x16x32_bf16 a[220:223], v[76:79], v[168:171], a[220:223]
    s_add_u32 m0, s27, 28672
    v_mfma_f32_16x16x32_bf16 a[220:223], v[80:83], v[204:207], a[220:223]
    s_nop 0
    v_mfma_f32_16x16x32_bf16 a[224:227], v[76:79], v[172:175], a[224:227]
    buffer_load_dwordx4 v14, s[8:11], s26 offen offset:0 lds
    v_mfma_f32_16x16x32_bf16 a[224:227], v[80:83], v[208:211], a[224:227]
    buffer_load_dwordx4 v15, s[8:11], s26 offen offset:1024 lds
    v_mfma_f32_16x16x32_bf16 a[228:231], v[76:79], v[176:179], a[228:231]
    buffer_load_dwordx4 v16, s[8:11], s26 offen offset:2048 lds
    v_mfma_f32_16x16x32_bf16 a[228:231], v[80:83], v[212:215], a[228:231]
    buffer_load_dwordx4 v17, s[8:11], s26 offen offset:3072 lds
    v_mfma_f32_16x16x32_bf16 a[232:235], v[76:79], v[180:183], a[232:235]
    s_add_u32 s26, s26, 163840
    v_mfma_f32_16x16x32_bf16 a[232:235], v[80:83], v[216:219], a[232:235]
    v_mfma_f32_16x16x32_bf16 a[236:239], v[76:79], v[184:187], a[236:239]
    v_mfma_f32_16x16x32_bf16 a[236:239], v[80:83], v[220:223], a[236:239]
    v_mfma_f32_16x16x32_bf16 a[240:243], v[76:79], v[188:191], a[240:243]
    v_mfma_f32_16x16x32_bf16 a[240:243], v[80:83], v[224:227], a[240:243]
    v_mfma_f32_16x16x32_bf16 a[244:247], v[76:79], v[192:195], a[244:247]
    v_mfma_f32_16x16x32_bf16 a[244:247], v[80:83], v[228:231], a[244:247]
    v_mfma_f32_16x16x32_bf16 a[248:251], v[76:79], v[196:199], a[248:251]
    v_mfma_f32_16x16x32_bf16 a[248:251], v[80:83], v[232:235], a[248:251]
    ds_read_b64_tr_b16 v[76:77], v20 offset:0
    ds_read_b64_tr_b16 v[78:79], v20 offset:1024
    ds_read_b64_tr_b16 v[80:81], v20 offset:8192
    ds_read_b64_tr_b16 v[82:83], v20 offset:9216
    s_waitcnt lgkmcnt(12)
    v_mfma_f32_16x16x32_bf16 a[252:255], v[84:87], v[164:167], a[252:255]
    v_mfma_f32_16x16x32_bf16 a[252:255], v[88:91], v[200:203], a[252:255]
    v_mfma_f32_16x16x32_bf16 v[28:31], v[84:87], v[168:171], v[28:31]
    v_mfma_f32_16x16x32_bf16 v[28:31], v[88:91], v[204:207], v[28:31]
    v_mfma_f32_16x16x32_bf16 v[32:35], v[84:87], v[172:175], v[32:35]
    v_mfma_f32_16x16x32_bf16 v[32:35], v[88:91], v[208:211], v[32:35]
    v_mfma_f32_16x16x32_bf16 v[36:39], v[84:87], v[176:179], v[36:39]
    v_mfma_f32_16x16x32_bf16 v[36:39], v[88:91], v[212:215], v[36:39]
    v_mfma_f32_16x16x32_bf16 v[40:43], v[84:87], v[180:183], v[40:43]
    v_mfma_f32_16x16x32_bf16 v[40:43], v[88:91], v[216:219], v[40:43]
    v_mfma_f32_16x16x32_bf16 v[44:47], v[84:87], v[184:187], v[44:47]
    v_mfma_f32_16x16x32_bf16 v[44:47], v[88:91], v[220:223], v[44:47]
    v_mfma_f32_16x16x32_bf16 v[48:51], v[84:87], v[188:191], v[48:51]
    v_mfma_f32_16x16x32_bf16 v[48:51], v[88:91], v[224:227], v[48:51]
    v_mfma_f32_16x16x32_bf16 v[52:55], v[84:87], v[192:195], v[52:55]
    v_mfma_f32_16x16x32_bf16 v[52:55], v[88:91], v[228:231], v[52:55]
    v_mfma_f32_16x16x32_bf16 v[56:59], v[84:87], v[196:199], v[56:59]
    v_mfma_f32_16x16x32_bf16 v[56:59], v[88:91], v[232:235], v[56:59]
    ds_read_b64_tr_b16 v[84:85], v21 offset:0
    ds_read_b64_tr_b16 v[86:87], v21 offset:1024
    ds_read_b64_tr_b16 v[88:89], v21 offset:8192
    ds_read_b64_tr_b16 v[90:91], v21 offset:9216
    s_mov_b32 s21, 0
L_op_loop:
    s_waitcnt vmcnt(16) lgkmcnt(12)
    v_mfma_f32_16x16x32_bf16 a[0:3], v[60:63], v[92:95], a[0:3]
    buffer_load_dwordx4 v[164:167], v7, s[4:7], s48 offen
    v_mfma_f32_16x16x32_bf16 a[0:3], v[64:67], v[128:131], a[0:3]
    buffer_load_dwordx4 v[168:171], v7, s[4:7], s49 offen
    v_mfma_f32_16x16x32_bf16 a[4:7], v[60:63], v[96:99], a[4:7]
    buffer_load_dwordx4 v[172:175], v7, s[4:7], s50 offen
    v_mfma_f32_16x16x32_bf16 a[4:7], v[64:67], v[132:135], a[4:7]
    buffer_load_dwordx4 v[176:179], v7, s[4:7], s51 offen
    v_mfma_f32_16x16x32_bf16 a[8:11], v[60:63], v[100:103], a[8:11]
    buffer_load_dwordx4 v[180:183], v7, s[4:7], s52 offen
    v_mfma_f32_16x16x32_bf16 a[8:11], v[64:67], v[136:139], a[8:11]
    buffer_load_dwordx4 v[184:187], v7, s[4:7], s53 offen
    v_mfma_f32_16x16x32_bf16 a[12:15], v[60:63], v[104:107], a[12:15]
    buffer_load_dwordx4 v[188:191], v7, s[4:7], s54 offen
    v_mfma_f32_16x16x32_bf16 a[12:15], v[64:67], v[140:143], a[12:15]
    buffer_load_dwordx4 v[192:195], v7, s[4:7], s55 offen
    v_mfma_f32_16x16x32_bf16 a[16:19], v[60:63], v[108:111], a[16:19]
    buffer_load_dwordx4 v[196:199], v7, s[4:7], s56 offen
    v_mfma_f32_16x16x32_bf16 a[16:19], v[64:67], v[144:147], a[16:19]
    v_add_u32 v7, 57344, v7
    v_mfma_f32_16x16x32_bf16 a[20:23], v[60:63], v[112:115], a[20:23]
    buffer_load_dwordx4 v[200:203], v7, s[4:7], s48 offen
    v_mfma_f32_16x16x32_bf16 a[20:23], v[64:67], v[148:151], a[20:23]
    buffer_load_dwordx4 v[204:207], v7, s[4:7], s49 offen
    v_mfma_f32_16x16x32_bf16 a[24:27], v[60:63], v[116:119], a[24:27]
    buffer_load_dwordx4 v[208:211], v7, s[4:7], s50 offen
    v_mfma_f32_16x16x32_bf16 a[24:27], v[64:67], v[152:155], a[24:27]
    buffer_load_dwordx4 v[212:215], v7, s[4:7], s51 offen
    v_mfma_f32_16x16x32_bf16 a[28:31], v[60:63], v[120:123], a[28:31]
    buffer_load_dwordx4 v[216:219], v7, s[4:7], s52 offen
    v_mfma_f32_16x16x32_bf16 a[28:31], v[64:67], v[156:159], a[28:31]
    buffer_load_dwordx4 v[220:223], v7, s[4:7], s53 offen
    v_mfma_f32_16x16x32_bf16 a[32:35], v[60:63], v[124:127], a[32:35]
    buffer_load_dwordx4 v[224:227], v7, s[4:7], s54 offen
    v_mfma_f32_16x16x32_bf16 a[32:35], v[64:67], v[160:163], a[32:35]
    ds_read_b64_tr_b16 v[60:61], v22 offset:0
    ds_read_b64_tr_b16 v[62:63], v22 offset:1024
    ds_read_b64_tr_b16 v[64:65], v22 offset:8192
    ds_read_b64_tr_b16 v[66:67], v22 offset:9216
    s_waitcnt lgkmcnt(12)
    v_mfma_f32_16x16x32_bf16 a[36:39], v[68:71], v[92:95], a[36:39]
    buffer_load_dwordx4 v[228:231], v7, s[4:7], s55 offen
    v_mfma_f32_16x16x32_bf16 a[36:39], v[72:75], v[128:131], a[36:39]
    buffer_load_dwordx4 v[232:235], v7, s[4:7], s56 offen
    v_mfma_f32_16x16x32_bf16 a[40:43], v[68:71], v[96:99], a[40:43]
    v_add_u32 v7, 57344, v7
    v_mfma_f32_16x16x32_bf16 a[40:43], v[72:75], v[132:135], a[40:43]
    v_mfma_f32_16x16x32_bf16 a[44:47], v[68:71], v[100:103], a[44:47]
    v_mfma_f32_16x16x32_bf16 a[44:47], v[72:75], v[136:139], a[44:47]
    v_mfma_f32_16x16x32_bf16 a[48:51], v[68:71], v[104:107], a[48:51]
    v_mfma_f32_16x16x32_bf16 a[48:51], v[72:75], v[140:143], a[48:51]
    v_mfma_f32_16x16x32_bf16 a[52:55], v[68:71], v[108:111], a[52:55]
    v_mfma_f32_16x16x32_bf16 a[52:55], v[72:75], v[144:147], a[52:55]
    v_mfma_f32_16x16x32_bf16 a[56:59], v[68:71], v[112:115], a[56:59]
    v_mfma_f32_16x16x32_bf16 a[56:59], v[72:75], v[148:151], a[56:59]
    v_mfma_f32_16x16x32_bf16 a[60:63], v[68:71], v[116:119], a[60:63]
    v_mfma_f32_16x16x32_bf16 a[60:63], v[72:75], v[152:155], a[60:63]
    v_mfma_f32_16x16x32_bf16 a[64:67], v[68:71], v[120:123], a[64:67]
    v_mfma_f32_16x16x32_bf16 a[64:67], v[72:75], v[156:159], a[64:67]
    v_mfma_f32_16x16x32_bf16 a[68:71], v[68:71], v[124:127], a[68:71]
    v_mfma_f32_16x16x32_bf16 a[68:71], v[72:75], v[160:163], a[68:71]
    ds_read_b64_tr_b16 v[68:69], v23 offset:0
    ds_read_b64_tr_b16 v[70:71], v23 offset:1024
    ds_read_b64_tr_b16 v[72:73], v23 offset:8192
    ds_read_b64_tr_b16 v[74:75], v23 offset:9216
    s_waitcnt lgkmcnt(12)
    v_mfma_f32_16x16x32_bf16 a[72:75], v[76:79], v[92:95], a[72:75]
    v_mfma_f32_16x16x32_bf16 a[72:75], v[80:83], v[128:131], a[72:75]
    v_mfma_f32_16x16x32_bf16 a[76:79], v[76:79], v[96:99], a[76:79]
    v_mfma_f32_16x16x32_bf16 a[76:79], v[80:83], v[132:135], a[76:79]
    v_mfma_f32_16x16x32_bf16 a[80:83], v[76:79], v[100:103], a[80:83]
    v_mfma_f32_16x16x32_bf16 a[80:83], v[80:83], v[136:139], a[80:83]
    v_mfma_f32_16x16x32_bf16 a[84:87], v[76:79], v[104:107], a[84:87]
    v_mfma_f32_16x16x32_bf16 a[84:87], v[80:83], v[140:143], a[84:87]
    v_mfma_f32_16x16x32_bf16 a[88:91], v[76:79], v[108:111], a[88:91]
    v_mfma_f32_16x16x32_bf16 a[88:91], v[80:83], v[144:147], a[88:91]
    v_mfma_f32_16x16x32_bf16 a[92:95], v[76:79], v[112:115], a[92:95]
    v_mfma_f32_16x16x32_bf16 a[92:95], v[80:83], v[148:151], a[92:95]
    v_mfma_f32_16x16x32_bf16 a[96:99], v[76:79], v[116:119], a[96:99]
    v_mfma_f32_16x16x32_bf16 a[96:99], v[80:83], v[152:155], a[96:99]
    v_mfma_f32_16x16x32_bf16 a[100:103], v[76:79], v[120:123], a[100:103]
    v_mfma_f32_16x16x32_bf16 a[100:103], v[80:83], v[156:159], a[100:103]
    v_mfma_f32_16x16x32_bf16 a[104:107], v[76:79], v[124:127], a[104:107]
    v_mfma_f32_16x16x32_bf16 a[104:107], v[80:83], v[160:163], a[104:107]
    ds_read_b64_tr_b16 v[76:77], v24 offset:0
    ds_read_b64_tr_b16 v[78:79], v24 offset:1024
    ds_read_b64_tr_b16 v[80:81], v24 offset:8192
    ds_read_b64_tr_b16 v[82:83], v24 offset:9216
    s_waitcnt lgkmcnt(12)
    v_mfma_f32_16x16x32_bf16 a[108:111], v[84:87], v[92:95], a[108:111]
    v_mfma_f32_16x16x32_bf16 a[108:111], v[88:91], v[128:131], a[108:111]
    v_mfma_f32_16x16x32_bf16 a[112:115], v[84:87], v[96:99], a[112:115]
    v_mfma_f32_16x16x32_bf16 a[112:115], v[88:91], v[132:135], a[112:115]
    v_mfma_f32_16x16x32_bf16 a[116:119], v[84:87], v[100:103], a[116:119]
    v_mfma_f32_16x16x32_bf16 a[116:119], v[88:91], v[136:139], a[116:119]
    v_mfma_f32_16x16x32_bf16 a[120:123], v[84:87], v[104:107], a[120:123]
    v_mfma_f32_16x16x32_bf16 a[120:123], v[88:91], v[140:143], a[120:123]
    v_mfma_f32_16x16x32_bf16 a[124:127], v[84:87], v[108:111], a[124:127]
    v_mfma_f32_16x16x32_bf16 a[124:127], v[88:91], v[144:147], a[124:127]
    v_mfma_f32_16x16x32_bf16 a[128:131], v[84:87], v[112:115], a[128:131]
    v_mfma_f32_16x16x32_bf16 a[128:131], v[88:91], v[148:151], a[128:131]
    v_mfma_f32_16x16x32_bf16 a[132:135], v[84:87], v[116:119], a[132:135]
    v_mfma_f32_16x16x32_bf16 a[132:135], v[88:91], v[152:155], a[132:135]
    v_mfma_f32_16x16x32_bf16 a[136:139], v[84:87], v[120:123], a[136:139]
    v_mfma_f32_16x16x32_bf16 a[136:139], v[88:91], v[156:159], a[136:139]
    v_mfma_f32_16x16x32_bf16 a[140:143], v[84:87], v[124:127], a[140:143]
    v_mfma_f32_16x16x32_bf16 a[140:143], v[88:91], v[160:163], a[140:143]
    ds_read_b64_tr_b16 v[84:85], v25 offset:0
    ds_read_b64_tr_b16 v[86:87], v25 offset:1024
    ds_read_b64_tr_b16 v[88:89], v25 offset:8192
    ds_read_b64_tr_b16 v[90:91], v25 offset:9216
    s_waitcnt lgkmcnt(12)
    v_mfma_f32_16x16x32_bf16 a[144:147], v[60:63], v[92:95], a[144:147]
    v_mfma_f32_16x16x32_bf16 a[144:147], v[64:67], v[128:131], a[144:147]
    v_mfma_f32_16x16x32_bf16 a[148:151], v[60:63], v[96:99], a[148:151]
    v_mfma_f32_16x16x32_bf16 a[148:151], v[64:67], v[132:135], a[148:151]
    v_mfma_f32_16x16x32_bf16 a[152:155], v[60:63], v[100:103], a[152:155]
    v_mfma_f32_16x16x32_bf16 a[152:155], v[64:67], v[136:139], a[152:155]
    v_mfma_f32_16x16x32_bf16 a[156:159], v[60:63], v[104:107], a[156:159]
    v_mfma_f32_16x16x32_bf16 a[156:159], v[64:67], v[140:143], a[156:159]
    v_mfma_f32_16x16x32_bf16 a[160:163], v[60:63], v[108:111], a[160:163]
    v_mfma_f32_16x16x32_bf16 a[160:163], v[64:67], v[144:147], a[160:163]
    v_mfma_f32_16x16x32_bf16 a[164:167], v[60:63], v[112:115], a[164:167]
    v_mfma_f32_16x16x32_bf16 a[164:167], v[64:67], v[148:151], a[164:167]
    v_mfma_f32_16x16x32_bf16 a[168:171], v[60:63], v[116:119], a[168:171]
    v_mfma_f32_16x16x32_bf16 a[168:171], v[64:67], v[152:155], a[168:171]
    v_mfma_f32_16x16x32_bf16 a[172:175], v[60:63], v[120:123], a[172:175]
    v_mfma_f32_16x16x32_bf16 a[172:175], v[64:67], v[156:159], a[172:175]
    v_mfma_f32_16x16x32_bf16 a[176:179], v[60:63], v[124:127], a[176:179]
    v_mfma_f32_16x16x32_bf16 a[176:179], v[64:67], v[160:163], a[176:179]
    s_waitcnt vmcnt(18)
    ds_read_b64_tr_b16 v[60:61], v18 offset:16384
    ds_read_b64_tr_b16 v[62:63], v18 offset:17408
    ds_read_b64_tr_b16 v[64:65], v18 offset:24576
    ds_read_b64_tr_b16 v[66:67], v18 offset:25600
    s_waitcnt lgkmcnt(4)
    v_mfma_f32_16x16x32_bf16 a[180:183], v[68:71], v[92:95], a[180:183]
    s_add_u32 m0, s27, 0
    v_mfma_f32_16x16x32_bf16 a[180:183], v[72:75], v[128:131], a[180:183]
    s_nop 0
    v_mfma_f32_16x16x32_bf16 a[184:187], v[68:71], v[96:99], a[184:187]
    buffer_load_dwordx4 v10, s[8:11], s26 offen offset:0 lds
    v_mfma_f32_16x16x32_bf16 a[184:187], v[72:75], v[132:135], a[184:187]
    buffer_load_dwordx4 v11, s[8:11], s26 offen offset:1024 lds
    v_mfma_f32_16x16x32_bf16 a[188:191], v[68:71], v[100:103], a[188:191]
    buffer_load_dwordx4 v12, s[8:11], s26 offen offset:2048 lds
    v_mfma_f32_16x16x32_bf16 a[188:191], v[72:75], v[136:139], a[188:191]
    buffer_load_dwordx4 v13, s[8:11], s26 offen offset:3072 lds
    v_mfma_f32_16x16x32_bf16 a[192:195], v[68:71], v[104:107], a[192:195]
    s_add_u32 m0, s27, 4096
    v_mfma_f32_16x16x32_bf16 a[192:195], v[72:75], v[140:143], a[192:195]
    s_nop 0
    v_mfma_f32_16x16x32_bf16 a[196:199], v[68:71], v[108:111], a[196:199]
    buffer_load_dwordx4 v14, s[8:11], s26 offen offset:0 lds
    v_mfma_f32_16x16x32_bf16 a[196:199], v[72:75], v[144:147], a[196:199]
    buffer_load_dwordx4 v15, s[8:11], s26 offen offset:1024 lds
    v_mfma_f32_16x16x32_bf16 a[200:203], v[68:71], v[112:115], a[200:203]
    buffer_load_dwordx4 v16, s[8:11], s26 offen offset:2048 lds
    v_mfma_f32_16x16x32_bf16 a[200:203], v[72:75], v[148:151], a[200:203]
    buffer_load_dwordx4 v17, s[8:11], s26 offen offset:3072 lds
    v_mfma_f32_16x16x32_bf16 a[204:207], v[68:71], v[116:119], a[204:207]
    s_add_u32 s26, s26, 163840
    v_mfma_f32_16x16x32_bf16 a[204:207], v[72:75], v[152:155], a[204:207]
    s_add_u32 m0, s27, 8192
    v_mfma_f32_16x16x32_bf16 a[208:211], v[68:71], v[120:123], a[208:211]
    s_nop 0
    v_mfma_f32_16x16x32_bf16 a[208:211], v[72:75], v[156:159], a[208:211]
    buffer_load_dwordx4 v10, s[8:11], s26 offen offset:0 lds
    v_mfma_f32_16x16x32_bf16 a[212:215], v[68:71], v[124:127], a[212:215]
    buffer_load_dwordx4 v11, s[8:11], s26 offen offset:1024 lds
    v_mfma_f32_16x16x32_bf16 a[212:215], v[72:75], v[160:163], a[212:215]
    ds_read_b64_tr_b16 v[68:69], v19 offset:16384
    ds_read_b64_tr_b16 v[70:71], v19 offset:17408
    ds_read_b64_tr_b16 v[72:73], v19 offset:24576
    ds_read_b64_tr_b16 v[74:75], v19 offset:25600
    s_waitcnt lgkmcnt(12)
    v_mfma_f32_16x16x32_bf16 a[216:219], v[76:79], v[92:95], a[216:219]
    buffer_load_dwordx4 v12, s[8:11], s26 offen offset:2048 lds
    v_mfma_f32_16x16x32_bf16 a[216:219], v[80:83], v[128:131], a[216:219]
    buffer_load_dwordx4 v13, s[8:11], s26 offen offset:3072 lds
    v_mfma_f32_16x16x32_bf16 a[220:223], v[76:79], v[96:99], a[220:223]
    s_add_u32 m0, s27, 12288
    v_mfma_f32_16x16x32_bf16 a[220:223], v[80:83], v[132:135], a[220:223]
    s_nop 0
    v_mfma_f32_16x16x32_bf16 a[224:227], v[76:79], v[100:103], a[224:227]
    buffer_load_dwordx4 v14, s[8:11], s26 offen offset:0 lds
    v_mfma_f32_16x16x32_bf16 a[224:227], v[80:83], v[136:139], a[224:227]
    buffer_load_dwordx4 v15, s[8:11], s26 offen offset:1024 lds
    v_mfma_f32_16x16x32_bf16 a[228:231], v[76:79], v[104:107], a[228:231]
    buffer_load_dwordx4 v16, s[8:11], s26 offen offset:2048 lds
    v_mfma_f32_16x16x32_bf16 a[228:231], v[80:83], v[140:143], a[228:231]
    buffer_load_dwordx4 v17, s[8:11], s26 offen offset:3072 lds
    v_mfma_f32_16x16x32_bf16 a[232:235], v[76:79], v[108:111], a[232:235]
    s_add_u32 s26, s26, 163840
    v_mfma_f32_16x16x32_bf16 a[232:235], v[80:83], v[144:147], a[232:235]
    v_mfma_f32_16x16x32_bf16 a[236:239], v[76:79], v[112:115], a[236:239]
    v_mfma_f32_16x16x32_bf16 a[236:239], v[80:83], v[148:151], a[236:239]
    v_mfma_f32_16x16x32_bf16 a[240:243], v[76:79], v[116:119], a[240:243]
    v_mfma_f32_16x16x32_bf16 a[240:243], v[80:83], v[152:155], a[240:243]
    v_mfma_f32_16x16x32_bf16 a[244:247], v[76:79], v[120:123], a[244:247]
    v_mfma_f32_16x16x32_bf16 a[244:247], v[80:83], v[156:159], a[244:247]
    v_mfma_f32_16x16x32_bf16 a[248:251], v[76:79], v[124:127], a[248:251]
    v_mfma_f32_16x16x32_bf16 a[248:251], v[80:83], v[160:163], a[248:251]
    ds_read_b64_tr_b16 v[76:77], v20 offset:16384
    ds_read_b64_tr_b16 v[78:79], v20 offset:17408
    ds_read_b64_tr_b16 v[80:81], v20 offset:24576
    ds_read_b64_tr_b16 v[82:83], v20 offset:25600
    s_waitcnt lgkmcnt(12)
    v_mfma_f32_16x16x32_bf16 a[252:255], v[84:87], v[92:95], a[252:255]
    v_mfma_f32_16x16x32_bf16 a[252:255], v[88:91], v[128:131], a[252:255]
    v_mfma_f32_16x16x32_bf16 v[28:31], v[84:87], v[96:99], v[28:31]
    v_mfma_f32_16x16x32_bf16 v[28:31], v[88:91], v[132:135], v[28:31]
    v_mfma_f32_16x16x32_bf16 v[32:35], v[84:87], v[100:103], v[32:35]
    v_mfma_f32_16x16x32_bf16 v[32:35], v[88:91], v[136:139], v[32:35]
    v_mfma_f32_16x16x32_bf16 v[36:39], v[84:87], v[104:107], v[36:39]
    v_mfma_f32_16x16x32_bf16 v[36:39], v[88:91], v[140:143], v[36:39]
    v_mfma_f32_16x16x32_bf16 v[40:43], v[84:87], v[108:111], v[40:43]
    v_mfma_f32_16x16x32_bf16 v[40:43], v[88:91], v[144:147], v[40:43]
    v_mfma_f32_16x16x32_bf16 v[44:47], v[84:87], v[112:115], v[44:47]
    v_mfma_f32_16x16x32_bf16 v[44:47], v[88:91], v[148:151], v[44:47]
    v_mfma_f32_16x16x32_bf16 v[48:51], v[84:87], v[116:119], v[48:51]
    v_mfma_f32_16x16x32_bf16 v[48:51], v[88:91], v[152:155], v[48:51]
    v_mfma_f32_16x16x32_bf16 v[52:55], v[84:87], v[120:123], v[52:55]
    v_mfma_f32_16x16x32_bf16 v[52:55], v[88:91], v[156:159], v[52:55]
    v_mfma_f32_16x16x32_bf16 v[56:59], v[84:87], v[124:127], v[56:59]
    v_mfma_f32_16x16x32_bf16 v[56:59], v[88:91], v[160:163], v[56:59]
    ds_read_b64_tr_b16 v[84:85], v21 offset:16384
    ds_read_b64_tr_b16 v[86:87], v21 offset:17408
    ds_read_b64_tr_b16 v[88:89], v21 offset:24576
    ds_read_b64_tr_b16 v[90:91], v21 offset:25600
    s_waitcnt vmcnt(16) lgkmcnt(12)
    v_mfma_f32_16x16x32_bf16 a[0:3], v[60:63], v[164:167], a[0:3]
    buffer_load_dwordx4 v[92:95], v7, s[4:7], s48 offen
    v_mfma_f32_16x16x32_bf16 a[0:3], v[64:67], v[200:203], a[0:3]
    buffer_load_dwordx4 v[96:99], v7, s[4:7], s49 offen
    v_mfma_f32_16x16x32_bf16 a[4:7], v[60:63], v[168:171], a[4:7]
    buffer_load_dwordx4 v[100:103], v7, s[4:7], s50 offen
    v_mfma_f32_16x16x32_bf16 a[4:7], v[64:67], v[204:207], a[4:7]
    buffer_load_dwordx4 v[104:107], v7, s[4:7], s51 offen
    v_mfma_f32_16x16x32_bf16 a[8:11], v[60:63], v[172:175], a[8:11]
    buffer_load_dwordx4 v[108:111], v7, s[4:7], s52 offen
    v_mfma_f32_16x16x32_bf16 a[8:11], v[64:67], v[208:211], a[8:11]
    buffer_load_dwordx4 v[112:115], v7, s[4:7], s53 offen
    v_mfma_f32_16x16x32_bf16 a[12:15], v[60:63], v[176:179], a[12:15]
    buffer_load_dwordx4 v[116:119], v7, s[4:7], s54 offen
    v_mfma_f32_16x16x32_bf16 a[12:15], v[64:67], v[212:215], a[12:15]
    buffer_load_dwordx4 v[120:123], v7, s[4:7], s55 offen
    v_mfma_f32_16x16x32_bf16 a[16:19], v[60:63], v[180:183], a[16:19]
    buffer_load_dwordx4 v[124:127], v7, s[4:7], s56 offen
    v_mfma_f32_16x16x32_bf16 a[16:19], v[64:67], v[216:219], a[16:19]
    v_add_u32 v7, 57344, v7
    v_mfma_f32_16x16x32_bf16 a[20:23], v[60:63], v[184:187], a[20:23]
    buffer_load_dwordx4 v[128:131], v7, s[4:7], s48 offen
    v_mfma_f32_16x16x32_bf16 a[20:23], v[64:67], v[220:223], a[20:23]
    buffer_load_dwordx4 v[132:135], v7, s[4:7], s49 offen
    v_mfma_f32_16x16x32_bf16 a[24:27], v[60:63], v[188:191], a[24:27]
    buffer_load_dwordx4 v[136:139], v7, s[4:7], s50 offen
    v_mfma_f32_16x16x32_bf16 a[24:27], v[64:67], v[224:227], a[24:27]
    buffer_load_dwordx4 v[140:143], v7, s[4:7], s51 offen
    v_mfma_f32_16x16x32_bf16 a[28:31], v[60:63], v[192:195], a[28:31]
    buffer_load_dwordx4 v[144:147], v7, s[4:7], s52 offen
    v_mfma_f32_16x16x32_bf16 a[28:31], v[64:67], v[228:231], a[28:31]
    buffer_load_dwordx4 v[148:151], v7, s[4:7], s53 offen
    v_mfma_f32_16x16x32_bf16 a[32:35], v[60:63], v[196:199], a[32:35]
    buffer_load_dwordx4 v[152:155], v7, s[4:7], s54 offen
    v_mfma_f32_16x16x32_bf16 a[32:35], v[64:67], v[232:235], a[32:35]
    ds_read_b64_tr_b16 v[60:61], v22 offset:16384
    ds_read_b64_tr_b16 v[62:63], v22 offset:17408
    ds_read_b64_tr_b16 v[64:65], v22 offset:24576
    ds_read_b64_tr_b16 v[66:67], v22 offset:25600
    s_waitcnt lgkmcnt(12)
    v_mfma_f32_16x16x32_bf16 a[36:39], v[68:71], v[164:167], a[36:39]
    buffer_load_dwordx4 v[156:159], v7, s[4:7], s55 offen
    v_mfma_f32_16x16x32_bf16 a[36:39], v[72:75], v[200:203], a[36:39]
    buffer_load_dwordx4 v[160:163], v7, s[4:7], s56 offen
    v_mfma_f32_16x16x32_bf16 a[40:43], v[68:71], v[168:171], a[40:43]
    v_add_u32 v7, 57344, v7
    v_mfma_f32_16x16x32_bf16 a[40:43], v[72:75], v[204:207], a[40:43]
    v_mfma_f32_16x16x32_bf16 a[44:47], v[68:71], v[172:175], a[44:47]
    v_mfma_f32_16x16x32_bf16 a[44:47], v[72:75], v[208:211], a[44:47]
    v_mfma_f32_16x16x32_bf16 a[48:51], v[68:71], v[176:179], a[48:51]
    v_mfma_f32_16x16x32_bf16 a[48:51], v[72:75], v[212:215], a[48:51]
    v_mfma_f32_16x16x32_bf16 a[52:55], v[68:71], v[180:183], a[52:55]
    v_mfma_f32_16x16x32_bf16 a[52:55], v[72:75], v[216:219], a[52:55]
    v_mfma_f32_16x16x32_bf16 a[56:59], v[68:71], v[184:187], a[56:59]
    v_mfma_f32_16x16x32_bf16 a[56:59], v[72:75], v[220:223], a[56:59]
    v_mfma_f32_16x16x32_bf16 a[60:63], v[68:71], v[188:191], a[60:63]
    v_mfma_f32_16x16x32_bf16 a[60:63], v[72:75], v[224:227], a[60:63]
    v_mfma_f32_16x16x32_bf16 a[64:67], v[68:71], v[192:195], a[64:67]
    v_mfma_f32_16x16x32_bf16 a[64:67], v[72:75], v[228:231], a[64:67]
    v_mfma_f32_16x16x32_bf16 a[68:71], v[68:71], v[196:199], a[68:71]
    v_mfma_f32_16x16x32_bf16 a[68:71], v[72:75], v[232:235], a[68:71]
    ds_read_b64_tr_b16 v[68:69], v23 offset:16384
    ds_read_b64_tr_b16 v[70:71], v23 offset:17408
    ds_read_b64_tr_b16 v[72:73], v23 offset:24576
    ds_read_b64_tr_b16 v[74:75], v23 offset:25600
    s_waitcnt lgkmcnt(12)
    v_mfma_f32_16x16x32_bf16 a[72:75], v[76:79], v[164:167], a[72:75]
    v_mfma_f32_16x16x32_bf16 a[72:75], v[80:83], v[200:203], a[72:75]
    v_mfma_f32_16x16x32_bf16 a[76:79], v[76:79], v[168:171], a[76:79]
    v_mfma_f32_16x16x32_bf16 a[76:79], v[80:83], v[204:207], a[76:79]
    v_mfma_f32_16x16x32_bf16 a[80:83], v[76:79], v[172:175], a[80:83]
    v_mfma_f32_16x16x32_bf16 a[80:83], v[80:83], v[208:211], a[80:83]
    v_mfma_f32_16x16x32_bf16 a[84:87], v[76:79], v[176:179], a[84:87]
    v_mfma_f32_16x16x32_bf16 a[84:87], v[80:83], v[212:215], a[84:87]
    v_mfma_f32_16x16x32_bf16 a[88:91], v[76:79], v[180:183], a[88:91]
    v_mfma_f32_16x16x32_bf16 a[88:91], v[80:83], v[216:219], a[88:91]
    v_mfma_f32_16x16x32_bf16 a[92:95], v[76:79], v[184:187], a[92:95]
    v_mfma_f32_16x16x32_bf16 a[92:95], v[80:83], v[220:223], a[92:95]
    v_mfma_f32_16x16x32_bf16 a[96:99], v[76:79], v[188:191], a[96:99]
    v_mfma_f32_16x16x32_bf16 a[96:99], v[80:83], v[224:227], a[96:99]
    v_mfma_f32_16x16x32_bf16 a[100:103], v[76:79], v[192:195], a[100:103]
    v_mfma_f32_16x16x32_bf16 a[100:103], v[80:83], v[228:231], a[100:103]
    v_mfma_f32_16x16x32_bf16 a[104:107], v[76:79], v[196:199], a[104:107]
    v_mfma_f32_16x16x32_bf16 a[104:107], v[80:83], v[232:235], a[104:107]
    ds_read_b64_tr_b16 v[76:77], v24 offset:16384
    ds_read_b64_tr_b16 v[78:79], v24 offset:17408
    ds_read_b64_tr_b16 v[80:81], v24 offset:24576
    ds_read_b64_tr_b16 v[82:83], v24 offset:25600
    s_waitcnt lgkmcnt(12)
    v_mfma_f32_16x16x32_bf16 a[108:111], v[84:87], v[164:167], a[108:111]
    v_mfma_f32_16x16x32_bf16 a[108:111], v[88:91], v[200:203], a[108:111]
    v_mfma_f32_16x16x32_bf16 a[112:115], v[84:87], v[168:171], a[112:115]
    v_mfma_f32_16x16x32_bf16 a[112:115], v[88:91], v[204:207], a[112:115]
    v_mfma_f32_16x16x32_bf16 a[116:119], v[84:87], v[172:175], a[116:119]
    v_mfma_f32_16x16x32_bf16 a[116:119], v[88:91], v[208:211], a[116:119]
    v_mfma_f32_16x16x32_bf16 a[120:123], v[84:87], v[176:179], a[120:123]
    v_mfma_f32_16x16x32_bf16 a[120:123], v[88:91], v[212:215], a[120:123]
    v_mfma_f32_16x16x32_bf16 a[124:127], v[84:87], v[180:183], a[124:127]
    v_mfma_f32_16x16x32_bf16 a[124:127], v[88:91], v[216:219], a[124:127]
    v_mfma_f32_16x16x32_bf16 a[128:131], v[84:87], v[184:187], a[128:131]
    v_mfma_f32_16x16x32_bf16 a[128:131], v[88:91], v[220:223], a[128:131]
    v_mfma_f32_16x16x32_bf16 a[132:135], v[84:87], v[188:191], a[132:135]
    v_mfma_f32_16x16x32_bf16 a[132:135], v[88:91], v[224:227], a[132:135]
    v_mfma_f32_16x16x32_bf16 a[136:139], v[84:87], v[192:195], a[136:139]
    v_mfma_f32_16x16x32_bf16 a[136:139], v[88:91], v[228:231], a[136:139]
    v_mfma_f32_16x16x32_bf16 a[140:143], v[84:87], v[196:199], a[140:143]
    v_mfma_f32_16x16x32_bf16 a[140:143], v[88:91], v[232:235], a[140:143]
    ds_read_b64_tr_b16 v[84:85], v25 offset:16384
    ds_read_b64_tr_b16 v[86:87], v25 offset:17408
    ds_read_b64_tr_b16 v[88:89], v25 offset:24576
    ds_read_b64_tr_b16 v[90:91], v25 offset:25600
    s_waitcnt lgkmcnt(12)
    v_mfma_f32_16x16x32_bf16 a[144:147], v[60:63], v[164:167], a[144:147]
    v_mfma_f32_16x16x32_bf16 a[144:147], v[64:67], v[200:203], a[144:147]
    v_mfma_f32_16x16x32_bf16 a[148:151], v[60:63], v[168:171], a[148:151]
    v_mfma_f32_16x16x32_bf16 a[148:151], v[64:67], v[204:207], a[148:151]
    v_mfma_f32_16x16x32_bf16 a[152:155], v[60:63], v[172:175], a[152:155]
    v_mfma_f32_16x16x32_bf16 a[152:155], v[64:67], v[208:211], a[152:155]
    v_mfma_f32_16x16x32_bf16 a[156:159], v[60:63], v[176:179], a[156:159]
    v_mfma_f32_16x16x32_bf16 a[156:159], v[64:67], v[212:215], a[156:159]
    v_mfma_f32_16x16x32_bf16 a[160:163], v[60:63], v[180:183], a[160:163]
    v_mfma_f32_16x16x32_bf16 a[160:163], v[64:67], v[216:219], a[160:163]
    v_mfma_f32_16x16x32_bf16 a[164:167], v[60:63], v[184:187], a[164:167]
    v_mfma_f32_16x16x32_bf16 a[164:167], v[64:67], v[220:223], a[164:167]
    v_mfma_f32_16x16x32_bf16 a[168:171], v[60:63], v[188:191], a[168:171]
    v_mfma_f32_16x16x32_bf16 a[168:171], v[64:67], v[224:227], a[168:171]
    v_mfma_f32_16x16x32_bf16 a[172:175], v[60:63], v[192:195], a[172:175]
    v_mfma_f32_16x16x32_bf16 a[172:175], v[64:67], v[228:231], a[172:175]
    v_mfma_f32_16x16x32_bf16 a[176:179], v[60:63], v[196:199], a[176:179]
    v_mfma_f32_16x16x32_bf16 a[176:179], v[64:67], v[232:235], a[176:179]
    s_waitcnt vmcnt(18)
    ds_read_b64_tr_b16 v[60:61], v18 offset:0
    ds_read_b64_tr_b16 v[62:63], v18 offset:1024
    ds_read_b64_tr_b16 v[64:65], v18 offset:8192
    ds_read_b64_tr_b16 v[66:67], v18 offset:9216
    s_waitcnt lgkmcnt(4)
    v_mfma_f32_16x16x32_bf16 a[180:183], v[68:71], v[164:167], a[180:183]
    s_add_u32 m0, s27, 16384
    v_mfma_f32_16x16x32_bf16 a[180:183], v[72:75], v[200:203], a[180:183]
    s_nop 0
    v_mfma_f32_16x16x32_bf16 a[184:187], v[68:71], v[168:171], a[184:187]
    buffer_load_dwordx4 v10, s[8:11], s26 offen offset:0 lds
    v_mfma_f32_16x16x32_bf16 a[184:187], v[72:75], v[204:207], a[184:187]
    buffer_load_dwordx4 v11, s[8:11], s26 offen offset:1024 lds
    v_mfma_f32_16x16x32_bf16 a[188:191], v[68:71], v[172:175], a[188:191]
    buffer_load_dwordx4 v12, s[8:11], s26 offen offset:2048 lds
    v_mfma_f32_16x16x32_bf16 a[188:191], v[72:75], v[208:211], a[188:191]
    buffer_load_dwordx4 v13, s[8:11], s26 offen offset:3072 lds
    v_mfma_f32_16x16x32_bf16 a[192:195], v[68:71], v[176:179], a[192:195]
    s_add_u32 m0, s27, 20480
    v_mfma_f32_16x16x32_bf16 a[192:195], v[72:75], v[212:215], a[192:195]
    s_nop 0
    v_mfma_f32_16x16x32_bf16 a[196:199], v[68:71], v[180:183], a[196:199]
    buffer_load_dwordx4 v14, s[8:11], s26 offen offset:0 lds
    v_mfma_f32_16x16x32_bf16 a[196:199], v[72:75], v[216:219], a[196:199]
    buffer_load_dwordx4 v15, s[8:11], s26 offen offset:1024 lds
    v_mfma_f32_16x16x32_bf16 a[200:203], v[68:71], v[184:187], a[200:203]
    buffer_load_dwordx4 v16, s[8:11], s26 offen offset:2048 lds
    v_mfma_f32_16x16x32_bf16 a[200:203], v[72:75], v[220:223], a[200:203]
    buffer_load_dwordx4 v17, s[8:11], s26 offen offset:3072 lds
    v_mfma_f32_16x16x32_bf16 a[204:207], v[68:71], v[188:191], a[204:207]
    s_add_u32 s26, s26, 163840
    v_mfma_f32_16x16x32_bf16 a[204:207], v[72:75], v[224:227], a[204:207]
    s_add_u32 m0, s27, 24576
    v_mfma_f32_16x16x32_bf16 a[208:211], v[68:71], v[192:195], a[208:211]
    s_nop 0
    v_mfma_f32_16x16x32_bf16 a[208:211], v[72:75], v[228:231], a[208:211]
    buffer_load_dwordx4 v10, s[8:11], s26 offen offset:0 lds
    v_mfma_f32_16x16x32_bf16 a[212:215], v[68:71], v[196:199], a[212:215]
    buffer_load_dwordx4 v11, s[8:11], s26 offen offset:1024 lds
    v_mfma_f32_16x16x32_bf16 a[212:215], v[72:75], v[232:235], a[212:215]
    ds_read_b64_tr_b16 v[68:69], v19 offset:0
    ds_read_b64_tr_b16 v[70:71], v19 offset:1024
    ds_read_b64_tr_b16 v[72:73], v19 offset:8192
    ds_read_b64_tr_b16 v[74:75], v19 offset:9216
    s_waitcnt lgkmcnt(12)
    v_mfma_f32_16x16x32_bf16 a[216:219], v[76:79], v[164:167], a[216:219]
    buffer_load_dwordx4 v12, s[8:11], s26 offen offset:2048 lds
    v_mfma_f32_16x16x32_bf16 a[216:219], v[80:83], v[200:203], a[216:219]
    buffer_load_dwordx4 v13, s[8:11], s26 offen offset:3072 lds
    v_mfma_f32_16x16x32_bf16 a[220:223], v[76:79], v[168:171], a[220:223]
    s_add_u32 m0, s27, 28672
    v_mfma_f32_16x16x32_bf16 a[220:223], v[80:83], v[204:207], a[220:223]
    s_nop 0
    v_mfma_f32_16x16x32_bf16 a[224:227], v[76:79], v[172:175], a[224:227]
    buffer_load_dwordx4 v14, s[8:11], s26 offen offset:0 lds
    v_mfma_f32_16x16x32_bf16 a[224:227], v[80:83], v[208:211], a[224:227]
    buffer_load_dwordx4 v15, s[8:11], s26 offen offset:1024 lds
    v_mfma_f32_16x16x32_bf16 a[228:231], v[76:79], v[176:179], a[228:231]
    buffer_load_dwordx4 v16, s[8:11], s26 offen offset:2048 lds
    v_mfma_f32_16x16x32_bf16 a[228:231], v[80:83], v[212:215], a[228:231]
    buffer_load_dwordx4 v17, s[8:11], s26 offen offset:3072 lds
    v_mfma_f32_16x16x32_bf16 a[232:235], v[76:79], v[180:183], a[232:235]
    s_add_u32 s26, s26, 163840
    v_mfma_f32_16x16x32_bf16 a[232:235], v[80:83], v[216:219], a[232:235]
    v_mfma_f32_16x16x32_bf16 a[236:239], v[76:79], v[184:187], a[236:239]
    v_mfma_f32_16x16x32_bf16 a[236:239], v[80:83], v[220:223], a[236:239]
    v_mfma_f32_16x16x32_bf16 a[240:243], v[76:79], v[188:191], a[240:243]
    v_mfma_f32_16x16x32_bf16 a[240:243], v[80:83], v[224:227], a[240:243]
    v_mfma_f32_16x16x32_bf16 a[244:247], v[76:79], v[192:195], a[244:247]
    v_mfma_f32_16x16x32_bf16 a[244:247], v[80:83], v[228:231], a[244:247]
    v_mfma_f32_16x16x32_bf16 a[248:251], v[76:79], v[196:199], a[248:251]
    v_mfma_f32_16x16x32_bf16 a[248:251], v[80:83], v[232:235], a[248:251]
    ds_read_b64_tr_b16 v[76:77], v20 offset:0
    ds_read_b64_tr_b16 v[78:79], v20 offset:1024
    ds_read_b64_tr_b16 v[80:81], v20 offset:8192
    ds_read_b64_tr_b16 v[82:83], v20 offset:9216
    s_waitcnt lgkmcnt(12)
    v_mfma_f32_16x16x32_bf16 a[252:255], v[84:87], v[164:167], a[252:255]
    v_mfma_f32_16x16x32_bf16 a[252:255], v[88:91], v[200:203], a[252:255]
    v_mfma_f32_16x16x32_bf16 v[28:31], v[84:87], v[168:171], v[28:31]
    v_mfma_f32_16x16x32_bf16 v[28:31], v[88:91], v[204:207], v[28:31]
    v_mfma_f32_16x16x32_bf16 v[32:35], v[84:87], v[172:175], v[32:35]
    v_mfma_f32_16x16x32_bf16 v[32:35], v[88:91], v[208:211], v[32:35]
    v_mfma_f32_16x16x32_bf16 v[36:39], v[84:87], v[176:179], v[36:39]
    v_mfma_f32_16x16x32_bf16 v[36:39], v[88:91], v[212:215], v[36:39]
    v_mfma_f32_16x16x32_bf16 v[40:43], v[84:87], v[180:183], v[40:43]
    v_mfma_f32_16x16x32_bf16 v[40:43], v[88:91], v[216:219], v[40:43]
    v_mfma_f32_16x16x32_bf16 v[44:47], v[84:87], v[184:187], v[44:47]
    v_mfma_f32_16x16x32_bf16 v[44:47], v[88:91], v[220:223], v[44:47]
    v_mfma_f32_16x16x32_bf16 v[48:51], v[84:87], v[188:191], v[48:51]
    v_mfma_f32_16x16x32_bf16 v[48:51], v[88:91], v[224:227], v[48:51]
    v_mfma_f32_16x16x32_bf16 v[52:55], v[84:87], v[192:195], v[52:55]
    v_mfma_f32_16x16x32_bf16 v[52:55], v[88:91], v[228:231], v[52:55]
    v_mfma_f32_16x16x32_bf16 v[56:59], v[84:87], v[196:199], v[56:59]
    v_mfma_f32_16x16x32_bf16 v[56:59], v[88:91], v[232:235], v[56:59]
    ds_read_b64_tr_b16 v[84:85], v21 offset:0
    ds_read_b64_tr_b16 v[86:87], v21 offset:1024
    ds_read_b64_tr_b16 v[88:89], v21 offset:8192
    ds_read_b64_tr_b16 v[90:91], v21 offset:9216
    s_add_u32 s21, s21, 1
    s_cmp_lt_u32 s21, 6
    s_cbranch_scc1 L_op_loop
    s_waitcnt vmcnt(16) lgkmcnt(12)
    v_mfma_f32_16x16x32_bf16 a[0:3], v[60:63], v[92:95], a[0:3]
    buffer_load_dwordx4 v[164:167], v7, s[4:7], s48 offen
    v_mfma_f32_16x16x32_bf16 a[0:3], v[64:67], v[128:131], a[0:3]
    buffer_load_dwordx4 v[168:171], v7, s[4:7], s49 offen
    v_mfma_f32_16x16x32_bf16 a[4:7], v[60:63], v[96:99], a[4:7]
    buffer_load_dwordx4 v[172:175], v7, s[4:7], s50 offen
    v_mfma_f32_16x16x32_bf16 a[4:7], v[64:67], v[132:135], a[4:7]
    buffer_load_dwordx4 v[176:179], v7, s[4:7], s51 offen
    v_mfma_f32_16x16x32_bf16 a[8:11], v[60:63], v[100:103], a[8:11]
    buffer_load_dwordx4 v[180:183], v7, s[4:7], s52 offen
    v_mfma_f32_16x16x32_bf16 a[8:11], v[64:67], v[136:139], a[8:11]
    buffer_load_dwordx4 v[184:187], v7, s[4:7], s53 offen
    v_mfma_f32_16x16x32_bf16 a[12:15], v[60:63], v[104:107], a[12:15]
    buffer_load_dwordx4 v[188:191], v7, s[4:7], s54 offen
    v_mfma_f32_16x16x32_bf16 a[12:15], v[64:67], v[140:143], a[12:15]
    buffer_load_dwordx4 v[192:195], v7, s[4:7], s55 offen
    v_mfma_f32_16x16x32_bf16 a[16:19], v[60:63], v[108:111], a[16:19]
    buffer_load_dwordx4 v[196:199], v7, s[4:7], s56 offen
    v_mfma_f32_16x16x32_bf16 a[16:19], v[64:67], v[144:147], a[16:19]
    v_add_u32 v7, 57344, v7
    v_mfma_f32_16x16x32_bf16 a[20:23], v[60:63], v[112:115], a[20:23]
    buffer_load_dwordx4 v[200:203], v7, s[4:7], s48 offen
    v_mfma_f32_16x16x32_bf16 a[20:23], v[64:67], v[148:151], a[20:23]
    buffer_load_dwordx4 v[204:207], v7, s[4:7], s49 offen
    v_mfma_f32_16x16x32_bf16 a[24:27], v[60:63], v[116:119], a[24:27]
    buffer_load_dwordx4 v[208:211], v7, s[4:7], s50 offen
    v_mfma_f32_16x16x32_bf16 a[24:27], v[64:67], v[152:155], a[24:27]
    buffer_load_dwordx4 v[212:215], v7, s[4:7], s51 offen
    v_mfma_f32_16x16x32_bf16 a[28:31], v[60:63], v[120:123], a[28:31]
    buffer_load_dwordx4 v[216:219], v7, s[4:7], s52 offen
    v_mfma_f32_16x16x32_bf16 a[28:31], v[64:67], v[156:159], a[28:31]
    buffer_load_dwordx4 v[220:223], v7, s[4:7], s53 offen
    v_mfma_f32_16x16x32_bf16 a[32:35], v[60:63], v[124:127], a[32:35]
    buffer_load_dwordx4 v[224:227], v7, s[4:7], s54 offen
    v_mfma_f32_16x16x32_bf16 a[32:35], v[64:67], v[160:163], a[32:35]
    ds_read_b64_tr_b16 v[60:61], v22 offset:0
    ds_read_b64_tr_b16 v[62:63], v22 offset:1024
    ds_read_b64_tr_b16 v[64:65], v22 offset:8192
    ds_read_b64_tr_b16 v[66:67], v22 offset:9216
    s_waitcnt lgkmcnt(12)
    v_mfma_f32_16x16x32_bf16 a[36:39], v[68:71], v[92:95], a[36:39]
    buffer_load_dwordx4 v[228:231], v7, s[4:7], s55 offen
    v_mfma_f32_16x16x32_bf16 a[36:39], v[72:75], v[128:131], a[36:39]
    buffer_load_dwordx4 v[232:235], v7, s[4:7], s56 offen
    v_mfma_f32_16x16x32_bf16 a[40:43], v[68:71], v[96:99], a[40:43]
    v_add_u32 v7, 57344, v7
    v_mfma_f32_16x16x32_bf16 a[40:43], v[72:75], v[132:135], a[40:43]
    v_mfma_f32_16x16x32_bf16 a[44:47], v[68:71], v[100:103], a[44:47]
    v_mfma_f32_16x16x32_bf16 a[44:47], v[72:75], v[136:139], a[44:47]
    v_mfma_f32_16x16x32_bf16 a[48:51], v[68:71], v[104:107], a[48:51]
    v_mfma_f32_16x16x32_bf16 a[48:51], v[72:75], v[140:143], a[48:51]
    v_mfma_f32_16x16x32_bf16 a[52:55], v[68:71], v[108:111], a[52:55]
    v_mfma_f32_16x16x32_bf16 a[52:55], v[72:75], v[144:147], a[52:55]
    v_mfma_f32_16x16x32_bf16 a[56:59], v[68:71], v[112:115], a[56:59]
    v_mfma_f32_16x16x32_bf16 a[56:59], v[72:75], v[148:151], a[56:59]
    v_mfma_f32_16x16x32_bf16 a[60:63], v[68:71], v[116:119], a[60:63]
    v_mfma_f32_16x16x32_bf16 a[60:63], v[72:75], v[152:155], a[60:63]
    v_mfma_f32_16x16x32_bf16 a[64:67], v[68:71], v[120:123], a[64:67]
    v_mfma_f32_16x16x32_bf16 a[64:67], v[72:75], v[156:159], a[64:67]
    v_mfma_f32_16x16x32_bf16 a[68:71], v[68:71], v[124:127], a[68:71]
    v_mfma_f32_16x16x32_bf16 a[68:71], v[72:75], v[160:163], a[68:71]
    ds_read_b64_tr_b16 v[68:69], v23 offset:0
    ds_read_b64_tr_b16 v[70:71], v23 offset:1024
    ds_read_b64_tr_b16 v[72:73], v23 offset:8192
    ds_read_b64_tr_b16 v[74:75], v23 offset:9216
    s_waitcnt lgkmcnt(12)
    v_mfma_f32_16x16x32_bf16 a[72:75], v[76:79], v[92:95], a[72:75]
    v_mfma_f32_16x16x32_bf16 a[72:75], v[80:83], v[128:131], a[72:75]
    v_mfma_f32_16x16x32_bf16 a[76:79], v[76:79], v[96:99], a[76:79]
    v_mfma_f32_16x16x32_bf16 a[76:79], v[80:83], v[132:135], a[76:79]
    v_mfma_f32_16x16x32_bf16 a[80:83], v[76:79], v[100:103], a[80:83]
    v_mfma_f32_16x16x32_bf16 a[80:83], v[80:83], v[136:139], a[80:83]
    v_mfma_f32_16x16x32_bf16 a[84:87], v[76:79], v[104:107], a[84:87]
    v_mfma_f32_16x16x32_bf16 a[84:87], v[80:83], v[140:143], a[84:87]
    v_mfma_f32_16x16x32_bf16 a[88:91], v[76:79], v[108:111], a[88:91]
    v_mfma_f32_16x16x32_bf16 a[88:91], v[80:83], v[144:147], a[88:91]
    v_mfma_f32_16x16x32_bf16 a[92:95], v[76:79], v[112:115], a[92:95]
    v_mfma_f32_16x16x32_bf16 a[92:95], v[80:83], v[148:151], a[92:95]
    v_mfma_f32_16x16x32_bf16 a[96:99], v[76:79], v[116:119], a[96:99]
    v_mfma_f32_16x16x32_bf16 a[96:99], v[80:83], v[152:155], a[96:99]
    v_mfma_f32_16x16x32_bf16 a[100:103], v[76:79], v[120:123], a[100:103]
    v_mfma_f32_16x16x32_bf16 a[100:103], v[80:83], v[156:159], a[100:103]
    v_mfma_f32_16x16x32_bf16 a[104:107], v[76:79], v[124:127], a[104:107]
    v_mfma_f32_16x16x32_bf16 a[104:107], v[80:83], v[160:163], a[104:107]
    ds_read_b64_tr_b16 v[76:77], v24 offset:0
    ds_read_b64_tr_b16 v[78:79], v24 offset:1024
    ds_read_b64_tr_b16 v[80:81], v24 offset:8192
    ds_read_b64_tr_b16 v[82:83], v24 offset:9216
    s_waitcnt lgkmcnt(12)
    v_mfma_f32_16x16x32_bf16 a[108:111], v[84:87], v[92:95], a[108:111]
    v_mfma_f32_16x16x32_bf16 a[108:111], v[88:91], v[128:131], a[108:111]
    v_mfma_f32_16x16x32_bf16 a[112:115], v[84:87], v[96:99], a[112:115]
    v_mfma_f32_16x16x32_bf16 a[112:115], v[88:91], v[132:135], a[112:115]
    v_mfma_f32_16x16x32_bf16 a[116:119], v[84:87], v[100:103], a[116:119]
    v_mfma_f32_16x16x32_bf16 a[116:119], v[88:91], v[136:139], a[116:119]
    v_mfma_f32_16x16x32_bf16 a[120:123], v[84:87], v[104:107], a[120:123]
    v_mfma_f32_16x16x32_bf16 a[120:123], v[88:91], v[140:143], a[120:123]
    v_mfma_f32_16x16x32_bf16 a[124:127], v[84:87], v[108:111], a[124:127]
    v_mfma_f32_16x16x32_bf16 a[124:127], v[88:91], v[144:147], a[124:127]
    v_mfma_f32_16x16x32_bf16 a[128:131], v[84:87], v[112:115], a[128:131]
    v_mfma_f32_16x16x32_bf16 a[128:131], v[88:91], v[148:151], a[128:131]
    v_mfma_f32_16x16x32_bf16 a[132:135], v[84:87], v[116:119], a[132:135]
    v_mfma_f32_16x16x32_bf16 a[132:135], v[88:91], v[152:155], a[132:135]
    v_mfma_f32_16x16x32_bf16 a[136:139], v[84:87], v[120:123], a[136:139]
    v_mfma_f32_16x16x32_bf16 a[136:139], v[88:91], v[156:159], a[136:139]
    v_mfma_f32_16x16x32_bf16 a[140:143], v[84:87], v[124:127], a[140:143]
    v_mfma_f32_16x16x32_bf16 a[140:143], v[88:91], v[160:163], a[140:143]
    ds_read_b64_tr_b16 v[84:85], v25 offset:0
    ds_read_b64_tr_b16 v[86:87], v25 offset:1024
    ds_read_b64_tr_b16 v[88:89], v25 offset:8192
    ds_read_b64_tr_b16 v[90:91], v25 offset:9216
    s_waitcnt lgkmcnt(12)
    v_mfma_f32_16x16x32_bf16 a[144:147], v[60:63], v[92:95], a[144:147]
    v_mfma_f32_16x16x32_bf16 a[144:147], v[64:67], v[128:131], a[144:147]
    v_mfma_f32_16x16x32_bf16 a[148:151], v[60:63], v[96:99], a[148:151]
    v_mfma_f32_16x16x32_bf16 a[148:151], v[64:67], v[132:135], a[148:151]
    v_mfma_f32_16x16x32_bf16 a[152:155], v[60:63], v[100:103], a[152:155]
    v_mfma_f32_16x16x32_bf16 a[152:155], v[64:67], v[136:139], a[152:155]
    v_mfma_f32_16x16x32_bf16 a[156:159], v[60:63], v[104:107], a[156:159]
    v_mfma_f32_16x16x32_bf16 a[156:159], v[64:67], v[140:143], a[156:159]
    v_mfma_f32_16x16x32_bf16 a[160:163], v[60:63], v[108:111], a[160:163]
    v_mfma_f32_16x16x32_bf16 a[160:163], v[64:67], v[144:147], a[160:163]
    v_mfma_f32_16x16x32_bf16 a[164:167], v[60:63], v[112:115], a[164:167]
    v_mfma_f32_16x16x32_bf16 a[164:167], v[64:67], v[148:151], a[164:167]
    v_mfma_f32_16x16x32_bf16 a[168:171], v[60:63], v[116:119], a[168:171]
    v_mfma_f32_16x16x32_bf16 a[168:171], v[64:67], v[152:155], a[168:171]
    v_mfma_f32_16x16x32_bf16 a[172:175], v[60:63], v[120:123], a[172:175]
    v_mfma_f32_16x16x32_bf16 a[172:175], v[64:67], v[156:159], a[172:175]
    v_mfma_f32_16x16x32_bf16 a[176:179], v[60:63], v[124:127], a[176:179]
    v_mfma_f32_16x16x32_bf16 a[176:179], v[64:67], v[160:163], a[176:179]
    s_waitcnt vmcnt(18)
    ds_read_b64_tr_b16 v[60:61], v18 offset:16384
    ds_read_b64_tr_b16 v[62:63], v18 offset:17408
    ds_read_b64_tr_b16 v[64:65], v18 offset:24576
    ds_read_b64_tr_b16 v[66:67], v18 offset:25600
    s_waitcnt lgkmcnt(12)
    v_mfma_f32_16x16x32_bf16 a[180:183], v[68:71], v[92:95], a[180:183]
    v_mfma_f32_16x16x32_bf16 a[180:183], v[72:75], v[128:131], a[180:183]
    v_mfma_f32_16x16x32_bf16 a[184:187], v[68:71], v[96:99], a[184:187]
    v_mfma_f32_16x16x32_bf16 a[184:187], v[72:75], v[132:135], a[184:187]
    v_mfma_f32_16x16x32_bf16 a[188:191], v[68:71], v[100:103], a[188:191]
    v_mfma_f32_16x16x32_bf16 a[188:191], v[72:75], v[136:139], a[188:191]
    v_mfma_f32_16x16x32_bf16 a[192:195], v[68:71], v[104:107], a[192:195]
    v_mfma_f32_16x16x32_bf16 a[192:195], v[72:75], v[140:143], a[192:195]
    v_mfma_f32_16x16x32_bf16 a[196:199], v[68:71], v[108:111], a[196:199]
    v_mfma_f32_16x16x32_bf16 a[196:199], v[72:75], v[144:147], a[196:199]
    v_mfma_f32_16x16x32_bf16 a[200:203], v[68:71], v[112:115], a[200:203]
    v_mfma_f32_16x16x32_bf16 a[200:203], v[72:75], v[148:151], a[200:203]
    v_mfma_f32_16x16x32_bf16 a[204:207], v[68:71], v[116:119], a[204:207]
    v_mfma_f32_16x16x32_bf16 a[204:207], v[72:75], v[152:155], a[204:207]
    v_mfma_f32_16x16x32_bf16 a[208:211], v[68:71], v[120:123], a[208:211]
    v_mfma_f32_16x16x32_bf16 a[208:211], v[72:75], v[156:159], a[208:211]
    v_mfma_f32_16x16x32_bf16 a[212:215], v[68:71], v[124:127], a[212:215]
    v_mfma_f32_16x16x32_bf16 a[212:215], v[72:75], v[160:163], a[212:215]
    ds_read_b64_tr_b16 v[68:69], v19 offset:16384
    ds_read_b64_tr_b16 v[70:71], v19 offset:17408
    ds_read_b64_tr_b16 v[72:73], v19 offset:24576
    ds_read_b64_tr_b16 v[74:75], v19 offset:25600
    s_waitcnt lgkmcnt(12)
    v_mfma_f32_16x16x32_bf16 a[216:219], v[76:79], v[92:95], a[216:219]
    v_mfma_f32_16x16x32_bf16 a[216:219], v[80:83], v[128:131], a[216:219]
    v_mfma_f32_16x16x32_bf16 a[220:223], v[76:79], v[96:99], a[220:223]
    v_mfma_f32_16x16x32_bf16 a[220:223], v[80:83], v[132:135], a[220:223]
    v_mfma_f32_16x16x32_bf16 a[224:227], v[76:79], v[100:103], a[224:227]
    v_mfma_f32_16x16x32_bf16 a[224:227], v[80:83], v[136:139], a[224:227]
    v_mfma_f32_16x16x32_bf16 a[228:231], v[76:79], v[104:107], a[228:231]
    v_mfma_f32_16x16x32_bf16 a[228:231], v[80:83], v[140:143], a[228:231]
    v_mfma_f32_16x16x32_bf16 a[232:235], v[76:79], v[108:111], a[232:235]
    v_mfma_f32_16x16x32_bf16 a[232:235], v[80:83], v[144:147], a[232:235]
    v_mfma_f32_16x16x32_bf16 a[236:239], v[76:79], v[112:115], a[236:239]
    v_mfma_f32_16x16x32_bf16 a[236:239], v[80:83], v[148:151], a[236:239]
    v_mfma_f32_16x16x32_bf16 a[240:243], v[76:79], v[116:119], a[240:243]
    v_mfma_f32_16x16x32_bf16 a[240:243], v[80:83], v[152:155], a[240:243]
    v_mfma_f32_16x16x32_bf16 a[244:247], v[76:79], v[120:123], a[244:247]
    v_mfma_f32_16x16x32_bf16 a[244:247], v[80:83], v[156:159], a[244:247]
    v_mfma_f32_16x16x32_bf16 a[248:251], v[76:79], v[124:127], a[248:251]
    v_mfma_f32_16x16x32_bf16 a[248:251], v[80:83], v[160:163], a[248:251]
    ds_read_b64_tr_b16 v[76:77], v20 offset:16384
    ds_read_b64_tr_b16 v[78:79], v20 offset:17408
    ds_read_b64_tr_b16 v[80:81], v20 offset:24576
    ds_read_b64_tr_b16 v[82:83], v20 offset:25600
    s_waitcnt lgkmcnt(12)
    v_mfma_f32_16x16x32_bf16 a[252:255], v[84:87], v[92:95], a[252:255]
    v_mfma_f32_16x16x32_bf16 a[252:255], v[88:91], v[128:131], a[252:255]
    v_mfma_f32_16x16x32_bf16 v[28:31], v[84:87], v[96:99], v[28:31]
    v_mfma_f32_16x16x32_bf16 v[28:31], v[88:91], v[132:135], v[28:31]
    v_mfma_f32_16x16x32_bf16 v[32:35], v[84:87], v[100:103], v[32:35]
    v_mfma_f32_16x16x32_bf16 v[32:35], v[88:91], v[136:139], v[32:35]
    v_mfma_f32_16x16x32_bf16 v[36:39], v[84:87], v[104:107], v[36:39]
    v_mfma_f32_16x16x32_bf16 v[36:39], v[88:91], v[140:143], v[36:39]
    v_mfma_f32_16x16x32_bf16 v[40:43], v[84:87], v[108:111], v[40:43]
    v_mfma_f32_16x16x32_bf16 v[40:43], v[88:91], v[144:147], v[40:43]
    v_mfma_f32_16x16x32_bf16 v[44:47], v[84:87], v[112:115], v[44:47]
    v_mfma_f32_16x16x32_bf16 v[44:47], v[88:91], v[148:151], v[44:47]
    v_mfma_f32_16x16x32_bf16 v[48:51], v[84:87], v[116:119], v[48:51]
    v_mfma_f32_16x16x32_bf16 v[48:51], v[88:91], v[152:155], v[48:51]
    v_mfma_f32_16x16x32_bf16 v[52:55], v[84:87], v[120:123], v[52:55]
    v_mfma_f32_16x16x32_bf16 v[52:55], v[88:91], v[156:159], v[52:55]
    v_mfma_f32_16x16x32_bf16 v[56:59], v[84:87], v[124:127], v[56:59]
    v_mfma_f32_16x16x32_bf16 v[56:59], v[88:91], v[160:163], v[56:59]
    ds_read_b64_tr_b16 v[84:85], v21 offset:16384
    ds_read_b64_tr_b16 v[86:87], v21 offset:17408
    ds_read_b64_tr_b16 v[88:89], v21 offset:24576
    ds_read_b64_tr_b16 v[90:91], v21 offset:25600
    s_waitcnt vmcnt(0) lgkmcnt(12)
    v_mfma_f32_16x16x32_bf16 a[0:3], v[60:63], v[164:167], a[0:3]
    ds_read_b64_tr_b16 v[92:93], v22 offset:16384
    v_mfma_f32_16x16x32_bf16 a[0:3], v[64:67], v[200:203], a[0:3]
    ds_read_b64_tr_b16 v[94:95], v22 offset:17408
    v_mfma_f32_16x16x32_bf16 a[4:7], v[60:63], v[168:171], a[4:7]
    ds_read_b64_tr_b16 v[96:97], v22 offset:24576
    v_mfma_f32_16x16x32_bf16 a[4:7], v[64:67], v[204:207], a[4:7]
    ds_read_b64_tr_b16 v[98:99], v22 offset:25600
    v_mfma_f32_16x16x32_bf16 a[8:11], v[60:63], v[172:175], a[8:11]
    ds_read_b64_tr_b16 v[100:101], v23 offset:16384
    v_mfma_f32_16x16x32_bf16 a[8:11], v[64:67], v[208:211], a[8:11]
    ds_read_b64_tr_b16 v[102:103], v23 offset:17408
    v_mfma_f32_16x16x32_bf16 a[12:15], v[60:63], v[176:179], a[12:15]
    ds_read_b64_tr_b16 v[104:105], v23 offset:24576
    v_mfma_f32_16x16x32_bf16 a[12:15], v[64:67], v[212:215], a[12:15]
    ds_read_b64_tr_b16 v[106:107], v23 offset:25600
    v_mfma_f32_16x16x32_bf16 a[16:19], v[60:63], v[180:183], a[16:19]
    ds_read_b64_tr_b16 v[108:109], v24 offset:16384
    v_mfma_f32_16x16x32_bf16 a[16:19], v[64:67], v[216:219], a[16:19]
    ds_read_b64_tr_b16 v[110:111], v24 offset:17408
    v_mfma_f32_16x16x32_bf16 a[20:23], v[60:63], v[184:187], a[20:23]
    ds_read_b64_tr_b16 v[112:113], v24 offset:24576
    v_mfma_f32_16x16x32_bf16 a[20:23], v[64:67], v[220:223], a[20:23]
    ds_read_b64_tr_b16 v[114:115], v24 offset:25600
    v_mfma_f32_16x16x32_bf16 a[24:27], v[60:63], v[188:191], a[24:27]
    ds_read_b64_tr_b16 v[116:117], v25 offset:16384
    v_mfma_f32_16x16x32_bf16 a[24:27], v[64:67], v[224:227], a[24:27]
    ds_read_b64_tr_b16 v[118:119], v25 offset:17408
    v_mfma_f32_16x16x32_bf16 a[28:31], v[60:63], v[192:195], a[28:31]
    ds_read_b64_tr_b16 v[120:121], v25 offset:24576
    v_mfma_f32_16x16x32_bf16 a[28:31], v[64:67], v[228:231], a[28:31]
    ds_read_b64_tr_b16 v[122:123], v25 offset:25600
    v_mfma_f32_16x16x32_bf16 a[32:35], v[60:63], v[196:199], a[32:35]
    v_mfma_f32_16x16x32_bf16 a[32:35], v[64:67], v[232:235], a[32:35]
    s_waitcnt lgkmcnt(15)
    v_mfma_f32_16x16x32_bf16 a[36:39], v[68:71], v[164:167], a[36:39]
    v_mfma_f32_16x16x32_bf16 a[36:39], v[72:75], v[200:203], a[36:39]
    v_mfma_f32_16x16x32_bf16 a[40:43], v[68:71], v[168:171], a[40:43]
    v_mfma_f32_16x16x32_bf16 a[40:43], v[72:75], v[204:207], a[40:43]
    v_mfma_f32_16x16x32_bf16 a[44:47], v[68:71], v[172:175], a[44:47]
    v_mfma_f32_16x16x32_bf16 a[44:47], v[72:75], v[208:211], a[44:47]
    v_mfma_f32_16x16x32_bf16 a[48:51], v[68:71], v[176:179], a[48:51]
    v_mfma_f32_16x16x32_bf16 a[48:51], v[72:75], v[212:215], a[48:51]
    v_mfma_f32_16x16x32_bf16 a[52:55], v[68:71], v[180:183], a[52:55]
    v_mfma_f32_16x16x32_bf16 a[52:55], v[72:75], v[216:219], a[52:55]
    v_mfma_f32_16x16x32_bf16 a[56:59], v[68:71], v[184:187], a[56:59]
    v_mfma_f32_16x16x32_bf16 a[56:59], v[72:75], v[220:223], a[56:59]
    v_mfma_f32_16x16x32_bf16 a[60:63], v[68:71], v[188:191], a[60:63]
    v_mfma_f32_16x16x32_bf16 a[60:63], v[72:75], v[224:227], a[60:63]
    v_mfma_f32_16x16x32_bf16 a[64:67], v[68:71], v[192:195], a[64:67]
    v_mfma_f32_16x16x32_bf16 a[64:67], v[72:75], v[228:231], a[64:67]
    v_mfma_f32_16x16x32_bf16 a[68:71], v[68:71], v[196:199], a[68:71]
    v_mfma_f32_16x16x32_bf16 a[68:71], v[72:75], v[232:235], a[68:71]
    s_waitcnt lgkmcnt(0)
    v_mfma_f32_16x16x32_bf16 a[72:75], v[76:79], v[164:167], a[72:75]
    ds_write_b128 v8, a[0:3] offset:0
    v_mfma_f32_16x16x32_bf16 a[72:75], v[80:83], v[200:203], a[72:75]
    ds_write_b128 v8, a[36:39] offset:1024
    v_mfma_f32_16x16x32_bf16 a[76:79], v[76:79], v[168:171], a[76:79]
    ds_write_b128 v8, a[4:7] offset:2048
    v_mfma_f32_16x16x32_bf16 a[76:79], v[80:83], v[204:207], a[76:79]
    ds_write_b128 v8, a[40:43] offset:3072
    v_mfma_f32_16x16x32_bf16 a[80:83], v[76:79], v[172:175], a[80:83]
    ds_write_b128 v8, a[8:11] offset:4096
    v_mfma_f32_16x16x32_bf16 a[80:83], v[80:83], v[208:211], a[80:83]
    ds_write_b128 v8, a[44:47] offset:5120
    v_mfma_f32_16x16x32_bf16 a[84:87], v[76:79], v[176:179], a[84:87]
    ds_write_b128 v8, a[12:15] offset:6144
    v_mfma_f32_16x16x32_bf16 a[84:87], v[80:83], v[212:215], a[84:87]
    ds_write_b128 v8, a[48:51] offset:7168
    v_mfma_f32_16x16x32_bf16 a[88:91], v[76:79], v[180:183], a[88:91]
    ds_write_b128 v8, a[16:19] offset:8192
    v_mfma_f32_16x16x32_bf16 a[88:91], v[80:83], v[216:219], a[88:91]
    ds_write_b128 v8, a[52:55] offset:9216
    v_mfma_f32_16x16x32_bf16 a[92:95], v[76:79], v[184:187], a[92:95]
    ds_write_b128 v8, a[20:23] offset:10240
    v_mfma_f32_16x16x32_bf16 a[92:95], v[80:83], v[220:223], a[92:95]
    ds_write_b128 v8, a[56:59] offset:11264
    v_mfma_f32_16x16x32_bf16 a[96:99], v[76:79], v[188:191], a[96:99]
    ds_write_b128 v8, a[24:27] offset:12288
    v_mfma_f32_16x16x32_bf16 a[96:99], v[80:83], v[224:227], a[96:99]
    ds_write_b128 v8, a[60:63] offset:13312
    v_mfma_f32_16x16x32_bf16 a[100:103], v[76:79], v[192:195], a[100:103]
    ds_write_b128 v8, a[28:31] offset:14336
    v_mfma_f32_16x16x32_bf16 a[100:103], v[80:83], v[228:231], a[100:103]
    ds_write_b128 v8, a[64:67] offset:15360
    v_mfma_f32_16x16x32_bf16 a[104:107], v[76:79], v[196:199], a[104:107]
    ds_write_b128 v8, a[32:35] offset:16384
    v_mfma_f32_16x16x32_bf16 a[104:107], v[80:83], v[232:235], a[104:107]
    ds_write_b128 v8, a[68:71] offset:17408
    v_mfma_f32_16x16x32_bf16 a[108:111], v[84:87], v[164:167], a[108:111]
    v_mfma_f32_16x16x32_bf16 a[108:111], v[88:91], v[200:203], a[108:111]
    v_mfma_f32_16x16x32_bf16 a[112:115], v[84:87], v[168:171], a[112:115]
    v_mfma_f32_16x16x32_bf16 a[112:115], v[88:91], v[204:207], a[112:115]
    v_mfma_f32_16x16x32_bf16 a[116:119], v[84:87], v[172:175], a[116:119]
    v_mfma_f32_16x16x32_bf16 a[116:119], v[88:91], v[208:211], a[116:119]
    v_mfma_f32_16x16x32_bf16 a[120:123], v[84:87], v[176:179], a[120:123]
    v_mfma_f32_16x16x32_bf16 a[120:123], v[88:91], v[212:215], a[120:123]
    v_mfma_f32_16x16x32_bf16 a[124:127], v[84:87], v[180:183], a[124:127]
    v_mfma_f32_16x16x32_bf16 a[124:127], v[88:91], v[216:219], a[124:127]
    ds_write_b128 v8, a[72:75] offset:18432
    v_mfma_f32_16x16x32_bf16 a[128:131], v[84:87], v[184:187], a[128:131]
    ds_write_b128 v8, a[108:111] offset:19456
    v_mfma_f32_16x16x32_bf16 a[128:131], v[88:91], v[220:223], a[128:131]
    ds_write_b128 v8, a[76:79] offset:20480
    v_mfma_f32_16x16x32_bf16 a[132:135], v[84:87], v[188:191], a[132:135]
    ds_write_b128 v8, a[112:115] offset:21504
    v_mfma_f32_16x16x32_bf16 a[132:135], v[88:91], v[224:227], a[132:135]
    ds_write_b128 v8, a[80:83] offset:22528
    v_mfma_f32_16x16x32_bf16 a[136:139], v[84:87], v[192:195], a[136:139]
    ds_write_b128 v8, a[116:119] offset:23552
    v_mfma_f32_16x16x32_bf16 a[136:139], v[88:91], v[228:231], a[136:139]
    ds_write_b128 v8, a[84:87] offset:24576
    v_mfma_f32_16x16x32_bf16 a[140:143], v[84:87], v[196:199], a[140:143]
    ds_write_b128 v8, a[120:123] offset:25600
    v_mfma_f32_16x16x32_bf16 a[140:143], v[88:91], v[232:235], a[140:143]
    ds_write_b128 v8, a[88:91] offset:26624
    v_mfma_f32_16x16x32_bf16 a[144:147], v[92:95], v[164:167], a[144:147]
    ds_write_b128 v8, a[124:127] offset:27648
    v_mfma_f32_16x16x32_bf16 a[144:147], v[96:99], v[200:203], a[144:147]
    ds_write_b128 v8, a[92:95] offset:28672
    v_mfma_f32_16x16x32_bf16 a[148:151], v[92:95], v[168:171], a[148:151]
    ds_write_b128 v8, a[128:131] offset:29696
    v_mfma_f32_16x16x32_bf16 a[148:151], v[96:99], v[204:207], a[148:151]
    ds_write_b128 v8, a[96:99] offset:30720
    v_mfma_f32_16x16x32_bf16 a[152:155], v[92:95], v[172:175], a[152:155]
    ds_write_b128 v8, a[132:135] offset:31744
    v_mfma_f32_16x16x32_bf16 a[152:155], v[96:99], v[208:211], a[152:155]
    ds_write_b128 v8, a[100:103] offset:32768
    v_mfma_f32_16x16x32_bf16 a[156:159], v[92:95], v[176:179], a[156:159]
    ds_write_b128 v8, a[136:139] offset:33792
    v_mfma_f32_16x16x32_bf16 a[156:159], v[96:99], v[212:215], a[156:159]
    ds_write_b128 v8, a[104:107] offset:34816
    v_mfma_f32_16x16x32_bf16 a[160:163], v[92:95], v[180:183], a[160:163]
    ds_write_b128 v8, a[140:143] offset:35840
    v_mfma_f32_16x16x32_bf16 a[160:163], v[96:99], v[216:219], a[160:163]
    v_mfma_f32_16x16x32_bf16 a[164:167], v[92:95], v[184:187], a[164:167]
    v_mfma_f32_16x16x32_bf16 a[164:167], v[96:99], v[220:223], a[164:167]
    v_mfma_f32_16x16x32_bf16 a[168:171], v[92:95], v[188:191], a[168:171]
    v_mfma_f32_16x16x32_bf16 a[168:171], v[96:99], v[224:227], a[168:171]
    v_mfma_f32_16x16x32_bf16 a[172:175], v[92:95], v[192:195], a[172:175]
    v_mfma_f32_16x16x32_bf16 a[172:175], v[96:99], v[228:231], a[172:175]
    v_mfma_f32_16x16x32_bf16 a[176:179], v[92:95], v[196:199], a[176:179]
    v_mfma_f32_16x16x32_bf16 a[176:179], v[96:99], v[232:235], a[176:179]
    v_mfma_f32_16x16x32_bf16 a[180:183], v[100:103], v[164:167], a[180:183]
    v_mfma_f32_16x16x32_bf16 a[180:183], v[104:107], v[200:203], a[180:183]
    v_mfma_f32_16x16x32_bf16 a[184:187], v[100:103], v[168:171], a[184:187]
    v_mfma_f32_16x16x32_bf16 a[184:187], v[104:107], v[204:207], a[184:187]
    v_mfma_f32_16x16x32_bf16 a[188:191], v[100:103], v[172:175], a[188:191]
    v_mfma_f32_16x16x32_bf16 a[188:191], v[104:107], v[208:211], a[188:191]
    v_mfma_f32_16x16x32_bf16 a[192:195], v[100:103], v[176:179], a[192:195]
    v_mfma_f32_16x16x32_bf16 a[192:195], v[104:107], v[212:215], a[192:195]
    v_mfma_f32_16x16x32_bf16 a[196:199], v[100:103], v[180:183], a[196:199]
    v_mfma_f32_16x16x32_bf16 a[196:199], v[104:107], v[216:219], a[196:199]
    ds_write_b128 v8, a[144:147] offset:36864
    v_mfma_f32_16x16x32_bf16 a[200:203], v[100:103], v[184:187], a[200:203]
    ds_write_b128 v8, a[180:183] offset:37888
    v_mfma_f32_16x16x32_bf16 a[200:203], v[104:107], v[220:223], a[200:203]
    ds_write_b128 v8, a[148:151] offset:38912
    v_mfma_f32_16x16x32_bf16 a[204:207], v[100:103], v[188:191], a[204:207]
    ds_write_b128 v8, a[184:187] offset:39936
    v_mfma_f32_16x16x32_bf16 a[204:207], v[104:107], v[224:227], a[204:207]
    v_mfma_f32_16x16x32_bf16 a[208:211], v[100:103], v[192:195], a[208:211]
    v_mfma_f32_16x16x32_bf16 a[208:211], v[104:107], v[228:231], a[208:211]
    v_mfma_f32_16x16x32_bf16 a[212:215], v[100:103], v[196:199], a[212:215]
    v_mfma_f32_16x16x32_bf16 a[212:215], v[104:107], v[232:235], a[212:215]
    v_mfma_f32_16x16x32_bf16 a[216:219], v[108:111], v[164:167], a[216:219]
    v_mfma_f32_16x16x32_bf16 a[216:219], v[112:115], v[200:203], a[216:219]
    v_mfma_f32_16x16x32_bf16 a[220:223], v[108:111], v[168:171], a[220:223]
    v_mfma_f32_16x16x32_bf16 a[220:223], v[112:115], v[204:207], a[220:223]
    v_mfma_f32_16x16x32_bf16 a[224:227], v[108:111], v[172:175], a[224:227]
    v_mfma_f32_16x16x32_bf16 a[224:227], v[112:115], v[208:211], a[224:227]
    v_mfma_f32_16x16x32_bf16 a[228:231], v[108:111], v[176:179], a[228:231]
    v_mfma_f32_16x16x32_bf16 a[228:231], v[112:115], v[212:215], a[228:231]
    v_mfma_f32_16x16x32_bf16 a[232:235], v[108:111], v[180:183], a[232:235]
    v_mfma_f32_16x16x32_bf16 a[232:235], v[112:115], v[216:219], a[232:235]
    v_mfma_f32_16x16x32_bf16 a[236:239], v[108:111], v[184:187], a[236:239]
    v_mfma_f32_16x16x32_bf16 a[236:239], v[112:115], v[220:223], a[236:239]
    v_mfma_f32_16x16x32_bf16 a[240:243], v[108:111], v[188:191], a[240:243]
    v_mfma_f32_16x16x32_bf16 a[240:243], v[112:115], v[224:227], a[240:243]
    v_mfma_f32_16x16x32_bf16 a[244:247], v[108:111], v[192:195], a[244:247]
    v_mfma_f32_16x16x32_bf16 a[244:247], v[112:115], v[228:231], a[244:247]
    v_mfma_f32_16x16x32_bf16 a[248:251], v[108:111], v[196:199], a[248:251]
    v_mfma_f32_16x16x32_bf16 a[248:251], v[112:115], v[232:235], a[248:251]
    v_mfma_f32_16x16x32_bf16 a[252:255], v[116:119], v[164:167], a[252:255]
    v_mfma_f32_16x16x32_bf16 a[252:255], v[120:123], v[200:203], a[252:255]
    v_mfma_f32_16x16x32_bf16 v[28:31], v[116:119], v[168:171], v[28:31]
    v_mfma_f32_16x16x32_bf16 v[28:31], v[120:123], v[204:207], v[28:31]
    v_mfma_f32_16x16x32_bf16 v[32:35], v[116:119], v[172:175], v[32:35]
    v_mfma_f32_16x16x32_bf16 v[32:35], v[120:123], v[208:211], v[32:35]
    v_mfma_f32_16x16x32_bf16 v[36:39], v[116:119], v[176:179], v[36:39]
    v_mfma_f32_16x16x32_bf16 v[36:39], v[120:123], v[212:215], v[36:39]
    v_mfma_f32_16x16x32_bf16 v[40:43], v[116:119], v[180:183], v[40:43]
    v_mfma_f32_16x16x32_bf16 v[40:43], v[120:123], v[216:219], v[40:43]
    v_mfma_f32_16x16x32_bf16 v[44:47], v[116:119], v[184:187], v[44:47]
    v_mfma_f32_16x16x32_bf16 v[44:47], v[120:123], v[220:223], v[44:47]
    v_mfma_f32_16x16x32_bf16 v[48:51], v[116:119], v[188:191], v[48:51]
    v_mfma_f32_16x16x32_bf16 v[48:51], v[120:123], v[224:227], v[48:51]
    v_mfma_f32_16x16x32_bf16 v[52:55], v[116:119], v[192:195], v[52:55]
    v_mfma_f32_16x16x32_bf16 v[52:55], v[120:123], v[228:231], v[52:55]
    v_mfma_f32_16x16x32_bf16 v[56:59], v[116:119], v[196:199], v[56:59]
    v_mfma_f32_16x16x32_bf16 v[56:59], v[120:123], v[232:235], v[56:59]
    s_waitcnt lgkmcnt(0)
    s_barrier
    ds_read_b128 v[60:63], v2 offset:0
    ds_read_b128 v[64:67], v2 offset:1024
    ds_read_b128 v[68:71], v3 offset:0
    ds_read_b128 v[72:75], v3 offset:1024
    ds_read_b128 v[76:79], v4 offset:0
    ds_read_b128 v[80:83], v4 offset:1024
    ds_read_b128 v[84:87], v5 offset:0
    ds_read_b128 v[88:91], v5 offset:1024
    ds_read_b128 v[92:95], v2 offset:8192
    ds_read_b128 v[96:99], v2 offset:9216
    ds_read_b128 v[100:103], v3 offset:8192
    ds_read_b128 v[104:107], v3 offset:9216
    ds_read_b128 v[108:111], v4 offset:8192
    ds_read_b128 v[112:115], v4 offset:9216
    ds_read_b128 v[116:119], v5 offset:8192
    ds_read_b128 v[120:123], v5 offset:9216
    ds_read_b128 v[124:127], v2 offset:16384
    ds_read_b128 v[128:131], v2 offset:17408
    ds_read_b128 v[132:135], v3 offset:16384
    ds_read_b128 v[136:139], v3 offset:17408
    ds_read_b128 v[140:143], v4 offset:16384
    ds_read_b128 v[144:147], v4 offset:17408
    ds_read_b128 v[148:151], v5 offset:16384
    ds_read_b128 v[152:155], v5 offset:17408
    ds_read_b128 v[156:159], v2 offset:24576
    ds_read_b128 v[160:163], v2 offset:25600
    ds_read_b128 v[164:167], v3 offset:24576
    ds_read_b128 v[168:171], v3 offset:25600
    ds_read_b128 v[172:175], v4 offset:24576
    ds_read_b128 v[176:179], v4 offset:25600
    ds_read_b128 v[180:183], v5 offset:24576
    ds_read_b128 v[184:187], v5 offset:25600
    ds_read_b128 v[188:191], v2 offset:32768
    ds_read_b128 v[192:195], v2 offset:33792
    ds_read_b128 v[196:199], v3 offset:32768
    ds_read_b128 v[200:203], v3 offset:33792
    ds_read_b128 v[204:207], v4 offset:32768
    ds_read_b128 v[208:211], v4 offset:33792
    ds_read_b128 v[212:215], v5 offset:32768
    ds_read_b128 v[216:219], v5 offset:33792
    s_waitcnt lgkmcnt(0)
    s_barrier
    ds_write_b128 v8, a[152:155] offset:0
    v_pk_add_f32 v[60:61], v[60:61], v[68:69]
    v_pk_add_f32 v[76:77], v[76:77], v[84:85]
    v_pk_add_f32 v[62:63], v[62:63], v[70:71]
    v_pk_add_f32 v[78:79], v[78:79], v[86:87]
    v_pk_add_f32 v[64:65], v[64:65], v[72:73]
    ds_write_b128 v8, a[188:191] offset:1024
    v_pk_add_f32 v[80:81], v[80:81], v[88:89]
    v_pk_add_f32 v[66:67], v[66:67], v[74:75]
    v_pk_add_f32 v[82:83], v[82:83], v[90:91]
    v_pk_add_f32 v[60:61], v[60:61], v[76:77]
    v_pk_add_f32 v[62:63], v[62:63], v[78:79]
    ds_write_b128 v8, a[156:159] offset:2048
    v_pk_add_f32 v[64:65], v[64:65], v[80:81]
    v_pk_add_f32 v[66:67], v[66:67], v[82:83]
    v_cvt_pk_bf16_f32 v68, v60, v61
    v_cvt_pk_bf16_f32 v69, v62, v63
    v_cvt_pk_bf16_f32 v70, v64, v65
    ds_write_b128 v8, a[192:195] offset:3072
    v_cvt_pk_bf16_f32 v71, v66, v67
    s_add_u32 s22, s20, 0
    s_mul_i32 s23, s22, 7282
    s_lshr_b32 s23, s23, 16
    v_permlane16_swap_b32 v68, v70
    ds_write_b128 v8, a[160:163] offset:4096
    v_permlane16_swap_b32 v69, v71
    s_mul_i32 s62, s23, 9
    s_sub_u32 s22, s22, s62
    s_mul_i32 s62, s22, 40960
    s_lshl_b32 s23, s23, 6
    ds_write_b128 v8, a[196:199] offset:5120
    s_add_u32 s62, s62, s23
    s_add_u32 s62, s62, s24
    s_add_u32 s22, s22, s31
    s_cmp_ge_u32 s22, 224
    s_cselect_b32 s23, 0x40000000, 0
    ds_write_b128 v8, a[164:167] offset:6144
    s_add_u32 s62, s62, s23
    buffer_store_dwordx4 v[68:71], v9, s[12:15], s62 offen sc0 sc1
    v_pk_add_f32 v[92:93], v[92:93], v[100:101]
    v_pk_add_f32 v[108:109], v[108:109], v[116:117]
    v_pk_add_f32 v[94:95], v[94:95], v[102:103]
    ds_write_b128 v8, a[200:203] offset:7168
    v_pk_add_f32 v[110:111], v[110:111], v[118:119]
    v_pk_add_f32 v[96:97], v[96:97], v[104:105]
    v_pk_add_f32 v[112:113], v[112:113], v[120:121]
    v_pk_add_f32 v[98:99], v[98:99], v[106:107]
    v_pk_add_f32 v[114:115], v[114:115], v[122:123]
    ds_write_b128 v8, a[168:171] offset:8192
    v_pk_add_f32 v[92:93], v[92:93], v[108:109]
    v_pk_add_f32 v[94:95], v[94:95], v[110:111]
    v_pk_add_f32 v[96:97], v[96:97], v[112:113]
    v_pk_add_f32 v[98:99], v[98:99], v[114:115]
    v_cvt_pk_bf16_f32 v100, v92, v93
    ds_write_b128 v8, a[204:207] offset:9216
    v_cvt_pk_bf16_f32 v101, v94, v95
    v_cvt_pk_bf16_f32 v102, v96, v97
    v_cvt_pk_bf16_f32 v103, v98, v99
    s_add_u32 s22, s20, 4
    s_mul_i32 s23, s22, 7282
    ds_write_b128 v8, a[172:175] offset:10240
    s_lshr_b32 s23, s23, 16
    v_permlane16_swap_b32 v100, v102
    v_permlane16_swap_b32 v101, v103
    s_mul_i32 s62, s23, 9
    s_sub_u32 s22, s22, s62
    ds_write_b128 v8, a[208:211] offset:11264
    s_mul_i32 s62, s22, 40960
    s_lshl_b32 s23, s23, 6
    s_add_u32 s62, s62, s23
    s_add_u32 s62, s62, s24
    s_add_u32 s22, s22, s31
    ds_write_b128 v8, a[176:179] offset:12288
    s_cmp_ge_u32 s22, 224
    s_cselect_b32 s23, 0x40000000, 0
    s_add_u32 s62, s62, s23
    buffer_store_dwordx4 v[100:103], v9, s[12:15], s62 offen sc0 sc1
    v_pk_add_f32 v[124:125], v[124:125], v[132:133]
    ds_write_b128 v8, a[212:215] offset:13312
    v_pk_add_f32 v[140:141], v[140:141], v[148:149]
    v_pk_add_f32 v[126:127], v[126:127], v[134:135]
    v_pk_add_f32 v[142:143], v[142:143], v[150:151]
    v_pk_add_f32 v[128:129], v[128:129], v[136:137]
    v_pk_add_f32 v[144:145], v[144:145], v[152:153]
    ds_write_b128 v8, a[216:219] offset:14336
    v_pk_add_f32 v[130:131], v[130:131], v[138:139]
    v_pk_add_f32 v[146:147], v[146:147], v[154:155]
    v_pk_add_f32 v[124:125], v[124:125], v[140:141]
    v_pk_add_f32 v[126:127], v[126:127], v[142:143]
    v_pk_add_f32 v[128:129], v[128:129], v[144:145]
    ds_write_b128 v8, a[252:255] offset:15360
    v_pk_add_f32 v[130:131], v[130:131], v[146:147]
    v_cvt_pk_bf16_f32 v132, v124, v125
    v_cvt_pk_bf16_f32 v133, v126, v127
    v_cvt_pk_bf16_f32 v134, v128, v129
    v_cvt_pk_bf16_f32 v135, v130, v131
    ds_write_b128 v8, a[220:223] offset:16384
    s_add_u32 s22, s20, 8
    s_mul_i32 s23, s22, 7282
    s_lshr_b32 s23, s23, 16
    v_permlane16_swap_b32 v132, v134
    v_permlane16_swap_b32 v133, v135
    ds_write_b128 v8, v[28:31] offset:17408
    s_mul_i32 s62, s23, 9
    s_sub_u32 s22, s22, s62
    s_mul_i32 s62, s22, 40960
    s_lshl_b32 s23, s23, 6
    s_add_u32 s62, s62, s23
    ds_write_b128 v8, a[224:227] offset:18432
    s_add_u32 s62, s62, s24
    s_add_u32 s22, s22, s31
    s_cmp_ge_u32 s22, 224
    s_cselect_b32 s23, 0x40000000, 0
    s_add_u32 s62, s62, s23
    ds_write_b128 v8, v[32:35] offset:19456
    buffer_store_dwordx4 v[132:135], v9, s[12:15], s62 offen sc0 sc1
    v_pk_add_f32 v[156:157], v[156:157], v[164:165]
    v_pk_add_f32 v[172:173], v[172:173], v[180:181]
    v_pk_add_f32 v[158:159], v[158:159], v[166:167]
    v_pk_add_f32 v[174:175], v[174:175], v[182:183]
    ds_write_b128 v8, a[228:231] offset:20480
    v_pk_add_f32 v[160:161], v[160:161], v[168:169]
    v_pk_add_f32 v[176:177], v[176:177], v[184:185]
    v_pk_add_f32 v[162:163], v[162:163], v[170:171]
    v_pk_add_f32 v[178:179], v[178:179], v[186:187]
    v_pk_add_f32 v[156:157], v[156:157], v[172:173]
    ds_write_b128 v8, v[36:39] offset:21504
    v_pk_add_f32 v[158:159], v[158:159], v[174:175]
    v_pk_add_f32 v[160:161], v[160:161], v[176:177]
    v_pk_add_f32 v[162:163], v[162:163], v[178:179]
    v_cvt_pk_bf16_f32 v164, v156, v157
    v_cvt_pk_bf16_f32 v165, v158, v159
    ds_write_b128 v8, a[232:235] offset:22528
    v_cvt_pk_bf16_f32 v166, v160, v161
    v_cvt_pk_bf16_f32 v167, v162, v163
    s_add_u32 s22, s20, 12
    s_mul_i32 s23, s22, 7282
    s_lshr_b32 s23, s23, 16
    ds_write_b128 v8, v[40:43] offset:23552
    v_permlane16_swap_b32 v164, v166
    v_permlane16_swap_b32 v165, v167
    s_mul_i32 s62, s23, 9
    s_sub_u32 s22, s22, s62
    s_mul_i32 s62, s22, 40960
    ds_write_b128 v8, a[236:239] offset:24576
    s_lshl_b32 s23, s23, 6
    s_add_u32 s62, s62, s23
    s_add_u32 s62, s62, s24
    s_add_u32 s22, s22, s31
    s_cmp_ge_u32 s22, 224
    ds_write_b128 v8, v[44:47] offset:25600
    s_cselect_b32 s23, 0x40000000, 0
    s_add_u32 s62, s62, s23
    buffer_store_dwordx4 v[164:167], v9, s[12:15], s62 offen sc0 sc1
    v_pk_add_f32 v[188:189], v[188:189], v[196:197]
    v_pk_add_f32 v[204:205], v[204:205], v[212:213]
    ds_write_b128 v8, a[240:243] offset:26624
    v_pk_add_f32 v[190:191], v[190:191], v[198:199]
    v_pk_add_f32 v[206:207], v[206:207], v[214:215]
    v_pk_add_f32 v[192:193], v[192:193], v[200:201]
    v_pk_add_f32 v[208:209], v[208:209], v[216:217]
    v_pk_add_f32 v[194:195], v[194:195], v[202:203]
    ds_write_b128 v8, v[48:51] offset:27648
    v_pk_add_f32 v[210:211], v[210:211], v[218:219]
    v_pk_add_f32 v[188:189], v[188:189], v[204:205]
    v_pk_add_f32 v[190:191], v[190:191], v[206:207]
    v_pk_add_f32 v[192:193], v[192:193], v[208:209]
    v_pk_add_f32 v[194:195], v[194:195], v[210:211]
    ds_write_b128 v8, a[244:247] offset:28672
    v_cvt_pk_bf16_f32 v196, v188, v189
    v_cvt_pk_bf16_f32 v197, v190, v191
    v_cvt_pk_bf16_f32 v198, v192, v193
    v_cvt_pk_bf16_f32 v199, v194, v195
    s_add_u32 s22, s20, 16
    ds_write_b128 v8, v[52:55] offset:29696
    s_mul_i32 s23, s22, 7282
    s_lshr_b32 s23, s23, 16
    v_permlane16_swap_b32 v196, v198
    v_permlane16_swap_b32 v197, v199
    s_mul_i32 s62, s23, 9
    ds_write_b128 v8, a[248:251] offset:30720
    s_sub_u32 s22, s22, s62
    s_mul_i32 s62, s22, 40960
    s_lshl_b32 s23, s23, 6
    s_add_u32 s62, s62, s23
    s_add_u32 s62, s62, s24
    ds_write_b128 v8, v[56:59] offset:31744
    s_add_u32 s22, s22, s31
    s_cmp_ge_u32 s22, 224
    s_cselect_b32 s23, 0x40000000, 0
    s_add_u32 s62, s62, s23
    buffer_store_dwordx4 v[196:199], v9, s[12:15], s62 offen sc0 sc1
    s_waitcnt lgkmcnt(0)
    s_barrier
    ds_read_b128 v[60:63], v2 offset:0
    ds_read_b128 v[64:67], v2 offset:1024
    ds_read_b128 v[68:71], v3 offset:0
    ds_read_b128 v[72:75], v3 offset:1024
    ds_read_b128 v[76:79], v4 offset:0
    ds_read_b128 v[80:83], v4 offset:1024
    ds_read_b128 v[84:87], v5 offset:0
    ds_read_b128 v[88:91], v5 offset:1024
    ds_read_b128 v[92:95], v2 offset:8192
    ds_read_b128 v[96:99], v2 offset:9216
    ds_read_b128 v[100:103], v3 offset:8192
    ds_read_b128 v[104:107], v3 offset:9216
    ds_read_b128 v[108:111], v4 offset:8192
    ds_read_b128 v[112:115], v4 offset:9216
    ds_read_b128 v[116:119], v5 offset:8192
    ds_read_b128 v[120:123], v5 offset:9216
    ds_read_b128 v[124:127], v2 offset:16384
    ds_read_b128 v[128:131], v2 offset:17408
    ds_read_b128 v[132:135], v3 offset:16384
    ds_read_b128 v[136:139], v3 offset:17408
    ds_read_b128 v[140:143], v4 offset:16384
    ds_read_b128 v[144:147], v4 offset:17408
    ds_read_b128 v[148:151], v5 offset:16384
    ds_read_b128 v[152:155], v5 offset:17408
    ds_read_b128 v[156:159], v2 offset:24576
    ds_read_b128 v[160:163], v2 offset:25600
    ds_read_b128 v[164:167], v3 offset:24576
    ds_read_b128 v[168:171], v3 offset:25600
    ds_read_b128 v[172:175], v4 offset:24576
    ds_read_b128 v[176:179], v4 offset:25600
    ds_read_b128 v[180:183], v5 offset:24576
    ds_read_b128 v[184:187], v5 offset:25600
    s_waitcnt lgkmcnt(15)
    v_pk_add_f32 v[60:61], v[60:61], v[68:69]
    v_pk_add_f32 v[76:77], v[76:77], v[84:85]
    v_pk_add_f32 v[62:63], v[62:63], v[70:71]
    v_pk_add_f32 v[78:79], v[78:79], v[86:87]
    v_pk_add_f32 v[64:65], v[64:65], v[72:73]
    v_pk_add_f32 v[80:81], v[80:81], v[88:89]
    v_pk_add_f32 v[66:67], v[66:67], v[74:75]
    v_pk_add_f32 v[82:83], v[82:83], v[90:91]
    v_pk_add_f32 v[60:61], v[60:61], v[76:77]
    v_pk_add_f32 v[62:63], v[62:63], v[78:79]
    v_pk_add_f32 v[64:65], v[64:65], v[80:81]
    v_pk_add_f32 v[66:67], v[66:67], v[82:83]
    v_cvt_pk_bf16_f32 v68, v60, v61
    v_cvt_pk_bf16_f32 v69, v62, v63
    v_cvt_pk_bf16_f32 v70, v64, v65
    v_cvt_pk_bf16_f32 v71, v66, v67
    s_add_u32 s22, s20, 20
    s_mul_i32 s23, s22, 7282
    s_lshr_b32 s23, s23, 16
    v_permlane16_swap_b32 v68, v70
    v_permlane16_swap_b32 v69, v71
    s_mul_i32 s62, s23, 9
    s_sub_u32 s22, s22, s62
    s_mul_i32 s62, s22, 40960
    s_lshl_b32 s23, s23, 6
    s_add_u32 s62, s62, s23
    s_add_u32 s62, s62, s24
    s_add_u32 s22, s22, s31
    s_cmp_ge_u32 s22, 224
    s_cselect_b32 s23, 0x40000000, 0
    s_add_u32 s62, s62, s23
    buffer_store_dwordx4 v[68:71], v9, s[12:15], s62 offen sc0 sc1
    s_waitcnt lgkmcnt(15)
    v_pk_add_f32 v[92:93], v[92:93], v[100:101]
    v_pk_add_f32 v[108:109], v[108:109], v[116:117]
    v_pk_add_f32 v[94:95], v[94:95], v[102:103]
    v_pk_add_f32 v[110:111], v[110:111], v[118:119]
    v_pk_add_f32 v[96:97], v[96:97], v[104:105]
    v_pk_add_f32 v[112:113], v[112:113], v[120:121]
    v_pk_add_f32 v[98:99], v[98:99], v[106:107]
    v_pk_add_f32 v[114:115], v[114:115], v[122:123]
    v_pk_add_f32 v[92:93], v[92:93], v[108:109]
    v_pk_add_f32 v[94:95], v[94:95], v[110:111]
    v_pk_add_f32 v[96:97], v[96:97], v[112:113]
    v_pk_add_f32 v[98:99], v[98:99], v[114:115]
    v_cvt_pk_bf16_f32 v100, v92, v93
    v_cvt_pk_bf16_f32 v101, v94, v95
    v_cvt_pk_bf16_f32 v102, v96, v97
    v_cvt_pk_bf16_f32 v103, v98, v99
    s_add_u32 s22, s20, 24
    s_mul_i32 s23, s22, 7282
    s_lshr_b32 s23, s23, 16
    v_permlane16_swap_b32 v100, v102
    v_permlane16_swap_b32 v101, v103
    s_mul_i32 s62, s23, 9
    s_sub_u32 s22, s22, s62
    s_mul_i32 s62, s22, 40960
    s_lshl_b32 s23, s23, 6
    s_add_u32 s62, s62, s23
    s_add_u32 s62, s62, s24
    s_add_u32 s22, s22, s31
    s_cmp_ge_u32 s22, 224
    s_cselect_b32 s23, 0x40000000, 0
    s_add_u32 s62, s62, s23
    buffer_store_dwordx4 v[100:103], v9, s[12:15], s62 offen sc0 sc1
    s_waitcnt lgkmcnt(8)
    v_pk_add_f32 v[124:125], v[124:125], v[132:133]
    v_pk_add_f32 v[140:141], v[140:141], v[148:149]
    v_pk_add_f32 v[126:127], v[126:127], v[134:135]
    v_pk_add_f32 v[142:143], v[142:143], v[150:151]
    v_pk_add_f32 v[128:129], v[128:129], v[136:137]
    v_pk_add_f32 v[144:145], v[144:145], v[152:153]
    v_pk_add_f32 v[130:131], v[130:131], v[138:139]
    v_pk_add_f32 v[146:147], v[146:147], v[154:155]
    v_pk_add_f32 v[124:125], v[124:125], v[140:141]
    v_pk_add_f32 v[126:127], v[126:127], v[142:143]
    v_pk_add_f32 v[128:129], v[128:129], v[144:145]
    v_pk_add_f32 v[130:131], v[130:131], v[146:147]
    v_cvt_pk_bf16_f32 v132, v124, v125
    v_cvt_pk_bf16_f32 v133, v126, v127
    v_cvt_pk_bf16_f32 v134, v128, v129
    v_cvt_pk_bf16_f32 v135, v130, v131
    s_add_u32 s22, s20, 28
    s_mul_i32 s23, s22, 7282
    s_lshr_b32 s23, s23, 16
    v_permlane16_swap_b32 v132, v134
    v_permlane16_swap_b32 v133, v135
    s_mul_i32 s62, s23, 9
    s_sub_u32 s22, s22, s62
    s_mul_i32 s62, s22, 40960
    s_lshl_b32 s23, s23, 6
    s_add_u32 s62, s62, s23
    s_add_u32 s62, s62, s24
    s_add_u32 s22, s22, s31
    s_cmp_ge_u32 s22, 224
    s_cselect_b32 s23, 0x40000000, 0
    s_add_u32 s62, s62, s23
    buffer_store_dwordx4 v[132:135], v9, s[12:15], s62 offen sc0 sc1
    s_waitcnt lgkmcnt(0)
    v_pk_add_f32 v[156:157], v[156:157], v[164:165]
    v_pk_add_f32 v[172:173], v[172:173], v[180:181]
    v_pk_add_f32 v[158:159], v[158:159], v[166:167]
    v_pk_add_f32 v[174:175], v[174:175], v[182:183]
    v_pk_add_f32 v[160:161], v[160:161], v[168:169]
    v_pk_add_f32 v[176:177], v[176:177], v[184:185]
    v_pk_add_f32 v[162:163], v[162:163], v[170:171]
    v_pk_add_f32 v[178:179], v[178:179], v[186:187]
    v_pk_add_f32 v[156:157], v[156:157], v[172:173]
    v_pk_add_f32 v[158:159], v[158:159], v[174:175]
    v_pk_add_f32 v[160:161], v[160:161], v[176:177]
    v_pk_add_f32 v[162:163], v[162:163], v[178:179]
    v_cvt_pk_bf16_f32 v164, v156, v157
    v_cvt_pk_bf16_f32 v165, v158, v159
    v_cvt_pk_bf16_f32 v166, v160, v161
    v_cvt_pk_bf16_f32 v167, v162, v163
    s_add_u32 s22, s20, 32
    s_mul_i32 s23, s22, 7282
    s_lshr_b32 s23, s23, 16
    v_permlane16_swap_b32 v164, v166
    v_permlane16_swap_b32 v165, v167
    s_mul_i32 s62, s23, 9
    s_sub_u32 s22, s22, s62
    s_mul_i32 s62, s22, 40960
    s_lshl_b32 s23, s23, 6
    s_add_u32 s62, s62, s23
    s_add_u32 s62, s62, s24
    s_add_u32 s22, s22, s31
    s_cmp_ge_u32 s22, 224
    s_cselect_b32 s23, 0x40000000, 0
    s_add_u32 s62, s62, s23
    buffer_store_dwordx4 v[164:167], v9, s[12:15], s62 offen sc0 sc1
L_op_end:
    s_endpgm
L_code_end:
.section .rodata,"a"
.p2align 6
.amdhsa_kernel fused_kernel
  .amdhsa_next_free_vgpr 512
  .amdhsa_next_free_sgpr 102
  .amdhsa_accum_offset 256
  .amdhsa_group_segment_fixed_size 0
  .amdhsa_kernarg_size 104
  .amdhsa_user_sgpr_count 2
  .amdhsa_user_sgpr_kernarg_segment_ptr 1
  .amdhsa_system_sgpr_workgroup_id_x 1
.end_amdhsa_kernel
.p2align 6
.amdhsa_kernel op_kernel
  .amdhsa_next_free_vgpr 512
  .amdhsa_next_free_sgpr 102
  .amdhsa_accum_offset 256
  .amdhsa_group_segment_fixed_size 0
  .amdhsa_kernarg_size 104
  .amdhsa_user_sgpr_count 2
  .amdhsa_user_sgpr_kernarg_segment_ptr 1
  .amdhsa_system_sgpr_workgroup_id_x 1
.end_amdhsa_kernel
```

```asm
; @launch kernel=fused_kernel grid=(256,1,1) block=(256,1,1) lds=163840
; @launch kernel=op_kernel grid=(256,1,1) block=(256,1,1) lds=163840
.amdgcn_target "amdgcn-amd-amdhsa--gfx950"
.text
.globl fused_kernel
.p2align 8
.type fused_kernel,@function
fused_kernel:
    s_cmp_ge_u32 s2, 256
    s_cbranch_scc1 L_at_end
    s_and_b32 s3, s2, 7
    s_lshl_b32 s3, s3, 5
    s_lshr_b32 s36, s2, 6
    s_lshl_b32 s36, s36, 3
    s_or_b32 s3, s3, s36
    s_bfe_u32 s36, s2, 0x30003
    s_or_b32 s2, s3, s36
    s_load_dwordx8 s[36:43], s[0:1], 0
    s_load_dwordx8 s[56:63], s[0:1], 40
    s_load_dwordx2 s[44:45], s[0:1], 96
    s_load_dwordx2 s[84:85], s[0:1], 32
    s_load_dwordx2 s[86:87], s[0:1], 72
    s_getpc_b64 s[72:73]
L_pc0:
    v_lshlrev_b32 v105, 7, v0
    v_add_u32 v104, 0, v105
    v_min_u32 v104, L_code_end - L_pc0 - 4, v104
    v_mov_b32 v107, s73
    v_add_co_u32 v106, vcc, s72, v104
    v_addc_co_u32 v107, vcc, 0, v107, vcc
    global_load_dword v108, v[106:107], off
    v_add_u32 v104, 32768, v105
    v_min_u32 v104, L_code_end - L_pc0 - 4, v104
    v_mov_b32 v107, s73
    v_add_co_u32 v106, vcc, s72, v104
    v_addc_co_u32 v107, vcc, 0, v107, vcc
    global_load_dword v108, v[106:107], off
    v_add_u32 v104, 65536, v105
    v_min_u32 v104, L_code_end - L_pc0 - 4, v104
    v_mov_b32 v107, s73
    v_add_co_u32 v106, vcc, s72, v104
    v_addc_co_u32 v107, vcc, 0, v107, vcc
    global_load_dword v108, v[106:107], off
    v_and_b32 v1, 63, v0
    v_lshrrev_b32 v2, 6, v0
    s_nop 0
    v_readfirstlane_b32 s20, v2
    s_waitcnt lgkmcnt(0)
    s_and_b32 s48, s20, 1
    s_lshr_b32 s35, s20, 1
    s_cmp_ge_u32 s2, 128
    s_cselect_b32 s36, s56, s36
    s_cselect_b32 s37, s57, s37
    s_cselect_b32 s38, s58, s38
    s_cselect_b32 s39, s59, s39
    s_cselect_b32 s40, s60, s40
    s_cselect_b32 s41, s61, s41
    s_cselect_b32 s42, s62, s42
    s_cselect_b32 s43, s63, s43
    s_cselect_b32 s84, s86, s84
    s_cselect_b32 s85, s87, s85
    s_mov_b32 s86, 5242880
    s_mov_b32 s87, 0x20000
    s_and_b32 s28, s2, 127
    s_lshl_b32 s29, s28, 20
    s_lshl_b32 s30, s35, 18
    s_add_u32 s29, s29, s30
    s_add_u32 s38, s38, s29
    s_addc_u32 s39, s39, 0
    s_add_u32 s40, s40, s29
    s_addc_u32 s41, s41, 0
    s_sub_u32 s30, 0x100000, s30
    s_mov_b32 s8, s38
    s_mov_b32 s9, s39
    s_mov_b32 s10, s30
    s_mov_b32 s11, 0x20000
    s_cmp_eq_u32 s48, 0
    s_cselect_b32 s4, s38, s40
    s_cselect_b32 s5, s39, s41
    s_mov_b32 s6, s30
    s_mov_b32 s7, 0x20000
    s_cselect_b32 s16, s42, s36
    s_cselect_b32 s17, s43, s37
    s_mov_b32 s28, 5242880
    s_mov_b32 s29, 4587520
    s_cselect_b32 s18, s28, s29
    s_mov_b32 s19, 0x20000
    s_mov_b32 s28, 262144
    s_mov_b32 s29, 64
    s_cselect_b32 s51, s28, s29
    s_cselect_b32 s52, 512, 0
    s_cselect_b32 s46, 128, 64
    s_mov_b32 s28, 1056
    s_mov_b32 s29, 1024
    s_cselect_b32 s53, s28, s29
    s_mov_b32 s28, 0
    s_mov_b32 s29, 0
    s_cselect_b32 s88, s28, s29
    s_mov_b32 s28, 8192
    s_mov_b32 s29, 20480
    s_cselect_b32 s89, s28, s29
    s_mov_b32 s28, 16384
    s_mov_b32 s29, 40960
    s_cselect_b32 s90, s28, s29
    s_mov_b32 s28, 24576
    s_mov_b32 s29, 61440
    s_cselect_b32 s91, s28, s29
    s_mov_b32 s28, 65536
    s_mov_b32 s29, 81920
    s_cselect_b32 s92, s28, s29
    s_mov_b32 s28, 73728
    s_mov_b32 s29, 102400
    s_cselect_b32 s93, s28, s29
    s_mov_b32 s28, 81920
    s_mov_b32 s29, 122880
    s_cselect_b32 s94, s28, s29
    s_mov_b32 s28, 90112
    s_mov_b32 s29, 1073741824
    s_cselect_b32 s95, s28, s29
    s_and_b32 s28, s2, 7
    s_lshl_b32 s28, s28, 2
    s_add_u32 s28, s28, s35
    s_lshl_b32 s28, s28, 8
    s_bfe_u32 s29, s2, 262147
    s_lshl_b32 s29, s29, 1
    s_add_u32 s29, s29, s35
    s_mul_i32 s29, s29, 143360
    s_cmp_eq_u32 s48, 0
    s_cselect_b32 s55, s28, s29
    s_add_u32 s12, s44, 0
    s_addc_u32 s13, s45, 0
    s_mov_b32 s14, 127926272
    s_mov_b32 s15, 0x20000
    s_lshl_b32 s28, s2, 2
    s_add_u32 s28, s28, s35
    s_mul_i32 s24, s28, 57344
    s_mul_i32 s28, s48, 28672
    s_add_u32 s24, s24, s28
    s_add_u32 s24, s24, 58720256
    s_mov_b32 s23, -1
    s_mov_b32 s60, s42
    s_mov_b32 s61, s43
    s_mov_b32 s62, 5242880
    s_mov_b32 s63, 0x20000
    s_mov_b32 s27, 0
    s_mov_b32 s25, 0
    s_mov_b32 s68, 0
    s_mov_b32 s71, 0
    s_lshr_b32 s26, s2, 3
    s_lshr_b32 s28, s2, 1
    s_add_u32 s26, s26, s28
    s_and_b32 s26, s26, 3
    s_mul_i32 s26, s26, 5
    s_and_b32 s26, s26, 30
    s_mul_i32 s83, s51, 20
    s_and_b32 s69, s2, 1
    s_min_u32 s69, s69, 1
    s_bfe_u32 s3, s2, 0x10005
    s_xor_b32 s3, s3, 1
    s_and_b32 s69, s2, s3
    s_nop 0
    s_mov_b32 s70, s69
    s_mov_b32 s32, 0x4e800000
    s_mov_b32 s54, 0x3e0293ee
    s_lshl_b32 s28, s48, 1
    s_add_u32 s28, s28, s35
    s_mul_i32 s33, s28, 33792
    v_lshlrev_b32 v6, 4, v1
    v_lshrrev_b32 v2, 4, v1
    v_and_b32 v3, 15, v1
    v_lshlrev_b32 v4, 4, v3
    v_lshl_add_u32 v7, v2, 14, v4
    v_and_b32 v26, 7, v1
    v_lshlrev_b32 v26, 4, v26
    v_bfe_u32 v5, v1, 3, 1
    v_lshl_add_u32 v26, v5, 15, v26
    v_bfe_u32 v5, v1, 4, 1
    v_lshl_add_u32 v26, v5, 17, v26
    v_bfe_u32 v5, v1, 5, 1
    v_lshl_add_u32 v26, v5, 18, v26
    v_mul_u32_u24 v27, 1280, v3
    v_lshl_add_u32 v27, v2, 4, v27
    v_lshrrev_b32 v5, 4, v1
    v_and_b32 v27, 1, v5
    v_lshlrev_b32 v27, 1, v27
    v_lshrrev_b32 v5, 1, v5
    v_mul_u32_u24 v5, 3, v5
    v_xor_b32 v27, v27, v5
    v_and_b32 v5, 3, v1
    v_xor_b32 v27, v27, v5
    v_lshlrev_b32 v27, 4, v27
    v_lshrrev_b32 v5, 2, v1
    v_mul_u32_u24 v5, 1280, v5
    v_add_u32 v27, v27, v5
    s_cmp_eq_u32 s48, 0
    s_cselect_b64 vcc, -1, 0
    s_nop 1
    v_cndmask_b32 v26, v27, v26, vcc
    s_add_u32 s28, s48, 2
    s_mul_i32 s28, s28, 33792
    v_bfe_u32 v5, v1, 2, 2
    v_and_b32 v27, 1, v5
    v_lshlrev_b32 v27, 1, v27
    v_lshrrev_b32 v5, 1, v5
    v_mul_u32_u24 v5, 3, v5
    v_xor_b32 v27, v27, v5
    v_xor_b32 v27, v27, v2
    v_lshlrev_b32 v27, 4, v27
    v_lshl_add_u32 v27, v3, 6, v27
    v_add_u32 v27, s28, v27
    v_bfe_u32 v5, v1, 4, 1
    v_lshl_add_u32 v4, v5, 9, v4
    v_bfe_u32 v5, v1, 5, 1
    v_lshl_add_u32 v10, v5, 8, v4
    v_and_b32 v4, 7, v3
    v_lshlrev_b32 v8, 10, v4
    v_and_b32 v5, 1, v3
    v_lshl_add_u32 v8, v5, 4, v8
    v_bfe_u32 v5, v3, 1, 2
    v_lshl_add_u32 v8, v5, 6, v8
    v_lshrrev_b32 v5, 3, v3
    v_lshl_add_u32 v8, v5, 8, v8
    v_bfe_u32 v5, v1, 4, 1
    v_lshl_add_u32 v8, v5, 5, v8
    v_bfe_u32 v5, v1, 5, 1
    v_lshl_add_u32 v8, v5, 4, v8
    s_mul_i32 s28, s35, 33792
    v_add_u32 v8, s28, v8
    v_bfe_u32 v3, v1, 2, 2
    v_bfe_u32 v5, v1, 4, 1
    v_lshl_add_u32 v4, v5, 2, v3
    v_mul_u32_u24 v4, 1056, v4
    v_bfe_u32 v5, v1, 5, 1
    v_lshl_add_u32 v4, v5, 8, v4
    v_and_b32 v5, 3, v1
    v_lshl_add_u32 v4, v5, 3, v4
    v_add_u32 v11, s28, v4
    v_lshl_add_u32 v3, v2, 2, v3
    v_and_b32 v4, 7, v3
    v_mul_u32_u24 v4, 1056, v4
    v_lshrrev_b32 v5, 3, v3
    v_lshl_add_u32 v4, v5, 8, v4
    v_and_b32 v5, 3, v1
    v_lshl_add_u32 v4, v5, 3, v4
    s_add_u32 s28, s28, 67584
    v_add_u32 v9, s28, v4
    v_mov_b32 v12, 0xff800000
    v_mov_b32 v14, 0xff800000
    v_mov_b32 v16, 0xff800000
    v_mov_b32 v18, 0xff800000
    v_mov_b32 v20, 0xff800000
    v_mov_b32 v22, 0xff800000
    v_mov_b32 v24, 0xff800000
    v_mov_b32 v2, 0x3f803f80
    v_accvgpr_write_b32 a252, v2
    v_accvgpr_write_b32 a253, v2
    v_accvgpr_write_b32 a254, v2
    v_accvgpr_write_b32 a255, v2
    v_and_b32 v2, 3, v1
    v_lshlrev_b32 v2, 2, v2
    v_add_u32 v2, 76000, v2
    v_mov_b32 v3, 0
    ds_write_b32 v2, v3
    s_cmp_eq_u32 s48, 0
    s_mov_b32 s28, 784
    s_mov_b32 s29, 800
    s_cselect_b32 s96, s28, s29
    s_mov_b32 s28, 816
    s_cselect_b32 s97, s28, s29
    v_lshrrev_b32 v2, 1, v1
    v_lshlrev_b32 v2, 13, v2
    v_and_b32 v3, 1, v1
    v_lshl_add_u32 v2, v3, 7, v2
    v_lshlrev_b32 v3, 7, v1
    s_bfe_u32 s28, s2, 0x20003
    s_lshl_b32 s28, s28, 18
    s_and_b32 s29, s2, 7
    s_mul_i32 s29, s29, 17920
    s_cmp_eq_u32 s48, 0
    s_cselect_b64 vcc, -1, 0
    s_cselect_b32 s100, s28, s29
    s_add_u32 s100, s100, s55
    s_cmp_eq_u32 s48, 0
    s_mov_b32 s28, 1048576
    s_mov_b32 s29, 8192
    s_cselect_b32 s99, s28, s29
    v_cndmask_b32 v6, v3, v2, vcc
    s_mul_i32 s100, s2, 11
    s_lshr_b32 s28, s2, 5
    s_mul_i32 s28, s28, 7
    s_add_u32 s100, s100, s28
    s_lshl_b32 s28, s35, 4
    s_add_u32 s100, s100, s28
    s_and_b32 s100, s100, 31
L_at_start:
    s_mov_b32 s21, s27
    s_lshl_b32 s34, s27, 5
    s_add_u32 s31, s21, s70
    s_mul_i32 s50, s31, s52
    s_mov_b32 s101, s31
    s_add_u32 s50, s50, s55
    s_cmp_ge_u32 s31, 2
    s_cselect_b32 s28, 0x40000000, 0
    s_add_u32 s50, s50, s28
    s_mov_b32 s82, s26
    s_mul_i32 s28, s26, s51
    s_add_u32 s50, s50, s28
    s_add_u32 m0, s33, 0
    s_mov_b32 s49, s50
    s_add_u32 s28, s49, s88
    buffer_load_dwordx4 v26, s[16:19], s28 offen lds
    s_add_u32 m0, m0, s53
    s_add_u32 s28, s49, s89
    buffer_load_dwordx4 v26, s[16:19], s28 offen lds
    s_add_u32 m0, m0, s53
    s_add_u32 s28, s49, s90
    buffer_load_dwordx4 v26, s[16:19], s28 offen lds
    s_add_u32 m0, m0, s53
    s_add_u32 s28, s49, s91
    buffer_load_dwordx4 v26, s[16:19], s28 offen lds
    s_add_u32 m0, m0, s53
    s_add_u32 s28, s49, s92
    buffer_load_dwordx4 v26, s[16:19], s28 offen lds
    s_add_u32 m0, m0, s53
    s_add_u32 s28, s49, s93
    buffer_load_dwordx4 v26, s[16:19], s28 offen lds
    s_add_u32 m0, m0, s53
    s_add_u32 s28, s49, s94
    buffer_load_dwordx4 v26, s[16:19], s28 offen lds
    s_add_u32 m0, m0, s53
    s_add_u32 s28, s49, s95
    buffer_load_dwordx4 v26, s[16:19], s28 offen lds
    s_add_u32 m0, s33, 8448
    s_add_u32 s49, s50, s46
    s_lshl1_add_u32 s50, s51, s50
    s_add_u32 s82, s82, 2
    s_cmp_eq_u32 s82, 20
    s_cselect_b32 s29, s83, 0
    s_sub_u32 s50, s50, s29
    s_add_u32 s28, s49, s88
    buffer_load_dwordx4 v26, s[16:19], s28 offen lds
    s_add_u32 m0, m0, s53
    s_add_u32 s28, s49, s89
    buffer_load_dwordx4 v26, s[16:19], s28 offen lds
    s_add_u32 m0, m0, s53
    s_add_u32 s28, s49, s90
    buffer_load_dwordx4 v26, s[16:19], s28 offen lds
    s_add_u32 m0, m0, s53
    s_add_u32 s28, s49, s91
    buffer_load_dwordx4 v26, s[16:19], s28 offen lds
    s_add_u32 m0, m0, s53
    s_add_u32 s28, s49, s92
    buffer_load_dwordx4 v26, s[16:19], s28 offen lds
    s_add_u32 m0, m0, s53
    s_add_u32 s28, s49, s93
    buffer_load_dwordx4 v26, s[16:19], s28 offen lds
    s_add_u32 m0, m0, s53
    s_add_u32 s28, s49, s94
    buffer_load_dwordx4 v26, s[16:19], s28 offen lds
    s_add_u32 m0, m0, s53
    s_add_u32 s28, s49, s95
    buffer_load_dwordx4 v26, s[16:19], s28 offen lds
    s_add_u32 m0, s33, 16896
    s_mov_b32 s49, s50
    s_add_u32 s28, s49, s88
    buffer_load_dwordx4 v26, s[16:19], s28 offen lds
    s_add_u32 m0, m0, s53
    s_add_u32 s28, s49, s89
    buffer_load_dwordx4 v26, s[16:19], s28 offen lds
    s_add_u32 m0, m0, s53
    s_add_u32 s28, s49, s90
    buffer_load_dwordx4 v26, s[16:19], s28 offen lds
    s_add_u32 m0, m0, s53
    s_add_u32 s28, s49, s91
    buffer_load_dwordx4 v26, s[16:19], s28 offen lds
    s_add_u32 m0, m0, s53
    s_add_u32 s28, s49, s92
    buffer_load_dwordx4 v26, s[16:19], s28 offen lds
    s_add_u32 m0, m0, s53
    s_add_u32 s28, s49, s93
    buffer_load_dwordx4 v26, s[16:19], s28 offen lds
    s_add_u32 m0, m0, s53
    s_add_u32 s28, s49, s94
    buffer_load_dwordx4 v26, s[16:19], s28 offen lds
    s_add_u32 m0, m0, s53
    s_add_u32 s28, s49, s95
    buffer_load_dwordx4 v26, s[16:19], s28 offen lds
    s_add_u32 m0, s33, 25344
    s_add_u32 s49, s50, s46
    s_lshl1_add_u32 s50, s51, s50
    s_add_u32 s82, s82, 2
    s_cmp_eq_u32 s82, 20
    s_cselect_b32 s29, s83, 0
    s_sub_u32 s50, s50, s29
    s_add_u32 s28, s49, s88
    buffer_load_dwordx4 v26, s[16:19], s28 offen lds
    s_add_u32 m0, m0, s53
    s_add_u32 s28, s49, s89
    buffer_load_dwordx4 v26, s[16:19], s28 offen lds
    s_add_u32 m0, m0, s53
    s_add_u32 s28, s49, s90
    buffer_load_dwordx4 v26, s[16:19], s28 offen lds
    s_add_u32 m0, m0, s53
    s_add_u32 s28, s49, s91
    buffer_load_dwordx4 v26, s[16:19], s28 offen lds
    s_add_u32 m0, m0, s53
    s_add_u32 s28, s49, s92
    buffer_load_dwordx4 v26, s[16:19], s28 offen lds
    s_add_u32 m0, m0, s53
    s_add_u32 s28, s49, s93
    buffer_load_dwordx4 v26, s[16:19], s28 offen lds
    s_add_u32 m0, m0, s53
    s_add_u32 s28, s49, s94
    buffer_load_dwordx4 v26, s[16:19], s28 offen lds
    s_add_u32 m0, m0, s53
    s_add_u32 s28, s49, s95
    buffer_load_dwordx4 v26, s[16:19], s28 offen lds
    s_waitcnt vmcnt(16) lgkmcnt(0)
    s_barrier
L_at_round:
    ds_read_b64_tr_b16 v[112:113], v11 offset:0
    ds_read_b64_tr_b16 v[114:115], v11 offset:128
    ds_read_b64_tr_b16 v[116:117], v11 offset:512
    ds_read_b64_tr_b16 v[118:119], v11 offset:640
    ds_read_b64_tr_b16 v[120:121], v11 offset:32
    ds_read_b64_tr_b16 v[122:123], v11 offset:160
    ds_read_b64_tr_b16 v[124:125], v11 offset:544
    ds_read_b64_tr_b16 v[126:127], v11 offset:672
    ds_read_b64_tr_b16 v[128:129], v11 offset:64
    ds_read_b64_tr_b16 v[130:131], v11 offset:192
    ds_read_b64_tr_b16 v[132:133], v11 offset:576
    ds_read_b64_tr_b16 v[134:135], v11 offset:704
    ds_read_b64_tr_b16 v[136:137], v11 offset:96
    ds_read_b64_tr_b16 v[138:139], v11 offset:224
    ds_read_b64_tr_b16 v[140:141], v11 offset:608
    ds_read_b64_tr_b16 v[142:143], v11 offset:736
    ds_read_b128 v[28:31], v27 offset:0
    ds_read_b128 v[32:35], v27 offset:1024
    ds_read_b128 v[36:39], v27 offset:2048
    ds_read_b128 v[40:43], v27 offset:3072
    ds_read_b128 v[44:47], v27 offset:4096
    ds_read_b128 v[48:51], v27 offset:5120
    ds_read_b128 v[52:55], v27 offset:6144
    ds_read_b128 v[56:59], v27 offset:8448
    ds_read_b128 v[60:63], v27 offset:9472
    ds_read_b128 v[64:67], v27 offset:10496
    ds_read_b128 v[68:71], v27 offset:11520
    ds_read_b128 v[72:75], v27 offset:12544
    ds_read_b128 v[76:79], v27 offset:13568
    ds_read_b128 v[80:83], v27 offset:14592
    s_waitcnt lgkmcnt(0)
    s_waitcnt lgkmcnt(8)
    v_mfma_f32_16x16x32_bf16 v[144:147], v[112:115], v[28:31], 0
    s_add_u32 m0, s33, 0
    v_mfma_f32_16x16x32_bf16 v[144:147], v[116:119], v[56:59], v[144:147]
    s_mov_b32 s49, s50
    v_mfma_f32_16x16x32_bf16 v[148:151], v[112:115], v[32:35], 0
    v_mfma_f32_16x16x32_bf16 v[148:151], v[116:119], v[60:63], v[148:151]
    v_mfma_f32_16x16x32_bf16 v[152:155], v[112:115], v[36:39], 0
    v_mfma_f32_16x16x32_bf16 v[152:155], v[116:119], v[64:67], v[152:155]
    v_mfma_f32_16x16x32_bf16 v[156:159], v[112:115], v[40:43], 0
    s_cmp_eq_u32 s68, 0
    s_cbranch_scc0 L_bw1_453
    s_waitcnt vmcnt(16) lgkmcnt(0)
L_bw2_453:
    s_barrier
    s_cmp_le_u32 s21, s27
    s_cbranch_scc1 L_at_nofb_458
    s_sub_u32 s28, s21, 1
    s_cmp_eq_u32 s28, s23
    s_cbranch_scc1 L_at_nofb_458
    s_lshl_b32 s29, s28, 2
    s_add_u32 s29, s29, 76000
    v_mov_b32 v4, s29
    ds_read_b32 v4, v4
    s_waitcnt lgkmcnt(0)
    v_readfirstlane_b32 s29, v4
    s_nop 3
    s_cmp_lg_u32 s29, 0
    s_cbranch_scc1 L_at_fallback
L_at_nofb_458:
    v_mfma_f32_16x16x32_bf16 v[156:159], v[116:119], v[68:71], v[156:159]
    v_mfma_f32_16x16x32_bf16 v[160:163], v[112:115], v[44:47], 0
    v_mfma_f32_16x16x32_bf16 v[160:163], v[116:119], v[72:75], v[160:163]
    s_add_u32 s28, s49, s88
    buffer_load_dwordx4 v26, s[16:19], s28 offen lds
    v_mfma_f32_16x16x32_bf16 v[164:167], v[112:115], v[48:51], 0
    s_add_u32 m0, m0, s53
    v_mfma_f32_16x16x32_bf16 v[164:167], v[116:119], v[76:79], v[164:167]
    v_mfma_f32_16x16x32_bf16 v[168:171], v[112:115], v[52:55], 0
    v_mfma_f32_16x16x32_bf16 v[168:171], v[116:119], v[80:83], v[168:171]
    ds_read_b64_tr_b16 v[112:113], v11 offset:8448
    v_mfma_f32_16x16x32_bf16 v[172:175], v[120:123], v[28:31], 0
    ds_read_b64_tr_b16 v[114:115], v11 offset:8576
    v_mfma_f32_16x16x32_bf16 v[172:175], v[124:127], v[56:59], v[172:175]
    s_add_u32 s28, s49, s89
    buffer_load_dwordx4 v26, s[16:19], s28 offen lds
    v_mfma_f32_16x16x32_bf16 v[176:179], v[120:123], v[32:35], 0
    s_add_u32 m0, m0, s53
    ds_read_b64_tr_b16 v[116:117], v11 offset:8960
    v_mfma_f32_16x16x32_bf16 v[176:179], v[124:127], v[60:63], v[176:179]
    ds_read_b64_tr_b16 v[118:119], v11 offset:9088
    v_mfma_f32_16x16x32_bf16 v[180:183], v[120:123], v[36:39], 0
    v_mfma_f32_16x16x32_bf16 v[180:183], v[124:127], v[64:67], v[180:183]
    v_mfma_f32_16x16x32_bf16 v[184:187], v[120:123], v[40:43], 0
    v_mfma_f32_16x16x32_bf16 v[184:187], v[124:127], v[68:71], v[184:187]
    s_add_u32 s28, s49, s90
    buffer_load_dwordx4 v26, s[16:19], s28 offen lds
    v_mfma_f32_16x16x32_bf16 v[188:191], v[120:123], v[44:47], 0
    s_add_u32 m0, m0, s53
    v_mfma_f32_16x16x32_bf16 v[188:191], v[124:127], v[72:75], v[188:191]
    v_mfma_f32_16x16x32_bf16 v[192:195], v[120:123], v[48:51], 0
    v_mfma_f32_16x16x32_bf16 v[192:195], v[124:127], v[76:79], v[192:195]
    v_mfma_f32_16x16x32_bf16 v[196:199], v[120:123], v[52:55], 0
    v_mfma_f32_16x16x32_bf16 v[196:199], v[124:127], v[80:83], v[196:199]
    s_add_u32 s28, s49, s91
    buffer_load_dwordx4 v26, s[16:19], s28 offen lds
    v_mfma_f32_16x16x32_bf16 v[200:203], v[128:131], v[28:31], 0
    s_add_u32 m0, m0, s53
    ds_read_b64_tr_b16 v[120:121], v11 offset:8480
    v_mfma_f32_16x16x32_bf16 v[200:203], v[132:135], v[56:59], v[200:203]
    ds_read_b64_tr_b16 v[122:123], v11 offset:8608
    v_mfma_f32_16x16x32_bf16 v[204:207], v[128:131], v[32:35], 0
    ds_read_b64_tr_b16 v[124:125], v11 offset:8992
    v_mfma_f32_16x16x32_bf16 v[204:207], v[132:135], v[60:63], v[204:207]
    ds_read_b64_tr_b16 v[126:127], v11 offset:9120
    v_mfma_f32_16x16x32_bf16 v[208:211], v[128:131], v[36:39], 0
    v_mfma_f32_16x16x32_bf16 v[208:211], v[132:135], v[64:67], v[208:211]
    s_add_u32 s28, s49, s92
    buffer_load_dwordx4 v26, s[16:19], s28 offen lds
    v_mfma_f32_16x16x32_bf16 v[212:215], v[128:131], v[40:43], 0
    s_add_u32 m0, m0, s53
    v_mfma_f32_16x16x32_bf16 v[212:215], v[132:135], v[68:71], v[212:215]
    v_mfma_f32_16x16x32_bf16 v[216:219], v[128:131], v[44:47], 0
    v_mfma_f32_16x16x32_bf16 v[216:219], v[132:135], v[72:75], v[216:219]
    v_mfma_f32_16x16x32_bf16 v[220:223], v[128:131], v[48:51], 0
    v_mfma_f32_16x16x32_bf16 v[220:223], v[132:135], v[76:79], v[220:223]
    s_add_u32 s28, s49, s93
    buffer_load_dwordx4 v26, s[16:19], s28 offen lds
    v_mfma_f32_16x16x32_bf16 v[224:227], v[128:131], v[52:55], 0
    s_add_u32 m0, m0, s53
    v_mfma_f32_16x16x32_bf16 v[224:227], v[132:135], v[80:83], v[224:227]
    ds_read_b64_tr_b16 v[128:129], v11 offset:8512
    v_mfma_f32_16x16x32_bf16 v[228:231], v[136:139], v[28:31], 0
    ds_read_b64_tr_b16 v[130:131], v11 offset:8640
    v_mfma_f32_16x16x32_bf16 v[228:231], v[140:143], v[56:59], v[228:231]
    ds_read_b64_tr_b16 v[132:133], v11 offset:9024
    v_mfma_f32_16x16x32_bf16 v[232:235], v[136:139], v[32:35], 0
    ds_read_b64_tr_b16 v[134:135], v11 offset:9152
    v_mfma_f32_16x16x32_bf16 v[232:235], v[140:143], v[60:63], v[232:235]
    s_add_u32 s28, s49, s94
    buffer_load_dwordx4 v26, s[16:19], s28 offen lds
    v_mfma_f32_16x16x32_bf16 v[236:239], v[136:139], v[36:39], 0
    s_add_u32 m0, m0, s53
    v_mfma_f32_16x16x32_bf16 v[236:239], v[140:143], v[64:67], v[236:239]
    v_mfma_f32_16x16x32_bf16 v[240:243], v[136:139], v[40:43], 0
    v_mfma_f32_16x16x32_bf16 v[240:243], v[140:143], v[68:71], v[240:243]
    v_mfma_f32_16x16x32_bf16 v[244:247], v[136:139], v[44:47], 0
    v_mfma_f32_16x16x32_bf16 v[244:247], v[140:143], v[72:75], v[244:247]
    s_add_u32 s28, s49, s95
    buffer_load_dwordx4 v26, s[16:19], s28 offen lds
    v_mfma_f32_16x16x32_bf16 v[248:251], v[136:139], v[48:51], 0
    v_mfma_f32_16x16x32_bf16 v[248:251], v[140:143], v[76:79], v[248:251]
    v_mfma_f32_16x16x32_bf16 v[252:255], v[136:139], v[52:55], 0
    v_mfma_f32_16x16x32_bf16 v[252:255], v[140:143], v[80:83], v[252:255]
    ds_read_b64_tr_b16 v[136:137], v11 offset:8544
    ds_read_b64_tr_b16 v[138:139], v11 offset:8672
    ds_read_b64_tr_b16 v[140:141], v11 offset:9056
    ds_read_b64_tr_b16 v[142:143], v11 offset:9184
    s_waitcnt lgkmcnt(8)
    v_mfma_f32_16x16x32_bf16 a[112:115], v[112:115], v[28:31], 0
    s_add_u32 m0, s33, 8448
    v_mfma_f32_16x16x32_bf16 a[112:115], v[116:119], v[56:59], a[112:115]
    s_add_u32 s49, s50, s46
    v_mfma_f32_16x16x32_bf16 a[116:119], v[112:115], v[32:35], 0
    s_lshl1_add_u32 s50, s51, s50
    v_mfma_f32_16x16x32_bf16 a[116:119], v[116:119], v[60:63], a[116:119]
    s_add_u32 s82, s82, 2
    v_mfma_f32_16x16x32_bf16 a[120:123], v[112:115], v[36:39], 0
    s_cmp_eq_u32 s82, 20
    v_mfma_f32_16x16x32_bf16 a[120:123], v[116:119], v[64:67], a[120:123]
    s_cselect_b32 s29, s83, 0
    v_mfma_f32_16x16x32_bf16 a[124:127], v[112:115], v[40:43], 0
    s_sub_u32 s50, s50, s29
    s_cmp_eq_u32 s68, 0
    s_cbranch_scc0 L_bw1_576
    s_waitcnt vmcnt(8) lgkmcnt(0)
L_bw2_576:
    s_barrier
    ds_read_b128 a[0:3], v27 offset:16896
    v_mfma_f32_16x16x32_bf16 a[124:127], v[116:119], v[68:71], a[124:127]
    ds_read_b128 a[4:7], v27 offset:17920
    v_mfma_f32_16x16x32_bf16 a[128:131], v[112:115], v[44:47], 0
    ds_read_b128 a[8:11], v27 offset:18944
    v_mfma_f32_16x16x32_bf16 a[128:131], v[116:119], v[72:75], a[128:131]
    s_add_u32 s28, s49, s88
    buffer_load_dwordx4 v26, s[16:19], s28 offen lds
    v_mfma_f32_16x16x32_bf16 a[132:135], v[112:115], v[48:51], 0
    s_add_u32 m0, m0, s53
    ds_read_b128 a[12:15], v27 offset:19968
    v_mfma_f32_16x16x32_bf16 a[132:135], v[116:119], v[76:79], a[132:135]
    ds_read_b128 a[16:19], v27 offset:20992
    v_mfma_f32_16x16x32_bf16 a[136:139], v[112:115], v[52:55], 0
    ds_read_b128 a[20:23], v27 offset:22016
    v_mfma_f32_16x16x32_bf16 a[136:139], v[116:119], v[80:83], a[136:139]
    ds_read_b128 a[24:27], v27 offset:23040
    v_mfma_f32_16x16x32_bf16 a[140:143], v[120:123], v[28:31], 0
    ds_read_b128 a[28:31], v27 offset:25344
    v_mfma_f32_16x16x32_bf16 a[140:143], v[124:127], v[56:59], a[140:143]
    s_add_u32 s28, s49, s89
    buffer_load_dwordx4 v26, s[16:19], s28 offen lds
    v_mfma_f32_16x16x32_bf16 a[144:147], v[120:123], v[32:35], 0
    s_add_u32 m0, m0, s53
    ds_read_b128 a[32:35], v27 offset:26368
    v_mfma_f32_16x16x32_bf16 a[144:147], v[124:127], v[60:63], a[144:147]
    ds_read_b128 a[36:39], v27 offset:27392
    v_mfma_f32_16x16x32_bf16 a[148:151], v[120:123], v[36:39], 0
    ds_read_b128 a[40:43], v27 offset:28416
    v_mfma_f32_16x16x32_bf16 a[148:151], v[124:127], v[64:67], a[148:151]
    ds_read_b128 a[44:47], v27 offset:29440
    v_mfma_f32_16x16x32_bf16 a[152:155], v[120:123], v[40:43], 0
    ds_read_b128 a[48:51], v27 offset:30464
    v_mfma_f32_16x16x32_bf16 a[152:155], v[124:127], v[68:71], a[152:155]
    s_add_u32 s28, s49, s90
    buffer_load_dwordx4 v26, s[16:19], s28 offen lds
    v_mfma_f32_16x16x32_bf16 a[156:159], v[120:123], v[44:47], 0
    s_add_u32 m0, m0, s53
    ds_read_b128 a[52:55], v27 offset:31488
    v_mfma_f32_16x16x32_bf16 a[156:159], v[124:127], v[72:75], a[156:159]
    ds_read_b64_tr_b16 v[112:113], v11 offset:16896
    v_mfma_f32_16x16x32_bf16 a[160:163], v[120:123], v[48:51], 0
    ds_read_b64_tr_b16 v[114:115], v11 offset:17024
    v_mfma_f32_16x16x32_bf16 a[160:163], v[124:127], v[76:79], a[160:163]
    ds_read_b64_tr_b16 v[116:117], v11 offset:17408
    v_mfma_f32_16x16x32_bf16 a[164:167], v[120:123], v[52:55], 0
    ds_read_b64_tr_b16 v[118:119], v11 offset:17536
    v_mfma_f32_16x16x32_bf16 a[164:167], v[124:127], v[80:83], a[164:167]
    s_add_u32 s28, s49, s91
    buffer_load_dwordx4 v26, s[16:19], s28 offen lds
    v_mfma_f32_16x16x32_bf16 a[168:171], v[128:131], v[28:31], 0
    s_add_u32 m0, m0, s53
    ds_read_b64_tr_b16 v[120:121], v11 offset:16928
    v_mfma_f32_16x16x32_bf16 a[168:171], v[132:135], v[56:59], a[168:171]
    ds_read_b64_tr_b16 v[122:123], v11 offset:17056
    v_mfma_f32_16x16x32_bf16 a[172:175], v[128:131], v[32:35], 0
    ds_read_b64_tr_b16 v[124:125], v11 offset:17440
    v_mfma_f32_16x16x32_bf16 a[172:175], v[132:135], v[60:63], a[172:175]
    ds_read_b64_tr_b16 v[126:127], v11 offset:17568
    v_mfma_f32_16x16x32_bf16 a[176:179], v[128:131], v[36:39], 0
    v_mfma_f32_16x16x32_bf16 a[176:179], v[132:135], v[64:67], a[176:179]
    s_add_u32 s28, s49, s92
    buffer_load_dwordx4 v26, s[16:19], s28 offen lds
    v_mfma_f32_16x16x32_bf16 a[180:183], v[128:131], v[40:43], 0
    s_add_u32 m0, m0, s53
    v_mfma_f32_16x16x32_bf16 a[180:183], v[132:135], v[68:71], a[180:183]
    v_mfma_f32_16x16x32_bf16 a[184:187], v[128:131], v[44:47], 0
    v_mfma_f32_16x16x32_bf16 a[184:187], v[132:135], v[72:75], a[184:187]
    v_mfma_f32_16x16x32_bf16 a[188:191], v[128:131], v[48:51], 0
    v_mfma_f32_16x16x32_bf16 a[188:191], v[132:135], v[76:79], a[188:191]
    s_add_u32 s28, s49, s93
    buffer_load_dwordx4 v26, s[16:19], s28 offen lds
    v_mfma_f32_16x16x32_bf16 a[192:195], v[128:131], v[52:55], 0
    s_add_u32 m0, m0, s53
    v_mfma_f32_16x16x32_bf16 a[192:195], v[132:135], v[80:83], a[192:195]
    ds_read_b64_tr_b16 v[128:129], v11 offset:16960
    v_mfma_f32_16x16x32_bf16 a[196:199], v[136:139], v[28:31], 0
    ds_read_b64_tr_b16 v[130:131], v11 offset:17088
    v_mfma_f32_16x16x32_bf16 a[196:199], v[140:143], v[56:59], a[196:199]
    ds_read_b64_tr_b16 v[132:133], v11 offset:17472
    v_mfma_f32_16x16x32_bf16 a[200:203], v[136:139], v[32:35], 0
    ds_read_b64_tr_b16 v[134:135], v11 offset:17600
    v_mfma_f32_16x16x32_bf16 a[200:203], v[140:143], v[60:63], a[200:203]
    s_add_u32 s28, s49, s94
    buffer_load_dwordx4 v26, s[16:19], s28 offen lds
    v_mfma_f32_16x16x32_bf16 a[204:207], v[136:139], v[36:39], 0
    s_add_u32 m0, m0, s53
    v_mfma_f32_16x16x32_bf16 a[204:207], v[140:143], v[64:67], a[204:207]
    v_mfma_f32_16x16x32_bf16 a[208:211], v[136:139], v[40:43], 0
    v_mfma_f32_16x16x32_bf16 a[208:211], v[140:143], v[68:71], a[208:211]
    v_mfma_f32_16x16x32_bf16 a[212:215], v[136:139], v[44:47], 0
    v_mfma_f32_16x16x32_bf16 a[212:215], v[140:143], v[72:75], a[212:215]
    s_add_u32 s28, s49, s95
    buffer_load_dwordx4 v26, s[16:19], s28 offen lds
    v_mfma_f32_16x16x32_bf16 a[216:219], v[136:139], v[48:51], 0
    v_mfma_f32_16x16x32_bf16 a[216:219], v[140:143], v[76:79], a[216:219]
    v_mfma_f32_16x16x32_bf16 a[220:223], v[136:139], v[52:55], 0
    v_mfma_f32_16x16x32_bf16 a[220:223], v[140:143], v[80:83], a[220:223]
    ds_read_b64_tr_b16 v[136:137], v11 offset:16992
    ds_read_b64_tr_b16 v[138:139], v11 offset:17120
    ds_read_b64_tr_b16 v[140:141], v11 offset:17504
    ds_read_b64_tr_b16 v[142:143], v11 offset:17632
    s_waitcnt lgkmcnt(8)
    v_mfma_f32_16x16x32_bf16 v[144:147], v[112:115], a[0:3], v[144:147]
    s_add_u32 m0, s33, 16896
    v_mfma_f32_16x16x32_bf16 v[144:147], v[116:119], a[28:31], v[144:147]
    s_mov_b32 s49, s50
    v_mfma_f32_16x16x32_bf16 v[148:151], v[112:115], a[4:7], v[148:151]
    v_mfma_f32_16x16x32_bf16 v[148:151], v[116:119], a[32:35], v[148:151]
    v_mfma_f32_16x16x32_bf16 v[152:155], v[112:115], a[8:11], v[152:155]
    v_mfma_f32_16x16x32_bf16 v[152:155], v[116:119], a[36:39], v[152:155]
    v_mfma_f32_16x16x32_bf16 v[156:159], v[112:115], a[12:15], v[156:159]
    s_cmp_eq_u32 s68, 0
    s_cbranch_scc0 L_bw1_693
    s_waitcnt vmcnt(16) lgkmcnt(0)
L_bw2_693:
    s_barrier
    v_mfma_f32_16x16x32_bf16 v[156:159], v[116:119], a[40:43], v[156:159]
    v_mfma_f32_16x16x32_bf16 v[160:163], v[112:115], a[16:19], v[160:163]
    v_mfma_f32_16x16x32_bf16 v[160:163], v[116:119], a[44:47], v[160:163]
    s_add_u32 s28, s49, s88
    buffer_load_dwordx4 v26, s[16:19], s28 offen lds
    v_mfma_f32_16x16x32_bf16 v[164:167], v[112:115], a[20:23], v[164:167]
    s_add_u32 m0, m0, s53
    v_mfma_f32_16x16x32_bf16 v[164:167], v[116:119], a[48:51], v[164:167]
    v_mfma_f32_16x16x32_bf16 v[168:171], v[112:115], a[24:27], v[168:171]
    v_mfma_f32_16x16x32_bf16 v[168:171], v[116:119], a[52:55], v[168:171]
    ds_read_b64_tr_b16 v[112:113], v11 offset:25344
    v_mfma_f32_16x16x32_bf16 v[172:175], v[120:123], a[0:3], v[172:175]
    ds_read_b64_tr_b16 v[114:115], v11 offset:25472
    v_mfma_f32_16x16x32_bf16 v[172:175], v[124:127], a[28:31], v[172:175]
    s_add_u32 s28, s49, s89
    buffer_load_dwordx4 v26, s[16:19], s28 offen lds
    v_mfma_f32_16x16x32_bf16 v[176:179], v[120:123], a[4:7], v[176:179]
    s_add_u32 m0, m0, s53
    ds_read_b64_tr_b16 v[116:117], v11 offset:25856
    v_mfma_f32_16x16x32_bf16 v[176:179], v[124:127], a[32:35], v[176:179]
    ds_read_b64_tr_b16 v[118:119], v11 offset:25984
    v_mfma_f32_16x16x32_bf16 v[180:183], v[120:123], a[8:11], v[180:183]
    v_mfma_f32_16x16x32_bf16 v[180:183], v[124:127], a[36:39], v[180:183]
    v_mfma_f32_16x16x32_bf16 v[184:187], v[120:123], a[12:15], v[184:187]
    v_mfma_f32_16x16x32_bf16 v[184:187], v[124:127], a[40:43], v[184:187]
    s_add_u32 s28, s49, s90
    buffer_load_dwordx4 v26, s[16:19], s28 offen lds
    v_mfma_f32_16x16x32_bf16 v[188:191], v[120:123], a[16:19], v[188:191]
    s_add_u32 m0, m0, s53
    v_mfma_f32_16x16x32_bf16 v[188:191], v[124:127], a[44:47], v[188:191]
    v_mfma_f32_16x16x32_bf16 v[192:195], v[120:123], a[20:23], v[192:195]
    v_mfma_f32_16x16x32_bf16 v[192:195], v[124:127], a[48:51], v[192:195]
    v_mfma_f32_16x16x32_bf16 v[196:199], v[120:123], a[24:27], v[196:199]
    v_mfma_f32_16x16x32_bf16 v[196:199], v[124:127], a[52:55], v[196:199]
    s_add_u32 s28, s49, s91
    buffer_load_dwordx4 v26, s[16:19], s28 offen lds
    v_mfma_f32_16x16x32_bf16 v[200:203], v[128:131], a[0:3], v[200:203]
    s_add_u32 m0, m0, s53
    ds_read_b64_tr_b16 v[120:121], v11 offset:25376
    v_mfma_f32_16x16x32_bf16 v[200:203], v[132:135], a[28:31], v[200:203]
    ds_read_b64_tr_b16 v[122:123], v11 offset:25504
    v_mfma_f32_16x16x32_bf16 v[204:207], v[128:131], a[4:7], v[204:207]
    ds_read_b64_tr_b16 v[124:125], v11 offset:25888
    v_mfma_f32_16x16x32_bf16 v[204:207], v[132:135], a[32:35], v[204:207]
    ds_read_b64_tr_b16 v[126:127], v11 offset:26016
    v_mfma_f32_16x16x32_bf16 v[208:211], v[128:131], a[8:11], v[208:211]
    v_mfma_f32_16x16x32_bf16 v[208:211], v[132:135], a[36:39], v[208:211]
    s_add_u32 s28, s49, s92
    buffer_load_dwordx4 v26, s[16:19], s28 offen lds
    v_mfma_f32_16x16x32_bf16 v[212:215], v[128:131], a[12:15], v[212:215]
    s_add_u32 m0, m0, s53
    v_mfma_f32_16x16x32_bf16 v[212:215], v[132:135], a[40:43], v[212:215]
    v_mfma_f32_16x16x32_bf16 v[216:219], v[128:131], a[16:19], v[216:219]
    v_mfma_f32_16x16x32_bf16 v[216:219], v[132:135], a[44:47], v[216:219]
    v_mfma_f32_16x16x32_bf16 v[220:223], v[128:131], a[20:23], v[220:223]
    v_mfma_f32_16x16x32_bf16 v[220:223], v[132:135], a[48:51], v[220:223]
    s_add_u32 s28, s49, s93
    buffer_load_dwordx4 v26, s[16:19], s28 offen lds
    v_mfma_f32_16x16x32_bf16 v[224:227], v[128:131], a[24:27], v[224:227]
    s_add_u32 m0, m0, s53
    v_mfma_f32_16x16x32_bf16 v[224:227], v[132:135], a[52:55], v[224:227]
    ds_read_b64_tr_b16 v[128:129], v11 offset:25408
    v_mfma_f32_16x16x32_bf16 v[228:231], v[136:139], a[0:3], v[228:231]
    ds_read_b64_tr_b16 v[130:131], v11 offset:25536
    v_mfma_f32_16x16x32_bf16 v[228:231], v[140:143], a[28:31], v[228:231]
    ds_read_b64_tr_b16 v[132:133], v11 offset:25920
    v_mfma_f32_16x16x32_bf16 v[232:235], v[136:139], a[4:7], v[232:235]
    ds_read_b64_tr_b16 v[134:135], v11 offset:26048
    v_mfma_f32_16x16x32_bf16 v[232:235], v[140:143], a[32:35], v[232:235]
    s_add_u32 s28, s49, s94
    buffer_load_dwordx4 v26, s[16:19], s28 offen lds
    v_mfma_f32_16x16x32_bf16 v[236:239], v[136:139], a[8:11], v[236:239]
    s_add_u32 m0, m0, s53
    v_mfma_f32_16x16x32_bf16 v[236:239], v[140:143], a[36:39], v[236:239]
    v_mfma_f32_16x16x32_bf16 v[240:243], v[136:139], a[12:15], v[240:243]
    v_mfma_f32_16x16x32_bf16 v[240:243], v[140:143], a[40:43], v[240:243]
    v_mfma_f32_16x16x32_bf16 v[244:247], v[136:139], a[16:19], v[244:247]
    v_mfma_f32_16x16x32_bf16 v[244:247], v[140:143], a[44:47], v[244:247]
    s_add_u32 s28, s49, s95
    buffer_load_dwordx4 v26, s[16:19], s28 offen lds
    v_mfma_f32_16x16x32_bf16 v[248:251], v[136:139], a[20:23], v[248:251]
    v_mfma_f32_16x16x32_bf16 v[248:251], v[140:143], a[48:51], v[248:251]
    v_mfma_f32_16x16x32_bf16 v[252:255], v[136:139], a[24:27], v[252:255]
    v_mfma_f32_16x16x32_bf16 v[252:255], v[140:143], a[52:55], v[252:255]
    ds_read_b64_tr_b16 v[136:137], v11 offset:25440
    ds_read_b64_tr_b16 v[138:139], v11 offset:25568
    ds_read_b64_tr_b16 v[140:141], v11 offset:25952
    ds_read_b64_tr_b16 v[142:143], v11 offset:26080
    s_waitcnt lgkmcnt(8)
    v_mfma_f32_16x16x32_bf16 a[112:115], v[112:115], a[0:3], a[112:115]
    s_add_u32 m0, s33, 25344
    v_mfma_f32_16x16x32_bf16 a[112:115], v[116:119], a[28:31], a[112:115]
    s_add_u32 s49, s50, s46
    v_mfma_f32_16x16x32_bf16 a[116:119], v[112:115], a[4:7], a[116:119]
    s_lshl1_add_u32 s50, s51, s50
    v_mfma_f32_16x16x32_bf16 a[116:119], v[116:119], a[32:35], a[116:119]
    s_add_u32 s82, s82, 2
    v_mfma_f32_16x16x32_bf16 a[120:123], v[112:115], a[8:11], a[120:123]
    s_cmp_eq_u32 s82, 20
    v_mfma_f32_16x16x32_bf16 a[120:123], v[116:119], a[36:39], a[120:123]
    s_cselect_b32 s29, s83, 0
    v_mfma_f32_16x16x32_bf16 a[124:127], v[112:115], a[12:15], a[124:127]
    s_sub_u32 s50, s50, s29
    s_waitcnt vmcnt(8) lgkmcnt(0)
    s_barrier
    ds_read_b128 v[28:31], v27 offset:0
    v_mfma_f32_16x16x32_bf16 a[124:127], v[116:119], a[40:43], a[124:127]
    ds_read_b128 v[32:35], v27 offset:1024
    v_mfma_f32_16x16x32_bf16 a[128:131], v[112:115], a[16:19], a[128:131]
    ds_read_b128 v[36:39], v27 offset:2048
    v_mfma_f32_16x16x32_bf16 a[128:131], v[116:119], a[44:47], a[128:131]
    s_add_u32 s28, s49, s88
    buffer_load_dwordx4 v26, s[16:19], s28 offen lds
    v_mfma_f32_16x16x32_bf16 a[132:135], v[112:115], a[20:23], a[132:135]
    s_add_u32 m0, m0, s53
    ds_read_b128 v[40:43], v27 offset:3072
    v_mfma_f32_16x16x32_bf16 a[132:135], v[116:119], a[48:51], a[132:135]
    ds_read_b128 v[44:47], v27 offset:4096
    v_mfma_f32_16x16x32_bf16 a[136:139], v[112:115], a[24:27], a[136:139]
    ds_read_b128 v[48:51], v27 offset:5120
    v_mfma_f32_16x16x32_bf16 a[136:139], v[116:119], a[52:55], a[136:139]
    ds_read_b128 v[52:55], v27 offset:6144
    v_mfma_f32_16x16x32_bf16 a[140:143], v[120:123], a[0:3], a[140:143]
    ds_read_b128 v[56:59], v27 offset:8448
    v_mfma_f32_16x16x32_bf16 a[140:143], v[124:127], a[28:31], a[140:143]
    s_add_u32 s28, s49, s89
    buffer_load_dwordx4 v26, s[16:19], s28 offen lds
    v_mfma_f32_16x16x32_bf16 a[144:147], v[120:123], a[4:7], a[144:147]
    s_add_u32 m0, m0, s53
    ds_read_b128 v[60:63], v27 offset:9472
    v_mfma_f32_16x16x32_bf16 a[144:147], v[124:127], a[32:35], a[144:147]
    ds_read_b128 v[64:67], v27 offset:10496
    v_mfma_f32_16x16x32_bf16 a[148:151], v[120:123], a[8:11], a[148:151]
    ds_read_b128 v[68:71], v27 offset:11520
    v_mfma_f32_16x16x32_bf16 a[148:151], v[124:127], a[36:39], a[148:151]
    ds_read_b128 v[72:75], v27 offset:12544
    v_mfma_f32_16x16x32_bf16 a[152:155], v[120:123], a[12:15], a[152:155]
    ds_read_b128 v[76:79], v27 offset:13568
    v_mfma_f32_16x16x32_bf16 a[152:155], v[124:127], a[40:43], a[152:155]
    s_add_u32 s28, s49, s90
    buffer_load_dwordx4 v26, s[16:19], s28 offen lds
    v_mfma_f32_16x16x32_bf16 a[156:159], v[120:123], a[16:19], a[156:159]
    s_add_u32 m0, m0, s53
    ds_read_b128 v[80:83], v27 offset:14592
    v_mfma_f32_16x16x32_bf16 a[156:159], v[124:127], a[44:47], a[156:159]
    ds_read_b64_tr_b16 v[112:113], v11 offset:0
    v_mfma_f32_16x16x32_bf16 a[160:163], v[120:123], a[20:23], a[160:163]
    ds_read_b64_tr_b16 v[114:115], v11 offset:128
    v_mfma_f32_16x16x32_bf16 a[160:163], v[124:127], a[48:51], a[160:163]
    ds_read_b64_tr_b16 v[116:117], v11 offset:512
    v_mfma_f32_16x16x32_bf16 a[164:167], v[120:123], a[24:27], a[164:167]
    ds_read_b64_tr_b16 v[118:119], v11 offset:640
    v_mfma_f32_16x16x32_bf16 a[164:167], v[124:127], a[52:55], a[164:167]
    s_add_u32 s28, s49, s91
    buffer_load_dwordx4 v26, s[16:19], s28 offen lds
    v_mfma_f32_16x16x32_bf16 a[168:171], v[128:131], a[0:3], a[168:171]
    s_add_u32 m0, m0, s53
    ds_read_b64_tr_b16 v[120:121], v11 offset:32
    v_mfma_f32_16x16x32_bf16 a[168:171], v[132:135], a[28:31], a[168:171]
    ds_read_b64_tr_b16 v[122:123], v11 offset:160
    v_mfma_f32_16x16x32_bf16 a[172:175], v[128:131], a[4:7], a[172:175]
    ds_read_b64_tr_b16 v[124:125], v11 offset:544
    v_mfma_f32_16x16x32_bf16 a[172:175], v[132:135], a[32:35], a[172:175]
    ds_read_b64_tr_b16 v[126:127], v11 offset:672
    v_mfma_f32_16x16x32_bf16 a[176:179], v[128:131], a[8:11], a[176:179]
    v_mfma_f32_16x16x32_bf16 a[176:179], v[132:135], a[36:39], a[176:179]
    s_add_u32 s28, s49, s92
    buffer_load_dwordx4 v26, s[16:19], s28 offen lds
    v_mfma_f32_16x16x32_bf16 a[180:183], v[128:131], a[12:15], a[180:183]
    s_add_u32 m0, m0, s53
    v_mfma_f32_16x16x32_bf16 a[180:183], v[132:135], a[40:43], a[180:183]
    v_mfma_f32_16x16x32_bf16 a[184:187], v[128:131], a[16:19], a[184:187]
    v_mfma_f32_16x16x32_bf16 a[184:187], v[132:135], a[44:47], a[184:187]
    v_mfma_f32_16x16x32_bf16 a[188:191], v[128:131], a[20:23], a[188:191]
    v_mfma_f32_16x16x32_bf16 a[188:191], v[132:135], a[48:51], a[188:191]
    s_add_u32 s28, s49, s93
    buffer_load_dwordx4 v26, s[16:19], s28 offen lds
    v_mfma_f32_16x16x32_bf16 a[192:195], v[128:131], a[24:27], a[192:195]
    s_add_u32 m0, m0, s53
    v_mfma_f32_16x16x32_bf16 a[192:195], v[132:135], a[52:55], a[192:195]
    ds_read_b64_tr_b16 v[128:129], v11 offset:64
    v_mfma_f32_16x16x32_bf16 a[196:199], v[136:139], a[0:3], a[196:199]
    ds_read_b64_tr_b16 v[130:131], v11 offset:192
    v_mfma_f32_16x16x32_bf16 a[196:199], v[140:143], a[28:31], a[196:199]
    ds_read_b64_tr_b16 v[132:133], v11 offset:576
    v_mfma_f32_16x16x32_bf16 a[200:203], v[136:139], a[4:7], a[200:203]
    ds_read_b64_tr_b16 v[134:135], v11 offset:704
    v_mfma_f32_16x16x32_bf16 a[200:203], v[140:143], a[32:35], a[200:203]
    s_add_u32 s28, s49, s94
    buffer_load_dwordx4 v26, s[16:19], s28 offen lds
    v_mfma_f32_16x16x32_bf16 a[204:207], v[136:139], a[8:11], a[204:207]
    s_add_u32 m0, m0, s53
    v_mfma_f32_16x16x32_bf16 a[204:207], v[140:143], a[36:39], a[204:207]
    v_mfma_f32_16x16x32_bf16 a[208:211], v[136:139], a[12:15], a[208:211]
    v_mfma_f32_16x16x32_bf16 a[208:211], v[140:143], a[40:43], a[208:211]
    v_mfma_f32_16x16x32_bf16 a[212:215], v[136:139], a[16:19], a[212:215]
    v_mfma_f32_16x16x32_bf16 a[212:215], v[140:143], a[44:47], a[212:215]
    s_add_u32 s28, s49, s95
    buffer_load_dwordx4 v26, s[16:19], s28 offen lds
    v_mfma_f32_16x16x32_bf16 a[216:219], v[136:139], a[20:23], a[216:219]
    v_mfma_f32_16x16x32_bf16 a[216:219], v[140:143], a[48:51], a[216:219]
    v_mfma_f32_16x16x32_bf16 a[220:223], v[136:139], a[24:27], a[220:223]
    v_mfma_f32_16x16x32_bf16 a[220:223], v[140:143], a[52:55], a[220:223]
    ds_read_b64_tr_b16 v[136:137], v11 offset:96
    ds_read_b64_tr_b16 v[138:139], v11 offset:224
    ds_read_b64_tr_b16 v[140:141], v11 offset:608
    ds_read_b64_tr_b16 v[142:143], v11 offset:736
    s_mov_b32 s22, 0
L_at_qploop:
    s_waitcnt lgkmcnt(8)
    v_mfma_f32_16x16x32_bf16 v[144:147], v[112:115], v[28:31], v[144:147]
    s_add_u32 m0, s33, 0
    v_mfma_f32_16x16x32_bf16 v[144:147], v[116:119], v[56:59], v[144:147]
    s_mov_b32 s49, s50
    v_mfma_f32_16x16x32_bf16 v[148:151], v[112:115], v[32:35], v[148:151]
    v_mfma_f32_16x16x32_bf16 v[148:151], v[116:119], v[60:63], v[148:151]
    v_mfma_f32_16x16x32_bf16 v[152:155], v[112:115], v[36:39], v[152:155]
    v_mfma_f32_16x16x32_bf16 v[152:155], v[116:119], v[64:67], v[152:155]
    v_mfma_f32_16x16x32_bf16 v[156:159], v[112:115], v[40:43], v[156:159]
    s_waitcnt vmcnt(16) lgkmcnt(0)
    s_barrier
    v_mfma_f32_16x16x32_bf16 v[156:159], v[116:119], v[68:71], v[156:159]
    v_mfma_f32_16x16x32_bf16 v[160:163], v[112:115], v[44:47], v[160:163]
    v_mfma_f32_16x16x32_bf16 v[160:163], v[116:119], v[72:75], v[160:163]
    s_add_u32 s28, s49, s88
    buffer_load_dwordx4 v26, s[16:19], s28 offen lds
    v_mfma_f32_16x16x32_bf16 v[164:167], v[112:115], v[48:51], v[164:167]
    s_add_u32 m0, m0, s53
    v_mfma_f32_16x16x32_bf16 v[164:167], v[116:119], v[76:79], v[164:167]
    v_mfma_f32_16x16x32_bf16 v[168:171], v[112:115], v[52:55], v[168:171]
    v_mfma_f32_16x16x32_bf16 v[168:171], v[116:119], v[80:83], v[168:171]
    ds_read_b64_tr_b16 v[112:113], v11 offset:8448
    v_mfma_f32_16x16x32_bf16 v[172:175], v[120:123], v[28:31], v[172:175]
    ds_read_b64_tr_b16 v[114:115], v11 offset:8576
    v_mfma_f32_16x16x32_bf16 v[172:175], v[124:127], v[56:59], v[172:175]
    s_add_u32 s28, s49, s89
    buffer_load_dwordx4 v26, s[16:19], s28 offen lds
    v_mfma_f32_16x16x32_bf16 v[176:179], v[120:123], v[32:35], v[176:179]
    s_add_u32 m0, m0, s53
    ds_read_b64_tr_b16 v[116:117], v11 offset:8960
    v_mfma_f32_16x16x32_bf16 v[176:179], v[124:127], v[60:63], v[176:179]
    ds_read_b64_tr_b16 v[118:119], v11 offset:9088
    v_mfma_f32_16x16x32_bf16 v[180:183], v[120:123], v[36:39], v[180:183]
    v_mfma_f32_16x16x32_bf16 v[180:183], v[124:127], v[64:67], v[180:183]
    v_mfma_f32_16x16x32_bf16 v[184:187], v[120:123], v[40:43], v[184:187]
    v_mfma_f32_16x16x32_bf16 v[184:187], v[124:127], v[68:71], v[184:187]
    s_add_u32 s28, s49, s90
    buffer_load_dwordx4 v26, s[16:19], s28 offen lds
    v_mfma_f32_16x16x32_bf16 v[188:191], v[120:123], v[44:47], v[188:191]
    s_add_u32 m0, m0, s53
    v_mfma_f32_16x16x32_bf16 v[188:191], v[124:127], v[72:75], v[188:191]
    v_mfma_f32_16x16x32_bf16 v[192:195], v[120:123], v[48:51], v[192:195]
    v_mfma_f32_16x16x32_bf16 v[192:195], v[124:127], v[76:79], v[192:195]
    v_mfma_f32_16x16x32_bf16 v[196:199], v[120:123], v[52:55], v[196:199]
    v_mfma_f32_16x16x32_bf16 v[196:199], v[124:127], v[80:83], v[196:199]
    s_add_u32 s28, s49, s91
    buffer_load_dwordx4 v26, s[16:19], s28 offen lds
    v_mfma_f32_16x16x32_bf16 v[200:203], v[128:131], v[28:31], v[200:203]
    s_add_u32 m0, m0, s53
    ds_read_b64_tr_b16 v[120:121], v11 offset:8480
    v_mfma_f32_16x16x32_bf16 v[200:203], v[132:135], v[56:59], v[200:203]
    ds_read_b64_tr_b16 v[122:123], v11 offset:8608
    v_mfma_f32_16x16x32_bf16 v[204:207], v[128:131], v[32:35], v[204:207]
    ds_read_b64_tr_b16 v[124:125], v11 offset:8992
    v_mfma_f32_16x16x32_bf16 v[204:207], v[132:135], v[60:63], v[204:207]
    ds_read_b64_tr_b16 v[126:127], v11 offset:9120
    v_mfma_f32_16x16x32_bf16 v[208:211], v[128:131], v[36:39], v[208:211]
    v_mfma_f32_16x16x32_bf16 v[208:211], v[132:135], v[64:67], v[208:211]
    s_add_u32 s28, s49, s92
    buffer_load_dwordx4 v26, s[16:19], s28 offen lds
    v_mfma_f32_16x16x32_bf16 v[212:215], v[128:131], v[40:43], v[212:215]
    s_add_u32 m0, m0, s53
    v_mfma_f32_16x16x32_bf16 v[212:215], v[132:135], v[68:71], v[212:215]
    v_mfma_f32_16x16x32_bf16 v[216:219], v[128:131], v[44:47], v[216:219]
    v_mfma_f32_16x16x32_bf16 v[216:219], v[132:135], v[72:75], v[216:219]
    v_mfma_f32_16x16x32_bf16 v[220:223], v[128:131], v[48:51], v[220:223]
    v_mfma_f32_16x16x32_bf16 v[220:223], v[132:135], v[76:79], v[220:223]
    s_add_u32 s28, s49, s93
    buffer_load_dwordx4 v26, s[16:19], s28 offen lds
    v_mfma_f32_16x16x32_bf16 v[224:227], v[128:131], v[52:55], v[224:227]
    s_add_u32 m0, m0, s53
    v_mfma_f32_16x16x32_bf16 v[224:227], v[132:135], v[80:83], v[224:227]
    ds_read_b64_tr_b16 v[128:129], v11 offset:8512
    v_mfma_f32_16x16x32_bf16 v[228:231], v[136:139], v[28:31], v[228:231]
    ds_read_b64_tr_b16 v[130:131], v11 offset:8640
    v_mfma_f32_16x16x32_bf16 v[228:231], v[140:143], v[56:59], v[228:231]
    ds_read_b64_tr_b16 v[132:133], v11 offset:9024
    v_mfma_f32_16x16x32_bf16 v[232:235], v[136:139], v[32:35], v[232:235]
    ds_read_b64_tr_b16 v[134:135], v11 offset:9152
    v_mfma_f32_16x16x32_bf16 v[232:235], v[140:143], v[60:63], v[232:235]
    s_add_u32 s28, s49, s94
    buffer_load_dwordx4 v26, s[16:19], s28 offen lds
    v_mfma_f32_16x16x32_bf16 v[236:239], v[136:139], v[36:39], v[236:239]
    s_add_u32 m0, m0, s53
    v_mfma_f32_16x16x32_bf16 v[236:239], v[140:143], v[64:67], v[236:239]
    v_mfma_f32_16x16x32_bf16 v[240:243], v[136:139], v[40:43], v[240:243]
    v_mfma_f32_16x16x32_bf16 v[240:243], v[140:143], v[68:71], v[240:243]
    v_mfma_f32_16x16x32_bf16 v[244:247], v[136:139], v[44:47], v[244:247]
    v_mfma_f32_16x16x32_bf16 v[244:247], v[140:143], v[72:75], v[244:247]
    s_add_u32 s28, s49, s95
    buffer_load_dwordx4 v26, s[16:19], s28 offen lds
    v_mfma_f32_16x16x32_bf16 v[248:251], v[136:139], v[48:51], v[248:251]
    v_mfma_f32_16x16x32_bf16 v[248:251], v[140:143], v[76:79], v[248:251]
    v_mfma_f32_16x16x32_bf16 v[252:255], v[136:139], v[52:55], v[252:255]
    v_mfma_f32_16x16x32_bf16 v[252:255], v[140:143], v[80:83], v[252:255]
    ds_read_b64_tr_b16 v[136:137], v11 offset:8544
    ds_read_b64_tr_b16 v[138:139], v11 offset:8672
    ds_read_b64_tr_b16 v[140:141], v11 offset:9056
    ds_read_b64_tr_b16 v[142:143], v11 offset:9184
    s_waitcnt lgkmcnt(8)
    v_mfma_f32_16x16x32_bf16 a[112:115], v[112:115], v[28:31], a[112:115]
    s_add_u32 m0, s33, 8448
    v_mfma_f32_16x16x32_bf16 a[112:115], v[116:119], v[56:59], a[112:115]
    s_add_u32 s49, s50, s46
    v_mfma_f32_16x16x32_bf16 a[116:119], v[112:115], v[32:35], a[116:119]
    s_lshl1_add_u32 s50, s51, s50
    v_mfma_f32_16x16x32_bf16 a[116:119], v[116:119], v[60:63], a[116:119]
    s_add_u32 s82, s82, 2
    v_mfma_f32_16x16x32_bf16 a[120:123], v[112:115], v[36:39], a[120:123]
    s_cmp_eq_u32 s82, 20
    v_mfma_f32_16x16x32_bf16 a[120:123], v[116:119], v[64:67], a[120:123]
    s_cselect_b32 s29, s83, 0
    v_mfma_f32_16x16x32_bf16 a[124:127], v[112:115], v[40:43], a[124:127]
    s_sub_u32 s50, s50, s29
    s_waitcnt vmcnt(8) lgkmcnt(0)
    s_barrier
    ds_read_b128 a[0:3], v27 offset:16896
    v_mfma_f32_16x16x32_bf16 a[124:127], v[116:119], v[68:71], a[124:127]
    ds_read_b128 a[4:7], v27 offset:17920
    v_mfma_f32_16x16x32_bf16 a[128:131], v[112:115], v[44:47], a[128:131]
    ds_read_b128 a[8:11], v27 offset:18944
    v_mfma_f32_16x16x32_bf16 a[128:131], v[116:119], v[72:75], a[128:131]
    s_add_u32 s28, s49, s88
    buffer_load_dwordx4 v26, s[16:19], s28 offen lds
    v_mfma_f32_16x16x32_bf16 a[132:135], v[112:115], v[48:51], a[132:135]
    s_add_u32 m0, m0, s53
    ds_read_b128 a[12:15], v27 offset:19968
    v_mfma_f32_16x16x32_bf16 a[132:135], v[116:119], v[76:79], a[132:135]
    ds_read_b128 a[16:19], v27 offset:20992
    v_mfma_f32_16x16x32_bf16 a[136:139], v[112:115], v[52:55], a[136:139]
    ds_read_b128 a[20:23], v27 offset:22016
    v_mfma_f32_16x16x32_bf16 a[136:139], v[116:119], v[80:83], a[136:139]
    ds_read_b128 a[24:27], v27 offset:23040
    v_mfma_f32_16x16x32_bf16 a[140:143], v[120:123], v[28:31], a[140:143]
    ds_read_b128 a[28:31], v27 offset:25344
    v_mfma_f32_16x16x32_bf16 a[140:143], v[124:127], v[56:59], a[140:143]
    s_add_u32 s28, s49, s89
    buffer_load_dwordx4 v26, s[16:19], s28 offen lds
    v_mfma_f32_16x16x32_bf16 a[144:147], v[120:123], v[32:35], a[144:147]
    s_add_u32 m0, m0, s53
    ds_read_b128 a[32:35], v27 offset:26368
    v_mfma_f32_16x16x32_bf16 a[144:147], v[124:127], v[60:63], a[144:147]
    ds_read_b128 a[36:39], v27 offset:27392
    v_mfma_f32_16x16x32_bf16 a[148:151], v[120:123], v[36:39], a[148:151]
    ds_read_b128 a[40:43], v27 offset:28416
    v_mfma_f32_16x16x32_bf16 a[148:151], v[124:127], v[64:67], a[148:151]
    ds_read_b128 a[44:47], v27 offset:29440
    v_mfma_f32_16x16x32_bf16 a[152:155], v[120:123], v[40:43], a[152:155]
    ds_read_b128 a[48:51], v27 offset:30464
    v_mfma_f32_16x16x32_bf16 a[152:155], v[124:127], v[68:71], a[152:155]
    s_add_u32 s28, s49, s90
    buffer_load_dwordx4 v26, s[16:19], s28 offen lds
    v_mfma_f32_16x16x32_bf16 a[156:159], v[120:123], v[44:47], a[156:159]
    s_add_u32 m0, m0, s53
    ds_read_b128 a[52:55], v27 offset:31488
    v_mfma_f32_16x16x32_bf16 a[156:159], v[124:127], v[72:75], a[156:159]
    ds_read_b64_tr_b16 v[112:113], v11 offset:16896
    v_mfma_f32_16x16x32_bf16 a[160:163], v[120:123], v[48:51], a[160:163]
    ds_read_b64_tr_b16 v[114:115], v11 offset:17024
    v_mfma_f32_16x16x32_bf16 a[160:163], v[124:127], v[76:79], a[160:163]
    ds_read_b64_tr_b16 v[116:117], v11 offset:17408
    v_mfma_f32_16x16x32_bf16 a[164:167], v[120:123], v[52:55], a[164:167]
    ds_read_b64_tr_b16 v[118:119], v11 offset:17536
    v_mfma_f32_16x16x32_bf16 a[164:167], v[124:127], v[80:83], a[164:167]
    s_add_u32 s28, s49, s91
    buffer_load_dwordx4 v26, s[16:19], s28 offen lds
    v_mfma_f32_16x16x32_bf16 a[168:171], v[128:131], v[28:31], a[168:171]
    s_add_u32 m0, m0, s53
    ds_read_b64_tr_b16 v[120:121], v11 offset:16928
    v_mfma_f32_16x16x32_bf16 a[168:171], v[132:135], v[56:59], a[168:171]
    ds_read_b64_tr_b16 v[122:123], v11 offset:17056
    v_mfma_f32_16x16x32_bf16 a[172:175], v[128:131], v[32:35], a[172:175]
    ds_read_b64_tr_b16 v[124:125], v11 offset:17440
    v_mfma_f32_16x16x32_bf16 a[172:175], v[132:135], v[60:63], a[172:175]
    ds_read_b64_tr_b16 v[126:127], v11 offset:17568
    v_mfma_f32_16x16x32_bf16 a[176:179], v[128:131], v[36:39], a[176:179]
    v_mfma_f32_16x16x32_bf16 a[176:179], v[132:135], v[64:67], a[176:179]
    s_add_u32 s28, s49, s92
    buffer_load_dwordx4 v26, s[16:19], s28 offen lds
    v_mfma_f32_16x16x32_bf16 a[180:183], v[128:131], v[40:43], a[180:183]
    s_add_u32 m0, m0, s53
    v_mfma_f32_16x16x32_bf16 a[180:183], v[132:135], v[68:71], a[180:183]
    v_mfma_f32_16x16x32_bf16 a[184:187], v[128:131], v[44:47], a[184:187]
    v_mfma_f32_16x16x32_bf16 a[184:187], v[132:135], v[72:75], a[184:187]
    v_mfma_f32_16x16x32_bf16 a[188:191], v[128:131], v[48:51], a[188:191]
    v_mfma_f32_16x16x32_bf16 a[188:191], v[132:135], v[76:79], a[188:191]
    s_add_u32 s28, s49, s93
    buffer_load_dwordx4 v26, s[16:19], s28 offen lds
    v_mfma_f32_16x16x32_bf16 a[192:195], v[128:131], v[52:55], a[192:195]
    s_add_u32 m0, m0, s53
    v_mfma_f32_16x16x32_bf16 a[192:195], v[132:135], v[80:83], a[192:195]
    ds_read_b64_tr_b16 v[128:129], v11 offset:16960
    v_mfma_f32_16x16x32_bf16 a[196:199], v[136:139], v[28:31], a[196:199]
    ds_read_b64_tr_b16 v[130:131], v11 offset:17088
    v_mfma_f32_16x16x32_bf16 a[196:199], v[140:143], v[56:59], a[196:199]
    ds_read_b64_tr_b16 v[132:133], v11 offset:17472
    v_mfma_f32_16x16x32_bf16 a[200:203], v[136:139], v[32:35], a[200:203]
    ds_read_b64_tr_b16 v[134:135], v11 offset:17600
    v_mfma_f32_16x16x32_bf16 a[200:203], v[140:143], v[60:63], a[200:203]
    s_add_u32 s28, s49, s94
    buffer_load_dwordx4 v26, s[16:19], s28 offen lds
    v_mfma_f32_16x16x32_bf16 a[204:207], v[136:139], v[36:39], a[204:207]
    s_add_u32 m0, m0, s53
    v_mfma_f32_16x16x32_bf16 a[204:207], v[140:143], v[64:67], a[204:207]
    v_mfma_f32_16x16x32_bf16 a[208:211], v[136:139], v[40:43], a[208:211]
    v_mfma_f32_16x16x32_bf16 a[208:211], v[140:143], v[68:71], a[208:211]
    v_mfma_f32_16x16x32_bf16 a[212:215], v[136:139], v[44:47], a[212:215]
    v_mfma_f32_16x16x32_bf16 a[212:215], v[140:143], v[72:75], a[212:215]
    s_add_u32 s28, s49, s95
    buffer_load_dwordx4 v26, s[16:19], s28 offen lds
    v_mfma_f32_16x16x32_bf16 a[216:219], v[136:139], v[48:51], a[216:219]
    v_mfma_f32_16x16x32_bf16 a[216:219], v[140:143], v[76:79], a[216:219]
    v_mfma_f32_16x16x32_bf16 a[220:223], v[136:139], v[52:55], a[220:223]
    v_mfma_f32_16x16x32_bf16 a[220:223], v[140:143], v[80:83], a[220:223]
    ds_read_b64_tr_b16 v[136:137], v11 offset:16992
    ds_read_b64_tr_b16 v[138:139], v11 offset:17120
    ds_read_b64_tr_b16 v[140:141], v11 offset:17504
    ds_read_b64_tr_b16 v[142:143], v11 offset:17632
    s_waitcnt lgkmcnt(8)
    v_mfma_f32_16x16x32_bf16 v[144:147], v[112:115], a[0:3], v[144:147]
    s_add_u32 m0, s33, 16896
    v_mfma_f32_16x16x32_bf16 v[144:147], v[116:119], a[28:31], v[144:147]
    s_mov_b32 s49, s50
    v_mfma_f32_16x16x32_bf16 v[148:151], v[112:115], a[4:7], v[148:151]
    v_mfma_f32_16x16x32_bf16 v[148:151], v[116:119], a[32:35], v[148:151]
    v_mfma_f32_16x16x32_bf16 v[152:155], v[112:115], a[8:11], v[152:155]
    v_mfma_f32_16x16x32_bf16 v[152:155], v[116:119], a[36:39], v[152:155]
    v_mfma_f32_16x16x32_bf16 v[156:159], v[112:115], a[12:15], v[156:159]
    s_waitcnt vmcnt(16) lgkmcnt(0)
    s_barrier
    v_mfma_f32_16x16x32_bf16 v[156:159], v[116:119], a[40:43], v[156:159]
    v_mfma_f32_16x16x32_bf16 v[160:163], v[112:115], a[16:19], v[160:163]
    v_mfma_f32_16x16x32_bf16 v[160:163], v[116:119], a[44:47], v[160:163]
    s_add_u32 s28, s49, s88
    buffer_load_dwordx4 v26, s[16:19], s28 offen lds
    v_mfma_f32_16x16x32_bf16 v[164:167], v[112:115], a[20:23], v[164:167]
    s_add_u32 m0, m0, s53
    v_mfma_f32_16x16x32_bf16 v[164:167], v[116:119], a[48:51], v[164:167]
    v_mfma_f32_16x16x32_bf16 v[168:171], v[112:115], a[24:27], v[168:171]
    v_mfma_f32_16x16x32_bf16 v[168:171], v[116:119], a[52:55], v[168:171]
    ds_read_b64_tr_b16 v[112:113], v11 offset:25344
    v_mfma_f32_16x16x32_bf16 v[172:175], v[120:123], a[0:3], v[172:175]
    ds_read_b64_tr_b16 v[114:115], v11 offset:25472
    v_mfma_f32_16x16x32_bf16 v[172:175], v[124:127], a[28:31], v[172:175]
    s_add_u32 s28, s49, s89
    buffer_load_dwordx4 v26, s[16:19], s28 offen lds
    v_mfma_f32_16x16x32_bf16 v[176:179], v[120:123], a[4:7], v[176:179]
    s_add_u32 m0, m0, s53
    ds_read_b64_tr_b16 v[116:117], v11 offset:25856
    v_mfma_f32_16x16x32_bf16 v[176:179], v[124:127], a[32:35], v[176:179]
    ds_read_b64_tr_b16 v[118:119], v11 offset:25984
    v_mfma_f32_16x16x32_bf16 v[180:183], v[120:123], a[8:11], v[180:183]
    v_mfma_f32_16x16x32_bf16 v[180:183], v[124:127], a[36:39], v[180:183]
    v_mfma_f32_16x16x32_bf16 v[184:187], v[120:123], a[12:15], v[184:187]
    v_mfma_f32_16x16x32_bf16 v[184:187], v[124:127], a[40:43], v[184:187]
    s_add_u32 s28, s49, s90
    buffer_load_dwordx4 v26, s[16:19], s28 offen lds
    v_mfma_f32_16x16x32_bf16 v[188:191], v[120:123], a[16:19], v[188:191]
    s_add_u32 m0, m0, s53
    v_mfma_f32_16x16x32_bf16 v[188:191], v[124:127], a[44:47], v[188:191]
    v_mfma_f32_16x16x32_bf16 v[192:195], v[120:123], a[20:23], v[192:195]
    v_mfma_f32_16x16x32_bf16 v[192:195], v[124:127], a[48:51], v[192:195]
    v_mfma_f32_16x16x32_bf16 v[196:199], v[120:123], a[24:27], v[196:199]
    v_mfma_f32_16x16x32_bf16 v[196:199], v[124:127], a[52:55], v[196:199]
    s_add_u32 s28, s49, s91
    buffer_load_dwordx4 v26, s[16:19], s28 offen lds
    v_mfma_f32_16x16x32_bf16 v[200:203], v[128:131], a[0:3], v[200:203]
    s_add_u32 m0, m0, s53
    ds_read_b64_tr_b16 v[120:121], v11 offset:25376
    v_mfma_f32_16x16x32_bf16 v[200:203], v[132:135], a[28:31], v[200:203]
    ds_read_b64_tr_b16 v[122:123], v11 offset:25504
    v_mfma_f32_16x16x32_bf16 v[204:207], v[128:131], a[4:7], v[204:207]
    ds_read_b64_tr_b16 v[124:125], v11 offset:25888
    v_mfma_f32_16x16x32_bf16 v[204:207], v[132:135], a[32:35], v[204:207]
    ds_read_b64_tr_b16 v[126:127], v11 offset:26016
    v_mfma_f32_16x16x32_bf16 v[208:211], v[128:131], a[8:11], v[208:211]
    v_mfma_f32_16x16x32_bf16 v[208:211], v[132:135], a[36:39], v[208:211]
    s_add_u32 s28, s49, s92
    buffer_load_dwordx4 v26, s[16:19], s28 offen lds
    v_mfma_f32_16x16x32_bf16 v[212:215], v[128:131], a[12:15], v[212:215]
    s_add_u32 m0, m0, s53
    v_mfma_f32_16x16x32_bf16 v[212:215], v[132:135], a[40:43], v[212:215]
    v_mfma_f32_16x16x32_bf16 v[216:219], v[128:131], a[16:19], v[216:219]
    v_mfma_f32_16x16x32_bf16 v[216:219], v[132:135], a[44:47], v[216:219]
    v_mfma_f32_16x16x32_bf16 v[220:223], v[128:131], a[20:23], v[220:223]
    v_mfma_f32_16x16x32_bf16 v[220:223], v[132:135], a[48:51], v[220:223]
    s_add_u32 s28, s49, s93
    buffer_load_dwordx4 v26, s[16:19], s28 offen lds
    v_mfma_f32_16x16x32_bf16 v[224:227], v[128:131], a[24:27], v[224:227]
    s_add_u32 m0, m0, s53
    v_mfma_f32_16x16x32_bf16 v[224:227], v[132:135], a[52:55], v[224:227]
    ds_read_b64_tr_b16 v[128:129], v11 offset:25408
    v_mfma_f32_16x16x32_bf16 v[228:231], v[136:139], a[0:3], v[228:231]
    ds_read_b64_tr_b16 v[130:131], v11 offset:25536
    v_mfma_f32_16x16x32_bf16 v[228:231], v[140:143], a[28:31], v[228:231]
    ds_read_b64_tr_b16 v[132:133], v11 offset:25920
    v_mfma_f32_16x16x32_bf16 v[232:235], v[136:139], a[4:7], v[232:235]
    ds_read_b64_tr_b16 v[134:135], v11 offset:26048
    v_mfma_f32_16x16x32_bf16 v[232:235], v[140:143], a[32:35], v[232:235]
    s_add_u32 s28, s49, s94
    buffer_load_dwordx4 v26, s[16:19], s28 offen lds
    v_mfma_f32_16x16x32_bf16 v[236:239], v[136:139], a[8:11], v[236:239]
    s_add_u32 m0, m0, s53
    v_mfma_f32_16x16x32_bf16 v[236:239], v[140:143], a[36:39], v[236:239]
    v_mfma_f32_16x16x32_bf16 v[240:243], v[136:139], a[12:15], v[240:243]
    v_mfma_f32_16x16x32_bf16 v[240:243], v[140:143], a[40:43], v[240:243]
    v_mfma_f32_16x16x32_bf16 v[244:247], v[136:139], a[16:19], v[244:247]
    v_mfma_f32_16x16x32_bf16 v[244:247], v[140:143], a[44:47], v[244:247]
    s_add_u32 s28, s49, s95
    buffer_load_dwordx4 v26, s[16:19], s28 offen lds
    v_mfma_f32_16x16x32_bf16 v[248:251], v[136:139], a[20:23], v[248:251]
    v_mfma_f32_16x16x32_bf16 v[248:251], v[140:143], a[48:51], v[248:251]
    v_mfma_f32_16x16x32_bf16 v[252:255], v[136:139], a[24:27], v[252:255]
    v_mfma_f32_16x16x32_bf16 v[252:255], v[140:143], a[52:55], v[252:255]
    ds_read_b64_tr_b16 v[136:137], v11 offset:25440
    ds_read_b64_tr_b16 v[138:139], v11 offset:25568
    ds_read_b64_tr_b16 v[140:141], v11 offset:25952
    ds_read_b64_tr_b16 v[142:143], v11 offset:26080
    s_waitcnt lgkmcnt(8)
    v_mfma_f32_16x16x32_bf16 a[112:115], v[112:115], a[0:3], a[112:115]
    s_add_u32 m0, s33, 25344
    v_mfma_f32_16x16x32_bf16 a[112:115], v[116:119], a[28:31], a[112:115]
    s_add_u32 s49, s50, s46
    v_mfma_f32_16x16x32_bf16 a[116:119], v[112:115], a[4:7], a[116:119]
    s_lshl1_add_u32 s50, s51, s50
    v_mfma_f32_16x16x32_bf16 a[116:119], v[116:119], a[32:35], a[116:119]
    s_add_u32 s82, s82, 2
    v_mfma_f32_16x16x32_bf16 a[120:123], v[112:115], a[8:11], a[120:123]
    s_cmp_eq_u32 s82, 20
    v_mfma_f32_16x16x32_bf16 a[120:123], v[116:119], a[36:39], a[120:123]
    s_cselect_b32 s29, s83, 0
    v_mfma_f32_16x16x32_bf16 a[124:127], v[112:115], a[12:15], a[124:127]
    s_sub_u32 s50, s50, s29
    s_waitcnt vmcnt(8) lgkmcnt(0)
    s_barrier
    ds_read_b128 v[28:31], v27 offset:0
    v_mfma_f32_16x16x32_bf16 a[124:127], v[116:119], a[40:43], a[124:127]
    ds_read_b128 v[32:35], v27 offset:1024
    v_mfma_f32_16x16x32_bf16 a[128:131], v[112:115], a[16:19], a[128:131]
    ds_read_b128 v[36:39], v27 offset:2048
    v_mfma_f32_16x16x32_bf16 a[128:131], v[116:119], a[44:47], a[128:131]
    s_add_u32 s28, s49, s88
    buffer_load_dwordx4 v26, s[16:19], s28 offen lds
    v_mfma_f32_16x16x32_bf16 a[132:135], v[112:115], a[20:23], a[132:135]
    s_add_u32 m0, m0, s53
    ds_read_b128 v[40:43], v27 offset:3072
    v_mfma_f32_16x16x32_bf16 a[132:135], v[116:119], a[48:51], a[132:135]
    ds_read_b128 v[44:47], v27 offset:4096
    v_mfma_f32_16x16x32_bf16 a[136:139], v[112:115], a[24:27], a[136:139]
    ds_read_b128 v[48:51], v27 offset:5120
    v_mfma_f32_16x16x32_bf16 a[136:139], v[116:119], a[52:55], a[136:139]
    ds_read_b128 v[52:55], v27 offset:6144
    v_mfma_f32_16x16x32_bf16 a[140:143], v[120:123], a[0:3], a[140:143]
    ds_read_b128 v[56:59], v27 offset:8448
    v_mfma_f32_16x16x32_bf16 a[140:143], v[124:127], a[28:31], a[140:143]
    s_add_u32 s28, s49, s89
    buffer_load_dwordx4 v26, s[16:19], s28 offen lds
    v_mfma_f32_16x16x32_bf16 a[144:147], v[120:123], a[4:7], a[144:147]
    s_add_u32 m0, m0, s53
    ds_read_b128 v[60:63], v27 offset:9472
    v_mfma_f32_16x16x32_bf16 a[144:147], v[124:127], a[32:35], a[144:147]
    ds_read_b128 v[64:67], v27 offset:10496
    v_mfma_f32_16x16x32_bf16 a[148:151], v[120:123], a[8:11], a[148:151]
    ds_read_b128 v[68:71], v27 offset:11520
    v_mfma_f32_16x16x32_bf16 a[148:151], v[124:127], a[36:39], a[148:151]
    ds_read_b128 v[72:75], v27 offset:12544
    v_mfma_f32_16x16x32_bf16 a[152:155], v[120:123], a[12:15], a[152:155]
    ds_read_b128 v[76:79], v27 offset:13568
    v_mfma_f32_16x16x32_bf16 a[152:155], v[124:127], a[40:43], a[152:155]
    s_add_u32 s28, s49, s90
    buffer_load_dwordx4 v26, s[16:19], s28 offen lds
    v_mfma_f32_16x16x32_bf16 a[156:159], v[120:123], a[16:19], a[156:159]
    s_add_u32 m0, m0, s53
    ds_read_b128 v[80:83], v27 offset:14592
    v_mfma_f32_16x16x32_bf16 a[156:159], v[124:127], a[44:47], a[156:159]
    ds_read_b64_tr_b16 v[112:113], v11 offset:0
    v_mfma_f32_16x16x32_bf16 a[160:163], v[120:123], a[20:23], a[160:163]
    ds_read_b64_tr_b16 v[114:115], v11 offset:128
    v_mfma_f32_16x16x32_bf16 a[160:163], v[124:127], a[48:51], a[160:163]
    ds_read_b64_tr_b16 v[116:117], v11 offset:512
    v_mfma_f32_16x16x32_bf16 a[164:167], v[120:123], a[24:27], a[164:167]
    ds_read_b64_tr_b16 v[118:119], v11 offset:640
    v_mfma_f32_16x16x32_bf16 a[164:167], v[124:127], a[52:55], a[164:167]
    s_add_u32 s28, s49, s91
    buffer_load_dwordx4 v26, s[16:19], s28 offen lds
    v_mfma_f32_16x16x32_bf16 a[168:171], v[128:131], a[0:3], a[168:171]
    s_add_u32 m0, m0, s53
    ds_read_b64_tr_b16 v[120:121], v11 offset:32
    v_mfma_f32_16x16x32_bf16 a[168:171], v[132:135], a[28:31], a[168:171]
    ds_read_b64_tr_b16 v[122:123], v11 offset:160
    v_mfma_f32_16x16x32_bf16 a[172:175], v[128:131], a[4:7], a[172:175]
    ds_read_b64_tr_b16 v[124:125], v11 offset:544
    v_mfma_f32_16x16x32_bf16 a[172:175], v[132:135], a[32:35], a[172:175]
    ds_read_b64_tr_b16 v[126:127], v11 offset:672
    v_mfma_f32_16x16x32_bf16 a[176:179], v[128:131], a[8:11], a[176:179]
    v_mfma_f32_16x16x32_bf16 a[176:179], v[132:135], a[36:39], a[176:179]
    s_add_u32 s28, s49, s92
    buffer_load_dwordx4 v26, s[16:19], s28 offen lds
    v_mfma_f32_16x16x32_bf16 a[180:183], v[128:131], a[12:15], a[180:183]
    s_add_u32 m0, m0, s53
    v_mfma_f32_16x16x32_bf16 a[180:183], v[132:135], a[40:43], a[180:183]
    v_mfma_f32_16x16x32_bf16 a[184:187], v[128:131], a[16:19], a[184:187]
    v_mfma_f32_16x16x32_bf16 a[184:187], v[132:135], a[44:47], a[184:187]
    v_mfma_f32_16x16x32_bf16 a[188:191], v[128:131], a[20:23], a[188:191]
    v_mfma_f32_16x16x32_bf16 a[188:191], v[132:135], a[48:51], a[188:191]
    s_add_u32 s28, s49, s93
    buffer_load_dwordx4 v26, s[16:19], s28 offen lds
    v_mfma_f32_16x16x32_bf16 a[192:195], v[128:131], a[24:27], a[192:195]
    s_add_u32 m0, m0, s53
    v_mfma_f32_16x16x32_bf16 a[192:195], v[132:135], a[52:55], a[192:195]
    ds_read_b64_tr_b16 v[128:129], v11 offset:64
    v_mfma_f32_16x16x32_bf16 a[196:199], v[136:139], a[0:3], a[196:199]
    ds_read_b64_tr_b16 v[130:131], v11 offset:192
    v_mfma_f32_16x16x32_bf16 a[196:199], v[140:143], a[28:31], a[196:199]
    ds_read_b64_tr_b16 v[132:133], v11 offset:576
    v_mfma_f32_16x16x32_bf16 a[200:203], v[136:139], a[4:7], a[200:203]
    ds_read_b64_tr_b16 v[134:135], v11 offset:704
    v_mfma_f32_16x16x32_bf16 a[200:203], v[140:143], a[32:35], a[200:203]
    s_add_u32 s28, s49, s94
    buffer_load_dwordx4 v26, s[16:19], s28 offen lds
    v_mfma_f32_16x16x32_bf16 a[204:207], v[136:139], a[8:11], a[204:207]
    s_add_u32 m0, m0, s53
    v_mfma_f32_16x16x32_bf16 a[204:207], v[140:143], a[36:39], a[204:207]
    v_mfma_f32_16x16x32_bf16 a[208:211], v[136:139], a[12:15], a[208:211]
    v_mfma_f32_16x16x32_bf16 a[208:211], v[140:143], a[40:43], a[208:211]
    v_mfma_f32_16x16x32_bf16 a[212:215], v[136:139], a[16:19], a[212:215]
    v_mfma_f32_16x16x32_bf16 a[212:215], v[140:143], a[44:47], a[212:215]
    s_add_u32 s28, s49, s95
    buffer_load_dwordx4 v26, s[16:19], s28 offen lds
    v_mfma_f32_16x16x32_bf16 a[216:219], v[136:139], a[20:23], a[216:219]
    v_mfma_f32_16x16x32_bf16 a[216:219], v[140:143], a[48:51], a[216:219]
    v_mfma_f32_16x16x32_bf16 a[220:223], v[136:139], a[24:27], a[220:223]
    v_mfma_f32_16x16x32_bf16 a[220:223], v[140:143], a[52:55], a[220:223]
    ds_read_b64_tr_b16 v[136:137], v11 offset:96
    ds_read_b64_tr_b16 v[138:139], v11 offset:224
    ds_read_b64_tr_b16 v[140:141], v11 offset:608
    ds_read_b64_tr_b16 v[142:143], v11 offset:736
    s_add_u32 s22, s22, 1
    s_cmp_lt_u32 s22, 3
    s_cbranch_scc1 L_at_qploop
    s_cmp_lg_u32 s70, 0
    s_cbranch_scc1 L_at_qptailB
    s_waitcnt lgkmcnt(8)
    v_mfma_f32_16x16x32_bf16 v[144:147], v[112:115], v[28:31], v[144:147]
    s_add_u32 s29, s34, s100
    v_mfma_f32_16x16x32_bf16 v[144:147], v[116:119], v[56:59], v[144:147]
    s_bfe_u32 s28, s29, 0x20003
    v_mfma_f32_16x16x32_bf16 v[148:151], v[112:115], v[32:35], v[148:151]
    s_lshl_b32 s28, s28, 16
    v_mfma_f32_16x16x32_bf16 v[148:151], v[116:119], v[60:63], v[148:151]
    s_and_b32 s29, s29, 7
    v_mfma_f32_16x16x32_bf16 v[152:155], v[112:115], v[36:39], v[152:155]
    s_lshl_b32 s29, s29, 11
    v_mfma_f32_16x16x32_bf16 v[152:155], v[116:119], v[64:67], v[152:155]
    s_add_u32 s29, s28, s29
    v_mfma_f32_16x16x32_bf16 v[156:159], v[112:115], v[40:43], v[156:159]
    s_lshr_b32 s28, s34, 5
    s_waitcnt vmcnt(16) lgkmcnt(0)
    s_barrier
    v_mfma_f32_16x16x32_bf16 v[156:159], v[116:119], v[68:71], v[156:159]
    s_lshl_b32 s28, s28, 19
    v_mfma_f32_16x16x32_bf16 v[160:163], v[112:115], v[44:47], v[160:163]
    s_add_u32 s49, s28, s29
    v_mfma_f32_16x16x32_bf16 v[160:163], v[116:119], v[72:75], v[160:163]
    s_add_u32 m0, s33, 0
    v_mfma_f32_16x16x32_bf16 v[164:167], v[112:115], v[48:51], v[164:167]
    s_add_u32 s34, s34, 1
    v_mfma_f32_16x16x32_bf16 v[164:167], v[116:119], v[76:79], v[164:167]
    buffer_load_dwordx4 v7, s[4:7], s49 offen offset:0 nt lds
    v_mfma_f32_16x16x32_bf16 v[168:171], v[112:115], v[52:55], v[168:171]
    s_add_u32 m0, m0, s96
    v_mfma_f32_16x16x32_bf16 v[168:171], v[116:119], v[80:83], v[168:171]
    ds_read_b64_tr_b16 v[112:113], v11 offset:8448
    v_mfma_f32_16x16x32_bf16 v[172:175], v[120:123], v[28:31], v[172:175]
    ds_read_b64_tr_b16 v[114:115], v11 offset:8576
    v_mfma_f32_16x16x32_bf16 v[172:175], v[124:127], v[56:59], v[172:175]
    buffer_load_dwordx4 v7, s[4:7], s49 offen offset:256 nt lds
    v_mfma_f32_16x16x32_bf16 v[176:179], v[120:123], v[32:35], v[176:179]
    s_add_u32 m0, m0, s97
    ds_read_b64_tr_b16 v[116:117], v11 offset:8960
    v_mfma_f32_16x16x32_bf16 v[176:179], v[124:127], v[60:63], v[176:179]
    ds_read_b64_tr_b16 v[118:119], v11 offset:9088
    v_mfma_f32_16x16x32_bf16 v[180:183], v[120:123], v[36:39], v[180:183]
    v_mfma_f32_16x16x32_bf16 v[180:183], v[124:127], v[64:67], v[180:183]
    v_mfma_f32_16x16x32_bf16 v[184:187], v[120:123], v[40:43], v[184:187]
    v_mfma_f32_16x16x32_bf16 v[184:187], v[124:127], v[68:71], v[184:187]
    buffer_load_dwordx4 v7, s[4:7], s49 offen offset:512 nt lds
    v_mfma_f32_16x16x32_bf16 v[188:191], v[120:123], v[44:47], v[188:191]
    s_add_u32 m0, m0, s96
    v_mfma_f32_16x16x32_bf16 v[188:191], v[124:127], v[72:75], v[188:191]
    v_mfma_f32_16x16x32_bf16 v[192:195], v[120:123], v[48:51], v[192:195]
    v_mfma_f32_16x16x32_bf16 v[192:195], v[124:127], v[76:79], v[192:195]
    v_mfma_f32_16x16x32_bf16 v[196:199], v[120:123], v[52:55], v[196:199]
    v_mfma_f32_16x16x32_bf16 v[196:199], v[124:127], v[80:83], v[196:199]
    buffer_load_dwordx4 v7, s[4:7], s49 offen offset:768 nt lds
    v_mfma_f32_16x16x32_bf16 v[200:203], v[128:131], v[28:31], v[200:203]
    s_add_u32 m0, m0, s97
    ds_read_b64_tr_b16 v[120:121], v11 offset:8480
    v_mfma_f32_16x16x32_bf16 v[200:203], v[132:135], v[56:59], v[200:203]
    ds_read_b64_tr_b16 v[122:123], v11 offset:8608
    v_mfma_f32_16x16x32_bf16 v[204:207], v[128:131], v[32:35], v[204:207]
    ds_read_b64_tr_b16 v[124:125], v11 offset:8992
    v_mfma_f32_16x16x32_bf16 v[204:207], v[132:135], v[60:63], v[204:207]
    ds_read_b64_tr_b16 v[126:127], v11 offset:9120
    v_mfma_f32_16x16x32_bf16 v[208:211], v[128:131], v[36:39], v[208:211]
    v_mfma_f32_16x16x32_bf16 v[208:211], v[132:135], v[64:67], v[208:211]
    buffer_load_dwordx4 v7, s[4:7], s49 offen offset:1024 nt lds
    v_mfma_f32_16x16x32_bf16 v[212:215], v[128:131], v[40:43], v[212:215]
    s_add_u32 m0, m0, s96
    v_mfma_f32_16x16x32_bf16 v[212:215], v[132:135], v[68:71], v[212:215]
    v_mfma_f32_16x16x32_bf16 v[216:219], v[128:131], v[44:47], v[216:219]
    v_mfma_f32_16x16x32_bf16 v[216:219], v[132:135], v[72:75], v[216:219]
    v_mfma_f32_16x16x32_bf16 v[220:223], v[128:131], v[48:51], v[220:223]
    v_mfma_f32_16x16x32_bf16 v[220:223], v[132:135], v[76:79], v[220:223]
    buffer_load_dwordx4 v7, s[4:7], s49 offen offset:1280 nt lds
    v_mfma_f32_16x16x32_bf16 v[224:227], v[128:131], v[52:55], v[224:227]
    s_add_u32 m0, m0, s97
    v_mfma_f32_16x16x32_bf16 v[224:227], v[132:135], v[80:83], v[224:227]
    ds_read_b64_tr_b16 v[128:129], v11 offset:8512
    v_mfma_f32_16x16x32_bf16 v[228:231], v[136:139], v[28:31], v[228:231]
    ds_read_b64_tr_b16 v[130:131], v11 offset:8640
    v_mfma_f32_16x16x32_bf16 v[228:231], v[140:143], v[56:59], v[228:231]
    ds_read_b64_tr_b16 v[132:133], v11 offset:9024
    v_mfma_f32_16x16x32_bf16 v[232:235], v[136:139], v[32:35], v[232:235]
    ds_read_b64_tr_b16 v[134:135], v11 offset:9152
    v_mfma_f32_16x16x32_bf16 v[232:235], v[140:143], v[60:63], v[232:235]
    buffer_load_dwordx4 v7, s[4:7], s49 offen offset:1536 nt lds
    v_mfma_f32_16x16x32_bf16 v[236:239], v[136:139], v[36:39], v[236:239]
    s_add_u32 m0, m0, s96
    v_mfma_f32_16x16x32_bf16 v[236:239], v[140:143], v[64:67], v[236:239]
    v_mfma_f32_16x16x32_bf16 v[240:243], v[136:139], v[40:43], v[240:243]
    v_mfma_f32_16x16x32_bf16 v[240:243], v[140:143], v[68:71], v[240:243]
    v_mfma_f32_16x16x32_bf16 v[244:247], v[136:139], v[44:47], v[244:247]
    v_mfma_f32_16x16x32_bf16 v[244:247], v[140:143], v[72:75], v[244:247]
    buffer_load_dwordx4 v7, s[4:7], s49 offen offset:1792 nt lds
    v_mfma_f32_16x16x32_bf16 v[248:251], v[136:139], v[48:51], v[248:251]
    v_mfma_f32_16x16x32_bf16 v[248:251], v[140:143], v[76:79], v[248:251]
    v_mfma_f32_16x16x32_bf16 v[252:255], v[136:139], v[52:55], v[252:255]
    v_mfma_f32_16x16x32_bf16 v[252:255], v[140:143], v[80:83], v[252:255]
    ds_read_b64_tr_b16 v[136:137], v11 offset:8544
    ds_read_b64_tr_b16 v[138:139], v11 offset:8672
    ds_read_b64_tr_b16 v[140:141], v11 offset:9056
    ds_read_b64_tr_b16 v[142:143], v11 offset:9184
    s_waitcnt lgkmcnt(8)
    v_mfma_f32_16x16x32_bf16 a[112:115], v[112:115], v[28:31], a[112:115]
    s_add_u32 s29, s34, s100
    v_mfma_f32_16x16x32_bf16 a[112:115], v[116:119], v[56:59], a[112:115]
    s_bfe_u32 s28, s29, 0x20003
    v_mfma_f32_16x16x32_bf16 a[116:119], v[112:115], v[32:35], a[116:119]
    s_lshl_b32 s28, s28, 16
    v_mfma_f32_16x16x32_bf16 a[116:119], v[116:119], v[60:63], a[116:119]
    s_and_b32 s29, s29, 7
    v_mfma_f32_16x16x32_bf16 a[120:123], v[112:115], v[36:39], a[120:123]
    s_lshl_b32 s29, s29, 11
    v_mfma_f32_16x16x32_bf16 a[120:123], v[116:119], v[64:67], a[120:123]
    s_add_u32 s29, s28, s29
    v_mfma_f32_16x16x32_bf16 a[124:127], v[112:115], v[40:43], a[124:127]
    s_lshr_b32 s28, s34, 5
    s_waitcnt vmcnt(8) lgkmcnt(0)
    s_barrier
    ds_read_b128 a[0:3], v27 offset:16896
    v_mfma_f32_16x16x32_bf16 a[124:127], v[116:119], v[68:71], a[124:127]
    s_lshl_b32 s28, s28, 19
    ds_read_b128 a[4:7], v27 offset:17920
    v_mfma_f32_16x16x32_bf16 a[128:131], v[112:115], v[44:47], a[128:131]
    s_add_u32 s49, s28, s29
    ds_read_b128 a[8:11], v27 offset:18944
    v_mfma_f32_16x16x32_bf16 a[128:131], v[116:119], v[72:75], a[128:131]
    s_add_u32 m0, s33, 8448
    ds_read_b128 a[12:15], v27 offset:19968
    v_mfma_f32_16x16x32_bf16 a[132:135], v[112:115], v[48:51], a[132:135]
    s_add_u32 s34, s34, 1
    ds_read_b128 a[16:19], v27 offset:20992
    v_mfma_f32_16x16x32_bf16 a[132:135], v[116:119], v[76:79], a[132:135]
    buffer_load_dwordx4 v7, s[4:7], s49 offen offset:0 nt lds
    v_mfma_f32_16x16x32_bf16 a[136:139], v[112:115], v[52:55], a[136:139]
    s_add_u32 m0, m0, s96
    ds_read_b128 a[20:23], v27 offset:22016
    v_mfma_f32_16x16x32_bf16 a[136:139], v[116:119], v[80:83], a[136:139]
    ds_read_b128 a[24:27], v27 offset:23040
    v_mfma_f32_16x16x32_bf16 a[140:143], v[120:123], v[28:31], a[140:143]
    ds_read_b128 a[28:31], v27 offset:25344
    v_mfma_f32_16x16x32_bf16 a[140:143], v[124:127], v[56:59], a[140:143]
    buffer_load_dwordx4 v7, s[4:7], s49 offen offset:256 nt lds
    v_mfma_f32_16x16x32_bf16 a[144:147], v[120:123], v[32:35], a[144:147]
    s_add_u32 m0, m0, s97
    ds_read_b128 a[32:35], v27 offset:26368
    v_mfma_f32_16x16x32_bf16 a[144:147], v[124:127], v[60:63], a[144:147]
    ds_read_b128 a[36:39], v27 offset:27392
    v_mfma_f32_16x16x32_bf16 a[148:151], v[120:123], v[36:39], a[148:151]
    ds_read_b128 a[40:43], v27 offset:28416
    v_mfma_f32_16x16x32_bf16 a[148:151], v[124:127], v[64:67], a[148:151]
    ds_read_b128 a[44:47], v27 offset:29440
    v_mfma_f32_16x16x32_bf16 a[152:155], v[120:123], v[40:43], a[152:155]
    ds_read_b128 a[48:51], v27 offset:30464
    v_mfma_f32_16x16x32_bf16 a[152:155], v[124:127], v[68:71], a[152:155]
    buffer_load_dwordx4 v7, s[4:7], s49 offen offset:512 nt lds
    v_mfma_f32_16x16x32_bf16 a[156:159], v[120:123], v[44:47], a[156:159]
    s_add_u32 m0, m0, s96
    ds_read_b128 a[52:55], v27 offset:31488
    v_mfma_f32_16x16x32_bf16 a[156:159], v[124:127], v[72:75], a[156:159]
    ds_read_b64_tr_b16 v[112:113], v11 offset:16896
    v_mfma_f32_16x16x32_bf16 a[160:163], v[120:123], v[48:51], a[160:163]
    ds_read_b64_tr_b16 v[114:115], v11 offset:17024
    v_mfma_f32_16x16x32_bf16 a[160:163], v[124:127], v[76:79], a[160:163]
    ds_read_b64_tr_b16 v[116:117], v11 offset:17408
    v_mfma_f32_16x16x32_bf16 a[164:167], v[120:123], v[52:55], a[164:167]
    ds_read_b64_tr_b16 v[118:119], v11 offset:17536
    v_mfma_f32_16x16x32_bf16 a[164:167], v[124:127], v[80:83], a[164:167]
    buffer_load_dwordx4 v7, s[4:7], s49 offen offset:768 nt lds
    v_mfma_f32_16x16x32_bf16 a[168:171], v[128:131], v[28:31], a[168:171]
    s_add_u32 m0, m0, s97
    ds_read_b64_tr_b16 v[120:121], v11 offset:16928
    v_mfma_f32_16x16x32_bf16 a[168:171], v[132:135], v[56:59], a[168:171]
    ds_read_b64_tr_b16 v[122:123], v11 offset:17056
    v_mfma_f32_16x16x32_bf16 a[172:175], v[128:131], v[32:35], a[172:175]
    ds_read_b64_tr_b16 v[124:125], v11 offset:17440
    v_mfma_f32_16x16x32_bf16 a[172:175], v[132:135], v[60:63], a[172:175]
    ds_read_b64_tr_b16 v[126:127], v11 offset:17568
    v_mfma_f32_16x16x32_bf16 a[176:179], v[128:131], v[36:39], a[176:179]
    v_mfma_f32_16x16x32_bf16 a[176:179], v[132:135], v[64:67], a[176:179]
    buffer_load_dwordx4 v7, s[4:7], s49 offen offset:1024 nt lds
    v_mfma_f32_16x16x32_bf16 a[180:183], v[128:131], v[40:43], a[180:183]
    s_add_u32 m0, m0, s96
    v_mfma_f32_16x16x32_bf16 a[180:183], v[132:135], v[68:71], a[180:183]
    v_mfma_f32_16x16x32_bf16 a[184:187], v[128:131], v[44:47], a[184:187]
    v_mfma_f32_16x16x32_bf16 a[184:187], v[132:135], v[72:75], a[184:187]
    v_mfma_f32_16x16x32_bf16 a[188:191], v[128:131], v[48:51], a[188:191]
    v_mfma_f32_16x16x32_bf16 a[188:191], v[132:135], v[76:79], a[188:191]
    buffer_load_dwordx4 v7, s[4:7], s49 offen offset:1280 nt lds
    v_mfma_f32_16x16x32_bf16 a[192:195], v[128:131], v[52:55], a[192:195]
    s_add_u32 m0, m0, s97
    v_mfma_f32_16x16x32_bf16 a[192:195], v[132:135], v[80:83], a[192:195]
    ds_read_b64_tr_b16 v[128:129], v11 offset:16960
    v_mfma_f32_16x16x32_bf16 a[196:199], v[136:139], v[28:31], a[196:199]
    ds_read_b64_tr_b16 v[130:131], v11 offset:17088
    v_mfma_f32_16x16x32_bf16 a[196:199], v[140:143], v[56:59], a[196:199]
    ds_read_b64_tr_b16 v[132:133], v11 offset:17472
    v_mfma_f32_16x16x32_bf16 a[200:203], v[136:139], v[32:35], a[200:203]
    ds_read_b64_tr_b16 v[134:135], v11 offset:17600
    v_mfma_f32_16x16x32_bf16 a[200:203], v[140:143], v[60:63], a[200:203]
    buffer_load_dwordx4 v7, s[4:7], s49 offen offset:1536 nt lds
    v_mfma_f32_16x16x32_bf16 a[204:207], v[136:139], v[36:39], a[204:207]
    s_add_u32 m0, m0, s96
    v_mfma_f32_16x16x32_bf16 a[204:207], v[140:143], v[64:67], a[204:207]
    v_mfma_f32_16x16x32_bf16 a[208:211], v[136:139], v[40:43], a[208:211]
    v_mfma_f32_16x16x32_bf16 a[208:211], v[140:143], v[68:71], a[208:211]
    v_mfma_f32_16x16x32_bf16 a[212:215], v[136:139], v[44:47], a[212:215]
    v_mfma_f32_16x16x32_bf16 a[212:215], v[140:143], v[72:75], a[212:215]
    buffer_load_dwordx4 v7, s[4:7], s49 offen offset:1792 nt lds
    v_mfma_f32_16x16x32_bf16 a[216:219], v[136:139], v[48:51], a[216:219]
    v_mfma_f32_16x16x32_bf16 a[216:219], v[140:143], v[76:79], a[216:219]
    v_mfma_f32_16x16x32_bf16 a[220:223], v[136:139], v[52:55], a[220:223]
    v_mfma_f32_16x16x32_bf16 a[220:223], v[140:143], v[80:83], a[220:223]
    ds_read_b64_tr_b16 v[136:137], v11 offset:16992
    ds_read_b64_tr_b16 v[138:139], v11 offset:17120
    ds_read_b64_tr_b16 v[140:141], v11 offset:17504
    ds_read_b64_tr_b16 v[142:143], v11 offset:17632
    s_waitcnt lgkmcnt(8)
    v_mfma_f32_16x16x32_bf16 v[144:147], v[112:115], a[0:3], v[144:147]
    s_add_u32 s29, s34, s100
    v_mfma_f32_16x16x32_bf16 v[144:147], v[116:119], a[28:31], v[144:147]
    s_bfe_u32 s28, s29, 0x20003
    v_mfma_f32_16x16x32_bf16 v[148:151], v[112:115], a[4:7], v[148:151]
    s_lshl_b32 s28, s28, 16
    v_mfma_f32_16x16x32_bf16 v[148:151], v[116:119], a[32:35], v[148:151]
    s_and_b32 s29, s29, 7
    v_mfma_f32_16x16x32_bf16 v[152:155], v[112:115], a[8:11], v[152:155]
    s_lshl_b32 s29, s29, 11
    v_mfma_f32_16x16x32_bf16 v[152:155], v[116:119], a[36:39], v[152:155]
    s_add_u32 s29, s28, s29
    v_mfma_f32_16x16x32_bf16 v[156:159], v[112:115], a[12:15], v[156:159]
    s_lshr_b32 s28, s34, 5
    s_waitcnt vmcnt(16) lgkmcnt(0)
    s_barrier
    v_mfma_f32_16x16x32_bf16 v[156:159], v[116:119], a[40:43], v[156:159]
    s_lshl_b32 s28, s28, 19
    v_mfma_f32_16x16x32_bf16 v[160:163], v[112:115], a[16:19], v[160:163]
    s_add_u32 s49, s28, s29
    v_mfma_f32_16x16x32_bf16 v[160:163], v[116:119], a[44:47], v[160:163]
    s_add_u32 m0, s33, 16896
    v_mfma_f32_16x16x32_bf16 v[164:167], v[112:115], a[20:23], v[164:167]
    s_add_u32 s34, s34, 1
    v_mfma_f32_16x16x32_bf16 v[164:167], v[116:119], a[48:51], v[164:167]
    buffer_load_dwordx4 v7, s[4:7], s49 offen offset:0 nt lds
    v_mfma_f32_16x16x32_bf16 v[168:171], v[112:115], a[24:27], v[168:171]
    s_add_u32 m0, m0, s96
    v_mfma_f32_16x16x32_bf16 v[168:171], v[116:119], a[52:55], v[168:171]
    ds_read_b64_tr_b16 v[112:113], v11 offset:25344
    v_mfma_f32_16x16x32_bf16 v[172:175], v[120:123], a[0:3], v[172:175]
    ds_read_b64_tr_b16 v[114:115], v11 offset:25472
    v_mfma_f32_16x16x32_bf16 v[172:175], v[124:127], a[28:31], v[172:175]
    buffer_load_dwordx4 v7, s[4:7], s49 offen offset:256 nt lds
    v_mfma_f32_16x16x32_bf16 v[176:179], v[120:123], a[4:7], v[176:179]
    s_add_u32 m0, m0, s97
    ds_read_b64_tr_b16 v[116:117], v11 offset:25856
    v_mfma_f32_16x16x32_bf16 v[176:179], v[124:127], a[32:35], v[176:179]
    ds_read_b64_tr_b16 v[118:119], v11 offset:25984
    v_mfma_f32_16x16x32_bf16 v[180:183], v[120:123], a[8:11], v[180:183]
    v_mfma_f32_16x16x32_bf16 v[180:183], v[124:127], a[36:39], v[180:183]
    v_mfma_f32_16x16x32_bf16 v[184:187], v[120:123], a[12:15], v[184:187]
    v_mfma_f32_16x16x32_bf16 v[184:187], v[124:127], a[40:43], v[184:187]
    buffer_load_dwordx4 v7, s[4:7], s49 offen offset:512 nt lds
    v_mfma_f32_16x16x32_bf16 v[188:191], v[120:123], a[16:19], v[188:191]
    s_add_u32 m0, m0, s96
    v_mfma_f32_16x16x32_bf16 v[188:191], v[124:127], a[44:47], v[188:191]
    v_mfma_f32_16x16x32_bf16 v[192:195], v[120:123], a[20:23], v[192:195]
    v_mfma_f32_16x16x32_bf16 v[192:195], v[124:127], a[48:51], v[192:195]
    v_mfma_f32_16x16x32_bf16 v[196:199], v[120:123], a[24:27], v[196:199]
    v_mfma_f32_16x16x32_bf16 v[196:199], v[124:127], a[52:55], v[196:199]
    buffer_load_dwordx4 v7, s[4:7], s49 offen offset:768 nt lds
    v_mfma_f32_16x16x32_bf16 v[200:203], v[128:131], a[0:3], v[200:203]
    s_add_u32 m0, m0, s97
    ds_read_b64_tr_b16 v[120:121], v11 offset:25376
    v_mfma_f32_16x16x32_bf16 v[200:203], v[132:135], a[28:31], v[200:203]
    ds_read_b64_tr_b16 v[122:123], v11 offset:25504
    v_mfma_f32_16x16x32_bf16 v[204:207], v[128:131], a[4:7], v[204:207]
    ds_read_b64_tr_b16 v[124:125], v11 offset:25888
    v_mfma_f32_16x16x32_bf16 v[204:207], v[132:135], a[32:35], v[204:207]
    ds_read_b64_tr_b16 v[126:127], v11 offset:26016
    v_mfma_f32_16x16x32_bf16 v[208:211], v[128:131], a[8:11], v[208:211]
    v_mfma_f32_16x16x32_bf16 v[208:211], v[132:135], a[36:39], v[208:211]
    buffer_load_dwordx4 v7, s[4:7], s49 offen offset:1024 nt lds
    v_mfma_f32_16x16x32_bf16 v[212:215], v[128:131], a[12:15], v[212:215]
    s_add_u32 m0, m0, s96
    v_mfma_f32_16x16x32_bf16 v[212:215], v[132:135], a[40:43], v[212:215]
    v_mfma_f32_16x16x32_bf16 v[216:219], v[128:131], a[16:19], v[216:219]
    v_mfma_f32_16x16x32_bf16 v[216:219], v[132:135], a[44:47], v[216:219]
    v_mfma_f32_16x16x32_bf16 v[220:223], v[128:131], a[20:23], v[220:223]
    v_mfma_f32_16x16x32_bf16 v[220:223], v[132:135], a[48:51], v[220:223]
    buffer_load_dwordx4 v7, s[4:7], s49 offen offset:1280 nt lds
    v_mfma_f32_16x16x32_bf16 v[224:227], v[128:131], a[24:27], v[224:227]
    s_add_u32 m0, m0, s97
    v_mfma_f32_16x16x32_bf16 v[224:227], v[132:135], a[52:55], v[224:227]
    ds_read_b64_tr_b16 v[128:129], v11 offset:25408
    v_mfma_f32_16x16x32_bf16 v[228:231], v[136:139], a[0:3], v[228:231]
    ds_read_b64_tr_b16 v[130:131], v11 offset:25536
    v_mfma_f32_16x16x32_bf16 v[228:231], v[140:143], a[28:31], v[228:231]
    ds_read_b64_tr_b16 v[132:133], v11 offset:25920
    v_mfma_f32_16x16x32_bf16 v[232:235], v[136:139], a[4:7], v[232:235]
    ds_read_b64_tr_b16 v[134:135], v11 offset:26048
    v_mfma_f32_16x16x32_bf16 v[232:235], v[140:143], a[32:35], v[232:235]
    buffer_load_dwordx4 v7, s[4:7], s49 offen offset:1536 nt lds
    v_mfma_f32_16x16x32_bf16 v[236:239], v[136:139], a[8:11], v[236:239]
    s_add_u32 m0, m0, s96
    v_mfma_f32_16x16x32_bf16 v[236:239], v[140:143], a[36:39], v[236:239]
    v_mfma_f32_16x16x32_bf16 v[240:243], v[136:139], a[12:15], v[240:243]
    v_mfma_f32_16x16x32_bf16 v[240:243], v[140:143], a[40:43], v[240:243]
    v_mfma_f32_16x16x32_bf16 v[244:247], v[136:139], a[16:19], v[244:247]
    v_mfma_f32_16x16x32_bf16 v[244:247], v[140:143], a[44:47], v[244:247]
    buffer_load_dwordx4 v7, s[4:7], s49 offen offset:1792 nt lds
    v_mfma_f32_16x16x32_bf16 v[248:251], v[136:139], a[20:23], v[248:251]
    v_mfma_f32_16x16x32_bf16 v[248:251], v[140:143], a[48:51], v[248:251]
    v_mfma_f32_16x16x32_bf16 v[252:255], v[136:139], a[24:27], v[252:255]
    v_mfma_f32_16x16x32_bf16 v[252:255], v[140:143], a[52:55], v[252:255]
    ds_read_b64_tr_b16 v[136:137], v11 offset:25440
    ds_read_b64_tr_b16 v[138:139], v11 offset:25568
    ds_read_b64_tr_b16 v[140:141], v11 offset:25952
    ds_read_b64_tr_b16 v[142:143], v11 offset:26080
    s_waitcnt lgkmcnt(8)
    v_mfma_f32_16x16x32_bf16 a[112:115], v[112:115], a[0:3], a[112:115]
    s_add_u32 s29, s34, s100
    v_mfma_f32_16x16x32_bf16 a[112:115], v[116:119], a[28:31], a[112:115]
    s_bfe_u32 s28, s29, 0x20003
    v_mfma_f32_16x16x32_bf16 a[116:119], v[112:115], a[4:7], a[116:119]
    s_lshl_b32 s28, s28, 16
    v_mfma_f32_16x16x32_bf16 a[116:119], v[116:119], a[32:35], a[116:119]
    s_and_b32 s29, s29, 7
    v_mfma_f32_16x16x32_bf16 a[120:123], v[112:115], a[8:11], a[120:123]
    s_lshl_b32 s29, s29, 11
    v_mfma_f32_16x16x32_bf16 a[120:123], v[116:119], a[36:39], a[120:123]
    s_add_u32 s29, s28, s29
    v_mfma_f32_16x16x32_bf16 a[124:127], v[112:115], a[12:15], a[124:127]
    s_lshr_b32 s28, s34, 5
    s_waitcnt vmcnt(16) lgkmcnt(0)
    s_barrier
    ds_read_b128 v[56:59], v8 offset:0
    v_mfma_f32_16x16x32_bf16 a[124:127], v[116:119], a[40:43], a[124:127]
    s_lshl_b32 s28, s28, 19
    ds_read_b128 v[60:63], v8 offset:64
    v_mfma_f32_16x16x32_bf16 a[128:131], v[112:115], a[16:19], a[128:131]
    s_add_u32 s49, s28, s29
    ds_read_b128 v[64:67], v8 offset:128
    v_mfma_f32_16x16x32_bf16 a[128:131], v[116:119], a[44:47], a[128:131]
    s_add_u32 m0, s33, 25344
    ds_read_b128 v[68:71], v8 offset:192
    v_mfma_f32_16x16x32_bf16 a[132:135], v[112:115], a[20:23], a[132:135]
    s_add_u32 s34, s34, 1
    ds_read_b128 v[72:75], v8 offset:512
    v_mfma_f32_16x16x32_bf16 a[132:135], v[116:119], a[48:51], a[132:135]
    buffer_load_dwordx4 v7, s[4:7], s49 offen offset:0 nt lds
    v_mfma_f32_16x16x32_bf16 a[136:139], v[112:115], a[24:27], a[136:139]
    s_add_u32 m0, m0, s96
    ds_read_b128 v[76:79], v8 offset:576
    v_mfma_f32_16x16x32_bf16 a[136:139], v[116:119], a[52:55], a[136:139]
    ds_read_b128 v[80:83], v8 offset:640
    v_mfma_f32_16x16x32_bf16 a[140:143], v[120:123], a[0:3], a[140:143]
    ds_read_b128 v[84:87], v8 offset:704
    v_mfma_f32_16x16x32_bf16 a[140:143], v[124:127], a[28:31], a[140:143]
    buffer_load_dwordx4 v7, s[4:7], s49 offen offset:256 nt lds
    v_mfma_f32_16x16x32_bf16 a[144:147], v[120:123], a[4:7], a[144:147]
    s_add_u32 m0, m0, s97
    v_mfma_f32_16x16x32_bf16 a[144:147], v[124:127], a[32:35], a[144:147]
    v_mfma_f32_16x16x32_bf16 a[148:151], v[120:123], a[8:11], a[148:151]
    v_mfma_f32_16x16x32_bf16 a[148:151], v[124:127], a[36:39], a[148:151]
    v_mfma_f32_16x16x32_bf16 a[152:155], v[120:123], a[12:15], a[152:155]
    v_mfma_f32_16x16x32_bf16 a[152:155], v[124:127], a[40:43], a[152:155]
    buffer_load_dwordx4 v7, s[4:7], s49 offen offset:512 nt lds
    v_mfma_f32_16x16x32_bf16 a[156:159], v[120:123], a[16:19], a[156:159]
    s_add_u32 m0, m0, s96
    v_mfma_f32_16x16x32_bf16 a[156:159], v[124:127], a[44:47], a[156:159]
    v_mfma_f32_16x16x32_bf16 a[160:163], v[120:123], a[20:23], a[160:163]
    v_mfma_f32_16x16x32_bf16 a[160:163], v[124:127], a[48:51], a[160:163]
    v_mfma_f32_16x16x32_bf16 a[164:167], v[120:123], a[24:27], a[164:167]
    v_mfma_f32_16x16x32_bf16 a[164:167], v[124:127], a[52:55], a[164:167]
    buffer_load_dwordx4 v7, s[4:7], s49 offen offset:768 nt lds
    v_mfma_f32_16x16x32_bf16 a[168:171], v[128:131], a[0:3], a[168:171]
    s_add_u32 m0, m0, s97
    v_mfma_f32_16x16x32_bf16 a[168:171], v[132:135], a[28:31], a[168:171]
    v_mfma_f32_16x16x32_bf16 a[172:175], v[128:131], a[4:7], a[172:175]
    v_mfma_f32_16x16x32_bf16 a[172:175], v[132:135], a[32:35], a[172:175]
    v_mfma_f32_16x16x32_bf16 a[176:179], v[128:131], a[8:11], a[176:179]
    v_mfma_f32_16x16x32_bf16 a[176:179], v[132:135], a[36:39], a[176:179]
    buffer_load_dwordx4 v7, s[4:7], s49 offen offset:1024 nt lds
    v_mfma_f32_16x16x32_bf16 a[180:183], v[128:131], a[12:15], a[180:183]
    s_add_u32 m0, m0, s96
    v_mfma_f32_16x16x32_bf16 a[180:183], v[132:135], a[40:43], a[180:183]
    v_mfma_f32_16x16x32_bf16 a[184:187], v[128:131], a[16:19], a[184:187]
    v_mfma_f32_16x16x32_bf16 a[184:187], v[132:135], a[44:47], a[184:187]
    v_mfma_f32_16x16x32_bf16 a[188:191], v[128:131], a[20:23], a[188:191]
    v_mfma_f32_16x16x32_bf16 a[188:191], v[132:135], a[48:51], a[188:191]
    buffer_load_dwordx4 v7, s[4:7], s49 offen offset:1280 nt lds
    v_mfma_f32_16x16x32_bf16 a[192:195], v[128:131], a[24:27], a[192:195]
    s_add_u32 m0, m0, s97
    v_mfma_f32_16x16x32_bf16 a[192:195], v[132:135], a[52:55], a[192:195]
    v_mfma_f32_16x16x32_bf16 a[196:199], v[136:139], a[0:3], a[196:199]
    v_mfma_f32_16x16x32_bf16 a[196:199], v[140:143], a[28:31], a[196:199]
    v_mfma_f32_16x16x32_bf16 a[200:203], v[136:139], a[4:7], a[200:203]
    v_mfma_f32_16x16x32_bf16 a[200:203], v[140:143], a[32:35], a[200:203]
    buffer_load_dwordx4 v7, s[4:7], s49 offen offset:1536 nt lds
    v_mfma_f32_16x16x32_bf16 a[204:207], v[136:139], a[8:11], a[204:207]
    s_add_u32 m0, m0, s96
    v_mfma_f32_16x16x32_bf16 a[204:207], v[140:143], a[36:39], a[204:207]
    v_mfma_f32_16x16x32_bf16 a[208:211], v[136:139], a[12:15], a[208:211]
    v_mfma_f32_16x16x32_bf16 a[208:211], v[140:143], a[40:43], a[208:211]
    v_mfma_f32_16x16x32_bf16 a[212:215], v[136:139], a[16:19], a[212:215]
    v_mfma_f32_16x16x32_bf16 a[212:215], v[140:143], a[44:47], a[212:215]
    buffer_load_dwordx4 v7, s[4:7], s49 offen offset:1792 nt lds
    v_mfma_f32_16x16x32_bf16 a[216:219], v[136:139], a[20:23], a[216:219]
    v_mfma_f32_16x16x32_bf16 a[216:219], v[140:143], a[48:51], a[216:219]
    v_mfma_f32_16x16x32_bf16 a[220:223], v[136:139], a[24:27], a[220:223]
    v_mfma_f32_16x16x32_bf16 a[220:223], v[140:143], a[52:55], a[220:223]
    s_branch L_at_qpepi
L_at_qptailB:
    s_mul_i32 s50, s21, s52
    s_mov_b32 s101, s21
    s_add_u32 s50, s50, s55
    s_cmp_ge_u32 s21, 2
    s_cselect_b32 s28, 0x40000000, 0
    s_add_u32 s50, s50, s28
    s_mov_b32 s82, s26
    s_mul_i32 s28, s26, s51
    s_add_u32 s50, s50, s28
    s_waitcnt lgkmcnt(8)
    v_mfma_f32_16x16x32_bf16 v[144:147], v[112:115], v[28:31], v[144:147]
    s_add_u32 m0, s33, 0
    v_mfma_f32_16x16x32_bf16 v[144:147], v[116:119], v[56:59], v[144:147]
    s_mov_b32 s49, s50
    v_mfma_f32_16x16x32_bf16 v[148:151], v[112:115], v[32:35], v[148:151]
    v_mfma_f32_16x16x32_bf16 v[148:151], v[116:119], v[60:63], v[148:151]
    v_mfma_f32_16x16x32_bf16 v[152:155], v[112:115], v[36:39], v[152:155]
    v_mfma_f32_16x16x32_bf16 v[152:155], v[116:119], v[64:67], v[152:155]
    v_mfma_f32_16x16x32_bf16 v[156:159], v[112:115], v[40:43], v[156:159]
    s_waitcnt vmcnt(16) lgkmcnt(0)
    s_barrier
    v_mfma_f32_16x16x32_bf16 v[156:159], v[116:119], v[68:71], v[156:159]
    v_mfma_f32_16x16x32_bf16 v[160:163], v[112:115], v[44:47], v[160:163]
    v_mfma_f32_16x16x32_bf16 v[160:163], v[116:119], v[72:75], v[160:163]
    s_add_u32 s28, s49, s88
    buffer_load_dwordx4 v26, s[16:19], s28 offen lds
    v_mfma_f32_16x16x32_bf16 v[164:167], v[112:115], v[48:51], v[164:167]
    s_add_u32 m0, m0, s53
    v_mfma_f32_16x16x32_bf16 v[164:167], v[116:119], v[76:79], v[164:167]
    v_mfma_f32_16x16x32_bf16 v[168:171], v[112:115], v[52:55], v[168:171]
    v_mfma_f32_16x16x32_bf16 v[168:171], v[116:119], v[80:83], v[168:171]
    ds_read_b64_tr_b16 v[112:113], v11 offset:8448
    v_mfma_f32_16x16x32_bf16 v[172:175], v[120:123], v[28:31], v[172:175]
    ds_read_b64_tr_b16 v[114:115], v11 offset:8576
    v_mfma_f32_16x16x32_bf16 v[172:175], v[124:127], v[56:59], v[172:175]
    s_add_u32 s28, s49, s89
    buffer_load_dwordx4 v26, s[16:19], s28 offen lds
    v_mfma_f32_16x16x32_bf16 v[176:179], v[120:123], v[32:35], v[176:179]
    s_add_u32 m0, m0, s53
    ds_read_b64_tr_b16 v[116:117], v11 offset:8960
    v_mfma_f32_16x16x32_bf16 v[176:179], v[124:127], v[60:63], v[176:179]
    ds_read_b64_tr_b16 v[118:119], v11 offset:9088
    v_mfma_f32_16x16x32_bf16 v[180:183], v[120:123], v[36:39], v[180:183]
    v_mfma_f32_16x16x32_bf16 v[180:183], v[124:127], v[64:67], v[180:183]
    v_mfma_f32_16x16x32_bf16 v[184:187], v[120:123], v[40:43], v[184:187]
    v_mfma_f32_16x16x32_bf16 v[184:187], v[124:127], v[68:71], v[184:187]
    s_add_u32 s28, s49, s90
    buffer_load_dwordx4 v26, s[16:19], s28 offen lds
    v_mfma_f32_16x16x32_bf16 v[188:191], v[120:123], v[44:47], v[188:191]
    s_add_u32 m0, m0, s53
    v_mfma_f32_16x16x32_bf16 v[188:191], v[124:127], v[72:75], v[188:191]
    v_mfma_f32_16x16x32_bf16 v[192:195], v[120:123], v[48:51], v[192:195]
    v_mfma_f32_16x16x32_bf16 v[192:195], v[124:127], v[76:79], v[192:195]
    v_mfma_f32_16x16x32_bf16 v[196:199], v[120:123], v[52:55], v[196:199]
    v_mfma_f32_16x16x32_bf16 v[196:199], v[124:127], v[80:83], v[196:199]
    s_add_u32 s28, s49, s91
    buffer_load_dwordx4 v26, s[16:19], s28 offen lds
    v_mfma_f32_16x16x32_bf16 v[200:203], v[128:131], v[28:31], v[200:203]
    s_add_u32 m0, m0, s53
    ds_read_b64_tr_b16 v[120:121], v11 offset:8480
    v_mfma_f32_16x16x32_bf16 v[200:203], v[132:135], v[56:59], v[200:203]
    ds_read_b64_tr_b16 v[122:123], v11 offset:8608
    v_mfma_f32_16x16x32_bf16 v[204:207], v[128:131], v[32:35], v[204:207]
    ds_read_b64_tr_b16 v[124:125], v11 offset:8992
    v_mfma_f32_16x16x32_bf16 v[204:207], v[132:135], v[60:63], v[204:207]
    ds_read_b64_tr_b16 v[126:127], v11 offset:9120
    v_mfma_f32_16x16x32_bf16 v[208:211], v[128:131], v[36:39], v[208:211]
    v_mfma_f32_16x16x32_bf16 v[208:211], v[132:135], v[64:67], v[208:211]
    s_add_u32 s28, s49, s92
    buffer_load_dwordx4 v26, s[16:19], s28 offen lds
    v_mfma_f32_16x16x32_bf16 v[212:215], v[128:131], v[40:43], v[212:215]
    s_add_u32 m0, m0, s53
    v_mfma_f32_16x16x32_bf16 v[212:215], v[132:135], v[68:71], v[212:215]
    v_mfma_f32_16x16x32_bf16 v[216:219], v[128:131], v[44:47], v[216:219]
    v_mfma_f32_16x16x32_bf16 v[216:219], v[132:135], v[72:75], v[216:219]
    v_mfma_f32_16x16x32_bf16 v[220:223], v[128:131], v[48:51], v[220:223]
    v_mfma_f32_16x16x32_bf16 v[220:223], v[132:135], v[76:79], v[220:223]
    s_add_u32 s28, s49, s93
    buffer_load_dwordx4 v26, s[16:19], s28 offen lds
    v_mfma_f32_16x16x32_bf16 v[224:227], v[128:131], v[52:55], v[224:227]
    s_add_u32 m0, m0, s53
    v_mfma_f32_16x16x32_bf16 v[224:227], v[132:135], v[80:83], v[224:227]
    ds_read_b64_tr_b16 v[128:129], v11 offset:8512
    v_mfma_f32_16x16x32_bf16 v[228:231], v[136:139], v[28:31], v[228:231]
    ds_read_b64_tr_b16 v[130:131], v11 offset:8640
    v_mfma_f32_16x16x32_bf16 v[228:231], v[140:143], v[56:59], v[228:231]
    ds_read_b64_tr_b16 v[132:133], v11 offset:9024
    v_mfma_f32_16x16x32_bf16 v[232:235], v[136:139], v[32:35], v[232:235]
    ds_read_b64_tr_b16 v[134:135], v11 offset:9152
    v_mfma_f32_16x16x32_bf16 v[232:235], v[140:143], v[60:63], v[232:235]
    s_add_u32 s28, s49, s94
    buffer_load_dwordx4 v26, s[16:19], s28 offen lds
    v_mfma_f32_16x16x32_bf16 v[236:239], v[136:139], v[36:39], v[236:239]
    s_add_u32 m0, m0, s53
    v_mfma_f32_16x16x32_bf16 v[236:239], v[140:143], v[64:67], v[236:239]
    v_mfma_f32_16x16x32_bf16 v[240:243], v[136:139], v[40:43], v[240:243]
    v_mfma_f32_16x16x32_bf16 v[240:243], v[140:143], v[68:71], v[240:243]
    v_mfma_f32_16x16x32_bf16 v[244:247], v[136:139], v[44:47], v[244:247]
    v_mfma_f32_16x16x32_bf16 v[244:247], v[140:143], v[72:75], v[244:247]
    s_add_u32 s28, s49, s95
    buffer_load_dwordx4 v26, s[16:19], s28 offen lds
    v_mfma_f32_16x16x32_bf16 v[248:251], v[136:139], v[48:51], v[248:251]
    v_mfma_f32_16x16x32_bf16 v[248:251], v[140:143], v[76:79], v[248:251]
    v_mfma_f32_16x16x32_bf16 v[252:255], v[136:139], v[52:55], v[252:255]
    v_mfma_f32_16x16x32_bf16 v[252:255], v[140:143], v[80:83], v[252:255]
    ds_read_b64_tr_b16 v[136:137], v11 offset:8544
    ds_read_b64_tr_b16 v[138:139], v11 offset:8672
    ds_read_b64_tr_b16 v[140:141], v11 offset:9056
    ds_read_b64_tr_b16 v[142:143], v11 offset:9184
    s_waitcnt lgkmcnt(8)
    v_mfma_f32_16x16x32_bf16 a[112:115], v[112:115], v[28:31], a[112:115]
    s_add_u32 m0, s33, 8448
    v_mfma_f32_16x16x32_bf16 a[112:115], v[116:119], v[56:59], a[112:115]
    s_add_u32 s49, s50, s46
    v_mfma_f32_16x16x32_bf16 a[116:119], v[112:115], v[32:35], a[116:119]
    s_lshl1_add_u32 s50, s51, s50
    v_mfma_f32_16x16x32_bf16 a[116:119], v[116:119], v[60:63], a[116:119]
    s_add_u32 s82, s82, 2
    v_mfma_f32_16x16x32_bf16 a[120:123], v[112:115], v[36:39], a[120:123]
    s_cmp_eq_u32 s82, 20
    v_mfma_f32_16x16x32_bf16 a[120:123], v[116:119], v[64:67], a[120:123]
    s_cselect_b32 s29, s83, 0
    v_mfma_f32_16x16x32_bf16 a[124:127], v[112:115], v[40:43], a[124:127]
    s_sub_u32 s50, s50, s29
    s_waitcnt vmcnt(8) lgkmcnt(0)
    s_barrier
    ds_read_b128 a[0:3], v27 offset:16896
    v_mfma_f32_16x16x32_bf16 a[124:127], v[116:119], v[68:71], a[124:127]
    ds_read_b128 a[4:7], v27 offset:17920
    v_mfma_f32_16x16x32_bf16 a[128:131], v[112:115], v[44:47], a[128:131]
    ds_read_b128 a[8:11], v27 offset:18944
    v_mfma_f32_16x16x32_bf16 a[128:131], v[116:119], v[72:75], a[128:131]
    s_add_u32 s28, s49, s88
    buffer_load_dwordx4 v26, s[16:19], s28 offen lds
    v_mfma_f32_16x16x32_bf16 a[132:135], v[112:115], v[48:51], a[132:135]
    s_add_u32 m0, m0, s53
    ds_read_b128 a[12:15], v27 offset:19968
    v_mfma_f32_16x16x32_bf16 a[132:135], v[116:119], v[76:79], a[132:135]
    ds_read_b128 a[16:19], v27 offset:20992
    v_mfma_f32_16x16x32_bf16 a[136:139], v[112:115], v[52:55], a[136:139]
    ds_read_b128 a[20:23], v27 offset:22016
    v_mfma_f32_16x16x32_bf16 a[136:139], v[116:119], v[80:83], a[136:139]
    ds_read_b128 a[24:27], v27 offset:23040
    v_mfma_f32_16x16x32_bf16 a[140:143], v[120:123], v[28:31], a[140:143]
    ds_read_b128 a[28:31], v27 offset:25344
    v_mfma_f32_16x16x32_bf16 a[140:143], v[124:127], v[56:59], a[140:143]
    s_add_u32 s28, s49, s89
    buffer_load_dwordx4 v26, s[16:19], s28 offen lds
    v_mfma_f32_16x16x32_bf16 a[144:147], v[120:123], v[32:35], a[144:147]
    s_add_u32 m0, m0, s53
    ds_read_b128 a[32:35], v27 offset:26368
    v_mfma_f32_16x16x32_bf16 a[144:147], v[124:127], v[60:63], a[144:147]
    ds_read_b128 a[36:39], v27 offset:27392
    v_mfma_f32_16x16x32_bf16 a[148:151], v[120:123], v[36:39], a[148:151]
    ds_read_b128 a[40:43], v27 offset:28416
    v_mfma_f32_16x16x32_bf16 a[148:151], v[124:127], v[64:67], a[148:151]
    ds_read_b128 a[44:47], v27 offset:29440
    v_mfma_f32_16x16x32_bf16 a[152:155], v[120:123], v[40:43], a[152:155]
    ds_read_b128 a[48:51], v27 offset:30464
    v_mfma_f32_16x16x32_bf16 a[152:155], v[124:127], v[68:71], a[152:155]
    s_add_u32 s28, s49, s90
    buffer_load_dwordx4 v26, s[16:19], s28 offen lds
    v_mfma_f32_16x16x32_bf16 a[156:159], v[120:123], v[44:47], a[156:159]
    s_add_u32 m0, m0, s53
    ds_read_b128 a[52:55], v27 offset:31488
    v_mfma_f32_16x16x32_bf16 a[156:159], v[124:127], v[72:75], a[156:159]
    ds_read_b64_tr_b16 v[112:113], v11 offset:16896
    v_mfma_f32_16x16x32_bf16 a[160:163], v[120:123], v[48:51], a[160:163]
    ds_read_b64_tr_b16 v[114:115], v11 offset:17024
    v_mfma_f32_16x16x32_bf16 a[160:163], v[124:127], v[76:79], a[160:163]
    ds_read_b64_tr_b16 v[116:117], v11 offset:17408
    v_mfma_f32_16x16x32_bf16 a[164:167], v[120:123], v[52:55], a[164:167]
    ds_read_b64_tr_b16 v[118:119], v11 offset:17536
    v_mfma_f32_16x16x32_bf16 a[164:167], v[124:127], v[80:83], a[164:167]
    s_add_u32 s28, s49, s91
    buffer_load_dwordx4 v26, s[16:19], s28 offen lds
    v_mfma_f32_16x16x32_bf16 a[168:171], v[128:131], v[28:31], a[168:171]
    s_add_u32 m0, m0, s53
    ds_read_b64_tr_b16 v[120:121], v11 offset:16928
    v_mfma_f32_16x16x32_bf16 a[168:171], v[132:135], v[56:59], a[168:171]
    ds_read_b64_tr_b16 v[122:123], v11 offset:17056
    v_mfma_f32_16x16x32_bf16 a[172:175], v[128:131], v[32:35], a[172:175]
    ds_read_b64_tr_b16 v[124:125], v11 offset:17440
    v_mfma_f32_16x16x32_bf16 a[172:175], v[132:135], v[60:63], a[172:175]
    ds_read_b64_tr_b16 v[126:127], v11 offset:17568
    v_mfma_f32_16x16x32_bf16 a[176:179], v[128:131], v[36:39], a[176:179]
    v_mfma_f32_16x16x32_bf16 a[176:179], v[132:135], v[64:67], a[176:179]
    s_add_u32 s28, s49, s92
    buffer_load_dwordx4 v26, s[16:19], s28 offen lds
    v_mfma_f32_16x16x32_bf16 a[180:183], v[128:131], v[40:43], a[180:183]
    s_add_u32 m0, m0, s53
    v_mfma_f32_16x16x32_bf16 a[180:183], v[132:135], v[68:71], a[180:183]
    v_mfma_f32_16x16x32_bf16 a[184:187], v[128:131], v[44:47], a[184:187]
    v_mfma_f32_16x16x32_bf16 a[184:187], v[132:135], v[72:75], a[184:187]
    v_mfma_f32_16x16x32_bf16 a[188:191], v[128:131], v[48:51], a[188:191]
    v_mfma_f32_16x16x32_bf16 a[188:191], v[132:135], v[76:79], a[188:191]
    s_add_u32 s28, s49, s93
    buffer_load_dwordx4 v26, s[16:19], s28 offen lds
    v_mfma_f32_16x16x32_bf16 a[192:195], v[128:131], v[52:55], a[192:195]
    s_add_u32 m0, m0, s53
    v_mfma_f32_16x16x32_bf16 a[192:195], v[132:135], v[80:83], a[192:195]
    ds_read_b64_tr_b16 v[128:129], v11 offset:16960
    v_mfma_f32_16x16x32_bf16 a[196:199], v[136:139], v[28:31], a[196:199]
    ds_read_b64_tr_b16 v[130:131], v11 offset:17088
    v_mfma_f32_16x16x32_bf16 a[196:199], v[140:143], v[56:59], a[196:199]
    ds_read_b64_tr_b16 v[132:133], v11 offset:17472
    v_mfma_f32_16x16x32_bf16 a[200:203], v[136:139], v[32:35], a[200:203]
    ds_read_b64_tr_b16 v[134:135], v11 offset:17600
    v_mfma_f32_16x16x32_bf16 a[200:203], v[140:143], v[60:63], a[200:203]
    s_add_u32 s28, s49, s94
    buffer_load_dwordx4 v26, s[16:19], s28 offen lds
    v_mfma_f32_16x16x32_bf16 a[204:207], v[136:139], v[36:39], a[204:207]
    s_add_u32 m0, m0, s53
    v_mfma_f32_16x16x32_bf16 a[204:207], v[140:143], v[64:67], a[204:207]
    v_mfma_f32_16x16x32_bf16 a[208:211], v[136:139], v[40:43], a[208:211]
    v_mfma_f32_16x16x32_bf16 a[208:211], v[140:143], v[68:71], a[208:211]
    v_mfma_f32_16x16x32_bf16 a[212:215], v[136:139], v[44:47], a[212:215]
    v_mfma_f32_16x16x32_bf16 a[212:215], v[140:143], v[72:75], a[212:215]
    s_add_u32 s28, s49, s95
    buffer_load_dwordx4 v26, s[16:19], s28 offen lds
    v_mfma_f32_16x16x32_bf16 a[216:219], v[136:139], v[48:51], a[216:219]
    v_mfma_f32_16x16x32_bf16 a[216:219], v[140:143], v[76:79], a[216:219]
    v_mfma_f32_16x16x32_bf16 a[220:223], v[136:139], v[52:55], a[220:223]
    v_mfma_f32_16x16x32_bf16 a[220:223], v[140:143], v[80:83], a[220:223]
    ds_read_b64_tr_b16 v[136:137], v11 offset:16992
    ds_read_b64_tr_b16 v[138:139], v11 offset:17120
    ds_read_b64_tr_b16 v[140:141], v11 offset:17504
    ds_read_b64_tr_b16 v[142:143], v11 offset:17632
    s_waitcnt lgkmcnt(8)
    v_mfma_f32_16x16x32_bf16 v[144:147], v[112:115], a[0:3], v[144:147]
    s_add_u32 m0, s33, 16896
    v_mfma_f32_16x16x32_bf16 v[144:147], v[116:119], a[28:31], v[144:147]
    s_mov_b32 s49, s50
    v_mfma_f32_16x16x32_bf16 v[148:151], v[112:115], a[4:7], v[148:151]
    v_mfma_f32_16x16x32_bf16 v[148:151], v[116:119], a[32:35], v[148:151]
    v_mfma_f32_16x16x32_bf16 v[152:155], v[112:115], a[8:11], v[152:155]
    v_mfma_f32_16x16x32_bf16 v[152:155], v[116:119], a[36:39], v[152:155]
    v_mfma_f32_16x16x32_bf16 v[156:159], v[112:115], a[12:15], v[156:159]
    s_waitcnt vmcnt(16) lgkmcnt(0)
    s_barrier
    v_mfma_f32_16x16x32_bf16 v[156:159], v[116:119], a[40:43], v[156:159]
    v_mfma_f32_16x16x32_bf16 v[160:163], v[112:115], a[16:19], v[160:163]
    v_mfma_f32_16x16x32_bf16 v[160:163], v[116:119], a[44:47], v[160:163]
    s_add_u32 s28, s49, s88
    buffer_load_dwordx4 v26, s[16:19], s28 offen lds
    v_mfma_f32_16x16x32_bf16 v[164:167], v[112:115], a[20:23], v[164:167]
    s_add_u32 m0, m0, s53
    v_mfma_f32_16x16x32_bf16 v[164:167], v[116:119], a[48:51], v[164:167]
    v_mfma_f32_16x16x32_bf16 v[168:171], v[112:115], a[24:27], v[168:171]
    v_mfma_f32_16x16x32_bf16 v[168:171], v[116:119], a[52:55], v[168:171]
    ds_read_b64_tr_b16 v[112:113], v11 offset:25344
    v_mfma_f32_16x16x32_bf16 v[172:175], v[120:123], a[0:3], v[172:175]
    ds_read_b64_tr_b16 v[114:115], v11 offset:25472
    v_mfma_f32_16x16x32_bf16 v[172:175], v[124:127], a[28:31], v[172:175]
    s_add_u32 s28, s49, s89
    buffer_load_dwordx4 v26, s[16:19], s28 offen lds
    v_mfma_f32_16x16x32_bf16 v[176:179], v[120:123], a[4:7], v[176:179]
    s_add_u32 m0, m0, s53
    ds_read_b64_tr_b16 v[116:117], v11 offset:25856
    v_mfma_f32_16x16x32_bf16 v[176:179], v[124:127], a[32:35], v[176:179]
    ds_read_b64_tr_b16 v[118:119], v11 offset:25984
    v_mfma_f32_16x16x32_bf16 v[180:183], v[120:123], a[8:11], v[180:183]
    v_mfma_f32_16x16x32_bf16 v[180:183], v[124:127], a[36:39], v[180:183]
    v_mfma_f32_16x16x32_bf16 v[184:187], v[120:123], a[12:15], v[184:187]
    v_mfma_f32_16x16x32_bf16 v[184:187], v[124:127], a[40:43], v[184:187]
    s_add_u32 s28, s49, s90
    buffer_load_dwordx4 v26, s[16:19], s28 offen lds
    v_mfma_f32_16x16x32_bf16 v[188:191], v[120:123], a[16:19], v[188:191]
    s_add_u32 m0, m0, s53
    v_mfma_f32_16x16x32_bf16 v[188:191], v[124:127], a[44:47], v[188:191]
    v_mfma_f32_16x16x32_bf16 v[192:195], v[120:123], a[20:23], v[192:195]
    v_mfma_f32_16x16x32_bf16 v[192:195], v[124:127], a[48:51], v[192:195]
    v_mfma_f32_16x16x32_bf16 v[196:199], v[120:123], a[24:27], v[196:199]
    v_mfma_f32_16x16x32_bf16 v[196:199], v[124:127], a[52:55], v[196:199]
    s_add_u32 s28, s49, s91
    buffer_load_dwordx4 v26, s[16:19], s28 offen lds
    v_mfma_f32_16x16x32_bf16 v[200:203], v[128:131], a[0:3], v[200:203]
    s_add_u32 m0, m0, s53
    ds_read_b64_tr_b16 v[120:121], v11 offset:25376
    v_mfma_f32_16x16x32_bf16 v[200:203], v[132:135], a[28:31], v[200:203]
    ds_read_b64_tr_b16 v[122:123], v11 offset:25504
    v_mfma_f32_16x16x32_bf16 v[204:207], v[128:131], a[4:7], v[204:207]
    ds_read_b64_tr_b16 v[124:125], v11 offset:25888
    v_mfma_f32_16x16x32_bf16 v[204:207], v[132:135], a[32:35], v[204:207]
    ds_read_b64_tr_b16 v[126:127], v11 offset:26016
    v_mfma_f32_16x16x32_bf16 v[208:211], v[128:131], a[8:11], v[208:211]
    v_mfma_f32_16x16x32_bf16 v[208:211], v[132:135], a[36:39], v[208:211]
    s_add_u32 s28, s49, s92
    buffer_load_dwordx4 v26, s[16:19], s28 offen lds
    v_mfma_f32_16x16x32_bf16 v[212:215], v[128:131], a[12:15], v[212:215]
    s_add_u32 m0, m0, s53
    v_mfma_f32_16x16x32_bf16 v[212:215], v[132:135], a[40:43], v[212:215]
    v_mfma_f32_16x16x32_bf16 v[216:219], v[128:131], a[16:19], v[216:219]
    v_mfma_f32_16x16x32_bf16 v[216:219], v[132:135], a[44:47], v[216:219]
    v_mfma_f32_16x16x32_bf16 v[220:223], v[128:131], a[20:23], v[220:223]
    v_mfma_f32_16x16x32_bf16 v[220:223], v[132:135], a[48:51], v[220:223]
    s_add_u32 s28, s49, s93
    buffer_load_dwordx4 v26, s[16:19], s28 offen lds
    v_mfma_f32_16x16x32_bf16 v[224:227], v[128:131], a[24:27], v[224:227]
    s_add_u32 m0, m0, s53
    v_mfma_f32_16x16x32_bf16 v[224:227], v[132:135], a[52:55], v[224:227]
    ds_read_b64_tr_b16 v[128:129], v11 offset:25408
    v_mfma_f32_16x16x32_bf16 v[228:231], v[136:139], a[0:3], v[228:231]
    ds_read_b64_tr_b16 v[130:131], v11 offset:25536
    v_mfma_f32_16x16x32_bf16 v[228:231], v[140:143], a[28:31], v[228:231]
    ds_read_b64_tr_b16 v[132:133], v11 offset:25920
    v_mfma_f32_16x16x32_bf16 v[232:235], v[136:139], a[4:7], v[232:235]
    ds_read_b64_tr_b16 v[134:135], v11 offset:26048
    v_mfma_f32_16x16x32_bf16 v[232:235], v[140:143], a[32:35], v[232:235]
    s_add_u32 s28, s49, s94
    buffer_load_dwordx4 v26, s[16:19], s28 offen lds
    v_mfma_f32_16x16x32_bf16 v[236:239], v[136:139], a[8:11], v[236:239]
    s_add_u32 m0, m0, s53
    v_mfma_f32_16x16x32_bf16 v[236:239], v[140:143], a[36:39], v[236:239]
    v_mfma_f32_16x16x32_bf16 v[240:243], v[136:139], a[12:15], v[240:243]
    v_mfma_f32_16x16x32_bf16 v[240:243], v[140:143], a[40:43], v[240:243]
    v_mfma_f32_16x16x32_bf16 v[244:247], v[136:139], a[16:19], v[244:247]
    v_mfma_f32_16x16x32_bf16 v[244:247], v[140:143], a[44:47], v[244:247]
    s_add_u32 s28, s49, s95
    buffer_load_dwordx4 v26, s[16:19], s28 offen lds
    v_mfma_f32_16x16x32_bf16 v[248:251], v[136:139], a[20:23], v[248:251]
    v_mfma_f32_16x16x32_bf16 v[248:251], v[140:143], a[48:51], v[248:251]
    v_mfma_f32_16x16x32_bf16 v[252:255], v[136:139], a[24:27], v[252:255]
    v_mfma_f32_16x16x32_bf16 v[252:255], v[140:143], a[52:55], v[252:255]
    ds_read_b64_tr_b16 v[136:137], v11 offset:25440
    ds_read_b64_tr_b16 v[138:139], v11 offset:25568
    ds_read_b64_tr_b16 v[140:141], v11 offset:25952
    ds_read_b64_tr_b16 v[142:143], v11 offset:26080
    s_waitcnt lgkmcnt(8)
    v_mfma_f32_16x16x32_bf16 a[112:115], v[112:115], a[0:3], a[112:115]
    s_add_u32 m0, s33, 25344
    v_mfma_f32_16x16x32_bf16 a[112:115], v[116:119], a[28:31], a[112:115]
    s_add_u32 s49, s50, s46
    v_mfma_f32_16x16x32_bf16 a[116:119], v[112:115], a[4:7], a[116:119]
    s_lshl1_add_u32 s50, s51, s50
    v_mfma_f32_16x16x32_bf16 a[116:119], v[116:119], a[32:35], a[116:119]
    s_add_u32 s82, s82, 2
    v_mfma_f32_16x16x32_bf16 a[120:123], v[112:115], a[8:11], a[120:123]
    s_cmp_eq_u32 s82, 20
    v_mfma_f32_16x16x32_bf16 a[120:123], v[116:119], a[36:39], a[120:123]
    s_cselect_b32 s29, s83, 0
    v_mfma_f32_16x16x32_bf16 a[124:127], v[112:115], a[12:15], a[124:127]
    s_sub_u32 s50, s50, s29
    s_waitcnt vmcnt(8) lgkmcnt(0)
    s_barrier
    v_mfma_f32_16x16x32_bf16 a[124:127], v[116:119], a[40:43], a[124:127]
    v_mfma_f32_16x16x32_bf16 a[128:131], v[112:115], a[16:19], a[128:131]
    v_mfma_f32_16x16x32_bf16 a[128:131], v[116:119], a[44:47], a[128:131]
    s_add_u32 s28, s49, s88
    buffer_load_dwordx4 v26, s[16:19], s28 offen lds
    v_mfma_f32_16x16x32_bf16 a[132:135], v[112:115], a[20:23], a[132:135]
    s_add_u32 m0, m0, s53
    v_mfma_f32_16x16x32_bf16 a[132:135], v[116:119], a[48:51], a[132:135]
    v_mfma_f32_16x16x32_bf16 a[136:139], v[112:115], a[24:27], a[136:139]
    v_mfma_f32_16x16x32_bf16 a[136:139], v[116:119], a[52:55], a[136:139]
    v_mfma_f32_16x16x32_bf16 a[140:143], v[120:123], a[0:3], a[140:143]
    v_mfma_f32_16x16x32_bf16 a[140:143], v[124:127], a[28:31], a[140:143]
    s_add_u32 s28, s49, s89
    buffer_load_dwordx4 v26, s[16:19], s28 offen lds
    v_mfma_f32_16x16x32_bf16 a[144:147], v[120:123], a[4:7], a[144:147]
    s_add_u32 m0, m0, s53
    v_mfma_f32_16x16x32_bf16 a[144:147], v[124:127], a[32:35], a[144:147]
    v_mfma_f32_16x16x32_bf16 a[148:151], v[120:123], a[8:11], a[148:151]
    v_mfma_f32_16x16x32_bf16 a[148:151], v[124:127], a[36:39], a[148:151]
    v_mfma_f32_16x16x32_bf16 a[152:155], v[120:123], a[12:15], a[152:155]
    v_mfma_f32_16x16x32_bf16 a[152:155], v[124:127], a[40:43], a[152:155]
    s_add_u32 s28, s49, s90
    buffer_load_dwordx4 v26, s[16:19], s28 offen lds
    v_mfma_f32_16x16x32_bf16 a[156:159], v[120:123], a[16:19], a[156:159]
    s_add_u32 m0, m0, s53
    v_mfma_f32_16x16x32_bf16 a[156:159], v[124:127], a[44:47], a[156:159]
    v_mfma_f32_16x16x32_bf16 a[160:163], v[120:123], a[20:23], a[160:163]
    v_mfma_f32_16x16x32_bf16 a[160:163], v[124:127], a[48:51], a[160:163]
    v_mfma_f32_16x16x32_bf16 a[164:167], v[120:123], a[24:27], a[164:167]
    v_mfma_f32_16x16x32_bf16 a[164:167], v[124:127], a[52:55], a[164:167]
    s_add_u32 s28, s49, s91
    buffer_load_dwordx4 v26, s[16:19], s28 offen lds
    v_mfma_f32_16x16x32_bf16 a[168:171], v[128:131], a[0:3], a[168:171]
    s_add_u32 m0, m0, s53
    v_mfma_f32_16x16x32_bf16 a[168:171], v[132:135], a[28:31], a[168:171]
    v_mfma_f32_16x16x32_bf16 a[172:175], v[128:131], a[4:7], a[172:175]
    v_mfma_f32_16x16x32_bf16 a[172:175], v[132:135], a[32:35], a[172:175]
    v_mfma_f32_16x16x32_bf16 a[176:179], v[128:131], a[8:11], a[176:179]
    v_mfma_f32_16x16x32_bf16 a[176:179], v[132:135], a[36:39], a[176:179]
    s_add_u32 s28, s49, s92
    buffer_load_dwordx4 v26, s[16:19], s28 offen lds
    v_mfma_f32_16x16x32_bf16 a[180:183], v[128:131], a[12:15], a[180:183]
    s_add_u32 m0, m0, s53
    v_mfma_f32_16x16x32_bf16 a[180:183], v[132:135], a[40:43], a[180:183]
    v_mfma_f32_16x16x32_bf16 a[184:187], v[128:131], a[16:19], a[184:187]
    v_mfma_f32_16x16x32_bf16 a[184:187], v[132:135], a[44:47], a[184:187]
    v_mfma_f32_16x16x32_bf16 a[188:191], v[128:131], a[20:23], a[188:191]
    v_mfma_f32_16x16x32_bf16 a[188:191], v[132:135], a[48:51], a[188:191]
    s_add_u32 s28, s49, s93
    buffer_load_dwordx4 v26, s[16:19], s28 offen lds
    v_mfma_f32_16x16x32_bf16 a[192:195], v[128:131], a[24:27], a[192:195]
    s_add_u32 m0, m0, s53
    v_mfma_f32_16x16x32_bf16 a[192:195], v[132:135], a[52:55], a[192:195]
    v_mfma_f32_16x16x32_bf16 a[196:199], v[136:139], a[0:3], a[196:199]
    v_mfma_f32_16x16x32_bf16 a[196:199], v[140:143], a[28:31], a[196:199]
    v_mfma_f32_16x16x32_bf16 a[200:203], v[136:139], a[4:7], a[200:203]
    v_mfma_f32_16x16x32_bf16 a[200:203], v[140:143], a[32:35], a[200:203]
    s_add_u32 s28, s49, s94
    buffer_load_dwordx4 v26, s[16:19], s28 offen lds
    v_mfma_f32_16x16x32_bf16 a[204:207], v[136:139], a[8:11], a[204:207]
    s_add_u32 m0, m0, s53
    v_mfma_f32_16x16x32_bf16 a[204:207], v[140:143], a[36:39], a[204:207]
    v_mfma_f32_16x16x32_bf16 a[208:211], v[136:139], a[12:15], a[208:211]
    v_mfma_f32_16x16x32_bf16 a[208:211], v[140:143], a[40:43], a[208:211]
    v_mfma_f32_16x16x32_bf16 a[212:215], v[136:139], a[16:19], a[212:215]
    v_mfma_f32_16x16x32_bf16 a[212:215], v[140:143], a[44:47], a[212:215]
    s_add_u32 s28, s49, s95
    buffer_load_dwordx4 v26, s[16:19], s28 offen lds
    v_mfma_f32_16x16x32_bf16 a[216:219], v[136:139], a[20:23], a[216:219]
    v_mfma_f32_16x16x32_bf16 a[216:219], v[140:143], a[48:51], a[216:219]
    v_mfma_f32_16x16x32_bf16 a[220:223], v[136:139], a[24:27], a[220:223]
    v_mfma_f32_16x16x32_bf16 a[220:223], v[140:143], a[52:55], a[220:223]
L_at_qpepi:
    v_mov_b32 v4, s54
    v_mov_b32 v5, s54
    s_nop 6
    v_pk_mul_f32 v[144:145], v[144:145], v[4:5]
    v_pk_mul_f32 v[146:147], v[146:147], v[4:5]
    v_pk_mul_f32 v[148:149], v[148:149], v[4:5]
    v_pk_mul_f32 v[150:151], v[150:151], v[4:5]
    v_pk_mul_f32 v[152:153], v[152:153], v[4:5]
    v_pk_mul_f32 v[154:155], v[154:155], v[4:5]
    v_pk_mul_f32 v[156:157], v[156:157], v[4:5]
    v_pk_mul_f32 v[158:159], v[158:159], v[4:5]
    v_pk_mul_f32 v[160:161], v[160:161], v[4:5]
    v_pk_mul_f32 v[162:163], v[162:163], v[4:5]
    v_pk_mul_f32 v[164:165], v[164:165], v[4:5]
    v_pk_mul_f32 v[166:167], v[166:167], v[4:5]
    v_pk_mul_f32 v[168:169], v[168:169], v[4:5]
    v_pk_mul_f32 v[170:171], v[170:171], v[4:5]
    v_pk_mul_f32 v[172:173], v[172:173], v[4:5]
    v_pk_mul_f32 v[174:175], v[174:175], v[4:5]
    v_pk_mul_f32 v[176:177], v[176:177], v[4:5]
    v_pk_mul_f32 v[178:179], v[178:179], v[4:5]
    v_pk_mul_f32 v[180:181], v[180:181], v[4:5]
    v_pk_mul_f32 v[182:183], v[182:183], v[4:5]
    v_pk_mul_f32 v[184:185], v[184:185], v[4:5]
    v_pk_mul_f32 v[186:187], v[186:187], v[4:5]
    v_pk_mul_f32 v[188:189], v[188:189], v[4:5]
    v_pk_mul_f32 v[190:191], v[190:191], v[4:5]
    v_pk_mul_f32 v[192:193], v[192:193], v[4:5]
    v_pk_mul_f32 v[194:195], v[194:195], v[4:5]
    v_pk_mul_f32 v[196:197], v[196:197], v[4:5]
    v_pk_mul_f32 v[198:199], v[198:199], v[4:5]
    v_cvt_pk_bf16_f32 v88, v144, v145
    v_cvt_pk_bf16_f32 v89, v146, v147
    v_cvt_pk_bf16_f32 v90, v172, v173
    v_cvt_pk_bf16_f32 v91, v174, v175
    v_cvt_pk_bf16_f32 v92, v148, v149
    v_cvt_pk_bf16_f32 v93, v150, v151
    v_cvt_pk_bf16_f32 v94, v176, v177
    v_cvt_pk_bf16_f32 v95, v178, v179
    v_cvt_pk_bf16_f32 v96, v152, v153
    v_cvt_pk_bf16_f32 v97, v154, v155
    v_cvt_pk_bf16_f32 v98, v180, v181
    v_cvt_pk_bf16_f32 v99, v182, v183
    v_cvt_pk_bf16_f32 v100, v156, v157
    v_cvt_pk_bf16_f32 v101, v158, v159
    v_cvt_pk_bf16_f32 v102, v184, v185
    v_cvt_pk_bf16_f32 v103, v186, v187
    v_cvt_pk_bf16_f32 v104, v160, v161
    v_cvt_pk_bf16_f32 v105, v162, v163
    v_cvt_pk_bf16_f32 v106, v188, v189
    v_cvt_pk_bf16_f32 v107, v190, v191
    v_cvt_pk_bf16_f32 v108, v164, v165
    v_cvt_pk_bf16_f32 v109, v166, v167
    v_cvt_pk_bf16_f32 v110, v192, v193
    v_cvt_pk_bf16_f32 v111, v194, v195
    v_cvt_pk_bf16_f32 v112, v168, v169
    v_cvt_pk_bf16_f32 v113, v170, v171
    v_cvt_pk_bf16_f32 v114, v196, v197
    v_cvt_pk_bf16_f32 v115, v198, v199
    s_nop 1
    v_permlane16_swap_b32 v88, v90
    v_permlane16_swap_b32 v89, v91
    v_permlane16_swap_b32 v92, v94
    v_permlane16_swap_b32 v93, v95
    v_permlane16_swap_b32 v96, v98
    v_permlane16_swap_b32 v97, v99
    v_permlane16_swap_b32 v100, v102
    v_permlane16_swap_b32 v101, v103
    v_permlane16_swap_b32 v104, v106
    v_permlane16_swap_b32 v105, v107
    v_permlane16_swap_b32 v108, v110
    v_permlane16_swap_b32 v109, v111
    v_permlane16_swap_b32 v112, v114
    v_permlane16_swap_b32 v113, v115
    v_accvgpr_write_b32 a0, v88
    v_accvgpr_write_b32 a1, v89
    v_accvgpr_write_b32 a2, v90
    v_accvgpr_write_b32 a3, v91
    v_accvgpr_write_b32 a16, v92
    v_accvgpr_write_b32 a17, v93
    v_accvgpr_write_b32 a18, v94
    v_accvgpr_write_b32 a19, v95
    v_accvgpr_write_b32 a32, v96
    v_accvgpr_write_b32 a33, v97
    v_accvgpr_write_b32 a34, v98
    v_accvgpr_write_b32 a35, v99
    v_accvgpr_write_b32 a48, v100
    v_accvgpr_write_b32 a49, v101
    v_accvgpr_write_b32 a50, v102
    v_accvgpr_write_b32 a51, v103
    v_accvgpr_write_b32 a64, v104
    v_accvgpr_write_b32 a65, v105
    v_accvgpr_write_b32 a66, v106
    v_accvgpr_write_b32 a67, v107
    v_accvgpr_write_b32 a80, v108
    v_accvgpr_write_b32 a81, v109
    v_accvgpr_write_b32 a82, v110
    v_accvgpr_write_b32 a83, v111
    v_accvgpr_write_b32 a96, v112
    v_accvgpr_write_b32 a97, v113
    v_accvgpr_write_b32 a98, v114
    v_accvgpr_write_b32 a99, v115
    v_pk_mul_f32 v[200:201], v[200:201], v[4:5]
    v_pk_mul_f32 v[202:203], v[202:203], v[4:5]
    v_pk_mul_f32 v[204:205], v[204:205], v[4:5]
    v_pk_mul_f32 v[206:207], v[206:207], v[4:5]
    v_pk_mul_f32 v[208:209], v[208:209], v[4:5]
    v_pk_mul_f32 v[210:211], v[210:211], v[4:5]
    v_pk_mul_f32 v[212:213], v[212:213], v[4:5]
    v_pk_mul_f32 v[214:215], v[214:215], v[4:5]
    v_pk_mul_f32 v[216:217], v[216:217], v[4:5]
    v_pk_mul_f32 v[218:219], v[218:219], v[4:5]
    v_pk_mul_f32 v[220:221], v[220:221], v[4:5]
    v_pk_mul_f32 v[222:223], v[222:223], v[4:5]
    v_pk_mul_f32 v[224:225], v[224:225], v[4:5]
    v_pk_mul_f32 v[226:227], v[226:227], v[4:5]
    v_pk_mul_f32 v[228:229], v[228:229], v[4:5]
    v_pk_mul_f32 v[230:231], v[230:231], v[4:5]
    v_pk_mul_f32 v[232:233], v[232:233], v[4:5]
    v_pk_mul_f32 v[234:235], v[234:235], v[4:5]
    v_pk_mul_f32 v[236:237], v[236:237], v[4:5]
    v_pk_mul_f32 v[238:239], v[238:239], v[4:5]
    v_pk_mul_f32 v[240:241], v[240:241], v[4:5]
    v_pk_mul_f32 v[242:243], v[242:243], v[4:5]
    v_pk_mul_f32 v[244:245], v[244:245], v[4:5]
    v_pk_mul_f32 v[246:247], v[246:247], v[4:5]
    v_pk_mul_f32 v[248:249], v[248:249], v[4:5]
    v_pk_mul_f32 v[250:251], v[250:251], v[4:5]
    v_pk_mul_f32 v[252:253], v[252:253], v[4:5]
    v_pk_mul_f32 v[254:255], v[254:255], v[4:5]
    v_cvt_pk_bf16_f32 v116, v200, v201
    v_cvt_pk_bf16_f32 v117, v202, v203
    v_cvt_pk_bf16_f32 v118, v228, v229
    v_cvt_pk_bf16_f32 v119, v230, v231
    v_cvt_pk_bf16_f32 v120, v204, v205
    v_cvt_pk_bf16_f32 v121, v206, v207
    v_cvt_pk_bf16_f32 v122, v232, v233
    v_cvt_pk_bf16_f32 v123, v234, v235
    v_cvt_pk_bf16_f32 v124, v208, v209
    v_cvt_pk_bf16_f32 v125, v210, v211
    v_cvt_pk_bf16_f32 v126, v236, v237
    v_cvt_pk_bf16_f32 v127, v238, v239
    v_cvt_pk_bf16_f32 v128, v212, v213
    v_cvt_pk_bf16_f32 v129, v214, v215
    v_cvt_pk_bf16_f32 v130, v240, v241
    v_cvt_pk_bf16_f32 v131, v242, v243
    v_cvt_pk_bf16_f32 v132, v216, v217
    v_cvt_pk_bf16_f32 v133, v218, v219
    v_cvt_pk_bf16_f32 v134, v244, v245
    v_cvt_pk_bf16_f32 v135, v246, v247
    v_cvt_pk_bf16_f32 v136, v220, v221
    v_cvt_pk_bf16_f32 v137, v222, v223
    v_cvt_pk_bf16_f32 v138, v248, v249
    v_cvt_pk_bf16_f32 v139, v250, v251
    v_cvt_pk_bf16_f32 v140, v224, v225
    v_cvt_pk_bf16_f32 v141, v226, v227
    v_cvt_pk_bf16_f32 v142, v252, v253
    v_cvt_pk_bf16_f32 v143, v254, v255
    s_nop 1
    v_permlane16_swap_b32 v116, v118
    v_permlane16_swap_b32 v117, v119
    v_permlane16_swap_b32 v120, v122
    v_permlane16_swap_b32 v121, v123
    v_permlane16_swap_b32 v124, v126
    v_permlane16_swap_b32 v125, v127
    v_permlane16_swap_b32 v128, v130
    v_permlane16_swap_b32 v129, v131
    v_permlane16_swap_b32 v132, v134
    v_permlane16_swap_b32 v133, v135
    v_permlane16_swap_b32 v136, v138
    v_permlane16_swap_b32 v137, v139
    v_permlane16_swap_b32 v140, v142
    v_permlane16_swap_b32 v141, v143
    v_accvgpr_write_b32 a4, v116
    v_accvgpr_write_b32 a5, v117
    v_accvgpr_write_b32 a6, v118
    v_accvgpr_write_b32 a7, v119
    v_accvgpr_write_b32 a20, v120
    v_accvgpr_write_b32 a21, v121
    v_accvgpr_write_b32 a22, v122
    v_accvgpr_write_b32 a23, v123
    v_accvgpr_write_b32 a36, v124
    v_accvgpr_write_b32 a37, v125
    v_accvgpr_write_b32 a38, v126
    v_accvgpr_write_b32 a39, v127
    v_accvgpr_write_b32 a52, v128
    v_accvgpr_write_b32 a53, v129
    v_accvgpr_write_b32 a54, v130
    v_accvgpr_write_b32 a55, v131
    v_accvgpr_write_b32 a68, v132
    v_accvgpr_write_b32 a69, v133
    v_accvgpr_write_b32 a70, v134
    v_accvgpr_write_b32 a71, v135
    v_accvgpr_write_b32 a84, v136
    v_accvgpr_write_b32 a85, v137
    v_accvgpr_write_b32 a86, v138
    v_accvgpr_write_b32 a87, v139
    v_accvgpr_write_b32 a100, v140
    v_accvgpr_write_b32 a101, v141
    v_accvgpr_write_b32 a102, v142
    v_accvgpr_write_b32 a103, v143
    v_accvgpr_read_b32 v144, a112
    v_accvgpr_read_b32 v145, a113
    v_accvgpr_read_b32 v146, a114
    v_accvgpr_read_b32 v147, a115
    v_accvgpr_read_b32 v148, a116
    v_accvgpr_read_b32 v149, a117
    v_accvgpr_read_b32 v150, a118
    v_accvgpr_read_b32 v151, a119
    v_accvgpr_read_b32 v152, a120
    v_accvgpr_read_b32 v153, a121
    v_accvgpr_read_b32 v154, a122
    v_accvgpr_read_b32 v155, a123
    v_accvgpr_read_b32 v156, a124
    v_accvgpr_read_b32 v157, a125
    v_accvgpr_read_b32 v158, a126
    v_accvgpr_read_b32 v159, a127
    v_accvgpr_read_b32 v160, a128
    v_accvgpr_read_b32 v161, a129
    v_accvgpr_read_b32 v162, a130
    v_accvgpr_read_b32 v163, a131
    v_accvgpr_read_b32 v164, a132
    v_accvgpr_read_b32 v165, a133
    v_accvgpr_read_b32 v166, a134
    v_accvgpr_read_b32 v167, a135
    v_accvgpr_read_b32 v168, a136
    v_accvgpr_read_b32 v169, a137
    v_accvgpr_read_b32 v170, a138
    v_accvgpr_read_b32 v171, a139
    v_accvgpr_read_b32 v172, a140
    v_accvgpr_read_b32 v173, a141
    v_accvgpr_read_b32 v174, a142
    v_accvgpr_read_b32 v175, a143
    v_accvgpr_read_b32 v176, a144
    v_accvgpr_read_b32 v177, a145
    v_accvgpr_read_b32 v178, a146
    v_accvgpr_read_b32 v179, a147
    v_accvgpr_read_b32 v180, a148
    v_accvgpr_read_b32 v181, a149
    v_accvgpr_read_b32 v182, a150
    v_accvgpr_read_b32 v183, a151
    v_accvgpr_read_b32 v184, a152
    v_accvgpr_read_b32 v185, a153
    v_accvgpr_read_b32 v186, a154
    v_accvgpr_read_b32 v187, a155
    v_accvgpr_read_b32 v188, a156
    v_accvgpr_read_b32 v189, a157
    v_accvgpr_read_b32 v190, a158
    v_accvgpr_read_b32 v191, a159
    v_accvgpr_read_b32 v192, a160
    v_accvgpr_read_b32 v193, a161
    v_accvgpr_read_b32 v194, a162
    v_accvgpr_read_b32 v195, a163
    v_accvgpr_read_b32 v196, a164
    v_accvgpr_read_b32 v197, a165
    v_accvgpr_read_b32 v198, a166
    v_accvgpr_read_b32 v199, a167
    v_pk_mul_f32 v[144:145], v[144:145], v[4:5]
    v_pk_mul_f32 v[146:147], v[146:147], v[4:5]
    v_pk_mul_f32 v[148:149], v[148:149], v[4:5]
    v_pk_mul_f32 v[150:151], v[150:151], v[4:5]
    v_pk_mul_f32 v[152:153], v[152:153], v[4:5]
    v_pk_mul_f32 v[154:155], v[154:155], v[4:5]
    v_pk_mul_f32 v[156:157], v[156:157], v[4:5]
    v_pk_mul_f32 v[158:159], v[158:159], v[4:5]
    v_pk_mul_f32 v[160:161], v[160:161], v[4:5]
    v_pk_mul_f32 v[162:163], v[162:163], v[4:5]
    v_pk_mul_f32 v[164:165], v[164:165], v[4:5]
    v_pk_mul_f32 v[166:167], v[166:167], v[4:5]
    v_pk_mul_f32 v[168:169], v[168:169], v[4:5]
    v_pk_mul_f32 v[170:171], v[170:171], v[4:5]
    v_pk_mul_f32 v[172:173], v[172:173], v[4:5]
    v_pk_mul_f32 v[174:175], v[174:175], v[4:5]
    v_pk_mul_f32 v[176:177], v[176:177], v[4:5]
    v_pk_mul_f32 v[178:179], v[178:179], v[4:5]
    v_pk_mul_f32 v[180:181], v[180:181], v[4:5]
    v_pk_mul_f32 v[182:183], v[182:183], v[4:5]
    v_pk_mul_f32 v[184:185], v[184:185], v[4:5]
    v_pk_mul_f32 v[186:187], v[186:187], v[4:5]
    v_pk_mul_f32 v[188:189], v[188:189], v[4:5]
    v_pk_mul_f32 v[190:191], v[190:191], v[4:5]
    v_pk_mul_f32 v[192:193], v[192:193], v[4:5]
    v_pk_mul_f32 v[194:195], v[194:195], v[4:5]
    v_pk_mul_f32 v[196:197], v[196:197], v[4:5]
    v_pk_mul_f32 v[198:199], v[198:199], v[4:5]
    v_cvt_pk_bf16_f32 v88, v144, v145
    v_cvt_pk_bf16_f32 v89, v146, v147
    v_cvt_pk_bf16_f32 v90, v172, v173
    v_cvt_pk_bf16_f32 v91, v174, v175
    v_cvt_pk_bf16_f32 v92, v148, v149
    v_cvt_pk_bf16_f32 v93, v150, v151
    v_cvt_pk_bf16_f32 v94, v176, v177
    v_cvt_pk_bf16_f32 v95, v178, v179
    v_cvt_pk_bf16_f32 v96, v152, v153
    v_cvt_pk_bf16_f32 v97, v154, v155
    v_cvt_pk_bf16_f32 v98, v180, v181
    v_cvt_pk_bf16_f32 v99, v182, v183
    v_cvt_pk_bf16_f32 v100, v156, v157
    v_cvt_pk_bf16_f32 v101, v158, v159
    v_cvt_pk_bf16_f32 v102, v184, v185
    v_cvt_pk_bf16_f32 v103, v186, v187
    v_cvt_pk_bf16_f32 v104, v160, v161
    v_cvt_pk_bf16_f32 v105, v162, v163
    v_cvt_pk_bf16_f32 v106, v188, v189
    v_cvt_pk_bf16_f32 v107, v190, v191
    v_cvt_pk_bf16_f32 v108, v164, v165
    v_cvt_pk_bf16_f32 v109, v166, v167
    v_cvt_pk_bf16_f32 v110, v192, v193
    v_cvt_pk_bf16_f32 v111, v194, v195
    v_cvt_pk_bf16_f32 v112, v168, v169
    v_cvt_pk_bf16_f32 v113, v170, v171
    v_cvt_pk_bf16_f32 v114, v196, v197
    v_cvt_pk_bf16_f32 v115, v198, v199
    s_nop 1
    v_permlane16_swap_b32 v88, v90
    v_permlane16_swap_b32 v89, v91
    v_permlane16_swap_b32 v92, v94
    v_permlane16_swap_b32 v93, v95
    v_permlane16_swap_b32 v96, v98
    v_permlane16_swap_b32 v97, v99
    v_permlane16_swap_b32 v100, v102
    v_permlane16_swap_b32 v101, v103
    v_permlane16_swap_b32 v104, v106
    v_permlane16_swap_b32 v105, v107
    v_permlane16_swap_b32 v108, v110
    v_permlane16_swap_b32 v109, v111
    v_permlane16_swap_b32 v112, v114
    v_permlane16_swap_b32 v113, v115
    v_accvgpr_write_b32 a8, v88
    v_accvgpr_write_b32 a9, v89
    v_accvgpr_write_b32 a10, v90
    v_accvgpr_write_b32 a11, v91
    v_accvgpr_write_b32 a24, v92
    v_accvgpr_write_b32 a25, v93
    v_accvgpr_write_b32 a26, v94
    v_accvgpr_write_b32 a27, v95
    v_accvgpr_write_b32 a40, v96
    v_accvgpr_write_b32 a41, v97
    v_accvgpr_write_b32 a42, v98
    v_accvgpr_write_b32 a43, v99
    v_accvgpr_write_b32 a56, v100
    v_accvgpr_write_b32 a57, v101
    v_accvgpr_write_b32 a58, v102
    v_accvgpr_write_b32 a59, v103
    v_accvgpr_write_b32 a72, v104
    v_accvgpr_write_b32 a73, v105
    v_accvgpr_write_b32 a74, v106
    v_accvgpr_write_b32 a75, v107
    v_accvgpr_write_b32 a88, v108
    v_accvgpr_write_b32 a89, v109
    v_accvgpr_write_b32 a90, v110
    v_accvgpr_write_b32 a91, v111
    v_accvgpr_write_b32 a104, v112
    v_accvgpr_write_b32 a105, v113
    v_accvgpr_write_b32 a106, v114
    v_accvgpr_write_b32 a107, v115
    v_accvgpr_read_b32 v200, a168
    v_accvgpr_read_b32 v201, a169
    v_accvgpr_read_b32 v202, a170
    v_accvgpr_read_b32 v203, a171
    v_accvgpr_read_b32 v204, a172
    v_accvgpr_read_b32 v205, a173
    v_accvgpr_read_b32 v206, a174
    v_accvgpr_read_b32 v207, a175
    v_accvgpr_read_b32 v208, a176
    v_accvgpr_read_b32 v209, a177
    v_accvgpr_read_b32 v210, a178
    v_accvgpr_read_b32 v211, a179
    v_accvgpr_read_b32 v212, a180
    v_accvgpr_read_b32 v213, a181
    v_accvgpr_read_b32 v214, a182
    v_accvgpr_read_b32 v215, a183
    v_accvgpr_read_b32 v216, a184
    v_accvgpr_read_b32 v217, a185
    v_accvgpr_read_b32 v218, a186
    v_accvgpr_read_b32 v219, a187
    v_accvgpr_read_b32 v220, a188
    v_accvgpr_read_b32 v221, a189
    v_accvgpr_read_b32 v222, a190
    v_accvgpr_read_b32 v223, a191
    v_accvgpr_read_b32 v224, a192
    v_accvgpr_read_b32 v225, a193
    v_accvgpr_read_b32 v226, a194
    v_accvgpr_read_b32 v227, a195
    v_accvgpr_read_b32 v228, a196
    v_accvgpr_read_b32 v229, a197
    v_accvgpr_read_b32 v230, a198
    v_accvgpr_read_b32 v231, a199
    v_accvgpr_read_b32 v232, a200
    v_accvgpr_read_b32 v233, a201
    v_accvgpr_read_b32 v234, a202
    v_accvgpr_read_b32 v235, a203
    v_accvgpr_read_b32 v236, a204
    v_accvgpr_read_b32 v237, a205
    v_accvgpr_read_b32 v238, a206
    v_accvgpr_read_b32 v239, a207
    v_accvgpr_read_b32 v240, a208
    v_accvgpr_read_b32 v241, a209
    v_accvgpr_read_b32 v242, a210
    v_accvgpr_read_b32 v243, a211
    v_accvgpr_read_b32 v244, a212
    v_accvgpr_read_b32 v245, a213
    v_accvgpr_read_b32 v246, a214
    v_accvgpr_read_b32 v247, a215
    v_accvgpr_read_b32 v248, a216
    v_accvgpr_read_b32 v249, a217
    v_accvgpr_read_b32 v250, a218
    v_accvgpr_read_b32 v251, a219
    v_accvgpr_read_b32 v252, a220
    v_accvgpr_read_b32 v253, a221
    v_accvgpr_read_b32 v254, a222
    v_accvgpr_read_b32 v255, a223
    v_pk_mul_f32 v[200:201], v[200:201], v[4:5]
    v_pk_mul_f32 v[202:203], v[202:203], v[4:5]
    v_pk_mul_f32 v[204:205], v[204:205], v[4:5]
    v_pk_mul_f32 v[206:207], v[206:207], v[4:5]
    v_pk_mul_f32 v[208:209], v[208:209], v[4:5]
    v_pk_mul_f32 v[210:211], v[210:211], v[4:5]
    v_pk_mul_f32 v[212:213], v[212:213], v[4:5]
    v_pk_mul_f32 v[214:215], v[214:215], v[4:5]
    v_pk_mul_f32 v[216:217], v[216:217], v[4:5]
    v_pk_mul_f32 v[218:219], v[218:219], v[4:5]
    v_pk_mul_f32 v[220:221], v[220:221], v[4:5]
    v_pk_mul_f32 v[222:223], v[222:223], v[4:5]
    v_pk_mul_f32 v[224:225], v[224:225], v[4:5]
    v_pk_mul_f32 v[226:227], v[226:227], v[4:5]
    v_pk_mul_f32 v[228:229], v[228:229], v[4:5]
    v_pk_mul_f32 v[230:231], v[230:231], v[4:5]
    v_pk_mul_f32 v[232:233], v[232:233], v[4:5]
    v_pk_mul_f32 v[234:235], v[234:235], v[4:5]
    v_pk_mul_f32 v[236:237], v[236:237], v[4:5]
    v_pk_mul_f32 v[238:239], v[238:239], v[4:5]
    v_pk_mul_f32 v[240:241], v[240:241], v[4:5]
    v_pk_mul_f32 v[242:243], v[242:243], v[4:5]
    v_pk_mul_f32 v[244:245], v[244:245], v[4:5]
    v_pk_mul_f32 v[246:247], v[246:247], v[4:5]
    v_pk_mul_f32 v[248:249], v[248:249], v[4:5]
    v_pk_mul_f32 v[250:251], v[250:251], v[4:5]
    v_pk_mul_f32 v[252:253], v[252:253], v[4:5]
    v_pk_mul_f32 v[254:255], v[254:255], v[4:5]
    v_cvt_pk_bf16_f32 v116, v200, v201
    v_cvt_pk_bf16_f32 v117, v202, v203
    v_cvt_pk_bf16_f32 v118, v228, v229
    v_cvt_pk_bf16_f32 v119, v230, v231
    v_cvt_pk_bf16_f32 v120, v204, v205
    v_cvt_pk_bf16_f32 v121, v206, v207
    v_cvt_pk_bf16_f32 v122, v232, v233
    v_cvt_pk_bf16_f32 v123, v234, v235
    v_cvt_pk_bf16_f32 v124, v208, v209
    v_cvt_pk_bf16_f32 v125, v210, v211
    v_cvt_pk_bf16_f32 v126, v236, v237
    v_cvt_pk_bf16_f32 v127, v238, v239
    v_cvt_pk_bf16_f32 v128, v212, v213
    v_cvt_pk_bf16_f32 v129, v214, v215
    v_cvt_pk_bf16_f32 v130, v240, v241
    v_cvt_pk_bf16_f32 v131, v242, v243
    v_cvt_pk_bf16_f32 v132, v216, v217
    v_cvt_pk_bf16_f32 v133, v218, v219
    v_cvt_pk_bf16_f32 v134, v244, v245
    v_cvt_pk_bf16_f32 v135, v246, v247
    v_cvt_pk_bf16_f32 v136, v220, v221
    v_cvt_pk_bf16_f32 v137, v222, v223
    v_cvt_pk_bf16_f32 v138, v248, v249
    v_cvt_pk_bf16_f32 v139, v250, v251
    v_cvt_pk_bf16_f32 v140, v224, v225
    v_cvt_pk_bf16_f32 v141, v226, v227
    v_cvt_pk_bf16_f32 v142, v252, v253
    v_cvt_pk_bf16_f32 v143, v254, v255
    s_nop 1
    v_permlane16_swap_b32 v116, v118
    v_permlane16_swap_b32 v117, v119
    v_permlane16_swap_b32 v120, v122
    v_permlane16_swap_b32 v121, v123
    v_permlane16_swap_b32 v124, v126
    v_permlane16_swap_b32 v125, v127
    v_permlane16_swap_b32 v128, v130
    v_permlane16_swap_b32 v129, v131
    v_permlane16_swap_b32 v132, v134
    v_permlane16_swap_b32 v133, v135
    v_permlane16_swap_b32 v136, v138
    v_permlane16_swap_b32 v137, v139
    v_permlane16_swap_b32 v140, v142
    v_permlane16_swap_b32 v141, v143
    v_accvgpr_write_b32 a12, v116
    v_accvgpr_write_b32 a13, v117
    v_accvgpr_write_b32 a14, v118
    v_accvgpr_write_b32 a15, v119
    v_accvgpr_write_b32 a28, v120
    v_accvgpr_write_b32 a29, v121
    v_accvgpr_write_b32 a30, v122
    v_accvgpr_write_b32 a31, v123
    v_accvgpr_write_b32 a44, v124
    v_accvgpr_write_b32 a45, v125
    v_accvgpr_write_b32 a46, v126
    v_accvgpr_write_b32 a47, v127
    v_accvgpr_write_b32 a60, v128
    v_accvgpr_write_b32 a61, v129
    v_accvgpr_write_b32 a62, v130
    v_accvgpr_write_b32 a63, v131
    v_accvgpr_write_b32 a76, v132
    v_accvgpr_write_b32 a77, v133
    v_accvgpr_write_b32 a78, v134
    v_accvgpr_write_b32 a79, v135
    v_accvgpr_write_b32 a92, v136
    v_accvgpr_write_b32 a93, v137
    v_accvgpr_write_b32 a94, v138
    v_accvgpr_write_b32 a95, v139
    v_accvgpr_write_b32 a108, v140
    v_accvgpr_write_b32 a109, v141
    v_accvgpr_write_b32 a110, v142
    v_accvgpr_write_b32 a111, v143
    s_cmp_eq_u32 s70, 0
    s_cbranch_scc1 L_at_nostash
    s_mov_b32 s70, 0
    s_lshl_b32 s30, s2, 2
    s_add_u32 s30, s30, s20
    s_mul_i32 s30, s30, 28672
    v_lshlrev_b32 v4, 4, v1
    buffer_store_dwordx4 a[0:3], v4, s[12:15], s30 offen offset:0
    buffer_store_dwordx4 a[4:7], v4, s[12:15], s30 offen offset:1024
    buffer_store_dwordx4 a[8:11], v4, s[12:15], s30 offen offset:2048
    buffer_store_dwordx4 a[12:15], v4, s[12:15], s30 offen offset:3072
    s_add_u32 s30, s30, 4096
    buffer_store_dwordx4 a[16:19], v4, s[12:15], s30 offen offset:0
    buffer_store_dwordx4 a[20:23], v4, s[12:15], s30 offen offset:1024
    buffer_store_dwordx4 a[24:27], v4, s[12:15], s30 offen offset:2048
    buffer_store_dwordx4 a[28:31], v4, s[12:15], s30 offen offset:3072
    s_add_u32 s30, s30, 4096
    buffer_store_dwordx4 a[32:35], v4, s[12:15], s30 offen offset:0
    buffer_store_dwordx4 a[36:39], v4, s[12:15], s30 offen offset:1024
    buffer_store_dwordx4 a[40:43], v4, s[12:15], s30 offen offset:2048
    buffer_store_dwordx4 a[44:47], v4, s[12:15], s30 offen offset:3072
    s_add_u32 s30, s30, 4096
    buffer_store_dwordx4 a[48:51], v4, s[12:15], s30 offen offset:0
    buffer_store_dwordx4 a[52:55], v4, s[12:15], s30 offen offset:1024
    buffer_store_dwordx4 a[56:59], v4, s[12:15], s30 offen offset:2048
    buffer_store_dwordx4 a[60:63], v4, s[12:15], s30 offen offset:3072
    s_add_u32 s30, s30, 4096
    buffer_store_dwordx4 a[64:67], v4, s[12:15], s30 offen offset:0
    buffer_store_dwordx4 a[68:71], v4, s[12:15], s30 offen offset:1024
    buffer_store_dwordx4 a[72:75], v4, s[12:15], s30 offen offset:2048
    buffer_store_dwordx4 a[76:79], v4, s[12:15], s30 offen offset:3072
    s_add_u32 s30, s30, 4096
    buffer_store_dwordx4 a[80:83], v4, s[12:15], s30 offen offset:0
    buffer_store_dwordx4 a[84:87], v4, s[12:15], s30 offen offset:1024
    buffer_store_dwordx4 a[88:91], v4, s[12:15], s30 offen offset:2048
    buffer_store_dwordx4 a[92:95], v4, s[12:15], s30 offen offset:3072
    s_add_u32 s30, s30, 4096
    buffer_store_dwordx4 a[96:99], v4, s[12:15], s30 offen offset:0
    buffer_store_dwordx4 a[100:103], v4, s[12:15], s30 offen offset:1024
    buffer_store_dwordx4 a[104:107], v4, s[12:15], s30 offen offset:2048
    buffer_store_dwordx4 a[108:111], v4, s[12:15], s30 offen offset:3072
    s_mov_b32 s68, 3
    s_branch L_at_round
L_at_nostash:
    s_cmp_lg_u32 s25, 0
    s_cbranch_scc1 L_at_maxpass
L_at_pre:
L_at_nowo1:
    s_waitcnt lgkmcnt(0)
    v_mfma_f32_16x16x32_bf16 v[88:91], v[56:59], a[0:3], 0
    v_mov_b32 v168, 0
    v_mov_b32 v169, 0
    v_mfma_f32_16x16x32_bf16 v[88:91], v[60:63], a[4:7], v[88:91]
    v_mov_b32 v170, 0
    v_mov_b32 v171, 0
    v_mfma_f32_16x16x32_bf16 v[88:91], v[64:67], a[8:11], v[88:91]
    v_mov_b32 v196, 0
    v_mov_b32 v197, 0
    v_mfma_f32_16x16x32_bf16 v[88:91], v[68:71], a[12:15], v[88:91]
    v_mov_b32 v198, 0
    v_mov_b32 v199, 0
    v_mfma_f32_16x16x32_bf16 v[92:95], v[84:87], a[12:15], 0
    v_mov_b32 v224, 0
    v_mov_b32 v225, 0
    v_mfma_f32_16x16x32_bf16 v[92:95], v[80:83], a[8:11], v[92:95]
    v_mov_b32 v226, 0
    v_mov_b32 v227, 0
    v_mfma_f32_16x16x32_bf16 v[92:95], v[76:79], a[4:7], v[92:95]
    v_mov_b32 v252, 0
    v_mov_b32 v253, 0
    v_mfma_f32_16x16x32_bf16 v[92:95], v[72:75], a[0:3], v[92:95]
    v_mov_b32 v254, 0
    v_mov_b32 v255, 0
    v_accvgpr_write_b32 a136, 0
    v_accvgpr_write_b32 a137, 0
    v_accvgpr_write_b32 a138, 0
    v_accvgpr_write_b32 a139, 0
    v_accvgpr_write_b32 a164, 0
    v_accvgpr_write_b32 a165, 0
    v_accvgpr_write_b32 a166, 0
    v_accvgpr_write_b32 a167, 0
    v_accvgpr_write_b32 a192, 0
    v_accvgpr_write_b32 a193, 0
    v_accvgpr_write_b32 a194, 0
    v_accvgpr_write_b32 a195, 0
    v_accvgpr_write_b32 a220, 0
    v_accvgpr_write_b32 a221, 0
    v_accvgpr_write_b32 a222, 0
    v_accvgpr_write_b32 a223, 0
    v_mfma_f32_16x16x32_bf16 v[96:99], v[56:59], a[16:19], 0
    v_max3_f32 v2, v88, v89, v12
    v_max3_f32 v3, v90, v91, v92
    v_max3_f32 v2, v93, v94, v2
    v_mfma_f32_16x16x32_bf16 v[96:99], v[60:63], a[20:23], v[96:99]
    v_max3_f32 v2, v95, v2, v3
    v_mov_b32 v3, v2
    s_nop 1
    v_permlane16_swap_b32 v2, v3
    v_mfma_f32_16x16x32_bf16 v[96:99], v[64:67], a[24:27], v[96:99]
    s_nop 1
    v_max_f32 v2, v2, v3
    v_mov_b32 v3, v2
    v_mfma_f32_16x16x32_bf16 v[96:99], v[68:71], a[28:31], v[96:99]
    s_nop 1
    v_permlane32_swap_b32 v2, v3
    s_nop 1
    v_max_f32 v2, v2, v3
    v_mfma_f32_16x16x32_bf16 v[100:103], v[84:87], a[28:31], 0
    v_mov_b32 v12, 0
    v_mov_b32 v13, 0
    v_sub_f32 v88, v88, v2
    v_mfma_f32_16x16x32_bf16 v[100:103], v[80:83], a[24:27], v[100:103]
    v_sub_f32 v89, v89, v2
    v_sub_f32 v90, v90, v2
    v_sub_f32 v91, v91, v2
    v_sub_f32 v92, v92, v2
    v_mfma_f32_16x16x32_bf16 v[100:103], v[76:79], a[20:23], v[100:103]
    v_sub_f32 v93, v93, v2
    v_sub_f32 v94, v94, v2
    v_sub_f32 v95, v95, v2
    v_mfma_f32_16x16x32_bf16 v[100:103], v[72:75], a[16:19], v[100:103]
    v_sub_f32 v28, 0, v2
    v_sub_f32 v29, 0, v2
    v_sub_f32 v30, 0, v2
    v_sub_f32 v31, 0, v2
    ds_read_b64_tr_b16 v[112:113], v9 offset:0
    ds_read_b64_tr_b16 v[114:115], v9 offset:512
    v_exp_f32 v88, v88
    ds_read_b64_tr_b16 v[116:117], v9 offset:32
    ds_read_b64_tr_b16 v[118:119], v9 offset:544
    v_exp_f32 v89, v89
    v_exp_f32 v90, v90
    ds_read_b64_tr_b16 v[120:121], v9 offset:64
    ds_read_b64_tr_b16 v[122:123], v9 offset:576
    v_exp_f32 v91, v91
    v_add_f32 v12, v12, v88
    v_add_f32 v13, v13, v89
    ds_read_b64_tr_b16 v[124:125], v9 offset:96
    ds_read_b64_tr_b16 v[126:127], v9 offset:608
    v_cvt_pk_bf16_f32 v104, v88, v89
    v_exp_f32 v92, v92
    ds_read_b64_tr_b16 v[128:129], v9 offset:128
    ds_read_b64_tr_b16 v[130:131], v9 offset:640
    v_exp_f32 v93, v93
    v_add_f32 v12, v12, v90
    v_add_f32 v13, v13, v91
    ds_read_b64_tr_b16 v[132:133], v9 offset:160
    ds_read_b64_tr_b16 v[134:135], v9 offset:672
    v_cvt_pk_bf16_f32 v105, v90, v91
    v_exp_f32 v94, v94
    ds_read_b64_tr_b16 v[136:137], v9 offset:192
    ds_read_b64_tr_b16 v[138:139], v9 offset:704
    v_exp_f32 v95, v95
    v_add_f32 v12, v12, v92
    v_add_f32 v13, v13, v93
    ds_read_b64_tr_b16 v[140:141], v9 offset:224
    ds_read_b64_tr_b16 v[142:143], v9 offset:736
    v_cvt_pk_bf16_f32 v106, v92, v93
    v_add_f32 v12, v12, v94
    v_add_f32 v13, v13, v95
    v_cvt_pk_bf16_f32 v107, v94, v95
    v_mfma_f32_16x16x32_bf16 v[88:91], v[56:59], a[32:35], 0
    v_max3_f32 v2, v96, v97, v14
    v_max3_f32 v3, v98, v99, v100
    v_max3_f32 v2, v101, v102, v2
    v_mfma_f32_16x16x32_bf16 v[88:91], v[60:63], a[36:39], v[88:91]
    v_max3_f32 v2, v103, v2, v3
    v_mov_b32 v3, v2
    s_nop 1
    v_permlane16_swap_b32 v2, v3
    v_mfma_f32_16x16x32_bf16 v[88:91], v[64:67], a[40:43], v[88:91]
    s_nop 1
    v_max_f32 v2, v2, v3
    v_mov_b32 v3, v2
    v_mfma_f32_16x16x32_bf16 v[88:91], v[68:71], a[44:47], v[88:91]
    s_nop 1
    v_permlane32_swap_b32 v2, v3
    s_nop 1
    v_max_f32 v2, v2, v3
    v_mfma_f32_16x16x32_bf16 v[92:95], v[84:87], a[44:47], 0
    v_mov_b32 v14, 0
    v_mov_b32 v15, 0
    v_sub_f32 v96, v96, v2
    v_mfma_f32_16x16x32_bf16 v[92:95], v[80:83], a[40:43], v[92:95]
    v_sub_f32 v97, v97, v2
    v_sub_f32 v98, v98, v2
    v_sub_f32 v99, v99, v2
    v_sub_f32 v100, v100, v2
    v_mfma_f32_16x16x32_bf16 v[92:95], v[76:79], a[36:39], v[92:95]
    v_sub_f32 v101, v101, v2
    v_sub_f32 v102, v102, v2
    v_sub_f32 v103, v103, v2
    v_mfma_f32_16x16x32_bf16 v[92:95], v[72:75], a[32:35], v[92:95]
    v_sub_f32 v32, 0, v2
    v_sub_f32 v33, 0, v2
    v_sub_f32 v34, 0, v2
    v_sub_f32 v35, 0, v2
    s_waitcnt lgkmcnt(0)
    v_mfma_f32_16x16x32_bf16 v[144:147], v[112:115], v[104:107], 0
    v_exp_f32 v96, v96
    v_mfma_f32_16x16x32_bf16 v[172:175], v[116:119], v[104:107], 0
    v_exp_f32 v97, v97
    v_exp_f32 v98, v98
    v_mfma_f32_16x16x32_bf16 v[200:203], v[120:123], v[104:107], 0
    v_exp_f32 v99, v99
    v_add_f32 v14, v14, v96
    v_add_f32 v15, v15, v97
    v_mfma_f32_16x16x32_bf16 v[228:231], v[124:127], v[104:107], 0
    v_cvt_pk_bf16_f32 v108, v96, v97
    v_exp_f32 v100, v100
    v_mfma_f32_16x16x32_bf16 a[112:115], v[128:131], v[104:107], 0
    v_exp_f32 v101, v101
    v_add_f32 v14, v14, v98
    v_add_f32 v15, v15, v99
    v_mfma_f32_16x16x32_bf16 a[140:143], v[132:135], v[104:107], 0
    v_cvt_pk_bf16_f32 v109, v98, v99
    v_exp_f32 v102, v102
    v_mfma_f32_16x16x32_bf16 a[168:171], v[136:139], v[104:107], 0
    v_exp_f32 v103, v103
    v_add_f32 v14, v14, v100
    v_add_f32 v15, v15, v101
    v_mfma_f32_16x16x32_bf16 a[196:199], v[140:143], v[104:107], 0
    v_cvt_pk_bf16_f32 v110, v100, v101
    v_add_f32 v14, v14, v102
    v_add_f32 v15, v15, v103
    v_cvt_pk_bf16_f32 v111, v102, v103
    v_mfma_f32_16x16x32_bf16 v[96:99], v[56:59], a[48:51], 0
    v_max3_f32 v2, v88, v89, v16
    v_max3_f32 v3, v90, v91, v92
    v_max3_f32 v2, v93, v94, v2
    v_mfma_f32_16x16x32_bf16 v[96:99], v[60:63], a[52:55], v[96:99]
    v_max3_f32 v2, v95, v2, v3
    v_mov_b32 v3, v2
    s_nop 1
    v_permlane16_swap_b32 v2, v3
    v_mfma_f32_16x16x32_bf16 v[96:99], v[64:67], a[56:59], v[96:99]
    s_nop 1
    v_max_f32 v2, v2, v3
    v_mov_b32 v3, v2
    v_mfma_f32_16x16x32_bf16 v[96:99], v[68:71], a[60:63], v[96:99]
    s_nop 1
    v_permlane32_swap_b32 v2, v3
    s_nop 1
    v_max_f32 v2, v2, v3
    v_mfma_f32_16x16x32_bf16 v[100:103], v[84:87], a[60:63], 0
    v_mov_b32 v16, 0
    v_mov_b32 v17, 0
    v_sub_f32 v88, v88, v2
    v_mfma_f32_16x16x32_bf16 v[100:103], v[80:83], a[56:59], v[100:103]
    v_sub_f32 v89, v89, v2
    v_sub_f32 v90, v90, v2
    v_sub_f32 v91, v91, v2
    v_sub_f32 v92, v92, v2
    v_mfma_f32_16x16x32_bf16 v[100:103], v[76:79], a[52:55], v[100:103]
    v_sub_f32 v93, v93, v2
    v_sub_f32 v94, v94, v2
    v_sub_f32 v95, v95, v2
    v_mfma_f32_16x16x32_bf16 v[100:103], v[72:75], a[48:51], v[100:103]
    v_sub_f32 v36, 0, v2
    v_sub_f32 v37, 0, v2
    v_sub_f32 v38, 0, v2
    v_sub_f32 v39, 0, v2
    v_mfma_f32_16x16x32_bf16 v[148:151], v[112:115], v[108:111], 0
    v_exp_f32 v88, v88
    v_mfma_f32_16x16x32_bf16 v[176:179], v[116:119], v[108:111], 0
    v_exp_f32 v89, v89
    v_exp_f32 v90, v90
    v_mfma_f32_16x16x32_bf16 v[204:207], v[120:123], v[108:111], 0
    v_exp_f32 v91, v91
    v_add_f32 v16, v16, v88
    v_add_f32 v17, v17, v89
    v_mfma_f32_16x16x32_bf16 v[232:235], v[124:127], v[108:111], 0
    v_cvt_pk_bf16_f32 v104, v88, v89
    v_exp_f32 v92, v92
    v_mfma_f32_16x16x32_bf16 a[116:119], v[128:131], v[108:111], 0
    v_exp_f32 v93, v93
    v_add_f32 v16, v16, v90
    v_add_f32 v17, v17, v91
    v_mfma_f32_16x16x32_bf16 a[144:147], v[132:135], v[108:111], 0
    v_cvt_pk_bf16_f32 v105, v90, v91
    v_exp_f32 v94, v94
    v_mfma_f32_16x16x32_bf16 a[172:175], v[136:139], v[108:111], 0
    v_exp_f32 v95, v95
    v_add_f32 v16, v16, v92
    v_add_f32 v17, v17, v93
    v_mfma_f32_16x16x32_bf16 a[200:203], v[140:143], v[108:111], 0
    v_cvt_pk_bf16_f32 v106, v92, v93
    v_add_f32 v16, v16, v94
    v_add_f32 v17, v17, v95
    v_cvt_pk_bf16_f32 v107, v94, v95
    v_mfma_f32_16x16x32_bf16 v[88:91], v[56:59], a[64:67], 0
    v_max3_f32 v2, v96, v97, v18
    v_max3_f32 v3, v98, v99, v100
    v_max3_f32 v2, v101, v102, v2
    v_mfma_f32_16x16x32_bf16 v[88:91], v[60:63], a[68:71], v[88:91]
    v_max3_f32 v2, v103, v2, v3
    v_mov_b32 v3, v2
    s_nop 1
    v_permlane16_swap_b32 v2, v3
    v_mfma_f32_16x16x32_bf16 v[88:91], v[64:67], a[72:75], v[88:91]
    s_nop 1
    v_max_f32 v2, v2, v3
    v_mov_b32 v3, v2
    v_mfma_f32_16x16x32_bf16 v[88:91], v[68:71], a[76:79], v[88:91]
    s_nop 1
    v_permlane32_swap_b32 v2, v3
    s_nop 1
    v_max_f32 v2, v2, v3
    v_mfma_f32_16x16x32_bf16 v[92:95], v[84:87], a[76:79], 0
    v_mov_b32 v18, 0
    v_mov_b32 v19, 0
    v_sub_f32 v96, v96, v2
    v_mfma_f32_16x16x32_bf16 v[92:95], v[80:83], a[72:75], v[92:95]
    v_sub_f32 v97, v97, v2
    v_sub_f32 v98, v98, v2
    v_sub_f32 v99, v99, v2
    v_sub_f32 v100, v100, v2
    v_mfma_f32_16x16x32_bf16 v[92:95], v[76:79], a[68:71], v[92:95]
    v_sub_f32 v101, v101, v2
    v_sub_f32 v102, v102, v2
    v_sub_f32 v103, v103, v2
    v_mfma_f32_16x16x32_bf16 v[92:95], v[72:75], a[64:67], v[92:95]
    v_sub_f32 v40, 0, v2
    v_sub_f32 v41, 0, v2
    v_sub_f32 v42, 0, v2
    v_sub_f32 v43, 0, v2
    v_mfma_f32_16x16x32_bf16 v[152:155], v[112:115], v[104:107], 0
    v_exp_f32 v96, v96
    v_mfma_f32_16x16x32_bf16 v[180:183], v[116:119], v[104:107], 0
    v_exp_f32 v97, v97
    v_exp_f32 v98, v98
    v_mfma_f32_16x16x32_bf16 v[208:211], v[120:123], v[104:107], 0
    v_exp_f32 v99, v99
    v_add_f32 v18, v18, v96
    v_add_f32 v19, v19, v97
    v_mfma_f32_16x16x32_bf16 v[236:239], v[124:127], v[104:107], 0
    v_cvt_pk_bf16_f32 v108, v96, v97
    v_exp_f32 v100, v100
    v_mfma_f32_16x16x32_bf16 a[120:123], v[128:131], v[104:107], 0
    v_exp_f32 v101, v101
    v_add_f32 v18, v18, v98
    v_add_f32 v19, v19, v99
    v_mfma_f32_16x16x32_bf16 a[148:151], v[132:135], v[104:107], 0
    v_cvt_pk_bf16_f32 v109, v98, v99
    v_exp_f32 v102, v102
    v_mfma_f32_16x16x32_bf16 a[176:179], v[136:139], v[104:107], 0
    v_exp_f32 v103, v103
    v_add_f32 v18, v18, v100
    v_add_f32 v19, v19, v101
    v_mfma_f32_16x16x32_bf16 a[204:207], v[140:143], v[104:107], 0
    v_cvt_pk_bf16_f32 v110, v100, v101
    v_add_f32 v18, v18, v102
    v_add_f32 v19, v19, v103
    v_cvt_pk_bf16_f32 v111, v102, v103
    v_mfma_f32_16x16x32_bf16 v[96:99], v[56:59], a[80:83], 0
    v_max3_f32 v2, v88, v89, v20
    v_max3_f32 v3, v90, v91, v92
    v_max3_f32 v2, v93, v94, v2
    v_mfma_f32_16x16x32_bf16 v[96:99], v[60:63], a[84:87], v[96:99]
    v_max3_f32 v2, v95, v2, v3
    v_mov_b32 v3, v2
    s_nop 1
    v_permlane16_swap_b32 v2, v3
    v_mfma_f32_16x16x32_bf16 v[96:99], v[64:67], a[88:91], v[96:99]
    s_nop 1
    v_max_f32 v2, v2, v3
    v_mov_b32 v3, v2
    v_mfma_f32_16x16x32_bf16 v[96:99], v[68:71], a[92:95], v[96:99]
    s_nop 1
    v_permlane32_swap_b32 v2, v3
    s_nop 1
    v_max_f32 v2, v2, v3
    v_mfma_f32_16x16x32_bf16 v[100:103], v[84:87], a[92:95], 0
    v_mov_b32 v20, 0
    v_mov_b32 v21, 0
    v_sub_f32 v88, v88, v2
    v_mfma_f32_16x16x32_bf16 v[100:103], v[80:83], a[88:91], v[100:103]
    v_sub_f32 v89, v89, v2
    v_sub_f32 v90, v90, v2
    v_sub_f32 v91, v91, v2
    v_sub_f32 v92, v92, v2
    v_mfma_f32_16x16x32_bf16 v[100:103], v[76:79], a[84:87], v[100:103]
    v_sub_f32 v93, v93, v2
    v_sub_f32 v94, v94, v2
    v_sub_f32 v95, v95, v2
    v_mfma_f32_16x16x32_bf16 v[100:103], v[72:75], a[80:83], v[100:103]
    v_sub_f32 v44, 0, v2
    v_sub_f32 v45, 0, v2
    v_sub_f32 v46, 0, v2
    v_sub_f32 v47, 0, v2
    v_mfma_f32_16x16x32_bf16 v[156:159], v[112:115], v[108:111], 0
    v_exp_f32 v88, v88
    v_mfma_f32_16x16x32_bf16 v[184:187], v[116:119], v[108:111], 0
    v_exp_f32 v89, v89
    v_exp_f32 v90, v90
    v_mfma_f32_16x16x32_bf16 v[212:215], v[120:123], v[108:111], 0
    v_exp_f32 v91, v91
    v_add_f32 v20, v20, v88
    v_add_f32 v21, v21, v89
    v_mfma_f32_16x16x32_bf16 v[240:243], v[124:127], v[108:111], 0
    v_cvt_pk_bf16_f32 v104, v88, v89
    v_exp_f32 v92, v92
    v_mfma_f32_16x16x32_bf16 a[124:127], v[128:131], v[108:111], 0
    v_exp_f32 v93, v93
    v_add_f32 v20, v20, v90
    v_add_f32 v21, v21, v91
    v_mfma_f32_16x16x32_bf16 a[152:155], v[132:135], v[108:111], 0
    v_cvt_pk_bf16_f32 v105, v90, v91
    v_exp_f32 v94, v94
    v_mfma_f32_16x16x32_bf16 a[180:183], v[136:139], v[108:111], 0
    v_exp_f32 v95, v95
    v_add_f32 v20, v20, v92
    v_add_f32 v21, v21, v93
    v_mfma_f32_16x16x32_bf16 a[208:211], v[140:143], v[108:111], 0
    v_cvt_pk_bf16_f32 v106, v92, v93
    v_add_f32 v20, v20, v94
    v_add_f32 v21, v21, v95
    v_cvt_pk_bf16_f32 v107, v94, v95
    s_cmp_eq_u32 s68, 0
    s_cbranch_scc0 L_bw1_3109
    s_waitcnt vmcnt(16) lgkmcnt(0)
L_bw2_3109:
    s_barrier
    s_cmp_le_u32 s21, s27
    s_cbranch_scc1 L_at_nofb_3114
    s_sub_u32 s28, s21, 1
    s_cmp_eq_u32 s28, s23
    s_cbranch_scc1 L_at_nofb_3114
    s_lshl_b32 s29, s28, 2
    s_add_u32 s29, s29, 76000
    v_mov_b32 v4, s29
    ds_read_b32 v4, v4
    s_waitcnt lgkmcnt(0)
    v_readfirstlane_b32 s29, v4
    s_nop 3
    s_cmp_lg_u32 s29, 0
    s_cbranch_scc1 L_at_fallback
L_at_nofb_3114:
    v_mfma_f32_16x16x32_bf16 v[88:91], v[56:59], a[96:99], 0
    ds_read_b128 v[56:59], v8 offset:8448
    v_max3_f32 v2, v96, v97, v22
    v_max3_f32 v3, v98, v99, v100
    v_max3_f32 v2, v101, v102, v2
    v_mfma_f32_16x16x32_bf16 v[88:91], v[60:63], a[100:103], v[88:91]
    ds_read_b128 v[60:63], v8 offset:8512
    v_max3_f32 v2, v103, v2, v3
    v_mov_b32 v3, v2
    s_nop 1
    v_permlane16_swap_b32 v2, v3
    v_mfma_f32_16x16x32_bf16 v[88:91], v[64:67], a[104:107], v[88:91]
    ds_read_b128 v[64:67], v8 offset:8576
    s_nop 1
    v_max_f32 v2, v2, v3
    v_mov_b32 v3, v2
    v_mfma_f32_16x16x32_bf16 v[88:91], v[68:71], a[108:111], v[88:91]
    ds_read_b128 v[68:71], v8 offset:8640
    s_nop 1
    v_permlane32_swap_b32 v2, v3
    s_nop 1
    v_max_f32 v2, v2, v3
    v_mfma_f32_16x16x32_bf16 v[92:95], v[84:87], a[108:111], 0
    ds_read_b128 v[84:87], v8 offset:9152
    v_mov_b32 v22, 0
    v_mov_b32 v23, 0
    v_sub_f32 v96, v96, v2
    v_mfma_f32_16x16x32_bf16 v[92:95], v[80:83], a[104:107], v[92:95]
    ds_read_b128 v[80:83], v8 offset:9088
    v_sub_f32 v97, v97, v2
    v_sub_f32 v98, v98, v2
    v_sub_f32 v99, v99, v2
    v_sub_f32 v100, v100, v2
    v_mfma_f32_16x16x32_bf16 v[92:95], v[76:79], a[100:103], v[92:95]
    ds_read_b128 v[76:79], v8 offset:9024
    v_sub_f32 v101, v101, v2
    v_sub_f32 v102, v102, v2
    v_sub_f32 v103, v103, v2
    v_mfma_f32_16x16x32_bf16 v[92:95], v[72:75], a[96:99], v[92:95]
    ds_read_b128 v[72:75], v8 offset:8960
    v_sub_f32 v48, 0, v2
    v_sub_f32 v49, 0, v2
    v_sub_f32 v50, 0, v2
    v_sub_f32 v51, 0, v2
    v_mfma_f32_16x16x32_bf16 v[160:163], v[112:115], v[104:107], 0
    v_exp_f32 v96, v96
    v_mfma_f32_16x16x32_bf16 v[188:191], v[116:119], v[104:107], 0
    v_exp_f32 v97, v97
    v_exp_f32 v98, v98
    v_mfma_f32_16x16x32_bf16 v[216:219], v[120:123], v[104:107], 0
    v_exp_f32 v99, v99
    v_add_f32 v22, v22, v96
    v_add_f32 v23, v23, v97
    v_mfma_f32_16x16x32_bf16 v[244:247], v[124:127], v[104:107], 0
    v_cvt_pk_bf16_f32 v108, v96, v97
    v_exp_f32 v100, v100
    v_mfma_f32_16x16x32_bf16 a[128:131], v[128:131], v[104:107], 0
    v_exp_f32 v101, v101
    v_add_f32 v22, v22, v98
    v_add_f32 v23, v23, v99
    v_mfma_f32_16x16x32_bf16 a[156:159], v[132:135], v[104:107], 0
    v_cvt_pk_bf16_f32 v109, v98, v99
    v_exp_f32 v102, v102
    v_mfma_f32_16x16x32_bf16 a[184:187], v[136:139], v[104:107], 0
    v_exp_f32 v103, v103
    v_add_f32 v22, v22, v100
    v_add_f32 v23, v23, v101
    v_mfma_f32_16x16x32_bf16 a[212:215], v[140:143], v[104:107], 0
    v_cvt_pk_bf16_f32 v110, v100, v101
    v_add_f32 v22, v22, v102
    v_add_f32 v23, v23, v103
    v_cvt_pk_bf16_f32 v111, v102, v103
    s_waitcnt lgkmcnt(0)
    v_mfma_f32_16x16x32_bf16 v[96:99], v[56:59], a[0:3], v[28:31]
    v_max3_f32 v2, v88, v89, v24
    v_max3_f32 v3, v90, v91, v92
    v_max3_f32 v2, v93, v94, v2
    v_mfma_f32_16x16x32_bf16 v[96:99], v[60:63], a[4:7], v[96:99]
    v_max3_f32 v2, v95, v2, v3
    v_mov_b32 v3, v2
    s_nop 1
    v_permlane16_swap_b32 v2, v3
    v_mfma_f32_16x16x32_bf16 v[96:99], v[64:67], a[8:11], v[96:99]
    s_nop 1
    v_max_f32 v2, v2, v3
    v_mov_b32 v3, v2
    v_mfma_f32_16x16x32_bf16 v[96:99], v[68:71], a[12:15], v[96:99]
    s_nop 1
    v_permlane32_swap_b32 v2, v3
    s_nop 1
    v_max_f32 v2, v2, v3
    v_mfma_f32_16x16x32_bf16 v[100:103], v[84:87], a[12:15], v[28:31]
    v_mov_b32 v24, 0
    v_mov_b32 v25, 0
    v_sub_f32 v88, v88, v2
    v_mfma_f32_16x16x32_bf16 v[100:103], v[80:83], a[8:11], v[100:103]
    v_sub_f32 v89, v89, v2
    v_sub_f32 v90, v90, v2
    v_sub_f32 v91, v91, v2
    v_sub_f32 v92, v92, v2
    v_mfma_f32_16x16x32_bf16 v[100:103], v[76:79], a[4:7], v[100:103]
    v_sub_f32 v93, v93, v2
    v_sub_f32 v94, v94, v2
    v_sub_f32 v95, v95, v2
    v_mfma_f32_16x16x32_bf16 v[100:103], v[72:75], a[0:3], v[100:103]
    v_sub_f32 v52, 0, v2
    v_sub_f32 v53, 0, v2
    v_sub_f32 v54, 0, v2
    v_sub_f32 v55, 0, v2
    v_mfma_f32_16x16x32_bf16 v[164:167], v[112:115], v[108:111], 0
    v_exp_f32 v88, v88
    v_mfma_f32_16x16x32_bf16 v[192:195], v[116:119], v[108:111], 0
    v_exp_f32 v89, v89
    v_exp_f32 v90, v90
    v_mfma_f32_16x16x32_bf16 v[220:223], v[120:123], v[108:111], 0
    v_exp_f32 v91, v91
    v_add_f32 v24, v24, v88
    v_add_f32 v25, v25, v89
    v_mfma_f32_16x16x32_bf16 v[248:251], v[124:127], v[108:111], 0
    v_cvt_pk_bf16_f32 v104, v88, v89
    v_exp_f32 v92, v92
    v_mfma_f32_16x16x32_bf16 a[132:135], v[128:131], v[108:111], 0
    v_exp_f32 v93, v93
    v_add_f32 v24, v24, v90
    v_add_f32 v25, v25, v91
    v_mfma_f32_16x16x32_bf16 a[160:163], v[132:135], v[108:111], 0
    v_cvt_pk_bf16_f32 v105, v90, v91
    v_exp_f32 v94, v94
    v_mfma_f32_16x16x32_bf16 a[188:191], v[136:139], v[108:111], 0
    v_exp_f32 v95, v95
    v_add_f32 v24, v24, v92
    v_add_f32 v25, v25, v93
    v_mfma_f32_16x16x32_bf16 a[216:219], v[140:143], v[108:111], 0
    v_cvt_pk_bf16_f32 v106, v92, v93
    v_add_f32 v24, v24, v94
    v_add_f32 v25, v25, v95
    v_cvt_pk_bf16_f32 v107, v94, v95
    s_mov_b32 s22, 0
L_at_loop:
    v_mfma_f32_16x16x32_bf16 v[88:91], v[56:59], a[16:19], v[32:35]
    v_mfma_f32_16x16x32_bf16 v[88:91], v[60:63], a[20:23], v[88:91]
    v_exp_f32 v96, v96
    v_mfma_f32_16x16x32_bf16 v[88:91], v[64:67], a[24:27], v[88:91]
    v_exp_f32 v97, v97
    v_mfma_f32_16x16x32_bf16 v[88:91], v[68:71], a[28:31], v[88:91]
    v_exp_f32 v98, v98
    v_mfma_f32_16x16x32_bf16 v[92:95], v[84:87], a[28:31], v[32:35]
    v_exp_f32 v99, v99
    v_mfma_f32_16x16x32_bf16 v[92:95], v[80:83], a[24:27], v[92:95]
    v_add_f32 v12, v12, v96
    v_add_f32 v13, v13, v97
    v_mfma_f32_16x16x32_bf16 v[92:95], v[76:79], a[20:23], v[92:95]
    v_cvt_pk_bf16_f32 v108, v96, v97
    v_mfma_f32_16x16x32_bf16 v[92:95], v[72:75], a[16:19], v[92:95]
    v_exp_f32 v100, v100
    v_mfma_f32_16x16x32_bf16 v[168:171], v[112:115], v[104:107], v[168:171]
    ds_read_b64_tr_b16 v[112:113], v9 offset:8448
    ds_read_b64_tr_b16 v[114:115], v9 offset:8960
    v_exp_f32 v101, v101
    v_mfma_f32_16x16x32_bf16 v[196:199], v[116:119], v[104:107], v[196:199]
    ds_read_b64_tr_b16 v[116:117], v9 offset:8480
    ds_read_b64_tr_b16 v[118:119], v9 offset:8992
    v_add_f32 v12, v12, v98
    v_add_f32 v13, v13, v99
    v_mfma_f32_16x16x32_bf16 v[224:227], v[120:123], v[104:107], v[224:227]
    ds_read_b64_tr_b16 v[120:121], v9 offset:8512
    ds_read_b64_tr_b16 v[122:123], v9 offset:9024
    v_cvt_pk_bf16_f32 v109, v98, v99
    v_mfma_f32_16x16x32_bf16 v[252:255], v[124:127], v[104:107], v[252:255]
    ds_read_b64_tr_b16 v[124:125], v9 offset:8544
    ds_read_b64_tr_b16 v[126:127], v9 offset:9056
    v_exp_f32 v102, v102
    v_mfma_f32_16x16x32_bf16 a[136:139], v[128:131], v[104:107], a[136:139]
    ds_read_b64_tr_b16 v[128:129], v9 offset:8576
    ds_read_b64_tr_b16 v[130:131], v9 offset:9088
    v_exp_f32 v103, v103
    v_mfma_f32_16x16x32_bf16 a[164:167], v[132:135], v[104:107], a[164:167]
    ds_read_b64_tr_b16 v[132:133], v9 offset:8608
    ds_read_b64_tr_b16 v[134:135], v9 offset:9120
    v_add_f32 v12, v12, v100
    v_add_f32 v13, v13, v101
    v_mfma_f32_16x16x32_bf16 a[192:195], v[136:139], v[104:107], a[192:195]
    ds_read_b64_tr_b16 v[136:137], v9 offset:8640
    ds_read_b64_tr_b16 v[138:139], v9 offset:9152
    v_cvt_pk_bf16_f32 v110, v100, v101
    v_add_f32 v12, v12, v102
    v_mfma_f32_16x16x32_bf16 a[220:223], v[140:143], v[104:107], a[220:223]
    ds_read_b64_tr_b16 v[140:141], v9 offset:8672
    ds_read_b64_tr_b16 v[142:143], v9 offset:9184
    v_add_f32 v13, v13, v103
    v_cvt_pk_bf16_f32 v111, v102, v103
    v_mfma_f32_16x16x32_bf16 v[96:99], v[56:59], a[32:35], v[36:39]
    v_mfma_f32_16x16x32_bf16 v[96:99], v[60:63], a[36:39], v[96:99]
    s_add_u32 s29, s34, s100
    v_exp_f32 v88, v88
    v_mfma_f32_16x16x32_bf16 v[96:99], v[64:67], a[40:43], v[96:99]
    v_exp_f32 v89, v89
    v_mfma_f32_16x16x32_bf16 v[96:99], v[68:71], a[44:47], v[96:99]
    s_bfe_u32 s28, s29, 0x20003
    v_exp_f32 v90, v90
    v_mfma_f32_16x16x32_bf16 v[100:103], v[84:87], a[44:47], v[36:39]
    v_exp_f32 v91, v91
    v_mfma_f32_16x16x32_bf16 v[100:103], v[80:83], a[40:43], v[100:103]
    s_lshl_b32 s28, s28, 16
    v_add_f32 v14, v14, v88
    v_add_f32 v15, v15, v89
    v_mfma_f32_16x16x32_bf16 v[100:103], v[76:79], a[36:39], v[100:103]
    v_cvt_pk_bf16_f32 v104, v88, v89
    v_mfma_f32_16x16x32_bf16 v[100:103], v[72:75], a[32:35], v[100:103]
    v_exp_f32 v92, v92
    s_waitcnt lgkmcnt(0)
    v_mfma_f32_16x16x32_bf16 v[144:147], v[112:115], v[108:111], v[144:147]
    s_and_b32 s29, s29, 7
    v_exp_f32 v93, v93
    v_mfma_f32_16x16x32_bf16 v[172:175], v[116:119], v[108:111], v[172:175]
    v_add_f32 v14, v14, v90
    v_add_f32 v15, v15, v91
    v_mfma_f32_16x16x32_bf16 v[200:203], v[120:123], v[108:111], v[200:203]
    s_lshl_b32 s29, s29, 11
    v_cvt_pk_bf16_f32 v105, v90, v91
    v_mfma_f32_16x16x32_bf16 v[228:231], v[124:127], v[108:111], v[228:231]
    v_exp_f32 v94, v94
    v_mfma_f32_16x16x32_bf16 a[112:115], v[128:131], v[108:111], a[112:115]
    s_add_u32 s29, s28, s29
    v_exp_f32 v95, v95
    v_mfma_f32_16x16x32_bf16 a[140:143], v[132:135], v[108:111], a[140:143]
    v_add_f32 v14, v14, v92
    v_add_f32 v15, v15, v93
    v_mfma_f32_16x16x32_bf16 a[168:171], v[136:139], v[108:111], a[168:171]
    s_lshr_b32 s28, s34, 5
    v_cvt_pk_bf16_f32 v106, v92, v93
    v_add_f32 v14, v14, v94
    v_mfma_f32_16x16x32_bf16 a[196:199], v[140:143], v[108:111], a[196:199]
    v_add_f32 v15, v15, v95
    v_cvt_pk_bf16_f32 v107, v94, v95
    v_mfma_f32_16x16x32_bf16 v[88:91], v[56:59], a[48:51], v[40:43]
    v_mfma_f32_16x16x32_bf16 v[88:91], v[60:63], a[52:55], v[88:91]
    s_lshl_b32 s28, s28, 19
    v_exp_f32 v96, v96
    v_mfma_f32_16x16x32_bf16 v[88:91], v[64:67], a[56:59], v[88:91]
    v_exp_f32 v97, v97
    v_mfma_f32_16x16x32_bf16 v[88:91], v[68:71], a[60:63], v[88:91]
    s_add_u32 s49, s28, s29
    v_exp_f32 v98, v98
    v_mfma_f32_16x16x32_bf16 v[92:95], v[84:87], a[60:63], v[40:43]
    v_exp_f32 v99, v99
    v_mfma_f32_16x16x32_bf16 v[92:95], v[80:83], a[56:59], v[92:95]
    s_add_u32 m0, s33, 0
    v_add_f32 v16, v16, v96
    v_add_f32 v17, v17, v97
    v_mfma_f32_16x16x32_bf16 v[92:95], v[76:79], a[52:55], v[92:95]
    v_cvt_pk_bf16_f32 v108, v96, v97
    v_mfma_f32_16x16x32_bf16 v[92:95], v[72:75], a[48:51], v[92:95]
    v_exp_f32 v100, v100
    v_mfma_f32_16x16x32_bf16 v[148:151], v[112:115], v[104:107], v[148:151]
    s_add_u32 s34, s34, 1
    v_exp_f32 v101, v101
    v_mfma_f32_16x16x32_bf16 v[176:179], v[116:119], v[104:107], v[176:179]
    v_add_f32 v16, v16, v98
    v_add_f32 v17, v17, v99
    v_mfma_f32_16x16x32_bf16 v[204:207], v[120:123], v[104:107], v[204:207]
    buffer_load_dwordx4 v7, s[4:7], s49 offen offset:0 nt lds
    v_cvt_pk_bf16_f32 v109, v98, v99
    v_mfma_f32_16x16x32_bf16 v[232:235], v[124:127], v[104:107], v[232:235]
    v_exp_f32 v102, v102
    v_mfma_f32_16x16x32_bf16 a[116:119], v[128:131], v[104:107], a[116:119]
    s_add_u32 m0, m0, s96
    v_exp_f32 v103, v103
    v_mfma_f32_16x16x32_bf16 a[144:147], v[132:135], v[104:107], a[144:147]
    v_add_f32 v16, v16, v100
    v_add_f32 v17, v17, v101
    v_mfma_f32_16x16x32_bf16 a[172:175], v[136:139], v[104:107], a[172:175]
    buffer_load_dwordx4 v7, s[4:7], s49 offen offset:256 nt lds
    v_cvt_pk_bf16_f32 v110, v100, v101
    v_add_f32 v16, v16, v102
    v_mfma_f32_16x16x32_bf16 a[200:203], v[140:143], v[104:107], a[200:203]
    v_add_f32 v17, v17, v103
    v_cvt_pk_bf16_f32 v111, v102, v103
    v_mfma_f32_16x16x32_bf16 v[96:99], v[56:59], a[64:67], v[44:47]
    v_mfma_f32_16x16x32_bf16 v[96:99], v[60:63], a[68:71], v[96:99]
    s_add_u32 m0, m0, s97
    v_exp_f32 v88, v88
    v_mfma_f32_16x16x32_bf16 v[96:99], v[64:67], a[72:75], v[96:99]
    v_exp_f32 v89, v89
    v_mfma_f32_16x16x32_bf16 v[96:99], v[68:71], a[76:79], v[96:99]
    buffer_load_dwordx4 v7, s[4:7], s49 offen offset:512 nt lds
    v_exp_f32 v90, v90
    v_mfma_f32_16x16x32_bf16 v[100:103], v[84:87], a[76:79], v[44:47]
    v_exp_f32 v91, v91
    v_mfma_f32_16x16x32_bf16 v[100:103], v[80:83], a[72:75], v[100:103]
    s_add_u32 m0, m0, s96
    v_add_f32 v18, v18, v88
    v_add_f32 v19, v19, v89
    v_mfma_f32_16x16x32_bf16 v[100:103], v[76:79], a[68:71], v[100:103]
    v_cvt_pk_bf16_f32 v104, v88, v89
    v_mfma_f32_16x16x32_bf16 v[100:103], v[72:75], a[64:67], v[100:103]
    v_exp_f32 v92, v92
    v_mfma_f32_16x16x32_bf16 v[152:155], v[112:115], v[108:111], v[152:155]
    buffer_load_dwordx4 v7, s[4:7], s49 offen offset:768 nt lds
    v_exp_f32 v93, v93
    v_mfma_f32_16x16x32_bf16 v[180:183], v[116:119], v[108:111], v[180:183]
    v_add_f32 v18, v18, v90
    v_add_f32 v19, v19, v91
    v_mfma_f32_16x16x32_bf16 v[208:211], v[120:123], v[108:111], v[208:211]
    s_add_u32 m0, m0, s97
    v_cvt_pk_bf16_f32 v105, v90, v91
    v_mfma_f32_16x16x32_bf16 v[236:239], v[124:127], v[108:111], v[236:239]
    v_exp_f32 v94, v94
    v_mfma_f32_16x16x32_bf16 a[120:123], v[128:131], v[108:111], a[120:123]
    buffer_load_dwordx4 v7, s[4:7], s49 offen offset:1024 nt lds
    v_exp_f32 v95, v95
    v_mfma_f32_16x16x32_bf16 a[148:151], v[132:135], v[108:111], a[148:151]
    v_add_f32 v18, v18, v92
    v_add_f32 v19, v19, v93
    v_mfma_f32_16x16x32_bf16 a[176:179], v[136:139], v[108:111], a[176:179]
    s_add_u32 m0, m0, s96
    v_cvt_pk_bf16_f32 v106, v92, v93
    v_add_f32 v18, v18, v94
    v_mfma_f32_16x16x32_bf16 a[204:207], v[140:143], v[108:111], a[204:207]
    v_add_f32 v19, v19, v95
    v_cvt_pk_bf16_f32 v107, v94, v95
    v_mfma_f32_16x16x32_bf16 v[88:91], v[56:59], a[80:83], v[48:51]
    v_mfma_f32_16x16x32_bf16 v[88:91], v[60:63], a[84:87], v[88:91]
    buffer_load_dwordx4 v7, s[4:7], s49 offen offset:1280 nt lds
    v_exp_f32 v96, v96
    v_mfma_f32_16x16x32_bf16 v[88:91], v[64:67], a[88:91], v[88:91]
    v_exp_f32 v97, v97
    v_mfma_f32_16x16x32_bf16 v[88:91], v[68:71], a[92:95], v[88:91]
    s_add_u32 m0, m0, s97
    v_exp_f32 v98, v98
    v_mfma_f32_16x16x32_bf16 v[92:95], v[84:87], a[92:95], v[48:51]
    v_exp_f32 v99, v99
    v_mfma_f32_16x16x32_bf16 v[92:95], v[80:83], a[88:91], v[92:95]
    buffer_load_dwordx4 v7, s[4:7], s49 offen offset:1536 nt lds
    v_add_f32 v20, v20, v96
    v_add_f32 v21, v21, v97
    v_mfma_f32_16x16x32_bf16 v[92:95], v[76:79], a[84:87], v[92:95]
    v_cvt_pk_bf16_f32 v108, v96, v97
    v_mfma_f32_16x16x32_bf16 v[92:95], v[72:75], a[80:83], v[92:95]
    v_exp_f32 v100, v100
    v_mfma_f32_16x16x32_bf16 v[156:159], v[112:115], v[104:107], v[156:159]
    s_add_u32 m0, m0, s96
    v_exp_f32 v101, v101
    v_mfma_f32_16x16x32_bf16 v[184:187], v[116:119], v[104:107], v[184:187]
    v_add_f32 v20, v20, v98
    v_add_f32 v21, v21, v99
    v_mfma_f32_16x16x32_bf16 v[212:215], v[120:123], v[104:107], v[212:215]
    buffer_load_dwordx4 v7, s[4:7], s49 offen offset:1792 nt lds
    v_cvt_pk_bf16_f32 v109, v98, v99
    v_mfma_f32_16x16x32_bf16 v[240:243], v[124:127], v[104:107], v[240:243]
    v_exp_f32 v102, v102
    v_mfma_f32_16x16x32_bf16 a[124:127], v[128:131], v[104:107], a[124:127]
    v_exp_f32 v103, v103
    v_mfma_f32_16x16x32_bf16 a[152:155], v[132:135], v[104:107], a[152:155]
    v_add_f32 v20, v20, v100
    v_add_f32 v21, v21, v101
    v_mfma_f32_16x16x32_bf16 a[180:183], v[136:139], v[104:107], a[180:183]
    v_cvt_pk_bf16_f32 v110, v100, v101
    v_add_f32 v20, v20, v102
    v_mfma_f32_16x16x32_bf16 a[208:211], v[140:143], v[104:107], a[208:211]
    v_add_f32 v21, v21, v103
    v_cvt_pk_bf16_f32 v111, v102, v103
    s_cmp_eq_u32 s68, 0
    s_cbranch_scc0 L_bw1_3491
    s_waitcnt vmcnt(16) lgkmcnt(0)
L_bw2_3491:
    s_barrier
    v_mfma_f32_16x16x32_bf16 v[96:99], v[56:59], a[96:99], v[52:55]
    ds_read_b128 v[56:59], v8 offset:16896
    v_mfma_f32_16x16x32_bf16 v[96:99], v[60:63], a[100:103], v[96:99]
    ds_read_b128 v[60:63], v8 offset:16960
    v_exp_f32 v88, v88
    v_mfma_f32_16x16x32_bf16 v[96:99], v[64:67], a[104:107], v[96:99]
    ds_read_b128 v[64:67], v8 offset:17024
    v_exp_f32 v89, v89
    v_mfma_f32_16x16x32_bf16 v[96:99], v[68:71], a[108:111], v[96:99]
    ds_read_b128 v[68:71], v8 offset:17088
    v_exp_f32 v90, v90
    v_mfma_f32_16x16x32_bf16 v[100:103], v[84:87], a[108:111], v[52:55]
    ds_read_b128 v[84:87], v8 offset:17600
    v_exp_f32 v91, v91
    v_mfma_f32_16x16x32_bf16 v[100:103], v[80:83], a[104:107], v[100:103]
    ds_read_b128 v[80:83], v8 offset:17536
    v_add_f32 v22, v22, v88
    v_add_f32 v23, v23, v89
    v_mfma_f32_16x16x32_bf16 v[100:103], v[76:79], a[100:103], v[100:103]
    ds_read_b128 v[76:79], v8 offset:17472
    v_cvt_pk_bf16_f32 v104, v88, v89
    v_mfma_f32_16x16x32_bf16 v[100:103], v[72:75], a[96:99], v[100:103]
    ds_read_b128 v[72:75], v8 offset:17408
    v_exp_f32 v92, v92
    v_mfma_f32_16x16x32_bf16 v[160:163], v[112:115], v[108:111], v[160:163]
    v_exp_f32 v93, v93
    v_mfma_f32_16x16x32_bf16 v[188:191], v[116:119], v[108:111], v[188:191]
    v_add_f32 v22, v22, v90
    v_add_f32 v23, v23, v91
    v_mfma_f32_16x16x32_bf16 v[216:219], v[120:123], v[108:111], v[216:219]
    v_cvt_pk_bf16_f32 v105, v90, v91
    v_mfma_f32_16x16x32_bf16 v[244:247], v[124:127], v[108:111], v[244:247]
    v_exp_f32 v94, v94
    v_mfma_f32_16x16x32_bf16 a[128:131], v[128:131], v[108:111], a[128:131]
    v_exp_f32 v95, v95
    v_mfma_f32_16x16x32_bf16 a[156:159], v[132:135], v[108:111], a[156:159]
    v_add_f32 v22, v22, v92
    v_add_f32 v23, v23, v93
    v_mfma_f32_16x16x32_bf16 a[184:187], v[136:139], v[108:111], a[184:187]
    v_cvt_pk_bf16_f32 v106, v92, v93
    v_add_f32 v22, v22, v94
    v_mfma_f32_16x16x32_bf16 a[212:215], v[140:143], v[108:111], a[212:215]
    v_add_f32 v23, v23, v95
    v_cvt_pk_bf16_f32 v107, v94, v95
    s_waitcnt lgkmcnt(0)
    v_mfma_f32_16x16x32_bf16 v[88:91], v[56:59], a[0:3], v[28:31]
    v_mfma_f32_16x16x32_bf16 v[88:91], v[60:63], a[4:7], v[88:91]
    v_exp_f32 v96, v96
    v_mfma_f32_16x16x32_bf16 v[88:91], v[64:67], a[8:11], v[88:91]
    v_exp_f32 v97, v97
    v_mfma_f32_16x16x32_bf16 v[88:91], v[68:71], a[12:15], v[88:91]
    v_exp_f32 v98, v98
    v_mfma_f32_16x16x32_bf16 v[92:95], v[84:87], a[12:15], v[28:31]
    v_exp_f32 v99, v99
    v_mfma_f32_16x16x32_bf16 v[92:95], v[80:83], a[8:11], v[92:95]
    v_add_f32 v24, v24, v96
    v_add_f32 v25, v25, v97
    v_mfma_f32_16x16x32_bf16 v[92:95], v[76:79], a[4:7], v[92:95]
    v_cvt_pk_bf16_f32 v108, v96, v97
    v_mfma_f32_16x16x32_bf16 v[92:95], v[72:75], a[0:3], v[92:95]
    v_exp_f32 v100, v100
    v_mfma_f32_16x16x32_bf16 v[164:167], v[112:115], v[104:107], v[164:167]
    v_exp_f32 v101, v101
    v_mfma_f32_16x16x32_bf16 v[192:195], v[116:119], v[104:107], v[192:195]
    v_add_f32 v24, v24, v98
    v_add_f32 v25, v25, v99
    v_mfma_f32_16x16x32_bf16 v[220:223], v[120:123], v[104:107], v[220:223]
    v_cvt_pk_bf16_f32 v109, v98, v99
    v_mfma_f32_16x16x32_bf16 v[248:251], v[124:127], v[104:107], v[248:251]
    v_exp_f32 v102, v102
    v_mfma_f32_16x16x32_bf16 a[132:135], v[128:131], v[104:107], a[132:135]
    v_exp_f32 v103, v103
    v_mfma_f32_16x16x32_bf16 a[160:163], v[132:135], v[104:107], a[160:163]
    v_add_f32 v24, v24, v100
    v_add_f32 v25, v25, v101
    v_mfma_f32_16x16x32_bf16 a[188:191], v[136:139], v[104:107], a[188:191]
    v_cvt_pk_bf16_f32 v110, v100, v101
    v_add_f32 v24, v24, v102
    v_mfma_f32_16x16x32_bf16 a[216:219], v[140:143], v[104:107], a[216:219]
    v_add_f32 v25, v25, v103
    v_cvt_pk_bf16_f32 v111, v102, v103
    v_mfma_f32_16x16x32_bf16 v[96:99], v[56:59], a[16:19], v[32:35]
    v_mfma_f32_16x16x32_bf16 v[96:99], v[60:63], a[20:23], v[96:99]
    v_exp_f32 v88, v88
    v_mfma_f32_16x16x32_bf16 v[96:99], v[64:67], a[24:27], v[96:99]
    v_exp_f32 v89, v89
    v_mfma_f32_16x16x32_bf16 v[96:99], v[68:71], a[28:31], v[96:99]
    v_exp_f32 v90, v90
    v_mfma_f32_16x16x32_bf16 v[100:103], v[84:87], a[28:31], v[32:35]
    v_exp_f32 v91, v91
    v_mfma_f32_16x16x32_bf16 v[100:103], v[80:83], a[24:27], v[100:103]
    v_add_f32 v12, v12, v88
    v_add_f32 v13, v13, v89
    v_mfma_f32_16x16x32_bf16 v[100:103], v[76:79], a[20:23], v[100:103]
    v_cvt_pk_bf16_f32 v104, v88, v89
    v_mfma_f32_16x16x32_bf16 v[100:103], v[72:75], a[16:19], v[100:103]
    v_exp_f32 v92, v92
    v_mfma_f32_16x16x32_bf16 v[168:171], v[112:115], v[108:111], v[168:171]
    ds_read_b64_tr_b16 v[112:113], v9 offset:16896
    ds_read_b64_tr_b16 v[114:115], v9 offset:17408
    v_exp_f32 v93, v93
    v_mfma_f32_16x16x32_bf16 v[196:199], v[116:119], v[108:111], v[196:199]
    ds_read_b64_tr_b16 v[116:117], v9 offset:16928
    ds_read_b64_tr_b16 v[118:119], v9 offset:17440
    v_add_f32 v12, v12, v90
    v_add_f32 v13, v13, v91
    v_mfma_f32_16x16x32_bf16 v[224:227], v[120:123], v[108:111], v[224:227]
    ds_read_b64_tr_b16 v[120:121], v9 offset:16960
    ds_read_b64_tr_b16 v[122:123], v9 offset:17472
    v_cvt_pk_bf16_f32 v105, v90, v91
    v_mfma_f32_16x16x32_bf16 v[252:255], v[124:127], v[108:111], v[252:255]
    ds_read_b64_tr_b16 v[124:125], v9 offset:16992
    ds_read_b64_tr_b16 v[126:127], v9 offset:17504
    v_exp_f32 v94, v94
    v_mfma_f32_16x16x32_bf16 a[136:139], v[128:131], v[108:111], a[136:139]
    ds_read_b64_tr_b16 v[128:129], v9 offset:17024
    ds_read_b64_tr_b16 v[130:131], v9 offset:17536
    v_exp_f32 v95, v95
    v_mfma_f32_16x16x32_bf16 a[164:167], v[132:135], v[108:111], a[164:167]
    ds_read_b64_tr_b16 v[132:133], v9 offset:17056
    ds_read_b64_tr_b16 v[134:135], v9 offset:17568
    v_add_f32 v12, v12, v92
    v_add_f32 v13, v13, v93
    v_mfma_f32_16x16x32_bf16 a[192:195], v[136:139], v[108:111], a[192:195]
    ds_read_b64_tr_b16 v[136:137], v9 offset:17088
    ds_read_b64_tr_b16 v[138:139], v9 offset:17600
    v_cvt_pk_bf16_f32 v106, v92, v93
    v_add_f32 v12, v12, v94
    v_mfma_f32_16x16x32_bf16 a[220:223], v[140:143], v[108:111], a[220:223]
    ds_read_b64_tr_b16 v[140:141], v9 offset:17120
    ds_read_b64_tr_b16 v[142:143], v9 offset:17632
    v_add_f32 v13, v13, v95
    v_cvt_pk_bf16_f32 v107, v94, v95
    v_mfma_f32_16x16x32_bf16 v[88:91], v[56:59], a[32:35], v[36:39]
    v_mfma_f32_16x16x32_bf16 v[88:91], v[60:63], a[36:39], v[88:91]
    s_add_u32 s29, s34, s100
    v_exp_f32 v96, v96
    v_mfma_f32_16x16x32_bf16 v[88:91], v[64:67], a[40:43], v[88:91]
    v_exp_f32 v97, v97
    v_mfma_f32_16x16x32_bf16 v[88:91], v[68:71], a[44:47], v[88:91]
    s_bfe_u32 s28, s29, 0x20003
    v_exp_f32 v98, v98
    v_mfma_f32_16x16x32_bf16 v[92:95], v[84:87], a[44:47], v[36:39]
    v_exp_f32 v99, v99
    v_mfma_f32_16x16x32_bf16 v[92:95], v[80:83], a[40:43], v[92:95]
    s_lshl_b32 s28, s28, 16
    v_add_f32 v14, v14, v96
    v_add_f32 v15, v15, v97
    v_mfma_f32_16x16x32_bf16 v[92:95], v[76:79], a[36:39], v[92:95]
    v_cvt_pk_bf16_f32 v108, v96, v97
    v_mfma_f32_16x16x32_bf16 v[92:95], v[72:75], a[32:35], v[92:95]
    v_exp_f32 v100, v100
    s_waitcnt lgkmcnt(0)
    v_mfma_f32_16x16x32_bf16 v[144:147], v[112:115], v[104:107], v[144:147]
    s_and_b32 s29, s29, 7
    v_exp_f32 v101, v101
    v_mfma_f32_16x16x32_bf16 v[172:175], v[116:119], v[104:107], v[172:175]
    v_add_f32 v14, v14, v98
    v_add_f32 v15, v15, v99
    v_mfma_f32_16x16x32_bf16 v[200:203], v[120:123], v[104:107], v[200:203]
    s_lshl_b32 s29, s29, 11
    v_cvt_pk_bf16_f32 v109, v98, v99
    v_mfma_f32_16x16x32_bf16 v[228:231], v[124:127], v[104:107], v[228:231]
    v_exp_f32 v102, v102
    v_mfma_f32_16x16x32_bf16 a[112:115], v[128:131], v[104:107], a[112:115]
    s_add_u32 s29, s28, s29
    v_exp_f32 v103, v103
    v_mfma_f32_16x16x32_bf16 a[140:143], v[132:135], v[104:107], a[140:143]
    v_add_f32 v14, v14, v100
    v_add_f32 v15, v15, v101
    v_mfma_f32_16x16x32_bf16 a[168:171], v[136:139], v[104:107], a[168:171]
    s_lshr_b32 s28, s34, 5
    v_cvt_pk_bf16_f32 v110, v100, v101
    v_add_f32 v14, v14, v102
    v_mfma_f32_16x16x32_bf16 a[196:199], v[140:143], v[104:107], a[196:199]
    v_add_f32 v15, v15, v103
    v_cvt_pk_bf16_f32 v111, v102, v103
    v_mfma_f32_16x16x32_bf16 v[96:99], v[56:59], a[48:51], v[40:43]
    v_mfma_f32_16x16x32_bf16 v[96:99], v[60:63], a[52:55], v[96:99]
    s_lshl_b32 s28, s28, 19
    v_exp_f32 v88, v88
    v_mfma_f32_16x16x32_bf16 v[96:99], v[64:67], a[56:59], v[96:99]
    v_exp_f32 v89, v89
    v_mfma_f32_16x16x32_bf16 v[96:99], v[68:71], a[60:63], v[96:99]
    s_add_u32 s49, s28, s29
    v_exp_f32 v90, v90
    v_mfma_f32_16x16x32_bf16 v[100:103], v[84:87], a[60:63], v[40:43]
    v_exp_f32 v91, v91
    v_mfma_f32_16x16x32_bf16 v[100:103], v[80:83], a[56:59], v[100:103]
    s_add_u32 m0, s33, 8448
    v_add_f32 v16, v16, v88
    v_add_f32 v17, v17, v89
    v_mfma_f32_16x16x32_bf16 v[100:103], v[76:79], a[52:55], v[100:103]
    v_cvt_pk_bf16_f32 v104, v88, v89
    v_mfma_f32_16x16x32_bf16 v[100:103], v[72:75], a[48:51], v[100:103]
    v_exp_f32 v92, v92
    v_mfma_f32_16x16x32_bf16 v[148:151], v[112:115], v[108:111], v[148:151]
    s_add_u32 s34, s34, 1
    v_exp_f32 v93, v93
    v_mfma_f32_16x16x32_bf16 v[176:179], v[116:119], v[108:111], v[176:179]
    v_add_f32 v16, v16, v90
    v_add_f32 v17, v17, v91
    v_mfma_f32_16x16x32_bf16 v[204:207], v[120:123], v[108:111], v[204:207]
    buffer_load_dwordx4 v7, s[4:7], s49 offen offset:0 nt lds
    v_cvt_pk_bf16_f32 v105, v90, v91
    v_mfma_f32_16x16x32_bf16 v[232:235], v[124:127], v[108:111], v[232:235]
    v_exp_f32 v94, v94
    v_mfma_f32_16x16x32_bf16 a[116:119], v[128:131], v[108:111], a[116:119]
    s_add_u32 m0, m0, s96
    v_exp_f32 v95, v95
    v_mfma_f32_16x16x32_bf16 a[144:147], v[132:135], v[108:111], a[144:147]
    v_add_f32 v16, v16, v92
    v_add_f32 v17, v17, v93
    v_mfma_f32_16x16x32_bf16 a[172:175], v[136:139], v[108:111], a[172:175]
    buffer_load_dwordx4 v7, s[4:7], s49 offen offset:256 nt lds
    v_cvt_pk_bf16_f32 v106, v92, v93
    v_add_f32 v16, v16, v94
    v_mfma_f32_16x16x32_bf16 a[200:203], v[140:143], v[108:111], a[200:203]
    v_add_f32 v17, v17, v95
    v_cvt_pk_bf16_f32 v107, v94, v95
    v_mfma_f32_16x16x32_bf16 v[88:91], v[56:59], a[64:67], v[44:47]
    v_mfma_f32_16x16x32_bf16 v[88:91], v[60:63], a[68:71], v[88:91]
    s_add_u32 m0, m0, s97
    v_exp_f32 v96, v96
    v_mfma_f32_16x16x32_bf16 v[88:91], v[64:67], a[72:75], v[88:91]
    v_exp_f32 v97, v97
    v_mfma_f32_16x16x32_bf16 v[88:91], v[68:71], a[76:79], v[88:91]
    buffer_load_dwordx4 v7, s[4:7], s49 offen offset:512 nt lds
    v_exp_f32 v98, v98
    v_mfma_f32_16x16x32_bf16 v[92:95], v[84:87], a[76:79], v[44:47]
    v_exp_f32 v99, v99
    v_mfma_f32_16x16x32_bf16 v[92:95], v[80:83], a[72:75], v[92:95]
    s_add_u32 m0, m0, s96
    v_add_f32 v18, v18, v96
    v_add_f32 v19, v19, v97
    v_mfma_f32_16x16x32_bf16 v[92:95], v[76:79], a[68:71], v[92:95]
    v_cvt_pk_bf16_f32 v108, v96, v97
    v_mfma_f32_16x16x32_bf16 v[92:95], v[72:75], a[64:67], v[92:95]
    v_exp_f32 v100, v100
    v_mfma_f32_16x16x32_bf16 v[152:155], v[112:115], v[104:107], v[152:155]
    buffer_load_dwordx4 v7, s[4:7], s49 offen offset:768 nt lds
    v_exp_f32 v101, v101
    v_mfma_f32_16x16x32_bf16 v[180:183], v[116:119], v[104:107], v[180:183]
    v_add_f32 v18, v18, v98
    v_add_f32 v19, v19, v99
    v_mfma_f32_16x16x32_bf16 v[208:211], v[120:123], v[104:107], v[208:211]
    s_add_u32 m0, m0, s97
    v_cvt_pk_bf16_f32 v109, v98, v99
    v_mfma_f32_16x16x32_bf16 v[236:239], v[124:127], v[104:107], v[236:239]
    v_exp_f32 v102, v102
    v_mfma_f32_16x16x32_bf16 a[120:123], v[128:131], v[104:107], a[120:123]
    buffer_load_dwordx4 v7, s[4:7], s49 offen offset:1024 nt lds
    v_exp_f32 v103, v103
    v_mfma_f32_16x16x32_bf16 a[148:151], v[132:135], v[104:107], a[148:151]
    v_add_f32 v18, v18, v100
    v_add_f32 v19, v19, v101
    v_mfma_f32_16x16x32_bf16 a[176:179], v[136:139], v[104:107], a[176:179]
    s_add_u32 m0, m0, s96
    v_cvt_pk_bf16_f32 v110, v100, v101
    v_add_f32 v18, v18, v102
    v_mfma_f32_16x16x32_bf16 a[204:207], v[140:143], v[104:107], a[204:207]
    v_add_f32 v19, v19, v103
    v_cvt_pk_bf16_f32 v111, v102, v103
    v_mfma_f32_16x16x32_bf16 v[96:99], v[56:59], a[80:83], v[48:51]
    v_mfma_f32_16x16x32_bf16 v[96:99], v[60:63], a[84:87], v[96:99]
    buffer_load_dwordx4 v7, s[4:7], s49 offen offset:1280 nt lds
    v_exp_f32 v88, v88
    v_mfma_f32_16x16x32_bf16 v[96:99], v[64:67], a[88:91], v[96:99]
    v_exp_f32 v89, v89
    v_mfma_f32_16x16x32_bf16 v[96:99], v[68:71], a[92:95], v[96:99]
    s_add_u32 m0, m0, s97
    v_exp_f32 v90, v90
    v_mfma_f32_16x16x32_bf16 v[100:103], v[84:87], a[92:95], v[48:51]
    v_exp_f32 v91, v91
    v_mfma_f32_16x16x32_bf16 v[100:103], v[80:83], a[88:91], v[100:103]
    buffer_load_dwordx4 v7, s[4:7], s49 offen offset:1536 nt lds
    v_add_f32 v20, v20, v88
    v_add_f32 v21, v21, v89
    v_mfma_f32_16x16x32_bf16 v[100:103], v[76:79], a[84:87], v[100:103]
    v_cvt_pk_bf16_f32 v104, v88, v89
    v_mfma_f32_16x16x32_bf16 v[100:103], v[72:75], a[80:83], v[100:103]
    v_exp_f32 v92, v92
    v_mfma_f32_16x16x32_bf16 v[156:159], v[112:115], v[108:111], v[156:159]
    s_add_u32 m0, m0, s96
    v_exp_f32 v93, v93
    v_mfma_f32_16x16x32_bf16 v[184:187], v[116:119], v[108:111], v[184:187]
    v_add_f32 v20, v20, v90
    v_add_f32 v21, v21, v91
    v_mfma_f32_16x16x32_bf16 v[212:215], v[120:123], v[108:111], v[212:215]
    buffer_load_dwordx4 v7, s[4:7], s49 offen offset:1792 nt lds
    v_cvt_pk_bf16_f32 v105, v90, v91
    v_mfma_f32_16x16x32_bf16 v[240:243], v[124:127], v[108:111], v[240:243]
    v_exp_f32 v94, v94
    v_mfma_f32_16x16x32_bf16 a[124:127], v[128:131], v[108:111], a[124:127]
    v_exp_f32 v95, v95
    v_mfma_f32_16x16x32_bf16 a[152:155], v[132:135], v[108:111], a[152:155]
    v_add_f32 v20, v20, v92
    v_add_f32 v21, v21, v93
    v_mfma_f32_16x16x32_bf16 a[180:183], v[136:139], v[108:111], a[180:183]
    v_cvt_pk_bf16_f32 v106, v92, v93
    v_add_f32 v20, v20, v94
    v_mfma_f32_16x16x32_bf16 a[208:211], v[140:143], v[108:111], a[208:211]
    v_add_f32 v21, v21, v95
    v_cvt_pk_bf16_f32 v107, v94, v95
    s_cmp_eq_u32 s68, 0
    s_cbranch_scc0 L_bw1_3800
    s_waitcnt vmcnt(16) lgkmcnt(0)
L_bw2_3800:
    s_barrier
    v_mfma_f32_16x16x32_bf16 v[88:91], v[56:59], a[96:99], v[52:55]
    ds_read_b128 v[56:59], v8 offset:25344
    v_mfma_f32_16x16x32_bf16 v[88:91], v[60:63], a[100:103], v[88:91]
    ds_read_b128 v[60:63], v8 offset:25408
    v_exp_f32 v96, v96
    v_mfma_f32_16x16x32_bf16 v[88:91], v[64:67], a[104:107], v[88:91]
    ds_read_b128 v[64:67], v8 offset:25472
    v_exp_f32 v97, v97
    v_mfma_f32_16x16x32_bf16 v[88:91], v[68:71], a[108:111], v[88:91]
    ds_read_b128 v[68:71], v8 offset:25536
    v_exp_f32 v98, v98
    v_mfma_f32_16x16x32_bf16 v[92:95], v[84:87], a[108:111], v[52:55]
    ds_read_b128 v[84:87], v8 offset:26048
    v_exp_f32 v99, v99
    v_mfma_f32_16x16x32_bf16 v[92:95], v[80:83], a[104:107], v[92:95]
    ds_read_b128 v[80:83], v8 offset:25984
    v_add_f32 v22, v22, v96
    v_add_f32 v23, v23, v97
    v_mfma_f32_16x16x32_bf16 v[92:95], v[76:79], a[100:103], v[92:95]
    ds_read_b128 v[76:79], v8 offset:25920
    v_cvt_pk_bf16_f32 v108, v96, v97
    v_mfma_f32_16x16x32_bf16 v[92:95], v[72:75], a[96:99], v[92:95]
    ds_read_b128 v[72:75], v8 offset:25856
    v_exp_f32 v100, v100
    v_mfma_f32_16x16x32_bf16 v[160:163], v[112:115], v[104:107], v[160:163]
    v_exp_f32 v101, v101
    v_mfma_f32_16x16x32_bf16 v[188:191], v[116:119], v[104:107], v[188:191]
    v_add_f32 v22, v22, v98
    v_add_f32 v23, v23, v99
    v_mfma_f32_16x16x32_bf16 v[216:219], v[120:123], v[104:107], v[216:219]
    v_cvt_pk_bf16_f32 v109, v98, v99
    v_mfma_f32_16x16x32_bf16 v[244:247], v[124:127], v[104:107], v[244:247]
    v_exp_f32 v102, v102
    v_mfma_f32_16x16x32_bf16 a[128:131], v[128:131], v[104:107], a[128:131]
    v_exp_f32 v103, v103
    v_mfma_f32_16x16x32_bf16 a[156:159], v[132:135], v[104:107], a[156:159]
    v_add_f32 v22, v22, v100
    v_add_f32 v23, v23, v101
    v_mfma_f32_16x16x32_bf16 a[184:187], v[136:139], v[104:107], a[184:187]
    v_cvt_pk_bf16_f32 v110, v100, v101
    v_add_f32 v22, v22, v102
    v_mfma_f32_16x16x32_bf16 a[212:215], v[140:143], v[104:107], a[212:215]
    v_add_f32 v23, v23, v103
    v_cvt_pk_bf16_f32 v111, v102, v103
    s_waitcnt lgkmcnt(0)
    v_mfma_f32_16x16x32_bf16 v[96:99], v[56:59], a[0:3], v[28:31]
    v_mfma_f32_16x16x32_bf16 v[96:99], v[60:63], a[4:7], v[96:99]
    v_exp_f32 v88, v88
    v_mfma_f32_16x16x32_bf16 v[96:99], v[64:67], a[8:11], v[96:99]
    v_exp_f32 v89, v89
    v_mfma_f32_16x16x32_bf16 v[96:99], v[68:71], a[12:15], v[96:99]
    v_exp_f32 v90, v90
    v_mfma_f32_16x16x32_bf16 v[100:103], v[84:87], a[12:15], v[28:31]
    v_exp_f32 v91, v91
    v_mfma_f32_16x16x32_bf16 v[100:103], v[80:83], a[8:11], v[100:103]
    v_add_f32 v24, v24, v88
    v_add_f32 v25, v25, v89
    v_mfma_f32_16x16x32_bf16 v[100:103], v[76:79], a[4:7], v[100:103]
    v_cvt_pk_bf16_f32 v104, v88, v89
    v_mfma_f32_16x16x32_bf16 v[100:103], v[72:75], a[0:3], v[100:103]
    v_exp_f32 v92, v92
    v_mfma_f32_16x16x32_bf16 v[164:167], v[112:115], v[108:111], v[164:167]
    v_exp_f32 v93, v93
    v_mfma_f32_16x16x32_bf16 v[192:195], v[116:119], v[108:111], v[192:195]
    v_add_f32 v24, v24, v90
    v_add_f32 v25, v25, v91
    v_mfma_f32_16x16x32_bf16 v[220:223], v[120:123], v[108:111], v[220:223]
    v_cvt_pk_bf16_f32 v105, v90, v91
    v_mfma_f32_16x16x32_bf16 v[248:251], v[124:127], v[108:111], v[248:251]
    v_exp_f32 v94, v94
    v_mfma_f32_16x16x32_bf16 a[132:135], v[128:131], v[108:111], a[132:135]
    v_exp_f32 v95, v95
    v_mfma_f32_16x16x32_bf16 a[160:163], v[132:135], v[108:111], a[160:163]
    v_add_f32 v24, v24, v92
    v_add_f32 v25, v25, v93
    v_mfma_f32_16x16x32_bf16 a[188:191], v[136:139], v[108:111], a[188:191]
    v_cvt_pk_bf16_f32 v106, v92, v93
    v_add_f32 v24, v24, v94
    v_mfma_f32_16x16x32_bf16 a[216:219], v[140:143], v[108:111], a[216:219]
    v_add_f32 v25, v25, v95
    v_cvt_pk_bf16_f32 v107, v94, v95
    v_mfma_f32_16x16x32_bf16 v[88:91], v[56:59], a[16:19], v[32:35]
    v_mfma_f32_16x16x32_bf16 v[88:91], v[60:63], a[20:23], v[88:91]
    v_exp_f32 v96, v96
    v_mfma_f32_16x16x32_bf16 v[88:91], v[64:67], a[24:27], v[88:91]
    v_exp_f32 v97, v97
    v_mfma_f32_16x16x32_bf16 v[88:91], v[68:71], a[28:31], v[88:91]
    v_exp_f32 v98, v98
    v_mfma_f32_16x16x32_bf16 v[92:95], v[84:87], a[28:31], v[32:35]
    v_exp_f32 v99, v99
    v_mfma_f32_16x16x32_bf16 v[92:95], v[80:83], a[24:27], v[92:95]
    v_add_f32 v12, v12, v96
    v_add_f32 v13, v13, v97
    v_mfma_f32_16x16x32_bf16 v[92:95], v[76:79], a[20:23], v[92:95]
    v_cvt_pk_bf16_f32 v108, v96, v97
    v_mfma_f32_16x16x32_bf16 v[92:95], v[72:75], a[16:19], v[92:95]
    v_exp_f32 v100, v100
    v_mfma_f32_16x16x32_bf16 v[168:171], v[112:115], v[104:107], v[168:171]
    ds_read_b64_tr_b16 v[112:113], v9 offset:25344
    ds_read_b64_tr_b16 v[114:115], v9 offset:25856
    v_exp_f32 v101, v101
    v_mfma_f32_16x16x32_bf16 v[196:199], v[116:119], v[104:107], v[196:199]
    ds_read_b64_tr_b16 v[116:117], v9 offset:25376
    ds_read_b64_tr_b16 v[118:119], v9 offset:25888
    v_add_f32 v12, v12, v98
    v_add_f32 v13, v13, v99
    v_mfma_f32_16x16x32_bf16 v[224:227], v[120:123], v[104:107], v[224:227]
    ds_read_b64_tr_b16 v[120:121], v9 offset:25408
    ds_read_b64_tr_b16 v[122:123], v9 offset:25920
    v_cvt_pk_bf16_f32 v109, v98, v99
    v_mfma_f32_16x16x32_bf16 v[252:255], v[124:127], v[104:107], v[252:255]
    ds_read_b64_tr_b16 v[124:125], v9 offset:25440
    ds_read_b64_tr_b16 v[126:127], v9 offset:25952
    v_exp_f32 v102, v102
    v_mfma_f32_16x16x32_bf16 a[136:139], v[128:131], v[104:107], a[136:139]
    ds_read_b64_tr_b16 v[128:129], v9 offset:25472
    ds_read_b64_tr_b16 v[130:131], v9 offset:25984
    v_exp_f32 v103, v103
    v_mfma_f32_16x16x32_bf16 a[164:167], v[132:135], v[104:107], a[164:167]
    ds_read_b64_tr_b16 v[132:133], v9 offset:25504
    ds_read_b64_tr_b16 v[134:135], v9 offset:26016
    v_add_f32 v12, v12, v100
    v_add_f32 v13, v13, v101
    v_mfma_f32_16x16x32_bf16 a[192:195], v[136:139], v[104:107], a[192:195]
    ds_read_b64_tr_b16 v[136:137], v9 offset:25536
    ds_read_b64_tr_b16 v[138:139], v9 offset:26048
    v_cvt_pk_bf16_f32 v110, v100, v101
    v_add_f32 v12, v12, v102
    v_mfma_f32_16x16x32_bf16 a[220:223], v[140:143], v[104:107], a[220:223]
    ds_read_b64_tr_b16 v[140:141], v9 offset:25568
    ds_read_b64_tr_b16 v[142:143], v9 offset:26080
    v_add_f32 v13, v13, v103
    v_cvt_pk_bf16_f32 v111, v102, v103
    v_mfma_f32_16x16x32_bf16 v[96:99], v[56:59], a[32:35], v[36:39]
    v_mfma_f32_16x16x32_bf16 v[96:99], v[60:63], a[36:39], v[96:99]
    s_add_u32 s29, s34, s100
    v_exp_f32 v88, v88
    v_mfma_f32_16x16x32_bf16 v[96:99], v[64:67], a[40:43], v[96:99]
    v_exp_f32 v89, v89
    v_mfma_f32_16x16x32_bf16 v[96:99], v[68:71], a[44:47], v[96:99]
    s_bfe_u32 s28, s29, 0x20003
    v_exp_f32 v90, v90
    v_mfma_f32_16x16x32_bf16 v[100:103], v[84:87], a[44:47], v[36:39]
    v_exp_f32 v91, v91
    v_mfma_f32_16x16x32_bf16 v[100:103], v[80:83], a[40:43], v[100:103]
    s_lshl_b32 s28, s28, 16
    v_add_f32 v14, v14, v88
    v_add_f32 v15, v15, v89
    v_mfma_f32_16x16x32_bf16 v[100:103], v[76:79], a[36:39], v[100:103]
    v_cvt_pk_bf16_f32 v104, v88, v89
    v_mfma_f32_16x16x32_bf16 v[100:103], v[72:75], a[32:35], v[100:103]
    v_exp_f32 v92, v92
    s_waitcnt lgkmcnt(0)
    v_mfma_f32_16x16x32_bf16 v[144:147], v[112:115], v[108:111], v[144:147]
    s_and_b32 s29, s29, 7
    v_exp_f32 v93, v93
    v_mfma_f32_16x16x32_bf16 v[172:175], v[116:119], v[108:111], v[172:175]
    v_add_f32 v14, v14, v90
    v_add_f32 v15, v15, v91
    v_mfma_f32_16x16x32_bf16 v[200:203], v[120:123], v[108:111], v[200:203]
    s_lshl_b32 s29, s29, 11
    v_cvt_pk_bf16_f32 v105, v90, v91
    v_mfma_f32_16x16x32_bf16 v[228:231], v[124:127], v[108:111], v[228:231]
    v_exp_f32 v94, v94
    v_mfma_f32_16x16x32_bf16 a[112:115], v[128:131], v[108:111], a[112:115]
    s_add_u32 s29, s28, s29
    v_exp_f32 v95, v95
    v_mfma_f32_16x16x32_bf16 a[140:143], v[132:135], v[108:111], a[140:143]
    v_add_f32 v14, v14, v92
    v_add_f32 v15, v15, v93
    v_mfma_f32_16x16x32_bf16 a[168:171], v[136:139], v[108:111], a[168:171]
    s_lshr_b32 s28, s34, 5
    v_cvt_pk_bf16_f32 v106, v92, v93
    v_add_f32 v14, v14, v94
    v_mfma_f32_16x16x32_bf16 a[196:199], v[140:143], v[108:111], a[196:199]
    v_add_f32 v15, v15, v95
    v_cvt_pk_bf16_f32 v107, v94, v95
    v_mfma_f32_16x16x32_bf16 v[88:91], v[56:59], a[48:51], v[40:43]
    v_mfma_f32_16x16x32_bf16 v[88:91], v[60:63], a[52:55], v[88:91]
    s_lshl_b32 s28, s28, 19
    v_exp_f32 v96, v96
    v_mfma_f32_16x16x32_bf16 v[88:91], v[64:67], a[56:59], v[88:91]
    v_exp_f32 v97, v97
    v_mfma_f32_16x16x32_bf16 v[88:91], v[68:71], a[60:63], v[88:91]
    s_add_u32 s49, s28, s29
    v_exp_f32 v98, v98
    v_mfma_f32_16x16x32_bf16 v[92:95], v[84:87], a[60:63], v[40:43]
    v_exp_f32 v99, v99
    v_mfma_f32_16x16x32_bf16 v[92:95], v[80:83], a[56:59], v[92:95]
    s_add_u32 m0, s33, 16896
    v_add_f32 v16, v16, v96
    v_add_f32 v17, v17, v97
    v_mfma_f32_16x16x32_bf16 v[92:95], v[76:79], a[52:55], v[92:95]
    v_cvt_pk_bf16_f32 v108, v96, v97
    v_mfma_f32_16x16x32_bf16 v[92:95], v[72:75], a[48:51], v[92:95]
    v_exp_f32 v100, v100
    v_mfma_f32_16x16x32_bf16 v[148:151], v[112:115], v[104:107], v[148:151]
    s_add_u32 s34, s34, 1
    v_exp_f32 v101, v101
    v_mfma_f32_16x16x32_bf16 v[176:179], v[116:119], v[104:107], v[176:179]
    v_add_f32 v16, v16, v98
    v_add_f32 v17, v17, v99
    v_mfma_f32_16x16x32_bf16 v[204:207], v[120:123], v[104:107], v[204:207]
    buffer_load_dwordx4 v7, s[4:7], s49 offen offset:0 nt lds
    v_cvt_pk_bf16_f32 v109, v98, v99
    v_mfma_f32_16x16x32_bf16 v[232:235], v[124:127], v[104:107], v[232:235]
    v_exp_f32 v102, v102
    v_mfma_f32_16x16x32_bf16 a[116:119], v[128:131], v[104:107], a[116:119]
    s_add_u32 m0, m0, s96
    v_exp_f32 v103, v103
    v_mfma_f32_16x16x32_bf16 a[144:147], v[132:135], v[104:107], a[144:147]
    v_add_f32 v16, v16, v100
    v_add_f32 v17, v17, v101
    v_mfma_f32_16x16x32_bf16 a[172:175], v[136:139], v[104:107], a[172:175]
    buffer_load_dwordx4 v7, s[4:7], s49 offen offset:256 nt lds
    v_cvt_pk_bf16_f32 v110, v100, v101
    v_add_f32 v16, v16, v102
    v_mfma_f32_16x16x32_bf16 a[200:203], v[140:143], v[104:107], a[200:203]
    v_add_f32 v17, v17, v103
    v_cvt_pk_bf16_f32 v111, v102, v103
    v_mfma_f32_16x16x32_bf16 v[96:99], v[56:59], a[64:67], v[44:47]
    v_mfma_f32_16x16x32_bf16 v[96:99], v[60:63], a[68:71], v[96:99]
    s_add_u32 m0, m0, s97
    v_exp_f32 v88, v88
    v_mfma_f32_16x16x32_bf16 v[96:99], v[64:67], a[72:75], v[96:99]
    v_exp_f32 v89, v89
    v_mfma_f32_16x16x32_bf16 v[96:99], v[68:71], a[76:79], v[96:99]
    buffer_load_dwordx4 v7, s[4:7], s49 offen offset:512 nt lds
    v_exp_f32 v90, v90
    v_mfma_f32_16x16x32_bf16 v[100:103], v[84:87], a[76:79], v[44:47]
    v_exp_f32 v91, v91
    v_mfma_f32_16x16x32_bf16 v[100:103], v[80:83], a[72:75], v[100:103]
    s_add_u32 m0, m0, s96
    v_add_f32 v18, v18, v88
    v_add_f32 v19, v19, v89
    v_mfma_f32_16x16x32_bf16 v[100:103], v[76:79], a[68:71], v[100:103]
    v_cvt_pk_bf16_f32 v104, v88, v89
    v_mfma_f32_16x16x32_bf16 v[100:103], v[72:75], a[64:67], v[100:103]
    v_exp_f32 v92, v92
    v_mfma_f32_16x16x32_bf16 v[152:155], v[112:115], v[108:111], v[152:155]
    buffer_load_dwordx4 v7, s[4:7], s49 offen offset:768 nt lds
    v_exp_f32 v93, v93
    v_mfma_f32_16x16x32_bf16 v[180:183], v[116:119], v[108:111], v[180:183]
    v_add_f32 v18, v18, v90
    v_add_f32 v19, v19, v91
    v_mfma_f32_16x16x32_bf16 v[208:211], v[120:123], v[108:111], v[208:211]
    s_add_u32 m0, m0, s97
    v_cvt_pk_bf16_f32 v105, v90, v91
    v_mfma_f32_16x16x32_bf16 v[236:239], v[124:127], v[108:111], v[236:239]
    v_exp_f32 v94, v94
    v_mfma_f32_16x16x32_bf16 a[120:123], v[128:131], v[108:111], a[120:123]
    buffer_load_dwordx4 v7, s[4:7], s49 offen offset:1024 nt lds
    v_exp_f32 v95, v95
    v_mfma_f32_16x16x32_bf16 a[148:151], v[132:135], v[108:111], a[148:151]
    v_add_f32 v18, v18, v92
    v_add_f32 v19, v19, v93
    v_mfma_f32_16x16x32_bf16 a[176:179], v[136:139], v[108:111], a[176:179]
    s_add_u32 m0, m0, s96
    v_cvt_pk_bf16_f32 v106, v92, v93
    v_add_f32 v18, v18, v94
    v_mfma_f32_16x16x32_bf16 a[204:207], v[140:143], v[108:111], a[204:207]
    v_add_f32 v19, v19, v95
    v_cvt_pk_bf16_f32 v107, v94, v95
    v_mfma_f32_16x16x32_bf16 v[88:91], v[56:59], a[80:83], v[48:51]
    v_mfma_f32_16x16x32_bf16 v[88:91], v[60:63], a[84:87], v[88:91]
    buffer_load_dwordx4 v7, s[4:7], s49 offen offset:1280 nt lds
    v_exp_f32 v96, v96
    v_mfma_f32_16x16x32_bf16 v[88:91], v[64:67], a[88:91], v[88:91]
    v_exp_f32 v97, v97
    v_mfma_f32_16x16x32_bf16 v[88:91], v[68:71], a[92:95], v[88:91]
    s_add_u32 m0, m0, s97
    v_exp_f32 v98, v98
    v_mfma_f32_16x16x32_bf16 v[92:95], v[84:87], a[92:95], v[48:51]
    v_exp_f32 v99, v99
    v_mfma_f32_16x16x32_bf16 v[92:95], v[80:83], a[88:91], v[92:95]
    buffer_load_dwordx4 v7, s[4:7], s49 offen offset:1536 nt lds
    v_add_f32 v20, v20, v96
    v_add_f32 v21, v21, v97
    v_mfma_f32_16x16x32_bf16 v[92:95], v[76:79], a[84:87], v[92:95]
    v_cvt_pk_bf16_f32 v108, v96, v97
    v_mfma_f32_16x16x32_bf16 v[92:95], v[72:75], a[80:83], v[92:95]
    v_exp_f32 v100, v100
    v_mfma_f32_16x16x32_bf16 v[156:159], v[112:115], v[104:107], v[156:159]
    s_add_u32 m0, m0, s96
    v_exp_f32 v101, v101
    v_mfma_f32_16x16x32_bf16 v[184:187], v[116:119], v[104:107], v[184:187]
    v_add_f32 v20, v20, v98
    v_add_f32 v21, v21, v99
    v_mfma_f32_16x16x32_bf16 v[212:215], v[120:123], v[104:107], v[212:215]
    buffer_load_dwordx4 v7, s[4:7], s49 offen offset:1792 nt lds
    v_cvt_pk_bf16_f32 v109, v98, v99
    v_mfma_f32_16x16x32_bf16 v[240:243], v[124:127], v[104:107], v[240:243]
    v_exp_f32 v102, v102
    v_mfma_f32_16x16x32_bf16 a[124:127], v[128:131], v[104:107], a[124:127]
    v_exp_f32 v103, v103
    v_mfma_f32_16x16x32_bf16 a[152:155], v[132:135], v[104:107], a[152:155]
    v_add_f32 v20, v20, v100
    v_add_f32 v21, v21, v101
    v_mfma_f32_16x16x32_bf16 a[180:183], v[136:139], v[104:107], a[180:183]
    v_cvt_pk_bf16_f32 v110, v100, v101
    v_add_f32 v20, v20, v102
    v_mfma_f32_16x16x32_bf16 a[208:211], v[140:143], v[104:107], a[208:211]
    v_add_f32 v21, v21, v103
    v_cvt_pk_bf16_f32 v111, v102, v103
    s_waitcnt vmcnt(16) lgkmcnt(0)
    s_barrier
    v_mfma_f32_16x16x32_bf16 v[96:99], v[56:59], a[96:99], v[52:55]
    ds_read_b128 v[56:59], v8 offset:0
    v_mfma_f32_16x16x32_bf16 v[96:99], v[60:63], a[100:103], v[96:99]
    ds_read_b128 v[60:63], v8 offset:64
    v_exp_f32 v88, v88
    v_mfma_f32_16x16x32_bf16 v[96:99], v[64:67], a[104:107], v[96:99]
    ds_read_b128 v[64:67], v8 offset:128
    v_exp_f32 v89, v89
    v_mfma_f32_16x16x32_bf16 v[96:99], v[68:71], a[108:111], v[96:99]
    ds_read_b128 v[68:71], v8 offset:192
    v_exp_f32 v90, v90
    v_mfma_f32_16x16x32_bf16 v[100:103], v[84:87], a[108:111], v[52:55]
    ds_read_b128 v[84:87], v8 offset:704
    v_exp_f32 v91, v91
    v_mfma_f32_16x16x32_bf16 v[100:103], v[80:83], a[104:107], v[100:103]
    ds_read_b128 v[80:83], v8 offset:640
    v_add_f32 v22, v22, v88
    v_add_f32 v23, v23, v89
    v_mfma_f32_16x16x32_bf16 v[100:103], v[76:79], a[100:103], v[100:103]
    ds_read_b128 v[76:79], v8 offset:576
    v_cvt_pk_bf16_f32 v104, v88, v89
    v_mfma_f32_16x16x32_bf16 v[100:103], v[72:75], a[96:99], v[100:103]
    ds_read_b128 v[72:75], v8 offset:512
    v_exp_f32 v92, v92
    v_mfma_f32_16x16x32_bf16 v[160:163], v[112:115], v[108:111], v[160:163]
    v_exp_f32 v93, v93
    v_mfma_f32_16x16x32_bf16 v[188:191], v[116:119], v[108:111], v[188:191]
    v_add_f32 v22, v22, v90
    v_add_f32 v23, v23, v91
    v_mfma_f32_16x16x32_bf16 v[216:219], v[120:123], v[108:111], v[216:219]
    v_cvt_pk_bf16_f32 v105, v90, v91
    v_mfma_f32_16x16x32_bf16 v[244:247], v[124:127], v[108:111], v[244:247]
    v_exp_f32 v94, v94
    v_mfma_f32_16x16x32_bf16 a[128:131], v[128:131], v[108:111], a[128:131]
    v_exp_f32 v95, v95
    v_mfma_f32_16x16x32_bf16 a[156:159], v[132:135], v[108:111], a[156:159]
    v_add_f32 v22, v22, v92
    v_add_f32 v23, v23, v93
    v_mfma_f32_16x16x32_bf16 a[184:187], v[136:139], v[108:111], a[184:187]
    v_cvt_pk_bf16_f32 v106, v92, v93
    v_add_f32 v22, v22, v94
    v_mfma_f32_16x16x32_bf16 a[212:215], v[140:143], v[108:111], a[212:215]
    v_add_f32 v23, v23, v95
    v_cvt_pk_bf16_f32 v107, v94, v95
    s_waitcnt lgkmcnt(0)
    v_mfma_f32_16x16x32_bf16 v[88:91], v[56:59], a[0:3], v[28:31]
    v_mfma_f32_16x16x32_bf16 v[88:91], v[60:63], a[4:7], v[88:91]
    v_exp_f32 v96, v96
    v_mfma_f32_16x16x32_bf16 v[88:91], v[64:67], a[8:11], v[88:91]
    v_exp_f32 v97, v97
    v_mfma_f32_16x16x32_bf16 v[88:91], v[68:71], a[12:15], v[88:91]
    v_exp_f32 v98, v98
    v_mfma_f32_16x16x32_bf16 v[92:95], v[84:87], a[12:15], v[28:31]
    v_exp_f32 v99, v99
    v_mfma_f32_16x16x32_bf16 v[92:95], v[80:83], a[8:11], v[92:95]
    v_add_f32 v24, v24, v96
    v_add_f32 v25, v25, v97
    v_mfma_f32_16x16x32_bf16 v[92:95], v[76:79], a[4:7], v[92:95]
    v_cvt_pk_bf16_f32 v108, v96, v97
    v_mfma_f32_16x16x32_bf16 v[92:95], v[72:75], a[0:3], v[92:95]
    v_exp_f32 v100, v100
    v_mfma_f32_16x16x32_bf16 v[164:167], v[112:115], v[104:107], v[164:167]
    v_exp_f32 v101, v101
    v_mfma_f32_16x16x32_bf16 v[192:195], v[116:119], v[104:107], v[192:195]
    v_add_f32 v24, v24, v98
    v_add_f32 v25, v25, v99
    v_mfma_f32_16x16x32_bf16 v[220:223], v[120:123], v[104:107], v[220:223]
    v_cvt_pk_bf16_f32 v109, v98, v99
    v_mfma_f32_16x16x32_bf16 v[248:251], v[124:127], v[104:107], v[248:251]
    v_exp_f32 v102, v102
    v_mfma_f32_16x16x32_bf16 a[132:135], v[128:131], v[104:107], a[132:135]
    v_exp_f32 v103, v103
    v_mfma_f32_16x16x32_bf16 a[160:163], v[132:135], v[104:107], a[160:163]
    v_add_f32 v24, v24, v100
    v_add_f32 v25, v25, v101
    v_mfma_f32_16x16x32_bf16 a[188:191], v[136:139], v[104:107], a[188:191]
    v_cvt_pk_bf16_f32 v110, v100, v101
    v_add_f32 v24, v24, v102
    v_mfma_f32_16x16x32_bf16 a[216:219], v[140:143], v[104:107], a[216:219]
    v_add_f32 v25, v25, v103
    v_cvt_pk_bf16_f32 v111, v102, v103
    v_mfma_f32_16x16x32_bf16 v[96:99], v[56:59], a[16:19], v[32:35]
    v_mfma_f32_16x16x32_bf16 v[96:99], v[60:63], a[20:23], v[96:99]
    v_exp_f32 v88, v88
    v_mfma_f32_16x16x32_bf16 v[96:99], v[64:67], a[24:27], v[96:99]
    v_exp_f32 v89, v89
    v_mfma_f32_16x16x32_bf16 v[96:99], v[68:71], a[28:31], v[96:99]
    v_exp_f32 v90, v90
    v_mfma_f32_16x16x32_bf16 v[100:103], v[84:87], a[28:31], v[32:35]
    v_exp_f32 v91, v91
    v_mfma_f32_16x16x32_bf16 v[100:103], v[80:83], a[24:27], v[100:103]
    v_add_f32 v12, v12, v88
    v_add_f32 v13, v13, v89
    v_mfma_f32_16x16x32_bf16 v[100:103], v[76:79], a[20:23], v[100:103]
    v_cvt_pk_bf16_f32 v104, v88, v89
    v_mfma_f32_16x16x32_bf16 v[100:103], v[72:75], a[16:19], v[100:103]
    v_exp_f32 v92, v92
    v_mfma_f32_16x16x32_bf16 v[168:171], v[112:115], v[108:111], v[168:171]
    ds_read_b64_tr_b16 v[112:113], v9 offset:0
    ds_read_b64_tr_b16 v[114:115], v9 offset:512
    v_exp_f32 v93, v93
    v_mfma_f32_16x16x32_bf16 v[196:199], v[116:119], v[108:111], v[196:199]
    ds_read_b64_tr_b16 v[116:117], v9 offset:32
    ds_read_b64_tr_b16 v[118:119], v9 offset:544
    v_add_f32 v12, v12, v90
    v_add_f32 v13, v13, v91
    v_mfma_f32_16x16x32_bf16 v[224:227], v[120:123], v[108:111], v[224:227]
    ds_read_b64_tr_b16 v[120:121], v9 offset:64
    ds_read_b64_tr_b16 v[122:123], v9 offset:576
    v_cvt_pk_bf16_f32 v105, v90, v91
    v_mfma_f32_16x16x32_bf16 v[252:255], v[124:127], v[108:111], v[252:255]
    ds_read_b64_tr_b16 v[124:125], v9 offset:96
    ds_read_b64_tr_b16 v[126:127], v9 offset:608
    v_exp_f32 v94, v94
    v_mfma_f32_16x16x32_bf16 a[136:139], v[128:131], v[108:111], a[136:139]
    ds_read_b64_tr_b16 v[128:129], v9 offset:128
    ds_read_b64_tr_b16 v[130:131], v9 offset:640
    v_exp_f32 v95, v95
    v_mfma_f32_16x16x32_bf16 a[164:167], v[132:135], v[108:111], a[164:167]
    ds_read_b64_tr_b16 v[132:133], v9 offset:160
    ds_read_b64_tr_b16 v[134:135], v9 offset:672
    v_add_f32 v12, v12, v92
    v_add_f32 v13, v13, v93
    v_mfma_f32_16x16x32_bf16 a[192:195], v[136:139], v[108:111], a[192:195]
    ds_read_b64_tr_b16 v[136:137], v9 offset:192
    ds_read_b64_tr_b16 v[138:139], v9 offset:704
    v_cvt_pk_bf16_f32 v106, v92, v93
    v_add_f32 v12, v12, v94
    v_mfma_f32_16x16x32_bf16 a[220:223], v[140:143], v[108:111], a[220:223]
    ds_read_b64_tr_b16 v[140:141], v9 offset:224
    ds_read_b64_tr_b16 v[142:143], v9 offset:736
    v_add_f32 v13, v13, v95
    v_cvt_pk_bf16_f32 v107, v94, v95
    v_mfma_f32_16x16x32_bf16 v[88:91], v[56:59], a[32:35], v[36:39]
    v_mfma_f32_16x16x32_bf16 v[88:91], v[60:63], a[36:39], v[88:91]
    s_add_u32 s29, s34, s100
    v_exp_f32 v96, v96
    v_mfma_f32_16x16x32_bf16 v[88:91], v[64:67], a[40:43], v[88:91]
    v_exp_f32 v97, v97
    v_mfma_f32_16x16x32_bf16 v[88:91], v[68:71], a[44:47], v[88:91]
    s_bfe_u32 s28, s29, 0x20003
    v_exp_f32 v98, v98
    v_mfma_f32_16x16x32_bf16 v[92:95], v[84:87], a[44:47], v[36:39]
    v_exp_f32 v99, v99
    v_mfma_f32_16x16x32_bf16 v[92:95], v[80:83], a[40:43], v[92:95]
    s_lshl_b32 s28, s28, 16
    v_add_f32 v14, v14, v96
    v_add_f32 v15, v15, v97
    v_mfma_f32_16x16x32_bf16 v[92:95], v[76:79], a[36:39], v[92:95]
    v_cvt_pk_bf16_f32 v108, v96, v97
    v_mfma_f32_16x16x32_bf16 v[92:95], v[72:75], a[32:35], v[92:95]
    v_exp_f32 v100, v100
    s_waitcnt lgkmcnt(0)
    v_mfma_f32_16x16x32_bf16 v[144:147], v[112:115], v[104:107], v[144:147]
    s_and_b32 s29, s29, 7
    v_exp_f32 v101, v101
    v_mfma_f32_16x16x32_bf16 v[172:175], v[116:119], v[104:107], v[172:175]
    v_add_f32 v14, v14, v98
    v_add_f32 v15, v15, v99
    v_mfma_f32_16x16x32_bf16 v[200:203], v[120:123], v[104:107], v[200:203]
    s_lshl_b32 s29, s29, 11
    v_cvt_pk_bf16_f32 v109, v98, v99
    v_mfma_f32_16x16x32_bf16 v[228:231], v[124:127], v[104:107], v[228:231]
    v_exp_f32 v102, v102
    v_mfma_f32_16x16x32_bf16 a[112:115], v[128:131], v[104:107], a[112:115]
    s_add_u32 s29, s28, s29
    v_exp_f32 v103, v103
    v_mfma_f32_16x16x32_bf16 a[140:143], v[132:135], v[104:107], a[140:143]
    v_add_f32 v14, v14, v100
    v_add_f32 v15, v15, v101
    v_mfma_f32_16x16x32_bf16 a[168:171], v[136:139], v[104:107], a[168:171]
    s_lshr_b32 s28, s34, 5
    v_cvt_pk_bf16_f32 v110, v100, v101
    v_add_f32 v14, v14, v102
    v_mfma_f32_16x16x32_bf16 a[196:199], v[140:143], v[104:107], a[196:199]
    v_add_f32 v15, v15, v103
    v_cvt_pk_bf16_f32 v111, v102, v103
    v_mfma_f32_16x16x32_bf16 v[96:99], v[56:59], a[48:51], v[40:43]
    v_mfma_f32_16x16x32_bf16 v[96:99], v[60:63], a[52:55], v[96:99]
    s_lshl_b32 s28, s28, 19
    v_exp_f32 v88, v88
    v_mfma_f32_16x16x32_bf16 v[96:99], v[64:67], a[56:59], v[96:99]
    v_exp_f32 v89, v89
    v_mfma_f32_16x16x32_bf16 v[96:99], v[68:71], a[60:63], v[96:99]
    s_add_u32 s49, s28, s29
    v_exp_f32 v90, v90
    v_mfma_f32_16x16x32_bf16 v[100:103], v[84:87], a[60:63], v[40:43]
    v_exp_f32 v91, v91
    v_mfma_f32_16x16x32_bf16 v[100:103], v[80:83], a[56:59], v[100:103]
    s_add_u32 m0, s33, 25344
    v_add_f32 v16, v16, v88
    v_add_f32 v17, v17, v89
    v_mfma_f32_16x16x32_bf16 v[100:103], v[76:79], a[52:55], v[100:103]
    v_cvt_pk_bf16_f32 v104, v88, v89
    v_mfma_f32_16x16x32_bf16 v[100:103], v[72:75], a[48:51], v[100:103]
    v_exp_f32 v92, v92
    v_mfma_f32_16x16x32_bf16 v[148:151], v[112:115], v[108:111], v[148:151]
    s_add_u32 s34, s34, 1
    v_exp_f32 v93, v93
    v_mfma_f32_16x16x32_bf16 v[176:179], v[116:119], v[108:111], v[176:179]
    v_add_f32 v16, v16, v90
    v_add_f32 v17, v17, v91
    v_mfma_f32_16x16x32_bf16 v[204:207], v[120:123], v[108:111], v[204:207]
    buffer_load_dwordx4 v7, s[4:7], s49 offen offset:0 nt lds
    v_cvt_pk_bf16_f32 v105, v90, v91
    v_mfma_f32_16x16x32_bf16 v[232:235], v[124:127], v[108:111], v[232:235]
    v_exp_f32 v94, v94
    v_mfma_f32_16x16x32_bf16 a[116:119], v[128:131], v[108:111], a[116:119]
    s_add_u32 m0, m0, s96
    v_exp_f32 v95, v95
    v_mfma_f32_16x16x32_bf16 a[144:147], v[132:135], v[108:111], a[144:147]
    v_add_f32 v16, v16, v92
    v_add_f32 v17, v17, v93
    v_mfma_f32_16x16x32_bf16 a[172:175], v[136:139], v[108:111], a[172:175]
    buffer_load_dwordx4 v7, s[4:7], s49 offen offset:256 nt lds
    v_cvt_pk_bf16_f32 v106, v92, v93
    v_add_f32 v16, v16, v94
    v_mfma_f32_16x16x32_bf16 a[200:203], v[140:143], v[108:111], a[200:203]
    v_add_f32 v17, v17, v95
    v_cvt_pk_bf16_f32 v107, v94, v95
    v_mfma_f32_16x16x32_bf16 v[88:91], v[56:59], a[64:67], v[44:47]
    v_mfma_f32_16x16x32_bf16 v[88:91], v[60:63], a[68:71], v[88:91]
    s_add_u32 m0, m0, s97
    v_exp_f32 v96, v96
    v_mfma_f32_16x16x32_bf16 v[88:91], v[64:67], a[72:75], v[88:91]
    v_exp_f32 v97, v97
    v_mfma_f32_16x16x32_bf16 v[88:91], v[68:71], a[76:79], v[88:91]
    buffer_load_dwordx4 v7, s[4:7], s49 offen offset:512 nt lds
    v_exp_f32 v98, v98
    v_mfma_f32_16x16x32_bf16 v[92:95], v[84:87], a[76:79], v[44:47]
    v_exp_f32 v99, v99
    v_mfma_f32_16x16x32_bf16 v[92:95], v[80:83], a[72:75], v[92:95]
    s_add_u32 m0, m0, s96
    v_add_f32 v18, v18, v96
    v_add_f32 v19, v19, v97
    v_mfma_f32_16x16x32_bf16 v[92:95], v[76:79], a[68:71], v[92:95]
    v_cvt_pk_bf16_f32 v108, v96, v97
    v_mfma_f32_16x16x32_bf16 v[92:95], v[72:75], a[64:67], v[92:95]
    v_exp_f32 v100, v100
    v_mfma_f32_16x16x32_bf16 v[152:155], v[112:115], v[104:107], v[152:155]
    buffer_load_dwordx4 v7, s[4:7], s49 offen offset:768 nt lds
    v_exp_f32 v101, v101
    v_mfma_f32_16x16x32_bf16 v[180:183], v[116:119], v[104:107], v[180:183]
    v_add_f32 v18, v18, v98
    v_add_f32 v19, v19, v99
    v_mfma_f32_16x16x32_bf16 v[208:211], v[120:123], v[104:107], v[208:211]
    s_add_u32 m0, m0, s97
    v_cvt_pk_bf16_f32 v109, v98, v99
    v_mfma_f32_16x16x32_bf16 v[236:239], v[124:127], v[104:107], v[236:239]
    v_exp_f32 v102, v102
    v_mfma_f32_16x16x32_bf16 a[120:123], v[128:131], v[104:107], a[120:123]
    buffer_load_dwordx4 v7, s[4:7], s49 offen offset:1024 nt lds
    v_exp_f32 v103, v103
    v_mfma_f32_16x16x32_bf16 a[148:151], v[132:135], v[104:107], a[148:151]
    v_add_f32 v18, v18, v100
    v_add_f32 v19, v19, v101
    v_mfma_f32_16x16x32_bf16 a[176:179], v[136:139], v[104:107], a[176:179]
    s_add_u32 m0, m0, s96
    v_cvt_pk_bf16_f32 v110, v100, v101
    v_add_f32 v18, v18, v102
    v_mfma_f32_16x16x32_bf16 a[204:207], v[140:143], v[104:107], a[204:207]
    v_add_f32 v19, v19, v103
    v_cvt_pk_bf16_f32 v111, v102, v103
    v_mfma_f32_16x16x32_bf16 v[96:99], v[56:59], a[80:83], v[48:51]
    v_mfma_f32_16x16x32_bf16 v[96:99], v[60:63], a[84:87], v[96:99]
    buffer_load_dwordx4 v7, s[4:7], s49 offen offset:1280 nt lds
    v_exp_f32 v88, v88
    v_mfma_f32_16x16x32_bf16 v[96:99], v[64:67], a[88:91], v[96:99]
    v_exp_f32 v89, v89
    v_mfma_f32_16x16x32_bf16 v[96:99], v[68:71], a[92:95], v[96:99]
    s_add_u32 m0, m0, s97
    v_exp_f32 v90, v90
    v_mfma_f32_16x16x32_bf16 v[100:103], v[84:87], a[92:95], v[48:51]
    v_exp_f32 v91, v91
    v_mfma_f32_16x16x32_bf16 v[100:103], v[80:83], a[88:91], v[100:103]
    buffer_load_dwordx4 v7, s[4:7], s49 offen offset:1536 nt lds
    v_add_f32 v20, v20, v88
    v_add_f32 v21, v21, v89
    v_mfma_f32_16x16x32_bf16 v[100:103], v[76:79], a[84:87], v[100:103]
    v_cvt_pk_bf16_f32 v104, v88, v89
    v_mfma_f32_16x16x32_bf16 v[100:103], v[72:75], a[80:83], v[100:103]
    v_exp_f32 v92, v92
    v_mfma_f32_16x16x32_bf16 v[156:159], v[112:115], v[108:111], v[156:159]
    s_add_u32 m0, m0, s96
    v_exp_f32 v93, v93
    v_mfma_f32_16x16x32_bf16 v[184:187], v[116:119], v[108:111], v[184:187]
    v_add_f32 v20, v20, v90
    v_add_f32 v21, v21, v91
    v_mfma_f32_16x16x32_bf16 v[212:215], v[120:123], v[108:111], v[212:215]
    buffer_load_dwordx4 v7, s[4:7], s49 offen offset:1792 nt lds
    v_cvt_pk_bf16_f32 v105, v90, v91
    v_mfma_f32_16x16x32_bf16 v[240:243], v[124:127], v[108:111], v[240:243]
    v_exp_f32 v94, v94
    v_mfma_f32_16x16x32_bf16 a[124:127], v[128:131], v[108:111], a[124:127]
    v_exp_f32 v95, v95
    v_mfma_f32_16x16x32_bf16 a[152:155], v[132:135], v[108:111], a[152:155]
    v_add_f32 v20, v20, v92
    v_add_f32 v21, v21, v93
    v_mfma_f32_16x16x32_bf16 a[180:183], v[136:139], v[108:111], a[180:183]
    v_cvt_pk_bf16_f32 v106, v92, v93
    v_add_f32 v20, v20, v94
    v_mfma_f32_16x16x32_bf16 a[208:211], v[140:143], v[108:111], a[208:211]
    v_add_f32 v21, v21, v95
    v_cvt_pk_bf16_f32 v107, v94, v95
    s_waitcnt vmcnt(16) lgkmcnt(0)
    s_barrier
    v_mfma_f32_16x16x32_bf16 v[88:91], v[56:59], a[96:99], v[52:55]
    ds_read_b128 v[56:59], v8 offset:8448
    v_mfma_f32_16x16x32_bf16 v[88:91], v[60:63], a[100:103], v[88:91]
    ds_read_b128 v[60:63], v8 offset:8512
    v_exp_f32 v96, v96
    v_mfma_f32_16x16x32_bf16 v[88:91], v[64:67], a[104:107], v[88:91]
    ds_read_b128 v[64:67], v8 offset:8576
    v_exp_f32 v97, v97
    v_mfma_f32_16x16x32_bf16 v[88:91], v[68:71], a[108:111], v[88:91]
    ds_read_b128 v[68:71], v8 offset:8640
    v_exp_f32 v98, v98
    v_mfma_f32_16x16x32_bf16 v[92:95], v[84:87], a[108:111], v[52:55]
    ds_read_b128 v[84:87], v8 offset:9152
    v_exp_f32 v99, v99
    v_mfma_f32_16x16x32_bf16 v[92:95], v[80:83], a[104:107], v[92:95]
    ds_read_b128 v[80:83], v8 offset:9088
    v_add_f32 v22, v22, v96
    v_add_f32 v23, v23, v97
    v_mfma_f32_16x16x32_bf16 v[92:95], v[76:79], a[100:103], v[92:95]
    ds_read_b128 v[76:79], v8 offset:9024
    v_cvt_pk_bf16_f32 v108, v96, v97
    v_mfma_f32_16x16x32_bf16 v[92:95], v[72:75], a[96:99], v[92:95]
    ds_read_b128 v[72:75], v8 offset:8960
    v_exp_f32 v100, v100
    v_mfma_f32_16x16x32_bf16 v[160:163], v[112:115], v[104:107], v[160:163]
    v_exp_f32 v101, v101
    v_mfma_f32_16x16x32_bf16 v[188:191], v[116:119], v[104:107], v[188:191]
    v_add_f32 v22, v22, v98
    v_add_f32 v23, v23, v99
    v_mfma_f32_16x16x32_bf16 v[216:219], v[120:123], v[104:107], v[216:219]
    v_cvt_pk_bf16_f32 v109, v98, v99
    v_mfma_f32_16x16x32_bf16 v[244:247], v[124:127], v[104:107], v[244:247]
    v_exp_f32 v102, v102
    v_mfma_f32_16x16x32_bf16 a[128:131], v[128:131], v[104:107], a[128:131]
    v_exp_f32 v103, v103
    v_mfma_f32_16x16x32_bf16 a[156:159], v[132:135], v[104:107], a[156:159]
    v_add_f32 v22, v22, v100
    v_add_f32 v23, v23, v101
    v_mfma_f32_16x16x32_bf16 a[184:187], v[136:139], v[104:107], a[184:187]
    v_cvt_pk_bf16_f32 v110, v100, v101
    v_add_f32 v22, v22, v102
    v_mfma_f32_16x16x32_bf16 a[212:215], v[140:143], v[104:107], a[212:215]
    v_add_f32 v23, v23, v103
    v_cvt_pk_bf16_f32 v111, v102, v103
    s_waitcnt lgkmcnt(0)
    v_mfma_f32_16x16x32_bf16 v[96:99], v[56:59], a[0:3], v[28:31]
    v_mfma_f32_16x16x32_bf16 v[96:99], v[60:63], a[4:7], v[96:99]
    v_exp_f32 v88, v88
    v_mfma_f32_16x16x32_bf16 v[96:99], v[64:67], a[8:11], v[96:99]
    v_exp_f32 v89, v89
    v_mfma_f32_16x16x32_bf16 v[96:99], v[68:71], a[12:15], v[96:99]
    v_exp_f32 v90, v90
    v_mfma_f32_16x16x32_bf16 v[100:103], v[84:87], a[12:15], v[28:31]
    v_exp_f32 v91, v91
    v_mfma_f32_16x16x32_bf16 v[100:103], v[80:83], a[8:11], v[100:103]
    v_add_f32 v24, v24, v88
    v_add_f32 v25, v25, v89
    v_mfma_f32_16x16x32_bf16 v[100:103], v[76:79], a[4:7], v[100:103]
    v_cvt_pk_bf16_f32 v104, v88, v89
    v_mfma_f32_16x16x32_bf16 v[100:103], v[72:75], a[0:3], v[100:103]
    v_exp_f32 v92, v92
    v_mfma_f32_16x16x32_bf16 v[164:167], v[112:115], v[108:111], v[164:167]
    v_exp_f32 v93, v93
    v_mfma_f32_16x16x32_bf16 v[192:195], v[116:119], v[108:111], v[192:195]
    v_add_f32 v24, v24, v90
    v_add_f32 v25, v25, v91
    v_mfma_f32_16x16x32_bf16 v[220:223], v[120:123], v[108:111], v[220:223]
    v_cvt_pk_bf16_f32 v105, v90, v91
    v_mfma_f32_16x16x32_bf16 v[248:251], v[124:127], v[108:111], v[248:251]
    v_exp_f32 v94, v94
    v_mfma_f32_16x16x32_bf16 a[132:135], v[128:131], v[108:111], a[132:135]
    v_exp_f32 v95, v95
    v_mfma_f32_16x16x32_bf16 a[160:163], v[132:135], v[108:111], a[160:163]
    v_add_f32 v24, v24, v92
    v_add_f32 v25, v25, v93
    v_mfma_f32_16x16x32_bf16 a[188:191], v[136:139], v[108:111], a[188:191]
    v_cvt_pk_bf16_f32 v106, v92, v93
    v_add_f32 v24, v24, v94
    v_mfma_f32_16x16x32_bf16 a[216:219], v[140:143], v[108:111], a[216:219]
    v_add_f32 v25, v25, v95
    v_cvt_pk_bf16_f32 v107, v94, v95
    s_add_u32 s22, s22, 1
    s_cmp_lt_u32 s22, 7
    s_cbranch_scc1 L_at_loop
    s_add_u32 s21, s21, 1
    s_mul_i32 s50, s21, s52
    s_mov_b32 s101, s21
    s_add_u32 s50, s50, s55
    s_cmp_ge_u32 s21, 2
    s_cselect_b32 s28, 0x40000000, 0
    s_add_u32 s50, s50, s28
    s_mov_b32 s82, s26
    s_mul_i32 s28, s26, s51
    s_add_u32 s50, s50, s28
    s_cmp_eq_u32 s21, 2
    s_cbranch_scc1 L_at_wt0
L_at_wt0r:
    s_cmp_lg_u32 s69, 0
    s_cbranch_scc1 L_at_atailB
    v_mfma_f32_16x16x32_bf16 v[88:91], v[56:59], a[16:19], v[32:35]
    v_mfma_f32_16x16x32_bf16 v[88:91], v[60:63], a[20:23], v[88:91]
    v_exp_f32 v96, v96
    v_mfma_f32_16x16x32_bf16 v[88:91], v[64:67], a[24:27], v[88:91]
    v_exp_f32 v97, v97
    v_mfma_f32_16x16x32_bf16 v[88:91], v[68:71], a[28:31], v[88:91]
    v_exp_f32 v98, v98
    v_mfma_f32_16x16x32_bf16 v[92:95], v[84:87], a[28:31], v[32:35]
    v_exp_f32 v99, v99
    v_mfma_f32_16x16x32_bf16 v[92:95], v[80:83], a[24:27], v[92:95]
    v_add_f32 v12, v12, v96
    v_add_f32 v13, v13, v97
    v_mfma_f32_16x16x32_bf16 v[92:95], v[76:79], a[20:23], v[92:95]
    v_cvt_pk_bf16_f32 v108, v96, v97
    v_mfma_f32_16x16x32_bf16 v[92:95], v[72:75], a[16:19], v[92:95]
    v_exp_f32 v100, v100
    v_mfma_f32_16x16x32_bf16 v[168:171], v[112:115], v[104:107], v[168:171]
    ds_read_b64_tr_b16 v[112:113], v9 offset:8448
    ds_read_b64_tr_b16 v[114:115], v9 offset:8960
    v_exp_f32 v101, v101
    v_mfma_f32_16x16x32_bf16 v[196:199], v[116:119], v[104:107], v[196:199]
    ds_read_b64_tr_b16 v[116:117], v9 offset:8480
    ds_read_b64_tr_b16 v[118:119], v9 offset:8992
    v_add_f32 v12, v12, v98
    v_add_f32 v13, v13, v99
    v_mfma_f32_16x16x32_bf16 v[224:227], v[120:123], v[104:107], v[224:227]
    ds_read_b64_tr_b16 v[120:121], v9 offset:8512
    ds_read_b64_tr_b16 v[122:123], v9 offset:9024
    v_cvt_pk_bf16_f32 v109, v98, v99
    v_mfma_f32_16x16x32_bf16 v[252:255], v[124:127], v[104:107], v[252:255]
    ds_read_b64_tr_b16 v[124:125], v9 offset:8544
    ds_read_b64_tr_b16 v[126:127], v9 offset:9056
    v_exp_f32 v102, v102
    v_mfma_f32_16x16x32_bf16 a[136:139], v[128:131], v[104:107], a[136:139]
    ds_read_b64_tr_b16 v[128:129], v9 offset:8576
    ds_read_b64_tr_b16 v[130:131], v9 offset:9088
    v_exp_f32 v103, v103
    v_mfma_f32_16x16x32_bf16 a[164:167], v[132:135], v[104:107], a[164:167]
    ds_read_b64_tr_b16 v[132:133], v9 offset:8608
    ds_read_b64_tr_b16 v[134:135], v9 offset:9120
    v_add_f32 v12, v12, v100
    v_add_f32 v13, v13, v101
    v_mfma_f32_16x16x32_bf16 a[192:195], v[136:139], v[104:107], a[192:195]
    ds_read_b64_tr_b16 v[136:137], v9 offset:8640
    ds_read_b64_tr_b16 v[138:139], v9 offset:9152
    v_cvt_pk_bf16_f32 v110, v100, v101
    v_add_f32 v12, v12, v102
    v_mfma_f32_16x16x32_bf16 a[220:223], v[140:143], v[104:107], a[220:223]
    ds_read_b64_tr_b16 v[140:141], v9 offset:8672
    ds_read_b64_tr_b16 v[142:143], v9 offset:9184
    v_add_f32 v13, v13, v103
    v_cvt_pk_bf16_f32 v111, v102, v103
    v_mfma_f32_16x16x32_bf16 v[96:99], v[56:59], a[32:35], v[36:39]
    v_mfma_f32_16x16x32_bf16 v[96:99], v[60:63], a[36:39], v[96:99]
    s_add_u32 m0, s33, 0
    v_exp_f32 v88, v88
    v_mfma_f32_16x16x32_bf16 v[96:99], v[64:67], a[40:43], v[96:99]
    v_exp_f32 v89, v89
    v_mfma_f32_16x16x32_bf16 v[96:99], v[68:71], a[44:47], v[96:99]
    s_mov_b32 s49, s50
    v_exp_f32 v90, v90
    v_mfma_f32_16x16x32_bf16 v[100:103], v[84:87], a[44:47], v[36:39]
    v_exp_f32 v91, v91
    v_mfma_f32_16x16x32_bf16 v[100:103], v[80:83], a[40:43], v[100:103]
    s_add_u32 s28, s49, s88
    v_add_f32 v14, v14, v88
    v_add_f32 v15, v15, v89
    v_mfma_f32_16x16x32_bf16 v[100:103], v[76:79], a[36:39], v[100:103]
    v_cvt_pk_bf16_f32 v104, v88, v89
    v_mfma_f32_16x16x32_bf16 v[100:103], v[72:75], a[32:35], v[100:103]
    v_exp_f32 v92, v92
    s_waitcnt lgkmcnt(0)
    v_mfma_f32_16x16x32_bf16 v[144:147], v[112:115], v[108:111], v[144:147]
    buffer_load_dwordx4 v26, s[16:19], s28 offen lds
    v_exp_f32 v93, v93
    v_mfma_f32_16x16x32_bf16 v[172:175], v[116:119], v[108:111], v[172:175]
    v_add_f32 v14, v14, v90
    v_add_f32 v15, v15, v91
    v_mfma_f32_16x16x32_bf16 v[200:203], v[120:123], v[108:111], v[200:203]
    s_add_u32 m0, m0, s53
    v_cvt_pk_bf16_f32 v105, v90, v91
    v_mfma_f32_16x16x32_bf16 v[228:231], v[124:127], v[108:111], v[228:231]
    v_exp_f32 v94, v94
    v_mfma_f32_16x16x32_bf16 a[112:115], v[128:131], v[108:111], a[112:115]
    s_add_u32 s28, s49, s89
    v_exp_f32 v95, v95
    v_mfma_f32_16x16x32_bf16 a[140:143], v[132:135], v[108:111], a[140:143]
    v_add_f32 v14, v14, v92
    v_add_f32 v15, v15, v93
    v_mfma_f32_16x16x32_bf16 a[168:171], v[136:139], v[108:111], a[168:171]
    buffer_load_dwordx4 v26, s[16:19], s28 offen lds
    v_cvt_pk_bf16_f32 v106, v92, v93
    v_add_f32 v14, v14, v94
    v_mfma_f32_16x16x32_bf16 a[196:199], v[140:143], v[108:111], a[196:199]
    v_add_f32 v15, v15, v95
    v_cvt_pk_bf16_f32 v107, v94, v95
    v_mfma_f32_16x16x32_bf16 v[88:91], v[56:59], a[48:51], v[40:43]
    v_mfma_f32_16x16x32_bf16 v[88:91], v[60:63], a[52:55], v[88:91]
    s_add_u32 m0, m0, s53
    v_exp_f32 v96, v96
    v_mfma_f32_16x16x32_bf16 v[88:91], v[64:67], a[56:59], v[88:91]
    v_exp_f32 v97, v97
    v_mfma_f32_16x16x32_bf16 v[88:91], v[68:71], a[60:63], v[88:91]
    s_add_u32 s28, s49, s90
    v_exp_f32 v98, v98
    v_mfma_f32_16x16x32_bf16 v[92:95], v[84:87], a[60:63], v[40:43]
    v_exp_f32 v99, v99
    v_mfma_f32_16x16x32_bf16 v[92:95], v[80:83], a[56:59], v[92:95]
    buffer_load_dwordx4 v26, s[16:19], s28 offen lds
    v_add_f32 v16, v16, v96
    v_add_f32 v17, v17, v97
    v_mfma_f32_16x16x32_bf16 v[92:95], v[76:79], a[52:55], v[92:95]
    v_cvt_pk_bf16_f32 v108, v96, v97
    v_mfma_f32_16x16x32_bf16 v[92:95], v[72:75], a[48:51], v[92:95]
    v_exp_f32 v100, v100
    v_mfma_f32_16x16x32_bf16 v[148:151], v[112:115], v[104:107], v[148:151]
    s_add_u32 m0, m0, s53
    v_exp_f32 v101, v101
    v_mfma_f32_16x16x32_bf16 v[176:179], v[116:119], v[104:107], v[176:179]
    v_add_f32 v16, v16, v98
    v_add_f32 v17, v17, v99
    v_mfma_f32_16x16x32_bf16 v[204:207], v[120:123], v[104:107], v[204:207]
    s_add_u32 s28, s49, s91
    v_cvt_pk_bf16_f32 v109, v98, v99
    v_mfma_f32_16x16x32_bf16 v[232:235], v[124:127], v[104:107], v[232:235]
    v_exp_f32 v102, v102
    v_mfma_f32_16x16x32_bf16 a[116:119], v[128:131], v[104:107], a[116:119]
    buffer_load_dwordx4 v26, s[16:19], s28 offen lds
    v_exp_f32 v103, v103
    v_mfma_f32_16x16x32_bf16 a[144:147], v[132:135], v[104:107], a[144:147]
    v_add_f32 v16, v16, v100
    v_add_f32 v17, v17, v101
    v_mfma_f32_16x16x32_bf16 a[172:175], v[136:139], v[104:107], a[172:175]
    s_add_u32 m0, m0, s53
    v_cvt_pk_bf16_f32 v110, v100, v101
    v_add_f32 v16, v16, v102
    v_mfma_f32_16x16x32_bf16 a[200:203], v[140:143], v[104:107], a[200:203]
    v_add_f32 v17, v17, v103
    v_cvt_pk_bf16_f32 v111, v102, v103
    v_mfma_f32_16x16x32_bf16 v[96:99], v[56:59], a[64:67], v[44:47]
    v_mfma_f32_16x16x32_bf16 v[96:99], v[60:63], a[68:71], v[96:99]
    s_add_u32 s28, s49, s92
    v_exp_f32 v88, v88
    v_mfma_f32_16x16x32_bf16 v[96:99], v[64:67], a[72:75], v[96:99]
    v_exp_f32 v89, v89
    v_mfma_f32_16x16x32_bf16 v[96:99], v[68:71], a[76:79], v[96:99]
    buffer_load_dwordx4 v26, s[16:19], s28 offen lds
    v_exp_f32 v90, v90
    v_mfma_f32_16x16x32_bf16 v[100:103], v[84:87], a[76:79], v[44:47]
    v_exp_f32 v91, v91
    v_mfma_f32_16x16x32_bf16 v[100:103], v[80:83], a[72:75], v[100:103]
    s_add_u32 m0, m0, s53
    v_add_f32 v18, v18, v88
    v_add_f32 v19, v19, v89
    v_mfma_f32_16x16x32_bf16 v[100:103], v[76:79], a[68:71], v[100:103]
    v_cvt_pk_bf16_f32 v104, v88, v89
    v_mfma_f32_16x16x32_bf16 v[100:103], v[72:75], a[64:67], v[100:103]
    v_exp_f32 v92, v92
    v_mfma_f32_16x16x32_bf16 v[152:155], v[112:115], v[108:111], v[152:155]
    s_add_u32 s28, s49, s93
    v_exp_f32 v93, v93
    v_mfma_f32_16x16x32_bf16 v[180:183], v[116:119], v[108:111], v[180:183]
    v_add_f32 v18, v18, v90
    v_add_f32 v19, v19, v91
    v_mfma_f32_16x16x32_bf16 v[208:211], v[120:123], v[108:111], v[208:211]
    buffer_load_dwordx4 v26, s[16:19], s28 offen lds
    v_cvt_pk_bf16_f32 v105, v90, v91
    v_mfma_f32_16x16x32_bf16 v[236:239], v[124:127], v[108:111], v[236:239]
    v_exp_f32 v94, v94
    v_mfma_f32_16x16x32_bf16 a[120:123], v[128:131], v[108:111], a[120:123]
    s_add_u32 m0, m0, s53
    v_exp_f32 v95, v95
    v_mfma_f32_16x16x32_bf16 a[148:151], v[132:135], v[108:111], a[148:151]
    v_add_f32 v18, v18, v92
    v_add_f32 v19, v19, v93
    v_mfma_f32_16x16x32_bf16 a[176:179], v[136:139], v[108:111], a[176:179]
    s_add_u32 s28, s49, s94
    v_cvt_pk_bf16_f32 v106, v92, v93
    v_add_f32 v18, v18, v94
    v_mfma_f32_16x16x32_bf16 a[204:207], v[140:143], v[108:111], a[204:207]
    v_add_f32 v19, v19, v95
    v_cvt_pk_bf16_f32 v107, v94, v95
    v_mfma_f32_16x16x32_bf16 v[88:91], v[56:59], a[80:83], v[48:51]
    v_mfma_f32_16x16x32_bf16 v[88:91], v[60:63], a[84:87], v[88:91]
    buffer_load_dwordx4 v26, s[16:19], s28 offen lds
    v_exp_f32 v96, v96
    v_mfma_f32_16x16x32_bf16 v[88:91], v[64:67], a[88:91], v[88:91]
    v_exp_f32 v97, v97
    v_mfma_f32_16x16x32_bf16 v[88:91], v[68:71], a[92:95], v[88:91]
    s_add_u32 m0, m0, s53
    v_exp_f32 v98, v98
    v_mfma_f32_16x16x32_bf16 v[92:95], v[84:87], a[92:95], v[48:51]
    v_exp_f32 v99, v99
    v_mfma_f32_16x16x32_bf16 v[92:95], v[80:83], a[88:91], v[92:95]
    s_add_u32 s28, s49, s95
    v_add_f32 v20, v20, v96
    v_add_f32 v21, v21, v97
    v_mfma_f32_16x16x32_bf16 v[92:95], v[76:79], a[84:87], v[92:95]
    v_cvt_pk_bf16_f32 v108, v96, v97
    v_mfma_f32_16x16x32_bf16 v[92:95], v[72:75], a[80:83], v[92:95]
    v_exp_f32 v100, v100
    v_mfma_f32_16x16x32_bf16 v[156:159], v[112:115], v[104:107], v[156:159]
    buffer_load_dwordx4 v26, s[16:19], s28 offen lds
    v_exp_f32 v101, v101
    v_mfma_f32_16x16x32_bf16 v[184:187], v[116:119], v[104:107], v[184:187]
    v_add_f32 v20, v20, v98
    v_add_f32 v21, v21, v99
    v_mfma_f32_16x16x32_bf16 v[212:215], v[120:123], v[104:107], v[212:215]
    v_cvt_pk_bf16_f32 v109, v98, v99
    v_mfma_f32_16x16x32_bf16 v[240:243], v[124:127], v[104:107], v[240:243]
    v_exp_f32 v102, v102
    v_mfma_f32_16x16x32_bf16 a[124:127], v[128:131], v[104:107], a[124:127]
    v_exp_f32 v103, v103
    v_mfma_f32_16x16x32_bf16 a[152:155], v[132:135], v[104:107], a[152:155]
    v_add_f32 v20, v20, v100
    v_add_f32 v21, v21, v101
    v_mfma_f32_16x16x32_bf16 a[180:183], v[136:139], v[104:107], a[180:183]
    v_cvt_pk_bf16_f32 v110, v100, v101
    v_add_f32 v20, v20, v102
    v_mfma_f32_16x16x32_bf16 a[208:211], v[140:143], v[104:107], a[208:211]
    v_add_f32 v21, v21, v103
    v_cvt_pk_bf16_f32 v111, v102, v103
    s_waitcnt vmcnt(16) lgkmcnt(0)
    s_barrier
    v_mfma_f32_16x16x32_bf16 v[96:99], v[56:59], a[96:99], v[52:55]
    ds_read_b128 v[56:59], v8 offset:16896
    v_mfma_f32_16x16x32_bf16 v[96:99], v[60:63], a[100:103], v[96:99]
    ds_read_b128 v[60:63], v8 offset:16960
    v_exp_f32 v88, v88
    v_mfma_f32_16x16x32_bf16 v[96:99], v[64:67], a[104:107], v[96:99]
    ds_read_b128 v[64:67], v8 offset:17024
    v_exp_f32 v89, v89
    v_mfma_f32_16x16x32_bf16 v[96:99], v[68:71], a[108:111], v[96:99]
    ds_read_b128 v[68:71], v8 offset:17088
    v_exp_f32 v90, v90
    v_mfma_f32_16x16x32_bf16 v[100:103], v[84:87], a[108:111], v[52:55]
    ds_read_b128 v[84:87], v8 offset:17600
    v_exp_f32 v91, v91
    v_mfma_f32_16x16x32_bf16 v[100:103], v[80:83], a[104:107], v[100:103]
    ds_read_b128 v[80:83], v8 offset:17536
    v_add_f32 v22, v22, v88
    v_add_f32 v23, v23, v89
    v_mfma_f32_16x16x32_bf16 v[100:103], v[76:79], a[100:103], v[100:103]
    ds_read_b128 v[76:79], v8 offset:17472
    v_cvt_pk_bf16_f32 v104, v88, v89
    v_mfma_f32_16x16x32_bf16 v[100:103], v[72:75], a[96:99], v[100:103]
    ds_read_b128 v[72:75], v8 offset:17408
    v_exp_f32 v92, v92
    v_mfma_f32_16x16x32_bf16 v[160:163], v[112:115], v[108:111], v[160:163]
    v_exp_f32 v93, v93
    v_mfma_f32_16x16x32_bf16 v[188:191], v[116:119], v[108:111], v[188:191]
    v_add_f32 v22, v22, v90
    v_add_f32 v23, v23, v91
    v_mfma_f32_16x16x32_bf16 v[216:219], v[120:123], v[108:111], v[216:219]
    v_cvt_pk_bf16_f32 v105, v90, v91
    v_mfma_f32_16x16x32_bf16 v[244:247], v[124:127], v[108:111], v[244:247]
    v_exp_f32 v94, v94
    v_mfma_f32_16x16x32_bf16 a[128:131], v[128:131], v[108:111], a[128:131]
    v_exp_f32 v95, v95
    v_mfma_f32_16x16x32_bf16 a[156:159], v[132:135], v[108:111], a[156:159]
    v_add_f32 v22, v22, v92
    v_add_f32 v23, v23, v93
    v_mfma_f32_16x16x32_bf16 a[184:187], v[136:139], v[108:111], a[184:187]
    v_cvt_pk_bf16_f32 v106, v92, v93
    v_add_f32 v22, v22, v94
    v_mfma_f32_16x16x32_bf16 a[212:215], v[140:143], v[108:111], a[212:215]
    v_add_f32 v23, v23, v95
    v_cvt_pk_bf16_f32 v107, v94, v95
    s_waitcnt lgkmcnt(0)
    v_mfma_f32_16x16x32_bf16 v[88:91], v[56:59], a[0:3], v[28:31]
    v_mfma_f32_16x16x32_bf16 v[88:91], v[60:63], a[4:7], v[88:91]
    v_exp_f32 v96, v96
    v_mfma_f32_16x16x32_bf16 v[88:91], v[64:67], a[8:11], v[88:91]
    v_exp_f32 v97, v97
    v_mfma_f32_16x16x32_bf16 v[88:91], v[68:71], a[12:15], v[88:91]
    v_exp_f32 v98, v98
    v_mfma_f32_16x16x32_bf16 v[92:95], v[84:87], a[12:15], v[28:31]
    v_exp_f32 v99, v99
    v_mfma_f32_16x16x32_bf16 v[92:95], v[80:83], a[8:11], v[92:95]
    v_add_f32 v24, v24, v96
    v_add_f32 v25, v25, v97
    v_mfma_f32_16x16x32_bf16 v[92:95], v[76:79], a[4:7], v[92:95]
    v_cvt_pk_bf16_f32 v108, v96, v97
    v_mfma_f32_16x16x32_bf16 v[92:95], v[72:75], a[0:3], v[92:95]
    v_exp_f32 v100, v100
    v_mfma_f32_16x16x32_bf16 v[164:167], v[112:115], v[104:107], v[164:167]
    v_exp_f32 v101, v101
    v_mfma_f32_16x16x32_bf16 v[192:195], v[116:119], v[104:107], v[192:195]
    v_add_f32 v24, v24, v98
    v_add_f32 v25, v25, v99
    v_mfma_f32_16x16x32_bf16 v[220:223], v[120:123], v[104:107], v[220:223]
    v_cvt_pk_bf16_f32 v109, v98, v99
    v_mfma_f32_16x16x32_bf16 v[248:251], v[124:127], v[104:107], v[248:251]
    v_exp_f32 v102, v102
    v_mfma_f32_16x16x32_bf16 a[132:135], v[128:131], v[104:107], a[132:135]
    v_exp_f32 v103, v103
    v_mfma_f32_16x16x32_bf16 a[160:163], v[132:135], v[104:107], a[160:163]
    v_add_f32 v24, v24, v100
    v_add_f32 v25, v25, v101
    v_mfma_f32_16x16x32_bf16 a[188:191], v[136:139], v[104:107], a[188:191]
    v_cvt_pk_bf16_f32 v110, v100, v101
    v_add_f32 v24, v24, v102
    v_mfma_f32_16x16x32_bf16 a[216:219], v[140:143], v[104:107], a[216:219]
    v_add_f32 v25, v25, v103
    v_cvt_pk_bf16_f32 v111, v102, v103
    v_mfma_f32_16x16x32_bf16 v[96:99], v[56:59], a[16:19], v[32:35]
    v_mfma_f32_16x16x32_bf16 v[96:99], v[60:63], a[20:23], v[96:99]
    v_exp_f32 v88, v88
    v_mfma_f32_16x16x32_bf16 v[96:99], v[64:67], a[24:27], v[96:99]
    v_exp_f32 v89, v89
    v_mfma_f32_16x16x32_bf16 v[96:99], v[68:71], a[28:31], v[96:99]
    v_exp_f32 v90, v90
    v_mfma_f32_16x16x32_bf16 v[100:103], v[84:87], a[28:31], v[32:35]
    v_exp_f32 v91, v91
    v_mfma_f32_16x16x32_bf16 v[100:103], v[80:83], a[24:27], v[100:103]
    v_add_f32 v12, v12, v88
    v_add_f32 v13, v13, v89
    v_mfma_f32_16x16x32_bf16 v[100:103], v[76:79], a[20:23], v[100:103]
    v_cvt_pk_bf16_f32 v104, v88, v89
    v_mfma_f32_16x16x32_bf16 v[100:103], v[72:75], a[16:19], v[100:103]
    v_exp_f32 v92, v92
    v_mfma_f32_16x16x32_bf16 v[168:171], v[112:115], v[108:111], v[168:171]
    ds_read_b64_tr_b16 v[112:113], v9 offset:16896
    ds_read_b64_tr_b16 v[114:115], v9 offset:17408
    v_exp_f32 v93, v93
    v_mfma_f32_16x16x32_bf16 v[196:199], v[116:119], v[108:111], v[196:199]
    ds_read_b64_tr_b16 v[116:117], v9 offset:16928
    ds_read_b64_tr_b16 v[118:119], v9 offset:17440
    v_add_f32 v12, v12, v90
    v_add_f32 v13, v13, v91
    v_mfma_f32_16x16x32_bf16 v[224:227], v[120:123], v[108:111], v[224:227]
    ds_read_b64_tr_b16 v[120:121], v9 offset:16960
    ds_read_b64_tr_b16 v[122:123], v9 offset:17472
    v_cvt_pk_bf16_f32 v105, v90, v91
    v_mfma_f32_16x16x32_bf16 v[252:255], v[124:127], v[108:111], v[252:255]
    ds_read_b64_tr_b16 v[124:125], v9 offset:16992
    ds_read_b64_tr_b16 v[126:127], v9 offset:17504
    v_exp_f32 v94, v94
    v_mfma_f32_16x16x32_bf16 a[136:139], v[128:131], v[108:111], a[136:139]
    ds_read_b64_tr_b16 v[128:129], v9 offset:17024
    ds_read_b64_tr_b16 v[130:131], v9 offset:17536
    v_exp_f32 v95, v95
    v_mfma_f32_16x16x32_bf16 a[164:167], v[132:135], v[108:111], a[164:167]
    ds_read_b64_tr_b16 v[132:133], v9 offset:17056
    ds_read_b64_tr_b16 v[134:135], v9 offset:17568
    v_add_f32 v12, v12, v92
    v_add_f32 v13, v13, v93
    v_mfma_f32_16x16x32_bf16 a[192:195], v[136:139], v[108:111], a[192:195]
    ds_read_b64_tr_b16 v[136:137], v9 offset:17088
    ds_read_b64_tr_b16 v[138:139], v9 offset:17600
    v_cvt_pk_bf16_f32 v106, v92, v93
    v_add_f32 v12, v12, v94
    v_mfma_f32_16x16x32_bf16 a[220:223], v[140:143], v[108:111], a[220:223]
    ds_read_b64_tr_b16 v[140:141], v9 offset:17120
    ds_read_b64_tr_b16 v[142:143], v9 offset:17632
    v_add_f32 v13, v13, v95
    v_cvt_pk_bf16_f32 v107, v94, v95
    v_mfma_f32_16x16x32_bf16 v[88:91], v[56:59], a[32:35], v[36:39]
    v_mfma_f32_16x16x32_bf16 v[88:91], v[60:63], a[36:39], v[88:91]
    s_add_u32 m0, s33, 8448
    v_exp_f32 v96, v96
    v_mfma_f32_16x16x32_bf16 v[88:91], v[64:67], a[40:43], v[88:91]
    v_exp_f32 v97, v97
    v_mfma_f32_16x16x32_bf16 v[88:91], v[68:71], a[44:47], v[88:91]
    s_add_u32 s49, s50, s46
    v_exp_f32 v98, v98
    v_mfma_f32_16x16x32_bf16 v[92:95], v[84:87], a[44:47], v[36:39]
    v_exp_f32 v99, v99
    v_mfma_f32_16x16x32_bf16 v[92:95], v[80:83], a[40:43], v[92:95]
    s_lshl1_add_u32 s50, s51, s50
    v_add_f32 v14, v14, v96
    v_add_f32 v15, v15, v97
    v_mfma_f32_16x16x32_bf16 v[92:95], v[76:79], a[36:39], v[92:95]
    v_cvt_pk_bf16_f32 v108, v96, v97
    v_mfma_f32_16x16x32_bf16 v[92:95], v[72:75], a[32:35], v[92:95]
    s_add_u32 s82, s82, 2
    v_exp_f32 v100, v100
    s_waitcnt lgkmcnt(0)
    v_mfma_f32_16x16x32_bf16 v[144:147], v[112:115], v[104:107], v[144:147]
    v_exp_f32 v101, v101
    v_mfma_f32_16x16x32_bf16 v[172:175], v[116:119], v[104:107], v[172:175]
    s_cmp_eq_u32 s82, 20
    v_add_f32 v14, v14, v98
    v_add_f32 v15, v15, v99
    v_mfma_f32_16x16x32_bf16 v[200:203], v[120:123], v[104:107], v[200:203]
    v_cvt_pk_bf16_f32 v109, v98, v99
    v_mfma_f32_16x16x32_bf16 v[228:231], v[124:127], v[104:107], v[228:231]
    s_cselect_b32 s29, s83, 0
    v_exp_f32 v102, v102
    v_mfma_f32_16x16x32_bf16 a[112:115], v[128:131], v[104:107], a[112:115]
    v_exp_f32 v103, v103
    v_mfma_f32_16x16x32_bf16 a[140:143], v[132:135], v[104:107], a[140:143]
    s_sub_u32 s50, s50, s29
    v_add_f32 v14, v14, v100
    v_add_f32 v15, v15, v101
    v_mfma_f32_16x16x32_bf16 a[168:171], v[136:139], v[104:107], a[168:171]
    v_cvt_pk_bf16_f32 v110, v100, v101
    v_add_f32 v14, v14, v102
    v_mfma_f32_16x16x32_bf16 a[196:199], v[140:143], v[104:107], a[196:199]
    s_add_u32 s28, s49, s88
    v_add_f32 v15, v15, v103
    v_cvt_pk_bf16_f32 v111, v102, v103
    v_mfma_f32_16x16x32_bf16 v[96:99], v[56:59], a[48:51], v[40:43]
    v_mfma_f32_16x16x32_bf16 v[96:99], v[60:63], a[52:55], v[96:99]
    buffer_load_dwordx4 v26, s[16:19], s28 offen lds
    v_exp_f32 v88, v88
    v_mfma_f32_16x16x32_bf16 v[96:99], v[64:67], a[56:59], v[96:99]
    v_exp_f32 v89, v89
    v_mfma_f32_16x16x32_bf16 v[96:99], v[68:71], a[60:63], v[96:99]
    s_add_u32 m0, m0, s53
    v_exp_f32 v90, v90
    v_mfma_f32_16x16x32_bf16 v[100:103], v[84:87], a[60:63], v[40:43]
    v_exp_f32 v91, v91
    v_mfma_f32_16x16x32_bf16 v[100:103], v[80:83], a[56:59], v[100:103]
    s_add_u32 s28, s49, s89
    v_add_f32 v16, v16, v88
    v_add_f32 v17, v17, v89
    v_mfma_f32_16x16x32_bf16 v[100:103], v[76:79], a[52:55], v[100:103]
    v_cvt_pk_bf16_f32 v104, v88, v89
    v_mfma_f32_16x16x32_bf16 v[100:103], v[72:75], a[48:51], v[100:103]
    buffer_load_dwordx4 v26, s[16:19], s28 offen lds
    v_exp_f32 v92, v92
    v_mfma_f32_16x16x32_bf16 v[148:151], v[112:115], v[108:111], v[148:151]
    v_exp_f32 v93, v93
    v_mfma_f32_16x16x32_bf16 v[176:179], v[116:119], v[108:111], v[176:179]
    s_add_u32 m0, m0, s53
    v_add_f32 v16, v16, v90
    v_add_f32 v17, v17, v91
    v_mfma_f32_16x16x32_bf16 v[204:207], v[120:123], v[108:111], v[204:207]
    v_cvt_pk_bf16_f32 v105, v90, v91
    v_mfma_f32_16x16x32_bf16 v[232:235], v[124:127], v[108:111], v[232:235]
    s_add_u32 s28, s49, s90
    v_exp_f32 v94, v94
    v_mfma_f32_16x16x32_bf16 a[116:119], v[128:131], v[108:111], a[116:119]
    v_exp_f32 v95, v95
    v_mfma_f32_16x16x32_bf16 a[144:147], v[132:135], v[108:111], a[144:147]
    buffer_load_dwordx4 v26, s[16:19], s28 offen lds
    v_add_f32 v16, v16, v92
    v_add_f32 v17, v17, v93
    v_mfma_f32_16x16x32_bf16 a[172:175], v[136:139], v[108:111], a[172:175]
    v_cvt_pk_bf16_f32 v106, v92, v93
    v_add_f32 v16, v16, v94
    v_mfma_f32_16x16x32_bf16 a[200:203], v[140:143], v[108:111], a[200:203]
    s_add_u32 m0, m0, s53
    v_add_f32 v17, v17, v95
    v_cvt_pk_bf16_f32 v107, v94, v95
    v_mfma_f32_16x16x32_bf16 v[88:91], v[56:59], a[64:67], v[44:47]
    v_mfma_f32_16x16x32_bf16 v[88:91], v[60:63], a[68:71], v[88:91]
    s_add_u32 s28, s49, s91
    v_exp_f32 v96, v96
    v_mfma_f32_16x16x32_bf16 v[88:91], v[64:67], a[72:75], v[88:91]
    v_exp_f32 v97, v97
    v_mfma_f32_16x16x32_bf16 v[88:91], v[68:71], a[76:79], v[88:91]
    buffer_load_dwordx4 v26, s[16:19], s28 offen lds
    v_exp_f32 v98, v98
    v_mfma_f32_16x16x32_bf16 v[92:95], v[84:87], a[76:79], v[44:47]
    v_exp_f32 v99, v99
    v_mfma_f32_16x16x32_bf16 v[92:95], v[80:83], a[72:75], v[92:95]
    s_add_u32 m0, m0, s53
    v_add_f32 v18, v18, v96
    v_add_f32 v19, v19, v97
    v_mfma_f32_16x16x32_bf16 v[92:95], v[76:79], a[68:71], v[92:95]
    v_cvt_pk_bf16_f32 v108, v96, v97
    v_mfma_f32_16x16x32_bf16 v[92:95], v[72:75], a[64:67], v[92:95]
    s_add_u32 s28, s49, s92
    v_exp_f32 v100, v100
    v_mfma_f32_16x16x32_bf16 v[152:155], v[112:115], v[104:107], v[152:155]
    v_exp_f32 v101, v101
    v_mfma_f32_16x16x32_bf16 v[180:183], v[116:119], v[104:107], v[180:183]
    buffer_load_dwordx4 v26, s[16:19], s28 offen lds
    v_add_f32 v18, v18, v98
    v_add_f32 v19, v19, v99
    v_mfma_f32_16x16x32_bf16 v[208:211], v[120:123], v[104:107], v[208:211]
    v_cvt_pk_bf16_f32 v109, v98, v99
    v_mfma_f32_16x16x32_bf16 v[236:239], v[124:127], v[104:107], v[236:239]
    s_add_u32 m0, m0, s53
    v_exp_f32 v102, v102
    v_mfma_f32_16x16x32_bf16 a[120:123], v[128:131], v[104:107], a[120:123]
    v_exp_f32 v103, v103
    v_mfma_f32_16x16x32_bf16 a[148:151], v[132:135], v[104:107], a[148:151]
    s_add_u32 s28, s49, s93
    v_add_f32 v18, v18, v100
    v_add_f32 v19, v19, v101
    v_mfma_f32_16x16x32_bf16 a[176:179], v[136:139], v[104:107], a[176:179]
    v_cvt_pk_bf16_f32 v110, v100, v101
    v_add_f32 v18, v18, v102
    v_mfma_f32_16x16x32_bf16 a[204:207], v[140:143], v[104:107], a[204:207]
    buffer_load_dwordx4 v26, s[16:19], s28 offen lds
    v_add_f32 v19, v19, v103
    v_cvt_pk_bf16_f32 v111, v102, v103
    v_mfma_f32_16x16x32_bf16 v[96:99], v[56:59], a[80:83], v[48:51]
    v_mfma_f32_16x16x32_bf16 v[96:99], v[60:63], a[84:87], v[96:99]
    s_add_u32 m0, m0, s53
    v_exp_f32 v88, v88
    v_mfma_f32_16x16x32_bf16 v[96:99], v[64:67], a[88:91], v[96:99]
    v_exp_f32 v89, v89
    v_mfma_f32_16x16x32_bf16 v[96:99], v[68:71], a[92:95], v[96:99]
    s_add_u32 s28, s49, s94
    v_exp_f32 v90, v90
    v_mfma_f32_16x16x32_bf16 v[100:103], v[84:87], a[92:95], v[48:51]
    v_exp_f32 v91, v91
    v_mfma_f32_16x16x32_bf16 v[100:103], v[80:83], a[88:91], v[100:103]
    buffer_load_dwordx4 v26, s[16:19], s28 offen lds
    v_add_f32 v20, v20, v88
    v_add_f32 v21, v21, v89
    v_mfma_f32_16x16x32_bf16 v[100:103], v[76:79], a[84:87], v[100:103]
    v_cvt_pk_bf16_f32 v104, v88, v89
    v_mfma_f32_16x16x32_bf16 v[100:103], v[72:75], a[80:83], v[100:103]
    s_add_u32 m0, m0, s53
    v_exp_f32 v92, v92
    v_mfma_f32_16x16x32_bf16 v[156:159], v[112:115], v[108:111], v[156:159]
    v_exp_f32 v93, v93
    v_mfma_f32_16x16x32_bf16 v[184:187], v[116:119], v[108:111], v[184:187]
    s_add_u32 s28, s49, s95
    v_add_f32 v20, v20, v90
    v_add_f32 v21, v21, v91
    v_mfma_f32_16x16x32_bf16 v[212:215], v[120:123], v[108:111], v[212:215]
    v_cvt_pk_bf16_f32 v105, v90, v91
    v_mfma_f32_16x16x32_bf16 v[240:243], v[124:127], v[108:111], v[240:243]
    buffer_load_dwordx4 v26, s[16:19], s28 offen lds
    v_exp_f32 v94, v94
    v_mfma_f32_16x16x32_bf16 a[124:127], v[128:131], v[108:111], a[124:127]
    v_exp_f32 v95, v95
    v_mfma_f32_16x16x32_bf16 a[152:155], v[132:135], v[108:111], a[152:155]
    v_add_f32 v20, v20, v92
    v_add_f32 v21, v21, v93
    v_mfma_f32_16x16x32_bf16 a[180:183], v[136:139], v[108:111], a[180:183]
    v_cvt_pk_bf16_f32 v106, v92, v93
    v_add_f32 v20, v20, v94
    v_mfma_f32_16x16x32_bf16 a[208:211], v[140:143], v[108:111], a[208:211]
    v_add_f32 v21, v21, v95
    v_cvt_pk_bf16_f32 v107, v94, v95
    s_waitcnt vmcnt(16) lgkmcnt(0)
    s_barrier
    v_mfma_f32_16x16x32_bf16 v[88:91], v[56:59], a[96:99], v[52:55]
    ds_read_b128 v[56:59], v8 offset:25344
    v_mfma_f32_16x16x32_bf16 v[88:91], v[60:63], a[100:103], v[88:91]
    ds_read_b128 v[60:63], v8 offset:25408
    v_exp_f32 v96, v96
    v_mfma_f32_16x16x32_bf16 v[88:91], v[64:67], a[104:107], v[88:91]
    ds_read_b128 v[64:67], v8 offset:25472
    v_exp_f32 v97, v97
    v_mfma_f32_16x16x32_bf16 v[88:91], v[68:71], a[108:111], v[88:91]
    ds_read_b128 v[68:71], v8 offset:25536
    v_exp_f32 v98, v98
    v_mfma_f32_16x16x32_bf16 v[92:95], v[84:87], a[108:111], v[52:55]
    ds_read_b128 v[84:87], v8 offset:26048
    v_exp_f32 v99, v99
    v_mfma_f32_16x16x32_bf16 v[92:95], v[80:83], a[104:107], v[92:95]
    ds_read_b128 v[80:83], v8 offset:25984
    v_add_f32 v22, v22, v96
    v_add_f32 v23, v23, v97
    v_mfma_f32_16x16x32_bf16 v[92:95], v[76:79], a[100:103], v[92:95]
    ds_read_b128 v[76:79], v8 offset:25920
    v_cvt_pk_bf16_f32 v108, v96, v97
    v_mfma_f32_16x16x32_bf16 v[92:95], v[72:75], a[96:99], v[92:95]
    ds_read_b128 v[72:75], v8 offset:25856
    v_exp_f32 v100, v100
    v_mfma_f32_16x16x32_bf16 v[160:163], v[112:115], v[104:107], v[160:163]
    v_exp_f32 v101, v101
    v_mfma_f32_16x16x32_bf16 v[188:191], v[116:119], v[104:107], v[188:191]
    v_add_f32 v22, v22, v98
    v_add_f32 v23, v23, v99
    v_mfma_f32_16x16x32_bf16 v[216:219], v[120:123], v[104:107], v[216:219]
    v_cvt_pk_bf16_f32 v109, v98, v99
    v_mfma_f32_16x16x32_bf16 v[244:247], v[124:127], v[104:107], v[244:247]
    v_exp_f32 v102, v102
    v_mfma_f32_16x16x32_bf16 a[128:131], v[128:131], v[104:107], a[128:131]
    v_exp_f32 v103, v103
    v_mfma_f32_16x16x32_bf16 a[156:159], v[132:135], v[104:107], a[156:159]
    v_add_f32 v22, v22, v100
    v_add_f32 v23, v23, v101
    v_mfma_f32_16x16x32_bf16 a[184:187], v[136:139], v[104:107], a[184:187]
    v_cvt_pk_bf16_f32 v110, v100, v101
    v_add_f32 v22, v22, v102
    v_mfma_f32_16x16x32_bf16 a[212:215], v[140:143], v[104:107], a[212:215]
    v_add_f32 v23, v23, v103
    v_cvt_pk_bf16_f32 v111, v102, v103
    s_waitcnt lgkmcnt(0)
    v_mfma_f32_16x16x32_bf16 v[96:99], v[56:59], a[0:3], v[28:31]
    v_mfma_f32_16x16x32_bf16 v[96:99], v[60:63], a[4:7], v[96:99]
    v_exp_f32 v88, v88
    v_mfma_f32_16x16x32_bf16 v[96:99], v[64:67], a[8:11], v[96:99]
    v_exp_f32 v89, v89
    v_mfma_f32_16x16x32_bf16 v[96:99], v[68:71], a[12:15], v[96:99]
    v_exp_f32 v90, v90
    v_mfma_f32_16x16x32_bf16 v[100:103], v[84:87], a[12:15], v[28:31]
    v_exp_f32 v91, v91
    v_mfma_f32_16x16x32_bf16 v[100:103], v[80:83], a[8:11], v[100:103]
    v_add_f32 v24, v24, v88
    v_add_f32 v25, v25, v89
    v_mfma_f32_16x16x32_bf16 v[100:103], v[76:79], a[4:7], v[100:103]
    v_cvt_pk_bf16_f32 v104, v88, v89
    v_mfma_f32_16x16x32_bf16 v[100:103], v[72:75], a[0:3], v[100:103]
    v_exp_f32 v92, v92
    v_mfma_f32_16x16x32_bf16 v[164:167], v[112:115], v[108:111], v[164:167]
    v_exp_f32 v93, v93
    v_mfma_f32_16x16x32_bf16 v[192:195], v[116:119], v[108:111], v[192:195]
    v_add_f32 v24, v24, v90
    v_add_f32 v25, v25, v91
    v_mfma_f32_16x16x32_bf16 v[220:223], v[120:123], v[108:111], v[220:223]
    v_cvt_pk_bf16_f32 v105, v90, v91
    v_mfma_f32_16x16x32_bf16 v[248:251], v[124:127], v[108:111], v[248:251]
    v_exp_f32 v94, v94
    v_mfma_f32_16x16x32_bf16 a[132:135], v[128:131], v[108:111], a[132:135]
    v_exp_f32 v95, v95
    v_mfma_f32_16x16x32_bf16 a[160:163], v[132:135], v[108:111], a[160:163]
    v_add_f32 v24, v24, v92
    v_add_f32 v25, v25, v93
    v_mfma_f32_16x16x32_bf16 a[188:191], v[136:139], v[108:111], a[188:191]
    v_cvt_pk_bf16_f32 v106, v92, v93
    v_add_f32 v24, v24, v94
    v_mfma_f32_16x16x32_bf16 a[216:219], v[140:143], v[108:111], a[216:219]
    v_add_f32 v25, v25, v95
    v_cvt_pk_bf16_f32 v107, v94, v95
    v_mfma_f32_16x16x32_bf16 v[88:91], v[56:59], a[16:19], v[32:35]
    v_mfma_f32_16x16x32_bf16 v[88:91], v[60:63], a[20:23], v[88:91]
    v_exp_f32 v96, v96
    v_mfma_f32_16x16x32_bf16 v[88:91], v[64:67], a[24:27], v[88:91]
    v_exp_f32 v97, v97
    v_mfma_f32_16x16x32_bf16 v[88:91], v[68:71], a[28:31], v[88:91]
    v_exp_f32 v98, v98
    v_mfma_f32_16x16x32_bf16 v[92:95], v[84:87], a[28:31], v[32:35]
    v_exp_f32 v99, v99
    v_mfma_f32_16x16x32_bf16 v[92:95], v[80:83], a[24:27], v[92:95]
    v_add_f32 v12, v12, v96
    v_add_f32 v13, v13, v97
    v_mfma_f32_16x16x32_bf16 v[92:95], v[76:79], a[20:23], v[92:95]
    v_cvt_pk_bf16_f32 v108, v96, v97
    v_mfma_f32_16x16x32_bf16 v[92:95], v[72:75], a[16:19], v[92:95]
    v_exp_f32 v100, v100
    v_mfma_f32_16x16x32_bf16 v[168:171], v[112:115], v[104:107], v[168:171]
    ds_read_b64_tr_b16 v[112:113], v9 offset:25344
    ds_read_b64_tr_b16 v[114:115], v9 offset:25856
    v_exp_f32 v101, v101
    v_mfma_f32_16x16x32_bf16 v[196:199], v[116:119], v[104:107], v[196:199]
    ds_read_b64_tr_b16 v[116:117], v9 offset:25376
    ds_read_b64_tr_b16 v[118:119], v9 offset:25888
    v_add_f32 v12, v12, v98
    v_add_f32 v13, v13, v99
    v_mfma_f32_16x16x32_bf16 v[224:227], v[120:123], v[104:107], v[224:227]
    ds_read_b64_tr_b16 v[120:121], v9 offset:25408
    ds_read_b64_tr_b16 v[122:123], v9 offset:25920
    v_cvt_pk_bf16_f32 v109, v98, v99
    v_mfma_f32_16x16x32_bf16 v[252:255], v[124:127], v[104:107], v[252:255]
    ds_read_b64_tr_b16 v[124:125], v9 offset:25440
    ds_read_b64_tr_b16 v[126:127], v9 offset:25952
    v_exp_f32 v102, v102
    v_mfma_f32_16x16x32_bf16 a[136:139], v[128:131], v[104:107], a[136:139]
    ds_read_b64_tr_b16 v[128:129], v9 offset:25472
    ds_read_b64_tr_b16 v[130:131], v9 offset:25984
    v_exp_f32 v103, v103
    v_mfma_f32_16x16x32_bf16 a[164:167], v[132:135], v[104:107], a[164:167]
    ds_read_b64_tr_b16 v[132:133], v9 offset:25504
    ds_read_b64_tr_b16 v[134:135], v9 offset:26016
    v_add_f32 v12, v12, v100
    v_add_f32 v13, v13, v101
    v_mfma_f32_16x16x32_bf16 a[192:195], v[136:139], v[104:107], a[192:195]
    ds_read_b64_tr_b16 v[136:137], v9 offset:25536
    ds_read_b64_tr_b16 v[138:139], v9 offset:26048
    v_cvt_pk_bf16_f32 v110, v100, v101
    v_add_f32 v12, v12, v102
    v_mfma_f32_16x16x32_bf16 a[220:223], v[140:143], v[104:107], a[220:223]
    ds_read_b64_tr_b16 v[140:141], v9 offset:25568
    ds_read_b64_tr_b16 v[142:143], v9 offset:26080
    v_add_f32 v13, v13, v103
    v_cvt_pk_bf16_f32 v111, v102, v103
    v_mfma_f32_16x16x32_bf16 v[96:99], v[56:59], a[32:35], v[36:39]
    v_mfma_f32_16x16x32_bf16 v[96:99], v[60:63], a[36:39], v[96:99]
    s_add_u32 m0, s33, 16896
    v_exp_f32 v88, v88
    v_mfma_f32_16x16x32_bf16 v[96:99], v[64:67], a[40:43], v[96:99]
    v_exp_f32 v89, v89
    v_mfma_f32_16x16x32_bf16 v[96:99], v[68:71], a[44:47], v[96:99]
    s_mov_b32 s49, s50
    v_exp_f32 v90, v90
    v_mfma_f32_16x16x32_bf16 v[100:103], v[84:87], a[44:47], v[36:39]
    v_exp_f32 v91, v91
    v_mfma_f32_16x16x32_bf16 v[100:103], v[80:83], a[40:43], v[100:103]
    s_add_u32 s28, s49, s88
    v_add_f32 v14, v14, v88
    v_add_f32 v15, v15, v89
    v_mfma_f32_16x16x32_bf16 v[100:103], v[76:79], a[36:39], v[100:103]
    v_cvt_pk_bf16_f32 v104, v88, v89
    v_mfma_f32_16x16x32_bf16 v[100:103], v[72:75], a[32:35], v[100:103]
    v_exp_f32 v92, v92
    s_waitcnt lgkmcnt(0)
    v_mfma_f32_16x16x32_bf16 v[144:147], v[112:115], v[108:111], v[144:147]
    buffer_load_dwordx4 v26, s[16:19], s28 offen lds
    v_exp_f32 v93, v93
    v_mfma_f32_16x16x32_bf16 v[172:175], v[116:119], v[108:111], v[172:175]
    v_add_f32 v14, v14, v90
    v_add_f32 v15, v15, v91
    v_mfma_f32_16x16x32_bf16 v[200:203], v[120:123], v[108:111], v[200:203]
    s_add_u32 m0, m0, s53
    v_cvt_pk_bf16_f32 v105, v90, v91
    v_mfma_f32_16x16x32_bf16 v[228:231], v[124:127], v[108:111], v[228:231]
    v_exp_f32 v94, v94
    v_mfma_f32_16x16x32_bf16 a[112:115], v[128:131], v[108:111], a[112:115]
    s_add_u32 s28, s49, s89
    v_exp_f32 v95, v95
    v_mfma_f32_16x16x32_bf16 a[140:143], v[132:135], v[108:111], a[140:143]
    v_add_f32 v14, v14, v92
    v_add_f32 v15, v15, v93
    v_mfma_f32_16x16x32_bf16 a[168:171], v[136:139], v[108:111], a[168:171]
    buffer_load_dwordx4 v26, s[16:19], s28 offen lds
    v_cvt_pk_bf16_f32 v106, v92, v93
    v_add_f32 v14, v14, v94
    v_mfma_f32_16x16x32_bf16 a[196:199], v[140:143], v[108:111], a[196:199]
    v_add_f32 v15, v15, v95
    v_cvt_pk_bf16_f32 v107, v94, v95
    v_mfma_f32_16x16x32_bf16 v[88:91], v[56:59], a[48:51], v[40:43]
    v_mfma_f32_16x16x32_bf16 v[88:91], v[60:63], a[52:55], v[88:91]
    s_add_u32 m0, m0, s53
    v_exp_f32 v96, v96
    v_mfma_f32_16x16x32_bf16 v[88:91], v[64:67], a[56:59], v[88:91]
    v_exp_f32 v97, v97
    v_mfma_f32_16x16x32_bf16 v[88:91], v[68:71], a[60:63], v[88:91]
    s_add_u32 s28, s49, s90
    v_exp_f32 v98, v98
    v_mfma_f32_16x16x32_bf16 v[92:95], v[84:87], a[60:63], v[40:43]
    v_exp_f32 v99, v99
    v_mfma_f32_16x16x32_bf16 v[92:95], v[80:83], a[56:59], v[92:95]
    buffer_load_dwordx4 v26, s[16:19], s28 offen lds
    v_add_f32 v16, v16, v96
    v_add_f32 v17, v17, v97
    v_mfma_f32_16x16x32_bf16 v[92:95], v[76:79], a[52:55], v[92:95]
    v_cvt_pk_bf16_f32 v108, v96, v97
    v_mfma_f32_16x16x32_bf16 v[92:95], v[72:75], a[48:51], v[92:95]
    v_exp_f32 v100, v100
    v_mfma_f32_16x16x32_bf16 v[148:151], v[112:115], v[104:107], v[148:151]
    s_add_u32 m0, m0, s53
    v_exp_f32 v101, v101
    v_mfma_f32_16x16x32_bf16 v[176:179], v[116:119], v[104:107], v[176:179]
    v_add_f32 v16, v16, v98
    v_add_f32 v17, v17, v99
    v_mfma_f32_16x16x32_bf16 v[204:207], v[120:123], v[104:107], v[204:207]
    s_add_u32 s28, s49, s91
    v_cvt_pk_bf16_f32 v109, v98, v99
    v_mfma_f32_16x16x32_bf16 v[232:235], v[124:127], v[104:107], v[232:235]
    v_exp_f32 v102, v102
    v_mfma_f32_16x16x32_bf16 a[116:119], v[128:131], v[104:107], a[116:119]
    buffer_load_dwordx4 v26, s[16:19], s28 offen lds
    v_exp_f32 v103, v103
    v_mfma_f32_16x16x32_bf16 a[144:147], v[132:135], v[104:107], a[144:147]
    v_add_f32 v16, v16, v100
    v_add_f32 v17, v17, v101
    v_mfma_f32_16x16x32_bf16 a[172:175], v[136:139], v[104:107], a[172:175]
    s_add_u32 m0, m0, s53
    v_cvt_pk_bf16_f32 v110, v100, v101
    v_add_f32 v16, v16, v102
    v_mfma_f32_16x16x32_bf16 a[200:203], v[140:143], v[104:107], a[200:203]
    v_add_f32 v17, v17, v103
    v_cvt_pk_bf16_f32 v111, v102, v103
    v_mfma_f32_16x16x32_bf16 v[96:99], v[56:59], a[64:67], v[44:47]
    v_mfma_f32_16x16x32_bf16 v[96:99], v[60:63], a[68:71], v[96:99]
    s_add_u32 s28, s49, s92
    v_exp_f32 v88, v88
    v_mfma_f32_16x16x32_bf16 v[96:99], v[64:67], a[72:75], v[96:99]
    v_exp_f32 v89, v89
    v_mfma_f32_16x16x32_bf16 v[96:99], v[68:71], a[76:79], v[96:99]
    buffer_load_dwordx4 v26, s[16:19], s28 offen lds
    v_exp_f32 v90, v90
    v_mfma_f32_16x16x32_bf16 v[100:103], v[84:87], a[76:79], v[44:47]
    v_exp_f32 v91, v91
    v_mfma_f32_16x16x32_bf16 v[100:103], v[80:83], a[72:75], v[100:103]
    s_add_u32 m0, m0, s53
    v_add_f32 v18, v18, v88
    v_add_f32 v19, v19, v89
    v_mfma_f32_16x16x32_bf16 v[100:103], v[76:79], a[68:71], v[100:103]
    v_cvt_pk_bf16_f32 v104, v88, v89
    v_mfma_f32_16x16x32_bf16 v[100:103], v[72:75], a[64:67], v[100:103]
    v_exp_f32 v92, v92
    v_mfma_f32_16x16x32_bf16 v[152:155], v[112:115], v[108:111], v[152:155]
    s_add_u32 s28, s49, s93
    v_exp_f32 v93, v93
    v_mfma_f32_16x16x32_bf16 v[180:183], v[116:119], v[108:111], v[180:183]
    v_add_f32 v18, v18, v90
    v_add_f32 v19, v19, v91
    v_mfma_f32_16x16x32_bf16 v[208:211], v[120:123], v[108:111], v[208:211]
    buffer_load_dwordx4 v26, s[16:19], s28 offen lds
    v_cvt_pk_bf16_f32 v105, v90, v91
    v_mfma_f32_16x16x32_bf16 v[236:239], v[124:127], v[108:111], v[236:239]
    v_exp_f32 v94, v94
    v_mfma_f32_16x16x32_bf16 a[120:123], v[128:131], v[108:111], a[120:123]
    s_add_u32 m0, m0, s53
    v_exp_f32 v95, v95
    v_mfma_f32_16x16x32_bf16 a[148:151], v[132:135], v[108:111], a[148:151]
    v_add_f32 v18, v18, v92
    v_add_f32 v19, v19, v93
    v_mfma_f32_16x16x32_bf16 a[176:179], v[136:139], v[108:111], a[176:179]
    s_add_u32 s28, s49, s94
    v_cvt_pk_bf16_f32 v106, v92, v93
    v_add_f32 v18, v18, v94
    v_mfma_f32_16x16x32_bf16 a[204:207], v[140:143], v[108:111], a[204:207]
    v_add_f32 v19, v19, v95
    v_cvt_pk_bf16_f32 v107, v94, v95
    v_mfma_f32_16x16x32_bf16 v[88:91], v[56:59], a[80:83], v[48:51]
    v_mfma_f32_16x16x32_bf16 v[88:91], v[60:63], a[84:87], v[88:91]
    buffer_load_dwordx4 v26, s[16:19], s28 offen lds
    v_exp_f32 v96, v96
    v_mfma_f32_16x16x32_bf16 v[88:91], v[64:67], a[88:91], v[88:91]
    v_exp_f32 v97, v97
    v_mfma_f32_16x16x32_bf16 v[88:91], v[68:71], a[92:95], v[88:91]
    s_add_u32 m0, m0, s53
    v_exp_f32 v98, v98
    v_mfma_f32_16x16x32_bf16 v[92:95], v[84:87], a[92:95], v[48:51]
    v_exp_f32 v99, v99
    v_mfma_f32_16x16x32_bf16 v[92:95], v[80:83], a[88:91], v[92:95]
    s_add_u32 s28, s49, s95
    v_add_f32 v20, v20, v96
    v_add_f32 v21, v21, v97
    v_mfma_f32_16x16x32_bf16 v[92:95], v[76:79], a[84:87], v[92:95]
    v_cvt_pk_bf16_f32 v108, v96, v97
    v_mfma_f32_16x16x32_bf16 v[92:95], v[72:75], a[80:83], v[92:95]
    v_exp_f32 v100, v100
    v_mfma_f32_16x16x32_bf16 v[156:159], v[112:115], v[104:107], v[156:159]
    buffer_load_dwordx4 v26, s[16:19], s28 offen lds
    v_exp_f32 v101, v101
    v_mfma_f32_16x16x32_bf16 v[184:187], v[116:119], v[104:107], v[184:187]
    v_add_f32 v20, v20, v98
    v_add_f32 v21, v21, v99
    v_mfma_f32_16x16x32_bf16 v[212:215], v[120:123], v[104:107], v[212:215]
    v_cvt_pk_bf16_f32 v109, v98, v99
    v_mfma_f32_16x16x32_bf16 v[240:243], v[124:127], v[104:107], v[240:243]
    v_exp_f32 v102, v102
    v_mfma_f32_16x16x32_bf16 a[124:127], v[128:131], v[104:107], a[124:127]
    v_exp_f32 v103, v103
    v_mfma_f32_16x16x32_bf16 a[152:155], v[132:135], v[104:107], a[152:155]
    v_add_f32 v20, v20, v100
    v_add_f32 v21, v21, v101
    v_mfma_f32_16x16x32_bf16 a[180:183], v[136:139], v[104:107], a[180:183]
    v_cvt_pk_bf16_f32 v110, v100, v101
    v_add_f32 v20, v20, v102
    v_mfma_f32_16x16x32_bf16 a[208:211], v[140:143], v[104:107], a[208:211]
    v_add_f32 v21, v21, v103
    v_cvt_pk_bf16_f32 v111, v102, v103
    s_waitcnt vmcnt(8) lgkmcnt(0)
    s_barrier
    v_mfma_f32_16x16x32_bf16 v[96:99], v[56:59], a[96:99], v[52:55]
    s_add_u32 m0, s33, 25344
    v_mfma_f32_16x16x32_bf16 v[96:99], v[60:63], a[100:103], v[96:99]
    s_add_u32 s49, s50, s46
    v_exp_f32 v88, v88
    v_mfma_f32_16x16x32_bf16 v[96:99], v[64:67], a[104:107], v[96:99]
    s_lshl1_add_u32 s50, s51, s50
    v_exp_f32 v89, v89
    v_mfma_f32_16x16x32_bf16 v[96:99], v[68:71], a[108:111], v[96:99]
    s_add_u32 s82, s82, 2
    v_exp_f32 v90, v90
    v_mfma_f32_16x16x32_bf16 v[100:103], v[84:87], a[108:111], v[52:55]
    s_cmp_eq_u32 s82, 20
    v_exp_f32 v91, v91
    v_mfma_f32_16x16x32_bf16 v[100:103], v[80:83], a[104:107], v[100:103]
    s_cselect_b32 s29, s83, 0
    v_add_f32 v22, v22, v88
    v_add_f32 v23, v23, v89
    v_mfma_f32_16x16x32_bf16 v[100:103], v[76:79], a[100:103], v[100:103]
    s_sub_u32 s50, s50, s29
    v_cvt_pk_bf16_f32 v104, v88, v89
    v_mfma_f32_16x16x32_bf16 v[100:103], v[72:75], a[96:99], v[100:103]
    v_exp_f32 v92, v92
    v_mfma_f32_16x16x32_bf16 v[160:163], v[112:115], v[108:111], v[160:163]
    s_add_u32 s28, s49, s88
    v_exp_f32 v93, v93
    v_mfma_f32_16x16x32_bf16 v[188:191], v[116:119], v[108:111], v[188:191]
    buffer_load_dwordx4 v26, s[16:19], s28 offen lds
    v_add_f32 v22, v22, v90
    v_add_f32 v23, v23, v91
    v_mfma_f32_16x16x32_bf16 v[216:219], v[120:123], v[108:111], v[216:219]
    s_add_u32 m0, m0, s53
    v_cvt_pk_bf16_f32 v105, v90, v91
    v_mfma_f32_16x16x32_bf16 v[244:247], v[124:127], v[108:111], v[244:247]
    s_add_u32 s28, s49, s89
    v_exp_f32 v94, v94
    v_mfma_f32_16x16x32_bf16 a[128:131], v[128:131], v[108:111], a[128:131]
    buffer_load_dwordx4 v26, s[16:19], s28 offen lds
    v_exp_f32 v95, v95
    v_mfma_f32_16x16x32_bf16 a[156:159], v[132:135], v[108:111], a[156:159]
    s_add_u32 m0, m0, s53
    v_add_f32 v22, v22, v92
    v_add_f32 v23, v23, v93
    v_mfma_f32_16x16x32_bf16 a[184:187], v[136:139], v[108:111], a[184:187]
    s_add_u32 s28, s49, s90
    v_cvt_pk_bf16_f32 v106, v92, v93
    v_add_f32 v22, v22, v94
    v_mfma_f32_16x16x32_bf16 a[212:215], v[140:143], v[108:111], a[212:215]
    buffer_load_dwordx4 v26, s[16:19], s28 offen lds
    v_add_f32 v23, v23, v95
    v_cvt_pk_bf16_f32 v107, v94, v95
    s_nop 1
    v_mfma_f32_16x16x32_bf16 v[164:167], v[112:115], v[104:107], v[164:167]
    s_add_u32 m0, m0, s53
    s_add_u32 s28, s49, s91
    v_exp_f32 v96, v96
    v_mfma_f32_16x16x32_bf16 v[192:195], v[116:119], v[104:107], v[192:195]
    buffer_load_dwordx4 v26, s[16:19], s28 offen lds
    s_add_u32 m0, m0, s53
    v_exp_f32 v97, v97
    v_exp_f32 v98, v98
    v_mfma_f32_16x16x32_bf16 v[220:223], v[120:123], v[104:107], v[220:223]
    s_add_u32 s28, s49, s92
    buffer_load_dwordx4 v26, s[16:19], s28 offen lds
    v_exp_f32 v99, v99
    v_add_f32 v24, v24, v96
    v_add_f32 v25, v25, v97
    v_mfma_f32_16x16x32_bf16 v[248:251], v[124:127], v[104:107], v[248:251]
    s_add_u32 m0, m0, s53
    v_cvt_pk_bf16_f32 v108, v96, v97
    v_exp_f32 v100, v100
    v_mfma_f32_16x16x32_bf16 a[132:135], v[128:131], v[104:107], a[132:135]
    s_add_u32 s28, s49, s93
    buffer_load_dwordx4 v26, s[16:19], s28 offen lds
    v_exp_f32 v101, v101
    v_add_f32 v24, v24, v98
    v_add_f32 v25, v25, v99
    v_mfma_f32_16x16x32_bf16 a[160:163], v[132:135], v[104:107], a[160:163]
    s_add_u32 m0, m0, s53
    s_add_u32 s28, s49, s94
    v_cvt_pk_bf16_f32 v109, v98, v99
    v_exp_f32 v102, v102
    v_mfma_f32_16x16x32_bf16 a[188:191], v[136:139], v[104:107], a[188:191]
    buffer_load_dwordx4 v26, s[16:19], s28 offen lds
    s_add_u32 m0, m0, s53
    v_exp_f32 v103, v103
    v_add_f32 v24, v24, v100
    v_add_f32 v25, v25, v101
    v_mfma_f32_16x16x32_bf16 a[216:219], v[140:143], v[104:107], a[216:219]
    s_add_u32 s28, s49, s95
    buffer_load_dwordx4 v26, s[16:19], s28 offen lds
    v_cvt_pk_bf16_f32 v110, v100, v101
    v_add_f32 v24, v24, v102
    v_add_f32 v25, v25, v103
    v_cvt_pk_bf16_f32 v111, v102, v103
    s_branch L_at_aepi
L_at_atailB:
    v_mfma_f32_16x16x32_bf16 v[88:91], v[56:59], a[16:19], v[32:35]
    v_mfma_f32_16x16x32_bf16 v[88:91], v[60:63], a[20:23], v[88:91]
    v_exp_f32 v96, v96
    v_mfma_f32_16x16x32_bf16 v[88:91], v[64:67], a[24:27], v[88:91]
    v_exp_f32 v97, v97
    v_mfma_f32_16x16x32_bf16 v[88:91], v[68:71], a[28:31], v[88:91]
    v_exp_f32 v98, v98
    v_mfma_f32_16x16x32_bf16 v[92:95], v[84:87], a[28:31], v[32:35]
    v_exp_f32 v99, v99
    v_mfma_f32_16x16x32_bf16 v[92:95], v[80:83], a[24:27], v[92:95]
    v_add_f32 v12, v12, v96
    v_add_f32 v13, v13, v97
    v_mfma_f32_16x16x32_bf16 v[92:95], v[76:79], a[20:23], v[92:95]
    v_cvt_pk_bf16_f32 v108, v96, v97
    v_mfma_f32_16x16x32_bf16 v[92:95], v[72:75], a[16:19], v[92:95]
    v_exp_f32 v100, v100
    v_mfma_f32_16x16x32_bf16 v[168:171], v[112:115], v[104:107], v[168:171]
    ds_read_b64_tr_b16 v[112:113], v9 offset:8448
    ds_read_b64_tr_b16 v[114:115], v9 offset:8960
    v_exp_f32 v101, v101
    v_mfma_f32_16x16x32_bf16 v[196:199], v[116:119], v[104:107], v[196:199]
    ds_read_b64_tr_b16 v[116:117], v9 offset:8480
    ds_read_b64_tr_b16 v[118:119], v9 offset:8992
    v_add_f32 v12, v12, v98
    v_add_f32 v13, v13, v99
    v_mfma_f32_16x16x32_bf16 v[224:227], v[120:123], v[104:107], v[224:227]
    ds_read_b64_tr_b16 v[120:121], v9 offset:8512
    ds_read_b64_tr_b16 v[122:123], v9 offset:9024
    v_cvt_pk_bf16_f32 v109, v98, v99
    v_mfma_f32_16x16x32_bf16 v[252:255], v[124:127], v[104:107], v[252:255]
    ds_read_b64_tr_b16 v[124:125], v9 offset:8544
    ds_read_b64_tr_b16 v[126:127], v9 offset:9056
    v_exp_f32 v102, v102
    v_mfma_f32_16x16x32_bf16 a[136:139], v[128:131], v[104:107], a[136:139]
    ds_read_b64_tr_b16 v[128:129], v9 offset:8576
    ds_read_b64_tr_b16 v[130:131], v9 offset:9088
    v_exp_f32 v103, v103
    v_mfma_f32_16x16x32_bf16 a[164:167], v[132:135], v[104:107], a[164:167]
    ds_read_b64_tr_b16 v[132:133], v9 offset:8608
    ds_read_b64_tr_b16 v[134:135], v9 offset:9120
    v_add_f32 v12, v12, v100
    v_add_f32 v13, v13, v101
    v_mfma_f32_16x16x32_bf16 a[192:195], v[136:139], v[104:107], a[192:195]
    ds_read_b64_tr_b16 v[136:137], v9 offset:8640
    ds_read_b64_tr_b16 v[138:139], v9 offset:9152
    v_cvt_pk_bf16_f32 v110, v100, v101
    v_add_f32 v12, v12, v102
    v_mfma_f32_16x16x32_bf16 a[220:223], v[140:143], v[104:107], a[220:223]
    ds_read_b64_tr_b16 v[140:141], v9 offset:8672
    ds_read_b64_tr_b16 v[142:143], v9 offset:9184
    v_add_f32 v13, v13, v103
    v_cvt_pk_bf16_f32 v111, v102, v103
    v_mfma_f32_16x16x32_bf16 v[96:99], v[56:59], a[32:35], v[36:39]
    v_mfma_f32_16x16x32_bf16 v[96:99], v[60:63], a[36:39], v[96:99]
    s_add_u32 s29, s34, s100
    v_exp_f32 v88, v88
    v_mfma_f32_16x16x32_bf16 v[96:99], v[64:67], a[40:43], v[96:99]
    v_exp_f32 v89, v89
    v_mfma_f32_16x16x32_bf16 v[96:99], v[68:71], a[44:47], v[96:99]
    s_bfe_u32 s28, s29, 0x20003
    v_exp_f32 v90, v90
    v_mfma_f32_16x16x32_bf16 v[100:103], v[84:87], a[44:47], v[36:39]
    v_exp_f32 v91, v91
    v_mfma_f32_16x16x32_bf16 v[100:103], v[80:83], a[40:43], v[100:103]
    s_lshl_b32 s28, s28, 16
    v_add_f32 v14, v14, v88
    v_add_f32 v15, v15, v89
    v_mfma_f32_16x16x32_bf16 v[100:103], v[76:79], a[36:39], v[100:103]
    v_cvt_pk_bf16_f32 v104, v88, v89
    v_mfma_f32_16x16x32_bf16 v[100:103], v[72:75], a[32:35], v[100:103]
    v_exp_f32 v92, v92
    s_waitcnt lgkmcnt(0)
    v_mfma_f32_16x16x32_bf16 v[144:147], v[112:115], v[108:111], v[144:147]
    s_and_b32 s29, s29, 7
    v_exp_f32 v93, v93
    v_mfma_f32_16x16x32_bf16 v[172:175], v[116:119], v[108:111], v[172:175]
    v_add_f32 v14, v14, v90
    v_add_f32 v15, v15, v91
    v_mfma_f32_16x16x32_bf16 v[200:203], v[120:123], v[108:111], v[200:203]
    s_lshl_b32 s29, s29, 11
    v_cvt_pk_bf16_f32 v105, v90, v91
    v_mfma_f32_16x16x32_bf16 v[228:231], v[124:127], v[108:111], v[228:231]
    v_exp_f32 v94, v94
    v_mfma_f32_16x16x32_bf16 a[112:115], v[128:131], v[108:111], a[112:115]
    s_add_u32 s29, s28, s29
    v_exp_f32 v95, v95
    v_mfma_f32_16x16x32_bf16 a[140:143], v[132:135], v[108:111], a[140:143]
    v_add_f32 v14, v14, v92
    v_add_f32 v15, v15, v93
    v_mfma_f32_16x16x32_bf16 a[168:171], v[136:139], v[108:111], a[168:171]
    s_lshr_b32 s28, s34, 5
    v_cvt_pk_bf16_f32 v106, v92, v93
    v_add_f32 v14, v14, v94
    v_mfma_f32_16x16x32_bf16 a[196:199], v[140:143], v[108:111], a[196:199]
    v_add_f32 v15, v15, v95
    v_cvt_pk_bf16_f32 v107, v94, v95
    v_mfma_f32_16x16x32_bf16 v[88:91], v[56:59], a[48:51], v[40:43]
    v_mfma_f32_16x16x32_bf16 v[88:91], v[60:63], a[52:55], v[88:91]
    s_lshl_b32 s28, s28, 19
    v_exp_f32 v96, v96
    v_mfma_f32_16x16x32_bf16 v[88:91], v[64:67], a[56:59], v[88:91]
    v_exp_f32 v97, v97
    v_mfma_f32_16x16x32_bf16 v[88:91], v[68:71], a[60:63], v[88:91]
    s_add_u32 s49, s28, s29
    v_exp_f32 v98, v98
    v_mfma_f32_16x16x32_bf16 v[92:95], v[84:87], a[60:63], v[40:43]
    v_exp_f32 v99, v99
    v_mfma_f32_16x16x32_bf16 v[92:95], v[80:83], a[56:59], v[92:95]
    s_add_u32 m0, s33, 0
    v_add_f32 v16, v16, v96
    v_add_f32 v17, v17, v97
    v_mfma_f32_16x16x32_bf16 v[92:95], v[76:79], a[52:55], v[92:95]
    v_cvt_pk_bf16_f32 v108, v96, v97
    v_mfma_f32_16x16x32_bf16 v[92:95], v[72:75], a[48:51], v[92:95]
    v_exp_f32 v100, v100
    v_mfma_f32_16x16x32_bf16 v[148:151], v[112:115], v[104:107], v[148:151]
    s_add_u32 s34, s34, 1
    v_exp_f32 v101, v101
    v_mfma_f32_16x16x32_bf16 v[176:179], v[116:119], v[104:107], v[176:179]
    v_add_f32 v16, v16, v98
    v_add_f32 v17, v17, v99
    v_mfma_f32_16x16x32_bf16 v[204:207], v[120:123], v[104:107], v[204:207]
    buffer_load_dwordx4 v7, s[4:7], s49 offen offset:0 nt lds
    v_cvt_pk_bf16_f32 v109, v98, v99
    v_mfma_f32_16x16x32_bf16 v[232:235], v[124:127], v[104:107], v[232:235]
    v_exp_f32 v102, v102
    v_mfma_f32_16x16x32_bf16 a[116:119], v[128:131], v[104:107], a[116:119]
    s_add_u32 m0, m0, s96
    v_exp_f32 v103, v103
    v_mfma_f32_16x16x32_bf16 a[144:147], v[132:135], v[104:107], a[144:147]
    v_add_f32 v16, v16, v100
    v_add_f32 v17, v17, v101
    v_mfma_f32_16x16x32_bf16 a[172:175], v[136:139], v[104:107], a[172:175]
    buffer_load_dwordx4 v7, s[4:7], s49 offen offset:256 nt lds
    v_cvt_pk_bf16_f32 v110, v100, v101
    v_add_f32 v16, v16, v102
    v_mfma_f32_16x16x32_bf16 a[200:203], v[140:143], v[104:107], a[200:203]
    v_add_f32 v17, v17, v103
    v_cvt_pk_bf16_f32 v111, v102, v103
    v_mfma_f32_16x16x32_bf16 v[96:99], v[56:59], a[64:67], v[44:47]
    v_mfma_f32_16x16x32_bf16 v[96:99], v[60:63], a[68:71], v[96:99]
    s_add_u32 m0, m0, s97
    v_exp_f32 v88, v88
    v_mfma_f32_16x16x32_bf16 v[96:99], v[64:67], a[72:75], v[96:99]
    v_exp_f32 v89, v89
    v_mfma_f32_16x16x32_bf16 v[96:99], v[68:71], a[76:79], v[96:99]
    buffer_load_dwordx4 v7, s[4:7], s49 offen offset:512 nt lds
    v_exp_f32 v90, v90
    v_mfma_f32_16x16x32_bf16 v[100:103], v[84:87], a[76:79], v[44:47]
    v_exp_f32 v91, v91
    v_mfma_f32_16x16x32_bf16 v[100:103], v[80:83], a[72:75], v[100:103]
    s_add_u32 m0, m0, s96
    v_add_f32 v18, v18, v88
    v_add_f32 v19, v19, v89
    v_mfma_f32_16x16x32_bf16 v[100:103], v[76:79], a[68:71], v[100:103]
    v_cvt_pk_bf16_f32 v104, v88, v89
    v_mfma_f32_16x16x32_bf16 v[100:103], v[72:75], a[64:67], v[100:103]
    v_exp_f32 v92, v92
    v_mfma_f32_16x16x32_bf16 v[152:155], v[112:115], v[108:111], v[152:155]
    buffer_load_dwordx4 v7, s[4:7], s49 offen offset:768 nt lds
    v_exp_f32 v93, v93
    v_mfma_f32_16x16x32_bf16 v[180:183], v[116:119], v[108:111], v[180:183]
    v_add_f32 v18, v18, v90
    v_add_f32 v19, v19, v91
    v_mfma_f32_16x16x32_bf16 v[208:211], v[120:123], v[108:111], v[208:211]
    s_add_u32 m0, m0, s97
    v_cvt_pk_bf16_f32 v105, v90, v91
    v_mfma_f32_16x16x32_bf16 v[236:239], v[124:127], v[108:111], v[236:239]
    v_exp_f32 v94, v94
    v_mfma_f32_16x16x32_bf16 a[120:123], v[128:131], v[108:111], a[120:123]
    buffer_load_dwordx4 v7, s[4:7], s49 offen offset:1024 nt lds
    v_exp_f32 v95, v95
    v_mfma_f32_16x16x32_bf16 a[148:151], v[132:135], v[108:111], a[148:151]
    v_add_f32 v18, v18, v92
    v_add_f32 v19, v19, v93
    v_mfma_f32_16x16x32_bf16 a[176:179], v[136:139], v[108:111], a[176:179]
    s_add_u32 m0, m0, s96
    v_cvt_pk_bf16_f32 v106, v92, v93
    v_add_f32 v18, v18, v94
    v_mfma_f32_16x16x32_bf16 a[204:207], v[140:143], v[108:111], a[204:207]
    v_add_f32 v19, v19, v95
    v_cvt_pk_bf16_f32 v107, v94, v95
    v_mfma_f32_16x16x32_bf16 v[88:91], v[56:59], a[80:83], v[48:51]
    v_mfma_f32_16x16x32_bf16 v[88:91], v[60:63], a[84:87], v[88:91]
    buffer_load_dwordx4 v7, s[4:7], s49 offen offset:1280 nt lds
    v_exp_f32 v96, v96
    v_mfma_f32_16x16x32_bf16 v[88:91], v[64:67], a[88:91], v[88:91]
    v_exp_f32 v97, v97
    v_mfma_f32_16x16x32_bf16 v[88:91], v[68:71], a[92:95], v[88:91]
    s_add_u32 m0, m0, s97
    v_exp_f32 v98, v98
    v_mfma_f32_16x16x32_bf16 v[92:95], v[84:87], a[92:95], v[48:51]
    v_exp_f32 v99, v99
    v_mfma_f32_16x16x32_bf16 v[92:95], v[80:83], a[88:91], v[92:95]
    buffer_load_dwordx4 v7, s[4:7], s49 offen offset:1536 nt lds
    v_add_f32 v20, v20, v96
    v_add_f32 v21, v21, v97
    v_mfma_f32_16x16x32_bf16 v[92:95], v[76:79], a[84:87], v[92:95]
    v_cvt_pk_bf16_f32 v108, v96, v97
    v_mfma_f32_16x16x32_bf16 v[92:95], v[72:75], a[80:83], v[92:95]
    v_exp_f32 v100, v100
    v_mfma_f32_16x16x32_bf16 v[156:159], v[112:115], v[104:107], v[156:159]
    s_add_u32 m0, m0, s96
    v_exp_f32 v101, v101
    v_mfma_f32_16x16x32_bf16 v[184:187], v[116:119], v[104:107], v[184:187]
    v_add_f32 v20, v20, v98
    v_add_f32 v21, v21, v99
    v_mfma_f32_16x16x32_bf16 v[212:215], v[120:123], v[104:107], v[212:215]
    buffer_load_dwordx4 v7, s[4:7], s49 offen offset:1792 nt lds
    v_cvt_pk_bf16_f32 v109, v98, v99
    v_mfma_f32_16x16x32_bf16 v[240:243], v[124:127], v[104:107], v[240:243]
    v_exp_f32 v102, v102
    v_mfma_f32_16x16x32_bf16 a[124:127], v[128:131], v[104:107], a[124:127]
    v_exp_f32 v103, v103
    v_mfma_f32_16x16x32_bf16 a[152:155], v[132:135], v[104:107], a[152:155]
    v_add_f32 v20, v20, v100
    v_add_f32 v21, v21, v101
    v_mfma_f32_16x16x32_bf16 a[180:183], v[136:139], v[104:107], a[180:183]
    v_cvt_pk_bf16_f32 v110, v100, v101
    v_add_f32 v20, v20, v102
    v_mfma_f32_16x16x32_bf16 a[208:211], v[140:143], v[104:107], a[208:211]
    v_add_f32 v21, v21, v103
    v_cvt_pk_bf16_f32 v111, v102, v103
    s_waitcnt vmcnt(16) lgkmcnt(0)
    s_barrier
    v_mfma_f32_16x16x32_bf16 v[96:99], v[56:59], a[96:99], v[52:55]
    ds_read_b128 v[56:59], v8 offset:16896
    v_mfma_f32_16x16x32_bf16 v[96:99], v[60:63], a[100:103], v[96:99]
    ds_read_b128 v[60:63], v8 offset:16960
    v_exp_f32 v88, v88
    v_mfma_f32_16x16x32_bf16 v[96:99], v[64:67], a[104:107], v[96:99]
    ds_read_b128 v[64:67], v8 offset:17024
    v_exp_f32 v89, v89
    v_mfma_f32_16x16x32_bf16 v[96:99], v[68:71], a[108:111], v[96:99]
    ds_read_b128 v[68:71], v8 offset:17088
    v_exp_f32 v90, v90
    v_mfma_f32_16x16x32_bf16 v[100:103], v[84:87], a[108:111], v[52:55]
    ds_read_b128 v[84:87], v8 offset:17600
    v_exp_f32 v91, v91
    v_mfma_f32_16x16x32_bf16 v[100:103], v[80:83], a[104:107], v[100:103]
    ds_read_b128 v[80:83], v8 offset:17536
    v_add_f32 v22, v22, v88
    v_add_f32 v23, v23, v89
    v_mfma_f32_16x16x32_bf16 v[100:103], v[76:79], a[100:103], v[100:103]
    ds_read_b128 v[76:79], v8 offset:17472
    v_cvt_pk_bf16_f32 v104, v88, v89
    v_mfma_f32_16x16x32_bf16 v[100:103], v[72:75], a[96:99], v[100:103]
    ds_read_b128 v[72:75], v8 offset:17408
    v_exp_f32 v92, v92
    v_mfma_f32_16x16x32_bf16 v[160:163], v[112:115], v[108:111], v[160:163]
    v_exp_f32 v93, v93
    v_mfma_f32_16x16x32_bf16 v[188:191], v[116:119], v[108:111], v[188:191]
    v_add_f32 v22, v22, v90
    v_add_f32 v23, v23, v91
    v_mfma_f32_16x16x32_bf16 v[216:219], v[120:123], v[108:111], v[216:219]
    v_cvt_pk_bf16_f32 v105, v90, v91
    v_mfma_f32_16x16x32_bf16 v[244:247], v[124:127], v[108:111], v[244:247]
    v_exp_f32 v94, v94
    v_mfma_f32_16x16x32_bf16 a[128:131], v[128:131], v[108:111], a[128:131]
    v_exp_f32 v95, v95
    v_mfma_f32_16x16x32_bf16 a[156:159], v[132:135], v[108:111], a[156:159]
    v_add_f32 v22, v22, v92
    v_add_f32 v23, v23, v93
    v_mfma_f32_16x16x32_bf16 a[184:187], v[136:139], v[108:111], a[184:187]
    v_cvt_pk_bf16_f32 v106, v92, v93
    v_add_f32 v22, v22, v94
    v_mfma_f32_16x16x32_bf16 a[212:215], v[140:143], v[108:111], a[212:215]
    v_add_f32 v23, v23, v95
    v_cvt_pk_bf16_f32 v107, v94, v95
    s_waitcnt lgkmcnt(0)
    v_mfma_f32_16x16x32_bf16 v[88:91], v[56:59], a[0:3], v[28:31]
    v_mfma_f32_16x16x32_bf16 v[88:91], v[60:63], a[4:7], v[88:91]
    v_exp_f32 v96, v96
    v_mfma_f32_16x16x32_bf16 v[88:91], v[64:67], a[8:11], v[88:91]
    v_exp_f32 v97, v97
    v_mfma_f32_16x16x32_bf16 v[88:91], v[68:71], a[12:15], v[88:91]
    v_exp_f32 v98, v98
    v_mfma_f32_16x16x32_bf16 v[92:95], v[84:87], a[12:15], v[28:31]
    v_exp_f32 v99, v99
    v_mfma_f32_16x16x32_bf16 v[92:95], v[80:83], a[8:11], v[92:95]
    v_add_f32 v24, v24, v96
    v_add_f32 v25, v25, v97
    v_mfma_f32_16x16x32_bf16 v[92:95], v[76:79], a[4:7], v[92:95]
    v_cvt_pk_bf16_f32 v108, v96, v97
    v_mfma_f32_16x16x32_bf16 v[92:95], v[72:75], a[0:3], v[92:95]
    v_exp_f32 v100, v100
    v_mfma_f32_16x16x32_bf16 v[164:167], v[112:115], v[104:107], v[164:167]
    v_exp_f32 v101, v101
    v_mfma_f32_16x16x32_bf16 v[192:195], v[116:119], v[104:107], v[192:195]
    v_add_f32 v24, v24, v98
    v_add_f32 v25, v25, v99
    v_mfma_f32_16x16x32_bf16 v[220:223], v[120:123], v[104:107], v[220:223]
    v_cvt_pk_bf16_f32 v109, v98, v99
    v_mfma_f32_16x16x32_bf16 v[248:251], v[124:127], v[104:107], v[248:251]
    v_exp_f32 v102, v102
    v_mfma_f32_16x16x32_bf16 a[132:135], v[128:131], v[104:107], a[132:135]
    v_exp_f32 v103, v103
    v_mfma_f32_16x16x32_bf16 a[160:163], v[132:135], v[104:107], a[160:163]
    v_add_f32 v24, v24, v100
    v_add_f32 v25, v25, v101
    v_mfma_f32_16x16x32_bf16 a[188:191], v[136:139], v[104:107], a[188:191]
    v_cvt_pk_bf16_f32 v110, v100, v101
    v_add_f32 v24, v24, v102
    v_mfma_f32_16x16x32_bf16 a[216:219], v[140:143], v[104:107], a[216:219]
    v_add_f32 v25, v25, v103
    v_cvt_pk_bf16_f32 v111, v102, v103
    v_mfma_f32_16x16x32_bf16 v[96:99], v[56:59], a[16:19], v[32:35]
    v_mfma_f32_16x16x32_bf16 v[96:99], v[60:63], a[20:23], v[96:99]
    v_exp_f32 v88, v88
    v_mfma_f32_16x16x32_bf16 v[96:99], v[64:67], a[24:27], v[96:99]
    v_exp_f32 v89, v89
    v_mfma_f32_16x16x32_bf16 v[96:99], v[68:71], a[28:31], v[96:99]
    v_exp_f32 v90, v90
    v_mfma_f32_16x16x32_bf16 v[100:103], v[84:87], a[28:31], v[32:35]
    v_exp_f32 v91, v91
    v_mfma_f32_16x16x32_bf16 v[100:103], v[80:83], a[24:27], v[100:103]
    v_add_f32 v12, v12, v88
    v_add_f32 v13, v13, v89
    v_mfma_f32_16x16x32_bf16 v[100:103], v[76:79], a[20:23], v[100:103]
    v_cvt_pk_bf16_f32 v104, v88, v89
    v_mfma_f32_16x16x32_bf16 v[100:103], v[72:75], a[16:19], v[100:103]
    v_exp_f32 v92, v92
    v_mfma_f32_16x16x32_bf16 v[168:171], v[112:115], v[108:111], v[168:171]
    ds_read_b64_tr_b16 v[112:113], v9 offset:16896
    ds_read_b64_tr_b16 v[114:115], v9 offset:17408
    v_exp_f32 v93, v93
    v_mfma_f32_16x16x32_bf16 v[196:199], v[116:119], v[108:111], v[196:199]
    ds_read_b64_tr_b16 v[116:117], v9 offset:16928
    ds_read_b64_tr_b16 v[118:119], v9 offset:17440
    v_add_f32 v12, v12, v90
    v_add_f32 v13, v13, v91
    v_mfma_f32_16x16x32_bf16 v[224:227], v[120:123], v[108:111], v[224:227]
    ds_read_b64_tr_b16 v[120:121], v9 offset:16960
    ds_read_b64_tr_b16 v[122:123], v9 offset:17472
    v_cvt_pk_bf16_f32 v105, v90, v91
    v_mfma_f32_16x16x32_bf16 v[252:255], v[124:127], v[108:111], v[252:255]
    ds_read_b64_tr_b16 v[124:125], v9 offset:16992
    ds_read_b64_tr_b16 v[126:127], v9 offset:17504
    v_exp_f32 v94, v94
    v_mfma_f32_16x16x32_bf16 a[136:139], v[128:131], v[108:111], a[136:139]
    ds_read_b64_tr_b16 v[128:129], v9 offset:17024
    ds_read_b64_tr_b16 v[130:131], v9 offset:17536
    v_exp_f32 v95, v95
    v_mfma_f32_16x16x32_bf16 a[164:167], v[132:135], v[108:111], a[164:167]
    ds_read_b64_tr_b16 v[132:133], v9 offset:17056
    ds_read_b64_tr_b16 v[134:135], v9 offset:17568
    v_add_f32 v12, v12, v92
    v_add_f32 v13, v13, v93
    v_mfma_f32_16x16x32_bf16 a[192:195], v[136:139], v[108:111], a[192:195]
    ds_read_b64_tr_b16 v[136:137], v9 offset:17088
    ds_read_b64_tr_b16 v[138:139], v9 offset:17600
    v_cvt_pk_bf16_f32 v106, v92, v93
    v_add_f32 v12, v12, v94
    v_mfma_f32_16x16x32_bf16 a[220:223], v[140:143], v[108:111], a[220:223]
    ds_read_b64_tr_b16 v[140:141], v9 offset:17120
    ds_read_b64_tr_b16 v[142:143], v9 offset:17632
    v_add_f32 v13, v13, v95
    v_cvt_pk_bf16_f32 v107, v94, v95
    v_mfma_f32_16x16x32_bf16 v[88:91], v[56:59], a[32:35], v[36:39]
    v_mfma_f32_16x16x32_bf16 v[88:91], v[60:63], a[36:39], v[88:91]
    s_add_u32 s29, s34, s100
    v_exp_f32 v96, v96
    v_mfma_f32_16x16x32_bf16 v[88:91], v[64:67], a[40:43], v[88:91]
    v_exp_f32 v97, v97
    v_mfma_f32_16x16x32_bf16 v[88:91], v[68:71], a[44:47], v[88:91]
    s_bfe_u32 s28, s29, 0x20003
    v_exp_f32 v98, v98
    v_mfma_f32_16x16x32_bf16 v[92:95], v[84:87], a[44:47], v[36:39]
    v_exp_f32 v99, v99
    v_mfma_f32_16x16x32_bf16 v[92:95], v[80:83], a[40:43], v[92:95]
    s_lshl_b32 s28, s28, 16
    v_add_f32 v14, v14, v96
    v_add_f32 v15, v15, v97
    v_mfma_f32_16x16x32_bf16 v[92:95], v[76:79], a[36:39], v[92:95]
    v_cvt_pk_bf16_f32 v108, v96, v97
    v_mfma_f32_16x16x32_bf16 v[92:95], v[72:75], a[32:35], v[92:95]
    v_exp_f32 v100, v100
    s_waitcnt lgkmcnt(0)
    v_mfma_f32_16x16x32_bf16 v[144:147], v[112:115], v[104:107], v[144:147]
    s_and_b32 s29, s29, 7
    v_exp_f32 v101, v101
    v_mfma_f32_16x16x32_bf16 v[172:175], v[116:119], v[104:107], v[172:175]
    v_add_f32 v14, v14, v98
    v_add_f32 v15, v15, v99
    v_mfma_f32_16x16x32_bf16 v[200:203], v[120:123], v[104:107], v[200:203]
    s_lshl_b32 s29, s29, 11
    v_cvt_pk_bf16_f32 v109, v98, v99
    v_mfma_f32_16x16x32_bf16 v[228:231], v[124:127], v[104:107], v[228:231]
    v_exp_f32 v102, v102
    v_mfma_f32_16x16x32_bf16 a[112:115], v[128:131], v[104:107], a[112:115]
    s_add_u32 s29, s28, s29
    v_exp_f32 v103, v103
    v_mfma_f32_16x16x32_bf16 a[140:143], v[132:135], v[104:107], a[140:143]
    v_add_f32 v14, v14, v100
    v_add_f32 v15, v15, v101
    v_mfma_f32_16x16x32_bf16 a[168:171], v[136:139], v[104:107], a[168:171]
    s_lshr_b32 s28, s34, 5
    v_cvt_pk_bf16_f32 v110, v100, v101
    v_add_f32 v14, v14, v102
    v_mfma_f32_16x16x32_bf16 a[196:199], v[140:143], v[104:107], a[196:199]
    v_add_f32 v15, v15, v103
    v_cvt_pk_bf16_f32 v111, v102, v103
    v_mfma_f32_16x16x32_bf16 v[96:99], v[56:59], a[48:51], v[40:43]
    v_mfma_f32_16x16x32_bf16 v[96:99], v[60:63], a[52:55], v[96:99]
    s_lshl_b32 s28, s28, 19
    v_exp_f32 v88, v88
    v_mfma_f32_16x16x32_bf16 v[96:99], v[64:67], a[56:59], v[96:99]
    v_exp_f32 v89, v89
    v_mfma_f32_16x16x32_bf16 v[96:99], v[68:71], a[60:63], v[96:99]
    s_add_u32 s49, s28, s29
    v_exp_f32 v90, v90
    v_mfma_f32_16x16x32_bf16 v[100:103], v[84:87], a[60:63], v[40:43]
    v_exp_f32 v91, v91
    v_mfma_f32_16x16x32_bf16 v[100:103], v[80:83], a[56:59], v[100:103]
    s_add_u32 m0, s33, 8448
    v_add_f32 v16, v16, v88
    v_add_f32 v17, v17, v89
    v_mfma_f32_16x16x32_bf16 v[100:103], v[76:79], a[52:55], v[100:103]
    v_cvt_pk_bf16_f32 v104, v88, v89
    v_mfma_f32_16x16x32_bf16 v[100:103], v[72:75], a[48:51], v[100:103]
    v_exp_f32 v92, v92
    v_mfma_f32_16x16x32_bf16 v[148:151], v[112:115], v[108:111], v[148:151]
    s_add_u32 s34, s34, 1
    v_exp_f32 v93, v93
    v_mfma_f32_16x16x32_bf16 v[176:179], v[116:119], v[108:111], v[176:179]
    v_add_f32 v16, v16, v90
    v_add_f32 v17, v17, v91
    v_mfma_f32_16x16x32_bf16 v[204:207], v[120:123], v[108:111], v[204:207]
    buffer_load_dwordx4 v7, s[4:7], s49 offen offset:0 nt lds
    v_cvt_pk_bf16_f32 v105, v90, v91
    v_mfma_f32_16x16x32_bf16 v[232:235], v[124:127], v[108:111], v[232:235]
    v_exp_f32 v94, v94
    v_mfma_f32_16x16x32_bf16 a[116:119], v[128:131], v[108:111], a[116:119]
    s_add_u32 m0, m0, s96
    v_exp_f32 v95, v95
    v_mfma_f32_16x16x32_bf16 a[144:147], v[132:135], v[108:111], a[144:147]
    v_add_f32 v16, v16, v92
    v_add_f32 v17, v17, v93
    v_mfma_f32_16x16x32_bf16 a[172:175], v[136:139], v[108:111], a[172:175]
    buffer_load_dwordx4 v7, s[4:7], s49 offen offset:256 nt lds
    v_cvt_pk_bf16_f32 v106, v92, v93
    v_add_f32 v16, v16, v94
    v_mfma_f32_16x16x32_bf16 a[200:203], v[140:143], v[108:111], a[200:203]
    v_add_f32 v17, v17, v95
    v_cvt_pk_bf16_f32 v107, v94, v95
    v_mfma_f32_16x16x32_bf16 v[88:91], v[56:59], a[64:67], v[44:47]
    v_mfma_f32_16x16x32_bf16 v[88:91], v[60:63], a[68:71], v[88:91]
    s_add_u32 m0, m0, s97
    v_exp_f32 v96, v96
    v_mfma_f32_16x16x32_bf16 v[88:91], v[64:67], a[72:75], v[88:91]
    v_exp_f32 v97, v97
    v_mfma_f32_16x16x32_bf16 v[88:91], v[68:71], a[76:79], v[88:91]
    buffer_load_dwordx4 v7, s[4:7], s49 offen offset:512 nt lds
    v_exp_f32 v98, v98
    v_mfma_f32_16x16x32_bf16 v[92:95], v[84:87], a[76:79], v[44:47]
    v_exp_f32 v99, v99
    v_mfma_f32_16x16x32_bf16 v[92:95], v[80:83], a[72:75], v[92:95]
    s_add_u32 m0, m0, s96
    v_add_f32 v18, v18, v96
    v_add_f32 v19, v19, v97
    v_mfma_f32_16x16x32_bf16 v[92:95], v[76:79], a[68:71], v[92:95]
    v_cvt_pk_bf16_f32 v108, v96, v97
    v_mfma_f32_16x16x32_bf16 v[92:95], v[72:75], a[64:67], v[92:95]
    v_exp_f32 v100, v100
    v_mfma_f32_16x16x32_bf16 v[152:155], v[112:115], v[104:107], v[152:155]
    buffer_load_dwordx4 v7, s[4:7], s49 offen offset:768 nt lds
    v_exp_f32 v101, v101
    v_mfma_f32_16x16x32_bf16 v[180:183], v[116:119], v[104:107], v[180:183]
    v_add_f32 v18, v18, v98
    v_add_f32 v19, v19, v99
    v_mfma_f32_16x16x32_bf16 v[208:211], v[120:123], v[104:107], v[208:211]
    s_add_u32 m0, m0, s97
    v_cvt_pk_bf16_f32 v109, v98, v99
    v_mfma_f32_16x16x32_bf16 v[236:239], v[124:127], v[104:107], v[236:239]
    v_exp_f32 v102, v102
    v_mfma_f32_16x16x32_bf16 a[120:123], v[128:131], v[104:107], a[120:123]
    buffer_load_dwordx4 v7, s[4:7], s49 offen offset:1024 nt lds
    v_exp_f32 v103, v103
    v_mfma_f32_16x16x32_bf16 a[148:151], v[132:135], v[104:107], a[148:151]
    v_add_f32 v18, v18, v100
    v_add_f32 v19, v19, v101
    v_mfma_f32_16x16x32_bf16 a[176:179], v[136:139], v[104:107], a[176:179]
    s_add_u32 m0, m0, s96
    v_cvt_pk_bf16_f32 v110, v100, v101
    v_add_f32 v18, v18, v102
    v_mfma_f32_16x16x32_bf16 a[204:207], v[140:143], v[104:107], a[204:207]
    v_add_f32 v19, v19, v103
    v_cvt_pk_bf16_f32 v111, v102, v103
    v_mfma_f32_16x16x32_bf16 v[96:99], v[56:59], a[80:83], v[48:51]
    v_mfma_f32_16x16x32_bf16 v[96:99], v[60:63], a[84:87], v[96:99]
    buffer_load_dwordx4 v7, s[4:7], s49 offen offset:1280 nt lds
    v_exp_f32 v88, v88
    v_mfma_f32_16x16x32_bf16 v[96:99], v[64:67], a[88:91], v[96:99]
    v_exp_f32 v89, v89
    v_mfma_f32_16x16x32_bf16 v[96:99], v[68:71], a[92:95], v[96:99]
    s_add_u32 m0, m0, s97
    v_exp_f32 v90, v90
    v_mfma_f32_16x16x32_bf16 v[100:103], v[84:87], a[92:95], v[48:51]
    v_exp_f32 v91, v91
    v_mfma_f32_16x16x32_bf16 v[100:103], v[80:83], a[88:91], v[100:103]
    buffer_load_dwordx4 v7, s[4:7], s49 offen offset:1536 nt lds
    v_add_f32 v20, v20, v88
    v_add_f32 v21, v21, v89
    v_mfma_f32_16x16x32_bf16 v[100:103], v[76:79], a[84:87], v[100:103]
    v_cvt_pk_bf16_f32 v104, v88, v89
    v_mfma_f32_16x16x32_bf16 v[100:103], v[72:75], a[80:83], v[100:103]
    v_exp_f32 v92, v92
    v_mfma_f32_16x16x32_bf16 v[156:159], v[112:115], v[108:111], v[156:159]
    s_add_u32 m0, m0, s96
    v_exp_f32 v93, v93
    v_mfma_f32_16x16x32_bf16 v[184:187], v[116:119], v[108:111], v[184:187]
    v_add_f32 v20, v20, v90
    v_add_f32 v21, v21, v91
    v_mfma_f32_16x16x32_bf16 v[212:215], v[120:123], v[108:111], v[212:215]
    buffer_load_dwordx4 v7, s[4:7], s49 offen offset:1792 nt lds
    v_cvt_pk_bf16_f32 v105, v90, v91
    v_mfma_f32_16x16x32_bf16 v[240:243], v[124:127], v[108:111], v[240:243]
    v_exp_f32 v94, v94
    v_mfma_f32_16x16x32_bf16 a[124:127], v[128:131], v[108:111], a[124:127]
    v_exp_f32 v95, v95
    v_mfma_f32_16x16x32_bf16 a[152:155], v[132:135], v[108:111], a[152:155]
    v_add_f32 v20, v20, v92
    v_add_f32 v21, v21, v93
    v_mfma_f32_16x16x32_bf16 a[180:183], v[136:139], v[108:111], a[180:183]
    v_cvt_pk_bf16_f32 v106, v92, v93
    v_add_f32 v20, v20, v94
    v_mfma_f32_16x16x32_bf16 a[208:211], v[140:143], v[108:111], a[208:211]
    v_add_f32 v21, v21, v95
    v_cvt_pk_bf16_f32 v107, v94, v95
    s_waitcnt vmcnt(16) lgkmcnt(0)
    s_barrier
    v_mfma_f32_16x16x32_bf16 v[88:91], v[56:59], a[96:99], v[52:55]
    ds_read_b128 v[56:59], v8 offset:25344
    v_mfma_f32_16x16x32_bf16 v[88:91], v[60:63], a[100:103], v[88:91]
    ds_read_b128 v[60:63], v8 offset:25408
    v_exp_f32 v96, v96
    v_mfma_f32_16x16x32_bf16 v[88:91], v[64:67], a[104:107], v[88:91]
    ds_read_b128 v[64:67], v8 offset:25472
    v_exp_f32 v97, v97
    v_mfma_f32_16x16x32_bf16 v[88:91], v[68:71], a[108:111], v[88:91]
    ds_read_b128 v[68:71], v8 offset:25536
    v_exp_f32 v98, v98
    v_mfma_f32_16x16x32_bf16 v[92:95], v[84:87], a[108:111], v[52:55]
    ds_read_b128 v[84:87], v8 offset:26048
    v_exp_f32 v99, v99
    v_mfma_f32_16x16x32_bf16 v[92:95], v[80:83], a[104:107], v[92:95]
    ds_read_b128 v[80:83], v8 offset:25984
    v_add_f32 v22, v22, v96
    v_add_f32 v23, v23, v97
    v_mfma_f32_16x16x32_bf16 v[92:95], v[76:79], a[100:103], v[92:95]
    ds_read_b128 v[76:79], v8 offset:25920
    v_cvt_pk_bf16_f32 v108, v96, v97
    v_mfma_f32_16x16x32_bf16 v[92:95], v[72:75], a[96:99], v[92:95]
    ds_read_b128 v[72:75], v8 offset:25856
    v_exp_f32 v100, v100
    v_mfma_f32_16x16x32_bf16 v[160:163], v[112:115], v[104:107], v[160:163]
    v_exp_f32 v101, v101
    v_mfma_f32_16x16x32_bf16 v[188:191], v[116:119], v[104:107], v[188:191]
    v_add_f32 v22, v22, v98
    v_add_f32 v23, v23, v99
    v_mfma_f32_16x16x32_bf16 v[216:219], v[120:123], v[104:107], v[216:219]
    v_cvt_pk_bf16_f32 v109, v98, v99
    v_mfma_f32_16x16x32_bf16 v[244:247], v[124:127], v[104:107], v[244:247]
    v_exp_f32 v102, v102
    v_mfma_f32_16x16x32_bf16 a[128:131], v[128:131], v[104:107], a[128:131]
    v_exp_f32 v103, v103
    v_mfma_f32_16x16x32_bf16 a[156:159], v[132:135], v[104:107], a[156:159]
    v_add_f32 v22, v22, v100
    v_add_f32 v23, v23, v101
    v_mfma_f32_16x16x32_bf16 a[184:187], v[136:139], v[104:107], a[184:187]
    v_cvt_pk_bf16_f32 v110, v100, v101
    v_add_f32 v22, v22, v102
    v_mfma_f32_16x16x32_bf16 a[212:215], v[140:143], v[104:107], a[212:215]
    v_add_f32 v23, v23, v103
    v_cvt_pk_bf16_f32 v111, v102, v103
    s_waitcnt lgkmcnt(0)
    v_mfma_f32_16x16x32_bf16 v[96:99], v[56:59], a[0:3], v[28:31]
    v_mfma_f32_16x16x32_bf16 v[96:99], v[60:63], a[4:7], v[96:99]
    v_exp_f32 v88, v88
    v_mfma_f32_16x16x32_bf16 v[96:99], v[64:67], a[8:11], v[96:99]
    v_exp_f32 v89, v89
    v_mfma_f32_16x16x32_bf16 v[96:99], v[68:71], a[12:15], v[96:99]
    v_exp_f32 v90, v90
    v_mfma_f32_16x16x32_bf16 v[100:103], v[84:87], a[12:15], v[28:31]
    v_exp_f32 v91, v91
    v_mfma_f32_16x16x32_bf16 v[100:103], v[80:83], a[8:11], v[100:103]
    v_add_f32 v24, v24, v88
    v_add_f32 v25, v25, v89
    v_mfma_f32_16x16x32_bf16 v[100:103], v[76:79], a[4:7], v[100:103]
    v_cvt_pk_bf16_f32 v104, v88, v89
    v_mfma_f32_16x16x32_bf16 v[100:103], v[72:75], a[0:3], v[100:103]
    v_exp_f32 v92, v92
    v_mfma_f32_16x16x32_bf16 v[164:167], v[112:115], v[108:111], v[164:167]
    v_exp_f32 v93, v93
    v_mfma_f32_16x16x32_bf16 v[192:195], v[116:119], v[108:111], v[192:195]
    v_add_f32 v24, v24, v90
    v_add_f32 v25, v25, v91
    v_mfma_f32_16x16x32_bf16 v[220:223], v[120:123], v[108:111], v[220:223]
    v_cvt_pk_bf16_f32 v105, v90, v91
    v_mfma_f32_16x16x32_bf16 v[248:251], v[124:127], v[108:111], v[248:251]
    v_exp_f32 v94, v94
    v_mfma_f32_16x16x32_bf16 a[132:135], v[128:131], v[108:111], a[132:135]
    v_exp_f32 v95, v95
    v_mfma_f32_16x16x32_bf16 a[160:163], v[132:135], v[108:111], a[160:163]
    v_add_f32 v24, v24, v92
    v_add_f32 v25, v25, v93
    v_mfma_f32_16x16x32_bf16 a[188:191], v[136:139], v[108:111], a[188:191]
    v_cvt_pk_bf16_f32 v106, v92, v93
    v_add_f32 v24, v24, v94
    v_mfma_f32_16x16x32_bf16 a[216:219], v[140:143], v[108:111], a[216:219]
    v_add_f32 v25, v25, v95
    v_cvt_pk_bf16_f32 v107, v94, v95
    v_mfma_f32_16x16x32_bf16 v[88:91], v[56:59], a[16:19], v[32:35]
    v_mfma_f32_16x16x32_bf16 v[88:91], v[60:63], a[20:23], v[88:91]
    v_exp_f32 v96, v96
    v_mfma_f32_16x16x32_bf16 v[88:91], v[64:67], a[24:27], v[88:91]
    v_exp_f32 v97, v97
    v_mfma_f32_16x16x32_bf16 v[88:91], v[68:71], a[28:31], v[88:91]
    v_exp_f32 v98, v98
    v_mfma_f32_16x16x32_bf16 v[92:95], v[84:87], a[28:31], v[32:35]
    v_exp_f32 v99, v99
    v_mfma_f32_16x16x32_bf16 v[92:95], v[80:83], a[24:27], v[92:95]
    v_add_f32 v12, v12, v96
    v_add_f32 v13, v13, v97
    v_mfma_f32_16x16x32_bf16 v[92:95], v[76:79], a[20:23], v[92:95]
    v_cvt_pk_bf16_f32 v108, v96, v97
    v_mfma_f32_16x16x32_bf16 v[92:95], v[72:75], a[16:19], v[92:95]
    v_exp_f32 v100, v100
    v_mfma_f32_16x16x32_bf16 v[168:171], v[112:115], v[104:107], v[168:171]
    ds_read_b64_tr_b16 v[112:113], v9 offset:25344
    ds_read_b64_tr_b16 v[114:115], v9 offset:25856
    v_exp_f32 v101, v101
    v_mfma_f32_16x16x32_bf16 v[196:199], v[116:119], v[104:107], v[196:199]
    ds_read_b64_tr_b16 v[116:117], v9 offset:25376
    ds_read_b64_tr_b16 v[118:119], v9 offset:25888
    v_add_f32 v12, v12, v98
    v_add_f32 v13, v13, v99
    v_mfma_f32_16x16x32_bf16 v[224:227], v[120:123], v[104:107], v[224:227]
    ds_read_b64_tr_b16 v[120:121], v9 offset:25408
    ds_read_b64_tr_b16 v[122:123], v9 offset:25920
    v_cvt_pk_bf16_f32 v109, v98, v99
    v_mfma_f32_16x16x32_bf16 v[252:255], v[124:127], v[104:107], v[252:255]
    ds_read_b64_tr_b16 v[124:125], v9 offset:25440
    ds_read_b64_tr_b16 v[126:127], v9 offset:25952
    v_exp_f32 v102, v102
    v_mfma_f32_16x16x32_bf16 a[136:139], v[128:131], v[104:107], a[136:139]
    ds_read_b64_tr_b16 v[128:129], v9 offset:25472
    ds_read_b64_tr_b16 v[130:131], v9 offset:25984
    v_exp_f32 v103, v103
    v_mfma_f32_16x16x32_bf16 a[164:167], v[132:135], v[104:107], a[164:167]
    ds_read_b64_tr_b16 v[132:133], v9 offset:25504
    ds_read_b64_tr_b16 v[134:135], v9 offset:26016
    v_add_f32 v12, v12, v100
    v_add_f32 v13, v13, v101
    v_mfma_f32_16x16x32_bf16 a[192:195], v[136:139], v[104:107], a[192:195]
    ds_read_b64_tr_b16 v[136:137], v9 offset:25536
    ds_read_b64_tr_b16 v[138:139], v9 offset:26048
    v_cvt_pk_bf16_f32 v110, v100, v101
    v_add_f32 v12, v12, v102
    v_mfma_f32_16x16x32_bf16 a[220:223], v[140:143], v[104:107], a[220:223]
    ds_read_b64_tr_b16 v[140:141], v9 offset:25568
    ds_read_b64_tr_b16 v[142:143], v9 offset:26080
    v_add_f32 v13, v13, v103
    v_cvt_pk_bf16_f32 v111, v102, v103
    v_mfma_f32_16x16x32_bf16 v[96:99], v[56:59], a[32:35], v[36:39]
    v_mfma_f32_16x16x32_bf16 v[96:99], v[60:63], a[36:39], v[96:99]
    s_add_u32 s29, s34, s100
    v_exp_f32 v88, v88
    v_mfma_f32_16x16x32_bf16 v[96:99], v[64:67], a[40:43], v[96:99]
    v_exp_f32 v89, v89
    v_mfma_f32_16x16x32_bf16 v[96:99], v[68:71], a[44:47], v[96:99]
    s_bfe_u32 s28, s29, 0x20003
    v_exp_f32 v90, v90
    v_mfma_f32_16x16x32_bf16 v[100:103], v[84:87], a[44:47], v[36:39]
    v_exp_f32 v91, v91
    v_mfma_f32_16x16x32_bf16 v[100:103], v[80:83], a[40:43], v[100:103]
    s_lshl_b32 s28, s28, 16
    v_add_f32 v14, v14, v88
    v_add_f32 v15, v15, v89
    v_mfma_f32_16x16x32_bf16 v[100:103], v[76:79], a[36:39], v[100:103]
    v_cvt_pk_bf16_f32 v104, v88, v89
    v_mfma_f32_16x16x32_bf16 v[100:103], v[72:75], a[32:35], v[100:103]
    v_exp_f32 v92, v92
    s_waitcnt lgkmcnt(0)
    v_mfma_f32_16x16x32_bf16 v[144:147], v[112:115], v[108:111], v[144:147]
    s_and_b32 s29, s29, 7
    v_exp_f32 v93, v93
    v_mfma_f32_16x16x32_bf16 v[172:175], v[116:119], v[108:111], v[172:175]
    v_add_f32 v14, v14, v90
    v_add_f32 v15, v15, v91
    v_mfma_f32_16x16x32_bf16 v[200:203], v[120:123], v[108:111], v[200:203]
    s_lshl_b32 s29, s29, 11
    v_cvt_pk_bf16_f32 v105, v90, v91
    v_mfma_f32_16x16x32_bf16 v[228:231], v[124:127], v[108:111], v[228:231]
    v_exp_f32 v94, v94
    v_mfma_f32_16x16x32_bf16 a[112:115], v[128:131], v[108:111], a[112:115]
    s_add_u32 s29, s28, s29
    v_exp_f32 v95, v95
    v_mfma_f32_16x16x32_bf16 a[140:143], v[132:135], v[108:111], a[140:143]
    v_add_f32 v14, v14, v92
    v_add_f32 v15, v15, v93
    v_mfma_f32_16x16x32_bf16 a[168:171], v[136:139], v[108:111], a[168:171]
    s_lshr_b32 s28, s34, 5
    v_cvt_pk_bf16_f32 v106, v92, v93
    v_add_f32 v14, v14, v94
    v_mfma_f32_16x16x32_bf16 a[196:199], v[140:143], v[108:111], a[196:199]
    v_add_f32 v15, v15, v95
    v_cvt_pk_bf16_f32 v107, v94, v95
    v_mfma_f32_16x16x32_bf16 v[88:91], v[56:59], a[48:51], v[40:43]
    v_mfma_f32_16x16x32_bf16 v[88:91], v[60:63], a[52:55], v[88:91]
    s_lshl_b32 s28, s28, 19
    v_exp_f32 v96, v96
    v_mfma_f32_16x16x32_bf16 v[88:91], v[64:67], a[56:59], v[88:91]
    v_exp_f32 v97, v97
    v_mfma_f32_16x16x32_bf16 v[88:91], v[68:71], a[60:63], v[88:91]
    s_add_u32 s49, s28, s29
    v_exp_f32 v98, v98
    v_mfma_f32_16x16x32_bf16 v[92:95], v[84:87], a[60:63], v[40:43]
    v_exp_f32 v99, v99
    v_mfma_f32_16x16x32_bf16 v[92:95], v[80:83], a[56:59], v[92:95]
    s_add_u32 m0, s33, 16896
    v_add_f32 v16, v16, v96
    v_add_f32 v17, v17, v97
    v_mfma_f32_16x16x32_bf16 v[92:95], v[76:79], a[52:55], v[92:95]
    v_cvt_pk_bf16_f32 v108, v96, v97
    v_mfma_f32_16x16x32_bf16 v[92:95], v[72:75], a[48:51], v[92:95]
    v_exp_f32 v100, v100
    v_mfma_f32_16x16x32_bf16 v[148:151], v[112:115], v[104:107], v[148:151]
    s_add_u32 s34, s34, 1
    v_exp_f32 v101, v101
    v_mfma_f32_16x16x32_bf16 v[176:179], v[116:119], v[104:107], v[176:179]
    v_add_f32 v16, v16, v98
    v_add_f32 v17, v17, v99
    v_mfma_f32_16x16x32_bf16 v[204:207], v[120:123], v[104:107], v[204:207]
    buffer_load_dwordx4 v7, s[4:7], s49 offen offset:0 nt lds
    v_cvt_pk_bf16_f32 v109, v98, v99
    v_mfma_f32_16x16x32_bf16 v[232:235], v[124:127], v[104:107], v[232:235]
    v_exp_f32 v102, v102
    v_mfma_f32_16x16x32_bf16 a[116:119], v[128:131], v[104:107], a[116:119]
    s_add_u32 m0, m0, s96
    v_exp_f32 v103, v103
    v_mfma_f32_16x16x32_bf16 a[144:147], v[132:135], v[104:107], a[144:147]
    v_add_f32 v16, v16, v100
    v_add_f32 v17, v17, v101
    v_mfma_f32_16x16x32_bf16 a[172:175], v[136:139], v[104:107], a[172:175]
    buffer_load_dwordx4 v7, s[4:7], s49 offen offset:256 nt lds
    v_cvt_pk_bf16_f32 v110, v100, v101
    v_add_f32 v16, v16, v102
    v_mfma_f32_16x16x32_bf16 a[200:203], v[140:143], v[104:107], a[200:203]
    v_add_f32 v17, v17, v103
    v_cvt_pk_bf16_f32 v111, v102, v103
    v_mfma_f32_16x16x32_bf16 v[96:99], v[56:59], a[64:67], v[44:47]
    v_mfma_f32_16x16x32_bf16 v[96:99], v[60:63], a[68:71], v[96:99]
    s_add_u32 m0, m0, s97
    v_exp_f32 v88, v88
    v_mfma_f32_16x16x32_bf16 v[96:99], v[64:67], a[72:75], v[96:99]
    v_exp_f32 v89, v89
    v_mfma_f32_16x16x32_bf16 v[96:99], v[68:71], a[76:79], v[96:99]
    buffer_load_dwordx4 v7, s[4:7], s49 offen offset:512 nt lds
    v_exp_f32 v90, v90
    v_mfma_f32_16x16x32_bf16 v[100:103], v[84:87], a[76:79], v[44:47]
    v_exp_f32 v91, v91
    v_mfma_f32_16x16x32_bf16 v[100:103], v[80:83], a[72:75], v[100:103]
    s_add_u32 m0, m0, s96
    v_add_f32 v18, v18, v88
    v_add_f32 v19, v19, v89
    v_mfma_f32_16x16x32_bf16 v[100:103], v[76:79], a[68:71], v[100:103]
    v_cvt_pk_bf16_f32 v104, v88, v89
    v_mfma_f32_16x16x32_bf16 v[100:103], v[72:75], a[64:67], v[100:103]
    v_exp_f32 v92, v92
    v_mfma_f32_16x16x32_bf16 v[152:155], v[112:115], v[108:111], v[152:155]
    buffer_load_dwordx4 v7, s[4:7], s49 offen offset:768 nt lds
    v_exp_f32 v93, v93
    v_mfma_f32_16x16x32_bf16 v[180:183], v[116:119], v[108:111], v[180:183]
    v_add_f32 v18, v18, v90
    v_add_f32 v19, v19, v91
    v_mfma_f32_16x16x32_bf16 v[208:211], v[120:123], v[108:111], v[208:211]
    s_add_u32 m0, m0, s97
    v_cvt_pk_bf16_f32 v105, v90, v91
    v_mfma_f32_16x16x32_bf16 v[236:239], v[124:127], v[108:111], v[236:239]
    v_exp_f32 v94, v94
    v_mfma_f32_16x16x32_bf16 a[120:123], v[128:131], v[108:111], a[120:123]
    buffer_load_dwordx4 v7, s[4:7], s49 offen offset:1024 nt lds
    v_exp_f32 v95, v95
    v_mfma_f32_16x16x32_bf16 a[148:151], v[132:135], v[108:111], a[148:151]
    v_add_f32 v18, v18, v92
    v_add_f32 v19, v19, v93
    v_mfma_f32_16x16x32_bf16 a[176:179], v[136:139], v[108:111], a[176:179]
    s_add_u32 m0, m0, s96
    v_cvt_pk_bf16_f32 v106, v92, v93
    v_add_f32 v18, v18, v94
    v_mfma_f32_16x16x32_bf16 a[204:207], v[140:143], v[108:111], a[204:207]
    v_add_f32 v19, v19, v95
    v_cvt_pk_bf16_f32 v107, v94, v95
    v_mfma_f32_16x16x32_bf16 v[88:91], v[56:59], a[80:83], v[48:51]
    v_mfma_f32_16x16x32_bf16 v[88:91], v[60:63], a[84:87], v[88:91]
    buffer_load_dwordx4 v7, s[4:7], s49 offen offset:1280 nt lds
    v_exp_f32 v96, v96
    v_mfma_f32_16x16x32_bf16 v[88:91], v[64:67], a[88:91], v[88:91]
    v_exp_f32 v97, v97
    v_mfma_f32_16x16x32_bf16 v[88:91], v[68:71], a[92:95], v[88:91]
    s_add_u32 m0, m0, s97
    v_exp_f32 v98, v98
    v_mfma_f32_16x16x32_bf16 v[92:95], v[84:87], a[92:95], v[48:51]
    v_exp_f32 v99, v99
    v_mfma_f32_16x16x32_bf16 v[92:95], v[80:83], a[88:91], v[92:95]
    buffer_load_dwordx4 v7, s[4:7], s49 offen offset:1536 nt lds
    v_add_f32 v20, v20, v96
    v_add_f32 v21, v21, v97
    v_mfma_f32_16x16x32_bf16 v[92:95], v[76:79], a[84:87], v[92:95]
    v_cvt_pk_bf16_f32 v108, v96, v97
    v_mfma_f32_16x16x32_bf16 v[92:95], v[72:75], a[80:83], v[92:95]
    v_exp_f32 v100, v100
    v_mfma_f32_16x16x32_bf16 v[156:159], v[112:115], v[104:107], v[156:159]
    s_add_u32 m0, m0, s96
    v_exp_f32 v101, v101
    v_mfma_f32_16x16x32_bf16 v[184:187], v[116:119], v[104:107], v[184:187]
    v_add_f32 v20, v20, v98
    v_add_f32 v21, v21, v99
    v_mfma_f32_16x16x32_bf16 v[212:215], v[120:123], v[104:107], v[212:215]
    buffer_load_dwordx4 v7, s[4:7], s49 offen offset:1792 nt lds
    v_cvt_pk_bf16_f32 v109, v98, v99
    v_mfma_f32_16x16x32_bf16 v[240:243], v[124:127], v[104:107], v[240:243]
    v_exp_f32 v102, v102
    v_mfma_f32_16x16x32_bf16 a[124:127], v[128:131], v[104:107], a[124:127]
    v_exp_f32 v103, v103
    v_mfma_f32_16x16x32_bf16 a[152:155], v[132:135], v[104:107], a[152:155]
    v_add_f32 v20, v20, v100
    v_add_f32 v21, v21, v101
    v_mfma_f32_16x16x32_bf16 a[180:183], v[136:139], v[104:107], a[180:183]
    v_cvt_pk_bf16_f32 v110, v100, v101
    v_add_f32 v20, v20, v102
    v_mfma_f32_16x16x32_bf16 a[208:211], v[140:143], v[104:107], a[208:211]
    v_add_f32 v21, v21, v103
    v_cvt_pk_bf16_f32 v111, v102, v103
    s_waitcnt vmcnt(16) lgkmcnt(0)
    s_barrier
    v_mfma_f32_16x16x32_bf16 v[96:99], v[56:59], a[96:99], v[52:55]
    ds_read_b128 v[56:59], v8 offset:0
    s_add_u32 s29, s34, s100
    v_mfma_f32_16x16x32_bf16 v[96:99], v[60:63], a[100:103], v[96:99]
    ds_read_b128 v[60:63], v8 offset:64
    s_bfe_u32 s28, s29, 0x20003
    v_exp_f32 v88, v88
    v_mfma_f32_16x16x32_bf16 v[96:99], v[64:67], a[104:107], v[96:99]
    ds_read_b128 v[64:67], v8 offset:128
    s_lshl_b32 s28, s28, 16
    v_exp_f32 v89, v89
    v_mfma_f32_16x16x32_bf16 v[96:99], v[68:71], a[108:111], v[96:99]
    ds_read_b128 v[68:71], v8 offset:192
    s_and_b32 s29, s29, 7
    v_exp_f32 v90, v90
    v_mfma_f32_16x16x32_bf16 v[100:103], v[84:87], a[108:111], v[52:55]
    ds_read_b128 v[84:87], v8 offset:704
    s_lshl_b32 s29, s29, 11
    v_exp_f32 v91, v91
    v_mfma_f32_16x16x32_bf16 v[100:103], v[80:83], a[104:107], v[100:103]
    ds_read_b128 v[80:83], v8 offset:640
    s_add_u32 s29, s28, s29
    v_add_f32 v22, v22, v88
    v_add_f32 v23, v23, v89
    v_mfma_f32_16x16x32_bf16 v[100:103], v[76:79], a[100:103], v[100:103]
    ds_read_b128 v[76:79], v8 offset:576
    s_lshr_b32 s28, s34, 5
    v_cvt_pk_bf16_f32 v104, v88, v89
    v_mfma_f32_16x16x32_bf16 v[100:103], v[72:75], a[96:99], v[100:103]
    ds_read_b128 v[72:75], v8 offset:512
    s_lshl_b32 s28, s28, 19
    v_exp_f32 v92, v92
    v_mfma_f32_16x16x32_bf16 v[160:163], v[112:115], v[108:111], v[160:163]
    s_add_u32 s49, s28, s29
    s_add_u32 m0, s33, 25344
    v_exp_f32 v93, v93
    v_mfma_f32_16x16x32_bf16 v[188:191], v[116:119], v[108:111], v[188:191]
    s_add_u32 s34, s34, 1
    v_add_f32 v22, v22, v90
    v_add_f32 v23, v23, v91
    v_mfma_f32_16x16x32_bf16 v[216:219], v[120:123], v[108:111], v[216:219]
    s_nop 0
    v_cvt_pk_bf16_f32 v105, v90, v91
    v_mfma_f32_16x16x32_bf16 v[244:247], v[124:127], v[108:111], v[244:247]
    buffer_load_dwordx4 v7, s[4:7], s49 offen offset:0 nt lds
    v_exp_f32 v94, v94
    v_mfma_f32_16x16x32_bf16 a[128:131], v[128:131], v[108:111], a[128:131]
    s_add_u32 m0, m0, s96
    v_exp_f32 v95, v95
    v_mfma_f32_16x16x32_bf16 a[156:159], v[132:135], v[108:111], a[156:159]
    s_nop 0
    v_add_f32 v22, v22, v92
    v_add_f32 v23, v23, v93
    v_mfma_f32_16x16x32_bf16 a[184:187], v[136:139], v[108:111], a[184:187]
    buffer_load_dwordx4 v7, s[4:7], s49 offen offset:256 nt lds
    v_cvt_pk_bf16_f32 v106, v92, v93
    v_add_f32 v22, v22, v94
    v_mfma_f32_16x16x32_bf16 a[212:215], v[140:143], v[108:111], a[212:215]
    s_add_u32 m0, m0, s97
    v_add_f32 v23, v23, v95
    v_cvt_pk_bf16_f32 v107, v94, v95
    s_lshl_b32 s30, s2, 2
    s_add_u32 s30, s30, s20
    s_mul_i32 s30, s30, 28672
    v_lshlrev_b32 v4, 4, v1
    buffer_load_dwordx4 a[0:3], v4, s[12:15], s30 offen offset:0
    buffer_load_dwordx4 a[4:7], v4, s[12:15], s30 offen offset:1024
    buffer_load_dwordx4 a[8:11], v4, s[12:15], s30 offen offset:2048
    buffer_load_dwordx4 a[12:15], v4, s[12:15], s30 offen offset:3072
    s_add_u32 s30, s30, 4096
    buffer_load_dwordx4 a[16:19], v4, s[12:15], s30 offen offset:0
    buffer_load_dwordx4 a[20:23], v4, s[12:15], s30 offen offset:1024
    buffer_load_dwordx4 a[24:27], v4, s[12:15], s30 offen offset:2048
    buffer_load_dwordx4 a[28:31], v4, s[12:15], s30 offen offset:3072
    s_add_u32 s30, s30, 4096
    buffer_load_dwordx4 a[32:35], v4, s[12:15], s30 offen offset:0
    buffer_load_dwordx4 a[36:39], v4, s[12:15], s30 offen offset:1024
    buffer_load_dwordx4 a[40:43], v4, s[12:15], s30 offen offset:2048
    buffer_load_dwordx4 a[44:47], v4, s[12:15], s30 offen offset:3072
    s_add_u32 s30, s30, 4096
    buffer_load_dwordx4 a[48:51], v4, s[12:15], s30 offen offset:0
    buffer_load_dwordx4 a[52:55], v4, s[12:15], s30 offen offset:1024
    buffer_load_dwordx4 a[56:59], v4, s[12:15], s30 offen offset:2048
    buffer_load_dwordx4 a[60:63], v4, s[12:15], s30 offen offset:3072
    s_add_u32 s30, s30, 4096
    buffer_load_dwordx4 a[64:67], v4, s[12:15], s30 offen offset:0
    buffer_load_dwordx4 a[68:71], v4, s[12:15], s30 offen offset:1024
    buffer_load_dwordx4 a[72:75], v4, s[12:15], s30 offen offset:2048
    buffer_load_dwordx4 a[76:79], v4, s[12:15], s30 offen offset:3072
    s_add_u32 s30, s30, 4096
    buffer_load_dwordx4 a[80:83], v4, s[12:15], s30 offen offset:0
    buffer_load_dwordx4 a[84:87], v4, s[12:15], s30 offen offset:1024
    buffer_load_dwordx4 a[88:91], v4, s[12:15], s30 offen offset:2048
    buffer_load_dwordx4 a[92:95], v4, s[12:15], s30 offen offset:3072
    s_add_u32 s30, s30, 4096
    buffer_load_dwordx4 a[96:99], v4, s[12:15], s30 offen offset:0
    buffer_load_dwordx4 a[100:103], v4, s[12:15], s30 offen offset:1024
    buffer_load_dwordx4 a[104:107], v4, s[12:15], s30 offen offset:2048
    buffer_load_dwordx4 a[108:111], v4, s[12:15], s30 offen offset:3072
    s_nop 1
    v_mfma_f32_16x16x32_bf16 v[164:167], v[112:115], v[104:107], v[164:167]
    s_nop 0
    buffer_load_dwordx4 v7, s[4:7], s49 offen offset:512 nt lds
    v_exp_f32 v96, v96
    v_mfma_f32_16x16x32_bf16 v[192:195], v[116:119], v[104:107], v[192:195]
    s_add_u32 m0, m0, s96
    s_nop 0
    v_exp_f32 v97, v97
    v_exp_f32 v98, v98
    v_mfma_f32_16x16x32_bf16 v[220:223], v[120:123], v[104:107], v[220:223]
    buffer_load_dwordx4 v7, s[4:7], s49 offen offset:768 nt lds
    s_add_u32 m0, m0, s97
    v_exp_f32 v99, v99
    v_add_f32 v24, v24, v96
    v_add_f32 v25, v25, v97
    v_mfma_f32_16x16x32_bf16 v[248:251], v[124:127], v[104:107], v[248:251]
    s_nop 0
    buffer_load_dwordx4 v7, s[4:7], s49 offen offset:1024 nt lds
    v_cvt_pk_bf16_f32 v108, v96, v97
    v_exp_f32 v100, v100
    v_mfma_f32_16x16x32_bf16 a[132:135], v[128:131], v[104:107], a[132:135]
    s_add_u32 m0, m0, s96
    s_nop 0
    buffer_load_dwordx4 v7, s[4:7], s49 offen offset:1280 nt lds
    v_exp_f32 v101, v101
    v_add_f32 v24, v24, v98
    v_add_f32 v25, v25, v99
    v_mfma_f32_16x16x32_bf16 a[160:163], v[132:135], v[104:107], a[160:163]
    s_add_u32 m0, m0, s97
    s_nop 0
    v_cvt_pk_bf16_f32 v109, v98, v99
    v_exp_f32 v102, v102
    v_mfma_f32_16x16x32_bf16 a[188:191], v[136:139], v[104:107], a[188:191]
    buffer_load_dwordx4 v7, s[4:7], s49 offen offset:1536 nt lds
    s_add_u32 m0, m0, s96
    v_exp_f32 v103, v103
    v_add_f32 v24, v24, v100
    v_add_f32 v25, v25, v101
    v_mfma_f32_16x16x32_bf16 a[216:219], v[140:143], v[104:107], a[216:219]
    s_nop 0
    buffer_load_dwordx4 v7, s[4:7], s49 offen offset:1792 nt lds
    v_cvt_pk_bf16_f32 v110, v100, v101
    v_add_f32 v24, v24, v102
    v_add_f32 v25, v25, v103
    v_cvt_pk_bf16_f32 v111, v102, v103
L_at_aepi:
    s_nop 1
    s_waitcnt lgkmcnt(0)
    v_mfma_f32_16x16x32_bf16 v[168:171], v[112:115], v[108:111], v[168:171]
    v_add_f32 v12, v12, v13
    v_add_f32 v14, v14, v15
    v_add_f32 v16, v16, v17
    v_add_f32 v18, v18, v19
    v_add_f32 v20, v20, v21
    v_add_f32 v22, v22, v23
    v_mfma_f32_16x16x32_bf16 v[196:199], v[116:119], v[108:111], v[196:199]
    v_add_f32 v24, v24, v25
    v_mov_b32 v88, v12
    v_mov_b32 v89, v14
    v_mov_b32 v90, v16
    v_mov_b32 v91, v18
    v_mov_b32 v92, v20
    v_mfma_f32_16x16x32_bf16 v[224:227], v[120:123], v[108:111], v[224:227]
    v_mov_b32 v93, v22
    v_mov_b32 v94, v24
    v_permlane16_swap_b32 v12, v88
    v_permlane16_swap_b32 v14, v89
    v_permlane16_swap_b32 v16, v90
    v_permlane16_swap_b32 v18, v91
    v_mfma_f32_16x16x32_bf16 v[252:255], v[124:127], v[108:111], v[252:255]
    v_permlane16_swap_b32 v20, v92
    v_permlane16_swap_b32 v22, v93
    v_permlane16_swap_b32 v24, v94
    v_add_f32 v12, v12, v88
    v_add_f32 v14, v14, v89
    v_add_f32 v16, v16, v90
    v_mfma_f32_16x16x32_bf16 a[136:139], v[128:131], v[108:111], a[136:139]
    v_add_f32 v18, v18, v91
    v_add_f32 v20, v20, v92
    v_add_f32 v22, v22, v93
    v_add_f32 v24, v24, v94
    v_mov_b32 v88, v12
    v_mov_b32 v89, v14
    v_mfma_f32_16x16x32_bf16 a[164:167], v[132:135], v[108:111], a[164:167]
    v_mov_b32 v90, v16
    v_mov_b32 v91, v18
    v_mov_b32 v92, v20
    v_mov_b32 v93, v22
    v_mov_b32 v94, v24
    v_permlane32_swap_b32 v12, v88
    v_mfma_f32_16x16x32_bf16 a[192:195], v[136:139], v[108:111], a[192:195]
    v_permlane32_swap_b32 v14, v89
    v_permlane32_swap_b32 v16, v90
    v_permlane32_swap_b32 v18, v91
    v_permlane32_swap_b32 v20, v92
    v_permlane32_swap_b32 v22, v93
    v_permlane32_swap_b32 v24, v94
    v_mfma_f32_16x16x32_bf16 a[220:223], v[140:143], v[108:111], a[220:223]
    v_add_f32 v12, v12, v88
    v_add_f32 v14, v14, v89
    v_add_f32 v16, v16, v90
    v_add_f32 v18, v18, v91
    v_add_f32 v20, v20, v92
    v_add_f32 v22, v22, v93
    v_add_f32 v24, v24, v94
    v_rcp_f32 v28, v12
    v_rcp_f32 v32, v14
    v_rcp_f32 v36, v16
    v_rcp_f32 v40, v18
    v_rcp_f32 v44, v20
    v_rcp_f32 v48, v22
    v_rcp_f32 v52, v24
    v_add_f32 v90, v12, v14
    v_add_f32 v91, v16, v18
    v_add_f32 v92, v20, v22
    v_add_f32 v90, v90, v24
    v_add_f32 v91, v91, v92
    v_add_f32 v90, v90, v91
    v_cmp_nge_f32 vcc, s32, v90
    v_mov_b32 v12, 0xff800000
    v_mov_b32 v14, 0xff800000
    v_mov_b32 v16, 0xff800000
    v_mov_b32 v18, 0xff800000
    v_mov_b32 v20, 0xff800000
    v_mov_b32 v22, 0xff800000
    v_mov_b32 v24, 0xff800000
    s_cmp_eq_u64 vcc, 0
    s_cbranch_scc1 L_at_noflag
    s_lshl_b32 s29, s21, 2
    s_add_u32 s29, s29, 75996
    v_mov_b32 v90, s29
    v_mov_b32 v91, 1
    ds_write_b32 v90, v91
L_at_noflag:
    s_mul_i32 s31, s21, 114688
    s_add_u32 s31, s31, s24
    s_sub_u32 s31, s31, 114688
    v_pk_mul_f32 v[144:145], v[144:145], v[28:29] op_sel_hi:[1,0]
    v_pk_mul_f32 v[146:147], v[146:147], v[28:29] op_sel_hi:[1,0]
    v_pk_mul_f32 v[148:149], v[148:149], v[32:33] op_sel_hi:[1,0]
    v_pk_mul_f32 v[150:151], v[150:151], v[32:33] op_sel_hi:[1,0]
    v_pk_mul_f32 v[152:153], v[152:153], v[36:37] op_sel_hi:[1,0]
    v_pk_mul_f32 v[154:155], v[154:155], v[36:37] op_sel_hi:[1,0]
    v_pk_mul_f32 v[156:157], v[156:157], v[40:41] op_sel_hi:[1,0]
    v_pk_mul_f32 v[158:159], v[158:159], v[40:41] op_sel_hi:[1,0]
    v_pk_mul_f32 v[160:161], v[160:161], v[44:45] op_sel_hi:[1,0]
    v_pk_mul_f32 v[162:163], v[162:163], v[44:45] op_sel_hi:[1,0]
    v_pk_mul_f32 v[164:165], v[164:165], v[48:49] op_sel_hi:[1,0]
    v_pk_mul_f32 v[166:167], v[166:167], v[48:49] op_sel_hi:[1,0]
    v_pk_mul_f32 v[168:169], v[168:169], v[52:53] op_sel_hi:[1,0]
    v_pk_mul_f32 v[170:171], v[170:171], v[52:53] op_sel_hi:[1,0]
    v_pk_mul_f32 v[172:173], v[172:173], v[28:29] op_sel_hi:[1,0]
    v_pk_mul_f32 v[174:175], v[174:175], v[28:29] op_sel_hi:[1,0]
    v_pk_mul_f32 v[176:177], v[176:177], v[32:33] op_sel_hi:[1,0]
    v_pk_mul_f32 v[178:179], v[178:179], v[32:33] op_sel_hi:[1,0]
    v_pk_mul_f32 v[180:181], v[180:181], v[36:37] op_sel_hi:[1,0]
    v_pk_mul_f32 v[182:183], v[182:183], v[36:37] op_sel_hi:[1,0]
    v_pk_mul_f32 v[184:185], v[184:185], v[40:41] op_sel_hi:[1,0]
    v_pk_mul_f32 v[186:187], v[186:187], v[40:41] op_sel_hi:[1,0]
    v_pk_mul_f32 v[188:189], v[188:189], v[44:45] op_sel_hi:[1,0]
    v_pk_mul_f32 v[190:191], v[190:191], v[44:45] op_sel_hi:[1,0]
    v_pk_mul_f32 v[192:193], v[192:193], v[48:49] op_sel_hi:[1,0]
    v_pk_mul_f32 v[194:195], v[194:195], v[48:49] op_sel_hi:[1,0]
    v_pk_mul_f32 v[196:197], v[196:197], v[52:53] op_sel_hi:[1,0]
    v_pk_mul_f32 v[198:199], v[198:199], v[52:53] op_sel_hi:[1,0]
    v_cvt_pk_bf16_f32 v88, v144, v145
    v_cvt_pk_bf16_f32 v89, v146, v147
    v_cvt_pk_bf16_f32 v90, v172, v173
    v_cvt_pk_bf16_f32 v91, v174, v175
    v_cvt_pk_bf16_f32 v92, v148, v149
    v_cvt_pk_bf16_f32 v93, v150, v151
    v_cvt_pk_bf16_f32 v94, v176, v177
    v_cvt_pk_bf16_f32 v95, v178, v179
    v_cvt_pk_bf16_f32 v96, v152, v153
    v_cvt_pk_bf16_f32 v97, v154, v155
    v_cvt_pk_bf16_f32 v98, v180, v181
    v_cvt_pk_bf16_f32 v99, v182, v183
    v_cvt_pk_bf16_f32 v100, v156, v157
    v_cvt_pk_bf16_f32 v101, v158, v159
    v_cvt_pk_bf16_f32 v102, v184, v185
    v_cvt_pk_bf16_f32 v103, v186, v187
    v_cvt_pk_bf16_f32 v104, v160, v161
    v_cvt_pk_bf16_f32 v105, v162, v163
    v_cvt_pk_bf16_f32 v106, v188, v189
    v_cvt_pk_bf16_f32 v107, v190, v191
    v_cvt_pk_bf16_f32 v108, v164, v165
    v_cvt_pk_bf16_f32 v109, v166, v167
    v_cvt_pk_bf16_f32 v110, v192, v193
    v_cvt_pk_bf16_f32 v111, v194, v195
    v_cvt_pk_bf16_f32 v112, v168, v169
    v_cvt_pk_bf16_f32 v113, v170, v171
    v_cvt_pk_bf16_f32 v114, v196, v197
    v_cvt_pk_bf16_f32 v115, v198, v199
    s_nop 1
    v_permlane16_swap_b32 v88, v90
    v_permlane16_swap_b32 v89, v91
    v_permlane16_swap_b32 v92, v94
    v_permlane16_swap_b32 v93, v95
    v_permlane16_swap_b32 v96, v98
    v_permlane16_swap_b32 v97, v99
    v_permlane16_swap_b32 v100, v102
    v_permlane16_swap_b32 v101, v103
    v_permlane16_swap_b32 v104, v106
    v_permlane16_swap_b32 v105, v107
    v_permlane16_swap_b32 v108, v110
    v_permlane16_swap_b32 v109, v111
    v_permlane16_swap_b32 v112, v114
    v_permlane16_swap_b32 v113, v115
    s_mov_b32 s28, s31
    buffer_store_dwordx4 v[88:91], v10, s[12:15], s28 offen offset:0 sc0 sc1
    s_add_u32 s28, s28, 4096
    buffer_store_dwordx4 v[92:95], v10, s[12:15], s28 offen offset:0 sc0 sc1
    s_add_u32 s28, s28, 4096
    buffer_store_dwordx4 v[96:99], v10, s[12:15], s28 offen offset:0 sc0 sc1
    s_add_u32 s28, s28, 4096
    buffer_store_dwordx4 v[100:103], v10, s[12:15], s28 offen offset:0 sc0 sc1
    s_add_u32 s28, s28, 4096
    buffer_store_dwordx4 v[104:107], v10, s[12:15], s28 offen offset:0 sc0 sc1
    s_add_u32 s28, s28, 4096
    buffer_store_dwordx4 v[108:111], v10, s[12:15], s28 offen offset:0 sc0 sc1
    s_add_u32 s28, s28, 4096
    buffer_store_dwordx4 v[112:115], v10, s[12:15], s28 offen offset:0 sc0 sc1
    v_pk_mul_f32 v[200:201], v[200:201], v[28:29] op_sel_hi:[1,0]
    v_pk_mul_f32 v[202:203], v[202:203], v[28:29] op_sel_hi:[1,0]
    v_pk_mul_f32 v[204:205], v[204:205], v[32:33] op_sel_hi:[1,0]
    v_pk_mul_f32 v[206:207], v[206:207], v[32:33] op_sel_hi:[1,0]
    v_pk_mul_f32 v[208:209], v[208:209], v[36:37] op_sel_hi:[1,0]
    v_pk_mul_f32 v[210:211], v[210:211], v[36:37] op_sel_hi:[1,0]
    v_pk_mul_f32 v[212:213], v[212:213], v[40:41] op_sel_hi:[1,0]
    v_pk_mul_f32 v[214:215], v[214:215], v[40:41] op_sel_hi:[1,0]
    v_pk_mul_f32 v[216:217], v[216:217], v[44:45] op_sel_hi:[1,0]
    v_pk_mul_f32 v[218:219], v[218:219], v[44:45] op_sel_hi:[1,0]
    v_pk_mul_f32 v[220:221], v[220:221], v[48:49] op_sel_hi:[1,0]
    v_pk_mul_f32 v[222:223], v[222:223], v[48:49] op_sel_hi:[1,0]
    v_pk_mul_f32 v[224:225], v[224:225], v[52:53] op_sel_hi:[1,0]
    v_pk_mul_f32 v[226:227], v[226:227], v[52:53] op_sel_hi:[1,0]
    v_pk_mul_f32 v[228:229], v[228:229], v[28:29] op_sel_hi:[1,0]
    v_pk_mul_f32 v[230:231], v[230:231], v[28:29] op_sel_hi:[1,0]
    v_pk_mul_f32 v[232:233], v[232:233], v[32:33] op_sel_hi:[1,0]
    v_pk_mul_f32 v[234:235], v[234:235], v[32:33] op_sel_hi:[1,0]
    v_pk_mul_f32 v[236:237], v[236:237], v[36:37] op_sel_hi:[1,0]
    v_pk_mul_f32 v[238:239], v[238:239], v[36:37] op_sel_hi:[1,0]
    v_pk_mul_f32 v[240:241], v[240:241], v[40:41] op_sel_hi:[1,0]
    v_pk_mul_f32 v[242:243], v[242:243], v[40:41] op_sel_hi:[1,0]
    v_pk_mul_f32 v[244:245], v[244:245], v[44:45] op_sel_hi:[1,0]
    v_pk_mul_f32 v[246:247], v[246:247], v[44:45] op_sel_hi:[1,0]
    v_pk_mul_f32 v[248:249], v[248:249], v[48:49] op_sel_hi:[1,0]
    v_pk_mul_f32 v[250:251], v[250:251], v[48:49] op_sel_hi:[1,0]
    v_pk_mul_f32 v[252:253], v[252:253], v[52:53] op_sel_hi:[1,0]
    v_pk_mul_f32 v[254:255], v[254:255], v[52:53] op_sel_hi:[1,0]
    v_cvt_pk_bf16_f32 v116, v200, v201
    v_cvt_pk_bf16_f32 v117, v202, v203
    v_cvt_pk_bf16_f32 v118, v228, v229
    v_cvt_pk_bf16_f32 v119, v230, v231
    v_cvt_pk_bf16_f32 v120, v204, v205
    v_cvt_pk_bf16_f32 v121, v206, v207
    v_cvt_pk_bf16_f32 v122, v232, v233
    v_cvt_pk_bf16_f32 v123, v234, v235
    v_cvt_pk_bf16_f32 v124, v208, v209
    v_cvt_pk_bf16_f32 v125, v210, v211
    v_cvt_pk_bf16_f32 v126, v236, v237
    v_cvt_pk_bf16_f32 v127, v238, v239
    v_cvt_pk_bf16_f32 v128, v212, v213
    v_cvt_pk_bf16_f32 v129, v214, v215
    v_cvt_pk_bf16_f32 v130, v240, v241
    v_cvt_pk_bf16_f32 v131, v242, v243
    v_cvt_pk_bf16_f32 v132, v216, v217
    v_cvt_pk_bf16_f32 v133, v218, v219
    v_cvt_pk_bf16_f32 v134, v244, v245
    v_cvt_pk_bf16_f32 v135, v246, v247
    v_cvt_pk_bf16_f32 v136, v220, v221
    v_cvt_pk_bf16_f32 v137, v222, v223
    v_cvt_pk_bf16_f32 v138, v248, v249
    v_cvt_pk_bf16_f32 v139, v250, v251
    v_cvt_pk_bf16_f32 v140, v224, v225
    v_cvt_pk_bf16_f32 v141, v226, v227
    v_cvt_pk_bf16_f32 v142, v252, v253
    v_cvt_pk_bf16_f32 v143, v254, v255
    s_nop 1
    v_permlane16_swap_b32 v116, v118
    v_permlane16_swap_b32 v117, v119
    v_permlane16_swap_b32 v120, v122
    v_permlane16_swap_b32 v121, v123
    v_permlane16_swap_b32 v124, v126
    v_permlane16_swap_b32 v125, v127
    v_permlane16_swap_b32 v128, v130
    v_permlane16_swap_b32 v129, v131
    v_permlane16_swap_b32 v132, v134
    v_permlane16_swap_b32 v133, v135
    v_permlane16_swap_b32 v136, v138
    v_permlane16_swap_b32 v137, v139
    v_permlane16_swap_b32 v140, v142
    v_permlane16_swap_b32 v141, v143
    s_mov_b32 s28, s31
    buffer_store_dwordx4 v[116:119], v10, s[12:15], s28 offen offset:1024 sc0 sc1
    s_add_u32 s28, s28, 4096
    buffer_store_dwordx4 v[120:123], v10, s[12:15], s28 offen offset:1024 sc0 sc1
    s_add_u32 s28, s28, 4096
    buffer_store_dwordx4 v[124:127], v10, s[12:15], s28 offen offset:1024 sc0 sc1
    s_add_u32 s28, s28, 4096
    buffer_store_dwordx4 v[128:131], v10, s[12:15], s28 offen offset:1024 sc0 sc1
    s_add_u32 s28, s28, 4096
    buffer_store_dwordx4 v[132:135], v10, s[12:15], s28 offen offset:1024 sc0 sc1
    s_add_u32 s28, s28, 4096
    buffer_store_dwordx4 v[136:139], v10, s[12:15], s28 offen offset:1024 sc0 sc1
    s_add_u32 s28, s28, 4096
    buffer_store_dwordx4 v[140:143], v10, s[12:15], s28 offen offset:1024 sc0 sc1
    v_accvgpr_read_b32 v144, a112
    v_accvgpr_read_b32 v145, a113
    v_accvgpr_read_b32 v146, a114
    v_accvgpr_read_b32 v147, a115
    v_accvgpr_read_b32 v148, a116
    v_accvgpr_read_b32 v149, a117
    v_accvgpr_read_b32 v150, a118
    v_accvgpr_read_b32 v151, a119
    v_accvgpr_read_b32 v152, a120
    v_accvgpr_read_b32 v153, a121
    v_accvgpr_read_b32 v154, a122
    v_accvgpr_read_b32 v155, a123
    v_accvgpr_read_b32 v156, a124
    v_accvgpr_read_b32 v157, a125
    v_accvgpr_read_b32 v158, a126
    v_accvgpr_read_b32 v159, a127
    v_accvgpr_read_b32 v160, a128
    v_accvgpr_read_b32 v161, a129
    v_accvgpr_read_b32 v162, a130
    v_accvgpr_read_b32 v163, a131
    v_accvgpr_read_b32 v164, a132
    v_accvgpr_read_b32 v165, a133
    v_accvgpr_read_b32 v166, a134
    v_accvgpr_read_b32 v167, a135
    v_accvgpr_read_b32 v168, a136
    v_accvgpr_read_b32 v169, a137
    v_accvgpr_read_b32 v170, a138
    v_accvgpr_read_b32 v171, a139
    v_accvgpr_read_b32 v172, a140
    v_accvgpr_read_b32 v173, a141
    v_accvgpr_read_b32 v174, a142
    v_accvgpr_read_b32 v175, a143
    v_accvgpr_read_b32 v176, a144
    v_accvgpr_read_b32 v177, a145
    v_accvgpr_read_b32 v178, a146
    v_accvgpr_read_b32 v179, a147
    v_accvgpr_read_b32 v180, a148
    v_accvgpr_read_b32 v181, a149
    v_accvgpr_read_b32 v182, a150
    v_accvgpr_read_b32 v183, a151
    v_accvgpr_read_b32 v184, a152
    v_accvgpr_read_b32 v185, a153
    v_accvgpr_read_b32 v186, a154
    v_accvgpr_read_b32 v187, a155
    v_accvgpr_read_b32 v188, a156
    v_accvgpr_read_b32 v189, a157
    v_accvgpr_read_b32 v190, a158
    v_accvgpr_read_b32 v191, a159
    v_accvgpr_read_b32 v192, a160
    v_accvgpr_read_b32 v193, a161
    v_accvgpr_read_b32 v194, a162
    v_accvgpr_read_b32 v195, a163
    v_accvgpr_read_b32 v196, a164
    v_accvgpr_read_b32 v197, a165
    v_accvgpr_read_b32 v198, a166
    v_accvgpr_read_b32 v199, a167
    v_pk_mul_f32 v[144:145], v[144:145], v[28:29] op_sel_hi:[1,0]
    v_pk_mul_f32 v[146:147], v[146:147], v[28:29] op_sel_hi:[1,0]
    v_pk_mul_f32 v[148:149], v[148:149], v[32:33] op_sel_hi:[1,0]
    v_pk_mul_f32 v[150:151], v[150:151], v[32:33] op_sel_hi:[1,0]
    v_pk_mul_f32 v[152:153], v[152:153], v[36:37] op_sel_hi:[1,0]
    v_pk_mul_f32 v[154:155], v[154:155], v[36:37] op_sel_hi:[1,0]
    v_pk_mul_f32 v[156:157], v[156:157], v[40:41] op_sel_hi:[1,0]
    v_pk_mul_f32 v[158:159], v[158:159], v[40:41] op_sel_hi:[1,0]
    v_pk_mul_f32 v[160:161], v[160:161], v[44:45] op_sel_hi:[1,0]
    v_pk_mul_f32 v[162:163], v[162:163], v[44:45] op_sel_hi:[1,0]
    v_pk_mul_f32 v[164:165], v[164:165], v[48:49] op_sel_hi:[1,0]
    v_pk_mul_f32 v[166:167], v[166:167], v[48:49] op_sel_hi:[1,0]
    v_pk_mul_f32 v[168:169], v[168:169], v[52:53] op_sel_hi:[1,0]
    v_pk_mul_f32 v[170:171], v[170:171], v[52:53] op_sel_hi:[1,0]
    v_pk_mul_f32 v[172:173], v[172:173], v[28:29] op_sel_hi:[1,0]
    v_pk_mul_f32 v[174:175], v[174:175], v[28:29] op_sel_hi:[1,0]
    v_pk_mul_f32 v[176:177], v[176:177], v[32:33] op_sel_hi:[1,0]
    v_pk_mul_f32 v[178:179], v[178:179], v[32:33] op_sel_hi:[1,0]
    v_pk_mul_f32 v[180:181], v[180:181], v[36:37] op_sel_hi:[1,0]
    v_pk_mul_f32 v[182:183], v[182:183], v[36:37] op_sel_hi:[1,0]
    v_pk_mul_f32 v[184:185], v[184:185], v[40:41] op_sel_hi:[1,0]
    v_pk_mul_f32 v[186:187], v[186:187], v[40:41] op_sel_hi:[1,0]
    v_pk_mul_f32 v[188:189], v[188:189], v[44:45] op_sel_hi:[1,0]
    v_pk_mul_f32 v[190:191], v[190:191], v[44:45] op_sel_hi:[1,0]
    v_pk_mul_f32 v[192:193], v[192:193], v[48:49] op_sel_hi:[1,0]
    v_pk_mul_f32 v[194:195], v[194:195], v[48:49] op_sel_hi:[1,0]
    v_pk_mul_f32 v[196:197], v[196:197], v[52:53] op_sel_hi:[1,0]
    v_pk_mul_f32 v[198:199], v[198:199], v[52:53] op_sel_hi:[1,0]
    v_cvt_pk_bf16_f32 v88, v144, v145
    v_cvt_pk_bf16_f32 v89, v146, v147
    v_cvt_pk_bf16_f32 v90, v172, v173
    v_cvt_pk_bf16_f32 v91, v174, v175
    v_cvt_pk_bf16_f32 v92, v148, v149
    v_cvt_pk_bf16_f32 v93, v150, v151
    v_cvt_pk_bf16_f32 v94, v176, v177
    v_cvt_pk_bf16_f32 v95, v178, v179
    v_cvt_pk_bf16_f32 v96, v152, v153
    v_cvt_pk_bf16_f32 v97, v154, v155
    v_cvt_pk_bf16_f32 v98, v180, v181
    v_cvt_pk_bf16_f32 v99, v182, v183
    v_cvt_pk_bf16_f32 v100, v156, v157
    v_cvt_pk_bf16_f32 v101, v158, v159
    v_cvt_pk_bf16_f32 v102, v184, v185
    v_cvt_pk_bf16_f32 v103, v186, v187
    v_cvt_pk_bf16_f32 v104, v160, v161
    v_cvt_pk_bf16_f32 v105, v162, v163
    v_cvt_pk_bf16_f32 v106, v188, v189
    v_cvt_pk_bf16_f32 v107, v190, v191
    v_cvt_pk_bf16_f32 v108, v164, v165
    v_cvt_pk_bf16_f32 v109, v166, v167
    v_cvt_pk_bf16_f32 v110, v192, v193
    v_cvt_pk_bf16_f32 v111, v194, v195
    v_cvt_pk_bf16_f32 v112, v168, v169
    v_cvt_pk_bf16_f32 v113, v170, v171
    v_cvt_pk_bf16_f32 v114, v196, v197
    v_cvt_pk_bf16_f32 v115, v198, v199
    s_nop 1
    v_permlane16_swap_b32 v88, v90
    v_permlane16_swap_b32 v89, v91
    v_permlane16_swap_b32 v92, v94
    v_permlane16_swap_b32 v93, v95
    v_permlane16_swap_b32 v96, v98
    v_permlane16_swap_b32 v97, v99
    v_permlane16_swap_b32 v100, v102
    v_permlane16_swap_b32 v101, v103
    v_permlane16_swap_b32 v104, v106
    v_permlane16_swap_b32 v105, v107
    v_permlane16_swap_b32 v108, v110
    v_permlane16_swap_b32 v109, v111
    v_permlane16_swap_b32 v112, v114
    v_permlane16_swap_b32 v113, v115
    s_mov_b32 s28, s31
    buffer_store_dwordx4 v[88:91], v10, s[12:15], s28 offen offset:2048 sc0 sc1
    s_add_u32 s28, s28, 4096
    buffer_store_dwordx4 v[92:95], v10, s[12:15], s28 offen offset:2048 sc0 sc1
    s_add_u32 s28, s28, 4096
    buffer_store_dwordx4 v[96:99], v10, s[12:15], s28 offen offset:2048 sc0 sc1
    s_add_u32 s28, s28, 4096
    buffer_store_dwordx4 v[100:103], v10, s[12:15], s28 offen offset:2048 sc0 sc1
    s_add_u32 s28, s28, 4096
    buffer_store_dwordx4 v[104:107], v10, s[12:15], s28 offen offset:2048 sc0 sc1
    s_add_u32 s28, s28, 4096
    buffer_store_dwordx4 v[108:111], v10, s[12:15], s28 offen offset:2048 sc0 sc1
    s_add_u32 s28, s28, 4096
    buffer_store_dwordx4 v[112:115], v10, s[12:15], s28 offen offset:2048 sc0 sc1
    v_accvgpr_read_b32 v200, a168
    v_accvgpr_read_b32 v201, a169
    v_accvgpr_read_b32 v202, a170
    v_accvgpr_read_b32 v203, a171
    v_accvgpr_read_b32 v204, a172
    v_accvgpr_read_b32 v205, a173
    v_accvgpr_read_b32 v206, a174
    v_accvgpr_read_b32 v207, a175
    v_accvgpr_read_b32 v208, a176
    v_accvgpr_read_b32 v209, a177
    v_accvgpr_read_b32 v210, a178
    v_accvgpr_read_b32 v211, a179
    v_accvgpr_read_b32 v212, a180
    v_accvgpr_read_b32 v213, a181
    v_accvgpr_read_b32 v214, a182
    v_accvgpr_read_b32 v215, a183
    v_accvgpr_read_b32 v216, a184
    v_accvgpr_read_b32 v217, a185
    v_accvgpr_read_b32 v218, a186
    v_accvgpr_read_b32 v219, a187
    v_accvgpr_read_b32 v220, a188
    v_accvgpr_read_b32 v221, a189
    v_accvgpr_read_b32 v222, a190
    v_accvgpr_read_b32 v223, a191
    v_accvgpr_read_b32 v224, a192
    v_accvgpr_read_b32 v225, a193
    v_accvgpr_read_b32 v226, a194
    v_accvgpr_read_b32 v227, a195
    v_accvgpr_read_b32 v228, a196
    v_accvgpr_read_b32 v229, a197
    v_accvgpr_read_b32 v230, a198
    v_accvgpr_read_b32 v231, a199
    v_accvgpr_read_b32 v232, a200
    v_accvgpr_read_b32 v233, a201
    v_accvgpr_read_b32 v234, a202
    v_accvgpr_read_b32 v235, a203
    v_accvgpr_read_b32 v236, a204
    v_accvgpr_read_b32 v237, a205
    v_accvgpr_read_b32 v238, a206
    v_accvgpr_read_b32 v239, a207
    v_accvgpr_read_b32 v240, a208
    v_accvgpr_read_b32 v241, a209
    v_accvgpr_read_b32 v242, a210
    v_accvgpr_read_b32 v243, a211
    v_accvgpr_read_b32 v244, a212
    v_accvgpr_read_b32 v245, a213
    v_accvgpr_read_b32 v246, a214
    v_accvgpr_read_b32 v247, a215
    v_accvgpr_read_b32 v248, a216
    v_accvgpr_read_b32 v249, a217
    v_accvgpr_read_b32 v250, a218
    v_accvgpr_read_b32 v251, a219
    v_accvgpr_read_b32 v252, a220
    v_accvgpr_read_b32 v253, a221
    v_accvgpr_read_b32 v254, a222
    v_accvgpr_read_b32 v255, a223
    v_pk_mul_f32 v[200:201], v[200:201], v[28:29] op_sel_hi:[1,0]
    v_pk_mul_f32 v[202:203], v[202:203], v[28:29] op_sel_hi:[1,0]
    v_pk_mul_f32 v[204:205], v[204:205], v[32:33] op_sel_hi:[1,0]
    v_pk_mul_f32 v[206:207], v[206:207], v[32:33] op_sel_hi:[1,0]
    v_pk_mul_f32 v[208:209], v[208:209], v[36:37] op_sel_hi:[1,0]
    v_pk_mul_f32 v[210:211], v[210:211], v[36:37] op_sel_hi:[1,0]
    v_pk_mul_f32 v[212:213], v[212:213], v[40:41] op_sel_hi:[1,0]
    v_pk_mul_f32 v[214:215], v[214:215], v[40:41] op_sel_hi:[1,0]
    v_pk_mul_f32 v[216:217], v[216:217], v[44:45] op_sel_hi:[1,0]
    v_pk_mul_f32 v[218:219], v[218:219], v[44:45] op_sel_hi:[1,0]
    v_pk_mul_f32 v[220:221], v[220:221], v[48:49] op_sel_hi:[1,0]
    v_pk_mul_f32 v[222:223], v[222:223], v[48:49] op_sel_hi:[1,0]
    v_pk_mul_f32 v[224:225], v[224:225], v[52:53] op_sel_hi:[1,0]
    v_pk_mul_f32 v[226:227], v[226:227], v[52:53] op_sel_hi:[1,0]
    v_pk_mul_f32 v[228:229], v[228:229], v[28:29] op_sel_hi:[1,0]
    v_pk_mul_f32 v[230:231], v[230:231], v[28:29] op_sel_hi:[1,0]
    v_pk_mul_f32 v[232:233], v[232:233], v[32:33] op_sel_hi:[1,0]
    v_pk_mul_f32 v[234:235], v[234:235], v[32:33] op_sel_hi:[1,0]
    v_pk_mul_f32 v[236:237], v[236:237], v[36:37] op_sel_hi:[1,0]
    v_pk_mul_f32 v[238:239], v[238:239], v[36:37] op_sel_hi:[1,0]
    v_pk_mul_f32 v[240:241], v[240:241], v[40:41] op_sel_hi:[1,0]
    v_pk_mul_f32 v[242:243], v[242:243], v[40:41] op_sel_hi:[1,0]
    v_pk_mul_f32 v[244:245], v[244:245], v[44:45] op_sel_hi:[1,0]
    v_pk_mul_f32 v[246:247], v[246:247], v[44:45] op_sel_hi:[1,0]
    v_pk_mul_f32 v[248:249], v[248:249], v[48:49] op_sel_hi:[1,0]
    v_pk_mul_f32 v[250:251], v[250:251], v[48:49] op_sel_hi:[1,0]
    v_pk_mul_f32 v[252:253], v[252:253], v[52:53] op_sel_hi:[1,0]
    v_pk_mul_f32 v[254:255], v[254:255], v[52:53] op_sel_hi:[1,0]
    v_cvt_pk_bf16_f32 v116, v200, v201
    v_cvt_pk_bf16_f32 v117, v202, v203
    v_cvt_pk_bf16_f32 v118, v228, v229
    v_cvt_pk_bf16_f32 v119, v230, v231
    v_cvt_pk_bf16_f32 v120, v204, v205
    v_cvt_pk_bf16_f32 v121, v206, v207
    v_cvt_pk_bf16_f32 v122, v232, v233
    v_cvt_pk_bf16_f32 v123, v234, v235
    v_cvt_pk_bf16_f32 v124, v208, v209
    v_cvt_pk_bf16_f32 v125, v210, v211
    v_cvt_pk_bf16_f32 v126, v236, v237
    v_cvt_pk_bf16_f32 v127, v238, v239
    v_cvt_pk_bf16_f32 v128, v212, v213
    v_cvt_pk_bf16_f32 v129, v214, v215
    v_cvt_pk_bf16_f32 v130, v240, v241
    v_cvt_pk_bf16_f32 v131, v242, v243
    v_cvt_pk_bf16_f32 v132, v216, v217
    v_cvt_pk_bf16_f32 v133, v218, v219
    v_cvt_pk_bf16_f32 v134, v244, v245
    v_cvt_pk_bf16_f32 v135, v246, v247
    v_cvt_pk_bf16_f32 v136, v220, v221
    v_cvt_pk_bf16_f32 v137, v222, v223
    v_cvt_pk_bf16_f32 v138, v248, v249
    v_cvt_pk_bf16_f32 v139, v250, v251
    v_cvt_pk_bf16_f32 v140, v224, v225
    v_cvt_pk_bf16_f32 v141, v226, v227
    v_cvt_pk_bf16_f32 v142, v252, v253
    v_cvt_pk_bf16_f32 v143, v254, v255
    s_nop 1
    v_permlane16_swap_b32 v116, v118
    v_permlane16_swap_b32 v117, v119
    v_permlane16_swap_b32 v120, v122
    v_permlane16_swap_b32 v121, v123
    v_permlane16_swap_b32 v124, v126
    v_permlane16_swap_b32 v125, v127
    v_permlane16_swap_b32 v128, v130
    v_permlane16_swap_b32 v129, v131
    v_permlane16_swap_b32 v132, v134
    v_permlane16_swap_b32 v133, v135
    v_permlane16_swap_b32 v136, v138
    v_permlane16_swap_b32 v137, v139
    v_permlane16_swap_b32 v140, v142
    v_permlane16_swap_b32 v141, v143
    s_mov_b32 s28, s31
    buffer_store_dwordx4 v[116:119], v10, s[12:15], s28 offen offset:3072 sc0 sc1
    s_add_u32 s28, s28, 4096
    buffer_store_dwordx4 v[120:123], v10, s[12:15], s28 offen offset:3072 sc0 sc1
    s_add_u32 s28, s28, 4096
    buffer_store_dwordx4 v[124:127], v10, s[12:15], s28 offen offset:3072 sc0 sc1
    s_add_u32 s28, s28, 4096
    buffer_store_dwordx4 v[128:131], v10, s[12:15], s28 offen offset:3072 sc0 sc1
    s_add_u32 s28, s28, 4096
    buffer_store_dwordx4 v[132:135], v10, s[12:15], s28 offen offset:3072 sc0 sc1
    s_add_u32 s28, s28, 4096
    buffer_store_dwordx4 v[136:139], v10, s[12:15], s28 offen offset:3072 sc0 sc1
    s_add_u32 s28, s28, 4096
    buffer_store_dwordx4 v[140:143], v10, s[12:15], s28 offen offset:3072 sc0 sc1
    s_nop 1
L_at_nowo2:
    s_mov_b32 s68, 3
    s_cmp_ge_u32 s21, 2
    s_cbranch_scc1 L_at_fin
    s_cmp_eq_u32 s69, 0
    s_cbranch_scc1 L_at_round
    s_waitcnt vmcnt(28)
    s_branch L_at_pre
L_at_fin:
    s_waitcnt lgkmcnt(0)
    s_barrier
    s_cmp_le_u32 s21, s27
    s_cbranch_scc1 L_at_nofb_6990
    s_sub_u32 s28, s21, 1
    s_cmp_eq_u32 s28, s23
    s_cbranch_scc1 L_at_nofb_6990
    s_lshl_b32 s29, s28, 2
    s_add_u32 s29, s29, 76000
    v_mov_b32 v4, s29
    ds_read_b32 v4, v4
    s_waitcnt lgkmcnt(0)
    v_readfirstlane_b32 s29, v4
    s_nop 3
    s_cmp_lg_u32 s29, 0
    s_cbranch_scc1 L_at_fallback
L_at_nofb_6990:
    s_branch L_at_end
L_bw1_453:
    s_sub_u32 s68, s68, 1
    s_waitcnt vmcnt(44) lgkmcnt(0)
    s_branch L_bw2_453
L_bw1_576:
    s_sub_u32 s68, s68, 1
    s_waitcnt vmcnt(36) lgkmcnt(0)
    s_branch L_bw2_576
L_bw1_693:
    s_sub_u32 s68, s68, 1
    s_waitcnt vmcnt(44) lgkmcnt(0)
    s_branch L_bw2_693
L_bw1_3109:
    s_sub_u32 s68, s68, 1
    s_waitcnt vmcnt(44) lgkmcnt(0)
    s_branch L_bw2_3109
L_bw1_3491:
    s_sub_u32 s68, s68, 1
    s_waitcnt vmcnt(44) lgkmcnt(0)
    s_branch L_bw2_3491
L_bw1_3800:
    s_sub_u32 s68, s68, 1
    s_waitcnt vmcnt(44) lgkmcnt(0)
    s_branch L_bw2_3800
L_at_wt0:
    s_and_b32 s28, s2, 127
    s_mul_i32 s28, s28, 40960
    s_mul_i32 s29, s20, 10240
    s_add_u32 s28, s28, s29
    v_lshlrev_b32 v4, 7, v1
    v_and_b32 v5, 15, v1
    v_lshlrev_b32 v5, 7, v5
    buffer_load_dword a250, v4, s[84:87], s28 offen
    s_add_u32 s28, s28, 8192
    buffer_load_dword a251, v5, s[84:87], s28 offen
    s_branch L_at_wt0r
L_at_fallback:
    s_sub_u32 s27, s21, 1
    s_mov_b32 s23, s27
    s_mov_b32 s25, 1
    s_mov_b32 s69, 0
    s_mov_b32 s70, 0
    s_mov_b32 s68, 0
    v_mov_b32 v12, 0xff800000
    v_mov_b32 v14, 0xff800000
    v_mov_b32 v16, 0xff800000
    v_mov_b32 v18, 0xff800000
    v_mov_b32 v20, 0xff800000
    v_mov_b32 v22, 0xff800000
    v_mov_b32 v24, 0xff800000
    s_waitcnt vmcnt(0) lgkmcnt(0)
    s_barrier
    s_branch L_at_start
L_at_maxpass:
    s_mov_b32 s25, 0
    s_waitcnt lgkmcnt(0)
    v_and_b32 v2, 15, v1
    v_lshlrev_b32 v2, 8, v2
    v_bfe_u32 v3, v1, 4, 1
    v_lshl_add_u32 v2, v3, 5, v2
    v_bfe_u32 v3, v1, 5, 1
    v_lshl_add_u32 v4, v3, 4, v2
    v_add_u32 v5, 4096, v4
    s_lshl_b32 s29, s21, 19
    s_mov_b32 s22, 0
L_at_mp:
    buffer_load_dwordx4 v[112:115], v4, s[8:11], s29 offen offset:0
    buffer_load_dwordx4 v[116:119], v4, s[8:11], s29 offen offset:64
    buffer_load_dwordx4 v[120:123], v4, s[8:11], s29 offen offset:128
    buffer_load_dwordx4 v[124:127], v4, s[8:11], s29 offen offset:192
    buffer_load_dwordx4 v[128:131], v5, s[8:11], s29 offen offset:0
    buffer_load_dwordx4 v[132:135], v5, s[8:11], s29 offen offset:64
    buffer_load_dwordx4 v[136:139], v5, s[8:11], s29 offen offset:128
    buffer_load_dwordx4 v[140:143], v5, s[8:11], s29 offen offset:192
    s_waitcnt vmcnt(0)
    v_mfma_f32_16x16x32_bf16 v[88:91], v[112:115], a[0:3], 0
    v_mfma_f32_16x16x32_bf16 v[88:91], v[116:119], a[4:7], v[88:91]
    v_mfma_f32_16x16x32_bf16 v[88:91], v[120:123], a[8:11], v[88:91]
    v_mfma_f32_16x16x32_bf16 v[88:91], v[124:127], a[12:15], v[88:91]
    v_mfma_f32_16x16x32_bf16 v[92:95], v[128:131], a[0:3], 0
    v_mfma_f32_16x16x32_bf16 v[92:95], v[132:135], a[4:7], v[92:95]
    v_mfma_f32_16x16x32_bf16 v[92:95], v[136:139], a[8:11], v[92:95]
    v_mfma_f32_16x16x32_bf16 v[92:95], v[140:143], a[12:15], v[92:95]
    s_nop 9
    v_max3_f32 v12, v88, v89, v12
    v_max3_f32 v12, v90, v91, v12
    v_max3_f32 v12, v92, v93, v12
    v_max3_f32 v12, v94, v95, v12
    s_nop 3
    v_mfma_f32_16x16x32_bf16 v[88:91], v[112:115], a[16:19], 0
    v_mfma_f32_16x16x32_bf16 v[88:91], v[116:119], a[20:23], v[88:91]
    v_mfma_f32_16x16x32_bf16 v[88:91], v[120:123], a[24:27], v[88:91]
    v_mfma_f32_16x16x32_bf16 v[88:91], v[124:127], a[28:31], v[88:91]
    v_mfma_f32_16x16x32_bf16 v[92:95], v[128:131], a[16:19], 0
    v_mfma_f32_16x16x32_bf16 v[92:95], v[132:135], a[20:23], v[92:95]
    v_mfma_f32_16x16x32_bf16 v[92:95], v[136:139], a[24:27], v[92:95]
    v_mfma_f32_16x16x32_bf16 v[92:95], v[140:143], a[28:31], v[92:95]
    s_nop 9
    v_max3_f32 v14, v88, v89, v14
    v_max3_f32 v14, v90, v91, v14
    v_max3_f32 v14, v92, v93, v14
    v_max3_f32 v14, v94, v95, v14
    s_nop 3
    v_mfma_f32_16x16x32_bf16 v[88:91], v[112:115], a[32:35], 0
    v_mfma_f32_16x16x32_bf16 v[88:91], v[116:119], a[36:39], v[88:91]
    v_mfma_f32_16x16x32_bf16 v[88:91], v[120:123], a[40:43], v[88:91]
    v_mfma_f32_16x16x32_bf16 v[88:91], v[124:127], a[44:47], v[88:91]
    v_mfma_f32_16x16x32_bf16 v[92:95], v[128:131], a[32:35], 0
    v_mfma_f32_16x16x32_bf16 v[92:95], v[132:135], a[36:39], v[92:95]
    v_mfma_f32_16x16x32_bf16 v[92:95], v[136:139], a[40:43], v[92:95]
    v_mfma_f32_16x16x32_bf16 v[92:95], v[140:143], a[44:47], v[92:95]
    s_nop 9
    v_max3_f32 v16, v88, v89, v16
    v_max3_f32 v16, v90, v91, v16
    v_max3_f32 v16, v92, v93, v16
    v_max3_f32 v16, v94, v95, v16
    s_nop 3
    v_mfma_f32_16x16x32_bf16 v[88:91], v[112:115], a[48:51], 0
    v_mfma_f32_16x16x32_bf16 v[88:91], v[116:119], a[52:55], v[88:91]
    v_mfma_f32_16x16x32_bf16 v[88:91], v[120:123], a[56:59], v[88:91]
    v_mfma_f32_16x16x32_bf16 v[88:91], v[124:127], a[60:63], v[88:91]
    v_mfma_f32_16x16x32_bf16 v[92:95], v[128:131], a[48:51], 0
    v_mfma_f32_16x16x32_bf16 v[92:95], v[132:135], a[52:55], v[92:95]
    v_mfma_f32_16x16x32_bf16 v[92:95], v[136:139], a[56:59], v[92:95]
    v_mfma_f32_16x16x32_bf16 v[92:95], v[140:143], a[60:63], v[92:95]
    s_nop 9
    v_max3_f32 v18, v88, v89, v18
    v_max3_f32 v18, v90, v91, v18
    v_max3_f32 v18, v92, v93, v18
    v_max3_f32 v18, v94, v95, v18
    s_nop 3
    v_mfma_f32_16x16x32_bf16 v[88:91], v[112:115], a[64:67], 0
    v_mfma_f32_16x16x32_bf16 v[88:91], v[116:119], a[68:71], v[88:91]
    v_mfma_f32_16x16x32_bf16 v[88:91], v[120:123], a[72:75], v[88:91]
    v_mfma_f32_16x16x32_bf16 v[88:91], v[124:127], a[76:79], v[88:91]
    v_mfma_f32_16x16x32_bf16 v[92:95], v[128:131], a[64:67], 0
    v_mfma_f32_16x16x32_bf16 v[92:95], v[132:135], a[68:71], v[92:95]
    v_mfma_f32_16x16x32_bf16 v[92:95], v[136:139], a[72:75], v[92:95]
    v_mfma_f32_16x16x32_bf16 v[92:95], v[140:143], a[76:79], v[92:95]
    s_nop 9
    v_max3_f32 v20, v88, v89, v20
    v_max3_f32 v20, v90, v91, v20
    v_max3_f32 v20, v92, v93, v20
    v_max3_f32 v20, v94, v95, v20
    s_nop 3
    v_mfma_f32_16x16x32_bf16 v[88:91], v[112:115], a[80:83], 0
    v_mfma_f32_16x16x32_bf16 v[88:91], v[116:119], a[84:87], v[88:91]
    v_mfma_f32_16x16x32_bf16 v[88:91], v[120:123], a[88:91], v[88:91]
    v_mfma_f32_16x16x32_bf16 v[88:91], v[124:127], a[92:95], v[88:91]
    v_mfma_f32_16x16x32_bf16 v[92:95], v[128:131], a[80:83], 0
    v_mfma_f32_16x16x32_bf16 v[92:95], v[132:135], a[84:87], v[92:95]
    v_mfma_f32_16x16x32_bf16 v[92:95], v[136:139], a[88:91], v[92:95]
    v_mfma_f32_16x16x32_bf16 v[92:95], v[140:143], a[92:95], v[92:95]
    s_nop 9
    v_max3_f32 v22, v88, v89, v22
    v_max3_f32 v22, v90, v91, v22
    v_max3_f32 v22, v92, v93, v22
    v_max3_f32 v22, v94, v95, v22
    s_nop 3
    v_mfma_f32_16x16x32_bf16 v[88:91], v[112:115], a[96:99], 0
    v_mfma_f32_16x16x32_bf16 v[88:91], v[116:119], a[100:103], v[88:91]
    v_mfma_f32_16x16x32_bf16 v[88:91], v[120:123], a[104:107], v[88:91]
    v_mfma_f32_16x16x32_bf16 v[88:91], v[124:127], a[108:111], v[88:91]
    v_mfma_f32_16x16x32_bf16 v[92:95], v[128:131], a[96:99], 0
    v_mfma_f32_16x16x32_bf16 v[92:95], v[132:135], a[100:103], v[92:95]
    v_mfma_f32_16x16x32_bf16 v[92:95], v[136:139], a[104:107], v[92:95]
    v_mfma_f32_16x16x32_bf16 v[92:95], v[140:143], a[108:111], v[92:95]
    s_nop 9
    v_max3_f32 v24, v88, v89, v24
    v_max3_f32 v24, v90, v91, v24
    v_max3_f32 v24, v92, v93, v24
    v_max3_f32 v24, v94, v95, v24
    s_nop 3
    s_add_u32 s29, s29, 8192
    s_add_u32 s22, s22, 1
    s_cmp_lt_u32 s22, 32
    s_cbranch_scc1 L_at_mp
    s_branch L_at_pre
L_at_end:
    s_endpgm
.globl op_kernel
.p2align 8
.type op_kernel,@function
op_kernel:
    s_cmp_ge_u32 s2, 256
    s_cbranch_scc1 L_op_end
    s_and_b32 s3, s2, 7
    s_lshl_b32 s3, s3, 5
    s_lshr_b32 s30, s2, 3
    s_add_u32 s3, s3, s30
    s_cmp_ge_u32 s3, 250
    s_cbranch_scc1 L_op_end
    s_load_dwordx2 s[36:37], s[0:1], 32
    s_load_dwordx2 s[38:39], s[0:1], 72
    s_load_dwordx2 s[40:41], s[0:1], 80
    s_load_dwordx2 s[44:45], s[0:1], 96
    v_and_b32 v1, 63, v0
    v_lshrrev_b32 v2, 6, v0
    s_nop 0
    v_readfirstlane_b32 s20, v2
    s_mul_i32 s28, s3, 13108
    s_lshr_b32 s28, s28, 16
    s_mul_i32 s22, s28, 5
    s_sub_u32 s29, s3, s22
    s_mov_b32 s61, s28
    s_cmp_ge_u32 s28, 25
    s_cselect_b32 s30, 1, 0
    s_cselect_b32 s22, 25, 0
    s_sub_u32 s28, s28, s22
    s_mul_i32 s31, s28, 9
    s_lshl_b32 s24, s20, 10
    s_add_u32 s24, s24, 58720256
    s_mul_i32 s23, s30, 29360128
    s_add_u32 s24, s24, s23
    s_cmp_lt_u32 s20, 2
    s_cselect_b32 s58, 5, 0
    s_add_u32 s22, s31, 0
    s_add_u32 s22, s22, s58
    s_mul_i32 s23, s22, 4682
    s_lshr_b32 s23, s23, 16
    s_mul_i32 s62, s23, 1777664
    s_lshl_b32 s48, s22, 12
    s_add_u32 s48, s48, s62
    s_add_u32 s48, s48, s24
    s_add_u32 s22, s31, 1
    s_add_u32 s22, s22, s58
    s_mul_i32 s23, s22, 4682
    s_lshr_b32 s23, s23, 16
    s_mul_i32 s62, s23, 1777664
    s_lshl_b32 s49, s22, 12
    s_add_u32 s49, s49, s62
    s_add_u32 s49, s49, s24
    s_add_u32 s22, s31, 2
    s_add_u32 s22, s22, s58
    s_mul_i32 s23, s22, 4682
    s_lshr_b32 s23, s23, 16
    s_mul_i32 s62, s23, 1777664
    s_lshl_b32 s50, s22, 12
    s_add_u32 s50, s50, s62
    s_add_u32 s50, s50, s24
    s_add_u32 s22, s31, 3
    s_add_u32 s22, s22, s58
    s_mul_i32 s23, s22, 4682
    s_lshr_b32 s23, s23, 16
    s_mul_i32 s62, s23, 1777664
    s_lshl_b32 s51, s22, 12
    s_add_u32 s51, s51, s62
    s_add_u32 s51, s51, s24
    s_cmp_ge_u32 s22, 224
    s_cselect_b32 s62, 0x40000000, 0
    s_add_u32 s51, s51, s62
    s_add_u32 s22, s31, 4
    s_mul_i32 s23, s22, 4682
    s_lshr_b32 s23, s23, 16
    s_mul_i32 s62, s23, 1777664
    s_lshl_b32 s52, s22, 12
    s_add_u32 s52, s52, s62
    s_add_u32 s52, s52, s24
    s_add_u32 s22, s31, 5
    s_sub_u32 s22, s22, s58
    s_mul_i32 s23, s22, 4682
    s_lshr_b32 s23, s23, 16
    s_mul_i32 s62, s23, 1777664
    s_lshl_b32 s53, s22, 12
    s_add_u32 s53, s53, s62
    s_add_u32 s53, s53, s24
    s_add_u32 s22, s31, 6
    s_sub_u32 s22, s22, s58
    s_mul_i32 s23, s22, 4682
    s_lshr_b32 s23, s23, 16
    s_mul_i32 s62, s23, 1777664
    s_lshl_b32 s54, s22, 12
    s_add_u32 s54, s54, s62
    s_add_u32 s54, s54, s24
    s_add_u32 s22, s31, 7
    s_sub_u32 s22, s22, s58
    s_mul_i32 s23, s22, 4682
    s_lshr_b32 s23, s23, 16
    s_mul_i32 s62, s23, 1777664
    s_lshl_b32 s55, s22, 12
    s_add_u32 s55, s55, s62
    s_add_u32 s55, s55, s24
    s_add_u32 s22, s31, 8
    s_sub_u32 s22, s22, s58
    s_mul_i32 s23, s22, 4682
    s_lshr_b32 s23, s23, 16
    s_mul_i32 s62, s23, 1777664
    s_lshl_b32 s56, s22, 12
    s_add_u32 s56, s56, s62
    s_add_u32 s56, s56, s24
    s_cmp_ge_u32 s22, 224
    s_cselect_b32 s62, 0x40000000, 0
    s_add_u32 s56, s56, s62
    v_lshlrev_b32 v6, 4, v1
    v_lshrrev_b32 v2, 4, v1
    v_and_b32 v3, 15, v1
    v_lshlrev_b32 v4, 1, v2
    v_xor_b32 v3, v3, v4
    v_lshlrev_b32 v3, 4, v3
    v_mul_u32_u24 v4, 1280, v2
    v_add_u32 v5, v4, v3
    v_xor_b32 v3, 128, v3
    v_add_u32 v4, v4, v3
    v_add_u32 v10, 0, v5
    v_add_u32 v11, 4096, v5
    v_add_u32 v12, 8192, v4
    v_add_u32 v13, 12288, v4
    v_add_u32 v14, 20480, v5
    v_add_u32 v15, 24576, v5
    v_add_u32 v16, 28672, v4
    v_add_u32 v17, 32768, v4
    s_mul_i32 s27, s20, 40960
    s_waitcnt lgkmcnt(0)
    s_cmp_lg_u32 s30, 0
    s_cselect_b32 s8, s38, s36
    s_cselect_b32 s9, s39, s37
    s_mov_b32 s10, 5242880
    s_mov_b32 s11, 0x20000
    s_mov_b32 s4, s44
    s_mov_b32 s5, s45
    s_mov_b32 s6, 127926272
    s_mov_b32 s7, 0x20000
    s_mov_b32 s12, s40
    s_mov_b32 s13, s41
    s_mov_b32 s14, 9175040
    s_mov_b32 s15, 0x20000
    s_mul_i32 s22, s20, 40960
    s_lshl_b32 s23, s29, 8
    s_add_u32 s26, s22, s23
    s_mov_b32 s25, 0
    v_add_u32 v7, s25, v6
    s_add_u32 m0, s27, 0
    s_nop 0
    buffer_load_dwordx4 v10, s[8:11], s26 offen offset:0 lds
    buffer_load_dwordx4 v11, s[8:11], s26 offen offset:1024 lds
    buffer_load_dwordx4 v12, s[8:11], s26 offen offset:2048 lds
    buffer_load_dwordx4 v13, s[8:11], s26 offen offset:3072 lds
    s_add_u32 m0, s27, 4096
    s_nop 0
    buffer_load_dwordx4 v14, s[8:11], s26 offen offset:0 lds
    buffer_load_dwordx4 v15, s[8:11], s26 offen offset:1024 lds
    buffer_load_dwordx4 v16, s[8:11], s26 offen offset:2048 lds
    buffer_load_dwordx4 v17, s[8:11], s26 offen offset:3072 lds
    s_add_u32 s26, s26, 163840
    buffer_load_dwordx4 v[92:95], v7, s[4:7], s48 offen
    buffer_load_dwordx4 v[96:99], v7, s[4:7], s49 offen
    buffer_load_dwordx4 v[100:103], v7, s[4:7], s50 offen
    buffer_load_dwordx4 v[104:107], v7, s[4:7], s51 offen
    buffer_load_dwordx4 v[108:111], v7, s[4:7], s52 offen
    buffer_load_dwordx4 v[112:115], v7, s[4:7], s53 offen
    buffer_load_dwordx4 v[116:119], v7, s[4:7], s54 offen
    buffer_load_dwordx4 v[120:123], v7, s[4:7], s55 offen
    buffer_load_dwordx4 v[124:127], v7, s[4:7], s56 offen
    v_add_u32 v7, 57344, v7
    s_add_u32 m0, s27, 8192
    s_nop 0
    buffer_load_dwordx4 v10, s[8:11], s26 offen offset:0 lds
    buffer_load_dwordx4 v11, s[8:11], s26 offen offset:1024 lds
    buffer_load_dwordx4 v12, s[8:11], s26 offen offset:2048 lds
    buffer_load_dwordx4 v13, s[8:11], s26 offen offset:3072 lds
    s_add_u32 m0, s27, 12288
    s_nop 0
    buffer_load_dwordx4 v14, s[8:11], s26 offen offset:0 lds
    buffer_load_dwordx4 v15, s[8:11], s26 offen offset:1024 lds
    buffer_load_dwordx4 v16, s[8:11], s26 offen offset:2048 lds
    buffer_load_dwordx4 v17, s[8:11], s26 offen offset:3072 lds
    s_add_u32 s26, s26, 163840
    v_lshrrev_b32 v2, 4, v1
    v_bfe_u32 v3, v1, 2, 2
    v_lshl_add_u32 v4, v2, 3, v3
    v_lshlrev_b32 v4, 8, v4
    v_and_b32 v2, 1, v2
    v_lshl_add_u32 v3, v2, 2, v3
    v_lshl_add_u32 v4, v3, 5, v4
    v_and_b32 v3, 3, v1
    v_lshl_add_u32 v4, v3, 3, v4
    v_add_u32 v4, s27, v4
    s_and_b32 s62, s20, 1
    s_lshl_b32 s62, s62, 1
    s_lshr_b32 s59, s20, 1
    s_add_u32 s59, s59, s62
    s_lshl_b32 s59, s59, 6
    s_xor_b32 s62, s59, 192
    v_xor_b32 v18, s62, v4
    s_xor_b32 s62, s59, 224
    v_xor_b32 v19, s62, v4
    s_xor_b32 s62, s59, 128
    v_xor_b32 v20, s62, v4
    s_xor_b32 s62, s59, 160
    v_xor_b32 v21, s62, v4
    s_xor_b32 s62, s59, 64
    v_xor_b32 v22, s62, v4
    s_xor_b32 s62, s59, 96
    v_xor_b32 v23, s62, v4
    s_xor_b32 s62, s59, 0
    v_xor_b32 v24, s62, v4
    s_xor_b32 s62, s59, 32
    v_xor_b32 v25, s62, v4
    v_add_u32 v8, s27, v6
    v_bfe_u32 v4, v1, 4, 1
    v_lshlrev_b32 v4, 5, v4
    v_and_b32 v2, 15, v1
    v_mul_u32_u24 v2, 2560, v2
    v_add_u32 v2, v2, v4
    v_bfe_u32 v4, v1, 5, 1
    v_lshl_add_u32 v9, v4, 4, v2
    s_xor_b32 s22, s20, 3
    s_mul_i32 s22, s22, 40960
    v_add_u32 v2, s22, v6
    s_xor_b32 s22, s20, 1
    s_mul_i32 s22, s22, 40960
    v_add_u32 v3, s22, v6
    s_xor_b32 s22, s20, 2
    s_mul_i32 s22, s22, 40960
    v_add_u32 v4, s22, v6
    v_and_b32 v26, 7, v1
    v_mul_u32_u24 v26, 2560, v26
    v_bfe_u32 v27, v1, 3, 1
    s_lshr_b32 s22, s20, 1
    s_xor_b32 s22, s22, 1
    v_xor_b32 v27, s22, v27
    v_lshl_add_u32 v26, v27, 6, v26
    v_bfe_u32 v27, v1, 4, 1
    v_lshl_add_u32 v26, v27, 5, v26
    v_bfe_u32 v27, v1, 5, 1
    v_lshl_add_u32 v26, v27, 4, v26
    v_xor_b32 v27, 64, v26
    v_add_u32 v27, 20480, v27
    s_mov_b32 s64, 0x00ff00ff
    s_mov_b32 s65, 0x00ff00ff
    s_mov_b32 s66, 0xff00ff00
    s_mov_b32 s67, 0xff00ff00
    s_mul_i32 s22, s28, 368640
    s_mul_i32 s23, s30, 1280
    s_add_u32 s22, s22, s23
    s_lshl_b32 s23, s29, 8
    s_add_u32 s24, s22, s23
    s_waitcnt vmcnt(17)
    ds_read_b64_tr_b16 v[60:61], v18 offset:0
    ds_read_b64_tr_b16 v[62:63], v18 offset:1024
    ds_read_b64_tr_b16 v[64:65], v19 offset:0
    ds_read_b64_tr_b16 v[66:67], v19 offset:1024
    ds_read_b64_tr_b16 v[68:69], v20 offset:0
    ds_read_b64_tr_b16 v[70:71], v20 offset:1024
    ds_read_b64_tr_b16 v[72:73], v21 offset:0
    ds_read_b64_tr_b16 v[74:75], v21 offset:1024
    ds_read_b64_tr_b16 v[76:77], v22 offset:0
    ds_read_b64_tr_b16 v[78:79], v22 offset:1024
    ds_read_b64_tr_b16 v[80:81], v23 offset:0
    ds_read_b64_tr_b16 v[82:83], v23 offset:1024
    ds_read_b64_tr_b16 v[84:85], v24 offset:0
    ds_read_b64_tr_b16 v[86:87], v24 offset:1024
    ds_read_b64_tr_b16 v[88:89], v25 offset:0
    ds_read_b64_tr_b16 v[90:91], v25 offset:1024
    s_waitcnt vmcnt(0) lgkmcnt(12)
    v_mfma_f32_16x16x32_bf16 a[0:3], v[60:63], v[92:95], 0
    buffer_load_dwordx4 v[128:131], v7, s[4:7], s48 offen
    v_mfma_f32_16x16x32_bf16 a[4:7], v[60:63], v[96:99], 0
    buffer_load_dwordx4 v[132:135], v7, s[4:7], s49 offen
    v_mfma_f32_16x16x32_bf16 a[8:11], v[60:63], v[100:103], 0
    buffer_load_dwordx4 v[136:139], v7, s[4:7], s50 offen
    v_mfma_f32_16x16x32_bf16 a[12:15], v[60:63], v[104:107], 0
    buffer_load_dwordx4 v[140:143], v7, s[4:7], s51 offen
    v_mfma_f32_16x16x32_bf16 a[16:19], v[60:63], v[108:111], 0
    buffer_load_dwordx4 v[144:147], v7, s[4:7], s52 offen
    v_mfma_f32_16x16x32_bf16 a[20:23], v[60:63], v[112:115], 0
    buffer_load_dwordx4 v[148:151], v7, s[4:7], s53 offen
    v_mfma_f32_16x16x32_bf16 a[24:27], v[60:63], v[116:119], 0
    buffer_load_dwordx4 v[152:155], v7, s[4:7], s54 offen
    v_mfma_f32_16x16x32_bf16 a[28:31], v[60:63], v[120:123], 0
    buffer_load_dwordx4 v[156:159], v7, s[4:7], s55 offen
    v_mfma_f32_16x16x32_bf16 a[32:35], v[60:63], v[124:127], 0
    ds_read_b64_tr_b16 v[60:61], v18 offset:8192
    ds_read_b64_tr_b16 v[62:63], v18 offset:9216
    v_mfma_f32_16x16x32_bf16 a[36:39], v[64:67], v[92:95], 0
    buffer_load_dwordx4 v[160:163], v7, s[4:7], s56 offen
    v_mfma_f32_16x16x32_bf16 a[40:43], v[64:67], v[96:99], 0
    v_add_u32 v7, 57344, v7
    v_mfma_f32_16x16x32_bf16 a[44:47], v[64:67], v[100:103], 0
    s_add_u32 m0, s27, 16384
    v_mfma_f32_16x16x32_bf16 a[48:51], v[64:67], v[104:107], 0
    s_nop 0
    v_mfma_f32_16x16x32_bf16 a[52:55], v[64:67], v[108:111], 0
    buffer_load_dwordx4 v10, s[8:11], s26 offen offset:0 lds
    v_mfma_f32_16x16x32_bf16 a[56:59], v[64:67], v[112:115], 0
    buffer_load_dwordx4 v11, s[8:11], s26 offen offset:1024 lds
    v_mfma_f32_16x16x32_bf16 a[60:63], v[64:67], v[116:119], 0
    buffer_load_dwordx4 v12, s[8:11], s26 offen offset:2048 lds
    v_mfma_f32_16x16x32_bf16 a[64:67], v[64:67], v[120:123], 0
    buffer_load_dwordx4 v13, s[8:11], s26 offen offset:3072 lds
    v_mfma_f32_16x16x32_bf16 a[68:71], v[64:67], v[124:127], 0
    ds_read_b64_tr_b16 v[64:65], v19 offset:8192
    ds_read_b64_tr_b16 v[66:67], v19 offset:9216
    s_waitcnt lgkmcnt(4)
    v_mfma_f32_16x16x32_bf16 a[72:75], v[68:71], v[92:95], 0
    s_add_u32 m0, s27, 20480
    v_mfma_f32_16x16x32_bf16 a[76:79], v[68:71], v[96:99], 0
    s_nop 0
    v_mfma_f32_16x16x32_bf16 a[80:83], v[68:71], v[100:103], 0
    buffer_load_dwordx4 v14, s[8:11], s26 offen offset:0 lds
    v_mfma_f32_16x16x32_bf16 a[84:87], v[68:71], v[104:107], 0
    buffer_load_dwordx4 v15, s[8:11], s26 offen offset:1024 lds
    v_mfma_f32_16x16x32_bf16 a[88:91], v[68:71], v[108:111], 0
    buffer_load_dwordx4 v16, s[8:11], s26 offen offset:2048 lds
    v_mfma_f32_16x16x32_bf16 a[92:95], v[68:71], v[112:115], 0
    buffer_load_dwordx4 v17, s[8:11], s26 offen offset:3072 lds
    v_mfma_f32_16x16x32_bf16 a[96:99], v[68:71], v[116:119], 0
    s_add_u32 s26, s26, 163840
    v_mfma_f32_16x16x32_bf16 a[100:103], v[68:71], v[120:123], 0
    s_add_u32 m0, s27, 24576
    v_mfma_f32_16x16x32_bf16 a[104:107], v[68:71], v[124:127], 0
    ds_read_b64_tr_b16 v[68:69], v20 offset:8192
    ds_read_b64_tr_b16 v[70:71], v20 offset:9216
    v_mfma_f32_16x16x32_bf16 a[108:111], v[72:75], v[92:95], 0
    s_nop 0
    v_mfma_f32_16x16x32_bf16 a[112:115], v[72:75], v[96:99], 0
    buffer_load_dwordx4 v10, s[8:11], s26 offen offset:0 lds
    v_mfma_f32_16x16x32_bf16 a[116:119], v[72:75], v[100:103], 0
    buffer_load_dwordx4 v11, s[8:11], s26 offen offset:1024 lds
    v_mfma_f32_16x16x32_bf16 a[120:123], v[72:75], v[104:107], 0
    buffer_load_dwordx4 v12, s[8:11], s26 offen offset:2048 lds
    v_mfma_f32_16x16x32_bf16 a[124:127], v[72:75], v[108:111], 0
    buffer_load_dwordx4 v13, s[8:11], s26 offen offset:3072 lds
    v_mfma_f32_16x16x32_bf16 a[128:131], v[72:75], v[112:115], 0
    s_add_u32 m0, s27, 28672
    v_mfma_f32_16x16x32_bf16 a[132:135], v[72:75], v[116:119], 0
    s_nop 0
    v_mfma_f32_16x16x32_bf16 a[136:139], v[72:75], v[120:123], 0
    buffer_load_dwordx4 v14, s[8:11], s26 offen offset:0 lds
    v_mfma_f32_16x16x32_bf16 a[140:143], v[72:75], v[124:127], 0
    ds_read_b64_tr_b16 v[72:73], v21 offset:8192
    ds_read_b64_tr_b16 v[74:75], v21 offset:9216
    v_mfma_f32_16x16x32_bf16 a[144:147], v[76:79], v[92:95], 0
    buffer_load_dwordx4 v15, s[8:11], s26 offen offset:1024 lds
    v_mfma_f32_16x16x32_bf16 a[148:151], v[76:79], v[96:99], 0
    buffer_load_dwordx4 v16, s[8:11], s26 offen offset:2048 lds
    v_mfma_f32_16x16x32_bf16 a[152:155], v[76:79], v[100:103], 0
    buffer_load_dwordx4 v17, s[8:11], s26 offen offset:3072 lds
    v_mfma_f32_16x16x32_bf16 a[156:159], v[76:79], v[104:107], 0
    s_add_u32 s26, s26, 163840
    v_mfma_f32_16x16x32_bf16 a[160:163], v[76:79], v[108:111], 0
    buffer_load_dwordx4 v[164:167], v7, s[4:7], s48 offen
    v_mfma_f32_16x16x32_bf16 a[164:167], v[76:79], v[112:115], 0
    buffer_load_dwordx4 v[168:171], v7, s[4:7], s49 offen
    v_mfma_f32_16x16x32_bf16 a[168:171], v[76:79], v[116:119], 0
    buffer_load_dwordx4 v[172:175], v7, s[4:7], s50 offen
    v_mfma_f32_16x16x32_bf16 v[36:39], v[76:79], v[120:123], 0
    buffer_load_dwordx4 v[176:179], v7, s[4:7], s51 offen
    v_mfma_f32_16x16x32_bf16 v[52:55], v[76:79], v[124:127], 0
    ds_read_b64_tr_b16 v[76:77], v22 offset:8192
    ds_read_b64_tr_b16 v[78:79], v22 offset:9216
    v_mfma_f32_16x16x32_bf16 a[172:175], v[80:83], v[92:95], 0
    buffer_load_dwordx4 v[180:183], v7, s[4:7], s52 offen
    v_mfma_f32_16x16x32_bf16 a[176:179], v[80:83], v[96:99], 0
    buffer_load_dwordx4 v[184:187], v7, s[4:7], s53 offen
    v_mfma_f32_16x16x32_bf16 a[180:183], v[80:83], v[100:103], 0
    buffer_load_dwordx4 v[188:191], v7, s[4:7], s54 offen
    v_mfma_f32_16x16x32_bf16 a[184:187], v[80:83], v[104:107], 0
    buffer_load_dwordx4 v[192:195], v7, s[4:7], s55 offen
    v_mfma_f32_16x16x32_bf16 a[188:191], v[80:83], v[108:111], 0
    buffer_load_dwordx4 v[196:199], v7, s[4:7], s56 offen
    v_mfma_f32_16x16x32_bf16 a[192:195], v[80:83], v[112:115], 0
    v_add_u32 v7, 57344, v7
    v_mfma_f32_16x16x32_bf16 a[196:199], v[80:83], v[116:119], 0
    buffer_load_dwordx4 v[200:203], v7, s[4:7], s48 offen
    v_mfma_f32_16x16x32_bf16 v[40:43], v[80:83], v[120:123], 0
    buffer_load_dwordx4 v[204:207], v7, s[4:7], s49 offen
    v_mfma_f32_16x16x32_bf16 v[56:59], v[80:83], v[124:127], 0
    ds_read_b64_tr_b16 v[80:81], v23 offset:8192
    ds_read_b64_tr_b16 v[82:83], v23 offset:9216
    v_mfma_f32_16x16x32_bf16 a[200:203], v[84:87], v[92:95], 0
    buffer_load_dwordx4 v[208:211], v7, s[4:7], s50 offen
    v_mfma_f32_16x16x32_bf16 a[204:207], v[84:87], v[96:99], 0
    buffer_load_dwordx4 v[212:215], v7, s[4:7], s51 offen
    v_mfma_f32_16x16x32_bf16 a[208:211], v[84:87], v[100:103], 0
    buffer_load_dwordx4 v[216:219], v7, s[4:7], s52 offen
    v_mfma_f32_16x16x32_bf16 a[212:215], v[84:87], v[104:107], 0
    buffer_load_dwordx4 v[220:223], v7, s[4:7], s53 offen
    v_mfma_f32_16x16x32_bf16 v[244:247], v[84:87], v[108:111], 0
    buffer_load_dwordx4 v[224:227], v7, s[4:7], s54 offen
    v_mfma_f32_16x16x32_bf16 a[216:219], v[84:87], v[112:115], 0
    buffer_load_dwordx4 v[228:231], v7, s[4:7], s55 offen
    v_mfma_f32_16x16x32_bf16 v[28:31], v[84:87], v[116:119], 0
    buffer_load_dwordx4 v[232:235], v7, s[4:7], s56 offen
    v_mfma_f32_16x16x32_bf16 v[44:47], v[84:87], v[120:123], 0
    v_add_u32 v7, 57344, v7
    v_mfma_f32_16x16x32_bf16 v[236:239], v[84:87], v[124:127], 0
    ds_read_b64_tr_b16 v[84:85], v24 offset:8192
    ds_read_b64_tr_b16 v[86:87], v24 offset:9216
    v_mfma_f32_16x16x32_bf16 a[220:223], v[88:91], v[92:95], 0
    v_mfma_f32_16x16x32_bf16 a[224:227], v[88:91], v[96:99], 0
    v_mfma_f32_16x16x32_bf16 a[228:231], v[88:91], v[100:103], 0
    v_mfma_f32_16x16x32_bf16 a[232:235], v[88:91], v[104:107], 0
    v_mfma_f32_16x16x32_bf16 v[248:251], v[88:91], v[108:111], 0
    v_mfma_f32_16x16x32_bf16 a[236:239], v[88:91], v[112:115], 0
    v_mfma_f32_16x16x32_bf16 v[32:35], v[88:91], v[116:119], 0
    v_mfma_f32_16x16x32_bf16 v[48:51], v[88:91], v[120:123], 0
    v_mfma_f32_16x16x32_bf16 v[240:243], v[88:91], v[124:127], 0
    ds_read_b64_tr_b16 v[88:89], v25 offset:8192
    ds_read_b64_tr_b16 v[90:91], v25 offset:9216
    s_waitcnt vmcnt(34) lgkmcnt(12)
    v_mfma_f32_16x16x32_bf16 a[0:3], v[60:63], v[128:131], a[0:3]
    v_mfma_f32_16x16x32_bf16 a[4:7], v[60:63], v[132:135], a[4:7]
    v_mfma_f32_16x16x32_bf16 a[8:11], v[60:63], v[136:139], a[8:11]
    v_mfma_f32_16x16x32_bf16 a[12:15], v[60:63], v[140:143], a[12:15]
    v_mfma_f32_16x16x32_bf16 a[16:19], v[60:63], v[144:147], a[16:19]
    v_mfma_f32_16x16x32_bf16 a[20:23], v[60:63], v[148:151], a[20:23]
    v_mfma_f32_16x16x32_bf16 a[24:27], v[60:63], v[152:155], a[24:27]
    v_mfma_f32_16x16x32_bf16 a[28:31], v[60:63], v[156:159], a[28:31]
    v_mfma_f32_16x16x32_bf16 a[32:35], v[60:63], v[160:163], a[32:35]
    v_mfma_f32_16x16x32_bf16 a[36:39], v[64:67], v[128:131], a[36:39]
    v_mfma_f32_16x16x32_bf16 a[40:43], v[64:67], v[132:135], a[40:43]
    v_mfma_f32_16x16x32_bf16 a[44:47], v[64:67], v[136:139], a[44:47]
    v_mfma_f32_16x16x32_bf16 a[48:51], v[64:67], v[140:143], a[48:51]
    v_mfma_f32_16x16x32_bf16 a[52:55], v[64:67], v[144:147], a[52:55]
    v_mfma_f32_16x16x32_bf16 a[56:59], v[64:67], v[148:151], a[56:59]
    v_mfma_f32_16x16x32_bf16 a[60:63], v[64:67], v[152:155], a[60:63]
    v_mfma_f32_16x16x32_bf16 a[64:67], v[64:67], v[156:159], a[64:67]
    v_mfma_f32_16x16x32_bf16 a[68:71], v[64:67], v[160:163], a[68:71]
    s_waitcnt vmcnt(18)
    ds_read_b64_tr_b16 v[60:61], v18 offset:16384
    ds_read_b64_tr_b16 v[62:63], v18 offset:17408
    ds_read_b64_tr_b16 v[64:65], v18 offset:24576
    ds_read_b64_tr_b16 v[66:67], v18 offset:25600
    s_waitcnt lgkmcnt(4)
    v_mfma_f32_16x16x32_bf16 a[72:75], v[68:71], v[128:131], a[72:75]
    s_add_u32 m0, s27, 0
    v_mfma_f32_16x16x32_bf16 a[76:79], v[68:71], v[132:135], a[76:79]
    s_nop 0
    v_mfma_f32_16x16x32_bf16 a[80:83], v[68:71], v[136:139], a[80:83]
    buffer_load_dwordx4 v10, s[8:11], s26 offen offset:0 lds
    v_mfma_f32_16x16x32_bf16 a[84:87], v[68:71], v[140:143], a[84:87]
    buffer_load_dwordx4 v11, s[8:11], s26 offen offset:1024 lds
    v_mfma_f32_16x16x32_bf16 a[88:91], v[68:71], v[144:147], a[88:91]
    buffer_load_dwordx4 v12, s[8:11], s26 offen offset:2048 lds
    v_mfma_f32_16x16x32_bf16 a[92:95], v[68:71], v[148:151], a[92:95]
    buffer_load_dwordx4 v13, s[8:11], s26 offen offset:3072 lds
    v_mfma_f32_16x16x32_bf16 a[96:99], v[68:71], v[152:155], a[96:99]
    s_add_u32 m0, s27, 4096
    v_mfma_f32_16x16x32_bf16 a[100:103], v[68:71], v[156:159], a[100:103]
    s_nop 0
    v_mfma_f32_16x16x32_bf16 a[104:107], v[68:71], v[160:163], a[104:107]
    buffer_load_dwordx4 v14, s[8:11], s26 offen offset:0 lds
    v_mfma_f32_16x16x32_bf16 a[108:111], v[72:75], v[128:131], a[108:111]
    buffer_load_dwordx4 v15, s[8:11], s26 offen offset:1024 lds
    v_mfma_f32_16x16x32_bf16 a[112:115], v[72:75], v[132:135], a[112:115]
    buffer_load_dwordx4 v16, s[8:11], s26 offen offset:2048 lds
    v_mfma_f32_16x16x32_bf16 a[116:119], v[72:75], v[136:139], a[116:119]
    buffer_load_dwordx4 v17, s[8:11], s26 offen offset:3072 lds
    v_mfma_f32_16x16x32_bf16 a[120:123], v[72:75], v[140:143], a[120:123]
    s_add_u32 s26, s26, 163840
    v_mfma_f32_16x16x32_bf16 a[124:127], v[72:75], v[144:147], a[124:127]
    s_add_u32 m0, s27, 8192
    v_mfma_f32_16x16x32_bf16 a[128:131], v[72:75], v[148:151], a[128:131]
    s_nop 0
    v_mfma_f32_16x16x32_bf16 a[132:135], v[72:75], v[152:155], a[132:135]
    buffer_load_dwordx4 v10, s[8:11], s26 offen offset:0 lds
    v_mfma_f32_16x16x32_bf16 a[136:139], v[72:75], v[156:159], a[136:139]
    buffer_load_dwordx4 v11, s[8:11], s26 offen offset:1024 lds
    v_mfma_f32_16x16x32_bf16 a[140:143], v[72:75], v[160:163], a[140:143]
    ds_read_b64_tr_b16 v[68:69], v19 offset:16384
    ds_read_b64_tr_b16 v[70:71], v19 offset:17408
    ds_read_b64_tr_b16 v[72:73], v19 offset:24576
    ds_read_b64_tr_b16 v[74:75], v19 offset:25600
    v_mfma_f32_16x16x32_bf16 a[144:147], v[76:79], v[128:131], a[144:147]
    buffer_load_dwordx4 v12, s[8:11], s26 offen offset:2048 lds
    v_mfma_f32_16x16x32_bf16 a[148:151], v[76:79], v[132:135], a[148:151]
    buffer_load_dwordx4 v13, s[8:11], s26 offen offset:3072 lds
    v_mfma_f32_16x16x32_bf16 a[152:155], v[76:79], v[136:139], a[152:155]
    s_add_u32 m0, s27, 12288
    v_mfma_f32_16x16x32_bf16 a[156:159], v[76:79], v[140:143], a[156:159]
    s_nop 0
    v_mfma_f32_16x16x32_bf16 a[160:163], v[76:79], v[144:147], a[160:163]
    buffer_load_dwordx4 v14, s[8:11], s26 offen offset:0 lds
    v_mfma_f32_16x16x32_bf16 a[164:167], v[76:79], v[148:151], a[164:167]
    buffer_load_dwordx4 v15, s[8:11], s26 offen offset:1024 lds
    v_mfma_f32_16x16x32_bf16 a[168:171], v[76:79], v[152:155], a[168:171]
    buffer_load_dwordx4 v16, s[8:11], s26 offen offset:2048 lds
    v_mfma_f32_16x16x32_bf16 v[36:39], v[76:79], v[156:159], v[36:39]
    buffer_load_dwordx4 v17, s[8:11], s26 offen offset:3072 lds
    v_mfma_f32_16x16x32_bf16 v[52:55], v[76:79], v[160:163], v[52:55]
    s_add_u32 s26, s26, 163840
    v_mfma_f32_16x16x32_bf16 a[172:175], v[80:83], v[128:131], a[172:175]
    v_mfma_f32_16x16x32_bf16 a[176:179], v[80:83], v[132:135], a[176:179]
    v_mfma_f32_16x16x32_bf16 a[180:183], v[80:83], v[136:139], a[180:183]
    v_mfma_f32_16x16x32_bf16 a[184:187], v[80:83], v[140:143], a[184:187]
    v_mfma_f32_16x16x32_bf16 a[188:191], v[80:83], v[144:147], a[188:191]
    v_mfma_f32_16x16x32_bf16 a[192:195], v[80:83], v[148:151], a[192:195]
    v_mfma_f32_16x16x32_bf16 a[196:199], v[80:83], v[152:155], a[196:199]
    v_mfma_f32_16x16x32_bf16 v[40:43], v[80:83], v[156:159], v[40:43]
    v_mfma_f32_16x16x32_bf16 v[56:59], v[80:83], v[160:163], v[56:59]
    ds_read_b64_tr_b16 v[76:77], v20 offset:16384
    ds_read_b64_tr_b16 v[78:79], v20 offset:17408
    ds_read_b64_tr_b16 v[80:81], v20 offset:24576
    ds_read_b64_tr_b16 v[82:83], v20 offset:25600
    v_mfma_f32_16x16x32_bf16 a[200:203], v[84:87], v[128:131], a[200:203]
    v_mfma_f32_16x16x32_bf16 a[204:207], v[84:87], v[132:135], a[204:207]
    v_mfma_f32_16x16x32_bf16 a[208:211], v[84:87], v[136:139], a[208:211]
    v_mfma_f32_16x16x32_bf16 a[212:215], v[84:87], v[140:143], a[212:215]
    v_mfma_f32_16x16x32_bf16 v[244:247], v[84:87], v[144:147], v[244:247]
    v_mfma_f32_16x16x32_bf16 a[216:219], v[84:87], v[148:151], a[216:219]
    v_mfma_f32_16x16x32_bf16 v[28:31], v[84:87], v[152:155], v[28:31]
    v_mfma_f32_16x16x32_bf16 v[44:47], v[84:87], v[156:159], v[44:47]
    v_mfma_f32_16x16x32_bf16 v[236:239], v[84:87], v[160:163], v[236:239]
    v_mfma_f32_16x16x32_bf16 a[220:223], v[88:91], v[128:131], a[220:223]
    v_mfma_f32_16x16x32_bf16 a[224:227], v[88:91], v[132:135], a[224:227]
    v_mfma_f32_16x16x32_bf16 a[228:231], v[88:91], v[136:139], a[228:231]
    v_mfma_f32_16x16x32_bf16 a[232:235], v[88:91], v[140:143], a[232:235]
    v_mfma_f32_16x16x32_bf16 v[248:251], v[88:91], v[144:147], v[248:251]
    v_mfma_f32_16x16x32_bf16 a[236:239], v[88:91], v[148:151], a[236:239]
    v_mfma_f32_16x16x32_bf16 v[32:35], v[88:91], v[152:155], v[32:35]
    v_mfma_f32_16x16x32_bf16 v[48:51], v[88:91], v[156:159], v[48:51]
    v_mfma_f32_16x16x32_bf16 v[240:243], v[88:91], v[160:163], v[240:243]
    ds_read_b64_tr_b16 v[84:85], v21 offset:16384
    ds_read_b64_tr_b16 v[86:87], v21 offset:17408
    ds_read_b64_tr_b16 v[88:89], v21 offset:24576
    ds_read_b64_tr_b16 v[90:91], v21 offset:25600
    s_waitcnt vmcnt(16) lgkmcnt(12)
    v_mfma_f32_16x16x32_bf16 a[0:3], v[60:63], v[164:167], a[0:3]
    buffer_load_dwordx4 v[92:95], v7, s[4:7], s48 offen
    v_mfma_f32_16x16x32_bf16 a[0:3], v[64:67], v[200:203], a[0:3]
    buffer_load_dwordx4 v[96:99], v7, s[4:7], s49 offen
    v_mfma_f32_16x16x32_bf16 a[4:7], v[60:63], v[168:171], a[4:7]
    buffer_load_dwordx4 v[100:103], v7, s[4:7], s50 offen
    v_mfma_f32_16x16x32_bf16 a[4:7], v[64:67], v[204:207], a[4:7]
    buffer_load_dwordx4 v[104:107], v7, s[4:7], s51 offen
    v_mfma_f32_16x16x32_bf16 a[8:11], v[60:63], v[172:175], a[8:11]
    buffer_load_dwordx4 v[108:111], v7, s[4:7], s52 offen
    v_mfma_f32_16x16x32_bf16 a[8:11], v[64:67], v[208:211], a[8:11]
    buffer_load_dwordx4 v[112:115], v7, s[4:7], s53 offen
    v_mfma_f32_16x16x32_bf16 a[12:15], v[60:63], v[176:179], a[12:15]
    buffer_load_dwordx4 v[116:119], v7, s[4:7], s54 offen
    v_mfma_f32_16x16x32_bf16 a[12:15], v[64:67], v[212:215], a[12:15]
    buffer_load_dwordx4 v[120:123], v7, s[4:7], s55 offen
    v_mfma_f32_16x16x32_bf16 a[16:19], v[60:63], v[180:183], a[16:19]
    buffer_load_dwordx4 v[124:127], v7, s[4:7], s56 offen
    v_mfma_f32_16x16x32_bf16 a[16:19], v[64:67], v[216:219], a[16:19]
    v_add_u32 v7, 57344, v7
    v_mfma_f32_16x16x32_bf16 a[20:23], v[60:63], v[184:187], a[20:23]
    buffer_load_dwordx4 v[128:131], v7, s[4:7], s48 offen
    v_mfma_f32_16x16x32_bf16 a[20:23], v[64:67], v[220:223], a[20:23]
    buffer_load_dwordx4 v[132:135], v7, s[4:7], s49 offen
    v_mfma_f32_16x16x32_bf16 a[24:27], v[60:63], v[188:191], a[24:27]
    buffer_load_dwordx4 v[136:139], v7, s[4:7], s50 offen
    v_mfma_f32_16x16x32_bf16 a[24:27], v[64:67], v[224:227], a[24:27]
    buffer_load_dwordx4 v[140:143], v7, s[4:7], s51 offen
    v_mfma_f32_16x16x32_bf16 a[28:31], v[60:63], v[192:195], a[28:31]
    buffer_load_dwordx4 v[144:147], v7, s[4:7], s52 offen
    v_mfma_f32_16x16x32_bf16 a[28:31], v[64:67], v[228:231], a[28:31]
    buffer_load_dwordx4 v[148:151], v7, s[4:7], s53 offen
    v_mfma_f32_16x16x32_bf16 a[32:35], v[60:63], v[196:199], a[32:35]
    buffer_load_dwordx4 v[152:155], v7, s[4:7], s54 offen
    v_mfma_f32_16x16x32_bf16 a[32:35], v[64:67], v[232:235], a[32:35]
    ds_read_b64_tr_b16 v[60:61], v22 offset:16384
    ds_read_b64_tr_b16 v[62:63], v22 offset:17408
    ds_read_b64_tr_b16 v[64:65], v22 offset:24576
    ds_read_b64_tr_b16 v[66:67], v22 offset:25600
    s_waitcnt lgkmcnt(12)
    v_mfma_f32_16x16x32_bf16 a[36:39], v[68:71], v[164:167], a[36:39]
    buffer_load_dwordx4 v[156:159], v7, s[4:7], s55 offen
    v_mfma_f32_16x16x32_bf16 a[36:39], v[72:75], v[200:203], a[36:39]
    buffer_load_dwordx4 v[160:163], v7, s[4:7], s56 offen
    v_mfma_f32_16x16x32_bf16 a[40:43], v[68:71], v[168:171], a[40:43]
    v_add_u32 v7, 57344, v7
    v_mfma_f32_16x16x32_bf16 a[40:43], v[72:75], v[204:207], a[40:43]
    v_mfma_f32_16x16x32_bf16 a[44:47], v[68:71], v[172:175], a[44:47]
    v_mfma_f32_16x16x32_bf16 a[44:47], v[72:75], v[208:211], a[44:47]
    v_mfma_f32_16x16x32_bf16 a[48:51], v[68:71], v[176:179], a[48:51]
    v_mfma_f32_16x16x32_bf16 a[48:51], v[72:75], v[212:215], a[48:51]
    v_mfma_f32_16x16x32_bf16 a[52:55], v[68:71], v[180:183], a[52:55]
    v_mfma_f32_16x16x32_bf16 a[52:55], v[72:75], v[216:219], a[52:55]
    v_mfma_f32_16x16x32_bf16 a[56:59], v[68:71], v[184:187], a[56:59]
    v_mfma_f32_16x16x32_bf16 a[56:59], v[72:75], v[220:223], a[56:59]
    v_mfma_f32_16x16x32_bf16 a[60:63], v[68:71], v[188:191], a[60:63]
    v_mfma_f32_16x16x32_bf16 a[60:63], v[72:75], v[224:227], a[60:63]
    v_mfma_f32_16x16x32_bf16 a[64:67], v[68:71], v[192:195], a[64:67]
    v_mfma_f32_16x16x32_bf16 a[64:67], v[72:75], v[228:231], a[64:67]
    v_mfma_f32_16x16x32_bf16 a[68:71], v[68:71], v[196:199], a[68:71]
    v_mfma_f32_16x16x32_bf16 a[68:71], v[72:75], v[232:235], a[68:71]
    ds_read_b64_tr_b16 v[68:69], v23 offset:16384
    ds_read_b64_tr_b16 v[70:71], v23 offset:17408
    ds_read_b64_tr_b16 v[72:73], v23 offset:24576
    ds_read_b64_tr_b16 v[74:75], v23 offset:25600
    s_waitcnt lgkmcnt(12)
    v_mfma_f32_16x16x32_bf16 a[72:75], v[76:79], v[164:167], a[72:75]
    v_mfma_f32_16x16x32_bf16 a[72:75], v[80:83], v[200:203], a[72:75]
    v_mfma_f32_16x16x32_bf16 a[76:79], v[76:79], v[168:171], a[76:79]
    v_mfma_f32_16x16x32_bf16 a[76:79], v[80:83], v[204:207], a[76:79]
    v_mfma_f32_16x16x32_bf16 a[80:83], v[76:79], v[172:175], a[80:83]
    v_mfma_f32_16x16x32_bf16 a[80:83], v[80:83], v[208:211], a[80:83]
    v_mfma_f32_16x16x32_bf16 a[84:87], v[76:79], v[176:179], a[84:87]
    v_mfma_f32_16x16x32_bf16 a[84:87], v[80:83], v[212:215], a[84:87]
    v_mfma_f32_16x16x32_bf16 a[88:91], v[76:79], v[180:183], a[88:91]
    v_mfma_f32_16x16x32_bf16 a[88:91], v[80:83], v[216:219], a[88:91]
    v_mfma_f32_16x16x32_bf16 a[92:95], v[76:79], v[184:187], a[92:95]
    v_mfma_f32_16x16x32_bf16 a[92:95], v[80:83], v[220:223], a[92:95]
    v_mfma_f32_16x16x32_bf16 a[96:99], v[76:79], v[188:191], a[96:99]
    v_mfma_f32_16x16x32_bf16 a[96:99], v[80:83], v[224:227], a[96:99]
    v_mfma_f32_16x16x32_bf16 a[100:103], v[76:79], v[192:195], a[100:103]
    v_mfma_f32_16x16x32_bf16 a[100:103], v[80:83], v[228:231], a[100:103]
    v_mfma_f32_16x16x32_bf16 a[104:107], v[76:79], v[196:199], a[104:107]
    v_mfma_f32_16x16x32_bf16 a[104:107], v[80:83], v[232:235], a[104:107]
    ds_read_b64_tr_b16 v[76:77], v24 offset:16384
    ds_read_b64_tr_b16 v[78:79], v24 offset:17408
    ds_read_b64_tr_b16 v[80:81], v24 offset:24576
    ds_read_b64_tr_b16 v[82:83], v24 offset:25600
    s_waitcnt lgkmcnt(12)
    v_mfma_f32_16x16x32_bf16 a[108:111], v[84:87], v[164:167], a[108:111]
    v_mfma_f32_16x16x32_bf16 a[108:111], v[88:91], v[200:203], a[108:111]
    v_mfma_f32_16x16x32_bf16 a[112:115], v[84:87], v[168:171], a[112:115]
    v_mfma_f32_16x16x32_bf16 a[112:115], v[88:91], v[204:207], a[112:115]
    v_mfma_f32_16x16x32_bf16 a[116:119], v[84:87], v[172:175], a[116:119]
    v_mfma_f32_16x16x32_bf16 a[116:119], v[88:91], v[208:211], a[116:119]
    v_mfma_f32_16x16x32_bf16 a[120:123], v[84:87], v[176:179], a[120:123]
    v_mfma_f32_16x16x32_bf16 a[120:123], v[88:91], v[212:215], a[120:123]
    v_mfma_f32_16x16x32_bf16 a[124:127], v[84:87], v[180:183], a[124:127]
    v_mfma_f32_16x16x32_bf16 a[124:127], v[88:91], v[216:219], a[124:127]
    v_mfma_f32_16x16x32_bf16 a[128:131], v[84:87], v[184:187], a[128:131]
    v_mfma_f32_16x16x32_bf16 a[128:131], v[88:91], v[220:223], a[128:131]
    v_mfma_f32_16x16x32_bf16 a[132:135], v[84:87], v[188:191], a[132:135]
    v_mfma_f32_16x16x32_bf16 a[132:135], v[88:91], v[224:227], a[132:135]
    v_mfma_f32_16x16x32_bf16 a[136:139], v[84:87], v[192:195], a[136:139]
    v_mfma_f32_16x16x32_bf16 a[136:139], v[88:91], v[228:231], a[136:139]
    v_mfma_f32_16x16x32_bf16 a[140:143], v[84:87], v[196:199], a[140:143]
    v_mfma_f32_16x16x32_bf16 a[140:143], v[88:91], v[232:235], a[140:143]
    ds_read_b64_tr_b16 v[84:85], v25 offset:16384
    ds_read_b64_tr_b16 v[86:87], v25 offset:17408
    ds_read_b64_tr_b16 v[88:89], v25 offset:24576
    ds_read_b64_tr_b16 v[90:91], v25 offset:25600
    s_waitcnt lgkmcnt(12)
    v_mfma_f32_16x16x32_bf16 a[144:147], v[60:63], v[164:167], a[144:147]
    v_mfma_f32_16x16x32_bf16 a[144:147], v[64:67], v[200:203], a[144:147]
    v_mfma_f32_16x16x32_bf16 a[148:151], v[60:63], v[168:171], a[148:151]
    v_mfma_f32_16x16x32_bf16 a[148:151], v[64:67], v[204:207], a[148:151]
    v_mfma_f32_16x16x32_bf16 a[152:155], v[60:63], v[172:175], a[152:155]
    v_mfma_f32_16x16x32_bf16 a[152:155], v[64:67], v[208:211], a[152:155]
    v_mfma_f32_16x16x32_bf16 a[156:159], v[60:63], v[176:179], a[156:159]
    v_mfma_f32_16x16x32_bf16 a[156:159], v[64:67], v[212:215], a[156:159]
    v_mfma_f32_16x16x32_bf16 a[160:163], v[60:63], v[180:183], a[160:163]
    v_mfma_f32_16x16x32_bf16 a[160:163], v[64:67], v[216:219], a[160:163]
    v_mfma_f32_16x16x32_bf16 a[164:167], v[60:63], v[184:187], a[164:167]
    v_mfma_f32_16x16x32_bf16 a[164:167], v[64:67], v[220:223], a[164:167]
    v_mfma_f32_16x16x32_bf16 a[168:171], v[60:63], v[188:191], a[168:171]
    v_mfma_f32_16x16x32_bf16 a[168:171], v[64:67], v[224:227], a[168:171]
    v_mfma_f32_16x16x32_bf16 v[36:39], v[60:63], v[192:195], v[36:39]
    v_mfma_f32_16x16x32_bf16 v[36:39], v[64:67], v[228:231], v[36:39]
    v_mfma_f32_16x16x32_bf16 v[52:55], v[60:63], v[196:199], v[52:55]
    v_mfma_f32_16x16x32_bf16 v[52:55], v[64:67], v[232:235], v[52:55]
    s_waitcnt vmcnt(18)
    ds_read_b64_tr_b16 v[60:61], v18 offset:0
    ds_read_b64_tr_b16 v[62:63], v18 offset:1024
    ds_read_b64_tr_b16 v[64:65], v18 offset:8192
    ds_read_b64_tr_b16 v[66:67], v18 offset:9216
    s_waitcnt lgkmcnt(4)
    v_mfma_f32_16x16x32_bf16 a[172:175], v[68:71], v[164:167], a[172:175]
    s_add_u32 m0, s27, 16384
    v_mfma_f32_16x16x32_bf16 a[172:175], v[72:75], v[200:203], a[172:175]
    s_nop 0
    v_mfma_f32_16x16x32_bf16 a[176:179], v[68:71], v[168:171], a[176:179]
    buffer_load_dwordx4 v10, s[8:11], s26 offen offset:0 lds
    v_mfma_f32_16x16x32_bf16 a[176:179], v[72:75], v[204:207], a[176:179]
    buffer_load_dwordx4 v11, s[8:11], s26 offen offset:1024 lds
    v_mfma_f32_16x16x32_bf16 a[180:183], v[68:71], v[172:175], a[180:183]
    buffer_load_dwordx4 v12, s[8:11], s26 offen offset:2048 lds
    v_mfma_f32_16x16x32_bf16 a[180:183], v[72:75], v[208:211], a[180:183]
    buffer_load_dwordx4 v13, s[8:11], s26 offen offset:3072 lds
    v_mfma_f32_16x16x32_bf16 a[184:187], v[68:71], v[176:179], a[184:187]
    s_add_u32 m0, s27, 20480
    v_mfma_f32_16x16x32_bf16 a[184:187], v[72:75], v[212:215], a[184:187]
    s_nop 0
    v_mfma_f32_16x16x32_bf16 a[188:191], v[68:71], v[180:183], a[188:191]
    buffer_load_dwordx4 v14, s[8:11], s26 offen offset:0 lds
    v_mfma_f32_16x16x32_bf16 a[188:191], v[72:75], v[216:219], a[188:191]
    buffer_load_dwordx4 v15, s[8:11], s26 offen offset:1024 lds
    v_mfma_f32_16x16x32_bf16 a[192:195], v[68:71], v[184:187], a[192:195]
    buffer_load_dwordx4 v16, s[8:11], s26 offen offset:2048 lds
    v_mfma_f32_16x16x32_bf16 a[192:195], v[72:75], v[220:223], a[192:195]
    buffer_load_dwordx4 v17, s[8:11], s26 offen offset:3072 lds
    v_mfma_f32_16x16x32_bf16 a[196:199], v[68:71], v[188:191], a[196:199]
    s_add_u32 s26, s26, 163840
    v_mfma_f32_16x16x32_bf16 a[196:199], v[72:75], v[224:227], a[196:199]
    s_add_u32 m0, s27, 24576
    v_mfma_f32_16x16x32_bf16 v[40:43], v[68:71], v[192:195], v[40:43]
    s_nop 0
    v_mfma_f32_16x16x32_bf16 v[40:43], v[72:75], v[228:231], v[40:43]
    buffer_load_dwordx4 v10, s[8:11], s26 offen offset:0 lds
    v_mfma_f32_16x16x32_bf16 v[56:59], v[68:71], v[196:199], v[56:59]
    buffer_load_dwordx4 v11, s[8:11], s26 offen offset:1024 lds
    v_mfma_f32_16x16x32_bf16 v[56:59], v[72:75], v[232:235], v[56:59]
    ds_read_b64_tr_b16 v[68:69], v19 offset:0
    ds_read_b64_tr_b16 v[70:71], v19 offset:1024
    ds_read_b64_tr_b16 v[72:73], v19 offset:8192
    ds_read_b64_tr_b16 v[74:75], v19 offset:9216
    s_waitcnt lgkmcnt(12)
    v_mfma_f32_16x16x32_bf16 a[200:203], v[76:79], v[164:167], a[200:203]
    buffer_load_dwordx4 v12, s[8:11], s26 offen offset:2048 lds
    v_mfma_f32_16x16x32_bf16 a[200:203], v[80:83], v[200:203], a[200:203]
    buffer_load_dwordx4 v13, s[8:11], s26 offen offset:3072 lds
    v_mfma_f32_16x16x32_bf16 a[204:207], v[76:79], v[168:171], a[204:207]
    s_add_u32 m0, s27, 28672
    v_mfma_f32_16x16x32_bf16 a[204:207], v[80:83], v[204:207], a[204:207]
    s_nop 0
    v_mfma_f32_16x16x32_bf16 a[208:211], v[76:79], v[172:175], a[208:211]
    buffer_load_dwordx4 v14, s[8:11], s26 offen offset:0 lds
    v_mfma_f32_16x16x32_bf16 a[208:211], v[80:83], v[208:211], a[208:211]
    buffer_load_dwordx4 v15, s[8:11], s26 offen offset:1024 lds
    v_mfma_f32_16x16x32_bf16 a[212:215], v[76:79], v[176:179], a[212:215]
    buffer_load_dwordx4 v16, s[8:11], s26 offen offset:2048 lds
    v_mfma_f32_16x16x32_bf16 a[212:215], v[80:83], v[212:215], a[212:215]
    buffer_load_dwordx4 v17, s[8:11], s26 offen offset:3072 lds
    v_mfma_f32_16x16x32_bf16 v[244:247], v[76:79], v[180:183], v[244:247]
    s_add_u32 s26, s26, 163840
    v_mfma_f32_16x16x32_bf16 v[244:247], v[80:83], v[216:219], v[244:247]
    v_mfma_f32_16x16x32_bf16 a[216:219], v[76:79], v[184:187], a[216:219]
    v_mfma_f32_16x16x32_bf16 a[216:219], v[80:83], v[220:223], a[216:219]
    v_mfma_f32_16x16x32_bf16 v[28:31], v[76:79], v[188:191], v[28:31]
    v_mfma_f32_16x16x32_bf16 v[28:31], v[80:83], v[224:227], v[28:31]
    v_mfma_f32_16x16x32_bf16 v[44:47], v[76:79], v[192:195], v[44:47]
    v_mfma_f32_16x16x32_bf16 v[44:47], v[80:83], v[228:231], v[44:47]
    v_mfma_f32_16x16x32_bf16 v[236:239], v[76:79], v[196:199], v[236:239]
    v_mfma_f32_16x16x32_bf16 v[236:239], v[80:83], v[232:235], v[236:239]
    ds_read_b64_tr_b16 v[76:77], v20 offset:0
    ds_read_b64_tr_b16 v[78:79], v20 offset:1024
    ds_read_b64_tr_b16 v[80:81], v20 offset:8192
    ds_read_b64_tr_b16 v[82:83], v20 offset:9216
    s_waitcnt lgkmcnt(12)
    v_mfma_f32_16x16x32_bf16 a[220:223], v[84:87], v[164:167], a[220:223]
    v_mfma_f32_16x16x32_bf16 a[220:223], v[88:91], v[200:203], a[220:223]
    v_mfma_f32_16x16x32_bf16 a[224:227], v[84:87], v[168:171], a[224:227]
    v_mfma_f32_16x16x32_bf16 a[224:227], v[88:91], v[204:207], a[224:227]
    v_mfma_f32_16x16x32_bf16 a[228:231], v[84:87], v[172:175], a[228:231]
    v_mfma_f32_16x16x32_bf16 a[228:231], v[88:91], v[208:211], a[228:231]
    v_mfma_f32_16x16x32_bf16 a[232:235], v[84:87], v[176:179], a[232:235]
    v_mfma_f32_16x16x32_bf16 a[232:235], v[88:91], v[212:215], a[232:235]
    v_mfma_f32_16x16x32_bf16 v[248:251], v[84:87], v[180:183], v[248:251]
    v_mfma_f32_16x16x32_bf16 v[248:251], v[88:91], v[216:219], v[248:251]
    v_mfma_f32_16x16x32_bf16 a[236:239], v[84:87], v[184:187], a[236:239]
    v_mfma_f32_16x16x32_bf16 a[236:239], v[88:91], v[220:223], a[236:239]
    v_mfma_f32_16x16x32_bf16 v[32:35], v[84:87], v[188:191], v[32:35]
    v_mfma_f32_16x16x32_bf16 v[32:35], v[88:91], v[224:227], v[32:35]
    v_mfma_f32_16x16x32_bf16 v[48:51], v[84:87], v[192:195], v[48:51]
    v_mfma_f32_16x16x32_bf16 v[48:51], v[88:91], v[228:231], v[48:51]
    v_mfma_f32_16x16x32_bf16 v[240:243], v[84:87], v[196:199], v[240:243]
    v_mfma_f32_16x16x32_bf16 v[240:243], v[88:91], v[232:235], v[240:243]
    ds_read_b64_tr_b16 v[84:85], v21 offset:0
    ds_read_b64_tr_b16 v[86:87], v21 offset:1024
    ds_read_b64_tr_b16 v[88:89], v21 offset:8192
    ds_read_b64_tr_b16 v[90:91], v21 offset:9216
    s_mov_b32 s21, 0
L_op_loop:
    s_waitcnt vmcnt(16) lgkmcnt(12)
    v_mfma_f32_16x16x32_bf16 a[0:3], v[60:63], v[92:95], a[0:3]
    buffer_load_dwordx4 v[164:167], v7, s[4:7], s48 offen
    v_mfma_f32_16x16x32_bf16 a[0:3], v[64:67], v[128:131], a[0:3]
    buffer_load_dwordx4 v[168:171], v7, s[4:7], s49 offen
    v_mfma_f32_16x16x32_bf16 a[4:7], v[60:63], v[96:99], a[4:7]
    buffer_load_dwordx4 v[172:175], v7, s[4:7], s50 offen
    v_mfma_f32_16x16x32_bf16 a[4:7], v[64:67], v[132:135], a[4:7]
    buffer_load_dwordx4 v[176:179], v7, s[4:7], s51 offen
    v_mfma_f32_16x16x32_bf16 a[8:11], v[60:63], v[100:103], a[8:11]
    buffer_load_dwordx4 v[180:183], v7, s[4:7], s52 offen
    v_mfma_f32_16x16x32_bf16 a[8:11], v[64:67], v[136:139], a[8:11]
    buffer_load_dwordx4 v[184:187], v7, s[4:7], s53 offen
    v_mfma_f32_16x16x32_bf16 a[12:15], v[60:63], v[104:107], a[12:15]
    buffer_load_dwordx4 v[188:191], v7, s[4:7], s54 offen
    v_mfma_f32_16x16x32_bf16 a[12:15], v[64:67], v[140:143], a[12:15]
    buffer_load_dwordx4 v[192:195], v7, s[4:7], s55 offen
    v_mfma_f32_16x16x32_bf16 a[16:19], v[60:63], v[108:111], a[16:19]
    buffer_load_dwordx4 v[196:199], v7, s[4:7], s56 offen
    v_mfma_f32_16x16x32_bf16 a[16:19], v[64:67], v[144:147], a[16:19]
    v_add_u32 v7, 57344, v7
    v_mfma_f32_16x16x32_bf16 a[20:23], v[60:63], v[112:115], a[20:23]
    buffer_load_dwordx4 v[200:203], v7, s[4:7], s48 offen
    v_mfma_f32_16x16x32_bf16 a[20:23], v[64:67], v[148:151], a[20:23]
    buffer_load_dwordx4 v[204:207], v7, s[4:7], s49 offen
    v_mfma_f32_16x16x32_bf16 a[24:27], v[60:63], v[116:119], a[24:27]
    buffer_load_dwordx4 v[208:211], v7, s[4:7], s50 offen
    v_mfma_f32_16x16x32_bf16 a[24:27], v[64:67], v[152:155], a[24:27]
    buffer_load_dwordx4 v[212:215], v7, s[4:7], s51 offen
    v_mfma_f32_16x16x32_bf16 a[28:31], v[60:63], v[120:123], a[28:31]
    buffer_load_dwordx4 v[216:219], v7, s[4:7], s52 offen
    v_mfma_f32_16x16x32_bf16 a[28:31], v[64:67], v[156:159], a[28:31]
    buffer_load_dwordx4 v[220:223], v7, s[4:7], s53 offen
    v_mfma_f32_16x16x32_bf16 a[32:35], v[60:63], v[124:127], a[32:35]
    buffer_load_dwordx4 v[224:227], v7, s[4:7], s54 offen
    v_mfma_f32_16x16x32_bf16 a[32:35], v[64:67], v[160:163], a[32:35]
    ds_read_b64_tr_b16 v[60:61], v22 offset:0
    ds_read_b64_tr_b16 v[62:63], v22 offset:1024
    ds_read_b64_tr_b16 v[64:65], v22 offset:8192
    ds_read_b64_tr_b16 v[66:67], v22 offset:9216
    s_waitcnt lgkmcnt(12)
    v_mfma_f32_16x16x32_bf16 a[36:39], v[68:71], v[92:95], a[36:39]
    buffer_load_dwordx4 v[228:231], v7, s[4:7], s55 offen
    v_mfma_f32_16x16x32_bf16 a[36:39], v[72:75], v[128:131], a[36:39]
    buffer_load_dwordx4 v[232:235], v7, s[4:7], s56 offen
    v_mfma_f32_16x16x32_bf16 a[40:43], v[68:71], v[96:99], a[40:43]
    v_add_u32 v7, 57344, v7
    v_mfma_f32_16x16x32_bf16 a[40:43], v[72:75], v[132:135], a[40:43]
    v_mfma_f32_16x16x32_bf16 a[44:47], v[68:71], v[100:103], a[44:47]
    v_mfma_f32_16x16x32_bf16 a[44:47], v[72:75], v[136:139], a[44:47]
    v_mfma_f32_16x16x32_bf16 a[48:51], v[68:71], v[104:107], a[48:51]
    v_mfma_f32_16x16x32_bf16 a[48:51], v[72:75], v[140:143], a[48:51]
    v_mfma_f32_16x16x32_bf16 a[52:55], v[68:71], v[108:111], a[52:55]
    v_mfma_f32_16x16x32_bf16 a[52:55], v[72:75], v[144:147], a[52:55]
    v_mfma_f32_16x16x32_bf16 a[56:59], v[68:71], v[112:115], a[56:59]
    v_mfma_f32_16x16x32_bf16 a[56:59], v[72:75], v[148:151], a[56:59]
    v_mfma_f32_16x16x32_bf16 a[60:63], v[68:71], v[116:119], a[60:63]
    v_mfma_f32_16x16x32_bf16 a[60:63], v[72:75], v[152:155], a[60:63]
    v_mfma_f32_16x16x32_bf16 a[64:67], v[68:71], v[120:123], a[64:67]
    v_mfma_f32_16x16x32_bf16 a[64:67], v[72:75], v[156:159], a[64:67]
    v_mfma_f32_16x16x32_bf16 a[68:71], v[68:71], v[124:127], a[68:71]
    v_mfma_f32_16x16x32_bf16 a[68:71], v[72:75], v[160:163], a[68:71]
    ds_read_b64_tr_b16 v[68:69], v23 offset:0
    ds_read_b64_tr_b16 v[70:71], v23 offset:1024
    ds_read_b64_tr_b16 v[72:73], v23 offset:8192
    ds_read_b64_tr_b16 v[74:75], v23 offset:9216
    s_waitcnt lgkmcnt(12)
    v_mfma_f32_16x16x32_bf16 a[72:75], v[76:79], v[92:95], a[72:75]
    v_mfma_f32_16x16x32_bf16 a[72:75], v[80:83], v[128:131], a[72:75]
    v_mfma_f32_16x16x32_bf16 a[76:79], v[76:79], v[96:99], a[76:79]
    v_mfma_f32_16x16x32_bf16 a[76:79], v[80:83], v[132:135], a[76:79]
    v_mfma_f32_16x16x32_bf16 a[80:83], v[76:79], v[100:103], a[80:83]
    v_mfma_f32_16x16x32_bf16 a[80:83], v[80:83], v[136:139], a[80:83]
    v_mfma_f32_16x16x32_bf16 a[84:87], v[76:79], v[104:107], a[84:87]
    v_mfma_f32_16x16x32_bf16 a[84:87], v[80:83], v[140:143], a[84:87]
    v_mfma_f32_16x16x32_bf16 a[88:91], v[76:79], v[108:111], a[88:91]
    v_mfma_f32_16x16x32_bf16 a[88:91], v[80:83], v[144:147], a[88:91]
    v_mfma_f32_16x16x32_bf16 a[92:95], v[76:79], v[112:115], a[92:95]
    v_mfma_f32_16x16x32_bf16 a[92:95], v[80:83], v[148:151], a[92:95]
    v_mfma_f32_16x16x32_bf16 a[96:99], v[76:79], v[116:119], a[96:99]
    v_mfma_f32_16x16x32_bf16 a[96:99], v[80:83], v[152:155], a[96:99]
    v_mfma_f32_16x16x32_bf16 a[100:103], v[76:79], v[120:123], a[100:103]
    v_mfma_f32_16x16x32_bf16 a[100:103], v[80:83], v[156:159], a[100:103]
    v_mfma_f32_16x16x32_bf16 a[104:107], v[76:79], v[124:127], a[104:107]
    v_mfma_f32_16x16x32_bf16 a[104:107], v[80:83], v[160:163], a[104:107]
    ds_read_b64_tr_b16 v[76:77], v24 offset:0
    ds_read_b64_tr_b16 v[78:79], v24 offset:1024
    ds_read_b64_tr_b16 v[80:81], v24 offset:8192
    ds_read_b64_tr_b16 v[82:83], v24 offset:9216
    s_waitcnt lgkmcnt(12)
    v_mfma_f32_16x16x32_bf16 a[108:111], v[84:87], v[92:95], a[108:111]
    v_mfma_f32_16x16x32_bf16 a[108:111], v[88:91], v[128:131], a[108:111]
    v_mfma_f32_16x16x32_bf16 a[112:115], v[84:87], v[96:99], a[112:115]
    v_mfma_f32_16x16x32_bf16 a[112:115], v[88:91], v[132:135], a[112:115]
    v_mfma_f32_16x16x32_bf16 a[116:119], v[84:87], v[100:103], a[116:119]
    v_mfma_f32_16x16x32_bf16 a[116:119], v[88:91], v[136:139], a[116:119]
    v_mfma_f32_16x16x32_bf16 a[120:123], v[84:87], v[104:107], a[120:123]
    v_mfma_f32_16x16x32_bf16 a[120:123], v[88:91], v[140:143], a[120:123]
    v_mfma_f32_16x16x32_bf16 a[124:127], v[84:87], v[108:111], a[124:127]
    v_mfma_f32_16x16x32_bf16 a[124:127], v[88:91], v[144:147], a[124:127]
    v_mfma_f32_16x16x32_bf16 a[128:131], v[84:87], v[112:115], a[128:131]
    v_mfma_f32_16x16x32_bf16 a[128:131], v[88:91], v[148:151], a[128:131]
    v_mfma_f32_16x16x32_bf16 a[132:135], v[84:87], v[116:119], a[132:135]
    v_mfma_f32_16x16x32_bf16 a[132:135], v[88:91], v[152:155], a[132:135]
    v_mfma_f32_16x16x32_bf16 a[136:139], v[84:87], v[120:123], a[136:139]
    v_mfma_f32_16x16x32_bf16 a[136:139], v[88:91], v[156:159], a[136:139]
    v_mfma_f32_16x16x32_bf16 a[140:143], v[84:87], v[124:127], a[140:143]
    v_mfma_f32_16x16x32_bf16 a[140:143], v[88:91], v[160:163], a[140:143]
    ds_read_b64_tr_b16 v[84:85], v25 offset:0
    ds_read_b64_tr_b16 v[86:87], v25 offset:1024
    ds_read_b64_tr_b16 v[88:89], v25 offset:8192
    ds_read_b64_tr_b16 v[90:91], v25 offset:9216
    s_waitcnt lgkmcnt(12)
    v_mfma_f32_16x16x32_bf16 a[144:147], v[60:63], v[92:95], a[144:147]
    v_mfma_f32_16x16x32_bf16 a[144:147], v[64:67], v[128:131], a[144:147]
    v_mfma_f32_16x16x32_bf16 a[148:151], v[60:63], v[96:99], a[148:151]
    v_mfma_f32_16x16x32_bf16 a[148:151], v[64:67], v[132:135], a[148:151]
    v_mfma_f32_16x16x32_bf16 a[152:155], v[60:63], v[100:103], a[152:155]
    v_mfma_f32_16x16x32_bf16 a[152:155], v[64:67], v[136:139], a[152:155]
    v_mfma_f32_16x16x32_bf16 a[156:159], v[60:63], v[104:107], a[156:159]
    v_mfma_f32_16x16x32_bf16 a[156:159], v[64:67], v[140:143], a[156:159]
    v_mfma_f32_16x16x32_bf16 a[160:163], v[60:63], v[108:111], a[160:163]
    v_mfma_f32_16x16x32_bf16 a[160:163], v[64:67], v[144:147], a[160:163]
    v_mfma_f32_16x16x32_bf16 a[164:167], v[60:63], v[112:115], a[164:167]
    v_mfma_f32_16x16x32_bf16 a[164:167], v[64:67], v[148:151], a[164:167]
    v_mfma_f32_16x16x32_bf16 a[168:171], v[60:63], v[116:119], a[168:171]
    v_mfma_f32_16x16x32_bf16 a[168:171], v[64:67], v[152:155], a[168:171]
    v_mfma_f32_16x16x32_bf16 v[36:39], v[60:63], v[120:123], v[36:39]
    v_mfma_f32_16x16x32_bf16 v[36:39], v[64:67], v[156:159], v[36:39]
    v_mfma_f32_16x16x32_bf16 v[52:55], v[60:63], v[124:127], v[52:55]
    v_mfma_f32_16x16x32_bf16 v[52:55], v[64:67], v[160:163], v[52:55]
    s_waitcnt vmcnt(18)
    ds_read_b64_tr_b16 v[60:61], v18 offset:16384
    ds_read_b64_tr_b16 v[62:63], v18 offset:17408
    ds_read_b64_tr_b16 v[64:65], v18 offset:24576
    ds_read_b64_tr_b16 v[66:67], v18 offset:25600
    s_waitcnt lgkmcnt(4)
    v_mfma_f32_16x16x32_bf16 a[172:175], v[68:71], v[92:95], a[172:175]
    s_add_u32 m0, s27, 0
    v_mfma_f32_16x16x32_bf16 a[172:175], v[72:75], v[128:131], a[172:175]
    s_nop 0
    v_mfma_f32_16x16x32_bf16 a[176:179], v[68:71], v[96:99], a[176:179]
    buffer_load_dwordx4 v10, s[8:11], s26 offen offset:0 lds
    v_mfma_f32_16x16x32_bf16 a[176:179], v[72:75], v[132:135], a[176:179]
    buffer_load_dwordx4 v11, s[8:11], s26 offen offset:1024 lds
    v_mfma_f32_16x16x32_bf16 a[180:183], v[68:71], v[100:103], a[180:183]
    buffer_load_dwordx4 v12, s[8:11], s26 offen offset:2048 lds
    v_mfma_f32_16x16x32_bf16 a[180:183], v[72:75], v[136:139], a[180:183]
    buffer_load_dwordx4 v13, s[8:11], s26 offen offset:3072 lds
    v_mfma_f32_16x16x32_bf16 a[184:187], v[68:71], v[104:107], a[184:187]
    s_add_u32 m0, s27, 4096
    v_mfma_f32_16x16x32_bf16 a[184:187], v[72:75], v[140:143], a[184:187]
    s_nop 0
    v_mfma_f32_16x16x32_bf16 a[188:191], v[68:71], v[108:111], a[188:191]
    buffer_load_dwordx4 v14, s[8:11], s26 offen offset:0 lds
    v_mfma_f32_16x16x32_bf16 a[188:191], v[72:75], v[144:147], a[188:191]
    buffer_load_dwordx4 v15, s[8:11], s26 offen offset:1024 lds
    v_mfma_f32_16x16x32_bf16 a[192:195], v[68:71], v[112:115], a[192:195]
    buffer_load_dwordx4 v16, s[8:11], s26 offen offset:2048 lds
    v_mfma_f32_16x16x32_bf16 a[192:195], v[72:75], v[148:151], a[192:195]
    buffer_load_dwordx4 v17, s[8:11], s26 offen offset:3072 lds
    v_mfma_f32_16x16x32_bf16 a[196:199], v[68:71], v[116:119], a[196:199]
    s_add_u32 s26, s26, 163840
    v_mfma_f32_16x16x32_bf16 a[196:199], v[72:75], v[152:155], a[196:199]
    s_add_u32 m0, s27, 8192
    v_mfma_f32_16x16x32_bf16 v[40:43], v[68:71], v[120:123], v[40:43]
    s_nop 0
    v_mfma_f32_16x16x32_bf16 v[40:43], v[72:75], v[156:159], v[40:43]
    buffer_load_dwordx4 v10, s[8:11], s26 offen offset:0 lds
    v_mfma_f32_16x16x32_bf16 v[56:59], v[68:71], v[124:127], v[56:59]
    buffer_load_dwordx4 v11, s[8:11], s26 offen offset:1024 lds
    v_mfma_f32_16x16x32_bf16 v[56:59], v[72:75], v[160:163], v[56:59]
    ds_read_b64_tr_b16 v[68:69], v19 offset:16384
    ds_read_b64_tr_b16 v[70:71], v19 offset:17408
    ds_read_b64_tr_b16 v[72:73], v19 offset:24576
    ds_read_b64_tr_b16 v[74:75], v19 offset:25600
    s_waitcnt lgkmcnt(12)
    v_mfma_f32_16x16x32_bf16 a[200:203], v[76:79], v[92:95], a[200:203]
    buffer_load_dwordx4 v12, s[8:11], s26 offen offset:2048 lds
    v_mfma_f32_16x16x32_bf16 a[200:203], v[80:83], v[128:131], a[200:203]
    buffer_load_dwordx4 v13, s[8:11], s26 offen offset:3072 lds
    v_mfma_f32_16x16x32_bf16 a[204:207], v[76:79], v[96:99], a[204:207]
    s_add_u32 m0, s27, 12288
    v_mfma_f32_16x16x32_bf16 a[204:207], v[80:83], v[132:135], a[204:207]
    s_nop 0
    v_mfma_f32_16x16x32_bf16 a[208:211], v[76:79], v[100:103], a[208:211]
    buffer_load_dwordx4 v14, s[8:11], s26 offen offset:0 lds
    v_mfma_f32_16x16x32_bf16 a[208:211], v[80:83], v[136:139], a[208:211]
    buffer_load_dwordx4 v15, s[8:11], s26 offen offset:1024 lds
    v_mfma_f32_16x16x32_bf16 a[212:215], v[76:79], v[104:107], a[212:215]
    buffer_load_dwordx4 v16, s[8:11], s26 offen offset:2048 lds
    v_mfma_f32_16x16x32_bf16 a[212:215], v[80:83], v[140:143], a[212:215]
    buffer_load_dwordx4 v17, s[8:11], s26 offen offset:3072 lds
    v_mfma_f32_16x16x32_bf16 v[244:247], v[76:79], v[108:111], v[244:247]
    s_add_u32 s26, s26, 163840
    v_mfma_f32_16x16x32_bf16 v[244:247], v[80:83], v[144:147], v[244:247]
    v_mfma_f32_16x16x32_bf16 a[216:219], v[76:79], v[112:115], a[216:219]
    v_mfma_f32_16x16x32_bf16 a[216:219], v[80:83], v[148:151], a[216:219]
    v_mfma_f32_16x16x32_bf16 v[28:31], v[76:79], v[116:119], v[28:31]
    v_mfma_f32_16x16x32_bf16 v[28:31], v[80:83], v[152:155], v[28:31]
    v_mfma_f32_16x16x32_bf16 v[44:47], v[76:79], v[120:123], v[44:47]
    v_mfma_f32_16x16x32_bf16 v[44:47], v[80:83], v[156:159], v[44:47]
    v_mfma_f32_16x16x32_bf16 v[236:239], v[76:79], v[124:127], v[236:239]
    v_mfma_f32_16x16x32_bf16 v[236:239], v[80:83], v[160:163], v[236:239]
    ds_read_b64_tr_b16 v[76:77], v20 offset:16384
    ds_read_b64_tr_b16 v[78:79], v20 offset:17408
    ds_read_b64_tr_b16 v[80:81], v20 offset:24576
    ds_read_b64_tr_b16 v[82:83], v20 offset:25600
    s_waitcnt lgkmcnt(12)
    v_mfma_f32_16x16x32_bf16 a[220:223], v[84:87], v[92:95], a[220:223]
    v_mfma_f32_16x16x32_bf16 a[220:223], v[88:91], v[128:131], a[220:223]
    v_mfma_f32_16x16x32_bf16 a[224:227], v[84:87], v[96:99], a[224:227]
    v_mfma_f32_16x16x32_bf16 a[224:227], v[88:91], v[132:135], a[224:227]
    v_mfma_f32_16x16x32_bf16 a[228:231], v[84:87], v[100:103], a[228:231]
    v_mfma_f32_16x16x32_bf16 a[228:231], v[88:91], v[136:139], a[228:231]
    v_mfma_f32_16x16x32_bf16 a[232:235], v[84:87], v[104:107], a[232:235]
    v_mfma_f32_16x16x32_bf16 a[232:235], v[88:91], v[140:143], a[232:235]
    v_mfma_f32_16x16x32_bf16 v[248:251], v[84:87], v[108:111], v[248:251]
    v_mfma_f32_16x16x32_bf16 v[248:251], v[88:91], v[144:147], v[248:251]
    v_mfma_f32_16x16x32_bf16 a[236:239], v[84:87], v[112:115], a[236:239]
    v_mfma_f32_16x16x32_bf16 a[236:239], v[88:91], v[148:151], a[236:239]
    v_mfma_f32_16x16x32_bf16 v[32:35], v[84:87], v[116:119], v[32:35]
    v_mfma_f32_16x16x32_bf16 v[32:35], v[88:91], v[152:155], v[32:35]
    v_mfma_f32_16x16x32_bf16 v[48:51], v[84:87], v[120:123], v[48:51]
    v_mfma_f32_16x16x32_bf16 v[48:51], v[88:91], v[156:159], v[48:51]
    v_mfma_f32_16x16x32_bf16 v[240:243], v[84:87], v[124:127], v[240:243]
    v_mfma_f32_16x16x32_bf16 v[240:243], v[88:91], v[160:163], v[240:243]
    ds_read_b64_tr_b16 v[84:85], v21 offset:16384
    ds_read_b64_tr_b16 v[86:87], v21 offset:17408
    ds_read_b64_tr_b16 v[88:89], v21 offset:24576
    ds_read_b64_tr_b16 v[90:91], v21 offset:25600
    s_waitcnt vmcnt(16) lgkmcnt(12)
    v_mfma_f32_16x16x32_bf16 a[0:3], v[60:63], v[164:167], a[0:3]
    buffer_load_dwordx4 v[92:95], v7, s[4:7], s48 offen
    v_mfma_f32_16x16x32_bf16 a[0:3], v[64:67], v[200:203], a[0:3]
    buffer_load_dwordx4 v[96:99], v7, s[4:7], s49 offen
    v_mfma_f32_16x16x32_bf16 a[4:7], v[60:63], v[168:171], a[4:7]
    buffer_load_dwordx4 v[100:103], v7, s[4:7], s50 offen
    v_mfma_f32_16x16x32_bf16 a[4:7], v[64:67], v[204:207], a[4:7]
    buffer_load_dwordx4 v[104:107], v7, s[4:7], s51 offen
    v_mfma_f32_16x16x32_bf16 a[8:11], v[60:63], v[172:175], a[8:11]
    buffer_load_dwordx4 v[108:111], v7, s[4:7], s52 offen
    v_mfma_f32_16x16x32_bf16 a[8:11], v[64:67], v[208:211], a[8:11]
    buffer_load_dwordx4 v[112:115], v7, s[4:7], s53 offen
    v_mfma_f32_16x16x32_bf16 a[12:15], v[60:63], v[176:179], a[12:15]
    buffer_load_dwordx4 v[116:119], v7, s[4:7], s54 offen
    v_mfma_f32_16x16x32_bf16 a[12:15], v[64:67], v[212:215], a[12:15]
    buffer_load_dwordx4 v[120:123], v7, s[4:7], s55 offen
    v_mfma_f32_16x16x32_bf16 a[16:19], v[60:63], v[180:183], a[16:19]
    buffer_load_dwordx4 v[124:127], v7, s[4:7], s56 offen
    v_mfma_f32_16x16x32_bf16 a[16:19], v[64:67], v[216:219], a[16:19]
    v_add_u32 v7, 57344, v7
    v_mfma_f32_16x16x32_bf16 a[20:23], v[60:63], v[184:187], a[20:23]
    buffer_load_dwordx4 v[128:131], v7, s[4:7], s48 offen
    v_mfma_f32_16x16x32_bf16 a[20:23], v[64:67], v[220:223], a[20:23]
    buffer_load_dwordx4 v[132:135], v7, s[4:7], s49 offen
    v_mfma_f32_16x16x32_bf16 a[24:27], v[60:63], v[188:191], a[24:27]
    buffer_load_dwordx4 v[136:139], v7, s[4:7], s50 offen
    v_mfma_f32_16x16x32_bf16 a[24:27], v[64:67], v[224:227], a[24:27]
    buffer_load_dwordx4 v[140:143], v7, s[4:7], s51 offen
    v_mfma_f32_16x16x32_bf16 a[28:31], v[60:63], v[192:195], a[28:31]
    buffer_load_dwordx4 v[144:147], v7, s[4:7], s52 offen
    v_mfma_f32_16x16x32_bf16 a[28:31], v[64:67], v[228:231], a[28:31]
    buffer_load_dwordx4 v[148:151], v7, s[4:7], s53 offen
    v_mfma_f32_16x16x32_bf16 a[32:35], v[60:63], v[196:199], a[32:35]
    buffer_load_dwordx4 v[152:155], v7, s[4:7], s54 offen
    v_mfma_f32_16x16x32_bf16 a[32:35], v[64:67], v[232:235], a[32:35]
    ds_read_b64_tr_b16 v[60:61], v22 offset:16384
    ds_read_b64_tr_b16 v[62:63], v22 offset:17408
    ds_read_b64_tr_b16 v[64:65], v22 offset:24576
    ds_read_b64_tr_b16 v[66:67], v22 offset:25600
    s_waitcnt lgkmcnt(12)
    v_mfma_f32_16x16x32_bf16 a[36:39], v[68:71], v[164:167], a[36:39]
    buffer_load_dwordx4 v[156:159], v7, s[4:7], s55 offen
    v_mfma_f32_16x16x32_bf16 a[36:39], v[72:75], v[200:203], a[36:39]
    buffer_load_dwordx4 v[160:163], v7, s[4:7], s56 offen
    v_mfma_f32_16x16x32_bf16 a[40:43], v[68:71], v[168:171], a[40:43]
    v_add_u32 v7, 57344, v7
    v_mfma_f32_16x16x32_bf16 a[40:43], v[72:75], v[204:207], a[40:43]
    v_mfma_f32_16x16x32_bf16 a[44:47], v[68:71], v[172:175], a[44:47]
    v_mfma_f32_16x16x32_bf16 a[44:47], v[72:75], v[208:211], a[44:47]
    v_mfma_f32_16x16x32_bf16 a[48:51], v[68:71], v[176:179], a[48:51]
    v_mfma_f32_16x16x32_bf16 a[48:51], v[72:75], v[212:215], a[48:51]
    v_mfma_f32_16x16x32_bf16 a[52:55], v[68:71], v[180:183], a[52:55]
    v_mfma_f32_16x16x32_bf16 a[52:55], v[72:75], v[216:219], a[52:55]
    v_mfma_f32_16x16x32_bf16 a[56:59], v[68:71], v[184:187], a[56:59]
    v_mfma_f32_16x16x32_bf16 a[56:59], v[72:75], v[220:223], a[56:59]
    v_mfma_f32_16x16x32_bf16 a[60:63], v[68:71], v[188:191], a[60:63]
    v_mfma_f32_16x16x32_bf16 a[60:63], v[72:75], v[224:227], a[60:63]
    v_mfma_f32_16x16x32_bf16 a[64:67], v[68:71], v[192:195], a[64:67]
    v_mfma_f32_16x16x32_bf16 a[64:67], v[72:75], v[228:231], a[64:67]
    v_mfma_f32_16x16x32_bf16 a[68:71], v[68:71], v[196:199], a[68:71]
    v_mfma_f32_16x16x32_bf16 a[68:71], v[72:75], v[232:235], a[68:71]
    ds_read_b64_tr_b16 v[68:69], v23 offset:16384
    ds_read_b64_tr_b16 v[70:71], v23 offset:17408
    ds_read_b64_tr_b16 v[72:73], v23 offset:24576
    ds_read_b64_tr_b16 v[74:75], v23 offset:25600
    s_waitcnt lgkmcnt(12)
    v_mfma_f32_16x16x32_bf16 a[72:75], v[76:79], v[164:167], a[72:75]
    v_mfma_f32_16x16x32_bf16 a[72:75], v[80:83], v[200:203], a[72:75]
    v_mfma_f32_16x16x32_bf16 a[76:79], v[76:79], v[168:171], a[76:79]
    v_mfma_f32_16x16x32_bf16 a[76:79], v[80:83], v[204:207], a[76:79]
    v_mfma_f32_16x16x32_bf16 a[80:83], v[76:79], v[172:175], a[80:83]
    v_mfma_f32_16x16x32_bf16 a[80:83], v[80:83], v[208:211], a[80:83]
    v_mfma_f32_16x16x32_bf16 a[84:87], v[76:79], v[176:179], a[84:87]
    v_mfma_f32_16x16x32_bf16 a[84:87], v[80:83], v[212:215], a[84:87]
    v_mfma_f32_16x16x32_bf16 a[88:91], v[76:79], v[180:183], a[88:91]
    v_mfma_f32_16x16x32_bf16 a[88:91], v[80:83], v[216:219], a[88:91]
    v_mfma_f32_16x16x32_bf16 a[92:95], v[76:79], v[184:187], a[92:95]
    v_mfma_f32_16x16x32_bf16 a[92:95], v[80:83], v[220:223], a[92:95]
    v_mfma_f32_16x16x32_bf16 a[96:99], v[76:79], v[188:191], a[96:99]
    v_mfma_f32_16x16x32_bf16 a[96:99], v[80:83], v[224:227], a[96:99]
    v_mfma_f32_16x16x32_bf16 a[100:103], v[76:79], v[192:195], a[100:103]
    v_mfma_f32_16x16x32_bf16 a[100:103], v[80:83], v[228:231], a[100:103]
    v_mfma_f32_16x16x32_bf16 a[104:107], v[76:79], v[196:199], a[104:107]
    v_mfma_f32_16x16x32_bf16 a[104:107], v[80:83], v[232:235], a[104:107]
    ds_read_b64_tr_b16 v[76:77], v24 offset:16384
    ds_read_b64_tr_b16 v[78:79], v24 offset:17408
    ds_read_b64_tr_b16 v[80:81], v24 offset:24576
    ds_read_b64_tr_b16 v[82:83], v24 offset:25600
    s_waitcnt lgkmcnt(12)
    v_mfma_f32_16x16x32_bf16 a[108:111], v[84:87], v[164:167], a[108:111]
    v_mfma_f32_16x16x32_bf16 a[108:111], v[88:91], v[200:203], a[108:111]
    v_mfma_f32_16x16x32_bf16 a[112:115], v[84:87], v[168:171], a[112:115]
    v_mfma_f32_16x16x32_bf16 a[112:115], v[88:91], v[204:207], a[112:115]
    v_mfma_f32_16x16x32_bf16 a[116:119], v[84:87], v[172:175], a[116:119]
    v_mfma_f32_16x16x32_bf16 a[116:119], v[88:91], v[208:211], a[116:119]
    v_mfma_f32_16x16x32_bf16 a[120:123], v[84:87], v[176:179], a[120:123]
    v_mfma_f32_16x16x32_bf16 a[120:123], v[88:91], v[212:215], a[120:123]
    v_mfma_f32_16x16x32_bf16 a[124:127], v[84:87], v[180:183], a[124:127]
    v_mfma_f32_16x16x32_bf16 a[124:127], v[88:91], v[216:219], a[124:127]
    v_mfma_f32_16x16x32_bf16 a[128:131], v[84:87], v[184:187], a[128:131]
    v_mfma_f32_16x16x32_bf16 a[128:131], v[88:91], v[220:223], a[128:131]
    v_mfma_f32_16x16x32_bf16 a[132:135], v[84:87], v[188:191], a[132:135]
    v_mfma_f32_16x16x32_bf16 a[132:135], v[88:91], v[224:227], a[132:135]
    v_mfma_f32_16x16x32_bf16 a[136:139], v[84:87], v[192:195], a[136:139]
    v_mfma_f32_16x16x32_bf16 a[136:139], v[88:91], v[228:231], a[136:139]
    v_mfma_f32_16x16x32_bf16 a[140:143], v[84:87], v[196:199], a[140:143]
    v_mfma_f32_16x16x32_bf16 a[140:143], v[88:91], v[232:235], a[140:143]
    ds_read_b64_tr_b16 v[84:85], v25 offset:16384
    ds_read_b64_tr_b16 v[86:87], v25 offset:17408
    ds_read_b64_tr_b16 v[88:89], v25 offset:24576
    ds_read_b64_tr_b16 v[90:91], v25 offset:25600
    s_waitcnt lgkmcnt(12)
    v_mfma_f32_16x16x32_bf16 a[144:147], v[60:63], v[164:167], a[144:147]
    v_mfma_f32_16x16x32_bf16 a[144:147], v[64:67], v[200:203], a[144:147]
    v_mfma_f32_16x16x32_bf16 a[148:151], v[60:63], v[168:171], a[148:151]
    v_mfma_f32_16x16x32_bf16 a[148:151], v[64:67], v[204:207], a[148:151]
    v_mfma_f32_16x16x32_bf16 a[152:155], v[60:63], v[172:175], a[152:155]
    v_mfma_f32_16x16x32_bf16 a[152:155], v[64:67], v[208:211], a[152:155]
    v_mfma_f32_16x16x32_bf16 a[156:159], v[60:63], v[176:179], a[156:159]
    v_mfma_f32_16x16x32_bf16 a[156:159], v[64:67], v[212:215], a[156:159]
    v_mfma_f32_16x16x32_bf16 a[160:163], v[60:63], v[180:183], a[160:163]
    v_mfma_f32_16x16x32_bf16 a[160:163], v[64:67], v[216:219], a[160:163]
    v_mfma_f32_16x16x32_bf16 a[164:167], v[60:63], v[184:187], a[164:167]
    v_mfma_f32_16x16x32_bf16 a[164:167], v[64:67], v[220:223], a[164:167]
    v_mfma_f32_16x16x32_bf16 a[168:171], v[60:63], v[188:191], a[168:171]
    v_mfma_f32_16x16x32_bf16 a[168:171], v[64:67], v[224:227], a[168:171]
    v_mfma_f32_16x16x32_bf16 v[36:39], v[60:63], v[192:195], v[36:39]
    v_mfma_f32_16x16x32_bf16 v[36:39], v[64:67], v[228:231], v[36:39]
    v_mfma_f32_16x16x32_bf16 v[52:55], v[60:63], v[196:199], v[52:55]
    v_mfma_f32_16x16x32_bf16 v[52:55], v[64:67], v[232:235], v[52:55]
    s_waitcnt vmcnt(18)
    ds_read_b64_tr_b16 v[60:61], v18 offset:0
    ds_read_b64_tr_b16 v[62:63], v18 offset:1024
    ds_read_b64_tr_b16 v[64:65], v18 offset:8192
    ds_read_b64_tr_b16 v[66:67], v18 offset:9216
    s_waitcnt lgkmcnt(4)
    v_mfma_f32_16x16x32_bf16 a[172:175], v[68:71], v[164:167], a[172:175]
    s_add_u32 m0, s27, 16384
    v_mfma_f32_16x16x32_bf16 a[172:175], v[72:75], v[200:203], a[172:175]
    s_nop 0
    v_mfma_f32_16x16x32_bf16 a[176:179], v[68:71], v[168:171], a[176:179]
    buffer_load_dwordx4 v10, s[8:11], s26 offen offset:0 lds
    v_mfma_f32_16x16x32_bf16 a[176:179], v[72:75], v[204:207], a[176:179]
    buffer_load_dwordx4 v11, s[8:11], s26 offen offset:1024 lds
    v_mfma_f32_16x16x32_bf16 a[180:183], v[68:71], v[172:175], a[180:183]
    buffer_load_dwordx4 v12, s[8:11], s26 offen offset:2048 lds
    v_mfma_f32_16x16x32_bf16 a[180:183], v[72:75], v[208:211], a[180:183]
    buffer_load_dwordx4 v13, s[8:11], s26 offen offset:3072 lds
    v_mfma_f32_16x16x32_bf16 a[184:187], v[68:71], v[176:179], a[184:187]
    s_add_u32 m0, s27, 20480
    v_mfma_f32_16x16x32_bf16 a[184:187], v[72:75], v[212:215], a[184:187]
    s_nop 0
    v_mfma_f32_16x16x32_bf16 a[188:191], v[68:71], v[180:183], a[188:191]
    buffer_load_dwordx4 v14, s[8:11], s26 offen offset:0 lds
    v_mfma_f32_16x16x32_bf16 a[188:191], v[72:75], v[216:219], a[188:191]
    buffer_load_dwordx4 v15, s[8:11], s26 offen offset:1024 lds
    v_mfma_f32_16x16x32_bf16 a[192:195], v[68:71], v[184:187], a[192:195]
    buffer_load_dwordx4 v16, s[8:11], s26 offen offset:2048 lds
    v_mfma_f32_16x16x32_bf16 a[192:195], v[72:75], v[220:223], a[192:195]
    buffer_load_dwordx4 v17, s[8:11], s26 offen offset:3072 lds
    v_mfma_f32_16x16x32_bf16 a[196:199], v[68:71], v[188:191], a[196:199]
    s_add_u32 s26, s26, 163840
    v_mfma_f32_16x16x32_bf16 a[196:199], v[72:75], v[224:227], a[196:199]
    s_add_u32 m0, s27, 24576
    v_mfma_f32_16x16x32_bf16 v[40:43], v[68:71], v[192:195], v[40:43]
    s_nop 0
    v_mfma_f32_16x16x32_bf16 v[40:43], v[72:75], v[228:231], v[40:43]
    buffer_load_dwordx4 v10, s[8:11], s26 offen offset:0 lds
    v_mfma_f32_16x16x32_bf16 v[56:59], v[68:71], v[196:199], v[56:59]
    buffer_load_dwordx4 v11, s[8:11], s26 offen offset:1024 lds
    v_mfma_f32_16x16x32_bf16 v[56:59], v[72:75], v[232:235], v[56:59]
    ds_read_b64_tr_b16 v[68:69], v19 offset:0
    ds_read_b64_tr_b16 v[70:71], v19 offset:1024
    ds_read_b64_tr_b16 v[72:73], v19 offset:8192
    ds_read_b64_tr_b16 v[74:75], v19 offset:9216
    s_waitcnt lgkmcnt(12)
    v_mfma_f32_16x16x32_bf16 a[200:203], v[76:79], v[164:167], a[200:203]
    buffer_load_dwordx4 v12, s[8:11], s26 offen offset:2048 lds
    v_mfma_f32_16x16x32_bf16 a[200:203], v[80:83], v[200:203], a[200:203]
    buffer_load_dwordx4 v13, s[8:11], s26 offen offset:3072 lds
    v_mfma_f32_16x16x32_bf16 a[204:207], v[76:79], v[168:171], a[204:207]
    s_add_u32 m0, s27, 28672
    v_mfma_f32_16x16x32_bf16 a[204:207], v[80:83], v[204:207], a[204:207]
    s_nop 0
    v_mfma_f32_16x16x32_bf16 a[208:211], v[76:79], v[172:175], a[208:211]
    buffer_load_dwordx4 v14, s[8:11], s26 offen offset:0 lds
    v_mfma_f32_16x16x32_bf16 a[208:211], v[80:83], v[208:211], a[208:211]
    buffer_load_dwordx4 v15, s[8:11], s26 offen offset:1024 lds
    v_mfma_f32_16x16x32_bf16 a[212:215], v[76:79], v[176:179], a[212:215]
    buffer_load_dwordx4 v16, s[8:11], s26 offen offset:2048 lds
    v_mfma_f32_16x16x32_bf16 a[212:215], v[80:83], v[212:215], a[212:215]
    buffer_load_dwordx4 v17, s[8:11], s26 offen offset:3072 lds
    v_mfma_f32_16x16x32_bf16 v[244:247], v[76:79], v[180:183], v[244:247]
    s_add_u32 s26, s26, 163840
    v_mfma_f32_16x16x32_bf16 v[244:247], v[80:83], v[216:219], v[244:247]
    v_mfma_f32_16x16x32_bf16 a[216:219], v[76:79], v[184:187], a[216:219]
    v_mfma_f32_16x16x32_bf16 a[216:219], v[80:83], v[220:223], a[216:219]
    v_mfma_f32_16x16x32_bf16 v[28:31], v[76:79], v[188:191], v[28:31]
    v_mfma_f32_16x16x32_bf16 v[28:31], v[80:83], v[224:227], v[28:31]
    v_mfma_f32_16x16x32_bf16 v[44:47], v[76:79], v[192:195], v[44:47]
    v_mfma_f32_16x16x32_bf16 v[44:47], v[80:83], v[228:231], v[44:47]
    v_mfma_f32_16x16x32_bf16 v[236:239], v[76:79], v[196:199], v[236:239]
    v_mfma_f32_16x16x32_bf16 v[236:239], v[80:83], v[232:235], v[236:239]
    ds_read_b64_tr_b16 v[76:77], v20 offset:0
    ds_read_b64_tr_b16 v[78:79], v20 offset:1024
    ds_read_b64_tr_b16 v[80:81], v20 offset:8192
    ds_read_b64_tr_b16 v[82:83], v20 offset:9216
    s_waitcnt lgkmcnt(12)
    v_mfma_f32_16x16x32_bf16 a[220:223], v[84:87], v[164:167], a[220:223]
    v_mfma_f32_16x16x32_bf16 a[220:223], v[88:91], v[200:203], a[220:223]
    v_mfma_f32_16x16x32_bf16 a[224:227], v[84:87], v[168:171], a[224:227]
    v_mfma_f32_16x16x32_bf16 a[224:227], v[88:91], v[204:207], a[224:227]
    v_mfma_f32_16x16x32_bf16 a[228:231], v[84:87], v[172:175], a[228:231]
    v_mfma_f32_16x16x32_bf16 a[228:231], v[88:91], v[208:211], a[228:231]
    v_mfma_f32_16x16x32_bf16 a[232:235], v[84:87], v[176:179], a[232:235]
    v_mfma_f32_16x16x32_bf16 a[232:235], v[88:91], v[212:215], a[232:235]
    v_mfma_f32_16x16x32_bf16 v[248:251], v[84:87], v[180:183], v[248:251]
    v_mfma_f32_16x16x32_bf16 v[248:251], v[88:91], v[216:219], v[248:251]
    v_mfma_f32_16x16x32_bf16 a[236:239], v[84:87], v[184:187], a[236:239]
    v_mfma_f32_16x16x32_bf16 a[236:239], v[88:91], v[220:223], a[236:239]
    v_mfma_f32_16x16x32_bf16 v[32:35], v[84:87], v[188:191], v[32:35]
    v_mfma_f32_16x16x32_bf16 v[32:35], v[88:91], v[224:227], v[32:35]
    v_mfma_f32_16x16x32_bf16 v[48:51], v[84:87], v[192:195], v[48:51]
    v_mfma_f32_16x16x32_bf16 v[48:51], v[88:91], v[228:231], v[48:51]
    v_mfma_f32_16x16x32_bf16 v[240:243], v[84:87], v[196:199], v[240:243]
    v_mfma_f32_16x16x32_bf16 v[240:243], v[88:91], v[232:235], v[240:243]
    ds_read_b64_tr_b16 v[84:85], v21 offset:0
    ds_read_b64_tr_b16 v[86:87], v21 offset:1024
    ds_read_b64_tr_b16 v[88:89], v21 offset:8192
    ds_read_b64_tr_b16 v[90:91], v21 offset:9216
    s_add_u32 s21, s21, 1
    s_cmp_lt_u32 s21, 6
    s_cbranch_scc1 L_op_loop
    s_waitcnt vmcnt(16) lgkmcnt(12)
    v_mfma_f32_16x16x32_bf16 a[0:3], v[60:63], v[92:95], a[0:3]
    buffer_load_dwordx4 v[164:167], v7, s[4:7], s48 offen
    v_mfma_f32_16x16x32_bf16 a[0:3], v[64:67], v[128:131], a[0:3]
    buffer_load_dwordx4 v[168:171], v7, s[4:7], s49 offen
    v_mfma_f32_16x16x32_bf16 a[4:7], v[60:63], v[96:99], a[4:7]
    buffer_load_dwordx4 v[172:175], v7, s[4:7], s50 offen
    v_mfma_f32_16x16x32_bf16 a[4:7], v[64:67], v[132:135], a[4:7]
    buffer_load_dwordx4 v[176:179], v7, s[4:7], s51 offen
    v_mfma_f32_16x16x32_bf16 a[8:11], v[60:63], v[100:103], a[8:11]
    buffer_load_dwordx4 v[180:183], v7, s[4:7], s52 offen
    v_mfma_f32_16x16x32_bf16 a[8:11], v[64:67], v[136:139], a[8:11]
    buffer_load_dwordx4 v[184:187], v7, s[4:7], s53 offen
    v_mfma_f32_16x16x32_bf16 a[12:15], v[60:63], v[104:107], a[12:15]
    buffer_load_dwordx4 v[188:191], v7, s[4:7], s54 offen
    v_mfma_f32_16x16x32_bf16 a[12:15], v[64:67], v[140:143], a[12:15]
    buffer_load_dwordx4 v[192:195], v7, s[4:7], s55 offen
    v_mfma_f32_16x16x32_bf16 a[16:19], v[60:63], v[108:111], a[16:19]
    buffer_load_dwordx4 v[196:199], v7, s[4:7], s56 offen
    v_mfma_f32_16x16x32_bf16 a[16:19], v[64:67], v[144:147], a[16:19]
    v_add_u32 v7, 57344, v7
    v_mfma_f32_16x16x32_bf16 a[20:23], v[60:63], v[112:115], a[20:23]
    buffer_load_dwordx4 v[200:203], v7, s[4:7], s48 offen
    v_mfma_f32_16x16x32_bf16 a[20:23], v[64:67], v[148:151], a[20:23]
    buffer_load_dwordx4 v[204:207], v7, s[4:7], s49 offen
    v_mfma_f32_16x16x32_bf16 a[24:27], v[60:63], v[116:119], a[24:27]
    buffer_load_dwordx4 v[208:211], v7, s[4:7], s50 offen
    v_mfma_f32_16x16x32_bf16 a[24:27], v[64:67], v[152:155], a[24:27]
    buffer_load_dwordx4 v[212:215], v7, s[4:7], s51 offen
    v_mfma_f32_16x16x32_bf16 a[28:31], v[60:63], v[120:123], a[28:31]
    buffer_load_dwordx4 v[216:219], v7, s[4:7], s52 offen
    v_mfma_f32_16x16x32_bf16 a[28:31], v[64:67], v[156:159], a[28:31]
    buffer_load_dwordx4 v[220:223], v7, s[4:7], s53 offen
    v_mfma_f32_16x16x32_bf16 a[32:35], v[60:63], v[124:127], a[32:35]
    buffer_load_dwordx4 v[224:227], v7, s[4:7], s54 offen
    v_mfma_f32_16x16x32_bf16 a[32:35], v[64:67], v[160:163], a[32:35]
    ds_read_b64_tr_b16 v[60:61], v22 offset:0
    ds_read_b64_tr_b16 v[62:63], v22 offset:1024
    ds_read_b64_tr_b16 v[64:65], v22 offset:8192
    ds_read_b64_tr_b16 v[66:67], v22 offset:9216
    s_waitcnt lgkmcnt(12)
    v_mfma_f32_16x16x32_bf16 a[36:39], v[68:71], v[92:95], a[36:39]
    buffer_load_dwordx4 v[228:231], v7, s[4:7], s55 offen
    v_mfma_f32_16x16x32_bf16 a[36:39], v[72:75], v[128:131], a[36:39]
    buffer_load_dwordx4 v[232:235], v7, s[4:7], s56 offen
    v_mfma_f32_16x16x32_bf16 a[40:43], v[68:71], v[96:99], a[40:43]
    v_add_u32 v7, 57344, v7
    v_mfma_f32_16x16x32_bf16 a[40:43], v[72:75], v[132:135], a[40:43]
    v_mfma_f32_16x16x32_bf16 a[44:47], v[68:71], v[100:103], a[44:47]
    v_mfma_f32_16x16x32_bf16 a[44:47], v[72:75], v[136:139], a[44:47]
    v_mfma_f32_16x16x32_bf16 a[48:51], v[68:71], v[104:107], a[48:51]
    v_mfma_f32_16x16x32_bf16 a[48:51], v[72:75], v[140:143], a[48:51]
    v_mfma_f32_16x16x32_bf16 a[52:55], v[68:71], v[108:111], a[52:55]
    v_mfma_f32_16x16x32_bf16 a[52:55], v[72:75], v[144:147], a[52:55]
    v_mfma_f32_16x16x32_bf16 a[56:59], v[68:71], v[112:115], a[56:59]
    v_mfma_f32_16x16x32_bf16 a[56:59], v[72:75], v[148:151], a[56:59]
    v_mfma_f32_16x16x32_bf16 a[60:63], v[68:71], v[116:119], a[60:63]
    v_mfma_f32_16x16x32_bf16 a[60:63], v[72:75], v[152:155], a[60:63]
    v_mfma_f32_16x16x32_bf16 a[64:67], v[68:71], v[120:123], a[64:67]
    v_mfma_f32_16x16x32_bf16 a[64:67], v[72:75], v[156:159], a[64:67]
    v_mfma_f32_16x16x32_bf16 a[68:71], v[68:71], v[124:127], a[68:71]
    v_mfma_f32_16x16x32_bf16 a[68:71], v[72:75], v[160:163], a[68:71]
    ds_read_b64_tr_b16 v[68:69], v23 offset:0
    ds_read_b64_tr_b16 v[70:71], v23 offset:1024
    ds_read_b64_tr_b16 v[72:73], v23 offset:8192
    ds_read_b64_tr_b16 v[74:75], v23 offset:9216
    s_waitcnt lgkmcnt(12)
    v_mfma_f32_16x16x32_bf16 a[72:75], v[76:79], v[92:95], a[72:75]
    v_mfma_f32_16x16x32_bf16 a[72:75], v[80:83], v[128:131], a[72:75]
    v_mfma_f32_16x16x32_bf16 a[76:79], v[76:79], v[96:99], a[76:79]
    v_mfma_f32_16x16x32_bf16 a[76:79], v[80:83], v[132:135], a[76:79]
    v_mfma_f32_16x16x32_bf16 a[80:83], v[76:79], v[100:103], a[80:83]
    v_mfma_f32_16x16x32_bf16 a[80:83], v[80:83], v[136:139], a[80:83]
    v_mfma_f32_16x16x32_bf16 a[84:87], v[76:79], v[104:107], a[84:87]
    v_mfma_f32_16x16x32_bf16 a[84:87], v[80:83], v[140:143], a[84:87]
    v_mfma_f32_16x16x32_bf16 a[88:91], v[76:79], v[108:111], a[88:91]
    v_mfma_f32_16x16x32_bf16 a[88:91], v[80:83], v[144:147], a[88:91]
    v_mfma_f32_16x16x32_bf16 a[92:95], v[76:79], v[112:115], a[92:95]
    v_mfma_f32_16x16x32_bf16 a[92:95], v[80:83], v[148:151], a[92:95]
    v_mfma_f32_16x16x32_bf16 a[96:99], v[76:79], v[116:119], a[96:99]
    v_mfma_f32_16x16x32_bf16 a[96:99], v[80:83], v[152:155], a[96:99]
    v_mfma_f32_16x16x32_bf16 a[100:103], v[76:79], v[120:123], a[100:103]
    v_mfma_f32_16x16x32_bf16 a[100:103], v[80:83], v[156:159], a[100:103]
    v_mfma_f32_16x16x32_bf16 a[104:107], v[76:79], v[124:127], a[104:107]
    v_mfma_f32_16x16x32_bf16 a[104:107], v[80:83], v[160:163], a[104:107]
    ds_read_b64_tr_b16 v[76:77], v24 offset:0
    ds_read_b64_tr_b16 v[78:79], v24 offset:1024
    ds_read_b64_tr_b16 v[80:81], v24 offset:8192
    ds_read_b64_tr_b16 v[82:83], v24 offset:9216
    s_waitcnt lgkmcnt(12)
    v_mfma_f32_16x16x32_bf16 a[108:111], v[84:87], v[92:95], a[108:111]
    v_mfma_f32_16x16x32_bf16 a[108:111], v[88:91], v[128:131], a[108:111]
    v_mfma_f32_16x16x32_bf16 a[112:115], v[84:87], v[96:99], a[112:115]
    v_mfma_f32_16x16x32_bf16 a[112:115], v[88:91], v[132:135], a[112:115]
    v_mfma_f32_16x16x32_bf16 a[116:119], v[84:87], v[100:103], a[116:119]
    v_mfma_f32_16x16x32_bf16 a[116:119], v[88:91], v[136:139], a[116:119]
    v_mfma_f32_16x16x32_bf16 a[120:123], v[84:87], v[104:107], a[120:123]
    v_mfma_f32_16x16x32_bf16 a[120:123], v[88:91], v[140:143], a[120:123]
    v_mfma_f32_16x16x32_bf16 a[124:127], v[84:87], v[108:111], a[124:127]
    v_mfma_f32_16x16x32_bf16 a[124:127], v[88:91], v[144:147], a[124:127]
    v_mfma_f32_16x16x32_bf16 a[128:131], v[84:87], v[112:115], a[128:131]
    v_mfma_f32_16x16x32_bf16 a[128:131], v[88:91], v[148:151], a[128:131]
    v_mfma_f32_16x16x32_bf16 a[132:135], v[84:87], v[116:119], a[132:135]
    v_mfma_f32_16x16x32_bf16 a[132:135], v[88:91], v[152:155], a[132:135]
    v_mfma_f32_16x16x32_bf16 a[136:139], v[84:87], v[120:123], a[136:139]
    v_mfma_f32_16x16x32_bf16 a[136:139], v[88:91], v[156:159], a[136:139]
    v_mfma_f32_16x16x32_bf16 a[140:143], v[84:87], v[124:127], a[140:143]
    v_mfma_f32_16x16x32_bf16 a[140:143], v[88:91], v[160:163], a[140:143]
    ds_read_b64_tr_b16 v[84:85], v25 offset:0
    ds_read_b64_tr_b16 v[86:87], v25 offset:1024
    ds_read_b64_tr_b16 v[88:89], v25 offset:8192
    ds_read_b64_tr_b16 v[90:91], v25 offset:9216
    s_waitcnt lgkmcnt(12)
    v_mfma_f32_16x16x32_bf16 a[144:147], v[60:63], v[92:95], a[144:147]
    v_mfma_f32_16x16x32_bf16 a[144:147], v[64:67], v[128:131], a[144:147]
    v_mfma_f32_16x16x32_bf16 a[148:151], v[60:63], v[96:99], a[148:151]
    v_mfma_f32_16x16x32_bf16 a[148:151], v[64:67], v[132:135], a[148:151]
    v_mfma_f32_16x16x32_bf16 a[152:155], v[60:63], v[100:103], a[152:155]
    v_mfma_f32_16x16x32_bf16 a[152:155], v[64:67], v[136:139], a[152:155]
    v_mfma_f32_16x16x32_bf16 a[156:159], v[60:63], v[104:107], a[156:159]
    v_mfma_f32_16x16x32_bf16 a[156:159], v[64:67], v[140:143], a[156:159]
    v_mfma_f32_16x16x32_bf16 a[160:163], v[60:63], v[108:111], a[160:163]
    v_mfma_f32_16x16x32_bf16 a[160:163], v[64:67], v[144:147], a[160:163]
    v_mfma_f32_16x16x32_bf16 a[164:167], v[60:63], v[112:115], a[164:167]
    v_mfma_f32_16x16x32_bf16 a[164:167], v[64:67], v[148:151], a[164:167]
    v_mfma_f32_16x16x32_bf16 a[168:171], v[60:63], v[116:119], a[168:171]
    v_mfma_f32_16x16x32_bf16 a[168:171], v[64:67], v[152:155], a[168:171]
    v_mfma_f32_16x16x32_bf16 v[36:39], v[60:63], v[120:123], v[36:39]
    v_mfma_f32_16x16x32_bf16 v[36:39], v[64:67], v[156:159], v[36:39]
    v_mfma_f32_16x16x32_bf16 v[52:55], v[60:63], v[124:127], v[52:55]
    v_mfma_f32_16x16x32_bf16 v[52:55], v[64:67], v[160:163], v[52:55]
    s_waitcnt vmcnt(18)
    ds_read_b64_tr_b16 v[60:61], v18 offset:16384
    ds_read_b64_tr_b16 v[62:63], v18 offset:17408
    ds_read_b64_tr_b16 v[64:65], v18 offset:24576
    ds_read_b64_tr_b16 v[66:67], v18 offset:25600
    s_waitcnt lgkmcnt(12)
    v_mfma_f32_16x16x32_bf16 a[172:175], v[68:71], v[92:95], a[172:175]
    v_mfma_f32_16x16x32_bf16 a[172:175], v[72:75], v[128:131], a[172:175]
    v_mfma_f32_16x16x32_bf16 a[176:179], v[68:71], v[96:99], a[176:179]
    v_mfma_f32_16x16x32_bf16 a[176:179], v[72:75], v[132:135], a[176:179]
    v_mfma_f32_16x16x32_bf16 a[180:183], v[68:71], v[100:103], a[180:183]
    v_mfma_f32_16x16x32_bf16 a[180:183], v[72:75], v[136:139], a[180:183]
    v_mfma_f32_16x16x32_bf16 a[184:187], v[68:71], v[104:107], a[184:187]
    v_mfma_f32_16x16x32_bf16 a[184:187], v[72:75], v[140:143], a[184:187]
    v_mfma_f32_16x16x32_bf16 a[188:191], v[68:71], v[108:111], a[188:191]
    v_mfma_f32_16x16x32_bf16 a[188:191], v[72:75], v[144:147], a[188:191]
    v_mfma_f32_16x16x32_bf16 a[192:195], v[68:71], v[112:115], a[192:195]
    v_mfma_f32_16x16x32_bf16 a[192:195], v[72:75], v[148:151], a[192:195]
    v_mfma_f32_16x16x32_bf16 a[196:199], v[68:71], v[116:119], a[196:199]
    v_mfma_f32_16x16x32_bf16 a[196:199], v[72:75], v[152:155], a[196:199]
    v_mfma_f32_16x16x32_bf16 v[40:43], v[68:71], v[120:123], v[40:43]
    v_mfma_f32_16x16x32_bf16 v[40:43], v[72:75], v[156:159], v[40:43]
    v_mfma_f32_16x16x32_bf16 v[56:59], v[68:71], v[124:127], v[56:59]
    v_mfma_f32_16x16x32_bf16 v[56:59], v[72:75], v[160:163], v[56:59]
    ds_read_b64_tr_b16 v[68:69], v19 offset:16384
    ds_read_b64_tr_b16 v[70:71], v19 offset:17408
    ds_read_b64_tr_b16 v[72:73], v19 offset:24576
    ds_read_b64_tr_b16 v[74:75], v19 offset:25600
    s_waitcnt lgkmcnt(12)
    v_mfma_f32_16x16x32_bf16 a[200:203], v[76:79], v[92:95], a[200:203]
    v_mfma_f32_16x16x32_bf16 a[200:203], v[80:83], v[128:131], a[200:203]
    v_mfma_f32_16x16x32_bf16 a[204:207], v[76:79], v[96:99], a[204:207]
    v_mfma_f32_16x16x32_bf16 a[204:207], v[80:83], v[132:135], a[204:207]
    v_mfma_f32_16x16x32_bf16 a[208:211], v[76:79], v[100:103], a[208:211]
    v_mfma_f32_16x16x32_bf16 a[208:211], v[80:83], v[136:139], a[208:211]
    v_mfma_f32_16x16x32_bf16 a[212:215], v[76:79], v[104:107], a[212:215]
    v_mfma_f32_16x16x32_bf16 a[212:215], v[80:83], v[140:143], a[212:215]
    v_mfma_f32_16x16x32_bf16 v[244:247], v[76:79], v[108:111], v[244:247]
    v_mfma_f32_16x16x32_bf16 v[244:247], v[80:83], v[144:147], v[244:247]
    v_mfma_f32_16x16x32_bf16 a[216:219], v[76:79], v[112:115], a[216:219]
    v_mfma_f32_16x16x32_bf16 a[216:219], v[80:83], v[148:151], a[216:219]
    v_mfma_f32_16x16x32_bf16 v[28:31], v[76:79], v[116:119], v[28:31]
    v_mfma_f32_16x16x32_bf16 v[28:31], v[80:83], v[152:155], v[28:31]
    v_mfma_f32_16x16x32_bf16 v[44:47], v[76:79], v[120:123], v[44:47]
    v_mfma_f32_16x16x32_bf16 v[44:47], v[80:83], v[156:159], v[44:47]
    v_mfma_f32_16x16x32_bf16 v[236:239], v[76:79], v[124:127], v[236:239]
    v_mfma_f32_16x16x32_bf16 v[236:239], v[80:83], v[160:163], v[236:239]
    ds_read_b64_tr_b16 v[76:77], v20 offset:16384
    ds_read_b64_tr_b16 v[78:79], v20 offset:17408
    ds_read_b64_tr_b16 v[80:81], v20 offset:24576
    ds_read_b64_tr_b16 v[82:83], v20 offset:25600
    s_waitcnt lgkmcnt(12)
    v_mfma_f32_16x16x32_bf16 a[220:223], v[84:87], v[92:95], a[220:223]
    v_mfma_f32_16x16x32_bf16 a[220:223], v[88:91], v[128:131], a[220:223]
    v_mfma_f32_16x16x32_bf16 a[224:227], v[84:87], v[96:99], a[224:227]
    v_mfma_f32_16x16x32_bf16 a[224:227], v[88:91], v[132:135], a[224:227]
    v_mfma_f32_16x16x32_bf16 a[228:231], v[84:87], v[100:103], a[228:231]
    v_mfma_f32_16x16x32_bf16 a[228:231], v[88:91], v[136:139], a[228:231]
    v_mfma_f32_16x16x32_bf16 a[232:235], v[84:87], v[104:107], a[232:235]
    v_mfma_f32_16x16x32_bf16 a[232:235], v[88:91], v[140:143], a[232:235]
    v_mfma_f32_16x16x32_bf16 v[248:251], v[84:87], v[108:111], v[248:251]
    v_mfma_f32_16x16x32_bf16 v[248:251], v[88:91], v[144:147], v[248:251]
    v_mfma_f32_16x16x32_bf16 a[236:239], v[84:87], v[112:115], a[236:239]
    v_mfma_f32_16x16x32_bf16 a[236:239], v[88:91], v[148:151], a[236:239]
    v_mfma_f32_16x16x32_bf16 v[32:35], v[84:87], v[116:119], v[32:35]
    v_mfma_f32_16x16x32_bf16 v[32:35], v[88:91], v[152:155], v[32:35]
    v_mfma_f32_16x16x32_bf16 v[48:51], v[84:87], v[120:123], v[48:51]
    v_mfma_f32_16x16x32_bf16 v[48:51], v[88:91], v[156:159], v[48:51]
    v_mfma_f32_16x16x32_bf16 v[240:243], v[84:87], v[124:127], v[240:243]
    v_mfma_f32_16x16x32_bf16 v[240:243], v[88:91], v[160:163], v[240:243]
    ds_read_b64_tr_b16 v[84:85], v21 offset:16384
    ds_read_b64_tr_b16 v[86:87], v21 offset:17408
    ds_read_b64_tr_b16 v[88:89], v21 offset:24576
    ds_read_b64_tr_b16 v[90:91], v21 offset:25600
    s_waitcnt vmcnt(0) lgkmcnt(12)
    v_mfma_f32_16x16x32_bf16 a[0:3], v[60:63], v[164:167], a[0:3]
    ds_read_b64_tr_b16 v[92:93], v22 offset:16384
    ds_read_b64_tr_b16 v[94:95], v22 offset:17408
    v_mfma_f32_16x16x32_bf16 a[0:3], v[64:67], v[200:203], a[0:3]
    ds_read_b64_tr_b16 v[96:97], v22 offset:24576
    ds_read_b64_tr_b16 v[98:99], v22 offset:25600
    v_mfma_f32_16x16x32_bf16 a[4:7], v[60:63], v[168:171], a[4:7]
    ds_read_b64_tr_b16 v[100:101], v23 offset:16384
    ds_read_b64_tr_b16 v[102:103], v23 offset:17408
    v_mfma_f32_16x16x32_bf16 a[4:7], v[64:67], v[204:207], a[4:7]
    ds_read_b64_tr_b16 v[104:105], v23 offset:24576
    ds_read_b64_tr_b16 v[106:107], v23 offset:25600
    v_mfma_f32_16x16x32_bf16 a[8:11], v[60:63], v[172:175], a[8:11]
    ds_read_b64_tr_b16 v[108:109], v24 offset:16384
    ds_read_b64_tr_b16 v[110:111], v24 offset:17408
    v_mfma_f32_16x16x32_bf16 a[8:11], v[64:67], v[208:211], a[8:11]
    ds_read_b64_tr_b16 v[112:113], v24 offset:24576
    ds_read_b64_tr_b16 v[114:115], v24 offset:25600
    v_mfma_f32_16x16x32_bf16 a[20:23], v[60:63], v[184:187], a[20:23]
    ds_read_b64_tr_b16 v[116:117], v25 offset:16384
    ds_read_b64_tr_b16 v[118:119], v25 offset:17408
    v_mfma_f32_16x16x32_bf16 a[20:23], v[64:67], v[220:223], a[20:23]
    ds_read_b64_tr_b16 v[120:121], v25 offset:24576
    ds_read_b64_tr_b16 v[122:123], v25 offset:25600
    v_mfma_f32_16x16x32_bf16 a[24:27], v[60:63], v[188:191], a[24:27]
    ds_write_b128 v8, a[0:3] offset:2048
    v_mfma_f32_16x16x32_bf16 a[24:27], v[64:67], v[224:227], a[24:27]
    v_mfma_f32_16x16x32_bf16 a[28:31], v[60:63], v[192:195], a[28:31]
    v_mfma_f32_16x16x32_bf16 a[28:31], v[64:67], v[228:231], a[28:31]
    ds_write_b128 v8, a[4:7] offset:6144
    v_mfma_f32_16x16x32_bf16 a[32:35], v[60:63], v[196:199], a[32:35]
    v_mfma_f32_16x16x32_bf16 a[32:35], v[64:67], v[232:235], a[32:35]
    s_waitcnt lgkmcnt(15)
    v_mfma_f32_16x16x32_bf16 a[36:39], v[68:71], v[164:167], a[36:39]
    ds_write_b128 v8, a[8:11] offset:10240
    v_mfma_f32_16x16x32_bf16 a[36:39], v[72:75], v[200:203], a[36:39]
    v_mfma_f32_16x16x32_bf16 a[40:43], v[68:71], v[168:171], a[40:43]
    v_mfma_f32_16x16x32_bf16 a[40:43], v[72:75], v[204:207], a[40:43]
    ds_write_b128 v8, a[20:23] offset:14336
    v_mfma_f32_16x16x32_bf16 a[44:47], v[68:71], v[172:175], a[44:47]
    v_mfma_f32_16x16x32_bf16 a[44:47], v[72:75], v[208:211], a[44:47]
    v_mfma_f32_16x16x32_bf16 a[56:59], v[68:71], v[184:187], a[56:59]
    ds_write_b128 v8, a[24:27] offset:18432
    v_mfma_f32_16x16x32_bf16 a[56:59], v[72:75], v[220:223], a[56:59]
    v_mfma_f32_16x16x32_bf16 a[60:63], v[68:71], v[188:191], a[60:63]
    v_mfma_f32_16x16x32_bf16 a[60:63], v[72:75], v[224:227], a[60:63]
    ds_write_b128 v8, a[28:31] offset:22528
    v_mfma_f32_16x16x32_bf16 a[64:67], v[68:71], v[192:195], a[64:67]
    v_mfma_f32_16x16x32_bf16 a[64:67], v[72:75], v[228:231], a[64:67]
    v_mfma_f32_16x16x32_bf16 a[72:75], v[76:79], v[164:167], a[72:75]
    ds_write_b128 v8, a[32:35] offset:26624
    v_mfma_f32_16x16x32_bf16 a[72:75], v[80:83], v[200:203], a[72:75]
    v_mfma_f32_16x16x32_bf16 a[76:79], v[76:79], v[168:171], a[76:79]
    v_mfma_f32_16x16x32_bf16 a[76:79], v[80:83], v[204:207], a[76:79]
    ds_write_b128 v8, a[36:39] offset:3072
    v_mfma_f32_16x16x32_bf16 a[80:83], v[76:79], v[172:175], a[80:83]
    v_mfma_f32_16x16x32_bf16 a[80:83], v[80:83], v[208:211], a[80:83]
    v_mfma_f32_16x16x32_bf16 a[84:87], v[76:79], v[176:179], a[84:87]
    ds_write_b128 v8, a[40:43] offset:7168
    v_mfma_f32_16x16x32_bf16 a[84:87], v[80:83], v[212:215], a[84:87]
    v_mfma_f32_16x16x32_bf16 a[92:95], v[76:79], v[184:187], a[92:95]
    v_mfma_f32_16x16x32_bf16 a[92:95], v[80:83], v[220:223], a[92:95]
    ds_write_b128 v8, a[44:47] offset:11264
    v_mfma_f32_16x16x32_bf16 a[96:99], v[76:79], v[188:191], a[96:99]
    v_mfma_f32_16x16x32_bf16 a[96:99], v[80:83], v[224:227], a[96:99]
    v_mfma_f32_16x16x32_bf16 a[100:103], v[76:79], v[192:195], a[100:103]
    ds_write_b128 v8, a[56:59] offset:15360
    v_mfma_f32_16x16x32_bf16 a[100:103], v[80:83], v[228:231], a[100:103]
    v_mfma_f32_16x16x32_bf16 a[108:111], v[84:87], v[164:167], a[108:111]
    v_mfma_f32_16x16x32_bf16 a[108:111], v[88:91], v[200:203], a[108:111]
    ds_write_b128 v8, a[60:63] offset:19456
    v_mfma_f32_16x16x32_bf16 a[112:115], v[84:87], v[168:171], a[112:115]
    v_mfma_f32_16x16x32_bf16 a[112:115], v[88:91], v[204:207], a[112:115]
    v_mfma_f32_16x16x32_bf16 a[116:119], v[84:87], v[172:175], a[116:119]
    ds_write_b128 v8, a[64:67] offset:23552
    v_mfma_f32_16x16x32_bf16 a[116:119], v[88:91], v[208:211], a[116:119]
    v_mfma_f32_16x16x32_bf16 a[120:123], v[84:87], v[176:179], a[120:123]
    v_mfma_f32_16x16x32_bf16 a[120:123], v[88:91], v[212:215], a[120:123]
    ds_write_b128 v8, a[72:75] offset:0
    v_mfma_f32_16x16x32_bf16 a[128:131], v[84:87], v[184:187], a[128:131]
    v_mfma_f32_16x16x32_bf16 a[128:131], v[88:91], v[220:223], a[128:131]
    v_mfma_f32_16x16x32_bf16 a[132:135], v[84:87], v[188:191], a[132:135]
    ds_write_b128 v8, a[76:79] offset:4096
    v_mfma_f32_16x16x32_bf16 a[132:135], v[88:91], v[224:227], a[132:135]
    v_mfma_f32_16x16x32_bf16 a[136:139], v[84:87], v[192:195], a[136:139]
    v_mfma_f32_16x16x32_bf16 a[136:139], v[88:91], v[228:231], a[136:139]
    ds_write_b128 v8, a[80:83] offset:8192
    s_waitcnt lgkmcnt(15)
    v_mfma_f32_16x16x32_bf16 a[200:203], v[108:111], v[164:167], a[200:203]
    v_mfma_f32_16x16x32_bf16 a[200:203], v[112:115], v[200:203], a[200:203]
    v_mfma_f32_16x16x32_bf16 a[220:223], v[116:119], v[164:167], a[220:223]
    ds_write_b128 v8, a[84:87] offset:12288
    v_mfma_f32_16x16x32_bf16 a[220:223], v[120:123], v[200:203], a[220:223]
    v_mfma_f32_16x16x32_bf16 a[144:147], v[92:95], v[164:167], a[144:147]
    v_mfma_f32_16x16x32_bf16 a[144:147], v[96:99], v[200:203], a[144:147]
    ds_write_b128 v8, a[92:95] offset:16384
    v_mfma_f32_16x16x32_bf16 a[172:175], v[100:103], v[164:167], a[172:175]
    v_mfma_f32_16x16x32_bf16 a[172:175], v[104:107], v[200:203], a[172:175]
    v_mfma_f32_16x16x32_bf16 a[204:207], v[108:111], v[168:171], a[204:207]
    ds_write_b128 v8, a[96:99] offset:20480
    v_mfma_f32_16x16x32_bf16 a[204:207], v[112:115], v[204:207], a[204:207]
    v_mfma_f32_16x16x32_bf16 a[224:227], v[116:119], v[168:171], a[224:227]
    v_mfma_f32_16x16x32_bf16 a[224:227], v[120:123], v[204:207], a[224:227]
    ds_write_b128 v8, a[100:103] offset:24576
    v_mfma_f32_16x16x32_bf16 a[148:151], v[92:95], v[168:171], a[148:151]
    v_mfma_f32_16x16x32_bf16 a[148:151], v[96:99], v[204:207], a[148:151]
    v_mfma_f32_16x16x32_bf16 a[176:179], v[100:103], v[168:171], a[176:179]
    ds_write_b128 v8, a[108:111] offset:1024
    v_mfma_f32_16x16x32_bf16 a[176:179], v[104:107], v[204:207], a[176:179]
    v_mfma_f32_16x16x32_bf16 a[208:211], v[108:111], v[172:175], a[208:211]
    v_mfma_f32_16x16x32_bf16 a[208:211], v[112:115], v[208:211], a[208:211]
    ds_write_b128 v8, a[112:115] offset:5120
    v_mfma_f32_16x16x32_bf16 a[228:231], v[116:119], v[172:175], a[228:231]
    v_mfma_f32_16x16x32_bf16 a[228:231], v[120:123], v[208:211], a[228:231]
    v_mfma_f32_16x16x32_bf16 a[152:155], v[92:95], v[172:175], a[152:155]
    ds_write_b128 v8, a[116:119] offset:9216
    v_mfma_f32_16x16x32_bf16 a[152:155], v[96:99], v[208:211], a[152:155]
    v_mfma_f32_16x16x32_bf16 a[180:183], v[100:103], v[172:175], a[180:183]
    v_mfma_f32_16x16x32_bf16 a[180:183], v[104:107], v[208:211], a[180:183]
    ds_write_b128 v8, a[120:123] offset:13312
    v_mfma_f32_16x16x32_bf16 a[212:215], v[108:111], v[176:179], a[212:215]
    v_mfma_f32_16x16x32_bf16 a[212:215], v[112:115], v[212:215], a[212:215]
    v_mfma_f32_16x16x32_bf16 a[12:15], v[60:63], v[176:179], a[12:15]
    ds_write_b128 v8, a[128:131] offset:17408
    v_mfma_f32_16x16x32_bf16 a[12:15], v[64:67], v[212:215], a[12:15]
    v_mfma_f32_16x16x32_bf16 a[48:51], v[68:71], v[176:179], a[48:51]
    v_mfma_f32_16x16x32_bf16 a[48:51], v[72:75], v[212:215], a[48:51]
    ds_write_b128 v8, a[132:135] offset:21504
    v_mfma_f32_16x16x32_bf16 a[16:19], v[60:63], v[180:183], a[16:19]
    v_mfma_f32_16x16x32_bf16 a[16:19], v[64:67], v[216:219], a[16:19]
    v_mfma_f32_16x16x32_bf16 a[52:55], v[68:71], v[180:183], a[52:55]
    ds_write_b128 v8, a[136:139] offset:25600
    v_mfma_f32_16x16x32_bf16 a[52:55], v[72:75], v[216:219], a[52:55]
    v_mfma_f32_16x16x32_bf16 a[68:71], v[68:71], v[196:199], a[68:71]
    v_mfma_f32_16x16x32_bf16 a[68:71], v[72:75], v[232:235], a[68:71]
    ds_write_b128 v8, a[200:203] offset:27648
    v_mfma_f32_16x16x32_bf16 a[104:107], v[76:79], v[196:199], a[104:107]
    v_mfma_f32_16x16x32_bf16 a[104:107], v[80:83], v[232:235], a[104:107]
    v_mfma_f32_16x16x32_bf16 a[140:143], v[84:87], v[196:199], a[140:143]
    ds_write_b128 v8, a[220:223] offset:28672
    v_mfma_f32_16x16x32_bf16 a[140:143], v[88:91], v[232:235], a[140:143]
    v_mfma_f32_16x16x32_bf16 a[88:91], v[76:79], v[180:183], a[88:91]
    v_mfma_f32_16x16x32_bf16 a[88:91], v[80:83], v[216:219], a[88:91]
    ds_write_b128 v8, a[144:147] offset:29696
    v_mfma_f32_16x16x32_bf16 a[124:127], v[84:87], v[180:183], a[124:127]
    v_mfma_f32_16x16x32_bf16 a[124:127], v[88:91], v[216:219], a[124:127]
    v_mfma_f32_16x16x32_bf16 a[232:235], v[116:119], v[176:179], a[232:235]
    ds_write_b128 v8, a[172:175] offset:30720
    v_mfma_f32_16x16x32_bf16 a[232:235], v[120:123], v[212:215], a[232:235]
    v_mfma_f32_16x16x32_bf16 a[156:159], v[92:95], v[176:179], a[156:159]
    v_mfma_f32_16x16x32_bf16 a[156:159], v[96:99], v[212:215], a[156:159]
    ds_write_b128 v8, a[204:207] offset:31744
    v_mfma_f32_16x16x32_bf16 a[184:187], v[100:103], v[176:179], a[184:187]
    v_mfma_f32_16x16x32_bf16 a[184:187], v[104:107], v[212:215], a[184:187]
    v_mfma_f32_16x16x32_bf16 a[160:163], v[92:95], v[180:183], a[160:163]
    ds_write_b128 v8, a[224:227] offset:32768
    v_mfma_f32_16x16x32_bf16 a[160:163], v[96:99], v[216:219], a[160:163]
    v_mfma_f32_16x16x32_bf16 a[188:191], v[100:103], v[180:183], a[188:191]
    v_mfma_f32_16x16x32_bf16 a[188:191], v[104:107], v[216:219], a[188:191]
    ds_write_b128 v8, a[148:151] offset:33792
    v_mfma_f32_16x16x32_bf16 a[164:167], v[92:95], v[184:187], a[164:167]
    v_mfma_f32_16x16x32_bf16 a[164:167], v[96:99], v[220:223], a[164:167]
    v_mfma_f32_16x16x32_bf16 a[192:195], v[100:103], v[184:187], a[192:195]
    ds_write_b128 v8, a[176:179] offset:34816
    v_mfma_f32_16x16x32_bf16 a[192:195], v[104:107], v[220:223], a[192:195]
    v_mfma_f32_16x16x32_bf16 a[216:219], v[108:111], v[184:187], a[216:219]
    v_mfma_f32_16x16x32_bf16 a[216:219], v[112:115], v[220:223], a[216:219]
    ds_write_b128 v8, a[208:211] offset:35840
    v_mfma_f32_16x16x32_bf16 a[236:239], v[116:119], v[184:187], a[236:239]
    v_mfma_f32_16x16x32_bf16 a[236:239], v[120:123], v[220:223], a[236:239]
    v_mfma_f32_16x16x32_bf16 a[168:171], v[92:95], v[188:191], a[168:171]
    ds_write_b128 v8, a[228:231] offset:36864
    v_mfma_f32_16x16x32_bf16 a[168:171], v[96:99], v[224:227], a[168:171]
    v_mfma_f32_16x16x32_bf16 a[196:199], v[100:103], v[188:191], a[196:199]
    v_mfma_f32_16x16x32_bf16 a[196:199], v[104:107], v[224:227], a[196:199]
    ds_write_b128 v8, a[152:155] offset:37888
    v_mfma_f32_16x16x32_bf16 v[28:31], v[108:111], v[188:191], v[28:31]
    v_mfma_f32_16x16x32_bf16 v[28:31], v[112:115], v[224:227], v[28:31]
    v_mfma_f32_16x16x32_bf16 v[32:35], v[116:119], v[188:191], v[32:35]
    ds_write_b128 v8, a[180:183] offset:38912
    v_mfma_f32_16x16x32_bf16 v[32:35], v[120:123], v[224:227], v[32:35]
    v_mfma_f32_16x16x32_bf16 v[36:39], v[92:95], v[192:195], v[36:39]
    v_mfma_f32_16x16x32_bf16 v[36:39], v[96:99], v[228:231], v[36:39]
    ds_write_b128 v8, a[212:215] offset:39936
    v_mfma_f32_16x16x32_bf16 v[40:43], v[100:103], v[192:195], v[40:43]
    v_mfma_f32_16x16x32_bf16 v[40:43], v[104:107], v[228:231], v[40:43]
    v_mfma_f32_16x16x32_bf16 v[44:47], v[108:111], v[192:195], v[44:47]
    v_mfma_f32_16x16x32_bf16 v[44:47], v[112:115], v[228:231], v[44:47]
    v_mfma_f32_16x16x32_bf16 v[48:51], v[116:119], v[192:195], v[48:51]
    v_mfma_f32_16x16x32_bf16 v[48:51], v[120:123], v[228:231], v[48:51]
    v_mfma_f32_16x16x32_bf16 v[52:55], v[92:95], v[196:199], v[52:55]
    v_mfma_f32_16x16x32_bf16 v[52:55], v[96:99], v[232:235], v[52:55]
    v_mfma_f32_16x16x32_bf16 v[56:59], v[100:103], v[196:199], v[56:59]
    v_mfma_f32_16x16x32_bf16 v[56:59], v[104:107], v[232:235], v[56:59]
    v_mfma_f32_16x16x32_bf16 v[236:239], v[108:111], v[196:199], v[236:239]
    v_mfma_f32_16x16x32_bf16 v[236:239], v[112:115], v[232:235], v[236:239]
    v_mfma_f32_16x16x32_bf16 v[240:243], v[116:119], v[196:199], v[240:243]
    v_mfma_f32_16x16x32_bf16 v[240:243], v[120:123], v[232:235], v[240:243]
    v_mfma_f32_16x16x32_bf16 v[244:247], v[108:111], v[180:183], v[244:247]
    v_mfma_f32_16x16x32_bf16 v[244:247], v[112:115], v[216:219], v[244:247]
    v_mfma_f32_16x16x32_bf16 v[248:251], v[116:119], v[180:183], v[248:251]
    v_mfma_f32_16x16x32_bf16 v[248:251], v[120:123], v[216:219], v[248:251]
    s_and_b32 s62, s20, 1
    s_lshl_b32 s62, s62, 7
    s_add_u32 s23, s24, s62
    s_lshr_b32 s62, s20, 1
    s_lshl_b32 s59, s62, 6
    s_add_u32 s59, s59, s23
    s_add_u32 s59, s59, 163840
    s_mul_i32 s62, s62, 5
    s_mul_i32 s22, s62, 40960
    s_add_u32 s23, s23, s22
    s_add_u32 s62, s62, s31
    s_add_u32 s62, s62, 3
    s_cmp_ge_u32 s62, 224
    s_cselect_b32 s22, 0x40000000, 0
    s_add_u32 s22, s22, 122880
    s_add_u32 s22, s22, s23
    s_waitcnt lgkmcnt(0)
    s_barrier
    ds_read_b128 v[60:63], v2 offset:0
    ds_read_b128 v[64:67], v2 offset:1024
    ds_read_b128 v[68:71], v2 offset:2048
    ds_read_b128 v[72:75], v2 offset:3072
    ds_read_b128 v[76:79], v3 offset:14336
    ds_read_b128 v[80:83], v3 offset:15360
    ds_read_b128 v[84:87], v3 offset:16384
    ds_read_b128 v[88:91], v3 offset:17408
    ds_read_b128 v[92:95], v4 offset:27648
    ds_read_b128 v[96:99], v4 offset:28672
    ds_read_b128 v[100:103], v4 offset:29696
    ds_read_b128 v[104:107], v4 offset:30720
    v_accvgpr_read_b32 v220, a164
    v_accvgpr_read_b32 v221, a165
    v_accvgpr_read_b32 v222, a166
    v_accvgpr_read_b32 v223, a167
    v_accvgpr_read_b32 v224, a192
    v_accvgpr_read_b32 v225, a193
    v_accvgpr_read_b32 v226, a194
    v_accvgpr_read_b32 v227, a195
    v_accvgpr_read_b32 v228, a216
    v_accvgpr_read_b32 v229, a217
    v_accvgpr_read_b32 v230, a218
    v_accvgpr_read_b32 v231, a219
    v_accvgpr_read_b32 v232, a236
    v_accvgpr_read_b32 v233, a237
    v_accvgpr_read_b32 v234, a238
    v_accvgpr_read_b32 v235, a239
    v_accvgpr_read_b32 v10, a168
    v_accvgpr_read_b32 v11, a169
    v_accvgpr_read_b32 v12, a170
    v_accvgpr_read_b32 v13, a171
    v_accvgpr_read_b32 v14, a196
    v_accvgpr_read_b32 v15, a197
    v_accvgpr_read_b32 v16, a198
    v_accvgpr_read_b32 v17, a199
    ds_read_b128 v[108:111], v2 offset:4096
    ds_read_b128 v[112:115], v2 offset:5120
    ds_read_b128 v[116:119], v2 offset:6144
    ds_read_b128 v[120:123], v2 offset:7168
    ds_read_b128 v[124:127], v3 offset:18432
    ds_read_b128 v[128:131], v3 offset:19456
    ds_read_b128 v[132:135], v3 offset:20480
    ds_read_b128 v[136:139], v3 offset:21504
    ds_read_b128 v[140:143], v4 offset:31744
    ds_read_b128 v[144:147], v4 offset:32768
    ds_read_b128 v[148:151], v4 offset:33792
    ds_read_b128 v[152:155], v4 offset:34816
    s_waitcnt lgkmcnt(12)
    v_pk_add_f32 v[76:77], v[76:77], v[92:93]
    v_pk_add_f32 v[78:79], v[78:79], v[94:95]
    ds_read_b128 v[156:159], v2 offset:8192
    v_pk_add_f32 v[80:81], v[80:81], v[96:97]
    v_pk_add_f32 v[82:83], v[82:83], v[98:99]
    ds_read_b128 v[160:163], v2 offset:9216
    v_pk_add_f32 v[84:85], v[84:85], v[100:101]
    v_pk_add_f32 v[86:87], v[86:87], v[102:103]
    ds_read_b128 v[164:167], v2 offset:10240
    v_pk_add_f32 v[88:89], v[88:89], v[104:105]
    v_pk_add_f32 v[90:91], v[90:91], v[106:107]
    ds_read_b128 v[168:171], v2 offset:11264
    v_pk_add_f32 v[220:221], v[220:221], v[60:61]
    v_pk_add_f32 v[222:223], v[222:223], v[62:63]
    ds_read_b128 v[172:175], v3 offset:22528
    v_pk_add_f32 v[224:225], v[224:225], v[64:65]
    v_pk_add_f32 v[226:227], v[226:227], v[66:67]
    ds_read_b128 v[176:179], v3 offset:23552
    v_pk_add_f32 v[228:229], v[228:229], v[68:69]
    v_pk_add_f32 v[230:231], v[230:231], v[70:71]
    ds_read_b128 v[180:183], v3 offset:24576
    v_pk_add_f32 v[232:233], v[232:233], v[72:73]
    v_pk_add_f32 v[234:235], v[234:235], v[74:75]
    ds_read_b128 v[184:187], v3 offset:25600
    v_pk_add_f32 v[220:221], v[220:221], v[76:77]
    v_pk_add_f32 v[222:223], v[222:223], v[78:79]
    ds_read_b128 v[188:191], v4 offset:35840
    v_pk_add_f32 v[224:225], v[224:225], v[80:81]
    v_pk_add_f32 v[226:227], v[226:227], v[82:83]
    ds_read_b128 v[192:195], v4 offset:36864
    v_pk_add_f32 v[228:229], v[228:229], v[84:85]
    v_pk_add_f32 v[230:231], v[230:231], v[86:87]
    ds_read_b128 v[196:199], v4 offset:37888
    v_pk_add_f32 v[232:233], v[232:233], v[88:89]
    v_pk_add_f32 v[234:235], v[234:235], v[90:91]
    ds_read_b128 v[200:203], v4 offset:38912
    v_cvt_pk_bf16_f32 v60, v220, v221
    v_cvt_pk_bf16_f32 v61, v222, v223
    v_cvt_pk_bf16_f32 v62, v224, v225
    ds_read_b128 v[204:207], v2 offset:12288
    v_cvt_pk_bf16_f32 v63, v226, v227
    v_cvt_pk_bf16_f32 v64, v228, v229
    v_cvt_pk_bf16_f32 v65, v230, v231
    ds_read_b128 v[208:211], v3 offset:26624
    v_cvt_pk_bf16_f32 v66, v232, v233
    v_cvt_pk_bf16_f32 v67, v234, v235
    s_add_u32 s62, s23, 0
    ds_read_b128 v[212:215], v4 offset:39936
    v_permlane16_swap_b32 v60, v62
    v_permlane16_swap_b32 v61, v63
    v_permlane16_swap_b32 v64, v66
    ds_read_b128 v[216:219], v2 offset:13312
    v_permlane16_swap_b32 v65, v67
    s_mov_b64 vcc, s[64:65]
    s_nop 0
    v_cndmask_b32_dpp v68, v64, v60, vcc row_ror:8 row_mask:0xf bank_mask:0xf
    v_cndmask_b32_dpp v69, v65, v61, vcc row_ror:8 row_mask:0xf bank_mask:0xf
    v_cndmask_b32_dpp v70, v66, v62, vcc row_ror:8 row_mask:0xf bank_mask:0xf
    v_cndmask_b32_dpp v71, v67, v63, vcc row_ror:8 row_mask:0xf bank_mask:0xf
    s_mov_b64 vcc, s[66:67]
    buffer_store_dwordx4 v[68:71], v26, s[12:15], s62 offen sc0 sc1
    v_cndmask_b32_dpp v72, v64, v60, vcc row_ror:8 row_mask:0xf bank_mask:0xf
    v_cndmask_b32_dpp v73, v65, v61, vcc row_ror:8 row_mask:0xf bank_mask:0xf
    v_cndmask_b32_dpp v74, v66, v62, vcc row_ror:8 row_mask:0xf bank_mask:0xf
    v_cndmask_b32_dpp v75, v67, v63, vcc row_ror:8 row_mask:0xf bank_mask:0xf
    buffer_store_dwordx4 v[72:75], v27, s[12:15], s62 offen sc0 sc1
    s_waitcnt lgkmcnt(15)
    v_pk_add_f32 v[124:125], v[124:125], v[140:141]
    v_pk_add_f32 v[126:127], v[126:127], v[142:143]
    v_pk_add_f32 v[128:129], v[128:129], v[144:145]
    ds_write_b128 v2, a[12:15] offset:0
    v_pk_add_f32 v[130:131], v[130:131], v[146:147]
    v_pk_add_f32 v[132:133], v[132:133], v[148:149]
    v_pk_add_f32 v[134:135], v[134:135], v[150:151]
    ds_write_b128 v2, a[48:51] offset:1024
    v_pk_add_f32 v[136:137], v[136:137], v[152:153]
    v_pk_add_f32 v[138:139], v[138:139], v[154:155]
    v_pk_add_f32 v[10:11], v[10:11], v[108:109]
    ds_write_b128 v2, a[16:19] offset:2048
    v_pk_add_f32 v[12:13], v[12:13], v[110:111]
    v_pk_add_f32 v[14:15], v[14:15], v[112:113]
    v_pk_add_f32 v[16:17], v[16:17], v[114:115]
    ds_write_b128 v2, a[52:55] offset:3072
    v_pk_add_f32 v[28:29], v[28:29], v[116:117]
    v_pk_add_f32 v[30:31], v[30:31], v[118:119]
    v_pk_add_f32 v[32:33], v[32:33], v[120:121]
    ds_write_b128 v2, a[68:71] offset:4096
    v_pk_add_f32 v[34:35], v[34:35], v[122:123]
    v_pk_add_f32 v[10:11], v[10:11], v[124:125]
    v_pk_add_f32 v[12:13], v[12:13], v[126:127]
    ds_write_b128 v2, a[104:107] offset:5120
    v_pk_add_f32 v[14:15], v[14:15], v[128:129]
    v_pk_add_f32 v[16:17], v[16:17], v[130:131]
    v_pk_add_f32 v[28:29], v[28:29], v[132:133]
    ds_write_b128 v2, a[140:143] offset:6144
    v_pk_add_f32 v[30:31], v[30:31], v[134:135]
    v_pk_add_f32 v[32:33], v[32:33], v[136:137]
    v_pk_add_f32 v[34:35], v[34:35], v[138:139]
    ds_write_b128 v2, a[88:91] offset:7168
    v_cvt_pk_bf16_f32 v108, v10, v11
    v_cvt_pk_bf16_f32 v109, v12, v13
    v_cvt_pk_bf16_f32 v110, v14, v15
    ds_write_b128 v2, a[124:127] offset:8192
    v_cvt_pk_bf16_f32 v111, v16, v17
    v_cvt_pk_bf16_f32 v112, v28, v29
    v_cvt_pk_bf16_f32 v113, v30, v31
    ds_write_b128 v2, a[232:235] offset:9216
    v_cvt_pk_bf16_f32 v114, v32, v33
    v_cvt_pk_bf16_f32 v115, v34, v35
    s_add_u32 s62, s23, 40960
    ds_write_b128 v2, a[156:159] offset:10240
    v_permlane16_swap_b32 v108, v110
    v_permlane16_swap_b32 v109, v111
    v_permlane16_swap_b32 v112, v114
    ds_write_b128 v2, a[184:187] offset:11264
    v_permlane16_swap_b32 v113, v115
    s_mov_b64 vcc, s[64:65]
    s_nop 0
    ds_write_b128 v2, a[160:163] offset:12288
    v_cndmask_b32_dpp v116, v112, v108, vcc row_ror:8 row_mask:0xf bank_mask:0xf
    v_cndmask_b32_dpp v117, v113, v109, vcc row_ror:8 row_mask:0xf bank_mask:0xf
    v_cndmask_b32_dpp v118, v114, v110, vcc row_ror:8 row_mask:0xf bank_mask:0xf
    ds_write_b128 v2, a[188:191] offset:13312
    v_cndmask_b32_dpp v119, v115, v111, vcc row_ror:8 row_mask:0xf bank_mask:0xf
    s_mov_b64 vcc, s[66:67]
    buffer_store_dwordx4 v[116:119], v26, s[12:15], s62 offen sc0 sc1
    v_cndmask_b32_dpp v120, v112, v108, vcc row_ror:8 row_mask:0xf bank_mask:0xf
    v_cndmask_b32_dpp v121, v113, v109, vcc row_ror:8 row_mask:0xf bank_mask:0xf
    v_cndmask_b32_dpp v122, v114, v110, vcc row_ror:8 row_mask:0xf bank_mask:0xf
    v_cndmask_b32_dpp v123, v115, v111, vcc row_ror:8 row_mask:0xf bank_mask:0xf
    buffer_store_dwordx4 v[120:123], v27, s[12:15], s62 offen sc0 sc1
    s_waitcnt lgkmcnt(15)
    v_pk_add_f32 v[172:173], v[172:173], v[188:189]
    v_pk_add_f32 v[174:175], v[174:175], v[190:191]
    v_pk_add_f32 v[176:177], v[176:177], v[192:193]
    v_pk_add_f32 v[178:179], v[178:179], v[194:195]
    v_pk_add_f32 v[180:181], v[180:181], v[196:197]
    v_pk_add_f32 v[182:183], v[182:183], v[198:199]
    v_pk_add_f32 v[184:185], v[184:185], v[200:201]
    v_pk_add_f32 v[186:187], v[186:187], v[202:203]
    v_pk_add_f32 v[36:37], v[36:37], v[156:157]
    v_pk_add_f32 v[38:39], v[38:39], v[158:159]
    v_pk_add_f32 v[40:41], v[40:41], v[160:161]
    v_pk_add_f32 v[42:43], v[42:43], v[162:163]
    v_pk_add_f32 v[44:45], v[44:45], v[164:165]
    v_pk_add_f32 v[46:47], v[46:47], v[166:167]
    v_pk_add_f32 v[48:49], v[48:49], v[168:169]
    v_pk_add_f32 v[50:51], v[50:51], v[170:171]
    v_pk_add_f32 v[36:37], v[36:37], v[172:173]
    v_pk_add_f32 v[38:39], v[38:39], v[174:175]
    v_pk_add_f32 v[40:41], v[40:41], v[176:177]
    v_pk_add_f32 v[42:43], v[42:43], v[178:179]
    v_pk_add_f32 v[44:45], v[44:45], v[180:181]
    v_pk_add_f32 v[46:47], v[46:47], v[182:183]
    v_pk_add_f32 v[48:49], v[48:49], v[184:185]
    v_pk_add_f32 v[50:51], v[50:51], v[186:187]
    v_cvt_pk_bf16_f32 v156, v36, v37
    v_cvt_pk_bf16_f32 v157, v38, v39
    v_cvt_pk_bf16_f32 v158, v40, v41
    v_cvt_pk_bf16_f32 v159, v42, v43
    v_cvt_pk_bf16_f32 v160, v44, v45
    v_cvt_pk_bf16_f32 v161, v46, v47
    v_cvt_pk_bf16_f32 v162, v48, v49
    v_cvt_pk_bf16_f32 v163, v50, v51
    s_add_u32 s62, s23, 81920
    v_permlane16_swap_b32 v156, v158
    v_permlane16_swap_b32 v157, v159
    v_permlane16_swap_b32 v160, v162
    v_permlane16_swap_b32 v161, v163
    s_mov_b64 vcc, s[64:65]
    s_nop 0
    v_cndmask_b32_dpp v164, v160, v156, vcc row_ror:8 row_mask:0xf bank_mask:0xf
    v_cndmask_b32_dpp v165, v161, v157, vcc row_ror:8 row_mask:0xf bank_mask:0xf
    v_cndmask_b32_dpp v166, v162, v158, vcc row_ror:8 row_mask:0xf bank_mask:0xf
    v_cndmask_b32_dpp v167, v163, v159, vcc row_ror:8 row_mask:0xf bank_mask:0xf
    s_mov_b64 vcc, s[66:67]
    buffer_store_dwordx4 v[164:167], v26, s[12:15], s62 offen sc0 sc1
    v_cndmask_b32_dpp v168, v160, v156, vcc row_ror:8 row_mask:0xf bank_mask:0xf
    v_cndmask_b32_dpp v169, v161, v157, vcc row_ror:8 row_mask:0xf bank_mask:0xf
    v_cndmask_b32_dpp v170, v162, v158, vcc row_ror:8 row_mask:0xf bank_mask:0xf
    v_cndmask_b32_dpp v171, v163, v159, vcc row_ror:8 row_mask:0xf bank_mask:0xf
    buffer_store_dwordx4 v[168:171], v27, s[12:15], s62 offen sc0 sc1
    s_waitcnt lgkmcnt(14)
    v_pk_add_f32 v[208:209], v[208:209], v[212:213]
    v_pk_add_f32 v[210:211], v[210:211], v[214:215]
    v_pk_add_f32 v[52:53], v[52:53], v[204:205]
    v_pk_add_f32 v[54:55], v[54:55], v[206:207]
    v_pk_add_f32 v[52:53], v[52:53], v[208:209]
    v_pk_add_f32 v[54:55], v[54:55], v[210:211]
    v_pk_add_f32 v[56:57], v[56:57], v[216:217]
    v_pk_add_f32 v[58:59], v[58:59], v[218:219]
    s_waitcnt lgkmcnt(0)
    s_barrier
    ds_read_b128 v[76:79], v4 offset:4096
    ds_read_b128 v[80:83], v3 offset:9216
    ds_read_b128 v[84:87], v8 offset:0
    ds_read_b128 v[88:91], v4 offset:5120
    ds_read_b128 v[92:95], v3 offset:10240
    ds_read_b128 v[96:99], v8 offset:1024
    ds_read_b128 v[100:103], v4 offset:6144
    ds_read_b128 v[104:107], v3 offset:11264
    ds_read_b128 v[124:127], v8 offset:2048
    ds_read_b128 v[128:131], v4 offset:7168
    ds_read_b128 v[132:135], v3 offset:12288
    ds_read_b128 v[136:139], v8 offset:3072
    ds_read_b128 v[140:143], v4 offset:8192
    ds_read_b128 v[144:147], v3 offset:13312
    s_waitcnt lgkmcnt(6)
    v_pk_add_f32 v[76:77], v[76:77], v[80:81]
    v_pk_add_f32 v[78:79], v[78:79], v[82:83]
    v_pk_add_f32 v[56:57], v[56:57], v[76:77]
    v_pk_add_f32 v[58:59], v[58:59], v[78:79]
    v_pk_add_f32 v[88:89], v[88:89], v[92:93]
    v_pk_add_f32 v[90:91], v[90:91], v[94:95]
    v_pk_add_f32 v[100:101], v[100:101], v[104:105]
    v_pk_add_f32 v[102:103], v[102:103], v[106:107]
    v_pk_add_f32 v[236:237], v[236:237], v[84:85]
    v_pk_add_f32 v[238:239], v[238:239], v[86:87]
    v_pk_add_f32 v[240:241], v[240:241], v[96:97]
    v_pk_add_f32 v[242:243], v[242:243], v[98:99]
    v_pk_add_f32 v[236:237], v[236:237], v[88:89]
    v_pk_add_f32 v[238:239], v[238:239], v[90:91]
    v_pk_add_f32 v[240:241], v[240:241], v[100:101]
    v_pk_add_f32 v[242:243], v[242:243], v[102:103]
    v_cvt_pk_bf16_f32 v204, v52, v53
    v_cvt_pk_bf16_f32 v205, v54, v55
    v_cvt_pk_bf16_f32 v206, v56, v57
    v_cvt_pk_bf16_f32 v207, v58, v59
    v_cvt_pk_bf16_f32 v208, v236, v237
    v_cvt_pk_bf16_f32 v209, v238, v239
    v_cvt_pk_bf16_f32 v210, v240, v241
    v_cvt_pk_bf16_f32 v211, v242, v243
    s_mov_b32 s62, s22
    v_permlane16_swap_b32 v204, v206
    v_permlane16_swap_b32 v205, v207
    v_permlane16_swap_b32 v208, v210
    v_permlane16_swap_b32 v209, v211
    s_mov_b64 vcc, s[64:65]
    s_nop 0
    v_cndmask_b32_dpp v212, v208, v204, vcc row_ror:8 row_mask:0xf bank_mask:0xf
    v_cndmask_b32_dpp v213, v209, v205, vcc row_ror:8 row_mask:0xf bank_mask:0xf
    v_cndmask_b32_dpp v214, v210, v206, vcc row_ror:8 row_mask:0xf bank_mask:0xf
    v_cndmask_b32_dpp v215, v211, v207, vcc row_ror:8 row_mask:0xf bank_mask:0xf
    s_mov_b64 vcc, s[66:67]
    buffer_store_dwordx4 v[212:215], v26, s[12:15], s62 offen sc0 sc1
    v_cndmask_b32_dpp v216, v208, v204, vcc row_ror:8 row_mask:0xf bank_mask:0xf
    v_cndmask_b32_dpp v217, v209, v205, vcc row_ror:8 row_mask:0xf bank_mask:0xf
    v_cndmask_b32_dpp v218, v210, v206, vcc row_ror:8 row_mask:0xf bank_mask:0xf
    v_cndmask_b32_dpp v219, v211, v207, vcc row_ror:8 row_mask:0xf bank_mask:0xf
    buffer_store_dwordx4 v[216:219], v27, s[12:15], s62 offen sc0 sc1
    s_waitcnt lgkmcnt(0)
    v_pk_add_f32 v[128:129], v[128:129], v[132:133]
    v_pk_add_f32 v[130:131], v[130:131], v[134:135]
    v_pk_add_f32 v[140:141], v[140:141], v[144:145]
    v_pk_add_f32 v[142:143], v[142:143], v[146:147]
    v_pk_add_f32 v[244:245], v[244:245], v[124:125]
    v_pk_add_f32 v[246:247], v[246:247], v[126:127]
    v_pk_add_f32 v[248:249], v[248:249], v[136:137]
    v_pk_add_f32 v[250:251], v[250:251], v[138:139]
    v_pk_add_f32 v[244:245], v[244:245], v[128:129]
    v_pk_add_f32 v[246:247], v[246:247], v[130:131]
    v_pk_add_f32 v[248:249], v[248:249], v[140:141]
    v_pk_add_f32 v[250:251], v[250:251], v[142:143]
    v_cvt_pk_bf16_f32 v60, v244, v245
    v_cvt_pk_bf16_f32 v61, v246, v247
    v_cvt_pk_bf16_f32 v62, v248, v249
    v_cvt_pk_bf16_f32 v63, v250, v251
    s_nop 1
    v_permlane16_swap_b32 v60, v62
    v_permlane16_swap_b32 v61, v63
    buffer_store_dwordx4 v[60:63], v9, s[12:15], s59 offen sc0 sc1
L_op_end:
    s_endpgm
L_code_end:
.section .rodata,"a"
.p2align 6
.amdhsa_kernel fused_kernel
  .amdhsa_next_free_vgpr 512
  .amdhsa_next_free_sgpr 102
  .amdhsa_accum_offset 256
  .amdhsa_group_segment_fixed_size 0
  .amdhsa_kernarg_size 104
  .amdhsa_user_sgpr_count 2
  .amdhsa_user_sgpr_kernarg_segment_ptr 1
  .amdhsa_system_sgpr_workgroup_id_x 1
.end_amdhsa_kernel
.p2align 6
.amdhsa_kernel op_kernel
  .amdhsa_next_free_vgpr 512
  .amdhsa_next_free_sgpr 102
  .amdhsa_accum_offset 256
  .amdhsa_group_segment_fixed_size 0
  .amdhsa_kernarg_size 104
  .amdhsa_user_sgpr_count 2
  .amdhsa_user_sgpr_kernarg_segment_ptr 1
  .amdhsa_system_sgpr_workgroup_id_x 1
.end_amdhsa_kernel
```

```asm
; @launch kernel=fused_kernel grid=(256,1,1) block=(256,1,1) lds=163840
; @launch kernel=op_kernel grid=(256,1,1) block=(256,1,1) lds=163840
.amdgcn_target "amdgcn-amd-amdhsa--gfx950"
.text
.globl fused_kernel
.p2align 8
.type fused_kernel,@function
fused_kernel:
    s_cmp_ge_u32 s2, 256
    s_cbranch_scc1 L_at_end
    s_and_b32 s3, s2, 7
    s_lshl_b32 s3, s3, 5
    s_lshr_b32 s36, s2, 6
    s_lshl_b32 s36, s36, 3
    s_or_b32 s3, s3, s36
    s_bfe_u32 s36, s2, 0x30003
    s_or_b32 s2, s3, s36
    s_load_dwordx8 s[36:43], s[0:1], 0
    s_load_dwordx8 s[56:63], s[0:1], 40
    s_load_dwordx2 s[44:45], s[0:1], 96
    s_load_dwordx2 s[84:85], s[0:1], 32
    s_load_dwordx2 s[86:87], s[0:1], 72
    s_getpc_b64 s[72:73]
L_pc0:
    v_lshlrev_b32 v105, 7, v0
    v_add_u32 v104, 0, v105
    v_min_u32 v104, L_code_end - L_pc0 - 4, v104
    v_mov_b32 v107, s73
    v_add_co_u32 v106, vcc, s72, v104
    v_addc_co_u32 v107, vcc, 0, v107, vcc
    global_load_dword v108, v[106:107], off
    v_add_u32 v104, 32768, v105
    v_min_u32 v104, L_code_end - L_pc0 - 4, v104
    v_mov_b32 v107, s73
    v_add_co_u32 v106, vcc, s72, v104
    v_addc_co_u32 v107, vcc, 0, v107, vcc
    global_load_dword v108, v[106:107], off
    v_add_u32 v104, 65536, v105
    v_min_u32 v104, L_code_end - L_pc0 - 4, v104
    v_mov_b32 v107, s73
    v_add_co_u32 v106, vcc, s72, v104
    v_addc_co_u32 v107, vcc, 0, v107, vcc
    global_load_dword v108, v[106:107], off
    v_and_b32 v1, 63, v0
    v_lshrrev_b32 v2, 6, v0
    s_nop 0
    v_readfirstlane_b32 s20, v2
    s_waitcnt lgkmcnt(0)
    s_and_b32 s48, s20, 1
    s_lshr_b32 s35, s20, 1
    s_cmp_ge_u32 s2, 128
    s_cselect_b32 s36, s56, s36
    s_cselect_b32 s37, s57, s37
    s_cselect_b32 s38, s58, s38
    s_cselect_b32 s39, s59, s39
    s_cselect_b32 s40, s60, s40
    s_cselect_b32 s41, s61, s41
    s_cselect_b32 s42, s62, s42
    s_cselect_b32 s43, s63, s43
    s_cselect_b32 s84, s86, s84
    s_cselect_b32 s85, s87, s85
    s_mov_b32 s86, 5242880
    s_mov_b32 s87, 0x20000
    s_and_b32 s28, s2, 127
    s_lshl_b32 s29, s28, 20
    s_lshl_b32 s30, s35, 18
    s_add_u32 s29, s29, s30
    s_add_u32 s38, s38, s29
    s_addc_u32 s39, s39, 0
    s_add_u32 s40, s40, s29
    s_addc_u32 s41, s41, 0
    s_sub_u32 s30, 0x100000, s30
    s_mov_b32 s8, s38
    s_mov_b32 s9, s39
    s_mov_b32 s10, s30
    s_mov_b32 s11, 0x20000
    s_cmp_eq_u32 s48, 0
    s_cselect_b32 s4, s38, s40
    s_cselect_b32 s5, s39, s41
    s_mov_b32 s6, s30
    s_mov_b32 s7, 0x20000
    s_cselect_b32 s16, s42, s36
    s_cselect_b32 s17, s43, s37
    s_mov_b32 s28, 5242880
    s_mov_b32 s29, 4587520
    s_cselect_b32 s18, s28, s29
    s_mov_b32 s19, 0x20000
    s_mov_b32 s28, 262144
    s_mov_b32 s29, 64
    s_cselect_b32 s51, s28, s29
    s_cselect_b32 s52, 512, 0
    s_mov_b32 s28, 81920
    s_cselect_b32 s46, 128, s28
    s_mov_b32 s28, 81920
    s_cselect_b32 s47, s28, 0x40000000
    s_mov_b32 s28, 90112
    s_cselect_b32 s98, s28, 0x40000000
    s_mov_b32 s28, 1056
    s_mov_b32 s29, 1024
    s_cselect_b32 s53, s28, s29
    s_mov_b32 s28, 0
    s_mov_b32 s29, 0
    s_cselect_b32 s88, s28, s29
    s_mov_b32 s28, 8192
    s_mov_b32 s29, 10240
    s_cselect_b32 s89, s28, s29
    s_mov_b32 s28, 16384
    s_mov_b32 s29, 20480
    s_cselect_b32 s90, s28, s29
    s_mov_b32 s28, 24576
    s_mov_b32 s29, 30720
    s_cselect_b32 s91, s28, s29
    s_mov_b32 s28, 65536
    s_mov_b32 s29, 40960
    s_cselect_b32 s92, s28, s29
    s_mov_b32 s28, 73728
    s_mov_b32 s29, 51200
    s_cselect_b32 s93, s28, s29
    s_mov_b32 s28, 81920
    s_mov_b32 s29, 61440
    s_cselect_b32 s94, s28, s29
    s_mov_b32 s28, 90112
    s_mov_b32 s29, 71680
    s_cselect_b32 s95, s28, s29
    s_and_b32 s28, s2, 7
    s_lshl_b32 s28, s28, 2
    s_add_u32 s28, s28, s35
    s_lshl_b32 s28, s28, 8
    s_bfe_u32 s29, s2, 262147
    s_lshl_b32 s29, s29, 1
    s_add_u32 s29, s29, s35
    s_mul_i32 s29, s29, 143360
    s_cmp_eq_u32 s48, 0
    s_cselect_b32 s55, s28, s29
    s_add_u32 s12, s44, 0
    s_addc_u32 s13, s45, 0
    s_mov_b32 s14, 127926272
    s_mov_b32 s15, 0x20000
    s_lshl_b32 s28, s2, 2
    s_add_u32 s28, s28, s35
    s_mul_i32 s24, s28, 57344
    s_mul_i32 s28, s48, 28672
    s_add_u32 s24, s24, s28
    s_add_u32 s24, s24, 58720256
    s_mov_b32 s23, -1
    s_mov_b32 s60, s42
    s_mov_b32 s61, s43
    s_mov_b32 s62, 5242880
    s_mov_b32 s63, 0x20000
    s_mov_b32 s27, 0
    s_mov_b32 s25, 0
    s_mov_b32 s68, 0
    s_mov_b32 s71, 0
    s_lshr_b32 s26, s2, 3
    s_lshr_b32 s28, s2, 1
    s_add_u32 s26, s26, s28
    s_and_b32 s26, s26, 3
    s_mul_i32 s26, s26, 5
    s_and_b32 s26, s26, 30
    s_mul_i32 s83, s51, 20
    s_and_b32 s69, s2, 1
    s_min_u32 s69, s69, 1
    s_bfe_u32 s3, s2, 0x10005
    s_xor_b32 s3, s3, 1
    s_and_b32 s69, s2, s3
    s_nop 0
    s_mov_b32 s70, s69
    s_mov_b32 s32, 0x4e800000
    s_mov_b32 s54, 0x3e0293ee
    s_lshl_b32 s28, s48, 1
    s_add_u32 s28, s28, s35
    s_mul_i32 s33, s28, 33792
    v_lshlrev_b32 v6, 4, v1
    v_lshrrev_b32 v2, 4, v1
    v_and_b32 v3, 15, v1
    v_lshlrev_b32 v4, 4, v3
    v_lshl_add_u32 v7, v2, 14, v4
    v_and_b32 v26, 7, v1
    v_lshlrev_b32 v26, 4, v26
    v_bfe_u32 v5, v1, 3, 1
    v_lshl_add_u32 v26, v5, 15, v26
    v_bfe_u32 v5, v1, 4, 1
    v_lshl_add_u32 v26, v5, 17, v26
    v_bfe_u32 v5, v1, 5, 1
    v_lshl_add_u32 v26, v5, 18, v26
    v_mul_u32_u24 v27, 1280, v3
    v_lshl_add_u32 v27, v2, 4, v27
    v_lshrrev_b32 v5, 3, v1
    v_and_b32 v27, 6, v5
    v_xor_b32 v27, v27, v1
    v_and_b32 v27, 7, v27
    v_lshlrev_b32 v27, 4, v27
    v_mul_u32_u24 v5, 1280, v5
    v_add_u32 v27, v27, v5
    s_cmp_eq_u32 s48, 0
    s_cselect_b64 vcc, -1, 0
    s_nop 1
    v_cndmask_b32 v26, v27, v26, vcc
    s_add_u32 s28, s48, 2
    s_mul_i32 s28, s28, 33792
    v_and_b32 v27, 6, v3
    v_xor_b32 v27, v27, v2
    v_lshlrev_b32 v27, 4, v27
    v_and_b32 v5, 7, v3
    v_lshl_add_u32 v27, v5, 7, v27
    v_lshrrev_b32 v5, 3, v3
    v_lshl_add_u32 v27, v5, 10, v27
    v_add_u32 v27, s28, v27
    v_bfe_u32 v5, v1, 4, 1
    v_lshl_add_u32 v4, v5, 9, v4
    v_bfe_u32 v5, v1, 5, 1
    v_lshl_add_u32 v10, v5, 8, v4
    v_and_b32 v4, 7, v3
    v_lshlrev_b32 v8, 10, v4
    v_and_b32 v5, 1, v3
    v_lshl_add_u32 v8, v5, 4, v8
    v_bfe_u32 v5, v3, 1, 2
    v_lshl_add_u32 v8, v5, 6, v8
    v_lshrrev_b32 v5, 3, v3
    v_lshl_add_u32 v8, v5, 8, v8
    v_bfe_u32 v5, v1, 4, 1
    v_lshl_add_u32 v8, v5, 5, v8
    v_bfe_u32 v5, v1, 5, 1
    v_lshl_add_u32 v8, v5, 4, v8
    s_mul_i32 s28, s35, 33792
    v_add_u32 v8, s28, v8
    v_bfe_u32 v3, v1, 2, 2
    v_bfe_u32 v5, v1, 4, 1
    v_lshl_add_u32 v4, v5, 2, v3
    v_mul_u32_u24 v4, 1056, v4
    v_bfe_u32 v5, v1, 5, 1
    v_lshl_add_u32 v4, v5, 8, v4
    v_and_b32 v5, 3, v1
    v_lshl_add_u32 v4, v5, 3, v4
    v_add_u32 v11, s28, v4
    v_lshl_add_u32 v3, v2, 2, v3
    v_and_b32 v4, 7, v3
    v_mul_u32_u24 v4, 1056, v4
    v_lshrrev_b32 v5, 3, v3
    v_lshl_add_u32 v4, v5, 8, v4
    v_and_b32 v5, 3, v1
    v_lshl_add_u32 v4, v5, 3, v4
    s_add_u32 s28, s28, 67584
    v_add_u32 v9, s28, v4
    v_mov_b32 v12, 0xff800000
    v_mov_b32 v14, 0xff800000
    v_mov_b32 v16, 0xff800000
    v_mov_b32 v18, 0xff800000
    v_mov_b32 v20, 0xff800000
    v_mov_b32 v22, 0xff800000
    v_mov_b32 v24, 0xff800000
    v_mov_b32 v2, 0x3f803f80
    v_accvgpr_write_b32 a252, v2
    v_accvgpr_write_b32 a253, v2
    v_accvgpr_write_b32 a254, v2
    v_accvgpr_write_b32 a255, v2
    v_and_b32 v2, 3, v1
    v_lshlrev_b32 v2, 2, v2
    v_add_u32 v2, 76000, v2
    v_mov_b32 v3, 0
    ds_write_b32 v2, v3
    s_cmp_eq_u32 s48, 0
    s_mov_b32 s28, 784
    s_mov_b32 s29, 800
    s_cselect_b32 s96, s28, s29
    s_mov_b32 s28, 816
    s_cselect_b32 s97, s28, s29
    v_lshrrev_b32 v2, 1, v1
    v_lshlrev_b32 v2, 13, v2
    v_and_b32 v3, 1, v1
    v_lshl_add_u32 v2, v3, 7, v2
    v_lshlrev_b32 v3, 7, v1
    s_bfe_u32 s28, s2, 0x20003
    s_lshl_b32 s28, s28, 18
    s_and_b32 s29, s2, 7
    s_mul_i32 s29, s29, 17920
    s_cmp_eq_u32 s48, 0
    s_cselect_b64 vcc, -1, 0
    s_cselect_b32 s100, s28, s29
    s_add_u32 s100, s100, s55
    s_cmp_eq_u32 s48, 0
    s_mov_b32 s28, 1048576
    s_mov_b32 s29, 8192
    s_cselect_b32 s99, s28, s29
    v_cndmask_b32 v6, v3, v2, vcc
    v_xor_b32 v6, 64, v27
    s_mul_i32 s100, s2, 11
    s_lshr_b32 s28, s2, 5
    s_mul_i32 s28, s28, 7
    s_add_u32 s100, s100, s28
    s_lshl_b32 s28, s35, 4
    s_add_u32 s100, s100, s28
    s_and_b32 s100, s100, 31
L_at_start:
    s_mov_b32 s21, s27
    s_lshl_b32 s34, s27, 5
    s_add_u32 s31, s21, s70
    s_mul_i32 s50, s31, s52
    s_mov_b32 s101, s31
    s_add_u32 s50, s50, s55
    s_cmp_ge_u32 s31, 2
    s_cselect_b32 s28, 0x40000000, 0
    s_add_u32 s50, s50, s28
    s_mov_b32 s82, s26
    s_mul_i32 s28, s26, s51
    s_add_u32 s50, s50, s28
    s_add_u32 m0, s33, 0
    s_mov_b32 s49, s50
    s_add_u32 s28, s49, s88
    buffer_load_dwordx4 v26, s[16:19], s28 offen lds
    s_add_u32 m0, m0, s53
    s_add_u32 s28, s49, s89
    buffer_load_dwordx4 v26, s[16:19], s28 offen lds
    s_add_u32 m0, m0, s53
    s_add_u32 s28, s49, s90
    buffer_load_dwordx4 v26, s[16:19], s28 offen lds
    s_add_u32 m0, m0, s53
    s_add_u32 s28, s49, s91
    buffer_load_dwordx4 v26, s[16:19], s28 offen lds
    s_add_u32 m0, m0, s53
    s_add_u32 s28, s49, s92
    buffer_load_dwordx4 v26, s[16:19], s28 offen lds
    s_add_u32 m0, m0, s53
    s_add_u32 s28, s49, s93
    buffer_load_dwordx4 v26, s[16:19], s28 offen lds
    s_add_u32 m0, m0, s53
    s_add_u32 s28, s49, s94
    buffer_load_dwordx4 v26, s[16:19], s28 offen lds
    s_add_u32 m0, m0, s53
    s_add_u32 s28, s49, s95
    buffer_load_dwordx4 v26, s[16:19], s28 offen lds
    s_add_u32 m0, s33, 8448
    s_add_u32 s49, s50, s46
    s_lshl1_add_u32 s50, s51, s50
    s_add_u32 s82, s82, 2
    s_cmp_eq_u32 s82, 20
    s_cselect_b32 s29, s83, 0
    s_sub_u32 s50, s50, s29
    s_add_u32 s28, s49, s88
    buffer_load_dwordx4 v26, s[16:19], s28 offen lds
    s_add_u32 m0, m0, s53
    s_add_u32 s28, s49, s89
    buffer_load_dwordx4 v26, s[16:19], s28 offen lds
    s_add_u32 m0, m0, s53
    s_add_u32 s28, s49, s90
    buffer_load_dwordx4 v26, s[16:19], s28 offen lds
    s_add_u32 m0, m0, s53
    s_add_u32 s28, s49, s91
    buffer_load_dwordx4 v26, s[16:19], s28 offen lds
    s_add_u32 m0, m0, s53
    s_add_u32 s28, s49, s92
    buffer_load_dwordx4 v26, s[16:19], s28 offen lds
    s_add_u32 m0, m0, s53
    s_add_u32 s28, s49, s93
    buffer_load_dwordx4 v26, s[16:19], s28 offen lds
    s_add_u32 m0, m0, s53
    s_add_u32 s28, s49, s47
    buffer_load_dwordx4 v26, s[16:19], s28 offen lds
    s_add_u32 m0, m0, s53
    s_add_u32 s28, s49, s98
    buffer_load_dwordx4 v26, s[16:19], s28 offen lds
    s_add_u32 m0, s33, 16896
    s_mov_b32 s49, s50
    s_add_u32 s28, s49, s88
    buffer_load_dwordx4 v26, s[16:19], s28 offen lds
    s_add_u32 m0, m0, s53
    s_add_u32 s28, s49, s89
    buffer_load_dwordx4 v26, s[16:19], s28 offen lds
    s_add_u32 m0, m0, s53
    s_add_u32 s28, s49, s90
    buffer_load_dwordx4 v26, s[16:19], s28 offen lds
    s_add_u32 m0, m0, s53
    s_add_u32 s28, s49, s91
    buffer_load_dwordx4 v26, s[16:19], s28 offen lds
    s_add_u32 m0, m0, s53
    s_add_u32 s28, s49, s92
    buffer_load_dwordx4 v26, s[16:19], s28 offen lds
    s_add_u32 m0, m0, s53
    s_add_u32 s28, s49, s93
    buffer_load_dwordx4 v26, s[16:19], s28 offen lds
    s_add_u32 m0, m0, s53
    s_add_u32 s28, s49, s94
    buffer_load_dwordx4 v26, s[16:19], s28 offen lds
    s_add_u32 m0, m0, s53
    s_add_u32 s28, s49, s95
    buffer_load_dwordx4 v26, s[16:19], s28 offen lds
    s_add_u32 m0, s33, 25344
    s_add_u32 s49, s50, s46
    s_lshl1_add_u32 s50, s51, s50
    s_add_u32 s82, s82, 2
    s_cmp_eq_u32 s82, 20
    s_cselect_b32 s29, s83, 0
    s_sub_u32 s50, s50, s29
    s_add_u32 s28, s49, s88
    buffer_load_dwordx4 v26, s[16:19], s28 offen lds
    s_add_u32 m0, m0, s53
    s_add_u32 s28, s49, s89
    buffer_load_dwordx4 v26, s[16:19], s28 offen lds
    s_add_u32 m0, m0, s53
    s_add_u32 s28, s49, s90
    buffer_load_dwordx4 v26, s[16:19], s28 offen lds
    s_add_u32 m0, m0, s53
    s_add_u32 s28, s49, s91
    buffer_load_dwordx4 v26, s[16:19], s28 offen lds
    s_add_u32 m0, m0, s53
    s_add_u32 s28, s49, s92
    buffer_load_dwordx4 v26, s[16:19], s28 offen lds
    s_add_u32 m0, m0, s53
    s_add_u32 s28, s49, s93
    buffer_load_dwordx4 v26, s[16:19], s28 offen lds
    s_add_u32 m0, m0, s53
    s_add_u32 s28, s49, s47
    buffer_load_dwordx4 v26, s[16:19], s28 offen lds
    s_add_u32 m0, m0, s53
    s_add_u32 s28, s49, s98
    buffer_load_dwordx4 v26, s[16:19], s28 offen lds
    s_waitcnt vmcnt(16) lgkmcnt(0)
    s_barrier
L_at_round:
    ds_read_b64_tr_b16 v[112:113], v11 offset:0
    ds_read_b64_tr_b16 v[114:115], v11 offset:128
    ds_read_b64_tr_b16 v[116:117], v11 offset:512
    ds_read_b64_tr_b16 v[118:119], v11 offset:640
    ds_read_b64_tr_b16 v[120:121], v11 offset:32
    ds_read_b64_tr_b16 v[122:123], v11 offset:160
    ds_read_b64_tr_b16 v[124:125], v11 offset:544
    ds_read_b64_tr_b16 v[126:127], v11 offset:672
    ds_read_b64_tr_b16 v[128:129], v11 offset:64
    ds_read_b64_tr_b16 v[130:131], v11 offset:192
    ds_read_b64_tr_b16 v[132:133], v11 offset:576
    ds_read_b64_tr_b16 v[134:135], v11 offset:704
    ds_read_b64_tr_b16 v[136:137], v11 offset:96
    ds_read_b64_tr_b16 v[138:139], v11 offset:224
    ds_read_b64_tr_b16 v[140:141], v11 offset:608
    ds_read_b64_tr_b16 v[142:143], v11 offset:736
    ds_read_b128 v[28:31], v27 offset:0
    ds_read_b128 v[32:35], v27 offset:2048
    ds_read_b128 v[36:39], v27 offset:4096
    ds_read_b128 v[40:43], v27 offset:6144
    ds_read_b128 v[44:47], v27 offset:8448
    ds_read_b128 v[48:51], v27 offset:10496
    ds_read_b128 v[52:55], v27 offset:12544
    ds_read_b128 v[56:59], v6 offset:0
    ds_read_b128 v[60:63], v6 offset:2048
    ds_read_b128 v[64:67], v6 offset:4096
    ds_read_b128 v[68:71], v6 offset:6144
    ds_read_b128 v[72:75], v6 offset:8448
    ds_read_b128 v[76:79], v6 offset:10496
    ds_read_b128 v[80:83], v6 offset:12544
    s_waitcnt lgkmcnt(0)
    s_waitcnt lgkmcnt(8)
    v_mfma_f32_16x16x32_bf16 v[144:147], v[112:115], v[28:31], 0
    s_add_u32 m0, s33, 0
    v_mfma_f32_16x16x32_bf16 v[144:147], v[116:119], v[56:59], v[144:147]
    s_mov_b32 s49, s50
    v_mfma_f32_16x16x32_bf16 v[148:151], v[112:115], v[32:35], 0
    v_mfma_f32_16x16x32_bf16 v[148:151], v[116:119], v[60:63], v[148:151]
    v_mfma_f32_16x16x32_bf16 v[152:155], v[112:115], v[36:39], 0
    v_mfma_f32_16x16x32_bf16 v[152:155], v[116:119], v[64:67], v[152:155]
    v_mfma_f32_16x16x32_bf16 v[156:159], v[112:115], v[40:43], 0
    s_cmp_eq_u32 s68, 0
    s_cbranch_scc0 L_bw1_452
    s_waitcnt vmcnt(16) lgkmcnt(0)
L_bw2_452:
    s_barrier
    s_cmp_le_u32 s21, s27
    s_cbranch_scc1 L_at_nofb_457
    s_sub_u32 s28, s21, 1
    s_cmp_eq_u32 s28, s23
    s_cbranch_scc1 L_at_nofb_457
    s_lshl_b32 s29, s28, 2
    s_add_u32 s29, s29, 76000
    v_mov_b32 v4, s29
    ds_read_b32 v4, v4
    s_waitcnt lgkmcnt(0)
    v_readfirstlane_b32 s29, v4
    s_nop 3
    s_cmp_lg_u32 s29, 0
    s_cbranch_scc1 L_at_fallback
L_at_nofb_457:
    v_mfma_f32_16x16x32_bf16 v[156:159], v[116:119], v[68:71], v[156:159]
    v_mfma_f32_16x16x32_bf16 v[160:163], v[112:115], v[44:47], 0
    v_mfma_f32_16x16x32_bf16 v[160:163], v[116:119], v[72:75], v[160:163]
    s_add_u32 s28, s49, s88
    buffer_load_dwordx4 v26, s[16:19], s28 offen lds
    v_mfma_f32_16x16x32_bf16 v[164:167], v[112:115], v[48:51], 0
    s_add_u32 m0, m0, s53
    v_mfma_f32_16x16x32_bf16 v[164:167], v[116:119], v[76:79], v[164:167]
    v_mfma_f32_16x16x32_bf16 v[168:171], v[112:115], v[52:55], 0
    v_mfma_f32_16x16x32_bf16 v[168:171], v[116:119], v[80:83], v[168:171]
    ds_read_b64_tr_b16 v[112:113], v11 offset:8448
    v_mfma_f32_16x16x32_bf16 v[172:175], v[120:123], v[28:31], 0
    ds_read_b64_tr_b16 v[114:115], v11 offset:8576
    v_mfma_f32_16x16x32_bf16 v[172:175], v[124:127], v[56:59], v[172:175]
    s_add_u32 s28, s49, s89
    buffer_load_dwordx4 v26, s[16:19], s28 offen lds
    v_mfma_f32_16x16x32_bf16 v[176:179], v[120:123], v[32:35], 0
    s_add_u32 m0, m0, s53
    ds_read_b64_tr_b16 v[116:117], v11 offset:8960
    v_mfma_f32_16x16x32_bf16 v[176:179], v[124:127], v[60:63], v[176:179]
    ds_read_b64_tr_b16 v[118:119], v11 offset:9088
    v_mfma_f32_16x16x32_bf16 v[180:183], v[120:123], v[36:39], 0
    v_mfma_f32_16x16x32_bf16 v[180:183], v[124:127], v[64:67], v[180:183]
    v_mfma_f32_16x16x32_bf16 v[184:187], v[120:123], v[40:43], 0
    v_mfma_f32_16x16x32_bf16 v[184:187], v[124:127], v[68:71], v[184:187]
    s_add_u32 s28, s49, s90
    buffer_load_dwordx4 v26, s[16:19], s28 offen lds
    v_mfma_f32_16x16x32_bf16 v[188:191], v[120:123], v[44:47], 0
    s_add_u32 m0, m0, s53
    v_mfma_f32_16x16x32_bf16 v[188:191], v[124:127], v[72:75], v[188:191]
    v_mfma_f32_16x16x32_bf16 v[192:195], v[120:123], v[48:51], 0
    v_mfma_f32_16x16x32_bf16 v[192:195], v[124:127], v[76:79], v[192:195]
    v_mfma_f32_16x16x32_bf16 v[196:199], v[120:123], v[52:55], 0
    v_mfma_f32_16x16x32_bf16 v[196:199], v[124:127], v[80:83], v[196:199]
    s_add_u32 s28, s49, s91
    buffer_load_dwordx4 v26, s[16:19], s28 offen lds
    v_mfma_f32_16x16x32_bf16 v[200:203], v[128:131], v[28:31], 0
    s_add_u32 m0, m0, s53
    ds_read_b64_tr_b16 v[120:121], v11 offset:8480
    v_mfma_f32_16x16x32_bf16 v[200:203], v[132:135], v[56:59], v[200:203]
    ds_read_b64_tr_b16 v[122:123], v11 offset:8608
    v_mfma_f32_16x16x32_bf16 v[204:207], v[128:131], v[32:35], 0
    ds_read_b64_tr_b16 v[124:125], v11 offset:8992
    v_mfma_f32_16x16x32_bf16 v[204:207], v[132:135], v[60:63], v[204:207]
    ds_read_b64_tr_b16 v[126:127], v11 offset:9120
    v_mfma_f32_16x16x32_bf16 v[208:211], v[128:131], v[36:39], 0
    v_mfma_f32_16x16x32_bf16 v[208:211], v[132:135], v[64:67], v[208:211]
    s_add_u32 s28, s49, s92
    buffer_load_dwordx4 v26, s[16:19], s28 offen lds
    v_mfma_f32_16x16x32_bf16 v[212:215], v[128:131], v[40:43], 0
    s_add_u32 m0, m0, s53
    v_mfma_f32_16x16x32_bf16 v[212:215], v[132:135], v[68:71], v[212:215]
    v_mfma_f32_16x16x32_bf16 v[216:219], v[128:131], v[44:47], 0
    v_mfma_f32_16x16x32_bf16 v[216:219], v[132:135], v[72:75], v[216:219]
    v_mfma_f32_16x16x32_bf16 v[220:223], v[128:131], v[48:51], 0
    v_mfma_f32_16x16x32_bf16 v[220:223], v[132:135], v[76:79], v[220:223]
    s_add_u32 s28, s49, s93
    buffer_load_dwordx4 v26, s[16:19], s28 offen lds
    v_mfma_f32_16x16x32_bf16 v[224:227], v[128:131], v[52:55], 0
    s_add_u32 m0, m0, s53
    v_mfma_f32_16x16x32_bf16 v[224:227], v[132:135], v[80:83], v[224:227]
    ds_read_b64_tr_b16 v[128:129], v11 offset:8512
    v_mfma_f32_16x16x32_bf16 v[228:231], v[136:139], v[28:31], 0
    ds_read_b64_tr_b16 v[130:131], v11 offset:8640
    v_mfma_f32_16x16x32_bf16 v[228:231], v[140:143], v[56:59], v[228:231]
    ds_read_b64_tr_b16 v[132:133], v11 offset:9024
    v_mfma_f32_16x16x32_bf16 v[232:235], v[136:139], v[32:35], 0
    ds_read_b64_tr_b16 v[134:135], v11 offset:9152
    v_mfma_f32_16x16x32_bf16 v[232:235], v[140:143], v[60:63], v[232:235]
    s_add_u32 s28, s49, s94
    buffer_load_dwordx4 v26, s[16:19], s28 offen lds
    v_mfma_f32_16x16x32_bf16 v[236:239], v[136:139], v[36:39], 0
    s_add_u32 m0, m0, s53
    v_mfma_f32_16x16x32_bf16 v[236:239], v[140:143], v[64:67], v[236:239]
    v_mfma_f32_16x16x32_bf16 v[240:243], v[136:139], v[40:43], 0
    v_mfma_f32_16x16x32_bf16 v[240:243], v[140:143], v[68:71], v[240:243]
    v_mfma_f32_16x16x32_bf16 v[244:247], v[136:139], v[44:47], 0
    v_mfma_f32_16x16x32_bf16 v[244:247], v[140:143], v[72:75], v[244:247]
    s_add_u32 s28, s49, s95
    buffer_load_dwordx4 v26, s[16:19], s28 offen lds
    v_mfma_f32_16x16x32_bf16 v[248:251], v[136:139], v[48:51], 0
    v_mfma_f32_16x16x32_bf16 v[248:251], v[140:143], v[76:79], v[248:251]
    v_mfma_f32_16x16x32_bf16 v[252:255], v[136:139], v[52:55], 0
    v_mfma_f32_16x16x32_bf16 v[252:255], v[140:143], v[80:83], v[252:255]
    ds_read_b64_tr_b16 v[136:137], v11 offset:8544
    ds_read_b64_tr_b16 v[138:139], v11 offset:8672
    ds_read_b64_tr_b16 v[140:141], v11 offset:9056
    ds_read_b64_tr_b16 v[142:143], v11 offset:9184
    s_waitcnt lgkmcnt(8)
    v_mfma_f32_16x16x32_bf16 a[112:115], v[112:115], v[28:31], 0
    s_add_u32 m0, s33, 8448
    v_mfma_f32_16x16x32_bf16 a[112:115], v[116:119], v[56:59], a[112:115]
    s_add_u32 s49, s50, s46
    v_mfma_f32_16x16x32_bf16 a[116:119], v[112:115], v[32:35], 0
    s_lshl1_add_u32 s50, s51, s50
    v_mfma_f32_16x16x32_bf16 a[116:119], v[116:119], v[60:63], a[116:119]
    s_add_u32 s82, s82, 2
    v_mfma_f32_16x16x32_bf16 a[120:123], v[112:115], v[36:39], 0
    s_cmp_eq_u32 s82, 20
    v_mfma_f32_16x16x32_bf16 a[120:123], v[116:119], v[64:67], a[120:123]
    s_cselect_b32 s29, s83, 0
    v_mfma_f32_16x16x32_bf16 a[124:127], v[112:115], v[40:43], 0
    s_sub_u32 s50, s50, s29
    s_cmp_eq_u32 s68, 0
    s_cbranch_scc0 L_bw1_575
    s_waitcnt vmcnt(8) lgkmcnt(0)
L_bw2_575:
    s_barrier
    ds_read_b128 a[0:3], v27 offset:16896
    v_mfma_f32_16x16x32_bf16 a[124:127], v[116:119], v[68:71], a[124:127]
    ds_read_b128 a[4:7], v27 offset:18944
    v_mfma_f32_16x16x32_bf16 a[128:131], v[112:115], v[44:47], 0
    ds_read_b128 a[8:11], v27 offset:20992
    v_mfma_f32_16x16x32_bf16 a[128:131], v[116:119], v[72:75], a[128:131]
    s_add_u32 s28, s49, s88
    buffer_load_dwordx4 v26, s[16:19], s28 offen lds
    v_mfma_f32_16x16x32_bf16 a[132:135], v[112:115], v[48:51], 0
    s_add_u32 m0, m0, s53
    ds_read_b128 a[12:15], v27 offset:23040
    v_mfma_f32_16x16x32_bf16 a[132:135], v[116:119], v[76:79], a[132:135]
    ds_read_b128 a[16:19], v27 offset:25344
    v_mfma_f32_16x16x32_bf16 a[136:139], v[112:115], v[52:55], 0
    ds_read_b128 a[20:23], v27 offset:27392
    v_mfma_f32_16x16x32_bf16 a[136:139], v[116:119], v[80:83], a[136:139]
    ds_read_b128 a[24:27], v27 offset:29440
    v_mfma_f32_16x16x32_bf16 a[140:143], v[120:123], v[28:31], 0
    ds_read_b128 a[28:31], v6 offset:16896
    v_mfma_f32_16x16x32_bf16 a[140:143], v[124:127], v[56:59], a[140:143]
    s_add_u32 s28, s49, s89
    buffer_load_dwordx4 v26, s[16:19], s28 offen lds
    v_mfma_f32_16x16x32_bf16 a[144:147], v[120:123], v[32:35], 0
    s_add_u32 m0, m0, s53
    ds_read_b128 a[32:35], v6 offset:18944
    v_mfma_f32_16x16x32_bf16 a[144:147], v[124:127], v[60:63], a[144:147]
    ds_read_b128 a[36:39], v6 offset:20992
    v_mfma_f32_16x16x32_bf16 a[148:151], v[120:123], v[36:39], 0
    ds_read_b128 a[40:43], v6 offset:23040
    v_mfma_f32_16x16x32_bf16 a[148:151], v[124:127], v[64:67], a[148:151]
    ds_read_b128 a[44:47], v6 offset:25344
    v_mfma_f32_16x16x32_bf16 a[152:155], v[120:123], v[40:43], 0
    ds_read_b128 a[48:51], v6 offset:27392
    v_mfma_f32_16x16x32_bf16 a[152:155], v[124:127], v[68:71], a[152:155]
    s_add_u32 s28, s49, s90
    buffer_load_dwordx4 v26, s[16:19], s28 offen lds
    v_mfma_f32_16x16x32_bf16 a[156:159], v[120:123], v[44:47], 0
    s_add_u32 m0, m0, s53
    ds_read_b128 a[52:55], v6 offset:29440
    v_mfma_f32_16x16x32_bf16 a[156:159], v[124:127], v[72:75], a[156:159]
    ds_read_b64_tr_b16 v[112:113], v11 offset:16896
    v_mfma_f32_16x16x32_bf16 a[160:163], v[120:123], v[48:51], 0
    ds_read_b64_tr_b16 v[114:115], v11 offset:17024
    v_mfma_f32_16x16x32_bf16 a[160:163], v[124:127], v[76:79], a[160:163]
    ds_read_b64_tr_b16 v[116:117], v11 offset:17408
    v_mfma_f32_16x16x32_bf16 a[164:167], v[120:123], v[52:55], 0
    ds_read_b64_tr_b16 v[118:119], v11 offset:17536
    v_mfma_f32_16x16x32_bf16 a[164:167], v[124:127], v[80:83], a[164:167]
    s_add_u32 s28, s49, s91
    buffer_load_dwordx4 v26, s[16:19], s28 offen lds
    v_mfma_f32_16x16x32_bf16 a[168:171], v[128:131], v[28:31], 0
    s_add_u32 m0, m0, s53
    ds_read_b64_tr_b16 v[120:121], v11 offset:16928
    v_mfma_f32_16x16x32_bf16 a[168:171], v[132:135], v[56:59], a[168:171]
    ds_read_b64_tr_b16 v[122:123], v11 offset:17056
    v_mfma_f32_16x16x32_bf16 a[172:175], v[128:131], v[32:35], 0
    ds_read_b64_tr_b16 v[124:125], v11 offset:17440
    v_mfma_f32_16x16x32_bf16 a[172:175], v[132:135], v[60:63], a[172:175]
    ds_read_b64_tr_b16 v[126:127], v11 offset:17568
    v_mfma_f32_16x16x32_bf16 a[176:179], v[128:131], v[36:39], 0
    v_mfma_f32_16x16x32_bf16 a[176:179], v[132:135], v[64:67], a[176:179]
    s_add_u32 s28, s49, s92
    buffer_load_dwordx4 v26, s[16:19], s28 offen lds
    v_mfma_f32_16x16x32_bf16 a[180:183], v[128:131], v[40:43], 0
    s_add_u32 m0, m0, s53
    v_mfma_f32_16x16x32_bf16 a[180:183], v[132:135], v[68:71], a[180:183]
    v_mfma_f32_16x16x32_bf16 a[184:187], v[128:131], v[44:47], 0
    v_mfma_f32_16x16x32_bf16 a[184:187], v[132:135], v[72:75], a[184:187]
    v_mfma_f32_16x16x32_bf16 a[188:191], v[128:131], v[48:51], 0
    v_mfma_f32_16x16x32_bf16 a[188:191], v[132:135], v[76:79], a[188:191]
    s_add_u32 s28, s49, s93
    buffer_load_dwordx4 v26, s[16:19], s28 offen lds
    v_mfma_f32_16x16x32_bf16 a[192:195], v[128:131], v[52:55], 0
    s_add_u32 m0, m0, s53
    v_mfma_f32_16x16x32_bf16 a[192:195], v[132:135], v[80:83], a[192:195]
    ds_read_b64_tr_b16 v[128:129], v11 offset:16960
    v_mfma_f32_16x16x32_bf16 a[196:199], v[136:139], v[28:31], 0
    ds_read_b64_tr_b16 v[130:131], v11 offset:17088
    v_mfma_f32_16x16x32_bf16 a[196:199], v[140:143], v[56:59], a[196:199]
    ds_read_b64_tr_b16 v[132:133], v11 offset:17472
    v_mfma_f32_16x16x32_bf16 a[200:203], v[136:139], v[32:35], 0
    ds_read_b64_tr_b16 v[134:135], v11 offset:17600
    v_mfma_f32_16x16x32_bf16 a[200:203], v[140:143], v[60:63], a[200:203]
    s_add_u32 s28, s49, s47
    buffer_load_dwordx4 v26, s[16:19], s28 offen lds
    v_mfma_f32_16x16x32_bf16 a[204:207], v[136:139], v[36:39], 0
    s_add_u32 m0, m0, s53
    v_mfma_f32_16x16x32_bf16 a[204:207], v[140:143], v[64:67], a[204:207]
    v_mfma_f32_16x16x32_bf16 a[208:211], v[136:139], v[40:43], 0
    v_mfma_f32_16x16x32_bf16 a[208:211], v[140:143], v[68:71], a[208:211]
    v_mfma_f32_16x16x32_bf16 a[212:215], v[136:139], v[44:47], 0
    v_mfma_f32_16x16x32_bf16 a[212:215], v[140:143], v[72:75], a[212:215]
    s_add_u32 s28, s49, s98
    buffer_load_dwordx4 v26, s[16:19], s28 offen lds
    v_mfma_f32_16x16x32_bf16 a[216:219], v[136:139], v[48:51], 0
    v_mfma_f32_16x16x32_bf16 a[216:219], v[140:143], v[76:79], a[216:219]
    v_mfma_f32_16x16x32_bf16 a[220:223], v[136:139], v[52:55], 0
    v_mfma_f32_16x16x32_bf16 a[220:223], v[140:143], v[80:83], a[220:223]
    ds_read_b64_tr_b16 v[136:137], v11 offset:16992
    ds_read_b64_tr_b16 v[138:139], v11 offset:17120
    ds_read_b64_tr_b16 v[140:141], v11 offset:17504
    ds_read_b64_tr_b16 v[142:143], v11 offset:17632
    s_waitcnt lgkmcnt(8)
    v_mfma_f32_16x16x32_bf16 v[144:147], v[112:115], a[0:3], v[144:147]
    s_add_u32 m0, s33, 16896
    v_mfma_f32_16x16x32_bf16 v[144:147], v[116:119], a[28:31], v[144:147]
    s_mov_b32 s49, s50
    v_mfma_f32_16x16x32_bf16 v[148:151], v[112:115], a[4:7], v[148:151]
    v_mfma_f32_16x16x32_bf16 v[148:151], v[116:119], a[32:35], v[148:151]
    v_mfma_f32_16x16x32_bf16 v[152:155], v[112:115], a[8:11], v[152:155]
    v_mfma_f32_16x16x32_bf16 v[152:155], v[116:119], a[36:39], v[152:155]
    v_mfma_f32_16x16x32_bf16 v[156:159], v[112:115], a[12:15], v[156:159]
    s_cmp_eq_u32 s68, 0
    s_cbranch_scc0 L_bw1_692
    s_waitcnt vmcnt(16) lgkmcnt(0)
L_bw2_692:
    s_barrier
    v_mfma_f32_16x16x32_bf16 v[156:159], v[116:119], a[40:43], v[156:159]
    v_mfma_f32_16x16x32_bf16 v[160:163], v[112:115], a[16:19], v[160:163]
    v_mfma_f32_16x16x32_bf16 v[160:163], v[116:119], a[44:47], v[160:163]
    s_add_u32 s28, s49, s88
    buffer_load_dwordx4 v26, s[16:19], s28 offen lds
    v_mfma_f32_16x16x32_bf16 v[164:167], v[112:115], a[20:23], v[164:167]
    s_add_u32 m0, m0, s53
    v_mfma_f32_16x16x32_bf16 v[164:167], v[116:119], a[48:51], v[164:167]
    v_mfma_f32_16x16x32_bf16 v[168:171], v[112:115], a[24:27], v[168:171]
    v_mfma_f32_16x16x32_bf16 v[168:171], v[116:119], a[52:55], v[168:171]
    ds_read_b64_tr_b16 v[112:113], v11 offset:25344
    v_mfma_f32_16x16x32_bf16 v[172:175], v[120:123], a[0:3], v[172:175]
    ds_read_b64_tr_b16 v[114:115], v11 offset:25472
    v_mfma_f32_16x16x32_bf16 v[172:175], v[124:127], a[28:31], v[172:175]
    s_add_u32 s28, s49, s89
    buffer_load_dwordx4 v26, s[16:19], s28 offen lds
    v_mfma_f32_16x16x32_bf16 v[176:179], v[120:123], a[4:7], v[176:179]
    s_add_u32 m0, m0, s53
    ds_read_b64_tr_b16 v[116:117], v11 offset:25856
    v_mfma_f32_16x16x32_bf16 v[176:179], v[124:127], a[32:35], v[176:179]
    ds_read_b64_tr_b16 v[118:119], v11 offset:25984
    v_mfma_f32_16x16x32_bf16 v[180:183], v[120:123], a[8:11], v[180:183]
    v_mfma_f32_16x16x32_bf16 v[180:183], v[124:127], a[36:39], v[180:183]
    v_mfma_f32_16x16x32_bf16 v[184:187], v[120:123], a[12:15], v[184:187]
    v_mfma_f32_16x16x32_bf16 v[184:187], v[124:127], a[40:43], v[184:187]
    s_add_u32 s28, s49, s90
    buffer_load_dwordx4 v26, s[16:19], s28 offen lds
    v_mfma_f32_16x16x32_bf16 v[188:191], v[120:123], a[16:19], v[188:191]
    s_add_u32 m0, m0, s53
    v_mfma_f32_16x16x32_bf16 v[188:191], v[124:127], a[44:47], v[188:191]
    v_mfma_f32_16x16x32_bf16 v[192:195], v[120:123], a[20:23], v[192:195]
    v_mfma_f32_16x16x32_bf16 v[192:195], v[124:127], a[48:51], v[192:195]
    v_mfma_f32_16x16x32_bf16 v[196:199], v[120:123], a[24:27], v[196:199]
    v_mfma_f32_16x16x32_bf16 v[196:199], v[124:127], a[52:55], v[196:199]
    s_add_u32 s28, s49, s91
    buffer_load_dwordx4 v26, s[16:19], s28 offen lds
    v_mfma_f32_16x16x32_bf16 v[200:203], v[128:131], a[0:3], v[200:203]
    s_add_u32 m0, m0, s53
    ds_read_b64_tr_b16 v[120:121], v11 offset:25376
    v_mfma_f32_16x16x32_bf16 v[200:203], v[132:135], a[28:31], v[200:203]
    ds_read_b64_tr_b16 v[122:123], v11 offset:25504
    v_mfma_f32_16x16x32_bf16 v[204:207], v[128:131], a[4:7], v[204:207]
    ds_read_b64_tr_b16 v[124:125], v11 offset:25888
    v_mfma_f32_16x16x32_bf16 v[204:207], v[132:135], a[32:35], v[204:207]
    ds_read_b64_tr_b16 v[126:127], v11 offset:26016
    v_mfma_f32_16x16x32_bf16 v[208:211], v[128:131], a[8:11], v[208:211]
    v_mfma_f32_16x16x32_bf16 v[208:211], v[132:135], a[36:39], v[208:211]
    s_add_u32 s28, s49, s92
    buffer_load_dwordx4 v26, s[16:19], s28 offen lds
    v_mfma_f32_16x16x32_bf16 v[212:215], v[128:131], a[12:15], v[212:215]
    s_add_u32 m0, m0, s53
    v_mfma_f32_16x16x32_bf16 v[212:215], v[132:135], a[40:43], v[212:215]
    v_mfma_f32_16x16x32_bf16 v[216:219], v[128:131], a[16:19], v[216:219]
    v_mfma_f32_16x16x32_bf16 v[216:219], v[132:135], a[44:47], v[216:219]
    v_mfma_f32_16x16x32_bf16 v[220:223], v[128:131], a[20:23], v[220:223]
    v_mfma_f32_16x16x32_bf16 v[220:223], v[132:135], a[48:51], v[220:223]
    s_add_u32 s28, s49, s93
    buffer_load_dwordx4 v26, s[16:19], s28 offen lds
    v_mfma_f32_16x16x32_bf16 v[224:227], v[128:131], a[24:27], v[224:227]
    s_add_u32 m0, m0, s53
    v_mfma_f32_16x16x32_bf16 v[224:227], v[132:135], a[52:55], v[224:227]
    ds_read_b64_tr_b16 v[128:129], v11 offset:25408
    v_mfma_f32_16x16x32_bf16 v[228:231], v[136:139], a[0:3], v[228:231]
    ds_read_b64_tr_b16 v[130:131], v11 offset:25536
    v_mfma_f32_16x16x32_bf16 v[228:231], v[140:143], a[28:31], v[228:231]
    ds_read_b64_tr_b16 v[132:133], v11 offset:25920
    v_mfma_f32_16x16x32_bf16 v[232:235], v[136:139], a[4:7], v[232:235]
    ds_read_b64_tr_b16 v[134:135], v11 offset:26048
    v_mfma_f32_16x16x32_bf16 v[232:235], v[140:143], a[32:35], v[232:235]
    s_add_u32 s28, s49, s94
    buffer_load_dwordx4 v26, s[16:19], s28 offen lds
    v_mfma_f32_16x16x32_bf16 v[236:239], v[136:139], a[8:11], v[236:239]
    s_add_u32 m0, m0, s53
    v_mfma_f32_16x16x32_bf16 v[236:239], v[140:143], a[36:39], v[236:239]
    v_mfma_f32_16x16x32_bf16 v[240:243], v[136:139], a[12:15], v[240:243]
    v_mfma_f32_16x16x32_bf16 v[240:243], v[140:143], a[40:43], v[240:243]
    v_mfma_f32_16x16x32_bf16 v[244:247], v[136:139], a[16:19], v[244:247]
    v_mfma_f32_16x16x32_bf16 v[244:247], v[140:143], a[44:47], v[244:247]
    s_add_u32 s28, s49, s95
    buffer_load_dwordx4 v26, s[16:19], s28 offen lds
    v_mfma_f32_16x16x32_bf16 v[248:251], v[136:139], a[20:23], v[248:251]
    v_mfma_f32_16x16x32_bf16 v[248:251], v[140:143], a[48:51], v[248:251]
    v_mfma_f32_16x16x32_bf16 v[252:255], v[136:139], a[24:27], v[252:255]
    v_mfma_f32_16x16x32_bf16 v[252:255], v[140:143], a[52:55], v[252:255]
    ds_read_b64_tr_b16 v[136:137], v11 offset:25440
    ds_read_b64_tr_b16 v[138:139], v11 offset:25568
    ds_read_b64_tr_b16 v[140:141], v11 offset:25952
    ds_read_b64_tr_b16 v[142:143], v11 offset:26080
    s_waitcnt lgkmcnt(8)
    v_mfma_f32_16x16x32_bf16 a[112:115], v[112:115], a[0:3], a[112:115]
    s_add_u32 m0, s33, 25344
    v_mfma_f32_16x16x32_bf16 a[112:115], v[116:119], a[28:31], a[112:115]
    s_add_u32 s49, s50, s46
    v_mfma_f32_16x16x32_bf16 a[116:119], v[112:115], a[4:7], a[116:119]
    s_lshl1_add_u32 s50, s51, s50
    v_mfma_f32_16x16x32_bf16 a[116:119], v[116:119], a[32:35], a[116:119]
    s_add_u32 s82, s82, 2
    v_mfma_f32_16x16x32_bf16 a[120:123], v[112:115], a[8:11], a[120:123]
    s_cmp_eq_u32 s82, 20
    v_mfma_f32_16x16x32_bf16 a[120:123], v[116:119], a[36:39], a[120:123]
    s_cselect_b32 s29, s83, 0
    v_mfma_f32_16x16x32_bf16 a[124:127], v[112:115], a[12:15], a[124:127]
    s_sub_u32 s50, s50, s29
    s_waitcnt vmcnt(8) lgkmcnt(0)
    s_barrier
    ds_read_b128 v[28:31], v27 offset:0
    v_mfma_f32_16x16x32_bf16 a[124:127], v[116:119], a[40:43], a[124:127]
    ds_read_b128 v[32:35], v27 offset:2048
    v_mfma_f32_16x16x32_bf16 a[128:131], v[112:115], a[16:19], a[128:131]
    ds_read_b128 v[36:39], v27 offset:4096
    v_mfma_f32_16x16x32_bf16 a[128:131], v[116:119], a[44:47], a[128:131]
    s_add_u32 s28, s49, s88
    buffer_load_dwordx4 v26, s[16:19], s28 offen lds
    v_mfma_f32_16x16x32_bf16 a[132:135], v[112:115], a[20:23], a[132:135]
    s_add_u32 m0, m0, s53
    ds_read_b128 v[40:43], v27 offset:6144
    v_mfma_f32_16x16x32_bf16 a[132:135], v[116:119], a[48:51], a[132:135]
    ds_read_b128 v[44:47], v27 offset:8448
    v_mfma_f32_16x16x32_bf16 a[136:139], v[112:115], a[24:27], a[136:139]
    ds_read_b128 v[48:51], v27 offset:10496
    v_mfma_f32_16x16x32_bf16 a[136:139], v[116:119], a[52:55], a[136:139]
    ds_read_b128 v[52:55], v27 offset:12544
    v_mfma_f32_16x16x32_bf16 a[140:143], v[120:123], a[0:3], a[140:143]
    ds_read_b128 v[56:59], v6 offset:0
    v_mfma_f32_16x16x32_bf16 a[140:143], v[124:127], a[28:31], a[140:143]
    s_add_u32 s28, s49, s89
    buffer_load_dwordx4 v26, s[16:19], s28 offen lds
    v_mfma_f32_16x16x32_bf16 a[144:147], v[120:123], a[4:7], a[144:147]
    s_add_u32 m0, m0, s53
    ds_read_b128 v[60:63], v6 offset:2048
    v_mfma_f32_16x16x32_bf16 a[144:147], v[124:127], a[32:35], a[144:147]
    ds_read_b128 v[64:67], v6 offset:4096
    v_mfma_f32_16x16x32_bf16 a[148:151], v[120:123], a[8:11], a[148:151]
    ds_read_b128 v[68:71], v6 offset:6144
    v_mfma_f32_16x16x32_bf16 a[148:151], v[124:127], a[36:39], a[148:151]
    ds_read_b128 v[72:75], v6 offset:8448
    v_mfma_f32_16x16x32_bf16 a[152:155], v[120:123], a[12:15], a[152:155]
    ds_read_b128 v[76:79], v6 offset:10496
    v_mfma_f32_16x16x32_bf16 a[152:155], v[124:127], a[40:43], a[152:155]
    s_add_u32 s28, s49, s90
    buffer_load_dwordx4 v26, s[16:19], s28 offen lds
    v_mfma_f32_16x16x32_bf16 a[156:159], v[120:123], a[16:19], a[156:159]
    s_add_u32 m0, m0, s53
    ds_read_b128 v[80:83], v6 offset:12544
    v_mfma_f32_16x16x32_bf16 a[156:159], v[124:127], a[44:47], a[156:159]
    ds_read_b64_tr_b16 v[112:113], v11 offset:0
    v_mfma_f32_16x16x32_bf16 a[160:163], v[120:123], a[20:23], a[160:163]
    ds_read_b64_tr_b16 v[114:115], v11 offset:128
    v_mfma_f32_16x16x32_bf16 a[160:163], v[124:127], a[48:51], a[160:163]
    ds_read_b64_tr_b16 v[116:117], v11 offset:512
    v_mfma_f32_16x16x32_bf16 a[164:167], v[120:123], a[24:27], a[164:167]
    ds_read_b64_tr_b16 v[118:119], v11 offset:640
    v_mfma_f32_16x16x32_bf16 a[164:167], v[124:127], a[52:55], a[164:167]
    s_add_u32 s28, s49, s91
    buffer_load_dwordx4 v26, s[16:19], s28 offen lds
    v_mfma_f32_16x16x32_bf16 a[168:171], v[128:131], a[0:3], a[168:171]
    s_add_u32 m0, m0, s53
    ds_read_b64_tr_b16 v[120:121], v11 offset:32
    v_mfma_f32_16x16x32_bf16 a[168:171], v[132:135], a[28:31], a[168:171]
    ds_read_b64_tr_b16 v[122:123], v11 offset:160
    v_mfma_f32_16x16x32_bf16 a[172:175], v[128:131], a[4:7], a[172:175]
    ds_read_b64_tr_b16 v[124:125], v11 offset:544
    v_mfma_f32_16x16x32_bf16 a[172:175], v[132:135], a[32:35], a[172:175]
    ds_read_b64_tr_b16 v[126:127], v11 offset:672
    v_mfma_f32_16x16x32_bf16 a[176:179], v[128:131], a[8:11], a[176:179]
    v_mfma_f32_16x16x32_bf16 a[176:179], v[132:135], a[36:39], a[176:179]
    s_add_u32 s28, s49, s92
    buffer_load_dwordx4 v26, s[16:19], s28 offen lds
    v_mfma_f32_16x16x32_bf16 a[180:183], v[128:131], a[12:15], a[180:183]
    s_add_u32 m0, m0, s53
    v_mfma_f32_16x16x32_bf16 a[180:183], v[132:135], a[40:43], a[180:183]
    v_mfma_f32_16x16x32_bf16 a[184:187], v[128:131], a[16:19], a[184:187]
    v_mfma_f32_16x16x32_bf16 a[184:187], v[132:135], a[44:47], a[184:187]
    v_mfma_f32_16x16x32_bf16 a[188:191], v[128:131], a[20:23], a[188:191]
    v_mfma_f32_16x16x32_bf16 a[188:191], v[132:135], a[48:51], a[188:191]
    s_add_u32 s28, s49, s93
    buffer_load_dwordx4 v26, s[16:19], s28 offen lds
    v_mfma_f32_16x16x32_bf16 a[192:195], v[128:131], a[24:27], a[192:195]
    s_add_u32 m0, m0, s53
    v_mfma_f32_16x16x32_bf16 a[192:195], v[132:135], a[52:55], a[192:195]
    ds_read_b64_tr_b16 v[128:129], v11 offset:64
    v_mfma_f32_16x16x32_bf16 a[196:199], v[136:139], a[0:3], a[196:199]
    ds_read_b64_tr_b16 v[130:131], v11 offset:192
    v_mfma_f32_16x16x32_bf16 a[196:199], v[140:143], a[28:31], a[196:199]
    ds_read_b64_tr_b16 v[132:133], v11 offset:576
    v_mfma_f32_16x16x32_bf16 a[200:203], v[136:139], a[4:7], a[200:203]
    ds_read_b64_tr_b16 v[134:135], v11 offset:704
    v_mfma_f32_16x16x32_bf16 a[200:203], v[140:143], a[32:35], a[200:203]
    s_add_u32 s28, s49, s47
    buffer_load_dwordx4 v26, s[16:19], s28 offen lds
    v_mfma_f32_16x16x32_bf16 a[204:207], v[136:139], a[8:11], a[204:207]
    s_add_u32 m0, m0, s53
    v_mfma_f32_16x16x32_bf16 a[204:207], v[140:143], a[36:39], a[204:207]
    v_mfma_f32_16x16x32_bf16 a[208:211], v[136:139], a[12:15], a[208:211]
    v_mfma_f32_16x16x32_bf16 a[208:211], v[140:143], a[40:43], a[208:211]
    v_mfma_f32_16x16x32_bf16 a[212:215], v[136:139], a[16:19], a[212:215]
    v_mfma_f32_16x16x32_bf16 a[212:215], v[140:143], a[44:47], a[212:215]
    s_add_u32 s28, s49, s98
    buffer_load_dwordx4 v26, s[16:19], s28 offen lds
    v_mfma_f32_16x16x32_bf16 a[216:219], v[136:139], a[20:23], a[216:219]
    v_mfma_f32_16x16x32_bf16 a[216:219], v[140:143], a[48:51], a[216:219]
    v_mfma_f32_16x16x32_bf16 a[220:223], v[136:139], a[24:27], a[220:223]
    v_mfma_f32_16x16x32_bf16 a[220:223], v[140:143], a[52:55], a[220:223]
    ds_read_b64_tr_b16 v[136:137], v11 offset:96
    ds_read_b64_tr_b16 v[138:139], v11 offset:224
    ds_read_b64_tr_b16 v[140:141], v11 offset:608
    ds_read_b64_tr_b16 v[142:143], v11 offset:736
    s_mov_b32 s22, 0
L_at_qploop:
    s_waitcnt lgkmcnt(8)
    v_mfma_f32_16x16x32_bf16 v[144:147], v[112:115], v[28:31], v[144:147]
    s_add_u32 m0, s33, 0
    v_mfma_f32_16x16x32_bf16 v[144:147], v[116:119], v[56:59], v[144:147]
    s_mov_b32 s49, s50
    v_mfma_f32_16x16x32_bf16 v[148:151], v[112:115], v[32:35], v[148:151]
    v_mfma_f32_16x16x32_bf16 v[148:151], v[116:119], v[60:63], v[148:151]
    v_mfma_f32_16x16x32_bf16 v[152:155], v[112:115], v[36:39], v[152:155]
    v_mfma_f32_16x16x32_bf16 v[152:155], v[116:119], v[64:67], v[152:155]
    v_mfma_f32_16x16x32_bf16 v[156:159], v[112:115], v[40:43], v[156:159]
    s_waitcnt vmcnt(16) lgkmcnt(0)
    s_barrier
    v_mfma_f32_16x16x32_bf16 v[156:159], v[116:119], v[68:71], v[156:159]
    v_mfma_f32_16x16x32_bf16 v[160:163], v[112:115], v[44:47], v[160:163]
    v_mfma_f32_16x16x32_bf16 v[160:163], v[116:119], v[72:75], v[160:163]
    s_add_u32 s28, s49, s88
    buffer_load_dwordx4 v26, s[16:19], s28 offen lds
    v_mfma_f32_16x16x32_bf16 v[164:167], v[112:115], v[48:51], v[164:167]
    s_add_u32 m0, m0, s53
    v_mfma_f32_16x16x32_bf16 v[164:167], v[116:119], v[76:79], v[164:167]
    v_mfma_f32_16x16x32_bf16 v[168:171], v[112:115], v[52:55], v[168:171]
    v_mfma_f32_16x16x32_bf16 v[168:171], v[116:119], v[80:83], v[168:171]
    ds_read_b64_tr_b16 v[112:113], v11 offset:8448
    v_mfma_f32_16x16x32_bf16 v[172:175], v[120:123], v[28:31], v[172:175]
    ds_read_b64_tr_b16 v[114:115], v11 offset:8576
    v_mfma_f32_16x16x32_bf16 v[172:175], v[124:127], v[56:59], v[172:175]
    s_add_u32 s28, s49, s89
    buffer_load_dwordx4 v26, s[16:19], s28 offen lds
    v_mfma_f32_16x16x32_bf16 v[176:179], v[120:123], v[32:35], v[176:179]
    s_add_u32 m0, m0, s53
    ds_read_b64_tr_b16 v[116:117], v11 offset:8960
    v_mfma_f32_16x16x32_bf16 v[176:179], v[124:127], v[60:63], v[176:179]
    ds_read_b64_tr_b16 v[118:119], v11 offset:9088
    v_mfma_f32_16x16x32_bf16 v[180:183], v[120:123], v[36:39], v[180:183]
    v_mfma_f32_16x16x32_bf16 v[180:183], v[124:127], v[64:67], v[180:183]
    v_mfma_f32_16x16x32_bf16 v[184:187], v[120:123], v[40:43], v[184:187]
    v_mfma_f32_16x16x32_bf16 v[184:187], v[124:127], v[68:71], v[184:187]
    s_add_u32 s28, s49, s90
    buffer_load_dwordx4 v26, s[16:19], s28 offen lds
    v_mfma_f32_16x16x32_bf16 v[188:191], v[120:123], v[44:47], v[188:191]
    s_add_u32 m0, m0, s53
    v_mfma_f32_16x16x32_bf16 v[188:191], v[124:127], v[72:75], v[188:191]
    v_mfma_f32_16x16x32_bf16 v[192:195], v[120:123], v[48:51], v[192:195]
    v_mfma_f32_16x16x32_bf16 v[192:195], v[124:127], v[76:79], v[192:195]
    v_mfma_f32_16x16x32_bf16 v[196:199], v[120:123], v[52:55], v[196:199]
    v_mfma_f32_16x16x32_bf16 v[196:199], v[124:127], v[80:83], v[196:199]
    s_add_u32 s28, s49, s91
    buffer_load_dwordx4 v26, s[16:19], s28 offen lds
    v_mfma_f32_16x16x32_bf16 v[200:203], v[128:131], v[28:31], v[200:203]
    s_add_u32 m0, m0, s53
    ds_read_b64_tr_b16 v[120:121], v11 offset:8480
    v_mfma_f32_16x16x32_bf16 v[200:203], v[132:135], v[56:59], v[200:203]
    ds_read_b64_tr_b16 v[122:123], v11 offset:8608
    v_mfma_f32_16x16x32_bf16 v[204:207], v[128:131], v[32:35], v[204:207]
    ds_read_b64_tr_b16 v[124:125], v11 offset:8992
    v_mfma_f32_16x16x32_bf16 v[204:207], v[132:135], v[60:63], v[204:207]
    ds_read_b64_tr_b16 v[126:127], v11 offset:9120
    v_mfma_f32_16x16x32_bf16 v[208:211], v[128:131], v[36:39], v[208:211]
    v_mfma_f32_16x16x32_bf16 v[208:211], v[132:135], v[64:67], v[208:211]
    s_add_u32 s28, s49, s92
    buffer_load_dwordx4 v26, s[16:19], s28 offen lds
    v_mfma_f32_16x16x32_bf16 v[212:215], v[128:131], v[40:43], v[212:215]
    s_add_u32 m0, m0, s53
    v_mfma_f32_16x16x32_bf16 v[212:215], v[132:135], v[68:71], v[212:215]
    v_mfma_f32_16x16x32_bf16 v[216:219], v[128:131], v[44:47], v[216:219]
    v_mfma_f32_16x16x32_bf16 v[216:219], v[132:135], v[72:75], v[216:219]
    v_mfma_f32_16x16x32_bf16 v[220:223], v[128:131], v[48:51], v[220:223]
    v_mfma_f32_16x16x32_bf16 v[220:223], v[132:135], v[76:79], v[220:223]
    s_add_u32 s28, s49, s93
    buffer_load_dwordx4 v26, s[16:19], s28 offen lds
    v_mfma_f32_16x16x32_bf16 v[224:227], v[128:131], v[52:55], v[224:227]
    s_add_u32 m0, m0, s53
    v_mfma_f32_16x16x32_bf16 v[224:227], v[132:135], v[80:83], v[224:227]
    ds_read_b64_tr_b16 v[128:129], v11 offset:8512
    v_mfma_f32_16x16x32_bf16 v[228:231], v[136:139], v[28:31], v[228:231]
    ds_read_b64_tr_b16 v[130:131], v11 offset:8640
    v_mfma_f32_16x16x32_bf16 v[228:231], v[140:143], v[56:59], v[228:231]
    ds_read_b64_tr_b16 v[132:133], v11 offset:9024
    v_mfma_f32_16x16x32_bf16 v[232:235], v[136:139], v[32:35], v[232:235]
    ds_read_b64_tr_b16 v[134:135], v11 offset:9152
    v_mfma_f32_16x16x32_bf16 v[232:235], v[140:143], v[60:63], v[232:235]
    s_add_u32 s28, s49, s94
    buffer_load_dwordx4 v26, s[16:19], s28 offen lds
    v_mfma_f32_16x16x32_bf16 v[236:239], v[136:139], v[36:39], v[236:239]
    s_add_u32 m0, m0, s53
    v_mfma_f32_16x16x32_bf16 v[236:239], v[140:143], v[64:67], v[236:239]
    v_mfma_f32_16x16x32_bf16 v[240:243], v[136:139], v[40:43], v[240:243]
    v_mfma_f32_16x16x32_bf16 v[240:243], v[140:143], v[68:71], v[240:243]
    v_mfma_f32_16x16x32_bf16 v[244:247], v[136:139], v[44:47], v[244:247]
    v_mfma_f32_16x16x32_bf16 v[244:247], v[140:143], v[72:75], v[244:247]
    s_add_u32 s28, s49, s95
    buffer_load_dwordx4 v26, s[16:19], s28 offen lds
    v_mfma_f32_16x16x32_bf16 v[248:251], v[136:139], v[48:51], v[248:251]
    v_mfma_f32_16x16x32_bf16 v[248:251], v[140:143], v[76:79], v[248:251]
    v_mfma_f32_16x16x32_bf16 v[252:255], v[136:139], v[52:55], v[252:255]
    v_mfma_f32_16x16x32_bf16 v[252:255], v[140:143], v[80:83], v[252:255]
    ds_read_b64_tr_b16 v[136:137], v11 offset:8544
    ds_read_b64_tr_b16 v[138:139], v11 offset:8672
    ds_read_b64_tr_b16 v[140:141], v11 offset:9056
    ds_read_b64_tr_b16 v[142:143], v11 offset:9184
    s_waitcnt lgkmcnt(8)
    v_mfma_f32_16x16x32_bf16 a[112:115], v[112:115], v[28:31], a[112:115]
    s_add_u32 m0, s33, 8448
    v_mfma_f32_16x16x32_bf16 a[112:115], v[116:119], v[56:59], a[112:115]
    s_add_u32 s49, s50, s46
    v_mfma_f32_16x16x32_bf16 a[116:119], v[112:115], v[32:35], a[116:119]
    s_lshl1_add_u32 s50, s51, s50
    v_mfma_f32_16x16x32_bf16 a[116:119], v[116:119], v[60:63], a[116:119]
    s_add_u32 s82, s82, 2
    v_mfma_f32_16x16x32_bf16 a[120:123], v[112:115], v[36:39], a[120:123]
    s_cmp_eq_u32 s82, 20
    v_mfma_f32_16x16x32_bf16 a[120:123], v[116:119], v[64:67], a[120:123]
    s_cselect_b32 s29, s83, 0
    v_mfma_f32_16x16x32_bf16 a[124:127], v[112:115], v[40:43], a[124:127]
    s_sub_u32 s50, s50, s29
    s_waitcnt vmcnt(8) lgkmcnt(0)
    s_barrier
    ds_read_b128 a[0:3], v27 offset:16896
    v_mfma_f32_16x16x32_bf16 a[124:127], v[116:119], v[68:71], a[124:127]
    ds_read_b128 a[4:7], v27 offset:18944
    v_mfma_f32_16x16x32_bf16 a[128:131], v[112:115], v[44:47], a[128:131]
    ds_read_b128 a[8:11], v27 offset:20992
    v_mfma_f32_16x16x32_bf16 a[128:131], v[116:119], v[72:75], a[128:131]
    s_add_u32 s28, s49, s88
    buffer_load_dwordx4 v26, s[16:19], s28 offen lds
    v_mfma_f32_16x16x32_bf16 a[132:135], v[112:115], v[48:51], a[132:135]
    s_add_u32 m0, m0, s53
    ds_read_b128 a[12:15], v27 offset:23040
    v_mfma_f32_16x16x32_bf16 a[132:135], v[116:119], v[76:79], a[132:135]
    ds_read_b128 a[16:19], v27 offset:25344
    v_mfma_f32_16x16x32_bf16 a[136:139], v[112:115], v[52:55], a[136:139]
    ds_read_b128 a[20:23], v27 offset:27392
    v_mfma_f32_16x16x32_bf16 a[136:139], v[116:119], v[80:83], a[136:139]
    ds_read_b128 a[24:27], v27 offset:29440
    v_mfma_f32_16x16x32_bf16 a[140:143], v[120:123], v[28:31], a[140:143]
    ds_read_b128 a[28:31], v6 offset:16896
    v_mfma_f32_16x16x32_bf16 a[140:143], v[124:127], v[56:59], a[140:143]
    s_add_u32 s28, s49, s89
    buffer_load_dwordx4 v26, s[16:19], s28 offen lds
    v_mfma_f32_16x16x32_bf16 a[144:147], v[120:123], v[32:35], a[144:147]
    s_add_u32 m0, m0, s53
    ds_read_b128 a[32:35], v6 offset:18944
    v_mfma_f32_16x16x32_bf16 a[144:147], v[124:127], v[60:63], a[144:147]
    ds_read_b128 a[36:39], v6 offset:20992
    v_mfma_f32_16x16x32_bf16 a[148:151], v[120:123], v[36:39], a[148:151]
    ds_read_b128 a[40:43], v6 offset:23040
    v_mfma_f32_16x16x32_bf16 a[148:151], v[124:127], v[64:67], a[148:151]
    ds_read_b128 a[44:47], v6 offset:25344
    v_mfma_f32_16x16x32_bf16 a[152:155], v[120:123], v[40:43], a[152:155]
    ds_read_b128 a[48:51], v6 offset:27392
    v_mfma_f32_16x16x32_bf16 a[152:155], v[124:127], v[68:71], a[152:155]
    s_add_u32 s28, s49, s90
    buffer_load_dwordx4 v26, s[16:19], s28 offen lds
    v_mfma_f32_16x16x32_bf16 a[156:159], v[120:123], v[44:47], a[156:159]
    s_add_u32 m0, m0, s53
    ds_read_b128 a[52:55], v6 offset:29440
    v_mfma_f32_16x16x32_bf16 a[156:159], v[124:127], v[72:75], a[156:159]
    ds_read_b64_tr_b16 v[112:113], v11 offset:16896
    v_mfma_f32_16x16x32_bf16 a[160:163], v[120:123], v[48:51], a[160:163]
    ds_read_b64_tr_b16 v[114:115], v11 offset:17024
    v_mfma_f32_16x16x32_bf16 a[160:163], v[124:127], v[76:79], a[160:163]
    ds_read_b64_tr_b16 v[116:117], v11 offset:17408
    v_mfma_f32_16x16x32_bf16 a[164:167], v[120:123], v[52:55], a[164:167]
    ds_read_b64_tr_b16 v[118:119], v11 offset:17536
    v_mfma_f32_16x16x32_bf16 a[164:167], v[124:127], v[80:83], a[164:167]
    s_add_u32 s28, s49, s91
    buffer_load_dwordx4 v26, s[16:19], s28 offen lds
    v_mfma_f32_16x16x32_bf16 a[168:171], v[128:131], v[28:31], a[168:171]
    s_add_u32 m0, m0, s53
    ds_read_b64_tr_b16 v[120:121], v11 offset:16928
    v_mfma_f32_16x16x32_bf16 a[168:171], v[132:135], v[56:59], a[168:171]
    ds_read_b64_tr_b16 v[122:123], v11 offset:17056
    v_mfma_f32_16x16x32_bf16 a[172:175], v[128:131], v[32:35], a[172:175]
    ds_read_b64_tr_b16 v[124:125], v11 offset:17440
    v_mfma_f32_16x16x32_bf16 a[172:175], v[132:135], v[60:63], a[172:175]
    ds_read_b64_tr_b16 v[126:127], v11 offset:17568
    v_mfma_f32_16x16x32_bf16 a[176:179], v[128:131], v[36:39], a[176:179]
    v_mfma_f32_16x16x32_bf16 a[176:179], v[132:135], v[64:67], a[176:179]
    s_add_u32 s28, s49, s92
    buffer_load_dwordx4 v26, s[16:19], s28 offen lds
    v_mfma_f32_16x16x32_bf16 a[180:183], v[128:131], v[40:43], a[180:183]
    s_add_u32 m0, m0, s53
    v_mfma_f32_16x16x32_bf16 a[180:183], v[132:135], v[68:71], a[180:183]
    v_mfma_f32_16x16x32_bf16 a[184:187], v[128:131], v[44:47], a[184:187]
    v_mfma_f32_16x16x32_bf16 a[184:187], v[132:135], v[72:75], a[184:187]
    v_mfma_f32_16x16x32_bf16 a[188:191], v[128:131], v[48:51], a[188:191]
    v_mfma_f32_16x16x32_bf16 a[188:191], v[132:135], v[76:79], a[188:191]
    s_add_u32 s28, s49, s93
    buffer_load_dwordx4 v26, s[16:19], s28 offen lds
    v_mfma_f32_16x16x32_bf16 a[192:195], v[128:131], v[52:55], a[192:195]
    s_add_u32 m0, m0, s53
    v_mfma_f32_16x16x32_bf16 a[192:195], v[132:135], v[80:83], a[192:195]
    ds_read_b64_tr_b16 v[128:129], v11 offset:16960
    v_mfma_f32_16x16x32_bf16 a[196:199], v[136:139], v[28:31], a[196:199]
    ds_read_b64_tr_b16 v[130:131], v11 offset:17088
    v_mfma_f32_16x16x32_bf16 a[196:199], v[140:143], v[56:59], a[196:199]
    ds_read_b64_tr_b16 v[132:133], v11 offset:17472
    v_mfma_f32_16x16x32_bf16 a[200:203], v[136:139], v[32:35], a[200:203]
    ds_read_b64_tr_b16 v[134:135], v11 offset:17600
    v_mfma_f32_16x16x32_bf16 a[200:203], v[140:143], v[60:63], a[200:203]
    s_add_u32 s28, s49, s47
    buffer_load_dwordx4 v26, s[16:19], s28 offen lds
    v_mfma_f32_16x16x32_bf16 a[204:207], v[136:139], v[36:39], a[204:207]
    s_add_u32 m0, m0, s53
    v_mfma_f32_16x16x32_bf16 a[204:207], v[140:143], v[64:67], a[204:207]
    v_mfma_f32_16x16x32_bf16 a[208:211], v[136:139], v[40:43], a[208:211]
    v_mfma_f32_16x16x32_bf16 a[208:211], v[140:143], v[68:71], a[208:211]
    v_mfma_f32_16x16x32_bf16 a[212:215], v[136:139], v[44:47], a[212:215]
    v_mfma_f32_16x16x32_bf16 a[212:215], v[140:143], v[72:75], a[212:215]
    s_add_u32 s28, s49, s98
    buffer_load_dwordx4 v26, s[16:19], s28 offen lds
    v_mfma_f32_16x16x32_bf16 a[216:219], v[136:139], v[48:51], a[216:219]
    v_mfma_f32_16x16x32_bf16 a[216:219], v[140:143], v[76:79], a[216:219]
    v_mfma_f32_16x16x32_bf16 a[220:223], v[136:139], v[52:55], a[220:223]
    v_mfma_f32_16x16x32_bf16 a[220:223], v[140:143], v[80:83], a[220:223]
    ds_read_b64_tr_b16 v[136:137], v11 offset:16992
    ds_read_b64_tr_b16 v[138:139], v11 offset:17120
    ds_read_b64_tr_b16 v[140:141], v11 offset:17504
    ds_read_b64_tr_b16 v[142:143], v11 offset:17632
    s_waitcnt lgkmcnt(8)
    v_mfma_f32_16x16x32_bf16 v[144:147], v[112:115], a[0:3], v[144:147]
    s_add_u32 m0, s33, 16896
    v_mfma_f32_16x16x32_bf16 v[144:147], v[116:119], a[28:31], v[144:147]
    s_mov_b32 s49, s50
    v_mfma_f32_16x16x32_bf16 v[148:151], v[112:115], a[4:7], v[148:151]
    v_mfma_f32_16x16x32_bf16 v[148:151], v[116:119], a[32:35], v[148:151]
    v_mfma_f32_16x16x32_bf16 v[152:155], v[112:115], a[8:11], v[152:155]
    v_mfma_f32_16x16x32_bf16 v[152:155], v[116:119], a[36:39], v[152:155]
    v_mfma_f32_16x16x32_bf16 v[156:159], v[112:115], a[12:15], v[156:159]
    s_waitcnt vmcnt(16) lgkmcnt(0)
    s_barrier
    v_mfma_f32_16x16x32_bf16 v[156:159], v[116:119], a[40:43], v[156:159]
    v_mfma_f32_16x16x32_bf16 v[160:163], v[112:115], a[16:19], v[160:163]
    v_mfma_f32_16x16x32_bf16 v[160:163], v[116:119], a[44:47], v[160:163]
    s_add_u32 s28, s49, s88
    buffer_load_dwordx4 v26, s[16:19], s28 offen lds
    v_mfma_f32_16x16x32_bf16 v[164:167], v[112:115], a[20:23], v[164:167]
    s_add_u32 m0, m0, s53
    v_mfma_f32_16x16x32_bf16 v[164:167], v[116:119], a[48:51], v[164:167]
    v_mfma_f32_16x16x32_bf16 v[168:171], v[112:115], a[24:27], v[168:171]
    v_mfma_f32_16x16x32_bf16 v[168:171], v[116:119], a[52:55], v[168:171]
    ds_read_b64_tr_b16 v[112:113], v11 offset:25344
    v_mfma_f32_16x16x32_bf16 v[172:175], v[120:123], a[0:3], v[172:175]
    ds_read_b64_tr_b16 v[114:115], v11 offset:25472
    v_mfma_f32_16x16x32_bf16 v[172:175], v[124:127], a[28:31], v[172:175]
    s_add_u32 s28, s49, s89
    buffer_load_dwordx4 v26, s[16:19], s28 offen lds
    v_mfma_f32_16x16x32_bf16 v[176:179], v[120:123], a[4:7], v[176:179]
    s_add_u32 m0, m0, s53
    ds_read_b64_tr_b16 v[116:117], v11 offset:25856
    v_mfma_f32_16x16x32_bf16 v[176:179], v[124:127], a[32:35], v[176:179]
    ds_read_b64_tr_b16 v[118:119], v11 offset:25984
    v_mfma_f32_16x16x32_bf16 v[180:183], v[120:123], a[8:11], v[180:183]
    v_mfma_f32_16x16x32_bf16 v[180:183], v[124:127], a[36:39], v[180:183]
    v_mfma_f32_16x16x32_bf16 v[184:187], v[120:123], a[12:15], v[184:187]
    v_mfma_f32_16x16x32_bf16 v[184:187], v[124:127], a[40:43], v[184:187]
    s_add_u32 s28, s49, s90
    buffer_load_dwordx4 v26, s[16:19], s28 offen lds
    v_mfma_f32_16x16x32_bf16 v[188:191], v[120:123], a[16:19], v[188:191]
    s_add_u32 m0, m0, s53
    v_mfma_f32_16x16x32_bf16 v[188:191], v[124:127], a[44:47], v[188:191]
    v_mfma_f32_16x16x32_bf16 v[192:195], v[120:123], a[20:23], v[192:195]
    v_mfma_f32_16x16x32_bf16 v[192:195], v[124:127], a[48:51], v[192:195]
    v_mfma_f32_16x16x32_bf16 v[196:199], v[120:123], a[24:27], v[196:199]
    v_mfma_f32_16x16x32_bf16 v[196:199], v[124:127], a[52:55], v[196:199]
    s_add_u32 s28, s49, s91
    buffer_load_dwordx4 v26, s[16:19], s28 offen lds
    v_mfma_f32_16x16x32_bf16 v[200:203], v[128:131], a[0:3], v[200:203]
    s_add_u32 m0, m0, s53
    ds_read_b64_tr_b16 v[120:121], v11 offset:25376
    v_mfma_f32_16x16x32_bf16 v[200:203], v[132:135], a[28:31], v[200:203]
    ds_read_b64_tr_b16 v[122:123], v11 offset:25504
    v_mfma_f32_16x16x32_bf16 v[204:207], v[128:131], a[4:7], v[204:207]
    ds_read_b64_tr_b16 v[124:125], v11 offset:25888
    v_mfma_f32_16x16x32_bf16 v[204:207], v[132:135], a[32:35], v[204:207]
    ds_read_b64_tr_b16 v[126:127], v11 offset:26016
    v_mfma_f32_16x16x32_bf16 v[208:211], v[128:131], a[8:11], v[208:211]
    v_mfma_f32_16x16x32_bf16 v[208:211], v[132:135], a[36:39], v[208:211]
    s_add_u32 s28, s49, s92
    buffer_load_dwordx4 v26, s[16:19], s28 offen lds
    v_mfma_f32_16x16x32_bf16 v[212:215], v[128:131], a[12:15], v[212:215]
    s_add_u32 m0, m0, s53
    v_mfma_f32_16x16x32_bf16 v[212:215], v[132:135], a[40:43], v[212:215]
    v_mfma_f32_16x16x32_bf16 v[216:219], v[128:131], a[16:19], v[216:219]
    v_mfma_f32_16x16x32_bf16 v[216:219], v[132:135], a[44:47], v[216:219]
    v_mfma_f32_16x16x32_bf16 v[220:223], v[128:131], a[20:23], v[220:223]
    v_mfma_f32_16x16x32_bf16 v[220:223], v[132:135], a[48:51], v[220:223]
    s_add_u32 s28, s49, s93
    buffer_load_dwordx4 v26, s[16:19], s28 offen lds
    v_mfma_f32_16x16x32_bf16 v[224:227], v[128:131], a[24:27], v[224:227]
    s_add_u32 m0, m0, s53
    v_mfma_f32_16x16x32_bf16 v[224:227], v[132:135], a[52:55], v[224:227]
    ds_read_b64_tr_b16 v[128:129], v11 offset:25408
    v_mfma_f32_16x16x32_bf16 v[228:231], v[136:139], a[0:3], v[228:231]
    ds_read_b64_tr_b16 v[130:131], v11 offset:25536
    v_mfma_f32_16x16x32_bf16 v[228:231], v[140:143], a[28:31], v[228:231]
    ds_read_b64_tr_b16 v[132:133], v11 offset:25920
    v_mfma_f32_16x16x32_bf16 v[232:235], v[136:139], a[4:7], v[232:235]
    ds_read_b64_tr_b16 v[134:135], v11 offset:26048
    v_mfma_f32_16x16x32_bf16 v[232:235], v[140:143], a[32:35], v[232:235]
    s_add_u32 s28, s49, s94
    buffer_load_dwordx4 v26, s[16:19], s28 offen lds
    v_mfma_f32_16x16x32_bf16 v[236:239], v[136:139], a[8:11], v[236:239]
    s_add_u32 m0, m0, s53
    v_mfma_f32_16x16x32_bf16 v[236:239], v[140:143], a[36:39], v[236:239]
    v_mfma_f32_16x16x32_bf16 v[240:243], v[136:139], a[12:15], v[240:243]
    v_mfma_f32_16x16x32_bf16 v[240:243], v[140:143], a[40:43], v[240:243]
    v_mfma_f32_16x16x32_bf16 v[244:247], v[136:139], a[16:19], v[244:247]
    v_mfma_f32_16x16x32_bf16 v[244:247], v[140:143], a[44:47], v[244:247]
    s_add_u32 s28, s49, s95
    buffer_load_dwordx4 v26, s[16:19], s28 offen lds
    v_mfma_f32_16x16x32_bf16 v[248:251], v[136:139], a[20:23], v[248:251]
    v_mfma_f32_16x16x32_bf16 v[248:251], v[140:143], a[48:51], v[248:251]
    v_mfma_f32_16x16x32_bf16 v[252:255], v[136:139], a[24:27], v[252:255]
    v_mfma_f32_16x16x32_bf16 v[252:255], v[140:143], a[52:55], v[252:255]
    ds_read_b64_tr_b16 v[136:137], v11 offset:25440
    ds_read_b64_tr_b16 v[138:139], v11 offset:25568
    ds_read_b64_tr_b16 v[140:141], v11 offset:25952
    ds_read_b64_tr_b16 v[142:143], v11 offset:26080
    s_waitcnt lgkmcnt(8)
    v_mfma_f32_16x16x32_bf16 a[112:115], v[112:115], a[0:3], a[112:115]
    s_add_u32 m0, s33, 25344
    v_mfma_f32_16x16x32_bf16 a[112:115], v[116:119], a[28:31], a[112:115]
    s_add_u32 s49, s50, s46
    v_mfma_f32_16x16x32_bf16 a[116:119], v[112:115], a[4:7], a[116:119]
    s_lshl1_add_u32 s50, s51, s50
    v_mfma_f32_16x16x32_bf16 a[116:119], v[116:119], a[32:35], a[116:119]
    s_add_u32 s82, s82, 2
    v_mfma_f32_16x16x32_bf16 a[120:123], v[112:115], a[8:11], a[120:123]
    s_cmp_eq_u32 s82, 20
    v_mfma_f32_16x16x32_bf16 a[120:123], v[116:119], a[36:39], a[120:123]
    s_cselect_b32 s29, s83, 0
    v_mfma_f32_16x16x32_bf16 a[124:127], v[112:115], a[12:15], a[124:127]
    s_sub_u32 s50, s50, s29
    s_waitcnt vmcnt(8) lgkmcnt(0)
    s_barrier
    ds_read_b128 v[28:31], v27 offset:0
    v_mfma_f32_16x16x32_bf16 a[124:127], v[116:119], a[40:43], a[124:127]
    ds_read_b128 v[32:35], v27 offset:2048
    v_mfma_f32_16x16x32_bf16 a[128:131], v[112:115], a[16:19], a[128:131]
    ds_read_b128 v[36:39], v27 offset:4096
    v_mfma_f32_16x16x32_bf16 a[128:131], v[116:119], a[44:47], a[128:131]
    s_add_u32 s28, s49, s88
    buffer_load_dwordx4 v26, s[16:19], s28 offen lds
    v_mfma_f32_16x16x32_bf16 a[132:135], v[112:115], a[20:23], a[132:135]
    s_add_u32 m0, m0, s53
    ds_read_b128 v[40:43], v27 offset:6144
    v_mfma_f32_16x16x32_bf16 a[132:135], v[116:119], a[48:51], a[132:135]
    ds_read_b128 v[44:47], v27 offset:8448
    v_mfma_f32_16x16x32_bf16 a[136:139], v[112:115], a[24:27], a[136:139]
    ds_read_b128 v[48:51], v27 offset:10496
    v_mfma_f32_16x16x32_bf16 a[136:139], v[116:119], a[52:55], a[136:139]
    ds_read_b128 v[52:55], v27 offset:12544
    v_mfma_f32_16x16x32_bf16 a[140:143], v[120:123], a[0:3], a[140:143]
    ds_read_b128 v[56:59], v6 offset:0
    v_mfma_f32_16x16x32_bf16 a[140:143], v[124:127], a[28:31], a[140:143]
    s_add_u32 s28, s49, s89
    buffer_load_dwordx4 v26, s[16:19], s28 offen lds
    v_mfma_f32_16x16x32_bf16 a[144:147], v[120:123], a[4:7], a[144:147]
    s_add_u32 m0, m0, s53
    ds_read_b128 v[60:63], v6 offset:2048
    v_mfma_f32_16x16x32_bf16 a[144:147], v[124:127], a[32:35], a[144:147]
    ds_read_b128 v[64:67], v6 offset:4096
    v_mfma_f32_16x16x32_bf16 a[148:151], v[120:123], a[8:11], a[148:151]
    ds_read_b128 v[68:71], v6 offset:6144
    v_mfma_f32_16x16x32_bf16 a[148:151], v[124:127], a[36:39], a[148:151]
    ds_read_b128 v[72:75], v6 offset:8448
    v_mfma_f32_16x16x32_bf16 a[152:155], v[120:123], a[12:15], a[152:155]
    ds_read_b128 v[76:79], v6 offset:10496
    v_mfma_f32_16x16x32_bf16 a[152:155], v[124:127], a[40:43], a[152:155]
    s_add_u32 s28, s49, s90
    buffer_load_dwordx4 v26, s[16:19], s28 offen lds
    v_mfma_f32_16x16x32_bf16 a[156:159], v[120:123], a[16:19], a[156:159]
    s_add_u32 m0, m0, s53
    ds_read_b128 v[80:83], v6 offset:12544
    v_mfma_f32_16x16x32_bf16 a[156:159], v[124:127], a[44:47], a[156:159]
    ds_read_b64_tr_b16 v[112:113], v11 offset:0
    v_mfma_f32_16x16x32_bf16 a[160:163], v[120:123], a[20:23], a[160:163]
    ds_read_b64_tr_b16 v[114:115], v11 offset:128
    v_mfma_f32_16x16x32_bf16 a[160:163], v[124:127], a[48:51], a[160:163]
    ds_read_b64_tr_b16 v[116:117], v11 offset:512
    v_mfma_f32_16x16x32_bf16 a[164:167], v[120:123], a[24:27], a[164:167]
    ds_read_b64_tr_b16 v[118:119], v11 offset:640
    v_mfma_f32_16x16x32_bf16 a[164:167], v[124:127], a[52:55], a[164:167]
    s_add_u32 s28, s49, s91
    buffer_load_dwordx4 v26, s[16:19], s28 offen lds
    v_mfma_f32_16x16x32_bf16 a[168:171], v[128:131], a[0:3], a[168:171]
    s_add_u32 m0, m0, s53
    ds_read_b64_tr_b16 v[120:121], v11 offset:32
    v_mfma_f32_16x16x32_bf16 a[168:171], v[132:135], a[28:31], a[168:171]
    ds_read_b64_tr_b16 v[122:123], v11 offset:160
    v_mfma_f32_16x16x32_bf16 a[172:175], v[128:131], a[4:7], a[172:175]
    ds_read_b64_tr_b16 v[124:125], v11 offset:544
    v_mfma_f32_16x16x32_bf16 a[172:175], v[132:135], a[32:35], a[172:175]
    ds_read_b64_tr_b16 v[126:127], v11 offset:672
    v_mfma_f32_16x16x32_bf16 a[176:179], v[128:131], a[8:11], a[176:179]
    v_mfma_f32_16x16x32_bf16 a[176:179], v[132:135], a[36:39], a[176:179]
    s_add_u32 s28, s49, s92
    buffer_load_dwordx4 v26, s[16:19], s28 offen lds
    v_mfma_f32_16x16x32_bf16 a[180:183], v[128:131], a[12:15], a[180:183]
    s_add_u32 m0, m0, s53
    v_mfma_f32_16x16x32_bf16 a[180:183], v[132:135], a[40:43], a[180:183]
    v_mfma_f32_16x16x32_bf16 a[184:187], v[128:131], a[16:19], a[184:187]
    v_mfma_f32_16x16x32_bf16 a[184:187], v[132:135], a[44:47], a[184:187]
    v_mfma_f32_16x16x32_bf16 a[188:191], v[128:131], a[20:23], a[188:191]
    v_mfma_f32_16x16x32_bf16 a[188:191], v[132:135], a[48:51], a[188:191]
    s_add_u32 s28, s49, s93
    buffer_load_dwordx4 v26, s[16:19], s28 offen lds
    v_mfma_f32_16x16x32_bf16 a[192:195], v[128:131], a[24:27], a[192:195]
    s_add_u32 m0, m0, s53
    v_mfma_f32_16x16x32_bf16 a[192:195], v[132:135], a[52:55], a[192:195]
    ds_read_b64_tr_b16 v[128:129], v11 offset:64
    v_mfma_f32_16x16x32_bf16 a[196:199], v[136:139], a[0:3], a[196:199]
    ds_read_b64_tr_b16 v[130:131], v11 offset:192
    v_mfma_f32_16x16x32_bf16 a[196:199], v[140:143], a[28:31], a[196:199]
    ds_read_b64_tr_b16 v[132:133], v11 offset:576
    v_mfma_f32_16x16x32_bf16 a[200:203], v[136:139], a[4:7], a[200:203]
    ds_read_b64_tr_b16 v[134:135], v11 offset:704
    v_mfma_f32_16x16x32_bf16 a[200:203], v[140:143], a[32:35], a[200:203]
    s_add_u32 s28, s49, s47
    buffer_load_dwordx4 v26, s[16:19], s28 offen lds
    v_mfma_f32_16x16x32_bf16 a[204:207], v[136:139], a[8:11], a[204:207]
    s_add_u32 m0, m0, s53
    v_mfma_f32_16x16x32_bf16 a[204:207], v[140:143], a[36:39], a[204:207]
    v_mfma_f32_16x16x32_bf16 a[208:211], v[136:139], a[12:15], a[208:211]
    v_mfma_f32_16x16x32_bf16 a[208:211], v[140:143], a[40:43], a[208:211]
    v_mfma_f32_16x16x32_bf16 a[212:215], v[136:139], a[16:19], a[212:215]
    v_mfma_f32_16x16x32_bf16 a[212:215], v[140:143], a[44:47], a[212:215]
    s_add_u32 s28, s49, s98
    buffer_load_dwordx4 v26, s[16:19], s28 offen lds
    v_mfma_f32_16x16x32_bf16 a[216:219], v[136:139], a[20:23], a[216:219]
    v_mfma_f32_16x16x32_bf16 a[216:219], v[140:143], a[48:51], a[216:219]
    v_mfma_f32_16x16x32_bf16 a[220:223], v[136:139], a[24:27], a[220:223]
    v_mfma_f32_16x16x32_bf16 a[220:223], v[140:143], a[52:55], a[220:223]
    ds_read_b64_tr_b16 v[136:137], v11 offset:96
    ds_read_b64_tr_b16 v[138:139], v11 offset:224
    ds_read_b64_tr_b16 v[140:141], v11 offset:608
    ds_read_b64_tr_b16 v[142:143], v11 offset:736
    s_add_u32 s22, s22, 1
    s_cmp_lt_u32 s22, 3
    s_cbranch_scc1 L_at_qploop
    s_cmp_lg_u32 s70, 0
    s_cbranch_scc1 L_at_qptailB
    s_waitcnt lgkmcnt(8)
    v_mfma_f32_16x16x32_bf16 v[144:147], v[112:115], v[28:31], v[144:147]
    s_add_u32 s29, s34, s100
    v_mfma_f32_16x16x32_bf16 v[144:147], v[116:119], v[56:59], v[144:147]
    s_bfe_u32 s28, s29, 0x20003
    v_mfma_f32_16x16x32_bf16 v[148:151], v[112:115], v[32:35], v[148:151]
    s_lshl_b32 s28, s28, 16
    v_mfma_f32_16x16x32_bf16 v[148:151], v[116:119], v[60:63], v[148:151]
    s_and_b32 s29, s29, 7
    v_mfma_f32_16x16x32_bf16 v[152:155], v[112:115], v[36:39], v[152:155]
    s_lshl_b32 s29, s29, 11
    v_mfma_f32_16x16x32_bf16 v[152:155], v[116:119], v[64:67], v[152:155]
    s_add_u32 s29, s28, s29
    v_mfma_f32_16x16x32_bf16 v[156:159], v[112:115], v[40:43], v[156:159]
    s_lshr_b32 s28, s34, 5
    s_waitcnt vmcnt(16) lgkmcnt(0)
    s_barrier
    v_mfma_f32_16x16x32_bf16 v[156:159], v[116:119], v[68:71], v[156:159]
    s_lshl_b32 s28, s28, 19
    v_mfma_f32_16x16x32_bf16 v[160:163], v[112:115], v[44:47], v[160:163]
    s_add_u32 s49, s28, s29
    v_mfma_f32_16x16x32_bf16 v[160:163], v[116:119], v[72:75], v[160:163]
    s_add_u32 m0, s33, 0
    v_mfma_f32_16x16x32_bf16 v[164:167], v[112:115], v[48:51], v[164:167]
    s_add_u32 s34, s34, 1
    v_mfma_f32_16x16x32_bf16 v[164:167], v[116:119], v[76:79], v[164:167]
    buffer_load_dwordx4 v7, s[4:7], s49 offen offset:0 nt lds
    v_mfma_f32_16x16x32_bf16 v[168:171], v[112:115], v[52:55], v[168:171]
    s_add_u32 m0, m0, s96
    v_mfma_f32_16x16x32_bf16 v[168:171], v[116:119], v[80:83], v[168:171]
    ds_read_b64_tr_b16 v[112:113], v11 offset:8448
    v_mfma_f32_16x16x32_bf16 v[172:175], v[120:123], v[28:31], v[172:175]
    ds_read_b64_tr_b16 v[114:115], v11 offset:8576
    v_mfma_f32_16x16x32_bf16 v[172:175], v[124:127], v[56:59], v[172:175]
    buffer_load_dwordx4 v7, s[4:7], s49 offen offset:256 nt lds
    v_mfma_f32_16x16x32_bf16 v[176:179], v[120:123], v[32:35], v[176:179]
    s_add_u32 m0, m0, s97
    ds_read_b64_tr_b16 v[116:117], v11 offset:8960
    v_mfma_f32_16x16x32_bf16 v[176:179], v[124:127], v[60:63], v[176:179]
    ds_read_b64_tr_b16 v[118:119], v11 offset:9088
    v_mfma_f32_16x16x32_bf16 v[180:183], v[120:123], v[36:39], v[180:183]
    v_mfma_f32_16x16x32_bf16 v[180:183], v[124:127], v[64:67], v[180:183]
    v_mfma_f32_16x16x32_bf16 v[184:187], v[120:123], v[40:43], v[184:187]
    v_mfma_f32_16x16x32_bf16 v[184:187], v[124:127], v[68:71], v[184:187]
    buffer_load_dwordx4 v7, s[4:7], s49 offen offset:512 nt lds
    v_mfma_f32_16x16x32_bf16 v[188:191], v[120:123], v[44:47], v[188:191]
    s_add_u32 m0, m0, s96
    v_mfma_f32_16x16x32_bf16 v[188:191], v[124:127], v[72:75], v[188:191]
    v_mfma_f32_16x16x32_bf16 v[192:195], v[120:123], v[48:51], v[192:195]
    v_mfma_f32_16x16x32_bf16 v[192:195], v[124:127], v[76:79], v[192:195]
    v_mfma_f32_16x16x32_bf16 v[196:199], v[120:123], v[52:55], v[196:199]
    v_mfma_f32_16x16x32_bf16 v[196:199], v[124:127], v[80:83], v[196:199]
    buffer_load_dwordx4 v7, s[4:7], s49 offen offset:768 nt lds
    v_mfma_f32_16x16x32_bf16 v[200:203], v[128:131], v[28:31], v[200:203]
    s_add_u32 m0, m0, s97
    ds_read_b64_tr_b16 v[120:121], v11 offset:8480
    v_mfma_f32_16x16x32_bf16 v[200:203], v[132:135], v[56:59], v[200:203]
    ds_read_b64_tr_b16 v[122:123], v11 offset:8608
    v_mfma_f32_16x16x32_bf16 v[204:207], v[128:131], v[32:35], v[204:207]
    ds_read_b64_tr_b16 v[124:125], v11 offset:8992
    v_mfma_f32_16x16x32_bf16 v[204:207], v[132:135], v[60:63], v[204:207]
    ds_read_b64_tr_b16 v[126:127], v11 offset:9120
    v_mfma_f32_16x16x32_bf16 v[208:211], v[128:131], v[36:39], v[208:211]
    v_mfma_f32_16x16x32_bf16 v[208:211], v[132:135], v[64:67], v[208:211]
    buffer_load_dwordx4 v7, s[4:7], s49 offen offset:1024 nt lds
    v_mfma_f32_16x16x32_bf16 v[212:215], v[128:131], v[40:43], v[212:215]
    s_add_u32 m0, m0, s96
    v_mfma_f32_16x16x32_bf16 v[212:215], v[132:135], v[68:71], v[212:215]
    v_mfma_f32_16x16x32_bf16 v[216:219], v[128:131], v[44:47], v[216:219]
    v_mfma_f32_16x16x32_bf16 v[216:219], v[132:135], v[72:75], v[216:219]
    v_mfma_f32_16x16x32_bf16 v[220:223], v[128:131], v[48:51], v[220:223]
    v_mfma_f32_16x16x32_bf16 v[220:223], v[132:135], v[76:79], v[220:223]
    buffer_load_dwordx4 v7, s[4:7], s49 offen offset:1280 nt lds
    v_mfma_f32_16x16x32_bf16 v[224:227], v[128:131], v[52:55], v[224:227]
    s_add_u32 m0, m0, s97
    v_mfma_f32_16x16x32_bf16 v[224:227], v[132:135], v[80:83], v[224:227]
    ds_read_b64_tr_b16 v[128:129], v11 offset:8512
    v_mfma_f32_16x16x32_bf16 v[228:231], v[136:139], v[28:31], v[228:231]
    ds_read_b64_tr_b16 v[130:131], v11 offset:8640
    v_mfma_f32_16x16x32_bf16 v[228:231], v[140:143], v[56:59], v[228:231]
    ds_read_b64_tr_b16 v[132:133], v11 offset:9024
    v_mfma_f32_16x16x32_bf16 v[232:235], v[136:139], v[32:35], v[232:235]
    ds_read_b64_tr_b16 v[134:135], v11 offset:9152
    v_mfma_f32_16x16x32_bf16 v[232:235], v[140:143], v[60:63], v[232:235]
    buffer_load_dwordx4 v7, s[4:7], s49 offen offset:1536 nt lds
    v_mfma_f32_16x16x32_bf16 v[236:239], v[136:139], v[36:39], v[236:239]
    s_add_u32 m0, m0, s96
    v_mfma_f32_16x16x32_bf16 v[236:239], v[140:143], v[64:67], v[236:239]
    v_mfma_f32_16x16x32_bf16 v[240:243], v[136:139], v[40:43], v[240:243]
    v_mfma_f32_16x16x32_bf16 v[240:243], v[140:143], v[68:71], v[240:243]
    v_mfma_f32_16x16x32_bf16 v[244:247], v[136:139], v[44:47], v[244:247]
    v_mfma_f32_16x16x32_bf16 v[244:247], v[140:143], v[72:75], v[244:247]
    buffer_load_dwordx4 v7, s[4:7], s49 offen offset:1792 nt lds
    v_mfma_f32_16x16x32_bf16 v[248:251], v[136:139], v[48:51], v[248:251]
    v_mfma_f32_16x16x32_bf16 v[248:251], v[140:143], v[76:79], v[248:251]
    v_mfma_f32_16x16x32_bf16 v[252:255], v[136:139], v[52:55], v[252:255]
    v_mfma_f32_16x16x32_bf16 v[252:255], v[140:143], v[80:83], v[252:255]
    ds_read_b64_tr_b16 v[136:137], v11 offset:8544
    ds_read_b64_tr_b16 v[138:139], v11 offset:8672
    ds_read_b64_tr_b16 v[140:141], v11 offset:9056
    ds_read_b64_tr_b16 v[142:143], v11 offset:9184
    s_waitcnt lgkmcnt(8)
    v_mfma_f32_16x16x32_bf16 a[112:115], v[112:115], v[28:31], a[112:115]
    s_add_u32 s29, s34, s100
    v_mfma_f32_16x16x32_bf16 a[112:115], v[116:119], v[56:59], a[112:115]
    s_bfe_u32 s28, s29, 0x20003
    v_mfma_f32_16x16x32_bf16 a[116:119], v[112:115], v[32:35], a[116:119]
    s_lshl_b32 s28, s28, 16
    v_mfma_f32_16x16x32_bf16 a[116:119], v[116:119], v[60:63], a[116:119]
    s_and_b32 s29, s29, 7
    v_mfma_f32_16x16x32_bf16 a[120:123], v[112:115], v[36:39], a[120:123]
    s_lshl_b32 s29, s29, 11
    v_mfma_f32_16x16x32_bf16 a[120:123], v[116:119], v[64:67], a[120:123]
    s_add_u32 s29, s28, s29
    v_mfma_f32_16x16x32_bf16 a[124:127], v[112:115], v[40:43], a[124:127]
    s_lshr_b32 s28, s34, 5
    s_waitcnt vmcnt(8) lgkmcnt(0)
    s_barrier
    ds_read_b128 a[0:3], v27 offset:16896
    v_mfma_f32_16x16x32_bf16 a[124:127], v[116:119], v[68:71], a[124:127]
    s_lshl_b32 s28, s28, 19
    ds_read_b128 a[4:7], v27 offset:18944
    v_mfma_f32_16x16x32_bf16 a[128:131], v[112:115], v[44:47], a[128:131]
    s_add_u32 s49, s28, s29
    ds_read_b128 a[8:11], v27 offset:20992
    v_mfma_f32_16x16x32_bf16 a[128:131], v[116:119], v[72:75], a[128:131]
    s_add_u32 m0, s33, 8448
    ds_read_b128 a[12:15], v27 offset:23040
    v_mfma_f32_16x16x32_bf16 a[132:135], v[112:115], v[48:51], a[132:135]
    s_add_u32 s34, s34, 1
    ds_read_b128 a[16:19], v27 offset:25344
    v_mfma_f32_16x16x32_bf16 a[132:135], v[116:119], v[76:79], a[132:135]
    buffer_load_dwordx4 v7, s[4:7], s49 offen offset:0 nt lds
    v_mfma_f32_16x16x32_bf16 a[136:139], v[112:115], v[52:55], a[136:139]
    s_add_u32 m0, m0, s96
    ds_read_b128 a[20:23], v27 offset:27392
    v_mfma_f32_16x16x32_bf16 a[136:139], v[116:119], v[80:83], a[136:139]
    ds_read_b128 a[24:27], v27 offset:29440
    v_mfma_f32_16x16x32_bf16 a[140:143], v[120:123], v[28:31], a[140:143]
    ds_read_b128 a[28:31], v6 offset:16896
    v_mfma_f32_16x16x32_bf16 a[140:143], v[124:127], v[56:59], a[140:143]
    buffer_load_dwordx4 v7, s[4:7], s49 offen offset:256 nt lds
    v_mfma_f32_16x16x32_bf16 a[144:147], v[120:123], v[32:35], a[144:147]
    s_add_u32 m0, m0, s97
    ds_read_b128 a[32:35], v6 offset:18944
    v_mfma_f32_16x16x32_bf16 a[144:147], v[124:127], v[60:63], a[144:147]
    ds_read_b128 a[36:39], v6 offset:20992
    v_mfma_f32_16x16x32_bf16 a[148:151], v[120:123], v[36:39], a[148:151]
    ds_read_b128 a[40:43], v6 offset:23040
    v_mfma_f32_16x16x32_bf16 a[148:151], v[124:127], v[64:67], a[148:151]
    ds_read_b128 a[44:47], v6 offset:25344
    v_mfma_f32_16x16x32_bf16 a[152:155], v[120:123], v[40:43], a[152:155]
    ds_read_b128 a[48:51], v6 offset:27392
    v_mfma_f32_16x16x32_bf16 a[152:155], v[124:127], v[68:71], a[152:155]
    buffer_load_dwordx4 v7, s[4:7], s49 offen offset:512 nt lds
    v_mfma_f32_16x16x32_bf16 a[156:159], v[120:123], v[44:47], a[156:159]
    s_add_u32 m0, m0, s96
    ds_read_b128 a[52:55], v6 offset:29440
    v_mfma_f32_16x16x32_bf16 a[156:159], v[124:127], v[72:75], a[156:159]
    ds_read_b64_tr_b16 v[112:113], v11 offset:16896
    v_mfma_f32_16x16x32_bf16 a[160:163], v[120:123], v[48:51], a[160:163]
    ds_read_b64_tr_b16 v[114:115], v11 offset:17024
    v_mfma_f32_16x16x32_bf16 a[160:163], v[124:127], v[76:79], a[160:163]
    ds_read_b64_tr_b16 v[116:117], v11 offset:17408
    v_mfma_f32_16x16x32_bf16 a[164:167], v[120:123], v[52:55], a[164:167]
    ds_read_b64_tr_b16 v[118:119], v11 offset:17536
    v_mfma_f32_16x16x32_bf16 a[164:167], v[124:127], v[80:83], a[164:167]
    buffer_load_dwordx4 v7, s[4:7], s49 offen offset:768 nt lds
    v_mfma_f32_16x16x32_bf16 a[168:171], v[128:131], v[28:31], a[168:171]
    s_add_u32 m0, m0, s97
    ds_read_b64_tr_b16 v[120:121], v11 offset:16928
    v_mfma_f32_16x16x32_bf16 a[168:171], v[132:135], v[56:59], a[168:171]
    ds_read_b64_tr_b16 v[122:123], v11 offset:17056
    v_mfma_f32_16x16x32_bf16 a[172:175], v[128:131], v[32:35], a[172:175]
    ds_read_b64_tr_b16 v[124:125], v11 offset:17440
    v_mfma_f32_16x16x32_bf16 a[172:175], v[132:135], v[60:63], a[172:175]
    ds_read_b64_tr_b16 v[126:127], v11 offset:17568
    v_mfma_f32_16x16x32_bf16 a[176:179], v[128:131], v[36:39], a[176:179]
    v_mfma_f32_16x16x32_bf16 a[176:179], v[132:135], v[64:67], a[176:179]
    buffer_load_dwordx4 v7, s[4:7], s49 offen offset:1024 nt lds
    v_mfma_f32_16x16x32_bf16 a[180:183], v[128:131], v[40:43], a[180:183]
    s_add_u32 m0, m0, s96
    v_mfma_f32_16x16x32_bf16 a[180:183], v[132:135], v[68:71], a[180:183]
    v_mfma_f32_16x16x32_bf16 a[184:187], v[128:131], v[44:47], a[184:187]
    v_mfma_f32_16x16x32_bf16 a[184:187], v[132:135], v[72:75], a[184:187]
    v_mfma_f32_16x16x32_bf16 a[188:191], v[128:131], v[48:51], a[188:191]
    v_mfma_f32_16x16x32_bf16 a[188:191], v[132:135], v[76:79], a[188:191]
    buffer_load_dwordx4 v7, s[4:7], s49 offen offset:1280 nt lds
    v_mfma_f32_16x16x32_bf16 a[192:195], v[128:131], v[52:55], a[192:195]
    s_add_u32 m0, m0, s97
    v_mfma_f32_16x16x32_bf16 a[192:195], v[132:135], v[80:83], a[192:195]
    ds_read_b64_tr_b16 v[128:129], v11 offset:16960
    v_mfma_f32_16x16x32_bf16 a[196:199], v[136:139], v[28:31], a[196:199]
    ds_read_b64_tr_b16 v[130:131], v11 offset:17088
    v_mfma_f32_16x16x32_bf16 a[196:199], v[140:143], v[56:59], a[196:199]
    ds_read_b64_tr_b16 v[132:133], v11 offset:17472
    v_mfma_f32_16x16x32_bf16 a[200:203], v[136:139], v[32:35], a[200:203]
    ds_read_b64_tr_b16 v[134:135], v11 offset:17600
    v_mfma_f32_16x16x32_bf16 a[200:203], v[140:143], v[60:63], a[200:203]
    buffer_load_dwordx4 v7, s[4:7], s49 offen offset:1536 nt lds
    v_mfma_f32_16x16x32_bf16 a[204:207], v[136:139], v[36:39], a[204:207]
    s_add_u32 m0, m0, s96
    v_mfma_f32_16x16x32_bf16 a[204:207], v[140:143], v[64:67], a[204:207]
    v_mfma_f32_16x16x32_bf16 a[208:211], v[136:139], v[40:43], a[208:211]
    v_mfma_f32_16x16x32_bf16 a[208:211], v[140:143], v[68:71], a[208:211]
    v_mfma_f32_16x16x32_bf16 a[212:215], v[136:139], v[44:47], a[212:215]
    v_mfma_f32_16x16x32_bf16 a[212:215], v[140:143], v[72:75], a[212:215]
    buffer_load_dwordx4 v7, s[4:7], s49 offen offset:1792 nt lds
    v_mfma_f32_16x16x32_bf16 a[216:219], v[136:139], v[48:51], a[216:219]
    v_mfma_f32_16x16x32_bf16 a[216:219], v[140:143], v[76:79], a[216:219]
    v_mfma_f32_16x16x32_bf16 a[220:223], v[136:139], v[52:55], a[220:223]
    v_mfma_f32_16x16x32_bf16 a[220:223], v[140:143], v[80:83], a[220:223]
    ds_read_b64_tr_b16 v[136:137], v11 offset:16992
    ds_read_b64_tr_b16 v[138:139], v11 offset:17120
    ds_read_b64_tr_b16 v[140:141], v11 offset:17504
    ds_read_b64_tr_b16 v[142:143], v11 offset:17632
    s_waitcnt lgkmcnt(8)
    v_mfma_f32_16x16x32_bf16 v[144:147], v[112:115], a[0:3], v[144:147]
    s_add_u32 s29, s34, s100
    v_mfma_f32_16x16x32_bf16 v[144:147], v[116:119], a[28:31], v[144:147]
    s_bfe_u32 s28, s29, 0x20003
    v_mfma_f32_16x16x32_bf16 v[148:151], v[112:115], a[4:7], v[148:151]
    s_lshl_b32 s28, s28, 16
    v_mfma_f32_16x16x32_bf16 v[148:151], v[116:119], a[32:35], v[148:151]
    s_and_b32 s29, s29, 7
    v_mfma_f32_16x16x32_bf16 v[152:155], v[112:115], a[8:11], v[152:155]
    s_lshl_b32 s29, s29, 11
    v_mfma_f32_16x16x32_bf16 v[152:155], v[116:119], a[36:39], v[152:155]
    s_add_u32 s29, s28, s29
    v_mfma_f32_16x16x32_bf16 v[156:159], v[112:115], a[12:15], v[156:159]
    s_lshr_b32 s28, s34, 5
    s_waitcnt vmcnt(16) lgkmcnt(0)
    s_barrier
    v_mfma_f32_16x16x32_bf16 v[156:159], v[116:119], a[40:43], v[156:159]
    s_lshl_b32 s28, s28, 19
    v_mfma_f32_16x16x32_bf16 v[160:163], v[112:115], a[16:19], v[160:163]
    s_add_u32 s49, s28, s29
    v_mfma_f32_16x16x32_bf16 v[160:163], v[116:119], a[44:47], v[160:163]
    s_add_u32 m0, s33, 16896
    v_mfma_f32_16x16x32_bf16 v[164:167], v[112:115], a[20:23], v[164:167]
    s_add_u32 s34, s34, 1
    v_mfma_f32_16x16x32_bf16 v[164:167], v[116:119], a[48:51], v[164:167]
    buffer_load_dwordx4 v7, s[4:7], s49 offen offset:0 nt lds
    v_mfma_f32_16x16x32_bf16 v[168:171], v[112:115], a[24:27], v[168:171]
    s_add_u32 m0, m0, s96
    v_mfma_f32_16x16x32_bf16 v[168:171], v[116:119], a[52:55], v[168:171]
    ds_read_b64_tr_b16 v[112:113], v11 offset:25344
    v_mfma_f32_16x16x32_bf16 v[172:175], v[120:123], a[0:3], v[172:175]
    ds_read_b64_tr_b16 v[114:115], v11 offset:25472
    v_mfma_f32_16x16x32_bf16 v[172:175], v[124:127], a[28:31], v[172:175]
    buffer_load_dwordx4 v7, s[4:7], s49 offen offset:256 nt lds
    v_mfma_f32_16x16x32_bf16 v[176:179], v[120:123], a[4:7], v[176:179]
    s_add_u32 m0, m0, s97
    ds_read_b64_tr_b16 v[116:117], v11 offset:25856
    v_mfma_f32_16x16x32_bf16 v[176:179], v[124:127], a[32:35], v[176:179]
    ds_read_b64_tr_b16 v[118:119], v11 offset:25984
    v_mfma_f32_16x16x32_bf16 v[180:183], v[120:123], a[8:11], v[180:183]
    v_mfma_f32_16x16x32_bf16 v[180:183], v[124:127], a[36:39], v[180:183]
    v_mfma_f32_16x16x32_bf16 v[184:187], v[120:123], a[12:15], v[184:187]
    v_mfma_f32_16x16x32_bf16 v[184:187], v[124:127], a[40:43], v[184:187]
    buffer_load_dwordx4 v7, s[4:7], s49 offen offset:512 nt lds
    v_mfma_f32_16x16x32_bf16 v[188:191], v[120:123], a[16:19], v[188:191]
    s_add_u32 m0, m0, s96
    v_mfma_f32_16x16x32_bf16 v[188:191], v[124:127], a[44:47], v[188:191]
    v_mfma_f32_16x16x32_bf16 v[192:195], v[120:123], a[20:23], v[192:195]
    v_mfma_f32_16x16x32_bf16 v[192:195], v[124:127], a[48:51], v[192:195]
    v_mfma_f32_16x16x32_bf16 v[196:199], v[120:123], a[24:27], v[196:199]
    v_mfma_f32_16x16x32_bf16 v[196:199], v[124:127], a[52:55], v[196:199]
    buffer_load_dwordx4 v7, s[4:7], s49 offen offset:768 nt lds
    v_mfma_f32_16x16x32_bf16 v[200:203], v[128:131], a[0:3], v[200:203]
    s_add_u32 m0, m0, s97
    ds_read_b64_tr_b16 v[120:121], v11 offset:25376
    v_mfma_f32_16x16x32_bf16 v[200:203], v[132:135], a[28:31], v[200:203]
    ds_read_b64_tr_b16 v[122:123], v11 offset:25504
    v_mfma_f32_16x16x32_bf16 v[204:207], v[128:131], a[4:7], v[204:207]
    ds_read_b64_tr_b16 v[124:125], v11 offset:25888
    v_mfma_f32_16x16x32_bf16 v[204:207], v[132:135], a[32:35], v[204:207]
    ds_read_b64_tr_b16 v[126:127], v11 offset:26016
    v_mfma_f32_16x16x32_bf16 v[208:211], v[128:131], a[8:11], v[208:211]
    v_mfma_f32_16x16x32_bf16 v[208:211], v[132:135], a[36:39], v[208:211]
    buffer_load_dwordx4 v7, s[4:7], s49 offen offset:1024 nt lds
    v_mfma_f32_16x16x32_bf16 v[212:215], v[128:131], a[12:15], v[212:215]
    s_add_u32 m0, m0, s96
    v_mfma_f32_16x16x32_bf16 v[212:215], v[132:135], a[40:43], v[212:215]
    v_mfma_f32_16x16x32_bf16 v[216:219], v[128:131], a[16:19], v[216:219]
    v_mfma_f32_16x16x32_bf16 v[216:219], v[132:135], a[44:47], v[216:219]
    v_mfma_f32_16x16x32_bf16 v[220:223], v[128:131], a[20:23], v[220:223]
    v_mfma_f32_16x16x32_bf16 v[220:223], v[132:135], a[48:51], v[220:223]
    buffer_load_dwordx4 v7, s[4:7], s49 offen offset:1280 nt lds
    v_mfma_f32_16x16x32_bf16 v[224:227], v[128:131], a[24:27], v[224:227]
    s_add_u32 m0, m0, s97
    v_mfma_f32_16x16x32_bf16 v[224:227], v[132:135], a[52:55], v[224:227]
    ds_read_b64_tr_b16 v[128:129], v11 offset:25408
    v_mfma_f32_16x16x32_bf16 v[228:231], v[136:139], a[0:3], v[228:231]
    ds_read_b64_tr_b16 v[130:131], v11 offset:25536
    v_mfma_f32_16x16x32_bf16 v[228:231], v[140:143], a[28:31], v[228:231]
    ds_read_b64_tr_b16 v[132:133], v11 offset:25920
    v_mfma_f32_16x16x32_bf16 v[232:235], v[136:139], a[4:7], v[232:235]
    ds_read_b64_tr_b16 v[134:135], v11 offset:26048
    v_mfma_f32_16x16x32_bf16 v[232:235], v[140:143], a[32:35], v[232:235]
    buffer_load_dwordx4 v7, s[4:7], s49 offen offset:1536 nt lds
    v_mfma_f32_16x16x32_bf16 v[236:239], v[136:139], a[8:11], v[236:239]
    s_add_u32 m0, m0, s96
    v_mfma_f32_16x16x32_bf16 v[236:239], v[140:143], a[36:39], v[236:239]
    v_mfma_f32_16x16x32_bf16 v[240:243], v[136:139], a[12:15], v[240:243]
    v_mfma_f32_16x16x32_bf16 v[240:243], v[140:143], a[40:43], v[240:243]
    v_mfma_f32_16x16x32_bf16 v[244:247], v[136:139], a[16:19], v[244:247]
    v_mfma_f32_16x16x32_bf16 v[244:247], v[140:143], a[44:47], v[244:247]
    buffer_load_dwordx4 v7, s[4:7], s49 offen offset:1792 nt lds
    v_mfma_f32_16x16x32_bf16 v[248:251], v[136:139], a[20:23], v[248:251]
    v_mfma_f32_16x16x32_bf16 v[248:251], v[140:143], a[48:51], v[248:251]
    v_mfma_f32_16x16x32_bf16 v[252:255], v[136:139], a[24:27], v[252:255]
    v_mfma_f32_16x16x32_bf16 v[252:255], v[140:143], a[52:55], v[252:255]
    ds_read_b64_tr_b16 v[136:137], v11 offset:25440
    ds_read_b64_tr_b16 v[138:139], v11 offset:25568
    ds_read_b64_tr_b16 v[140:141], v11 offset:25952
    ds_read_b64_tr_b16 v[142:143], v11 offset:26080
    s_waitcnt lgkmcnt(8)
    v_mfma_f32_16x16x32_bf16 a[112:115], v[112:115], a[0:3], a[112:115]
    s_add_u32 s29, s34, s100
    v_mfma_f32_16x16x32_bf16 a[112:115], v[116:119], a[28:31], a[112:115]
    s_bfe_u32 s28, s29, 0x20003
    v_mfma_f32_16x16x32_bf16 a[116:119], v[112:115], a[4:7], a[116:119]
    s_lshl_b32 s28, s28, 16
    v_mfma_f32_16x16x32_bf16 a[116:119], v[116:119], a[32:35], a[116:119]
    s_and_b32 s29, s29, 7
    v_mfma_f32_16x16x32_bf16 a[120:123], v[112:115], a[8:11], a[120:123]
    s_lshl_b32 s29, s29, 11
    v_mfma_f32_16x16x32_bf16 a[120:123], v[116:119], a[36:39], a[120:123]
    s_add_u32 s29, s28, s29
    v_mfma_f32_16x16x32_bf16 a[124:127], v[112:115], a[12:15], a[124:127]
    s_lshr_b32 s28, s34, 5
    s_waitcnt vmcnt(16) lgkmcnt(0)
    s_barrier
    ds_read_b128 v[56:59], v8 offset:0
    v_mfma_f32_16x16x32_bf16 a[124:127], v[116:119], a[40:43], a[124:127]
    s_lshl_b32 s28, s28, 19
    ds_read_b128 v[60:63], v8 offset:64
    v_mfma_f32_16x16x32_bf16 a[128:131], v[112:115], a[16:19], a[128:131]
    s_add_u32 s49, s28, s29
    ds_read_b128 v[64:67], v8 offset:128
    v_mfma_f32_16x16x32_bf16 a[128:131], v[116:119], a[44:47], a[128:131]
    s_add_u32 m0, s33, 25344
    ds_read_b128 v[68:71], v8 offset:192
    v_mfma_f32_16x16x32_bf16 a[132:135], v[112:115], a[20:23], a[132:135]
    s_add_u32 s34, s34, 1
    ds_read_b128 v[72:75], v8 offset:512
    v_mfma_f32_16x16x32_bf16 a[132:135], v[116:119], a[48:51], a[132:135]
    buffer_load_dwordx4 v7, s[4:7], s49 offen offset:0 nt lds
    v_mfma_f32_16x16x32_bf16 a[136:139], v[112:115], a[24:27], a[136:139]
    s_add_u32 m0, m0, s96
    ds_read_b128 v[76:79], v8 offset:576
    v_mfma_f32_16x16x32_bf16 a[136:139], v[116:119], a[52:55], a[136:139]
    ds_read_b128 v[80:83], v8 offset:640
    v_mfma_f32_16x16x32_bf16 a[140:143], v[120:123], a[0:3], a[140:143]
    ds_read_b128 v[84:87], v8 offset:704
    v_mfma_f32_16x16x32_bf16 a[140:143], v[124:127], a[28:31], a[140:143]
    buffer_load_dwordx4 v7, s[4:7], s49 offen offset:256 nt lds
    v_mfma_f32_16x16x32_bf16 a[144:147], v[120:123], a[4:7], a[144:147]
    s_add_u32 m0, m0, s97
    v_mfma_f32_16x16x32_bf16 a[144:147], v[124:127], a[32:35], a[144:147]
    v_mfma_f32_16x16x32_bf16 a[148:151], v[120:123], a[8:11], a[148:151]
    v_mfma_f32_16x16x32_bf16 a[148:151], v[124:127], a[36:39], a[148:151]
    v_mfma_f32_16x16x32_bf16 a[152:155], v[120:123], a[12:15], a[152:155]
    v_mfma_f32_16x16x32_bf16 a[152:155], v[124:127], a[40:43], a[152:155]
    buffer_load_dwordx4 v7, s[4:7], s49 offen offset:512 nt lds
    v_mfma_f32_16x16x32_bf16 a[156:159], v[120:123], a[16:19], a[156:159]
    s_add_u32 m0, m0, s96
    v_mfma_f32_16x16x32_bf16 a[156:159], v[124:127], a[44:47], a[156:159]
    v_mfma_f32_16x16x32_bf16 a[160:163], v[120:123], a[20:23], a[160:163]
    v_mfma_f32_16x16x32_bf16 a[160:163], v[124:127], a[48:51], a[160:163]
    v_mfma_f32_16x16x32_bf16 a[164:167], v[120:123], a[24:27], a[164:167]
    v_mfma_f32_16x16x32_bf16 a[164:167], v[124:127], a[52:55], a[164:167]
    buffer_load_dwordx4 v7, s[4:7], s49 offen offset:768 nt lds
    v_mfma_f32_16x16x32_bf16 a[168:171], v[128:131], a[0:3], a[168:171]
    s_add_u32 m0, m0, s97
    v_mfma_f32_16x16x32_bf16 a[168:171], v[132:135], a[28:31], a[168:171]
    v_mfma_f32_16x16x32_bf16 a[172:175], v[128:131], a[4:7], a[172:175]
    v_mfma_f32_16x16x32_bf16 a[172:175], v[132:135], a[32:35], a[172:175]
    v_mfma_f32_16x16x32_bf16 a[176:179], v[128:131], a[8:11], a[176:179]
    v_mfma_f32_16x16x32_bf16 a[176:179], v[132:135], a[36:39], a[176:179]
    buffer_load_dwordx4 v7, s[4:7], s49 offen offset:1024 nt lds
    v_mfma_f32_16x16x32_bf16 a[180:183], v[128:131], a[12:15], a[180:183]
    s_add_u32 m0, m0, s96
    v_mfma_f32_16x16x32_bf16 a[180:183], v[132:135], a[40:43], a[180:183]
    v_mfma_f32_16x16x32_bf16 a[184:187], v[128:131], a[16:19], a[184:187]
    v_mfma_f32_16x16x32_bf16 a[184:187], v[132:135], a[44:47], a[184:187]
    v_mfma_f32_16x16x32_bf16 a[188:191], v[128:131], a[20:23], a[188:191]
    v_mfma_f32_16x16x32_bf16 a[188:191], v[132:135], a[48:51], a[188:191]
    buffer_load_dwordx4 v7, s[4:7], s49 offen offset:1280 nt lds
    v_mfma_f32_16x16x32_bf16 a[192:195], v[128:131], a[24:27], a[192:195]
    s_add_u32 m0, m0, s97
    v_mfma_f32_16x16x32_bf16 a[192:195], v[132:135], a[52:55], a[192:195]
    v_mfma_f32_16x16x32_bf16 a[196:199], v[136:139], a[0:3], a[196:199]
    v_mfma_f32_16x16x32_bf16 a[196:199], v[140:143], a[28:31], a[196:199]
    v_mfma_f32_16x16x32_bf16 a[200:203], v[136:139], a[4:7], a[200:203]
    v_mfma_f32_16x16x32_bf16 a[200:203], v[140:143], a[32:35], a[200:203]
    buffer_load_dwordx4 v7, s[4:7], s49 offen offset:1536 nt lds
    v_mfma_f32_16x16x32_bf16 a[204:207], v[136:139], a[8:11], a[204:207]
    s_add_u32 m0, m0, s96
    v_mfma_f32_16x16x32_bf16 a[204:207], v[140:143], a[36:39], a[204:207]
    v_mfma_f32_16x16x32_bf16 a[208:211], v[136:139], a[12:15], a[208:211]
    v_mfma_f32_16x16x32_bf16 a[208:211], v[140:143], a[40:43], a[208:211]
    v_mfma_f32_16x16x32_bf16 a[212:215], v[136:139], a[16:19], a[212:215]
    v_mfma_f32_16x16x32_bf16 a[212:215], v[140:143], a[44:47], a[212:215]
    buffer_load_dwordx4 v7, s[4:7], s49 offen offset:1792 nt lds
    v_mfma_f32_16x16x32_bf16 a[216:219], v[136:139], a[20:23], a[216:219]
    v_mfma_f32_16x16x32_bf16 a[216:219], v[140:143], a[48:51], a[216:219]
    v_mfma_f32_16x16x32_bf16 a[220:223], v[136:139], a[24:27], a[220:223]
    v_mfma_f32_16x16x32_bf16 a[220:223], v[140:143], a[52:55], a[220:223]
    s_branch L_at_qpepi
L_at_qptailB:
    s_mul_i32 s50, s21, s52
    s_mov_b32 s101, s21
    s_add_u32 s50, s50, s55
    s_cmp_ge_u32 s21, 2
    s_cselect_b32 s28, 0x40000000, 0
    s_add_u32 s50, s50, s28
    s_mov_b32 s82, s26
    s_mul_i32 s28, s26, s51
    s_add_u32 s50, s50, s28
    s_waitcnt lgkmcnt(8)
    v_mfma_f32_16x16x32_bf16 v[144:147], v[112:115], v[28:31], v[144:147]
    s_add_u32 m0, s33, 0
    v_mfma_f32_16x16x32_bf16 v[144:147], v[116:119], v[56:59], v[144:147]
    s_mov_b32 s49, s50
    v_mfma_f32_16x16x32_bf16 v[148:151], v[112:115], v[32:35], v[148:151]
    v_mfma_f32_16x16x32_bf16 v[148:151], v[116:119], v[60:63], v[148:151]
    v_mfma_f32_16x16x32_bf16 v[152:155], v[112:115], v[36:39], v[152:155]
    v_mfma_f32_16x16x32_bf16 v[152:155], v[116:119], v[64:67], v[152:155]
    v_mfma_f32_16x16x32_bf16 v[156:159], v[112:115], v[40:43], v[156:159]
    s_waitcnt vmcnt(16) lgkmcnt(0)
    s_barrier
    v_mfma_f32_16x16x32_bf16 v[156:159], v[116:119], v[68:71], v[156:159]
    v_mfma_f32_16x16x32_bf16 v[160:163], v[112:115], v[44:47], v[160:163]
    v_mfma_f32_16x16x32_bf16 v[160:163], v[116:119], v[72:75], v[160:163]
    s_add_u32 s28, s49, s88
    buffer_load_dwordx4 v26, s[16:19], s28 offen lds
    v_mfma_f32_16x16x32_bf16 v[164:167], v[112:115], v[48:51], v[164:167]
    s_add_u32 m0, m0, s53
    v_mfma_f32_16x16x32_bf16 v[164:167], v[116:119], v[76:79], v[164:167]
    v_mfma_f32_16x16x32_bf16 v[168:171], v[112:115], v[52:55], v[168:171]
    v_mfma_f32_16x16x32_bf16 v[168:171], v[116:119], v[80:83], v[168:171]
    ds_read_b64_tr_b16 v[112:113], v11 offset:8448
    v_mfma_f32_16x16x32_bf16 v[172:175], v[120:123], v[28:31], v[172:175]
    ds_read_b64_tr_b16 v[114:115], v11 offset:8576
    v_mfma_f32_16x16x32_bf16 v[172:175], v[124:127], v[56:59], v[172:175]
    s_add_u32 s28, s49, s89
    buffer_load_dwordx4 v26, s[16:19], s28 offen lds
    v_mfma_f32_16x16x32_bf16 v[176:179], v[120:123], v[32:35], v[176:179]
    s_add_u32 m0, m0, s53
    ds_read_b64_tr_b16 v[116:117], v11 offset:8960
    v_mfma_f32_16x16x32_bf16 v[176:179], v[124:127], v[60:63], v[176:179]
    ds_read_b64_tr_b16 v[118:119], v11 offset:9088
    v_mfma_f32_16x16x32_bf16 v[180:183], v[120:123], v[36:39], v[180:183]
    v_mfma_f32_16x16x32_bf16 v[180:183], v[124:127], v[64:67], v[180:183]
    v_mfma_f32_16x16x32_bf16 v[184:187], v[120:123], v[40:43], v[184:187]
    v_mfma_f32_16x16x32_bf16 v[184:187], v[124:127], v[68:71], v[184:187]
    s_add_u32 s28, s49, s90
    buffer_load_dwordx4 v26, s[16:19], s28 offen lds
    v_mfma_f32_16x16x32_bf16 v[188:191], v[120:123], v[44:47], v[188:191]
    s_add_u32 m0, m0, s53
    v_mfma_f32_16x16x32_bf16 v[188:191], v[124:127], v[72:75], v[188:191]
    v_mfma_f32_16x16x32_bf16 v[192:195], v[120:123], v[48:51], v[192:195]
    v_mfma_f32_16x16x32_bf16 v[192:195], v[124:127], v[76:79], v[192:195]
    v_mfma_f32_16x16x32_bf16 v[196:199], v[120:123], v[52:55], v[196:199]
    v_mfma_f32_16x16x32_bf16 v[196:199], v[124:127], v[80:83], v[196:199]
    s_add_u32 s28, s49, s91
    buffer_load_dwordx4 v26, s[16:19], s28 offen lds
    v_mfma_f32_16x16x32_bf16 v[200:203], v[128:131], v[28:31], v[200:203]
    s_add_u32 m0, m0, s53
    ds_read_b64_tr_b16 v[120:121], v11 offset:8480
    v_mfma_f32_16x16x32_bf16 v[200:203], v[132:135], v[56:59], v[200:203]
    ds_read_b64_tr_b16 v[122:123], v11 offset:8608
    v_mfma_f32_16x16x32_bf16 v[204:207], v[128:131], v[32:35], v[204:207]
    ds_read_b64_tr_b16 v[124:125], v11 offset:8992
    v_mfma_f32_16x16x32_bf16 v[204:207], v[132:135], v[60:63], v[204:207]
    ds_read_b64_tr_b16 v[126:127], v11 offset:9120
    v_mfma_f32_16x16x32_bf16 v[208:211], v[128:131], v[36:39], v[208:211]
    v_mfma_f32_16x16x32_bf16 v[208:211], v[132:135], v[64:67], v[208:211]
    s_add_u32 s28, s49, s92
    buffer_load_dwordx4 v26, s[16:19], s28 offen lds
    v_mfma_f32_16x16x32_bf16 v[212:215], v[128:131], v[40:43], v[212:215]
    s_add_u32 m0, m0, s53
    v_mfma_f32_16x16x32_bf16 v[212:215], v[132:135], v[68:71], v[212:215]
    v_mfma_f32_16x16x32_bf16 v[216:219], v[128:131], v[44:47], v[216:219]
    v_mfma_f32_16x16x32_bf16 v[216:219], v[132:135], v[72:75], v[216:219]
    v_mfma_f32_16x16x32_bf16 v[220:223], v[128:131], v[48:51], v[220:223]
    v_mfma_f32_16x16x32_bf16 v[220:223], v[132:135], v[76:79], v[220:223]
    s_add_u32 s28, s49, s93
    buffer_load_dwordx4 v26, s[16:19], s28 offen lds
    v_mfma_f32_16x16x32_bf16 v[224:227], v[128:131], v[52:55], v[224:227]
    s_add_u32 m0, m0, s53
    v_mfma_f32_16x16x32_bf16 v[224:227], v[132:135], v[80:83], v[224:227]
    ds_read_b64_tr_b16 v[128:129], v11 offset:8512
    v_mfma_f32_16x16x32_bf16 v[228:231], v[136:139], v[28:31], v[228:231]
    ds_read_b64_tr_b16 v[130:131], v11 offset:8640
    v_mfma_f32_16x16x32_bf16 v[228:231], v[140:143], v[56:59], v[228:231]
    ds_read_b64_tr_b16 v[132:133], v11 offset:9024
    v_mfma_f32_16x16x32_bf16 v[232:235], v[136:139], v[32:35], v[232:235]
    ds_read_b64_tr_b16 v[134:135], v11 offset:9152
    v_mfma_f32_16x16x32_bf16 v[232:235], v[140:143], v[60:63], v[232:235]
    s_add_u32 s28, s49, s94
    buffer_load_dwordx4 v26, s[16:19], s28 offen lds
    v_mfma_f32_16x16x32_bf16 v[236:239], v[136:139], v[36:39], v[236:239]
    s_add_u32 m0, m0, s53
    v_mfma_f32_16x16x32_bf16 v[236:239], v[140:143], v[64:67], v[236:239]
    v_mfma_f32_16x16x32_bf16 v[240:243], v[136:139], v[40:43], v[240:243]
    v_mfma_f32_16x16x32_bf16 v[240:243], v[140:143], v[68:71], v[240:243]
    v_mfma_f32_16x16x32_bf16 v[244:247], v[136:139], v[44:47], v[244:247]
    v_mfma_f32_16x16x32_bf16 v[244:247], v[140:143], v[72:75], v[244:247]
    s_add_u32 s28, s49, s95
    buffer_load_dwordx4 v26, s[16:19], s28 offen lds
    v_mfma_f32_16x16x32_bf16 v[248:251], v[136:139], v[48:51], v[248:251]
    v_mfma_f32_16x16x32_bf16 v[248:251], v[140:143], v[76:79], v[248:251]
    v_mfma_f32_16x16x32_bf16 v[252:255], v[136:139], v[52:55], v[252:255]
    v_mfma_f32_16x16x32_bf16 v[252:255], v[140:143], v[80:83], v[252:255]
    ds_read_b64_tr_b16 v[136:137], v11 offset:8544
    ds_read_b64_tr_b16 v[138:139], v11 offset:8672
    ds_read_b64_tr_b16 v[140:141], v11 offset:9056
    ds_read_b64_tr_b16 v[142:143], v11 offset:9184
    s_waitcnt lgkmcnt(8)
    v_mfma_f32_16x16x32_bf16 a[112:115], v[112:115], v[28:31], a[112:115]
    s_add_u32 m0, s33, 8448
    v_mfma_f32_16x16x32_bf16 a[112:115], v[116:119], v[56:59], a[112:115]
    s_add_u32 s49, s50, s46
    v_mfma_f32_16x16x32_bf16 a[116:119], v[112:115], v[32:35], a[116:119]
    s_lshl1_add_u32 s50, s51, s50
    v_mfma_f32_16x16x32_bf16 a[116:119], v[116:119], v[60:63], a[116:119]
    s_add_u32 s82, s82, 2
    v_mfma_f32_16x16x32_bf16 a[120:123], v[112:115], v[36:39], a[120:123]
    s_cmp_eq_u32 s82, 20
    v_mfma_f32_16x16x32_bf16 a[120:123], v[116:119], v[64:67], a[120:123]
    s_cselect_b32 s29, s83, 0
    v_mfma_f32_16x16x32_bf16 a[124:127], v[112:115], v[40:43], a[124:127]
    s_sub_u32 s50, s50, s29
    s_waitcnt vmcnt(8) lgkmcnt(0)
    s_barrier
    ds_read_b128 a[0:3], v27 offset:16896
    v_mfma_f32_16x16x32_bf16 a[124:127], v[116:119], v[68:71], a[124:127]
    ds_read_b128 a[4:7], v27 offset:18944
    v_mfma_f32_16x16x32_bf16 a[128:131], v[112:115], v[44:47], a[128:131]
    ds_read_b128 a[8:11], v27 offset:20992
    v_mfma_f32_16x16x32_bf16 a[128:131], v[116:119], v[72:75], a[128:131]
    s_add_u32 s28, s49, s88
    buffer_load_dwordx4 v26, s[16:19], s28 offen lds
    v_mfma_f32_16x16x32_bf16 a[132:135], v[112:115], v[48:51], a[132:135]
    s_add_u32 m0, m0, s53
    ds_read_b128 a[12:15], v27 offset:23040
    v_mfma_f32_16x16x32_bf16 a[132:135], v[116:119], v[76:79], a[132:135]
    ds_read_b128 a[16:19], v27 offset:25344
    v_mfma_f32_16x16x32_bf16 a[136:139], v[112:115], v[52:55], a[136:139]
    ds_read_b128 a[20:23], v27 offset:27392
    v_mfma_f32_16x16x32_bf16 a[136:139], v[116:119], v[80:83], a[136:139]
    ds_read_b128 a[24:27], v27 offset:29440
    v_mfma_f32_16x16x32_bf16 a[140:143], v[120:123], v[28:31], a[140:143]
    ds_read_b128 a[28:31], v6 offset:16896
    v_mfma_f32_16x16x32_bf16 a[140:143], v[124:127], v[56:59], a[140:143]
    s_add_u32 s28, s49, s89
    buffer_load_dwordx4 v26, s[16:19], s28 offen lds
    v_mfma_f32_16x16x32_bf16 a[144:147], v[120:123], v[32:35], a[144:147]
    s_add_u32 m0, m0, s53
    ds_read_b128 a[32:35], v6 offset:18944
    v_mfma_f32_16x16x32_bf16 a[144:147], v[124:127], v[60:63], a[144:147]
    ds_read_b128 a[36:39], v6 offset:20992
    v_mfma_f32_16x16x32_bf16 a[148:151], v[120:123], v[36:39], a[148:151]
    ds_read_b128 a[40:43], v6 offset:23040
    v_mfma_f32_16x16x32_bf16 a[148:151], v[124:127], v[64:67], a[148:151]
    ds_read_b128 a[44:47], v6 offset:25344
    v_mfma_f32_16x16x32_bf16 a[152:155], v[120:123], v[40:43], a[152:155]
    ds_read_b128 a[48:51], v6 offset:27392
    v_mfma_f32_16x16x32_bf16 a[152:155], v[124:127], v[68:71], a[152:155]
    s_add_u32 s28, s49, s90
    buffer_load_dwordx4 v26, s[16:19], s28 offen lds
    v_mfma_f32_16x16x32_bf16 a[156:159], v[120:123], v[44:47], a[156:159]
    s_add_u32 m0, m0, s53
    ds_read_b128 a[52:55], v6 offset:29440
    v_mfma_f32_16x16x32_bf16 a[156:159], v[124:127], v[72:75], a[156:159]
    ds_read_b64_tr_b16 v[112:113], v11 offset:16896
    v_mfma_f32_16x16x32_bf16 a[160:163], v[120:123], v[48:51], a[160:163]
    ds_read_b64_tr_b16 v[114:115], v11 offset:17024
    v_mfma_f32_16x16x32_bf16 a[160:163], v[124:127], v[76:79], a[160:163]
    ds_read_b64_tr_b16 v[116:117], v11 offset:17408
    v_mfma_f32_16x16x32_bf16 a[164:167], v[120:123], v[52:55], a[164:167]
    ds_read_b64_tr_b16 v[118:119], v11 offset:17536
    v_mfma_f32_16x16x32_bf16 a[164:167], v[124:127], v[80:83], a[164:167]
    s_add_u32 s28, s49, s91
    buffer_load_dwordx4 v26, s[16:19], s28 offen lds
    v_mfma_f32_16x16x32_bf16 a[168:171], v[128:131], v[28:31], a[168:171]
    s_add_u32 m0, m0, s53
    ds_read_b64_tr_b16 v[120:121], v11 offset:16928
    v_mfma_f32_16x16x32_bf16 a[168:171], v[132:135], v[56:59], a[168:171]
    ds_read_b64_tr_b16 v[122:123], v11 offset:17056
    v_mfma_f32_16x16x32_bf16 a[172:175], v[128:131], v[32:35], a[172:175]
    ds_read_b64_tr_b16 v[124:125], v11 offset:17440
    v_mfma_f32_16x16x32_bf16 a[172:175], v[132:135], v[60:63], a[172:175]
    ds_read_b64_tr_b16 v[126:127], v11 offset:17568
    v_mfma_f32_16x16x32_bf16 a[176:179], v[128:131], v[36:39], a[176:179]
    v_mfma_f32_16x16x32_bf16 a[176:179], v[132:135], v[64:67], a[176:179]
    s_add_u32 s28, s49, s92
    buffer_load_dwordx4 v26, s[16:19], s28 offen lds
    v_mfma_f32_16x16x32_bf16 a[180:183], v[128:131], v[40:43], a[180:183]
    s_add_u32 m0, m0, s53
    v_mfma_f32_16x16x32_bf16 a[180:183], v[132:135], v[68:71], a[180:183]
    v_mfma_f32_16x16x32_bf16 a[184:187], v[128:131], v[44:47], a[184:187]
    v_mfma_f32_16x16x32_bf16 a[184:187], v[132:135], v[72:75], a[184:187]
    v_mfma_f32_16x16x32_bf16 a[188:191], v[128:131], v[48:51], a[188:191]
    v_mfma_f32_16x16x32_bf16 a[188:191], v[132:135], v[76:79], a[188:191]
    s_add_u32 s28, s49, s93
    buffer_load_dwordx4 v26, s[16:19], s28 offen lds
    v_mfma_f32_16x16x32_bf16 a[192:195], v[128:131], v[52:55], a[192:195]
    s_add_u32 m0, m0, s53
    v_mfma_f32_16x16x32_bf16 a[192:195], v[132:135], v[80:83], a[192:195]
    ds_read_b64_tr_b16 v[128:129], v11 offset:16960
    v_mfma_f32_16x16x32_bf16 a[196:199], v[136:139], v[28:31], a[196:199]
    ds_read_b64_tr_b16 v[130:131], v11 offset:17088
    v_mfma_f32_16x16x32_bf16 a[196:199], v[140:143], v[56:59], a[196:199]
    ds_read_b64_tr_b16 v[132:133], v11 offset:17472
    v_mfma_f32_16x16x32_bf16 a[200:203], v[136:139], v[32:35], a[200:203]
    ds_read_b64_tr_b16 v[134:135], v11 offset:17600
    v_mfma_f32_16x16x32_bf16 a[200:203], v[140:143], v[60:63], a[200:203]
    s_add_u32 s28, s49, s47
    buffer_load_dwordx4 v26, s[16:19], s28 offen lds
    v_mfma_f32_16x16x32_bf16 a[204:207], v[136:139], v[36:39], a[204:207]
    s_add_u32 m0, m0, s53
    v_mfma_f32_16x16x32_bf16 a[204:207], v[140:143], v[64:67], a[204:207]
    v_mfma_f32_16x16x32_bf16 a[208:211], v[136:139], v[40:43], a[208:211]
    v_mfma_f32_16x16x32_bf16 a[208:211], v[140:143], v[68:71], a[208:211]
    v_mfma_f32_16x16x32_bf16 a[212:215], v[136:139], v[44:47], a[212:215]
    v_mfma_f32_16x16x32_bf16 a[212:215], v[140:143], v[72:75], a[212:215]
    s_add_u32 s28, s49, s98
    buffer_load_dwordx4 v26, s[16:19], s28 offen lds
    v_mfma_f32_16x16x32_bf16 a[216:219], v[136:139], v[48:51], a[216:219]
    v_mfma_f32_16x16x32_bf16 a[216:219], v[140:143], v[76:79], a[216:219]
    v_mfma_f32_16x16x32_bf16 a[220:223], v[136:139], v[52:55], a[220:223]
    v_mfma_f32_16x16x32_bf16 a[220:223], v[140:143], v[80:83], a[220:223]
    ds_read_b64_tr_b16 v[136:137], v11 offset:16992
    ds_read_b64_tr_b16 v[138:139], v11 offset:17120
    ds_read_b64_tr_b16 v[140:141], v11 offset:17504
    ds_read_b64_tr_b16 v[142:143], v11 offset:17632
    s_waitcnt lgkmcnt(8)
    v_mfma_f32_16x16x32_bf16 v[144:147], v[112:115], a[0:3], v[144:147]
    s_add_u32 m0, s33, 16896
    v_mfma_f32_16x16x32_bf16 v[144:147], v[116:119], a[28:31], v[144:147]
    s_mov_b32 s49, s50
    v_mfma_f32_16x16x32_bf16 v[148:151], v[112:115], a[4:7], v[148:151]
    v_mfma_f32_16x16x32_bf16 v[148:151], v[116:119], a[32:35], v[148:151]
    v_mfma_f32_16x16x32_bf16 v[152:155], v[112:115], a[8:11], v[152:155]
    v_mfma_f32_16x16x32_bf16 v[152:155], v[116:119], a[36:39], v[152:155]
    v_mfma_f32_16x16x32_bf16 v[156:159], v[112:115], a[12:15], v[156:159]
    s_waitcnt vmcnt(16) lgkmcnt(0)
    s_barrier
    v_mfma_f32_16x16x32_bf16 v[156:159], v[116:119], a[40:43], v[156:159]
    v_mfma_f32_16x16x32_bf16 v[160:163], v[112:115], a[16:19], v[160:163]
    v_mfma_f32_16x16x32_bf16 v[160:163], v[116:119], a[44:47], v[160:163]
    s_add_u32 s28, s49, s88
    buffer_load_dwordx4 v26, s[16:19], s28 offen lds
    v_mfma_f32_16x16x32_bf16 v[164:167], v[112:115], a[20:23], v[164:167]
    s_add_u32 m0, m0, s53
    v_mfma_f32_16x16x32_bf16 v[164:167], v[116:119], a[48:51], v[164:167]
    v_mfma_f32_16x16x32_bf16 v[168:171], v[112:115], a[24:27], v[168:171]
    v_mfma_f32_16x16x32_bf16 v[168:171], v[116:119], a[52:55], v[168:171]
    ds_read_b64_tr_b16 v[112:113], v11 offset:25344
    v_mfma_f32_16x16x32_bf16 v[172:175], v[120:123], a[0:3], v[172:175]
    ds_read_b64_tr_b16 v[114:115], v11 offset:25472
    v_mfma_f32_16x16x32_bf16 v[172:175], v[124:127], a[28:31], v[172:175]
    s_add_u32 s28, s49, s89
    buffer_load_dwordx4 v26, s[16:19], s28 offen lds
    v_mfma_f32_16x16x32_bf16 v[176:179], v[120:123], a[4:7], v[176:179]
    s_add_u32 m0, m0, s53
    ds_read_b64_tr_b16 v[116:117], v11 offset:25856
    v_mfma_f32_16x16x32_bf16 v[176:179], v[124:127], a[32:35], v[176:179]
    ds_read_b64_tr_b16 v[118:119], v11 offset:25984
    v_mfma_f32_16x16x32_bf16 v[180:183], v[120:123], a[8:11], v[180:183]
    v_mfma_f32_16x16x32_bf16 v[180:183], v[124:127], a[36:39], v[180:183]
    v_mfma_f32_16x16x32_bf16 v[184:187], v[120:123], a[12:15], v[184:187]
    v_mfma_f32_16x16x32_bf16 v[184:187], v[124:127], a[40:43], v[184:187]
    s_add_u32 s28, s49, s90
    buffer_load_dwordx4 v26, s[16:19], s28 offen lds
    v_mfma_f32_16x16x32_bf16 v[188:191], v[120:123], a[16:19], v[188:191]
    s_add_u32 m0, m0, s53
    v_mfma_f32_16x16x32_bf16 v[188:191], v[124:127], a[44:47], v[188:191]
    v_mfma_f32_16x16x32_bf16 v[192:195], v[120:123], a[20:23], v[192:195]
    v_mfma_f32_16x16x32_bf16 v[192:195], v[124:127], a[48:51], v[192:195]
    v_mfma_f32_16x16x32_bf16 v[196:199], v[120:123], a[24:27], v[196:199]
    v_mfma_f32_16x16x32_bf16 v[196:199], v[124:127], a[52:55], v[196:199]
    s_add_u32 s28, s49, s91
    buffer_load_dwordx4 v26, s[16:19], s28 offen lds
    v_mfma_f32_16x16x32_bf16 v[200:203], v[128:131], a[0:3], v[200:203]
    s_add_u32 m0, m0, s53
    ds_read_b64_tr_b16 v[120:121], v11 offset:25376
    v_mfma_f32_16x16x32_bf16 v[200:203], v[132:135], a[28:31], v[200:203]
    ds_read_b64_tr_b16 v[122:123], v11 offset:25504
    v_mfma_f32_16x16x32_bf16 v[204:207], v[128:131], a[4:7], v[204:207]
    ds_read_b64_tr_b16 v[124:125], v11 offset:25888
    v_mfma_f32_16x16x32_bf16 v[204:207], v[132:135], a[32:35], v[204:207]
    ds_read_b64_tr_b16 v[126:127], v11 offset:26016
    v_mfma_f32_16x16x32_bf16 v[208:211], v[128:131], a[8:11], v[208:211]
    v_mfma_f32_16x16x32_bf16 v[208:211], v[132:135], a[36:39], v[208:211]
    s_add_u32 s28, s49, s92
    buffer_load_dwordx4 v26, s[16:19], s28 offen lds
    v_mfma_f32_16x16x32_bf16 v[212:215], v[128:131], a[12:15], v[212:215]
    s_add_u32 m0, m0, s53
    v_mfma_f32_16x16x32_bf16 v[212:215], v[132:135], a[40:43], v[212:215]
    v_mfma_f32_16x16x32_bf16 v[216:219], v[128:131], a[16:19], v[216:219]
    v_mfma_f32_16x16x32_bf16 v[216:219], v[132:135], a[44:47], v[216:219]
    v_mfma_f32_16x16x32_bf16 v[220:223], v[128:131], a[20:23], v[220:223]
    v_mfma_f32_16x16x32_bf16 v[220:223], v[132:135], a[48:51], v[220:223]
    s_add_u32 s28, s49, s93
    buffer_load_dwordx4 v26, s[16:19], s28 offen lds
    v_mfma_f32_16x16x32_bf16 v[224:227], v[128:131], a[24:27], v[224:227]
    s_add_u32 m0, m0, s53
    v_mfma_f32_16x16x32_bf16 v[224:227], v[132:135], a[52:55], v[224:227]
    ds_read_b64_tr_b16 v[128:129], v11 offset:25408
    v_mfma_f32_16x16x32_bf16 v[228:231], v[136:139], a[0:3], v[228:231]
    ds_read_b64_tr_b16 v[130:131], v11 offset:25536
    v_mfma_f32_16x16x32_bf16 v[228:231], v[140:143], a[28:31], v[228:231]
    ds_read_b64_tr_b16 v[132:133], v11 offset:25920
    v_mfma_f32_16x16x32_bf16 v[232:235], v[136:139], a[4:7], v[232:235]
    ds_read_b64_tr_b16 v[134:135], v11 offset:26048
    v_mfma_f32_16x16x32_bf16 v[232:235], v[140:143], a[32:35], v[232:235]
    s_add_u32 s28, s49, s94
    buffer_load_dwordx4 v26, s[16:19], s28 offen lds
    v_mfma_f32_16x16x32_bf16 v[236:239], v[136:139], a[8:11], v[236:239]
    s_add_u32 m0, m0, s53
    v_mfma_f32_16x16x32_bf16 v[236:239], v[140:143], a[36:39], v[236:239]
    v_mfma_f32_16x16x32_bf16 v[240:243], v[136:139], a[12:15], v[240:243]
    v_mfma_f32_16x16x32_bf16 v[240:243], v[140:143], a[40:43], v[240:243]
    v_mfma_f32_16x16x32_bf16 v[244:247], v[136:139], a[16:19], v[244:247]
    v_mfma_f32_16x16x32_bf16 v[244:247], v[140:143], a[44:47], v[244:247]
    s_add_u32 s28, s49, s95
    buffer_load_dwordx4 v26, s[16:19], s28 offen lds
    v_mfma_f32_16x16x32_bf16 v[248:251], v[136:139], a[20:23], v[248:251]
    v_mfma_f32_16x16x32_bf16 v[248:251], v[140:143], a[48:51], v[248:251]
    v_mfma_f32_16x16x32_bf16 v[252:255], v[136:139], a[24:27], v[252:255]
    v_mfma_f32_16x16x32_bf16 v[252:255], v[140:143], a[52:55], v[252:255]
    ds_read_b64_tr_b16 v[136:137], v11 offset:25440
    ds_read_b64_tr_b16 v[138:139], v11 offset:25568
    ds_read_b64_tr_b16 v[140:141], v11 offset:25952
    ds_read_b64_tr_b16 v[142:143], v11 offset:26080
    s_waitcnt lgkmcnt(8)
    v_mfma_f32_16x16x32_bf16 a[112:115], v[112:115], a[0:3], a[112:115]
    s_add_u32 m0, s33, 25344
    v_mfma_f32_16x16x32_bf16 a[112:115], v[116:119], a[28:31], a[112:115]
    s_add_u32 s49, s50, s46
    v_mfma_f32_16x16x32_bf16 a[116:119], v[112:115], a[4:7], a[116:119]
    s_lshl1_add_u32 s50, s51, s50
    v_mfma_f32_16x16x32_bf16 a[116:119], v[116:119], a[32:35], a[116:119]
    s_add_u32 s82, s82, 2
    v_mfma_f32_16x16x32_bf16 a[120:123], v[112:115], a[8:11], a[120:123]
    s_cmp_eq_u32 s82, 20
    v_mfma_f32_16x16x32_bf16 a[120:123], v[116:119], a[36:39], a[120:123]
    s_cselect_b32 s29, s83, 0
    v_mfma_f32_16x16x32_bf16 a[124:127], v[112:115], a[12:15], a[124:127]
    s_sub_u32 s50, s50, s29
    s_waitcnt vmcnt(8) lgkmcnt(0)
    s_barrier
    v_mfma_f32_16x16x32_bf16 a[124:127], v[116:119], a[40:43], a[124:127]
    v_mfma_f32_16x16x32_bf16 a[128:131], v[112:115], a[16:19], a[128:131]
    v_mfma_f32_16x16x32_bf16 a[128:131], v[116:119], a[44:47], a[128:131]
    s_add_u32 s28, s49, s88
    buffer_load_dwordx4 v26, s[16:19], s28 offen lds
    v_mfma_f32_16x16x32_bf16 a[132:135], v[112:115], a[20:23], a[132:135]
    s_add_u32 m0, m0, s53
    v_mfma_f32_16x16x32_bf16 a[132:135], v[116:119], a[48:51], a[132:135]
    v_mfma_f32_16x16x32_bf16 a[136:139], v[112:115], a[24:27], a[136:139]
    v_mfma_f32_16x16x32_bf16 a[136:139], v[116:119], a[52:55], a[136:139]
    v_mfma_f32_16x16x32_bf16 a[140:143], v[120:123], a[0:3], a[140:143]
    v_mfma_f32_16x16x32_bf16 a[140:143], v[124:127], a[28:31], a[140:143]
    s_add_u32 s28, s49, s89
    buffer_load_dwordx4 v26, s[16:19], s28 offen lds
    v_mfma_f32_16x16x32_bf16 a[144:147], v[120:123], a[4:7], a[144:147]
    s_add_u32 m0, m0, s53
    v_mfma_f32_16x16x32_bf16 a[144:147], v[124:127], a[32:35], a[144:147]
    v_mfma_f32_16x16x32_bf16 a[148:151], v[120:123], a[8:11], a[148:151]
    v_mfma_f32_16x16x32_bf16 a[148:151], v[124:127], a[36:39], a[148:151]
    v_mfma_f32_16x16x32_bf16 a[152:155], v[120:123], a[12:15], a[152:155]
    v_mfma_f32_16x16x32_bf16 a[152:155], v[124:127], a[40:43], a[152:155]
    s_add_u32 s28, s49, s90
    buffer_load_dwordx4 v26, s[16:19], s28 offen lds
    v_mfma_f32_16x16x32_bf16 a[156:159], v[120:123], a[16:19], a[156:159]
    s_add_u32 m0, m0, s53
    v_mfma_f32_16x16x32_bf16 a[156:159], v[124:127], a[44:47], a[156:159]
    v_mfma_f32_16x16x32_bf16 a[160:163], v[120:123], a[20:23], a[160:163]
    v_mfma_f32_16x16x32_bf16 a[160:163], v[124:127], a[48:51], a[160:163]
    v_mfma_f32_16x16x32_bf16 a[164:167], v[120:123], a[24:27], a[164:167]
    v_mfma_f32_16x16x32_bf16 a[164:167], v[124:127], a[52:55], a[164:167]
    s_add_u32 s28, s49, s91
    buffer_load_dwordx4 v26, s[16:19], s28 offen lds
    v_mfma_f32_16x16x32_bf16 a[168:171], v[128:131], a[0:3], a[168:171]
    s_add_u32 m0, m0, s53
    v_mfma_f32_16x16x32_bf16 a[168:171], v[132:135], a[28:31], a[168:171]
    v_mfma_f32_16x16x32_bf16 a[172:175], v[128:131], a[4:7], a[172:175]
    v_mfma_f32_16x16x32_bf16 a[172:175], v[132:135], a[32:35], a[172:175]
    v_mfma_f32_16x16x32_bf16 a[176:179], v[128:131], a[8:11], a[176:179]
    v_mfma_f32_16x16x32_bf16 a[176:179], v[132:135], a[36:39], a[176:179]
    s_add_u32 s28, s49, s92
    buffer_load_dwordx4 v26, s[16:19], s28 offen lds
    v_mfma_f32_16x16x32_bf16 a[180:183], v[128:131], a[12:15], a[180:183]
    s_add_u32 m0, m0, s53
    v_mfma_f32_16x16x32_bf16 a[180:183], v[132:135], a[40:43], a[180:183]
    v_mfma_f32_16x16x32_bf16 a[184:187], v[128:131], a[16:19], a[184:187]
    v_mfma_f32_16x16x32_bf16 a[184:187], v[132:135], a[44:47], a[184:187]
    v_mfma_f32_16x16x32_bf16 a[188:191], v[128:131], a[20:23], a[188:191]
    v_mfma_f32_16x16x32_bf16 a[188:191], v[132:135], a[48:51], a[188:191]
    s_add_u32 s28, s49, s93
    buffer_load_dwordx4 v26, s[16:19], s28 offen lds
    v_mfma_f32_16x16x32_bf16 a[192:195], v[128:131], a[24:27], a[192:195]
    s_add_u32 m0, m0, s53
    v_mfma_f32_16x16x32_bf16 a[192:195], v[132:135], a[52:55], a[192:195]
    v_mfma_f32_16x16x32_bf16 a[196:199], v[136:139], a[0:3], a[196:199]
    v_mfma_f32_16x16x32_bf16 a[196:199], v[140:143], a[28:31], a[196:199]
    v_mfma_f32_16x16x32_bf16 a[200:203], v[136:139], a[4:7], a[200:203]
    v_mfma_f32_16x16x32_bf16 a[200:203], v[140:143], a[32:35], a[200:203]
    s_add_u32 s28, s49, s47
    buffer_load_dwordx4 v26, s[16:19], s28 offen lds
    v_mfma_f32_16x16x32_bf16 a[204:207], v[136:139], a[8:11], a[204:207]
    s_add_u32 m0, m0, s53
    v_mfma_f32_16x16x32_bf16 a[204:207], v[140:143], a[36:39], a[204:207]
    v_mfma_f32_16x16x32_bf16 a[208:211], v[136:139], a[12:15], a[208:211]
    v_mfma_f32_16x16x32_bf16 a[208:211], v[140:143], a[40:43], a[208:211]
    v_mfma_f32_16x16x32_bf16 a[212:215], v[136:139], a[16:19], a[212:215]
    v_mfma_f32_16x16x32_bf16 a[212:215], v[140:143], a[44:47], a[212:215]
    s_add_u32 s28, s49, s98
    buffer_load_dwordx4 v26, s[16:19], s28 offen lds
    v_mfma_f32_16x16x32_bf16 a[216:219], v[136:139], a[20:23], a[216:219]
    v_mfma_f32_16x16x32_bf16 a[216:219], v[140:143], a[48:51], a[216:219]
    v_mfma_f32_16x16x32_bf16 a[220:223], v[136:139], a[24:27], a[220:223]
    v_mfma_f32_16x16x32_bf16 a[220:223], v[140:143], a[52:55], a[220:223]
L_at_qpepi:
    v_mov_b32 v4, s54
    v_mov_b32 v5, s54
    s_nop 6
    v_pk_mul_f32 v[144:145], v[144:145], v[4:5]
    v_pk_mul_f32 v[146:147], v[146:147], v[4:5]
    v_pk_mul_f32 v[148:149], v[148:149], v[4:5]
    v_pk_mul_f32 v[150:151], v[150:151], v[4:5]
    v_pk_mul_f32 v[152:153], v[152:153], v[4:5]
    v_pk_mul_f32 v[154:155], v[154:155], v[4:5]
    v_pk_mul_f32 v[156:157], v[156:157], v[4:5]
    v_pk_mul_f32 v[158:159], v[158:159], v[4:5]
    v_pk_mul_f32 v[160:161], v[160:161], v[4:5]
    v_pk_mul_f32 v[162:163], v[162:163], v[4:5]
    v_pk_mul_f32 v[164:165], v[164:165], v[4:5]
    v_pk_mul_f32 v[166:167], v[166:167], v[4:5]
    v_pk_mul_f32 v[168:169], v[168:169], v[4:5]
    v_pk_mul_f32 v[170:171], v[170:171], v[4:5]
    v_pk_mul_f32 v[172:173], v[172:173], v[4:5]
    v_pk_mul_f32 v[174:175], v[174:175], v[4:5]
    v_pk_mul_f32 v[176:177], v[176:177], v[4:5]
    v_pk_mul_f32 v[178:179], v[178:179], v[4:5]
    v_pk_mul_f32 v[180:181], v[180:181], v[4:5]
    v_pk_mul_f32 v[182:183], v[182:183], v[4:5]
    v_pk_mul_f32 v[184:185], v[184:185], v[4:5]
    v_pk_mul_f32 v[186:187], v[186:187], v[4:5]
    v_pk_mul_f32 v[188:189], v[188:189], v[4:5]
    v_pk_mul_f32 v[190:191], v[190:191], v[4:5]
    v_pk_mul_f32 v[192:193], v[192:193], v[4:5]
    v_pk_mul_f32 v[194:195], v[194:195], v[4:5]
    v_pk_mul_f32 v[196:197], v[196:197], v[4:5]
    v_pk_mul_f32 v[198:199], v[198:199], v[4:5]
    v_cvt_pk_bf16_f32 v88, v144, v145
    v_cvt_pk_bf16_f32 v89, v146, v147
    v_cvt_pk_bf16_f32 v90, v172, v173
    v_cvt_pk_bf16_f32 v91, v174, v175
    v_cvt_pk_bf16_f32 v92, v148, v149
    v_cvt_pk_bf16_f32 v93, v150, v151
    v_cvt_pk_bf16_f32 v94, v176, v177
    v_cvt_pk_bf16_f32 v95, v178, v179
    v_cvt_pk_bf16_f32 v96, v152, v153
    v_cvt_pk_bf16_f32 v97, v154, v155
    v_cvt_pk_bf16_f32 v98, v180, v181
    v_cvt_pk_bf16_f32 v99, v182, v183
    v_cvt_pk_bf16_f32 v100, v156, v157
    v_cvt_pk_bf16_f32 v101, v158, v159
    v_cvt_pk_bf16_f32 v102, v184, v185
    v_cvt_pk_bf16_f32 v103, v186, v187
    v_cvt_pk_bf16_f32 v104, v160, v161
    v_cvt_pk_bf16_f32 v105, v162, v163
    v_cvt_pk_bf16_f32 v106, v188, v189
    v_cvt_pk_bf16_f32 v107, v190, v191
    v_cvt_pk_bf16_f32 v108, v164, v165
    v_cvt_pk_bf16_f32 v109, v166, v167
    v_cvt_pk_bf16_f32 v110, v192, v193
    v_cvt_pk_bf16_f32 v111, v194, v195
    v_cvt_pk_bf16_f32 v112, v168, v169
    v_cvt_pk_bf16_f32 v113, v170, v171
    v_cvt_pk_bf16_f32 v114, v196, v197
    v_cvt_pk_bf16_f32 v115, v198, v199
    s_nop 1
    v_permlane16_swap_b32 v88, v90
    v_permlane16_swap_b32 v89, v91
    v_permlane16_swap_b32 v92, v94
    v_permlane16_swap_b32 v93, v95
    v_permlane16_swap_b32 v96, v98
    v_permlane16_swap_b32 v97, v99
    v_permlane16_swap_b32 v100, v102
    v_permlane16_swap_b32 v101, v103
    v_permlane16_swap_b32 v104, v106
    v_permlane16_swap_b32 v105, v107
    v_permlane16_swap_b32 v108, v110
    v_permlane16_swap_b32 v109, v111
    v_permlane16_swap_b32 v112, v114
    v_permlane16_swap_b32 v113, v115
    v_accvgpr_write_b32 a0, v88
    v_accvgpr_write_b32 a1, v89
    v_accvgpr_write_b32 a2, v90
    v_accvgpr_write_b32 a3, v91
    v_accvgpr_write_b32 a16, v92
    v_accvgpr_write_b32 a17, v93
    v_accvgpr_write_b32 a18, v94
    v_accvgpr_write_b32 a19, v95
    v_accvgpr_write_b32 a32, v96
    v_accvgpr_write_b32 a33, v97
    v_accvgpr_write_b32 a34, v98
    v_accvgpr_write_b32 a35, v99
    v_accvgpr_write_b32 a48, v100
    v_accvgpr_write_b32 a49, v101
    v_accvgpr_write_b32 a50, v102
    v_accvgpr_write_b32 a51, v103
    v_accvgpr_write_b32 a64, v104
    v_accvgpr_write_b32 a65, v105
    v_accvgpr_write_b32 a66, v106
    v_accvgpr_write_b32 a67, v107
    v_accvgpr_write_b32 a80, v108
    v_accvgpr_write_b32 a81, v109
    v_accvgpr_write_b32 a82, v110
    v_accvgpr_write_b32 a83, v111
    v_accvgpr_write_b32 a96, v112
    v_accvgpr_write_b32 a97, v113
    v_accvgpr_write_b32 a98, v114
    v_accvgpr_write_b32 a99, v115
    v_pk_mul_f32 v[200:201], v[200:201], v[4:5]
    v_pk_mul_f32 v[202:203], v[202:203], v[4:5]
    v_pk_mul_f32 v[204:205], v[204:205], v[4:5]
    v_pk_mul_f32 v[206:207], v[206:207], v[4:5]
    v_pk_mul_f32 v[208:209], v[208:209], v[4:5]
    v_pk_mul_f32 v[210:211], v[210:211], v[4:5]
    v_pk_mul_f32 v[212:213], v[212:213], v[4:5]
    v_pk_mul_f32 v[214:215], v[214:215], v[4:5]
    v_pk_mul_f32 v[216:217], v[216:217], v[4:5]
    v_pk_mul_f32 v[218:219], v[218:219], v[4:5]
    v_pk_mul_f32 v[220:221], v[220:221], v[4:5]
    v_pk_mul_f32 v[222:223], v[222:223], v[4:5]
    v_pk_mul_f32 v[224:225], v[224:225], v[4:5]
    v_pk_mul_f32 v[226:227], v[226:227], v[4:5]
    v_pk_mul_f32 v[228:229], v[228:229], v[4:5]
    v_pk_mul_f32 v[230:231], v[230:231], v[4:5]
    v_pk_mul_f32 v[232:233], v[232:233], v[4:5]
    v_pk_mul_f32 v[234:235], v[234:235], v[4:5]
    v_pk_mul_f32 v[236:237], v[236:237], v[4:5]
    v_pk_mul_f32 v[238:239], v[238:239], v[4:5]
    v_pk_mul_f32 v[240:241], v[240:241], v[4:5]
    v_pk_mul_f32 v[242:243], v[242:243], v[4:5]
    v_pk_mul_f32 v[244:245], v[244:245], v[4:5]
    v_pk_mul_f32 v[246:247], v[246:247], v[4:5]
    v_pk_mul_f32 v[248:249], v[248:249], v[4:5]
    v_pk_mul_f32 v[250:251], v[250:251], v[4:5]
    v_pk_mul_f32 v[252:253], v[252:253], v[4:5]
    v_pk_mul_f32 v[254:255], v[254:255], v[4:5]
    v_cvt_pk_bf16_f32 v116, v200, v201
    v_cvt_pk_bf16_f32 v117, v202, v203
    v_cvt_pk_bf16_f32 v118, v228, v229
    v_cvt_pk_bf16_f32 v119, v230, v231
    v_cvt_pk_bf16_f32 v120, v204, v205
    v_cvt_pk_bf16_f32 v121, v206, v207
    v_cvt_pk_bf16_f32 v122, v232, v233
    v_cvt_pk_bf16_f32 v123, v234, v235
    v_cvt_pk_bf16_f32 v124, v208, v209
    v_cvt_pk_bf16_f32 v125, v210, v211
    v_cvt_pk_bf16_f32 v126, v236, v237
    v_cvt_pk_bf16_f32 v127, v238, v239
    v_cvt_pk_bf16_f32 v128, v212, v213
    v_cvt_pk_bf16_f32 v129, v214, v215
    v_cvt_pk_bf16_f32 v130, v240, v241
    v_cvt_pk_bf16_f32 v131, v242, v243
    v_cvt_pk_bf16_f32 v132, v216, v217
    v_cvt_pk_bf16_f32 v133, v218, v219
    v_cvt_pk_bf16_f32 v134, v244, v245
    v_cvt_pk_bf16_f32 v135, v246, v247
    v_cvt_pk_bf16_f32 v136, v220, v221
    v_cvt_pk_bf16_f32 v137, v222, v223
    v_cvt_pk_bf16_f32 v138, v248, v249
    v_cvt_pk_bf16_f32 v139, v250, v251
    v_cvt_pk_bf16_f32 v140, v224, v225
    v_cvt_pk_bf16_f32 v141, v226, v227
    v_cvt_pk_bf16_f32 v142, v252, v253
    v_cvt_pk_bf16_f32 v143, v254, v255
    s_nop 1
    v_permlane16_swap_b32 v116, v118
    v_permlane16_swap_b32 v117, v119
    v_permlane16_swap_b32 v120, v122
    v_permlane16_swap_b32 v121, v123
    v_permlane16_swap_b32 v124, v126
    v_permlane16_swap_b32 v125, v127
    v_permlane16_swap_b32 v128, v130
    v_permlane16_swap_b32 v129, v131
    v_permlane16_swap_b32 v132, v134
    v_permlane16_swap_b32 v133, v135
    v_permlane16_swap_b32 v136, v138
    v_permlane16_swap_b32 v137, v139
    v_permlane16_swap_b32 v140, v142
    v_permlane16_swap_b32 v141, v143
    v_accvgpr_write_b32 a4, v116
    v_accvgpr_write_b32 a5, v117
    v_accvgpr_write_b32 a6, v118
    v_accvgpr_write_b32 a7, v119
    v_accvgpr_write_b32 a20, v120
    v_accvgpr_write_b32 a21, v121
    v_accvgpr_write_b32 a22, v122
    v_accvgpr_write_b32 a23, v123
    v_accvgpr_write_b32 a36, v124
    v_accvgpr_write_b32 a37, v125
    v_accvgpr_write_b32 a38, v126
    v_accvgpr_write_b32 a39, v127
    v_accvgpr_write_b32 a52, v128
    v_accvgpr_write_b32 a53, v129
    v_accvgpr_write_b32 a54, v130
    v_accvgpr_write_b32 a55, v131
    v_accvgpr_write_b32 a68, v132
    v_accvgpr_write_b32 a69, v133
    v_accvgpr_write_b32 a70, v134
    v_accvgpr_write_b32 a71, v135
    v_accvgpr_write_b32 a84, v136
    v_accvgpr_write_b32 a85, v137
    v_accvgpr_write_b32 a86, v138
    v_accvgpr_write_b32 a87, v139
    v_accvgpr_write_b32 a100, v140
    v_accvgpr_write_b32 a101, v141
    v_accvgpr_write_b32 a102, v142
    v_accvgpr_write_b32 a103, v143
    v_accvgpr_read_b32 v144, a112
    v_accvgpr_read_b32 v145, a113
    v_accvgpr_read_b32 v146, a114
    v_accvgpr_read_b32 v147, a115
    v_accvgpr_read_b32 v148, a116
    v_accvgpr_read_b32 v149, a117
    v_accvgpr_read_b32 v150, a118
    v_accvgpr_read_b32 v151, a119
    v_accvgpr_read_b32 v152, a120
    v_accvgpr_read_b32 v153, a121
    v_accvgpr_read_b32 v154, a122
    v_accvgpr_read_b32 v155, a123
    v_accvgpr_read_b32 v156, a124
    v_accvgpr_read_b32 v157, a125
    v_accvgpr_read_b32 v158, a126
    v_accvgpr_read_b32 v159, a127
    v_accvgpr_read_b32 v160, a128
    v_accvgpr_read_b32 v161, a129
    v_accvgpr_read_b32 v162, a130
    v_accvgpr_read_b32 v163, a131
    v_accvgpr_read_b32 v164, a132
    v_accvgpr_read_b32 v165, a133
    v_accvgpr_read_b32 v166, a134
    v_accvgpr_read_b32 v167, a135
    v_accvgpr_read_b32 v168, a136
    v_accvgpr_read_b32 v169, a137
    v_accvgpr_read_b32 v170, a138
    v_accvgpr_read_b32 v171, a139
    v_accvgpr_read_b32 v172, a140
    v_accvgpr_read_b32 v173, a141
    v_accvgpr_read_b32 v174, a142
    v_accvgpr_read_b32 v175, a143
    v_accvgpr_read_b32 v176, a144
    v_accvgpr_read_b32 v177, a145
    v_accvgpr_read_b32 v178, a146
    v_accvgpr_read_b32 v179, a147
    v_accvgpr_read_b32 v180, a148
    v_accvgpr_read_b32 v181, a149
    v_accvgpr_read_b32 v182, a150
    v_accvgpr_read_b32 v183, a151
    v_accvgpr_read_b32 v184, a152
    v_accvgpr_read_b32 v185, a153
    v_accvgpr_read_b32 v186, a154
    v_accvgpr_read_b32 v187, a155
    v_accvgpr_read_b32 v188, a156
    v_accvgpr_read_b32 v189, a157
    v_accvgpr_read_b32 v190, a158
    v_accvgpr_read_b32 v191, a159
    v_accvgpr_read_b32 v192, a160
    v_accvgpr_read_b32 v193, a161
    v_accvgpr_read_b32 v194, a162
    v_accvgpr_read_b32 v195, a163
    v_accvgpr_read_b32 v196, a164
    v_accvgpr_read_b32 v197, a165
    v_accvgpr_read_b32 v198, a166
    v_accvgpr_read_b32 v199, a167
    v_pk_mul_f32 v[144:145], v[144:145], v[4:5]
    v_pk_mul_f32 v[146:147], v[146:147], v[4:5]
    v_pk_mul_f32 v[148:149], v[148:149], v[4:5]
    v_pk_mul_f32 v[150:151], v[150:151], v[4:5]
    v_pk_mul_f32 v[152:153], v[152:153], v[4:5]
    v_pk_mul_f32 v[154:155], v[154:155], v[4:5]
    v_pk_mul_f32 v[156:157], v[156:157], v[4:5]
    v_pk_mul_f32 v[158:159], v[158:159], v[4:5]
    v_pk_mul_f32 v[160:161], v[160:161], v[4:5]
    v_pk_mul_f32 v[162:163], v[162:163], v[4:5]
    v_pk_mul_f32 v[164:165], v[164:165], v[4:5]
    v_pk_mul_f32 v[166:167], v[166:167], v[4:5]
    v_pk_mul_f32 v[168:169], v[168:169], v[4:5]
    v_pk_mul_f32 v[170:171], v[170:171], v[4:5]
    v_pk_mul_f32 v[172:173], v[172:173], v[4:5]
    v_pk_mul_f32 v[174:175], v[174:175], v[4:5]
    v_pk_mul_f32 v[176:177], v[176:177], v[4:5]
    v_pk_mul_f32 v[178:179], v[178:179], v[4:5]
    v_pk_mul_f32 v[180:181], v[180:181], v[4:5]
    v_pk_mul_f32 v[182:183], v[182:183], v[4:5]
    v_pk_mul_f32 v[184:185], v[184:185], v[4:5]
    v_pk_mul_f32 v[186:187], v[186:187], v[4:5]
    v_pk_mul_f32 v[188:189], v[188:189], v[4:5]
    v_pk_mul_f32 v[190:191], v[190:191], v[4:5]
    v_pk_mul_f32 v[192:193], v[192:193], v[4:5]
    v_pk_mul_f32 v[194:195], v[194:195], v[4:5]
    v_pk_mul_f32 v[196:197], v[196:197], v[4:5]
    v_pk_mul_f32 v[198:199], v[198:199], v[4:5]
    v_cvt_pk_bf16_f32 v88, v144, v145
    v_cvt_pk_bf16_f32 v89, v146, v147
    v_cvt_pk_bf16_f32 v90, v172, v173
    v_cvt_pk_bf16_f32 v91, v174, v175
    v_cvt_pk_bf16_f32 v92, v148, v149
    v_cvt_pk_bf16_f32 v93, v150, v151
    v_cvt_pk_bf16_f32 v94, v176, v177
    v_cvt_pk_bf16_f32 v95, v178, v179
    v_cvt_pk_bf16_f32 v96, v152, v153
    v_cvt_pk_bf16_f32 v97, v154, v155
    v_cvt_pk_bf16_f32 v98, v180, v181
    v_cvt_pk_bf16_f32 v99, v182, v183
    v_cvt_pk_bf16_f32 v100, v156, v157
    v_cvt_pk_bf16_f32 v101, v158, v159
    v_cvt_pk_bf16_f32 v102, v184, v185
    v_cvt_pk_bf16_f32 v103, v186, v187
    v_cvt_pk_bf16_f32 v104, v160, v161
    v_cvt_pk_bf16_f32 v105, v162, v163
    v_cvt_pk_bf16_f32 v106, v188, v189
    v_cvt_pk_bf16_f32 v107, v190, v191
    v_cvt_pk_bf16_f32 v108, v164, v165
    v_cvt_pk_bf16_f32 v109, v166, v167
    v_cvt_pk_bf16_f32 v110, v192, v193
    v_cvt_pk_bf16_f32 v111, v194, v195
    v_cvt_pk_bf16_f32 v112, v168, v169
    v_cvt_pk_bf16_f32 v113, v170, v171
    v_cvt_pk_bf16_f32 v114, v196, v197
    v_cvt_pk_bf16_f32 v115, v198, v199
    s_nop 1
    v_permlane16_swap_b32 v88, v90
    v_permlane16_swap_b32 v89, v91
    v_permlane16_swap_b32 v92, v94
    v_permlane16_swap_b32 v93, v95
    v_permlane16_swap_b32 v96, v98
    v_permlane16_swap_b32 v97, v99
    v_permlane16_swap_b32 v100, v102
    v_permlane16_swap_b32 v101, v103
    v_permlane16_swap_b32 v104, v106
    v_permlane16_swap_b32 v105, v107
    v_permlane16_swap_b32 v108, v110
    v_permlane16_swap_b32 v109, v111
    v_permlane16_swap_b32 v112, v114
    v_permlane16_swap_b32 v113, v115
    v_accvgpr_write_b32 a8, v88
    v_accvgpr_write_b32 a9, v89
    v_accvgpr_write_b32 a10, v90
    v_accvgpr_write_b32 a11, v91
    v_accvgpr_write_b32 a24, v92
    v_accvgpr_write_b32 a25, v93
    v_accvgpr_write_b32 a26, v94
    v_accvgpr_write_b32 a27, v95
    v_accvgpr_write_b32 a40, v96
    v_accvgpr_write_b32 a41, v97
    v_accvgpr_write_b32 a42, v98
    v_accvgpr_write_b32 a43, v99
    v_accvgpr_write_b32 a56, v100
    v_accvgpr_write_b32 a57, v101
    v_accvgpr_write_b32 a58, v102
    v_accvgpr_write_b32 a59, v103
    v_accvgpr_write_b32 a72, v104
    v_accvgpr_write_b32 a73, v105
    v_accvgpr_write_b32 a74, v106
    v_accvgpr_write_b32 a75, v107
    v_accvgpr_write_b32 a88, v108
    v_accvgpr_write_b32 a89, v109
    v_accvgpr_write_b32 a90, v110
    v_accvgpr_write_b32 a91, v111
    v_accvgpr_write_b32 a104, v112
    v_accvgpr_write_b32 a105, v113
    v_accvgpr_write_b32 a106, v114
    v_accvgpr_write_b32 a107, v115
    v_accvgpr_read_b32 v200, a168
    v_accvgpr_read_b32 v201, a169
    v_accvgpr_read_b32 v202, a170
    v_accvgpr_read_b32 v203, a171
    v_accvgpr_read_b32 v204, a172
    v_accvgpr_read_b32 v205, a173
    v_accvgpr_read_b32 v206, a174
    v_accvgpr_read_b32 v207, a175
    v_accvgpr_read_b32 v208, a176
    v_accvgpr_read_b32 v209, a177
    v_accvgpr_read_b32 v210, a178
    v_accvgpr_read_b32 v211, a179
    v_accvgpr_read_b32 v212, a180
    v_accvgpr_read_b32 v213, a181
    v_accvgpr_read_b32 v214, a182
    v_accvgpr_read_b32 v215, a183
    v_accvgpr_read_b32 v216, a184
    v_accvgpr_read_b32 v217, a185
    v_accvgpr_read_b32 v218, a186
    v_accvgpr_read_b32 v219, a187
    v_accvgpr_read_b32 v220, a188
    v_accvgpr_read_b32 v221, a189
    v_accvgpr_read_b32 v222, a190
    v_accvgpr_read_b32 v223, a191
    v_accvgpr_read_b32 v224, a192
    v_accvgpr_read_b32 v225, a193
    v_accvgpr_read_b32 v226, a194
    v_accvgpr_read_b32 v227, a195
    v_accvgpr_read_b32 v228, a196
    v_accvgpr_read_b32 v229, a197
    v_accvgpr_read_b32 v230, a198
    v_accvgpr_read_b32 v231, a199
    v_accvgpr_read_b32 v232, a200
    v_accvgpr_read_b32 v233, a201
    v_accvgpr_read_b32 v234, a202
    v_accvgpr_read_b32 v235, a203
    v_accvgpr_read_b32 v236, a204
    v_accvgpr_read_b32 v237, a205
    v_accvgpr_read_b32 v238, a206
    v_accvgpr_read_b32 v239, a207
    v_accvgpr_read_b32 v240, a208
    v_accvgpr_read_b32 v241, a209
    v_accvgpr_read_b32 v242, a210
    v_accvgpr_read_b32 v243, a211
    v_accvgpr_read_b32 v244, a212
    v_accvgpr_read_b32 v245, a213
    v_accvgpr_read_b32 v246, a214
    v_accvgpr_read_b32 v247, a215
    v_accvgpr_read_b32 v248, a216
    v_accvgpr_read_b32 v249, a217
    v_accvgpr_read_b32 v250, a218
    v_accvgpr_read_b32 v251, a219
    v_accvgpr_read_b32 v252, a220
    v_accvgpr_read_b32 v253, a221
    v_accvgpr_read_b32 v254, a222
    v_accvgpr_read_b32 v255, a223
    v_pk_mul_f32 v[200:201], v[200:201], v[4:5]
    v_pk_mul_f32 v[202:203], v[202:203], v[4:5]
    v_pk_mul_f32 v[204:205], v[204:205], v[4:5]
    v_pk_mul_f32 v[206:207], v[206:207], v[4:5]
    v_pk_mul_f32 v[208:209], v[208:209], v[4:5]
    v_pk_mul_f32 v[210:211], v[210:211], v[4:5]
    v_pk_mul_f32 v[212:213], v[212:213], v[4:5]
    v_pk_mul_f32 v[214:215], v[214:215], v[4:5]
    v_pk_mul_f32 v[216:217], v[216:217], v[4:5]
    v_pk_mul_f32 v[218:219], v[218:219], v[4:5]
    v_pk_mul_f32 v[220:221], v[220:221], v[4:5]
    v_pk_mul_f32 v[222:223], v[222:223], v[4:5]
    v_pk_mul_f32 v[224:225], v[224:225], v[4:5]
    v_pk_mul_f32 v[226:227], v[226:227], v[4:5]
    v_pk_mul_f32 v[228:229], v[228:229], v[4:5]
    v_pk_mul_f32 v[230:231], v[230:231], v[4:5]
    v_pk_mul_f32 v[232:233], v[232:233], v[4:5]
    v_pk_mul_f32 v[234:235], v[234:235], v[4:5]
    v_pk_mul_f32 v[236:237], v[236:237], v[4:5]
    v_pk_mul_f32 v[238:239], v[238:239], v[4:5]
    v_pk_mul_f32 v[240:241], v[240:241], v[4:5]
    v_pk_mul_f32 v[242:243], v[242:243], v[4:5]
    v_pk_mul_f32 v[244:245], v[244:245], v[4:5]
    v_pk_mul_f32 v[246:247], v[246:247], v[4:5]
    v_pk_mul_f32 v[248:249], v[248:249], v[4:5]
    v_pk_mul_f32 v[250:251], v[250:251], v[4:5]
    v_pk_mul_f32 v[252:253], v[252:253], v[4:5]
    v_pk_mul_f32 v[254:255], v[254:255], v[4:5]
    v_cvt_pk_bf16_f32 v116, v200, v201
    v_cvt_pk_bf16_f32 v117, v202, v203
    v_cvt_pk_bf16_f32 v118, v228, v229
    v_cvt_pk_bf16_f32 v119, v230, v231
    v_cvt_pk_bf16_f32 v120, v204, v205
    v_cvt_pk_bf16_f32 v121, v206, v207
    v_cvt_pk_bf16_f32 v122, v232, v233
    v_cvt_pk_bf16_f32 v123, v234, v235
    v_cvt_pk_bf16_f32 v124, v208, v209
    v_cvt_pk_bf16_f32 v125, v210, v211
    v_cvt_pk_bf16_f32 v126, v236, v237
    v_cvt_pk_bf16_f32 v127, v238, v239
    v_cvt_pk_bf16_f32 v128, v212, v213
    v_cvt_pk_bf16_f32 v129, v214, v215
    v_cvt_pk_bf16_f32 v130, v240, v241
    v_cvt_pk_bf16_f32 v131, v242, v243
    v_cvt_pk_bf16_f32 v132, v216, v217
    v_cvt_pk_bf16_f32 v133, v218, v219
    v_cvt_pk_bf16_f32 v134, v244, v245
    v_cvt_pk_bf16_f32 v135, v246, v247
    v_cvt_pk_bf16_f32 v136, v220, v221
    v_cvt_pk_bf16_f32 v137, v222, v223
    v_cvt_pk_bf16_f32 v138, v248, v249
    v_cvt_pk_bf16_f32 v139, v250, v251
    v_cvt_pk_bf16_f32 v140, v224, v225
    v_cvt_pk_bf16_f32 v141, v226, v227
    v_cvt_pk_bf16_f32 v142, v252, v253
    v_cvt_pk_bf16_f32 v143, v254, v255
    s_nop 1
    v_permlane16_swap_b32 v116, v118
    v_permlane16_swap_b32 v117, v119
    v_permlane16_swap_b32 v120, v122
    v_permlane16_swap_b32 v121, v123
    v_permlane16_swap_b32 v124, v126
    v_permlane16_swap_b32 v125, v127
    v_permlane16_swap_b32 v128, v130
    v_permlane16_swap_b32 v129, v131
    v_permlane16_swap_b32 v132, v134
    v_permlane16_swap_b32 v133, v135
    v_permlane16_swap_b32 v136, v138
    v_permlane16_swap_b32 v137, v139
    v_permlane16_swap_b32 v140, v142
    v_permlane16_swap_b32 v141, v143
    v_accvgpr_write_b32 a12, v116
    v_accvgpr_write_b32 a13, v117
    v_accvgpr_write_b32 a14, v118
    v_accvgpr_write_b32 a15, v119
    v_accvgpr_write_b32 a28, v120
    v_accvgpr_write_b32 a29, v121
    v_accvgpr_write_b32 a30, v122
    v_accvgpr_write_b32 a31, v123
    v_accvgpr_write_b32 a44, v124
    v_accvgpr_write_b32 a45, v125
    v_accvgpr_write_b32 a46, v126
    v_accvgpr_write_b32 a47, v127
    v_accvgpr_write_b32 a60, v128
    v_accvgpr_write_b32 a61, v129
    v_accvgpr_write_b32 a62, v130
    v_accvgpr_write_b32 a63, v131
    v_accvgpr_write_b32 a76, v132
    v_accvgpr_write_b32 a77, v133
    v_accvgpr_write_b32 a78, v134
    v_accvgpr_write_b32 a79, v135
    v_accvgpr_write_b32 a92, v136
    v_accvgpr_write_b32 a93, v137
    v_accvgpr_write_b32 a94, v138
    v_accvgpr_write_b32 a95, v139
    v_accvgpr_write_b32 a108, v140
    v_accvgpr_write_b32 a109, v141
    v_accvgpr_write_b32 a110, v142
    v_accvgpr_write_b32 a111, v143
    s_cmp_eq_u32 s70, 0
    s_cbranch_scc1 L_at_nostash
    s_mov_b32 s70, 0
    s_lshl_b32 s30, s2, 2
    s_add_u32 s30, s30, s20
    s_mul_i32 s30, s30, 28672
    v_lshlrev_b32 v4, 4, v1
    buffer_store_dwordx4 a[0:3], v4, s[12:15], s30 offen offset:0
    buffer_store_dwordx4 a[4:7], v4, s[12:15], s30 offen offset:1024
    buffer_store_dwordx4 a[8:11], v4, s[12:15], s30 offen offset:2048
    buffer_store_dwordx4 a[12:15], v4, s[12:15], s30 offen offset:3072
    s_add_u32 s30, s30, 4096
    buffer_store_dwordx4 a[16:19], v4, s[12:15], s30 offen offset:0
    buffer_store_dwordx4 a[20:23], v4, s[12:15], s30 offen offset:1024
    buffer_store_dwordx4 a[24:27], v4, s[12:15], s30 offen offset:2048
    buffer_store_dwordx4 a[28:31], v4, s[12:15], s30 offen offset:3072
    s_add_u32 s30, s30, 4096
    buffer_store_dwordx4 a[32:35], v4, s[12:15], s30 offen offset:0
    buffer_store_dwordx4 a[36:39], v4, s[12:15], s30 offen offset:1024
    buffer_store_dwordx4 a[40:43], v4, s[12:15], s30 offen offset:2048
    buffer_store_dwordx4 a[44:47], v4, s[12:15], s30 offen offset:3072
    s_add_u32 s30, s30, 4096
    buffer_store_dwordx4 a[48:51], v4, s[12:15], s30 offen offset:0
    buffer_store_dwordx4 a[52:55], v4, s[12:15], s30 offen offset:1024
    buffer_store_dwordx4 a[56:59], v4, s[12:15], s30 offen offset:2048
    buffer_store_dwordx4 a[60:63], v4, s[12:15], s30 offen offset:3072
    s_add_u32 s30, s30, 4096
    buffer_store_dwordx4 a[64:67], v4, s[12:15], s30 offen offset:0
    buffer_store_dwordx4 a[68:71], v4, s[12:15], s30 offen offset:1024
    buffer_store_dwordx4 a[72:75], v4, s[12:15], s30 offen offset:2048
    buffer_store_dwordx4 a[76:79], v4, s[12:15], s30 offen offset:3072
    s_add_u32 s30, s30, 4096
    buffer_store_dwordx4 a[80:83], v4, s[12:15], s30 offen offset:0
    buffer_store_dwordx4 a[84:87], v4, s[12:15], s30 offen offset:1024
    buffer_store_dwordx4 a[88:91], v4, s[12:15], s30 offen offset:2048
    buffer_store_dwordx4 a[92:95], v4, s[12:15], s30 offen offset:3072
    s_add_u32 s30, s30, 4096
    buffer_store_dwordx4 a[96:99], v4, s[12:15], s30 offen offset:0
    buffer_store_dwordx4 a[100:103], v4, s[12:15], s30 offen offset:1024
    buffer_store_dwordx4 a[104:107], v4, s[12:15], s30 offen offset:2048
    buffer_store_dwordx4 a[108:111], v4, s[12:15], s30 offen offset:3072
    s_mov_b32 s68, 3
    s_branch L_at_round
L_at_nostash:
    s_cmp_lg_u32 s25, 0
    s_cbranch_scc1 L_at_maxpass
L_at_pre:
L_at_nowo1:
    s_waitcnt lgkmcnt(0)
    v_mfma_f32_16x16x32_bf16 v[88:91], v[56:59], a[0:3], 0
    v_mov_b32 v168, 0
    v_mov_b32 v169, 0
    v_mfma_f32_16x16x32_bf16 v[88:91], v[60:63], a[4:7], v[88:91]
    v_mov_b32 v170, 0
    v_mov_b32 v171, 0
    v_mfma_f32_16x16x32_bf16 v[88:91], v[64:67], a[8:11], v[88:91]
    v_mov_b32 v196, 0
    v_mov_b32 v197, 0
    v_mfma_f32_16x16x32_bf16 v[88:91], v[68:71], a[12:15], v[88:91]
    v_mov_b32 v198, 0
    v_mov_b32 v199, 0
    v_mfma_f32_16x16x32_bf16 v[92:95], v[84:87], a[12:15], 0
    v_mov_b32 v224, 0
    v_mov_b32 v225, 0
    v_mfma_f32_16x16x32_bf16 v[92:95], v[80:83], a[8:11], v[92:95]
    v_mov_b32 v226, 0
    v_mov_b32 v227, 0
    v_mfma_f32_16x16x32_bf16 v[92:95], v[76:79], a[4:7], v[92:95]
    v_mov_b32 v252, 0
    v_mov_b32 v253, 0
    v_mfma_f32_16x16x32_bf16 v[92:95], v[72:75], a[0:3], v[92:95]
    v_mov_b32 v254, 0
    v_mov_b32 v255, 0
    v_accvgpr_write_b32 a136, 0
    v_accvgpr_write_b32 a137, 0
    v_accvgpr_write_b32 a138, 0
    v_accvgpr_write_b32 a139, 0
    v_accvgpr_write_b32 a164, 0
    v_accvgpr_write_b32 a165, 0
    v_accvgpr_write_b32 a166, 0
    v_accvgpr_write_b32 a167, 0
    v_accvgpr_write_b32 a192, 0
    v_accvgpr_write_b32 a193, 0
    v_accvgpr_write_b32 a194, 0
    v_accvgpr_write_b32 a195, 0
    v_accvgpr_write_b32 a220, 0
    v_accvgpr_write_b32 a221, 0
    v_accvgpr_write_b32 a222, 0
    v_accvgpr_write_b32 a223, 0
    v_mfma_f32_16x16x32_bf16 v[96:99], v[56:59], a[16:19], 0
    v_max3_f32 v2, v88, v89, v12
    v_max3_f32 v3, v90, v91, v92
    v_max3_f32 v2, v93, v94, v2
    v_mfma_f32_16x16x32_bf16 v[96:99], v[60:63], a[20:23], v[96:99]
    v_max3_f32 v2, v95, v2, v3
    v_mov_b32 v3, v2
    s_nop 1
    v_permlane16_swap_b32 v2, v3
    v_mfma_f32_16x16x32_bf16 v[96:99], v[64:67], a[24:27], v[96:99]
    s_nop 1
    v_max_f32 v2, v2, v3
    v_mov_b32 v3, v2
    v_mfma_f32_16x16x32_bf16 v[96:99], v[68:71], a[28:31], v[96:99]
    s_nop 1
    v_permlane32_swap_b32 v2, v3
    s_nop 1
    v_max_f32 v2, v2, v3
    v_mfma_f32_16x16x32_bf16 v[100:103], v[84:87], a[28:31], 0
    v_mov_b32 v12, 0
    v_mov_b32 v13, 0
    v_sub_f32 v88, v88, v2
    v_mfma_f32_16x16x32_bf16 v[100:103], v[80:83], a[24:27], v[100:103]
    v_sub_f32 v89, v89, v2
    v_sub_f32 v90, v90, v2
    v_sub_f32 v91, v91, v2
    v_sub_f32 v92, v92, v2
    v_mfma_f32_16x16x32_bf16 v[100:103], v[76:79], a[20:23], v[100:103]
    v_sub_f32 v93, v93, v2
    v_sub_f32 v94, v94, v2
    v_sub_f32 v95, v95, v2
    v_mfma_f32_16x16x32_bf16 v[100:103], v[72:75], a[16:19], v[100:103]
    v_sub_f32 v28, 0, v2
    v_sub_f32 v29, 0, v2
    v_sub_f32 v30, 0, v2
    v_sub_f32 v31, 0, v2
    ds_read_b64_tr_b16 v[112:113], v9 offset:0
    ds_read_b64_tr_b16 v[114:115], v9 offset:512
    v_exp_f32 v88, v88
    ds_read_b64_tr_b16 v[116:117], v9 offset:32
    ds_read_b64_tr_b16 v[118:119], v9 offset:544
    v_exp_f32 v89, v89
    v_exp_f32 v90, v90
    ds_read_b64_tr_b16 v[120:121], v9 offset:64
    ds_read_b64_tr_b16 v[122:123], v9 offset:576
    v_exp_f32 v91, v91
    v_add_f32 v12, v12, v88
    v_add_f32 v13, v13, v89
    ds_read_b64_tr_b16 v[124:125], v9 offset:96
    ds_read_b64_tr_b16 v[126:127], v9 offset:608
    v_cvt_pk_bf16_f32 v104, v88, v89
    v_exp_f32 v92, v92
    ds_read_b64_tr_b16 v[128:129], v9 offset:128
    ds_read_b64_tr_b16 v[130:131], v9 offset:640
    v_exp_f32 v93, v93
    v_add_f32 v12, v12, v90
    v_add_f32 v13, v13, v91
    ds_read_b64_tr_b16 v[132:133], v9 offset:160
    ds_read_b64_tr_b16 v[134:135], v9 offset:672
    v_cvt_pk_bf16_f32 v105, v90, v91
    v_exp_f32 v94, v94
    ds_read_b64_tr_b16 v[136:137], v9 offset:192
    ds_read_b64_tr_b16 v[138:139], v9 offset:704
    v_exp_f32 v95, v95
    v_add_f32 v12, v12, v92
    v_add_f32 v13, v13, v93
    ds_read_b64_tr_b16 v[140:141], v9 offset:224
    ds_read_b64_tr_b16 v[142:143], v9 offset:736
    v_cvt_pk_bf16_f32 v106, v92, v93
    v_add_f32 v12, v12, v94
    v_add_f32 v13, v13, v95
    v_cvt_pk_bf16_f32 v107, v94, v95
    v_mfma_f32_16x16x32_bf16 v[88:91], v[56:59], a[32:35], 0
    v_max3_f32 v2, v96, v97, v14
    v_max3_f32 v3, v98, v99, v100
    v_max3_f32 v2, v101, v102, v2
    v_mfma_f32_16x16x32_bf16 v[88:91], v[60:63], a[36:39], v[88:91]
    v_max3_f32 v2, v103, v2, v3
    v_mov_b32 v3, v2
    s_nop 1
    v_permlane16_swap_b32 v2, v3
    v_mfma_f32_16x16x32_bf16 v[88:91], v[64:67], a[40:43], v[88:91]
    s_nop 1
    v_max_f32 v2, v2, v3
    v_mov_b32 v3, v2
    v_mfma_f32_16x16x32_bf16 v[88:91], v[68:71], a[44:47], v[88:91]
    s_nop 1
    v_permlane32_swap_b32 v2, v3
    s_nop 1
    v_max_f32 v2, v2, v3
    v_mfma_f32_16x16x32_bf16 v[92:95], v[84:87], a[44:47], 0
    v_mov_b32 v14, 0
    v_mov_b32 v15, 0
    v_sub_f32 v96, v96, v2
    v_mfma_f32_16x16x32_bf16 v[92:95], v[80:83], a[40:43], v[92:95]
    v_sub_f32 v97, v97, v2
    v_sub_f32 v98, v98, v2
    v_sub_f32 v99, v99, v2
    v_sub_f32 v100, v100, v2
    v_mfma_f32_16x16x32_bf16 v[92:95], v[76:79], a[36:39], v[92:95]
    v_sub_f32 v101, v101, v2
    v_sub_f32 v102, v102, v2
    v_sub_f32 v103, v103, v2
    v_mfma_f32_16x16x32_bf16 v[92:95], v[72:75], a[32:35], v[92:95]
    v_sub_f32 v32, 0, v2
    v_sub_f32 v33, 0, v2
    v_sub_f32 v34, 0, v2
    v_sub_f32 v35, 0, v2
    s_waitcnt lgkmcnt(0)
    v_mfma_f32_16x16x32_bf16 v[144:147], v[112:115], v[104:107], 0
    v_exp_f32 v96, v96
    v_mfma_f32_16x16x32_bf16 v[172:175], v[116:119], v[104:107], 0
    v_exp_f32 v97, v97
    v_exp_f32 v98, v98
    v_mfma_f32_16x16x32_bf16 v[200:203], v[120:123], v[104:107], 0
    v_exp_f32 v99, v99
    v_add_f32 v14, v14, v96
    v_add_f32 v15, v15, v97
    v_mfma_f32_16x16x32_bf16 v[228:231], v[124:127], v[104:107], 0
    v_cvt_pk_bf16_f32 v108, v96, v97
    v_exp_f32 v100, v100
    v_mfma_f32_16x16x32_bf16 a[112:115], v[128:131], v[104:107], 0
    v_exp_f32 v101, v101
    v_add_f32 v14, v14, v98
    v_add_f32 v15, v15, v99
    v_mfma_f32_16x16x32_bf16 a[140:143], v[132:135], v[104:107], 0
    v_cvt_pk_bf16_f32 v109, v98, v99
    v_exp_f32 v102, v102
    v_mfma_f32_16x16x32_bf16 a[168:171], v[136:139], v[104:107], 0
    v_exp_f32 v103, v103
    v_add_f32 v14, v14, v100
    v_add_f32 v15, v15, v101
    v_mfma_f32_16x16x32_bf16 a[196:199], v[140:143], v[104:107], 0
    v_cvt_pk_bf16_f32 v110, v100, v101
    v_add_f32 v14, v14, v102
    v_add_f32 v15, v15, v103
    v_cvt_pk_bf16_f32 v111, v102, v103
    v_mfma_f32_16x16x32_bf16 v[96:99], v[56:59], a[48:51], 0
    v_max3_f32 v2, v88, v89, v16
    v_max3_f32 v3, v90, v91, v92
    v_max3_f32 v2, v93, v94, v2
    v_mfma_f32_16x16x32_bf16 v[96:99], v[60:63], a[52:55], v[96:99]
    v_max3_f32 v2, v95, v2, v3
    v_mov_b32 v3, v2
    s_nop 1
    v_permlane16_swap_b32 v2, v3
    v_mfma_f32_16x16x32_bf16 v[96:99], v[64:67], a[56:59], v[96:99]
    s_nop 1
    v_max_f32 v2, v2, v3
    v_mov_b32 v3, v2
    v_mfma_f32_16x16x32_bf16 v[96:99], v[68:71], a[60:63], v[96:99]
    s_nop 1
    v_permlane32_swap_b32 v2, v3
    s_nop 1
    v_max_f32 v2, v2, v3
    v_mfma_f32_16x16x32_bf16 v[100:103], v[84:87], a[60:63], 0
    v_mov_b32 v16, 0
    v_mov_b32 v17, 0
    v_sub_f32 v88, v88, v2
    v_mfma_f32_16x16x32_bf16 v[100:103], v[80:83], a[56:59], v[100:103]
    v_sub_f32 v89, v89, v2
    v_sub_f32 v90, v90, v2
    v_sub_f32 v91, v91, v2
    v_sub_f32 v92, v92, v2
    v_mfma_f32_16x16x32_bf16 v[100:103], v[76:79], a[52:55], v[100:103]
    v_sub_f32 v93, v93, v2
    v_sub_f32 v94, v94, v2
    v_sub_f32 v95, v95, v2
    v_mfma_f32_16x16x32_bf16 v[100:103], v[72:75], a[48:51], v[100:103]
    v_sub_f32 v36, 0, v2
    v_sub_f32 v37, 0, v2
    v_sub_f32 v38, 0, v2
    v_sub_f32 v39, 0, v2
    v_mfma_f32_16x16x32_bf16 v[148:151], v[112:115], v[108:111], 0
    v_exp_f32 v88, v88
    v_mfma_f32_16x16x32_bf16 v[176:179], v[116:119], v[108:111], 0
    v_exp_f32 v89, v89
    v_exp_f32 v90, v90
    v_mfma_f32_16x16x32_bf16 v[204:207], v[120:123], v[108:111], 0
    v_exp_f32 v91, v91
    v_add_f32 v16, v16, v88
    v_add_f32 v17, v17, v89
    v_mfma_f32_16x16x32_bf16 v[232:235], v[124:127], v[108:111], 0
    v_cvt_pk_bf16_f32 v104, v88, v89
    v_exp_f32 v92, v92
    v_mfma_f32_16x16x32_bf16 a[116:119], v[128:131], v[108:111], 0
    v_exp_f32 v93, v93
    v_add_f32 v16, v16, v90
    v_add_f32 v17, v17, v91
    v_mfma_f32_16x16x32_bf16 a[144:147], v[132:135], v[108:111], 0
    v_cvt_pk_bf16_f32 v105, v90, v91
    v_exp_f32 v94, v94
    v_mfma_f32_16x16x32_bf16 a[172:175], v[136:139], v[108:111], 0
    v_exp_f32 v95, v95
    v_add_f32 v16, v16, v92
    v_add_f32 v17, v17, v93
    v_mfma_f32_16x16x32_bf16 a[200:203], v[140:143], v[108:111], 0
    v_cvt_pk_bf16_f32 v106, v92, v93
    v_add_f32 v16, v16, v94
    v_add_f32 v17, v17, v95
    v_cvt_pk_bf16_f32 v107, v94, v95
    v_mfma_f32_16x16x32_bf16 v[88:91], v[56:59], a[64:67], 0
    v_max3_f32 v2, v96, v97, v18
    v_max3_f32 v3, v98, v99, v100
    v_max3_f32 v2, v101, v102, v2
    v_mfma_f32_16x16x32_bf16 v[88:91], v[60:63], a[68:71], v[88:91]
    v_max3_f32 v2, v103, v2, v3
    v_mov_b32 v3, v2
    s_nop 1
    v_permlane16_swap_b32 v2, v3
    v_mfma_f32_16x16x32_bf16 v[88:91], v[64:67], a[72:75], v[88:91]
    s_nop 1
    v_max_f32 v2, v2, v3
    v_mov_b32 v3, v2
    v_mfma_f32_16x16x32_bf16 v[88:91], v[68:71], a[76:79], v[88:91]
    s_nop 1
    v_permlane32_swap_b32 v2, v3
    s_nop 1
    v_max_f32 v2, v2, v3
    v_mfma_f32_16x16x32_bf16 v[92:95], v[84:87], a[76:79], 0
    v_mov_b32 v18, 0
    v_mov_b32 v19, 0
    v_sub_f32 v96, v96, v2
    v_mfma_f32_16x16x32_bf16 v[92:95], v[80:83], a[72:75], v[92:95]
    v_sub_f32 v97, v97, v2
    v_sub_f32 v98, v98, v2
    v_sub_f32 v99, v99, v2
    v_sub_f32 v100, v100, v2
    v_mfma_f32_16x16x32_bf16 v[92:95], v[76:79], a[68:71], v[92:95]
    v_sub_f32 v101, v101, v2
    v_sub_f32 v102, v102, v2
    v_sub_f32 v103, v103, v2
    v_mfma_f32_16x16x32_bf16 v[92:95], v[72:75], a[64:67], v[92:95]
    v_sub_f32 v40, 0, v2
    v_sub_f32 v41, 0, v2
    v_sub_f32 v42, 0, v2
    v_sub_f32 v43, 0, v2
    v_mfma_f32_16x16x32_bf16 v[152:155], v[112:115], v[104:107], 0
    v_exp_f32 v96, v96
    v_mfma_f32_16x16x32_bf16 v[180:183], v[116:119], v[104:107], 0
    v_exp_f32 v97, v97
    v_exp_f32 v98, v98
    v_mfma_f32_16x16x32_bf16 v[208:211], v[120:123], v[104:107], 0
    v_exp_f32 v99, v99
    v_add_f32 v18, v18, v96
    v_add_f32 v19, v19, v97
    v_mfma_f32_16x16x32_bf16 v[236:239], v[124:127], v[104:107], 0
    v_cvt_pk_bf16_f32 v108, v96, v97
    v_exp_f32 v100, v100
    v_mfma_f32_16x16x32_bf16 a[120:123], v[128:131], v[104:107], 0
    v_exp_f32 v101, v101
    v_add_f32 v18, v18, v98
    v_add_f32 v19, v19, v99
    v_mfma_f32_16x16x32_bf16 a[148:151], v[132:135], v[104:107], 0
    v_cvt_pk_bf16_f32 v109, v98, v99
    v_exp_f32 v102, v102
    v_mfma_f32_16x16x32_bf16 a[176:179], v[136:139], v[104:107], 0
    v_exp_f32 v103, v103
    v_add_f32 v18, v18, v100
    v_add_f32 v19, v19, v101
    v_mfma_f32_16x16x32_bf16 a[204:207], v[140:143], v[104:107], 0
    v_cvt_pk_bf16_f32 v110, v100, v101
    v_add_f32 v18, v18, v102
    v_add_f32 v19, v19, v103
    v_cvt_pk_bf16_f32 v111, v102, v103
    v_mfma_f32_16x16x32_bf16 v[96:99], v[56:59], a[80:83], 0
    v_max3_f32 v2, v88, v89, v20
    v_max3_f32 v3, v90, v91, v92
    v_max3_f32 v2, v93, v94, v2
    v_mfma_f32_16x16x32_bf16 v[96:99], v[60:63], a[84:87], v[96:99]
    v_max3_f32 v2, v95, v2, v3
    v_mov_b32 v3, v2
    s_nop 1
    v_permlane16_swap_b32 v2, v3
    v_mfma_f32_16x16x32_bf16 v[96:99], v[64:67], a[88:91], v[96:99]
    s_nop 1
    v_max_f32 v2, v2, v3
    v_mov_b32 v3, v2
    v_mfma_f32_16x16x32_bf16 v[96:99], v[68:71], a[92:95], v[96:99]
    s_nop 1
    v_permlane32_swap_b32 v2, v3
    s_nop 1
    v_max_f32 v2, v2, v3
    v_mfma_f32_16x16x32_bf16 v[100:103], v[84:87], a[92:95], 0
    v_mov_b32 v20, 0
    v_mov_b32 v21, 0
    v_sub_f32 v88, v88, v2
    v_mfma_f32_16x16x32_bf16 v[100:103], v[80:83], a[88:91], v[100:103]
    v_sub_f32 v89, v89, v2
    v_sub_f32 v90, v90, v2
    v_sub_f32 v91, v91, v2
    v_sub_f32 v92, v92, v2
    v_mfma_f32_16x16x32_bf16 v[100:103], v[76:79], a[84:87], v[100:103]
    v_sub_f32 v93, v93, v2
    v_sub_f32 v94, v94, v2
    v_sub_f32 v95, v95, v2
    v_mfma_f32_16x16x32_bf16 v[100:103], v[72:75], a[80:83], v[100:103]
    v_sub_f32 v44, 0, v2
    v_sub_f32 v45, 0, v2
    v_sub_f32 v46, 0, v2
    v_sub_f32 v47, 0, v2
    v_mfma_f32_16x16x32_bf16 v[156:159], v[112:115], v[108:111], 0
    v_exp_f32 v88, v88
    v_mfma_f32_16x16x32_bf16 v[184:187], v[116:119], v[108:111], 0
    v_exp_f32 v89, v89
    v_exp_f32 v90, v90
    v_mfma_f32_16x16x32_bf16 v[212:215], v[120:123], v[108:111], 0
    v_exp_f32 v91, v91
    v_add_f32 v20, v20, v88
    v_add_f32 v21, v21, v89
    v_mfma_f32_16x16x32_bf16 v[240:243], v[124:127], v[108:111], 0
    v_cvt_pk_bf16_f32 v104, v88, v89
    v_exp_f32 v92, v92
    v_mfma_f32_16x16x32_bf16 a[124:127], v[128:131], v[108:111], 0
    v_exp_f32 v93, v93
    v_add_f32 v20, v20, v90
    v_add_f32 v21, v21, v91
    v_mfma_f32_16x16x32_bf16 a[152:155], v[132:135], v[108:111], 0
    v_cvt_pk_bf16_f32 v105, v90, v91
    v_exp_f32 v94, v94
    v_mfma_f32_16x16x32_bf16 a[180:183], v[136:139], v[108:111], 0
    v_exp_f32 v95, v95
    v_add_f32 v20, v20, v92
    v_add_f32 v21, v21, v93
    v_mfma_f32_16x16x32_bf16 a[208:211], v[140:143], v[108:111], 0
    v_cvt_pk_bf16_f32 v106, v92, v93
    v_add_f32 v20, v20, v94
    v_add_f32 v21, v21, v95
    v_cvt_pk_bf16_f32 v107, v94, v95
    s_cmp_eq_u32 s68, 0
    s_cbranch_scc0 L_bw1_3108
    s_waitcnt vmcnt(16) lgkmcnt(0)
L_bw2_3108:
    s_barrier
    s_cmp_le_u32 s21, s27
    s_cbranch_scc1 L_at_nofb_3113
    s_sub_u32 s28, s21, 1
    s_cmp_eq_u32 s28, s23
    s_cbranch_scc1 L_at_nofb_3113
    s_lshl_b32 s29, s28, 2
    s_add_u32 s29, s29, 76000
    v_mov_b32 v4, s29
    ds_read_b32 v4, v4
    s_waitcnt lgkmcnt(0)
    v_readfirstlane_b32 s29, v4
    s_nop 3
    s_cmp_lg_u32 s29, 0
    s_cbranch_scc1 L_at_fallback
L_at_nofb_3113:
    v_mfma_f32_16x16x32_bf16 v[88:91], v[56:59], a[96:99], 0
    ds_read_b128 v[56:59], v8 offset:8448
    v_max3_f32 v2, v96, v97, v22
    v_max3_f32 v3, v98, v99, v100
    v_max3_f32 v2, v101, v102, v2
    v_mfma_f32_16x16x32_bf16 v[88:91], v[60:63], a[100:103], v[88:91]
    ds_read_b128 v[60:63], v8 offset:8512
    v_max3_f32 v2, v103, v2, v3
    v_mov_b32 v3, v2
    s_nop 1
    v_permlane16_swap_b32 v2, v3
    v_mfma_f32_16x16x32_bf16 v[88:91], v[64:67], a[104:107], v[88:91]
    ds_read_b128 v[64:67], v8 offset:8576
    s_nop 1
    v_max_f32 v2, v2, v3
    v_mov_b32 v3, v2
    v_mfma_f32_16x16x32_bf16 v[88:91], v[68:71], a[108:111], v[88:91]
    ds_read_b128 v[68:71], v8 offset:8640
    s_nop 1
    v_permlane32_swap_b32 v2, v3
    s_nop 1
    v_max_f32 v2, v2, v3
    v_mfma_f32_16x16x32_bf16 v[92:95], v[84:87], a[108:111], 0
    ds_read_b128 v[84:87], v8 offset:9152
    v_mov_b32 v22, 0
    v_mov_b32 v23, 0
    v_sub_f32 v96, v96, v2
    v_mfma_f32_16x16x32_bf16 v[92:95], v[80:83], a[104:107], v[92:95]
    ds_read_b128 v[80:83], v8 offset:9088
    v_sub_f32 v97, v97, v2
    v_sub_f32 v98, v98, v2
    v_sub_f32 v99, v99, v2
    v_sub_f32 v100, v100, v2
    v_mfma_f32_16x16x32_bf16 v[92:95], v[76:79], a[100:103], v[92:95]
    ds_read_b128 v[76:79], v8 offset:9024
    v_sub_f32 v101, v101, v2
    v_sub_f32 v102, v102, v2
    v_sub_f32 v103, v103, v2
    v_mfma_f32_16x16x32_bf16 v[92:95], v[72:75], a[96:99], v[92:95]
    ds_read_b128 v[72:75], v8 offset:8960
    v_sub_f32 v48, 0, v2
    v_sub_f32 v49, 0, v2
    v_sub_f32 v50, 0, v2
    v_sub_f32 v51, 0, v2
    v_mfma_f32_16x16x32_bf16 v[160:163], v[112:115], v[104:107], 0
    v_exp_f32 v96, v96
    v_mfma_f32_16x16x32_bf16 v[188:191], v[116:119], v[104:107], 0
    v_exp_f32 v97, v97
    v_exp_f32 v98, v98
    v_mfma_f32_16x16x32_bf16 v[216:219], v[120:123], v[104:107], 0
    v_exp_f32 v99, v99
    v_add_f32 v22, v22, v96
    v_add_f32 v23, v23, v97
    v_mfma_f32_16x16x32_bf16 v[244:247], v[124:127], v[104:107], 0
    v_cvt_pk_bf16_f32 v108, v96, v97
    v_exp_f32 v100, v100
    v_mfma_f32_16x16x32_bf16 a[128:131], v[128:131], v[104:107], 0
    v_exp_f32 v101, v101
    v_add_f32 v22, v22, v98
    v_add_f32 v23, v23, v99
    v_mfma_f32_16x16x32_bf16 a[156:159], v[132:135], v[104:107], 0
    v_cvt_pk_bf16_f32 v109, v98, v99
    v_exp_f32 v102, v102
    v_mfma_f32_16x16x32_bf16 a[184:187], v[136:139], v[104:107], 0
    v_exp_f32 v103, v103
    v_add_f32 v22, v22, v100
    v_add_f32 v23, v23, v101
    v_mfma_f32_16x16x32_bf16 a[212:215], v[140:143], v[104:107], 0
    v_cvt_pk_bf16_f32 v110, v100, v101
    v_add_f32 v22, v22, v102
    v_add_f32 v23, v23, v103
    v_cvt_pk_bf16_f32 v111, v102, v103
    s_waitcnt lgkmcnt(0)
    v_mfma_f32_16x16x32_bf16 v[96:99], v[56:59], a[0:3], v[28:31]
    v_max3_f32 v2, v88, v89, v24
    v_max3_f32 v3, v90, v91, v92
    v_max3_f32 v2, v93, v94, v2
    v_mfma_f32_16x16x32_bf16 v[96:99], v[60:63], a[4:7], v[96:99]
    v_max3_f32 v2, v95, v2, v3
    v_mov_b32 v3, v2
    s_nop 1
    v_permlane16_swap_b32 v2, v3
    v_mfma_f32_16x16x32_bf16 v[96:99], v[64:67], a[8:11], v[96:99]
    s_nop 1
    v_max_f32 v2, v2, v3
    v_mov_b32 v3, v2
    v_mfma_f32_16x16x32_bf16 v[96:99], v[68:71], a[12:15], v[96:99]
    s_nop 1
    v_permlane32_swap_b32 v2, v3
    s_nop 1
    v_max_f32 v2, v2, v3
    v_mfma_f32_16x16x32_bf16 v[100:103], v[84:87], a[12:15], v[28:31]
    v_mov_b32 v24, 0
    v_mov_b32 v25, 0
    v_sub_f32 v88, v88, v2
    v_mfma_f32_16x16x32_bf16 v[100:103], v[80:83], a[8:11], v[100:103]
    v_sub_f32 v89, v89, v2
    v_sub_f32 v90, v90, v2
    v_sub_f32 v91, v91, v2
    v_sub_f32 v92, v92, v2
    v_mfma_f32_16x16x32_bf16 v[100:103], v[76:79], a[4:7], v[100:103]
    v_sub_f32 v93, v93, v2
    v_sub_f32 v94, v94, v2
    v_sub_f32 v95, v95, v2
    v_mfma_f32_16x16x32_bf16 v[100:103], v[72:75], a[0:3], v[100:103]
    v_sub_f32 v52, 0, v2
    v_sub_f32 v53, 0, v2
    v_sub_f32 v54, 0, v2
    v_sub_f32 v55, 0, v2
    v_mfma_f32_16x16x32_bf16 v[164:167], v[112:115], v[108:111], 0
    v_exp_f32 v88, v88
    v_mfma_f32_16x16x32_bf16 v[192:195], v[116:119], v[108:111], 0
    v_exp_f32 v89, v89
    v_exp_f32 v90, v90
    v_mfma_f32_16x16x32_bf16 v[220:223], v[120:123], v[108:111], 0
    v_exp_f32 v91, v91
    v_add_f32 v24, v24, v88
    v_add_f32 v25, v25, v89
    v_mfma_f32_16x16x32_bf16 v[248:251], v[124:127], v[108:111], 0
    v_cvt_pk_bf16_f32 v104, v88, v89
    v_exp_f32 v92, v92
    v_mfma_f32_16x16x32_bf16 a[132:135], v[128:131], v[108:111], 0
    v_exp_f32 v93, v93
    v_add_f32 v24, v24, v90
    v_add_f32 v25, v25, v91
    v_mfma_f32_16x16x32_bf16 a[160:163], v[132:135], v[108:111], 0
    v_cvt_pk_bf16_f32 v105, v90, v91
    v_exp_f32 v94, v94
    v_mfma_f32_16x16x32_bf16 a[188:191], v[136:139], v[108:111], 0
    v_exp_f32 v95, v95
    v_add_f32 v24, v24, v92
    v_add_f32 v25, v25, v93
    v_mfma_f32_16x16x32_bf16 a[216:219], v[140:143], v[108:111], 0
    v_cvt_pk_bf16_f32 v106, v92, v93
    v_add_f32 v24, v24, v94
    v_add_f32 v25, v25, v95
    v_cvt_pk_bf16_f32 v107, v94, v95
    s_mov_b32 s22, 0
L_at_loop:
    v_mfma_f32_16x16x32_bf16 v[88:91], v[56:59], a[16:19], v[32:35]
    v_mfma_f32_16x16x32_bf16 v[88:91], v[60:63], a[20:23], v[88:91]
    v_exp_f32 v96, v96
    v_mfma_f32_16x16x32_bf16 v[88:91], v[64:67], a[24:27], v[88:91]
    v_exp_f32 v97, v97
    v_mfma_f32_16x16x32_bf16 v[88:91], v[68:71], a[28:31], v[88:91]
    v_exp_f32 v98, v98
    v_mfma_f32_16x16x32_bf16 v[92:95], v[84:87], a[28:31], v[32:35]
    v_exp_f32 v99, v99
    v_mfma_f32_16x16x32_bf16 v[92:95], v[80:83], a[24:27], v[92:95]
    v_add_f32 v12, v12, v96
    v_add_f32 v13, v13, v97
    v_mfma_f32_16x16x32_bf16 v[92:95], v[76:79], a[20:23], v[92:95]
    v_cvt_pk_bf16_f32 v108, v96, v97
    v_mfma_f32_16x16x32_bf16 v[92:95], v[72:75], a[16:19], v[92:95]
    v_exp_f32 v100, v100
    v_mfma_f32_16x16x32_bf16 v[168:171], v[112:115], v[104:107], v[168:171]
    ds_read_b64_tr_b16 v[112:113], v9 offset:8448
    ds_read_b64_tr_b16 v[114:115], v9 offset:8960
    v_exp_f32 v101, v101
    v_mfma_f32_16x16x32_bf16 v[196:199], v[116:119], v[104:107], v[196:199]
    ds_read_b64_tr_b16 v[116:117], v9 offset:8480
    ds_read_b64_tr_b16 v[118:119], v9 offset:8992
    v_add_f32 v12, v12, v98
    v_add_f32 v13, v13, v99
    v_mfma_f32_16x16x32_bf16 v[224:227], v[120:123], v[104:107], v[224:227]
    ds_read_b64_tr_b16 v[120:121], v9 offset:8512
    ds_read_b64_tr_b16 v[122:123], v9 offset:9024
    v_cvt_pk_bf16_f32 v109, v98, v99
    v_mfma_f32_16x16x32_bf16 v[252:255], v[124:127], v[104:107], v[252:255]
    ds_read_b64_tr_b16 v[124:125], v9 offset:8544
    ds_read_b64_tr_b16 v[126:127], v9 offset:9056
    v_exp_f32 v102, v102
    v_mfma_f32_16x16x32_bf16 a[136:139], v[128:131], v[104:107], a[136:139]
    ds_read_b64_tr_b16 v[128:129], v9 offset:8576
    ds_read_b64_tr_b16 v[130:131], v9 offset:9088
    v_exp_f32 v103, v103
    v_mfma_f32_16x16x32_bf16 a[164:167], v[132:135], v[104:107], a[164:167]
    ds_read_b64_tr_b16 v[132:133], v9 offset:8608
    ds_read_b64_tr_b16 v[134:135], v9 offset:9120
    v_add_f32 v12, v12, v100
    v_add_f32 v13, v13, v101
    v_mfma_f32_16x16x32_bf16 a[192:195], v[136:139], v[104:107], a[192:195]
    ds_read_b64_tr_b16 v[136:137], v9 offset:8640
    ds_read_b64_tr_b16 v[138:139], v9 offset:9152
    v_cvt_pk_bf16_f32 v110, v100, v101
    v_add_f32 v12, v12, v102
    v_mfma_f32_16x16x32_bf16 a[220:223], v[140:143], v[104:107], a[220:223]
    ds_read_b64_tr_b16 v[140:141], v9 offset:8672
    ds_read_b64_tr_b16 v[142:143], v9 offset:9184
    v_add_f32 v13, v13, v103
    v_cvt_pk_bf16_f32 v111, v102, v103
    v_mfma_f32_16x16x32_bf16 v[96:99], v[56:59], a[32:35], v[36:39]
    v_mfma_f32_16x16x32_bf16 v[96:99], v[60:63], a[36:39], v[96:99]
    s_add_u32 s29, s34, s100
    v_exp_f32 v88, v88
    v_mfma_f32_16x16x32_bf16 v[96:99], v[64:67], a[40:43], v[96:99]
    v_exp_f32 v89, v89
    v_mfma_f32_16x16x32_bf16 v[96:99], v[68:71], a[44:47], v[96:99]
    s_bfe_u32 s28, s29, 0x20003
    v_exp_f32 v90, v90
    v_mfma_f32_16x16x32_bf16 v[100:103], v[84:87], a[44:47], v[36:39]
    v_exp_f32 v91, v91
    v_mfma_f32_16x16x32_bf16 v[100:103], v[80:83], a[40:43], v[100:103]
    s_lshl_b32 s28, s28, 16
    v_add_f32 v14, v14, v88
    v_add_f32 v15, v15, v89
    v_mfma_f32_16x16x32_bf16 v[100:103], v[76:79], a[36:39], v[100:103]
    v_cvt_pk_bf16_f32 v104, v88, v89
    v_mfma_f32_16x16x32_bf16 v[100:103], v[72:75], a[32:35], v[100:103]
    v_exp_f32 v92, v92
    s_waitcnt lgkmcnt(0)
    v_mfma_f32_16x16x32_bf16 v[144:147], v[112:115], v[108:111], v[144:147]
    s_and_b32 s29, s29, 7
    v_exp_f32 v93, v93
    v_mfma_f32_16x16x32_bf16 v[172:175], v[116:119], v[108:111], v[172:175]
    v_add_f32 v14, v14, v90
    v_add_f32 v15, v15, v91
    v_mfma_f32_16x16x32_bf16 v[200:203], v[120:123], v[108:111], v[200:203]
    s_lshl_b32 s29, s29, 11
    v_cvt_pk_bf16_f32 v105, v90, v91
    v_mfma_f32_16x16x32_bf16 v[228:231], v[124:127], v[108:111], v[228:231]
    v_exp_f32 v94, v94
    v_mfma_f32_16x16x32_bf16 a[112:115], v[128:131], v[108:111], a[112:115]
    s_add_u32 s29, s28, s29
    v_exp_f32 v95, v95
    v_mfma_f32_16x16x32_bf16 a[140:143], v[132:135], v[108:111], a[140:143]
    v_add_f32 v14, v14, v92
    v_add_f32 v15, v15, v93
    v_mfma_f32_16x16x32_bf16 a[168:171], v[136:139], v[108:111], a[168:171]
    s_lshr_b32 s28, s34, 5
    v_cvt_pk_bf16_f32 v106, v92, v93
    v_add_f32 v14, v14, v94
    v_mfma_f32_16x16x32_bf16 a[196:199], v[140:143], v[108:111], a[196:199]
    v_add_f32 v15, v15, v95
    v_cvt_pk_bf16_f32 v107, v94, v95
    v_mfma_f32_16x16x32_bf16 v[88:91], v[56:59], a[48:51], v[40:43]
    v_mfma_f32_16x16x32_bf16 v[88:91], v[60:63], a[52:55], v[88:91]
    s_lshl_b32 s28, s28, 19
    v_exp_f32 v96, v96
    v_mfma_f32_16x16x32_bf16 v[88:91], v[64:67], a[56:59], v[88:91]
    v_exp_f32 v97, v97
    v_mfma_f32_16x16x32_bf16 v[88:91], v[68:71], a[60:63], v[88:91]
    s_add_u32 s49, s28, s29
    v_exp_f32 v98, v98
    v_mfma_f32_16x16x32_bf16 v[92:95], v[84:87], a[60:63], v[40:43]
    v_exp_f32 v99, v99
    v_mfma_f32_16x16x32_bf16 v[92:95], v[80:83], a[56:59], v[92:95]
    s_add_u32 m0, s33, 0
    v_add_f32 v16, v16, v96
    v_add_f32 v17, v17, v97
    v_mfma_f32_16x16x32_bf16 v[92:95], v[76:79], a[52:55], v[92:95]
    v_cvt_pk_bf16_f32 v108, v96, v97
    v_mfma_f32_16x16x32_bf16 v[92:95], v[72:75], a[48:51], v[92:95]
    v_exp_f32 v100, v100
    v_mfma_f32_16x16x32_bf16 v[148:151], v[112:115], v[104:107], v[148:151]
    s_add_u32 s34, s34, 1
    v_exp_f32 v101, v101
    v_mfma_f32_16x16x32_bf16 v[176:179], v[116:119], v[104:107], v[176:179]
    v_add_f32 v16, v16, v98
    v_add_f32 v17, v17, v99
    v_mfma_f32_16x16x32_bf16 v[204:207], v[120:123], v[104:107], v[204:207]
    buffer_load_dwordx4 v7, s[4:7], s49 offen offset:0 nt lds
    v_cvt_pk_bf16_f32 v109, v98, v99
    v_mfma_f32_16x16x32_bf16 v[232:235], v[124:127], v[104:107], v[232:235]
    v_exp_f32 v102, v102
    v_mfma_f32_16x16x32_bf16 a[116:119], v[128:131], v[104:107], a[116:119]
    s_add_u32 m0, m0, s96
    v_exp_f32 v103, v103
    v_mfma_f32_16x16x32_bf16 a[144:147], v[132:135], v[104:107], a[144:147]
    v_add_f32 v16, v16, v100
    v_add_f32 v17, v17, v101
    v_mfma_f32_16x16x32_bf16 a[172:175], v[136:139], v[104:107], a[172:175]
    buffer_load_dwordx4 v7, s[4:7], s49 offen offset:256 nt lds
    v_cvt_pk_bf16_f32 v110, v100, v101
    v_add_f32 v16, v16, v102
    v_mfma_f32_16x16x32_bf16 a[200:203], v[140:143], v[104:107], a[200:203]
    v_add_f32 v17, v17, v103
    v_cvt_pk_bf16_f32 v111, v102, v103
    v_mfma_f32_16x16x32_bf16 v[96:99], v[56:59], a[64:67], v[44:47]
    v_mfma_f32_16x16x32_bf16 v[96:99], v[60:63], a[68:71], v[96:99]
    s_add_u32 m0, m0, s97
    v_exp_f32 v88, v88
    v_mfma_f32_16x16x32_bf16 v[96:99], v[64:67], a[72:75], v[96:99]
    v_exp_f32 v89, v89
    v_mfma_f32_16x16x32_bf16 v[96:99], v[68:71], a[76:79], v[96:99]
    buffer_load_dwordx4 v7, s[4:7], s49 offen offset:512 nt lds
    v_exp_f32 v90, v90
    v_mfma_f32_16x16x32_bf16 v[100:103], v[84:87], a[76:79], v[44:47]
    v_exp_f32 v91, v91
    v_mfma_f32_16x16x32_bf16 v[100:103], v[80:83], a[72:75], v[100:103]
    s_add_u32 m0, m0, s96
    v_add_f32 v18, v18, v88
    v_add_f32 v19, v19, v89
    v_mfma_f32_16x16x32_bf16 v[100:103], v[76:79], a[68:71], v[100:103]
    v_cvt_pk_bf16_f32 v104, v88, v89
    v_mfma_f32_16x16x32_bf16 v[100:103], v[72:75], a[64:67], v[100:103]
    v_exp_f32 v92, v92
    v_mfma_f32_16x16x32_bf16 v[152:155], v[112:115], v[108:111], v[152:155]
    buffer_load_dwordx4 v7, s[4:7], s49 offen offset:768 nt lds
    v_exp_f32 v93, v93
    v_mfma_f32_16x16x32_bf16 v[180:183], v[116:119], v[108:111], v[180:183]
    v_add_f32 v18, v18, v90
    v_add_f32 v19, v19, v91
    v_mfma_f32_16x16x32_bf16 v[208:211], v[120:123], v[108:111], v[208:211]
    s_add_u32 m0, m0, s97
    v_cvt_pk_bf16_f32 v105, v90, v91
    v_mfma_f32_16x16x32_bf16 v[236:239], v[124:127], v[108:111], v[236:239]
    v_exp_f32 v94, v94
    v_mfma_f32_16x16x32_bf16 a[120:123], v[128:131], v[108:111], a[120:123]
    buffer_load_dwordx4 v7, s[4:7], s49 offen offset:1024 nt lds
    v_exp_f32 v95, v95
    v_mfma_f32_16x16x32_bf16 a[148:151], v[132:135], v[108:111], a[148:151]
    v_add_f32 v18, v18, v92
    v_add_f32 v19, v19, v93
    v_mfma_f32_16x16x32_bf16 a[176:179], v[136:139], v[108:111], a[176:179]
    s_add_u32 m0, m0, s96
    v_cvt_pk_bf16_f32 v106, v92, v93
    v_add_f32 v18, v18, v94
    v_mfma_f32_16x16x32_bf16 a[204:207], v[140:143], v[108:111], a[204:207]
    v_add_f32 v19, v19, v95
    v_cvt_pk_bf16_f32 v107, v94, v95
    v_mfma_f32_16x16x32_bf16 v[88:91], v[56:59], a[80:83], v[48:51]
    v_mfma_f32_16x16x32_bf16 v[88:91], v[60:63], a[84:87], v[88:91]
    buffer_load_dwordx4 v7, s[4:7], s49 offen offset:1280 nt lds
    v_exp_f32 v96, v96
    v_mfma_f32_16x16x32_bf16 v[88:91], v[64:67], a[88:91], v[88:91]
    v_exp_f32 v97, v97
    v_mfma_f32_16x16x32_bf16 v[88:91], v[68:71], a[92:95], v[88:91]
    s_add_u32 m0, m0, s97
    v_exp_f32 v98, v98
    v_mfma_f32_16x16x32_bf16 v[92:95], v[84:87], a[92:95], v[48:51]
    v_exp_f32 v99, v99
    v_mfma_f32_16x16x32_bf16 v[92:95], v[80:83], a[88:91], v[92:95]
    buffer_load_dwordx4 v7, s[4:7], s49 offen offset:1536 nt lds
    v_add_f32 v20, v20, v96
    v_add_f32 v21, v21, v97
    v_mfma_f32_16x16x32_bf16 v[92:95], v[76:79], a[84:87], v[92:95]
    v_cvt_pk_bf16_f32 v108, v96, v97
    v_mfma_f32_16x16x32_bf16 v[92:95], v[72:75], a[80:83], v[92:95]
    v_exp_f32 v100, v100
    v_mfma_f32_16x16x32_bf16 v[156:159], v[112:115], v[104:107], v[156:159]
    s_add_u32 m0, m0, s96
    v_exp_f32 v101, v101
    v_mfma_f32_16x16x32_bf16 v[184:187], v[116:119], v[104:107], v[184:187]
    v_add_f32 v20, v20, v98
    v_add_f32 v21, v21, v99
    v_mfma_f32_16x16x32_bf16 v[212:215], v[120:123], v[104:107], v[212:215]
    buffer_load_dwordx4 v7, s[4:7], s49 offen offset:1792 nt lds
    v_cvt_pk_bf16_f32 v109, v98, v99
    v_mfma_f32_16x16x32_bf16 v[240:243], v[124:127], v[104:107], v[240:243]
    v_exp_f32 v102, v102
    v_mfma_f32_16x16x32_bf16 a[124:127], v[128:131], v[104:107], a[124:127]
    v_exp_f32 v103, v103
    v_mfma_f32_16x16x32_bf16 a[152:155], v[132:135], v[104:107], a[152:155]
    v_add_f32 v20, v20, v100
    v_add_f32 v21, v21, v101
    v_mfma_f32_16x16x32_bf16 a[180:183], v[136:139], v[104:107], a[180:183]
    v_cvt_pk_bf16_f32 v110, v100, v101
    v_add_f32 v20, v20, v102
    v_mfma_f32_16x16x32_bf16 a[208:211], v[140:143], v[104:107], a[208:211]
    v_add_f32 v21, v21, v103
    v_cvt_pk_bf16_f32 v111, v102, v103
    s_cmp_eq_u32 s68, 0
    s_cbranch_scc0 L_bw1_3490
    s_waitcnt vmcnt(16) lgkmcnt(0)
L_bw2_3490:
    s_barrier
    v_mfma_f32_16x16x32_bf16 v[96:99], v[56:59], a[96:99], v[52:55]
    ds_read_b128 v[56:59], v8 offset:16896
    v_mfma_f32_16x16x32_bf16 v[96:99], v[60:63], a[100:103], v[96:99]
    ds_read_b128 v[60:63], v8 offset:16960
    v_exp_f32 v88, v88
    v_mfma_f32_16x16x32_bf16 v[96:99], v[64:67], a[104:107], v[96:99]
    ds_read_b128 v[64:67], v8 offset:17024
    v_exp_f32 v89, v89
    v_mfma_f32_16x16x32_bf16 v[96:99], v[68:71], a[108:111], v[96:99]
    ds_read_b128 v[68:71], v8 offset:17088
    v_exp_f32 v90, v90
    v_mfma_f32_16x16x32_bf16 v[100:103], v[84:87], a[108:111], v[52:55]
    ds_read_b128 v[84:87], v8 offset:17600
    v_exp_f32 v91, v91
    v_mfma_f32_16x16x32_bf16 v[100:103], v[80:83], a[104:107], v[100:103]
    ds_read_b128 v[80:83], v8 offset:17536
    v_add_f32 v22, v22, v88
    v_add_f32 v23, v23, v89
    v_mfma_f32_16x16x32_bf16 v[100:103], v[76:79], a[100:103], v[100:103]
    ds_read_b128 v[76:79], v8 offset:17472
    v_cvt_pk_bf16_f32 v104, v88, v89
    v_mfma_f32_16x16x32_bf16 v[100:103], v[72:75], a[96:99], v[100:103]
    ds_read_b128 v[72:75], v8 offset:17408
    v_exp_f32 v92, v92
    v_mfma_f32_16x16x32_bf16 v[160:163], v[112:115], v[108:111], v[160:163]
    v_exp_f32 v93, v93
    v_mfma_f32_16x16x32_bf16 v[188:191], v[116:119], v[108:111], v[188:191]
    v_add_f32 v22, v22, v90
    v_add_f32 v23, v23, v91
    v_mfma_f32_16x16x32_bf16 v[216:219], v[120:123], v[108:111], v[216:219]
    v_cvt_pk_bf16_f32 v105, v90, v91
    v_mfma_f32_16x16x32_bf16 v[244:247], v[124:127], v[108:111], v[244:247]
    v_exp_f32 v94, v94
    v_mfma_f32_16x16x32_bf16 a[128:131], v[128:131], v[108:111], a[128:131]
    v_exp_f32 v95, v95
    v_mfma_f32_16x16x32_bf16 a[156:159], v[132:135], v[108:111], a[156:159]
    v_add_f32 v22, v22, v92
    v_add_f32 v23, v23, v93
    v_mfma_f32_16x16x32_bf16 a[184:187], v[136:139], v[108:111], a[184:187]
    v_cvt_pk_bf16_f32 v106, v92, v93
    v_add_f32 v22, v22, v94
    v_mfma_f32_16x16x32_bf16 a[212:215], v[140:143], v[108:111], a[212:215]
    v_add_f32 v23, v23, v95
    v_cvt_pk_bf16_f32 v107, v94, v95
    s_waitcnt lgkmcnt(0)
    v_mfma_f32_16x16x32_bf16 v[88:91], v[56:59], a[0:3], v[28:31]
    v_mfma_f32_16x16x32_bf16 v[88:91], v[60:63], a[4:7], v[88:91]
    v_exp_f32 v96, v96
    v_mfma_f32_16x16x32_bf16 v[88:91], v[64:67], a[8:11], v[88:91]
    v_exp_f32 v97, v97
    v_mfma_f32_16x16x32_bf16 v[88:91], v[68:71], a[12:15], v[88:91]
    v_exp_f32 v98, v98
    v_mfma_f32_16x16x32_bf16 v[92:95], v[84:87], a[12:15], v[28:31]
    v_exp_f32 v99, v99
    v_mfma_f32_16x16x32_bf16 v[92:95], v[80:83], a[8:11], v[92:95]
    v_add_f32 v24, v24, v96
    v_add_f32 v25, v25, v97
    v_mfma_f32_16x16x32_bf16 v[92:95], v[76:79], a[4:7], v[92:95]
    v_cvt_pk_bf16_f32 v108, v96, v97
    v_mfma_f32_16x16x32_bf16 v[92:95], v[72:75], a[0:3], v[92:95]
    v_exp_f32 v100, v100
    v_mfma_f32_16x16x32_bf16 v[164:167], v[112:115], v[104:107], v[164:167]
    v_exp_f32 v101, v101
    v_mfma_f32_16x16x32_bf16 v[192:195], v[116:119], v[104:107], v[192:195]
    v_add_f32 v24, v24, v98
    v_add_f32 v25, v25, v99
    v_mfma_f32_16x16x32_bf16 v[220:223], v[120:123], v[104:107], v[220:223]
    v_cvt_pk_bf16_f32 v109, v98, v99
    v_mfma_f32_16x16x32_bf16 v[248:251], v[124:127], v[104:107], v[248:251]
    v_exp_f32 v102, v102
    v_mfma_f32_16x16x32_bf16 a[132:135], v[128:131], v[104:107], a[132:135]
    v_exp_f32 v103, v103
    v_mfma_f32_16x16x32_bf16 a[160:163], v[132:135], v[104:107], a[160:163]
    v_add_f32 v24, v24, v100
    v_add_f32 v25, v25, v101
    v_mfma_f32_16x16x32_bf16 a[188:191], v[136:139], v[104:107], a[188:191]
    v_cvt_pk_bf16_f32 v110, v100, v101
    v_add_f32 v24, v24, v102
    v_mfma_f32_16x16x32_bf16 a[216:219], v[140:143], v[104:107], a[216:219]
    v_add_f32 v25, v25, v103
    v_cvt_pk_bf16_f32 v111, v102, v103
    v_mfma_f32_16x16x32_bf16 v[96:99], v[56:59], a[16:19], v[32:35]
    v_mfma_f32_16x16x32_bf16 v[96:99], v[60:63], a[20:23], v[96:99]
    v_exp_f32 v88, v88
    v_mfma_f32_16x16x32_bf16 v[96:99], v[64:67], a[24:27], v[96:99]
    v_exp_f32 v89, v89
    v_mfma_f32_16x16x32_bf16 v[96:99], v[68:71], a[28:31], v[96:99]
    v_exp_f32 v90, v90
    v_mfma_f32_16x16x32_bf16 v[100:103], v[84:87], a[28:31], v[32:35]
    v_exp_f32 v91, v91
    v_mfma_f32_16x16x32_bf16 v[100:103], v[80:83], a[24:27], v[100:103]
    v_add_f32 v12, v12, v88
    v_add_f32 v13, v13, v89
    v_mfma_f32_16x16x32_bf16 v[100:103], v[76:79], a[20:23], v[100:103]
    v_cvt_pk_bf16_f32 v104, v88, v89
    v_mfma_f32_16x16x32_bf16 v[100:103], v[72:75], a[16:19], v[100:103]
    v_exp_f32 v92, v92
    v_mfma_f32_16x16x32_bf16 v[168:171], v[112:115], v[108:111], v[168:171]
    ds_read_b64_tr_b16 v[112:113], v9 offset:16896
    ds_read_b64_tr_b16 v[114:115], v9 offset:17408
    v_exp_f32 v93, v93
    v_mfma_f32_16x16x32_bf16 v[196:199], v[116:119], v[108:111], v[196:199]
    ds_read_b64_tr_b16 v[116:117], v9 offset:16928
    ds_read_b64_tr_b16 v[118:119], v9 offset:17440
    v_add_f32 v12, v12, v90
    v_add_f32 v13, v13, v91
    v_mfma_f32_16x16x32_bf16 v[224:227], v[120:123], v[108:111], v[224:227]
    ds_read_b64_tr_b16 v[120:121], v9 offset:16960
    ds_read_b64_tr_b16 v[122:123], v9 offset:17472
    v_cvt_pk_bf16_f32 v105, v90, v91
    v_mfma_f32_16x16x32_bf16 v[252:255], v[124:127], v[108:111], v[252:255]
    ds_read_b64_tr_b16 v[124:125], v9 offset:16992
    ds_read_b64_tr_b16 v[126:127], v9 offset:17504
    v_exp_f32 v94, v94
    v_mfma_f32_16x16x32_bf16 a[136:139], v[128:131], v[108:111], a[136:139]
    ds_read_b64_tr_b16 v[128:129], v9 offset:17024
    ds_read_b64_tr_b16 v[130:131], v9 offset:17536
    v_exp_f32 v95, v95
    v_mfma_f32_16x16x32_bf16 a[164:167], v[132:135], v[108:111], a[164:167]
    ds_read_b64_tr_b16 v[132:133], v9 offset:17056
    ds_read_b64_tr_b16 v[134:135], v9 offset:17568
    v_add_f32 v12, v12, v92
    v_add_f32 v13, v13, v93
    v_mfma_f32_16x16x32_bf16 a[192:195], v[136:139], v[108:111], a[192:195]
    ds_read_b64_tr_b16 v[136:137], v9 offset:17088
    ds_read_b64_tr_b16 v[138:139], v9 offset:17600
    v_cvt_pk_bf16_f32 v106, v92, v93
    v_add_f32 v12, v12, v94
    v_mfma_f32_16x16x32_bf16 a[220:223], v[140:143], v[108:111], a[220:223]
    ds_read_b64_tr_b16 v[140:141], v9 offset:17120
    ds_read_b64_tr_b16 v[142:143], v9 offset:17632
    v_add_f32 v13, v13, v95
    v_cvt_pk_bf16_f32 v107, v94, v95
    v_mfma_f32_16x16x32_bf16 v[88:91], v[56:59], a[32:35], v[36:39]
    v_mfma_f32_16x16x32_bf16 v[88:91], v[60:63], a[36:39], v[88:91]
    s_add_u32 s29, s34, s100
    v_exp_f32 v96, v96
    v_mfma_f32_16x16x32_bf16 v[88:91], v[64:67], a[40:43], v[88:91]
    v_exp_f32 v97, v97
    v_mfma_f32_16x16x32_bf16 v[88:91], v[68:71], a[44:47], v[88:91]
    s_bfe_u32 s28, s29, 0x20003
    v_exp_f32 v98, v98
    v_mfma_f32_16x16x32_bf16 v[92:95], v[84:87], a[44:47], v[36:39]
    v_exp_f32 v99, v99
    v_mfma_f32_16x16x32_bf16 v[92:95], v[80:83], a[40:43], v[92:95]
    s_lshl_b32 s28, s28, 16
    v_add_f32 v14, v14, v96
    v_add_f32 v15, v15, v97
    v_mfma_f32_16x16x32_bf16 v[92:95], v[76:79], a[36:39], v[92:95]
    v_cvt_pk_bf16_f32 v108, v96, v97
    v_mfma_f32_16x16x32_bf16 v[92:95], v[72:75], a[32:35], v[92:95]
    v_exp_f32 v100, v100
    s_waitcnt lgkmcnt(0)
    v_mfma_f32_16x16x32_bf16 v[144:147], v[112:115], v[104:107], v[144:147]
    s_and_b32 s29, s29, 7
    v_exp_f32 v101, v101
    v_mfma_f32_16x16x32_bf16 v[172:175], v[116:119], v[104:107], v[172:175]
    v_add_f32 v14, v14, v98
    v_add_f32 v15, v15, v99
    v_mfma_f32_16x16x32_bf16 v[200:203], v[120:123], v[104:107], v[200:203]
    s_lshl_b32 s29, s29, 11
    v_cvt_pk_bf16_f32 v109, v98, v99
    v_mfma_f32_16x16x32_bf16 v[228:231], v[124:127], v[104:107], v[228:231]
    v_exp_f32 v102, v102
    v_mfma_f32_16x16x32_bf16 a[112:115], v[128:131], v[104:107], a[112:115]
    s_add_u32 s29, s28, s29
    v_exp_f32 v103, v103
    v_mfma_f32_16x16x32_bf16 a[140:143], v[132:135], v[104:107], a[140:143]
    v_add_f32 v14, v14, v100
    v_add_f32 v15, v15, v101
    v_mfma_f32_16x16x32_bf16 a[168:171], v[136:139], v[104:107], a[168:171]
    s_lshr_b32 s28, s34, 5
    v_cvt_pk_bf16_f32 v110, v100, v101
    v_add_f32 v14, v14, v102
    v_mfma_f32_16x16x32_bf16 a[196:199], v[140:143], v[104:107], a[196:199]
    v_add_f32 v15, v15, v103
    v_cvt_pk_bf16_f32 v111, v102, v103
    v_mfma_f32_16x16x32_bf16 v[96:99], v[56:59], a[48:51], v[40:43]
    v_mfma_f32_16x16x32_bf16 v[96:99], v[60:63], a[52:55], v[96:99]
    s_lshl_b32 s28, s28, 19
    v_exp_f32 v88, v88
    v_mfma_f32_16x16x32_bf16 v[96:99], v[64:67], a[56:59], v[96:99]
    v_exp_f32 v89, v89
    v_mfma_f32_16x16x32_bf16 v[96:99], v[68:71], a[60:63], v[96:99]
    s_add_u32 s49, s28, s29
    v_exp_f32 v90, v90
    v_mfma_f32_16x16x32_bf16 v[100:103], v[84:87], a[60:63], v[40:43]
    v_exp_f32 v91, v91
    v_mfma_f32_16x16x32_bf16 v[100:103], v[80:83], a[56:59], v[100:103]
    s_add_u32 m0, s33, 8448
    v_add_f32 v16, v16, v88
    v_add_f32 v17, v17, v89
    v_mfma_f32_16x16x32_bf16 v[100:103], v[76:79], a[52:55], v[100:103]
    v_cvt_pk_bf16_f32 v104, v88, v89
    v_mfma_f32_16x16x32_bf16 v[100:103], v[72:75], a[48:51], v[100:103]
    v_exp_f32 v92, v92
    v_mfma_f32_16x16x32_bf16 v[148:151], v[112:115], v[108:111], v[148:151]
    s_add_u32 s34, s34, 1
    v_exp_f32 v93, v93
    v_mfma_f32_16x16x32_bf16 v[176:179], v[116:119], v[108:111], v[176:179]
    v_add_f32 v16, v16, v90
    v_add_f32 v17, v17, v91
    v_mfma_f32_16x16x32_bf16 v[204:207], v[120:123], v[108:111], v[204:207]
    buffer_load_dwordx4 v7, s[4:7], s49 offen offset:0 nt lds
    v_cvt_pk_bf16_f32 v105, v90, v91
    v_mfma_f32_16x16x32_bf16 v[232:235], v[124:127], v[108:111], v[232:235]
    v_exp_f32 v94, v94
    v_mfma_f32_16x16x32_bf16 a[116:119], v[128:131], v[108:111], a[116:119]
    s_add_u32 m0, m0, s96
    v_exp_f32 v95, v95
    v_mfma_f32_16x16x32_bf16 a[144:147], v[132:135], v[108:111], a[144:147]
    v_add_f32 v16, v16, v92
    v_add_f32 v17, v17, v93
    v_mfma_f32_16x16x32_bf16 a[172:175], v[136:139], v[108:111], a[172:175]
    buffer_load_dwordx4 v7, s[4:7], s49 offen offset:256 nt lds
    v_cvt_pk_bf16_f32 v106, v92, v93
    v_add_f32 v16, v16, v94
    v_mfma_f32_16x16x32_bf16 a[200:203], v[140:143], v[108:111], a[200:203]
    v_add_f32 v17, v17, v95
    v_cvt_pk_bf16_f32 v107, v94, v95
    v_mfma_f32_16x16x32_bf16 v[88:91], v[56:59], a[64:67], v[44:47]
    v_mfma_f32_16x16x32_bf16 v[88:91], v[60:63], a[68:71], v[88:91]
    s_add_u32 m0, m0, s97
    v_exp_f32 v96, v96
    v_mfma_f32_16x16x32_bf16 v[88:91], v[64:67], a[72:75], v[88:91]
    v_exp_f32 v97, v97
    v_mfma_f32_16x16x32_bf16 v[88:91], v[68:71], a[76:79], v[88:91]
    buffer_load_dwordx4 v7, s[4:7], s49 offen offset:512 nt lds
    v_exp_f32 v98, v98
    v_mfma_f32_16x16x32_bf16 v[92:95], v[84:87], a[76:79], v[44:47]
    v_exp_f32 v99, v99
    v_mfma_f32_16x16x32_bf16 v[92:95], v[80:83], a[72:75], v[92:95]
    s_add_u32 m0, m0, s96
    v_add_f32 v18, v18, v96
    v_add_f32 v19, v19, v97
    v_mfma_f32_16x16x32_bf16 v[92:95], v[76:79], a[68:71], v[92:95]
    v_cvt_pk_bf16_f32 v108, v96, v97
    v_mfma_f32_16x16x32_bf16 v[92:95], v[72:75], a[64:67], v[92:95]
    v_exp_f32 v100, v100
    v_mfma_f32_16x16x32_bf16 v[152:155], v[112:115], v[104:107], v[152:155]
    buffer_load_dwordx4 v7, s[4:7], s49 offen offset:768 nt lds
    v_exp_f32 v101, v101
    v_mfma_f32_16x16x32_bf16 v[180:183], v[116:119], v[104:107], v[180:183]
    v_add_f32 v18, v18, v98
    v_add_f32 v19, v19, v99
    v_mfma_f32_16x16x32_bf16 v[208:211], v[120:123], v[104:107], v[208:211]
    s_add_u32 m0, m0, s97
    v_cvt_pk_bf16_f32 v109, v98, v99
    v_mfma_f32_16x16x32_bf16 v[236:239], v[124:127], v[104:107], v[236:239]
    v_exp_f32 v102, v102
    v_mfma_f32_16x16x32_bf16 a[120:123], v[128:131], v[104:107], a[120:123]
    buffer_load_dwordx4 v7, s[4:7], s49 offen offset:1024 nt lds
    v_exp_f32 v103, v103
    v_mfma_f32_16x16x32_bf16 a[148:151], v[132:135], v[104:107], a[148:151]
    v_add_f32 v18, v18, v100
    v_add_f32 v19, v19, v101
    v_mfma_f32_16x16x32_bf16 a[176:179], v[136:139], v[104:107], a[176:179]
    s_add_u32 m0, m0, s96
    v_cvt_pk_bf16_f32 v110, v100, v101
    v_add_f32 v18, v18, v102
    v_mfma_f32_16x16x32_bf16 a[204:207], v[140:143], v[104:107], a[204:207]
    v_add_f32 v19, v19, v103
    v_cvt_pk_bf16_f32 v111, v102, v103
    v_mfma_f32_16x16x32_bf16 v[96:99], v[56:59], a[80:83], v[48:51]
    v_mfma_f32_16x16x32_bf16 v[96:99], v[60:63], a[84:87], v[96:99]
    buffer_load_dwordx4 v7, s[4:7], s49 offen offset:1280 nt lds
    v_exp_f32 v88, v88
    v_mfma_f32_16x16x32_bf16 v[96:99], v[64:67], a[88:91], v[96:99]
    v_exp_f32 v89, v89
    v_mfma_f32_16x16x32_bf16 v[96:99], v[68:71], a[92:95], v[96:99]
    s_add_u32 m0, m0, s97
    v_exp_f32 v90, v90
    v_mfma_f32_16x16x32_bf16 v[100:103], v[84:87], a[92:95], v[48:51]
    v_exp_f32 v91, v91
    v_mfma_f32_16x16x32_bf16 v[100:103], v[80:83], a[88:91], v[100:103]
    buffer_load_dwordx4 v7, s[4:7], s49 offen offset:1536 nt lds
    v_add_f32 v20, v20, v88
    v_add_f32 v21, v21, v89
    v_mfma_f32_16x16x32_bf16 v[100:103], v[76:79], a[84:87], v[100:103]
    v_cvt_pk_bf16_f32 v104, v88, v89
    v_mfma_f32_16x16x32_bf16 v[100:103], v[72:75], a[80:83], v[100:103]
    v_exp_f32 v92, v92
    v_mfma_f32_16x16x32_bf16 v[156:159], v[112:115], v[108:111], v[156:159]
    s_add_u32 m0, m0, s96
    v_exp_f32 v93, v93
    v_mfma_f32_16x16x32_bf16 v[184:187], v[116:119], v[108:111], v[184:187]
    v_add_f32 v20, v20, v90
    v_add_f32 v21, v21, v91
    v_mfma_f32_16x16x32_bf16 v[212:215], v[120:123], v[108:111], v[212:215]
    buffer_load_dwordx4 v7, s[4:7], s49 offen offset:1792 nt lds
    v_cvt_pk_bf16_f32 v105, v90, v91
    v_mfma_f32_16x16x32_bf16 v[240:243], v[124:127], v[108:111], v[240:243]
    v_exp_f32 v94, v94
    v_mfma_f32_16x16x32_bf16 a[124:127], v[128:131], v[108:111], a[124:127]
    v_exp_f32 v95, v95
    v_mfma_f32_16x16x32_bf16 a[152:155], v[132:135], v[108:111], a[152:155]
    v_add_f32 v20, v20, v92
    v_add_f32 v21, v21, v93
    v_mfma_f32_16x16x32_bf16 a[180:183], v[136:139], v[108:111], a[180:183]
    v_cvt_pk_bf16_f32 v106, v92, v93
    v_add_f32 v20, v20, v94
    v_mfma_f32_16x16x32_bf16 a[208:211], v[140:143], v[108:111], a[208:211]
    v_add_f32 v21, v21, v95
    v_cvt_pk_bf16_f32 v107, v94, v95
    s_cmp_eq_u32 s68, 0
    s_cbranch_scc0 L_bw1_3799
    s_waitcnt vmcnt(16) lgkmcnt(0)
L_bw2_3799:
    s_barrier
    v_mfma_f32_16x16x32_bf16 v[88:91], v[56:59], a[96:99], v[52:55]
    ds_read_b128 v[56:59], v8 offset:25344
    v_mfma_f32_16x16x32_bf16 v[88:91], v[60:63], a[100:103], v[88:91]
    ds_read_b128 v[60:63], v8 offset:25408
    v_exp_f32 v96, v96
    v_mfma_f32_16x16x32_bf16 v[88:91], v[64:67], a[104:107], v[88:91]
    ds_read_b128 v[64:67], v8 offset:25472
    v_exp_f32 v97, v97
    v_mfma_f32_16x16x32_bf16 v[88:91], v[68:71], a[108:111], v[88:91]
    ds_read_b128 v[68:71], v8 offset:25536
    v_exp_f32 v98, v98
    v_mfma_f32_16x16x32_bf16 v[92:95], v[84:87], a[108:111], v[52:55]
    ds_read_b128 v[84:87], v8 offset:26048
    v_exp_f32 v99, v99
    v_mfma_f32_16x16x32_bf16 v[92:95], v[80:83], a[104:107], v[92:95]
    ds_read_b128 v[80:83], v8 offset:25984
    v_add_f32 v22, v22, v96
    v_add_f32 v23, v23, v97
    v_mfma_f32_16x16x32_bf16 v[92:95], v[76:79], a[100:103], v[92:95]
    ds_read_b128 v[76:79], v8 offset:25920
    v_cvt_pk_bf16_f32 v108, v96, v97
    v_mfma_f32_16x16x32_bf16 v[92:95], v[72:75], a[96:99], v[92:95]
    ds_read_b128 v[72:75], v8 offset:25856
    v_exp_f32 v100, v100
    v_mfma_f32_16x16x32_bf16 v[160:163], v[112:115], v[104:107], v[160:163]
    v_exp_f32 v101, v101
    v_mfma_f32_16x16x32_bf16 v[188:191], v[116:119], v[104:107], v[188:191]
    v_add_f32 v22, v22, v98
    v_add_f32 v23, v23, v99
    v_mfma_f32_16x16x32_bf16 v[216:219], v[120:123], v[104:107], v[216:219]
    v_cvt_pk_bf16_f32 v109, v98, v99
    v_mfma_f32_16x16x32_bf16 v[244:247], v[124:127], v[104:107], v[244:247]
    v_exp_f32 v102, v102
    v_mfma_f32_16x16x32_bf16 a[128:131], v[128:131], v[104:107], a[128:131]
    v_exp_f32 v103, v103
    v_mfma_f32_16x16x32_bf16 a[156:159], v[132:135], v[104:107], a[156:159]
    v_add_f32 v22, v22, v100
    v_add_f32 v23, v23, v101
    v_mfma_f32_16x16x32_bf16 a[184:187], v[136:139], v[104:107], a[184:187]
    v_cvt_pk_bf16_f32 v110, v100, v101
    v_add_f32 v22, v22, v102
    v_mfma_f32_16x16x32_bf16 a[212:215], v[140:143], v[104:107], a[212:215]
    v_add_f32 v23, v23, v103
    v_cvt_pk_bf16_f32 v111, v102, v103
    s_waitcnt lgkmcnt(0)
    v_mfma_f32_16x16x32_bf16 v[96:99], v[56:59], a[0:3], v[28:31]
    v_mfma_f32_16x16x32_bf16 v[96:99], v[60:63], a[4:7], v[96:99]
    v_exp_f32 v88, v88
    v_mfma_f32_16x16x32_bf16 v[96:99], v[64:67], a[8:11], v[96:99]
    v_exp_f32 v89, v89
    v_mfma_f32_16x16x32_bf16 v[96:99], v[68:71], a[12:15], v[96:99]
    v_exp_f32 v90, v90
    v_mfma_f32_16x16x32_bf16 v[100:103], v[84:87], a[12:15], v[28:31]
    v_exp_f32 v91, v91
    v_mfma_f32_16x16x32_bf16 v[100:103], v[80:83], a[8:11], v[100:103]
    v_add_f32 v24, v24, v88
    v_add_f32 v25, v25, v89
    v_mfma_f32_16x16x32_bf16 v[100:103], v[76:79], a[4:7], v[100:103]
    v_cvt_pk_bf16_f32 v104, v88, v89
    v_mfma_f32_16x16x32_bf16 v[100:103], v[72:75], a[0:3], v[100:103]
    v_exp_f32 v92, v92
    v_mfma_f32_16x16x32_bf16 v[164:167], v[112:115], v[108:111], v[164:167]
    v_exp_f32 v93, v93
    v_mfma_f32_16x16x32_bf16 v[192:195], v[116:119], v[108:111], v[192:195]
    v_add_f32 v24, v24, v90
    v_add_f32 v25, v25, v91
    v_mfma_f32_16x16x32_bf16 v[220:223], v[120:123], v[108:111], v[220:223]
    v_cvt_pk_bf16_f32 v105, v90, v91
    v_mfma_f32_16x16x32_bf16 v[248:251], v[124:127], v[108:111], v[248:251]
    v_exp_f32 v94, v94
    v_mfma_f32_16x16x32_bf16 a[132:135], v[128:131], v[108:111], a[132:135]
    v_exp_f32 v95, v95
    v_mfma_f32_16x16x32_bf16 a[160:163], v[132:135], v[108:111], a[160:163]
    v_add_f32 v24, v24, v92
    v_add_f32 v25, v25, v93
    v_mfma_f32_16x16x32_bf16 a[188:191], v[136:139], v[108:111], a[188:191]
    v_cvt_pk_bf16_f32 v106, v92, v93
    v_add_f32 v24, v24, v94
    v_mfma_f32_16x16x32_bf16 a[216:219], v[140:143], v[108:111], a[216:219]
    v_add_f32 v25, v25, v95
    v_cvt_pk_bf16_f32 v107, v94, v95
    v_mfma_f32_16x16x32_bf16 v[88:91], v[56:59], a[16:19], v[32:35]
    v_mfma_f32_16x16x32_bf16 v[88:91], v[60:63], a[20:23], v[88:91]
    v_exp_f32 v96, v96
    v_mfma_f32_16x16x32_bf16 v[88:91], v[64:67], a[24:27], v[88:91]
    v_exp_f32 v97, v97
    v_mfma_f32_16x16x32_bf16 v[88:91], v[68:71], a[28:31], v[88:91]
    v_exp_f32 v98, v98
    v_mfma_f32_16x16x32_bf16 v[92:95], v[84:87], a[28:31], v[32:35]
    v_exp_f32 v99, v99
    v_mfma_f32_16x16x32_bf16 v[92:95], v[80:83], a[24:27], v[92:95]
    v_add_f32 v12, v12, v96
    v_add_f32 v13, v13, v97
    v_mfma_f32_16x16x32_bf16 v[92:95], v[76:79], a[20:23], v[92:95]
    v_cvt_pk_bf16_f32 v108, v96, v97
    v_mfma_f32_16x16x32_bf16 v[92:95], v[72:75], a[16:19], v[92:95]
    v_exp_f32 v100, v100
    v_mfma_f32_16x16x32_bf16 v[168:171], v[112:115], v[104:107], v[168:171]
    ds_read_b64_tr_b16 v[112:113], v9 offset:25344
    ds_read_b64_tr_b16 v[114:115], v9 offset:25856
    v_exp_f32 v101, v101
    v_mfma_f32_16x16x32_bf16 v[196:199], v[116:119], v[104:107], v[196:199]
    ds_read_b64_tr_b16 v[116:117], v9 offset:25376
    ds_read_b64_tr_b16 v[118:119], v9 offset:25888
    v_add_f32 v12, v12, v98
    v_add_f32 v13, v13, v99
    v_mfma_f32_16x16x32_bf16 v[224:227], v[120:123], v[104:107], v[224:227]
    ds_read_b64_tr_b16 v[120:121], v9 offset:25408
    ds_read_b64_tr_b16 v[122:123], v9 offset:25920
    v_cvt_pk_bf16_f32 v109, v98, v99
    v_mfma_f32_16x16x32_bf16 v[252:255], v[124:127], v[104:107], v[252:255]
    ds_read_b64_tr_b16 v[124:125], v9 offset:25440
    ds_read_b64_tr_b16 v[126:127], v9 offset:25952
    v_exp_f32 v102, v102
    v_mfma_f32_16x16x32_bf16 a[136:139], v[128:131], v[104:107], a[136:139]
    ds_read_b64_tr_b16 v[128:129], v9 offset:25472
    ds_read_b64_tr_b16 v[130:131], v9 offset:25984
    v_exp_f32 v103, v103
    v_mfma_f32_16x16x32_bf16 a[164:167], v[132:135], v[104:107], a[164:167]
    ds_read_b64_tr_b16 v[132:133], v9 offset:25504
    ds_read_b64_tr_b16 v[134:135], v9 offset:26016
    v_add_f32 v12, v12, v100
    v_add_f32 v13, v13, v101
    v_mfma_f32_16x16x32_bf16 a[192:195], v[136:139], v[104:107], a[192:195]
    ds_read_b64_tr_b16 v[136:137], v9 offset:25536
    ds_read_b64_tr_b16 v[138:139], v9 offset:26048
    v_cvt_pk_bf16_f32 v110, v100, v101
    v_add_f32 v12, v12, v102
    v_mfma_f32_16x16x32_bf16 a[220:223], v[140:143], v[104:107], a[220:223]
    ds_read_b64_tr_b16 v[140:141], v9 offset:25568
    ds_read_b64_tr_b16 v[142:143], v9 offset:26080
    v_add_f32 v13, v13, v103
    v_cvt_pk_bf16_f32 v111, v102, v103
    v_mfma_f32_16x16x32_bf16 v[96:99], v[56:59], a[32:35], v[36:39]
    v_mfma_f32_16x16x32_bf16 v[96:99], v[60:63], a[36:39], v[96:99]
    s_add_u32 s29, s34, s100
    v_exp_f32 v88, v88
    v_mfma_f32_16x16x32_bf16 v[96:99], v[64:67], a[40:43], v[96:99]
    v_exp_f32 v89, v89
    v_mfma_f32_16x16x32_bf16 v[96:99], v[68:71], a[44:47], v[96:99]
    s_bfe_u32 s28, s29, 0x20003
    v_exp_f32 v90, v90
    v_mfma_f32_16x16x32_bf16 v[100:103], v[84:87], a[44:47], v[36:39]
    v_exp_f32 v91, v91
    v_mfma_f32_16x16x32_bf16 v[100:103], v[80:83], a[40:43], v[100:103]
    s_lshl_b32 s28, s28, 16
    v_add_f32 v14, v14, v88
    v_add_f32 v15, v15, v89
    v_mfma_f32_16x16x32_bf16 v[100:103], v[76:79], a[36:39], v[100:103]
    v_cvt_pk_bf16_f32 v104, v88, v89
    v_mfma_f32_16x16x32_bf16 v[100:103], v[72:75], a[32:35], v[100:103]
    v_exp_f32 v92, v92
    s_waitcnt lgkmcnt(0)
    v_mfma_f32_16x16x32_bf16 v[144:147], v[112:115], v[108:111], v[144:147]
    s_and_b32 s29, s29, 7
    v_exp_f32 v93, v93
    v_mfma_f32_16x16x32_bf16 v[172:175], v[116:119], v[108:111], v[172:175]
    v_add_f32 v14, v14, v90
    v_add_f32 v15, v15, v91
    v_mfma_f32_16x16x32_bf16 v[200:203], v[120:123], v[108:111], v[200:203]
    s_lshl_b32 s29, s29, 11
    v_cvt_pk_bf16_f32 v105, v90, v91
    v_mfma_f32_16x16x32_bf16 v[228:231], v[124:127], v[108:111], v[228:231]
    v_exp_f32 v94, v94
    v_mfma_f32_16x16x32_bf16 a[112:115], v[128:131], v[108:111], a[112:115]
    s_add_u32 s29, s28, s29
    v_exp_f32 v95, v95
    v_mfma_f32_16x16x32_bf16 a[140:143], v[132:135], v[108:111], a[140:143]
    v_add_f32 v14, v14, v92
    v_add_f32 v15, v15, v93
    v_mfma_f32_16x16x32_bf16 a[168:171], v[136:139], v[108:111], a[168:171]
    s_lshr_b32 s28, s34, 5
    v_cvt_pk_bf16_f32 v106, v92, v93
    v_add_f32 v14, v14, v94
    v_mfma_f32_16x16x32_bf16 a[196:199], v[140:143], v[108:111], a[196:199]
    v_add_f32 v15, v15, v95
    v_cvt_pk_bf16_f32 v107, v94, v95
    v_mfma_f32_16x16x32_bf16 v[88:91], v[56:59], a[48:51], v[40:43]
    v_mfma_f32_16x16x32_bf16 v[88:91], v[60:63], a[52:55], v[88:91]
    s_lshl_b32 s28, s28, 19
    v_exp_f32 v96, v96
    v_mfma_f32_16x16x32_bf16 v[88:91], v[64:67], a[56:59], v[88:91]
    v_exp_f32 v97, v97
    v_mfma_f32_16x16x32_bf16 v[88:91], v[68:71], a[60:63], v[88:91]
    s_add_u32 s49, s28, s29
    v_exp_f32 v98, v98
    v_mfma_f32_16x16x32_bf16 v[92:95], v[84:87], a[60:63], v[40:43]
    v_exp_f32 v99, v99
    v_mfma_f32_16x16x32_bf16 v[92:95], v[80:83], a[56:59], v[92:95]
    s_add_u32 m0, s33, 16896
    v_add_f32 v16, v16, v96
    v_add_f32 v17, v17, v97
    v_mfma_f32_16x16x32_bf16 v[92:95], v[76:79], a[52:55], v[92:95]
    v_cvt_pk_bf16_f32 v108, v96, v97
    v_mfma_f32_16x16x32_bf16 v[92:95], v[72:75], a[48:51], v[92:95]
    v_exp_f32 v100, v100
    v_mfma_f32_16x16x32_bf16 v[148:151], v[112:115], v[104:107], v[148:151]
    s_add_u32 s34, s34, 1
    v_exp_f32 v101, v101
    v_mfma_f32_16x16x32_bf16 v[176:179], v[116:119], v[104:107], v[176:179]
    v_add_f32 v16, v16, v98
    v_add_f32 v17, v17, v99
    v_mfma_f32_16x16x32_bf16 v[204:207], v[120:123], v[104:107], v[204:207]
    buffer_load_dwordx4 v7, s[4:7], s49 offen offset:0 nt lds
    v_cvt_pk_bf16_f32 v109, v98, v99
    v_mfma_f32_16x16x32_bf16 v[232:235], v[124:127], v[104:107], v[232:235]
    v_exp_f32 v102, v102
    v_mfma_f32_16x16x32_bf16 a[116:119], v[128:131], v[104:107], a[116:119]
    s_add_u32 m0, m0, s96
    v_exp_f32 v103, v103
    v_mfma_f32_16x16x32_bf16 a[144:147], v[132:135], v[104:107], a[144:147]
    v_add_f32 v16, v16, v100
    v_add_f32 v17, v17, v101
    v_mfma_f32_16x16x32_bf16 a[172:175], v[136:139], v[104:107], a[172:175]
    buffer_load_dwordx4 v7, s[4:7], s49 offen offset:256 nt lds
    v_cvt_pk_bf16_f32 v110, v100, v101
    v_add_f32 v16, v16, v102
    v_mfma_f32_16x16x32_bf16 a[200:203], v[140:143], v[104:107], a[200:203]
    v_add_f32 v17, v17, v103
    v_cvt_pk_bf16_f32 v111, v102, v103
    v_mfma_f32_16x16x32_bf16 v[96:99], v[56:59], a[64:67], v[44:47]
    v_mfma_f32_16x16x32_bf16 v[96:99], v[60:63], a[68:71], v[96:99]
    s_add_u32 m0, m0, s97
    v_exp_f32 v88, v88
    v_mfma_f32_16x16x32_bf16 v[96:99], v[64:67], a[72:75], v[96:99]
    v_exp_f32 v89, v89
    v_mfma_f32_16x16x32_bf16 v[96:99], v[68:71], a[76:79], v[96:99]
    buffer_load_dwordx4 v7, s[4:7], s49 offen offset:512 nt lds
    v_exp_f32 v90, v90
    v_mfma_f32_16x16x32_bf16 v[100:103], v[84:87], a[76:79], v[44:47]
    v_exp_f32 v91, v91
    v_mfma_f32_16x16x32_bf16 v[100:103], v[80:83], a[72:75], v[100:103]
    s_add_u32 m0, m0, s96
    v_add_f32 v18, v18, v88
    v_add_f32 v19, v19, v89
    v_mfma_f32_16x16x32_bf16 v[100:103], v[76:79], a[68:71], v[100:103]
    v_cvt_pk_bf16_f32 v104, v88, v89
    v_mfma_f32_16x16x32_bf16 v[100:103], v[72:75], a[64:67], v[100:103]
    v_exp_f32 v92, v92
    v_mfma_f32_16x16x32_bf16 v[152:155], v[112:115], v[108:111], v[152:155]
    buffer_load_dwordx4 v7, s[4:7], s49 offen offset:768 nt lds
    v_exp_f32 v93, v93
    v_mfma_f32_16x16x32_bf16 v[180:183], v[116:119], v[108:111], v[180:183]
    v_add_f32 v18, v18, v90
    v_add_f32 v19, v19, v91
    v_mfma_f32_16x16x32_bf16 v[208:211], v[120:123], v[108:111], v[208:211]
    s_add_u32 m0, m0, s97
    v_cvt_pk_bf16_f32 v105, v90, v91
    v_mfma_f32_16x16x32_bf16 v[236:239], v[124:127], v[108:111], v[236:239]
    v_exp_f32 v94, v94
    v_mfma_f32_16x16x32_bf16 a[120:123], v[128:131], v[108:111], a[120:123]
    buffer_load_dwordx4 v7, s[4:7], s49 offen offset:1024 nt lds
    v_exp_f32 v95, v95
    v_mfma_f32_16x16x32_bf16 a[148:151], v[132:135], v[108:111], a[148:151]
    v_add_f32 v18, v18, v92
    v_add_f32 v19, v19, v93
    v_mfma_f32_16x16x32_bf16 a[176:179], v[136:139], v[108:111], a[176:179]
    s_add_u32 m0, m0, s96
    v_cvt_pk_bf16_f32 v106, v92, v93
    v_add_f32 v18, v18, v94
    v_mfma_f32_16x16x32_bf16 a[204:207], v[140:143], v[108:111], a[204:207]
    v_add_f32 v19, v19, v95
    v_cvt_pk_bf16_f32 v107, v94, v95
    v_mfma_f32_16x16x32_bf16 v[88:91], v[56:59], a[80:83], v[48:51]
    v_mfma_f32_16x16x32_bf16 v[88:91], v[60:63], a[84:87], v[88:91]
    buffer_load_dwordx4 v7, s[4:7], s49 offen offset:1280 nt lds
    v_exp_f32 v96, v96
    v_mfma_f32_16x16x32_bf16 v[88:91], v[64:67], a[88:91], v[88:91]
    v_exp_f32 v97, v97
    v_mfma_f32_16x16x32_bf16 v[88:91], v[68:71], a[92:95], v[88:91]
    s_add_u32 m0, m0, s97
    v_exp_f32 v98, v98
    v_mfma_f32_16x16x32_bf16 v[92:95], v[84:87], a[92:95], v[48:51]
    v_exp_f32 v99, v99
    v_mfma_f32_16x16x32_bf16 v[92:95], v[80:83], a[88:91], v[92:95]
    buffer_load_dwordx4 v7, s[4:7], s49 offen offset:1536 nt lds
    v_add_f32 v20, v20, v96
    v_add_f32 v21, v21, v97
    v_mfma_f32_16x16x32_bf16 v[92:95], v[76:79], a[84:87], v[92:95]
    v_cvt_pk_bf16_f32 v108, v96, v97
    v_mfma_f32_16x16x32_bf16 v[92:95], v[72:75], a[80:83], v[92:95]
    v_exp_f32 v100, v100
    v_mfma_f32_16x16x32_bf16 v[156:159], v[112:115], v[104:107], v[156:159]
    s_add_u32 m0, m0, s96
    v_exp_f32 v101, v101
    v_mfma_f32_16x16x32_bf16 v[184:187], v[116:119], v[104:107], v[184:187]
    v_add_f32 v20, v20, v98
    v_add_f32 v21, v21, v99
    v_mfma_f32_16x16x32_bf16 v[212:215], v[120:123], v[104:107], v[212:215]
    buffer_load_dwordx4 v7, s[4:7], s49 offen offset:1792 nt lds
    v_cvt_pk_bf16_f32 v109, v98, v99
    v_mfma_f32_16x16x32_bf16 v[240:243], v[124:127], v[104:107], v[240:243]
    v_exp_f32 v102, v102
    v_mfma_f32_16x16x32_bf16 a[124:127], v[128:131], v[104:107], a[124:127]
    v_exp_f32 v103, v103
    v_mfma_f32_16x16x32_bf16 a[152:155], v[132:135], v[104:107], a[152:155]
    v_add_f32 v20, v20, v100
    v_add_f32 v21, v21, v101
    v_mfma_f32_16x16x32_bf16 a[180:183], v[136:139], v[104:107], a[180:183]
    v_cvt_pk_bf16_f32 v110, v100, v101
    v_add_f32 v20, v20, v102
    v_mfma_f32_16x16x32_bf16 a[208:211], v[140:143], v[104:107], a[208:211]
    v_add_f32 v21, v21, v103
    v_cvt_pk_bf16_f32 v111, v102, v103
    s_waitcnt vmcnt(16) lgkmcnt(0)
    s_barrier
    v_mfma_f32_16x16x32_bf16 v[96:99], v[56:59], a[96:99], v[52:55]
    ds_read_b128 v[56:59], v8 offset:0
    v_mfma_f32_16x16x32_bf16 v[96:99], v[60:63], a[100:103], v[96:99]
    ds_read_b128 v[60:63], v8 offset:64
    v_exp_f32 v88, v88
    v_mfma_f32_16x16x32_bf16 v[96:99], v[64:67], a[104:107], v[96:99]
    ds_read_b128 v[64:67], v8 offset:128
    v_exp_f32 v89, v89
    v_mfma_f32_16x16x32_bf16 v[96:99], v[68:71], a[108:111], v[96:99]
    ds_read_b128 v[68:71], v8 offset:192
    v_exp_f32 v90, v90
    v_mfma_f32_16x16x32_bf16 v[100:103], v[84:87], a[108:111], v[52:55]
    ds_read_b128 v[84:87], v8 offset:704
    v_exp_f32 v91, v91
    v_mfma_f32_16x16x32_bf16 v[100:103], v[80:83], a[104:107], v[100:103]
    ds_read_b128 v[80:83], v8 offset:640
    v_add_f32 v22, v22, v88
    v_add_f32 v23, v23, v89
    v_mfma_f32_16x16x32_bf16 v[100:103], v[76:79], a[100:103], v[100:103]
    ds_read_b128 v[76:79], v8 offset:576
    v_cvt_pk_bf16_f32 v104, v88, v89
    v_mfma_f32_16x16x32_bf16 v[100:103], v[72:75], a[96:99], v[100:103]
    ds_read_b128 v[72:75], v8 offset:512
    v_exp_f32 v92, v92
    v_mfma_f32_16x16x32_bf16 v[160:163], v[112:115], v[108:111], v[160:163]
    v_exp_f32 v93, v93
    v_mfma_f32_16x16x32_bf16 v[188:191], v[116:119], v[108:111], v[188:191]
    v_add_f32 v22, v22, v90
    v_add_f32 v23, v23, v91
    v_mfma_f32_16x16x32_bf16 v[216:219], v[120:123], v[108:111], v[216:219]
    v_cvt_pk_bf16_f32 v105, v90, v91
    v_mfma_f32_16x16x32_bf16 v[244:247], v[124:127], v[108:111], v[244:247]
    v_exp_f32 v94, v94
    v_mfma_f32_16x16x32_bf16 a[128:131], v[128:131], v[108:111], a[128:131]
    v_exp_f32 v95, v95
    v_mfma_f32_16x16x32_bf16 a[156:159], v[132:135], v[108:111], a[156:159]
    v_add_f32 v22, v22, v92
    v_add_f32 v23, v23, v93
    v_mfma_f32_16x16x32_bf16 a[184:187], v[136:139], v[108:111], a[184:187]
    v_cvt_pk_bf16_f32 v106, v92, v93
    v_add_f32 v22, v22, v94
    v_mfma_f32_16x16x32_bf16 a[212:215], v[140:143], v[108:111], a[212:215]
    v_add_f32 v23, v23, v95
    v_cvt_pk_bf16_f32 v107, v94, v95
    s_waitcnt lgkmcnt(0)
    v_mfma_f32_16x16x32_bf16 v[88:91], v[56:59], a[0:3], v[28:31]
    v_mfma_f32_16x16x32_bf16 v[88:91], v[60:63], a[4:7], v[88:91]
    v_exp_f32 v96, v96
    v_mfma_f32_16x16x32_bf16 v[88:91], v[64:67], a[8:11], v[88:91]
    v_exp_f32 v97, v97
    v_mfma_f32_16x16x32_bf16 v[88:91], v[68:71], a[12:15], v[88:91]
    v_exp_f32 v98, v98
    v_mfma_f32_16x16x32_bf16 v[92:95], v[84:87], a[12:15], v[28:31]
    v_exp_f32 v99, v99
    v_mfma_f32_16x16x32_bf16 v[92:95], v[80:83], a[8:11], v[92:95]
    v_add_f32 v24, v24, v96
    v_add_f32 v25, v25, v97
    v_mfma_f32_16x16x32_bf16 v[92:95], v[76:79], a[4:7], v[92:95]
    v_cvt_pk_bf16_f32 v108, v96, v97
    v_mfma_f32_16x16x32_bf16 v[92:95], v[72:75], a[0:3], v[92:95]
    v_exp_f32 v100, v100
    v_mfma_f32_16x16x32_bf16 v[164:167], v[112:115], v[104:107], v[164:167]
    v_exp_f32 v101, v101
    v_mfma_f32_16x16x32_bf16 v[192:195], v[116:119], v[104:107], v[192:195]
    v_add_f32 v24, v24, v98
    v_add_f32 v25, v25, v99
    v_mfma_f32_16x16x32_bf16 v[220:223], v[120:123], v[104:107], v[220:223]
    v_cvt_pk_bf16_f32 v109, v98, v99
    v_mfma_f32_16x16x32_bf16 v[248:251], v[124:127], v[104:107], v[248:251]
    v_exp_f32 v102, v102
    v_mfma_f32_16x16x32_bf16 a[132:135], v[128:131], v[104:107], a[132:135]
    v_exp_f32 v103, v103
    v_mfma_f32_16x16x32_bf16 a[160:163], v[132:135], v[104:107], a[160:163]
    v_add_f32 v24, v24, v100
    v_add_f32 v25, v25, v101
    v_mfma_f32_16x16x32_bf16 a[188:191], v[136:139], v[104:107], a[188:191]
    v_cvt_pk_bf16_f32 v110, v100, v101
    v_add_f32 v24, v24, v102
    v_mfma_f32_16x16x32_bf16 a[216:219], v[140:143], v[104:107], a[216:219]
    v_add_f32 v25, v25, v103
    v_cvt_pk_bf16_f32 v111, v102, v103
    v_mfma_f32_16x16x32_bf16 v[96:99], v[56:59], a[16:19], v[32:35]
    v_mfma_f32_16x16x32_bf16 v[96:99], v[60:63], a[20:23], v[96:99]
    v_exp_f32 v88, v88
    v_mfma_f32_16x16x32_bf16 v[96:99], v[64:67], a[24:27], v[96:99]
    v_exp_f32 v89, v89
    v_mfma_f32_16x16x32_bf16 v[96:99], v[68:71], a[28:31], v[96:99]
    v_exp_f32 v90, v90
    v_mfma_f32_16x16x32_bf16 v[100:103], v[84:87], a[28:31], v[32:35]
    v_exp_f32 v91, v91
    v_mfma_f32_16x16x32_bf16 v[100:103], v[80:83], a[24:27], v[100:103]
    v_add_f32 v12, v12, v88
    v_add_f32 v13, v13, v89
    v_mfma_f32_16x16x32_bf16 v[100:103], v[76:79], a[20:23], v[100:103]
    v_cvt_pk_bf16_f32 v104, v88, v89
    v_mfma_f32_16x16x32_bf16 v[100:103], v[72:75], a[16:19], v[100:103]
    v_exp_f32 v92, v92
    v_mfma_f32_16x16x32_bf16 v[168:171], v[112:115], v[108:111], v[168:171]
    ds_read_b64_tr_b16 v[112:113], v9 offset:0
    ds_read_b64_tr_b16 v[114:115], v9 offset:512
    v_exp_f32 v93, v93
    v_mfma_f32_16x16x32_bf16 v[196:199], v[116:119], v[108:111], v[196:199]
    ds_read_b64_tr_b16 v[116:117], v9 offset:32
    ds_read_b64_tr_b16 v[118:119], v9 offset:544
    v_add_f32 v12, v12, v90
    v_add_f32 v13, v13, v91
    v_mfma_f32_16x16x32_bf16 v[224:227], v[120:123], v[108:111], v[224:227]
    ds_read_b64_tr_b16 v[120:121], v9 offset:64
    ds_read_b64_tr_b16 v[122:123], v9 offset:576
    v_cvt_pk_bf16_f32 v105, v90, v91
    v_mfma_f32_16x16x32_bf16 v[252:255], v[124:127], v[108:111], v[252:255]
    ds_read_b64_tr_b16 v[124:125], v9 offset:96
    ds_read_b64_tr_b16 v[126:127], v9 offset:608
    v_exp_f32 v94, v94
    v_mfma_f32_16x16x32_bf16 a[136:139], v[128:131], v[108:111], a[136:139]
    ds_read_b64_tr_b16 v[128:129], v9 offset:128
    ds_read_b64_tr_b16 v[130:131], v9 offset:640
    v_exp_f32 v95, v95
    v_mfma_f32_16x16x32_bf16 a[164:167], v[132:135], v[108:111], a[164:167]
    ds_read_b64_tr_b16 v[132:133], v9 offset:160
    ds_read_b64_tr_b16 v[134:135], v9 offset:672
    v_add_f32 v12, v12, v92
    v_add_f32 v13, v13, v93
    v_mfma_f32_16x16x32_bf16 a[192:195], v[136:139], v[108:111], a[192:195]
    ds_read_b64_tr_b16 v[136:137], v9 offset:192
    ds_read_b64_tr_b16 v[138:139], v9 offset:704
    v_cvt_pk_bf16_f32 v106, v92, v93
    v_add_f32 v12, v12, v94
    v_mfma_f32_16x16x32_bf16 a[220:223], v[140:143], v[108:111], a[220:223]
    ds_read_b64_tr_b16 v[140:141], v9 offset:224
    ds_read_b64_tr_b16 v[142:143], v9 offset:736
    v_add_f32 v13, v13, v95
    v_cvt_pk_bf16_f32 v107, v94, v95
    v_mfma_f32_16x16x32_bf16 v[88:91], v[56:59], a[32:35], v[36:39]
    v_mfma_f32_16x16x32_bf16 v[88:91], v[60:63], a[36:39], v[88:91]
    s_add_u32 s29, s34, s100
    v_exp_f32 v96, v96
    v_mfma_f32_16x16x32_bf16 v[88:91], v[64:67], a[40:43], v[88:91]
    v_exp_f32 v97, v97
    v_mfma_f32_16x16x32_bf16 v[88:91], v[68:71], a[44:47], v[88:91]
    s_bfe_u32 s28, s29, 0x20003
    v_exp_f32 v98, v98
    v_mfma_f32_16x16x32_bf16 v[92:95], v[84:87], a[44:47], v[36:39]
    v_exp_f32 v99, v99
    v_mfma_f32_16x16x32_bf16 v[92:95], v[80:83], a[40:43], v[92:95]
    s_lshl_b32 s28, s28, 16
    v_add_f32 v14, v14, v96
    v_add_f32 v15, v15, v97
    v_mfma_f32_16x16x32_bf16 v[92:95], v[76:79], a[36:39], v[92:95]
    v_cvt_pk_bf16_f32 v108, v96, v97
    v_mfma_f32_16x16x32_bf16 v[92:95], v[72:75], a[32:35], v[92:95]
    v_exp_f32 v100, v100
    s_waitcnt lgkmcnt(0)
    v_mfma_f32_16x16x32_bf16 v[144:147], v[112:115], v[104:107], v[144:147]
    s_and_b32 s29, s29, 7
    v_exp_f32 v101, v101
    v_mfma_f32_16x16x32_bf16 v[172:175], v[116:119], v[104:107], v[172:175]
    v_add_f32 v14, v14, v98
    v_add_f32 v15, v15, v99
    v_mfma_f32_16x16x32_bf16 v[200:203], v[120:123], v[104:107], v[200:203]
    s_lshl_b32 s29, s29, 11
    v_cvt_pk_bf16_f32 v109, v98, v99
    v_mfma_f32_16x16x32_bf16 v[228:231], v[124:127], v[104:107], v[228:231]
    v_exp_f32 v102, v102
    v_mfma_f32_16x16x32_bf16 a[112:115], v[128:131], v[104:107], a[112:115]
    s_add_u32 s29, s28, s29
    v_exp_f32 v103, v103
    v_mfma_f32_16x16x32_bf16 a[140:143], v[132:135], v[104:107], a[140:143]
    v_add_f32 v14, v14, v100
    v_add_f32 v15, v15, v101
    v_mfma_f32_16x16x32_bf16 a[168:171], v[136:139], v[104:107], a[168:171]
    s_lshr_b32 s28, s34, 5
    v_cvt_pk_bf16_f32 v110, v100, v101
    v_add_f32 v14, v14, v102
    v_mfma_f32_16x16x32_bf16 a[196:199], v[140:143], v[104:107], a[196:199]
    v_add_f32 v15, v15, v103
    v_cvt_pk_bf16_f32 v111, v102, v103
    v_mfma_f32_16x16x32_bf16 v[96:99], v[56:59], a[48:51], v[40:43]
    v_mfma_f32_16x16x32_bf16 v[96:99], v[60:63], a[52:55], v[96:99]
    s_lshl_b32 s28, s28, 19
    v_exp_f32 v88, v88
    v_mfma_f32_16x16x32_bf16 v[96:99], v[64:67], a[56:59], v[96:99]
    v_exp_f32 v89, v89
    v_mfma_f32_16x16x32_bf16 v[96:99], v[68:71], a[60:63], v[96:99]
    s_add_u32 s49, s28, s29
    v_exp_f32 v90, v90
    v_mfma_f32_16x16x32_bf16 v[100:103], v[84:87], a[60:63], v[40:43]
    v_exp_f32 v91, v91
    v_mfma_f32_16x16x32_bf16 v[100:103], v[80:83], a[56:59], v[100:103]
    s_add_u32 m0, s33, 25344
    v_add_f32 v16, v16, v88
    v_add_f32 v17, v17, v89
    v_mfma_f32_16x16x32_bf16 v[100:103], v[76:79], a[52:55], v[100:103]
    v_cvt_pk_bf16_f32 v104, v88, v89
    v_mfma_f32_16x16x32_bf16 v[100:103], v[72:75], a[48:51], v[100:103]
    v_exp_f32 v92, v92
    v_mfma_f32_16x16x32_bf16 v[148:151], v[112:115], v[108:111], v[148:151]
    s_add_u32 s34, s34, 1
    v_exp_f32 v93, v93
    v_mfma_f32_16x16x32_bf16 v[176:179], v[116:119], v[108:111], v[176:179]
    v_add_f32 v16, v16, v90
    v_add_f32 v17, v17, v91
    v_mfma_f32_16x16x32_bf16 v[204:207], v[120:123], v[108:111], v[204:207]
    buffer_load_dwordx4 v7, s[4:7], s49 offen offset:0 nt lds
    v_cvt_pk_bf16_f32 v105, v90, v91
    v_mfma_f32_16x16x32_bf16 v[232:235], v[124:127], v[108:111], v[232:235]
    v_exp_f32 v94, v94
    v_mfma_f32_16x16x32_bf16 a[116:119], v[128:131], v[108:111], a[116:119]
    s_add_u32 m0, m0, s96
    v_exp_f32 v95, v95
    v_mfma_f32_16x16x32_bf16 a[144:147], v[132:135], v[108:111], a[144:147]
    v_add_f32 v16, v16, v92
    v_add_f32 v17, v17, v93
    v_mfma_f32_16x16x32_bf16 a[172:175], v[136:139], v[108:111], a[172:175]
    buffer_load_dwordx4 v7, s[4:7], s49 offen offset:256 nt lds
    v_cvt_pk_bf16_f32 v106, v92, v93
    v_add_f32 v16, v16, v94
    v_mfma_f32_16x16x32_bf16 a[200:203], v[140:143], v[108:111], a[200:203]
    v_add_f32 v17, v17, v95
    v_cvt_pk_bf16_f32 v107, v94, v95
    v_mfma_f32_16x16x32_bf16 v[88:91], v[56:59], a[64:67], v[44:47]
    v_mfma_f32_16x16x32_bf16 v[88:91], v[60:63], a[68:71], v[88:91]
    s_add_u32 m0, m0, s97
    v_exp_f32 v96, v96
    v_mfma_f32_16x16x32_bf16 v[88:91], v[64:67], a[72:75], v[88:91]
    v_exp_f32 v97, v97
    v_mfma_f32_16x16x32_bf16 v[88:91], v[68:71], a[76:79], v[88:91]
    buffer_load_dwordx4 v7, s[4:7], s49 offen offset:512 nt lds
    v_exp_f32 v98, v98
    v_mfma_f32_16x16x32_bf16 v[92:95], v[84:87], a[76:79], v[44:47]
    v_exp_f32 v99, v99
    v_mfma_f32_16x16x32_bf16 v[92:95], v[80:83], a[72:75], v[92:95]
    s_add_u32 m0, m0, s96
    v_add_f32 v18, v18, v96
    v_add_f32 v19, v19, v97
    v_mfma_f32_16x16x32_bf16 v[92:95], v[76:79], a[68:71], v[92:95]
    v_cvt_pk_bf16_f32 v108, v96, v97
    v_mfma_f32_16x16x32_bf16 v[92:95], v[72:75], a[64:67], v[92:95]
    v_exp_f32 v100, v100
    v_mfma_f32_16x16x32_bf16 v[152:155], v[112:115], v[104:107], v[152:155]
    buffer_load_dwordx4 v7, s[4:7], s49 offen offset:768 nt lds
    v_exp_f32 v101, v101
    v_mfma_f32_16x16x32_bf16 v[180:183], v[116:119], v[104:107], v[180:183]
    v_add_f32 v18, v18, v98
    v_add_f32 v19, v19, v99
    v_mfma_f32_16x16x32_bf16 v[208:211], v[120:123], v[104:107], v[208:211]
    s_add_u32 m0, m0, s97
    v_cvt_pk_bf16_f32 v109, v98, v99
    v_mfma_f32_16x16x32_bf16 v[236:239], v[124:127], v[104:107], v[236:239]
    v_exp_f32 v102, v102
    v_mfma_f32_16x16x32_bf16 a[120:123], v[128:131], v[104:107], a[120:123]
    buffer_load_dwordx4 v7, s[4:7], s49 offen offset:1024 nt lds
    v_exp_f32 v103, v103
    v_mfma_f32_16x16x32_bf16 a[148:151], v[132:135], v[104:107], a[148:151]
    v_add_f32 v18, v18, v100
    v_add_f32 v19, v19, v101
    v_mfma_f32_16x16x32_bf16 a[176:179], v[136:139], v[104:107], a[176:179]
    s_add_u32 m0, m0, s96
    v_cvt_pk_bf16_f32 v110, v100, v101
    v_add_f32 v18, v18, v102
    v_mfma_f32_16x16x32_bf16 a[204:207], v[140:143], v[104:107], a[204:207]
    v_add_f32 v19, v19, v103
    v_cvt_pk_bf16_f32 v111, v102, v103
    v_mfma_f32_16x16x32_bf16 v[96:99], v[56:59], a[80:83], v[48:51]
    v_mfma_f32_16x16x32_bf16 v[96:99], v[60:63], a[84:87], v[96:99]
    buffer_load_dwordx4 v7, s[4:7], s49 offen offset:1280 nt lds
    v_exp_f32 v88, v88
    v_mfma_f32_16x16x32_bf16 v[96:99], v[64:67], a[88:91], v[96:99]
    v_exp_f32 v89, v89
    v_mfma_f32_16x16x32_bf16 v[96:99], v[68:71], a[92:95], v[96:99]
    s_add_u32 m0, m0, s97
    v_exp_f32 v90, v90
    v_mfma_f32_16x16x32_bf16 v[100:103], v[84:87], a[92:95], v[48:51]
    v_exp_f32 v91, v91
    v_mfma_f32_16x16x32_bf16 v[100:103], v[80:83], a[88:91], v[100:103]
    buffer_load_dwordx4 v7, s[4:7], s49 offen offset:1536 nt lds
    v_add_f32 v20, v20, v88
    v_add_f32 v21, v21, v89
    v_mfma_f32_16x16x32_bf16 v[100:103], v[76:79], a[84:87], v[100:103]
    v_cvt_pk_bf16_f32 v104, v88, v89
    v_mfma_f32_16x16x32_bf16 v[100:103], v[72:75], a[80:83], v[100:103]
    v_exp_f32 v92, v92
    v_mfma_f32_16x16x32_bf16 v[156:159], v[112:115], v[108:111], v[156:159]
    s_add_u32 m0, m0, s96
    v_exp_f32 v93, v93
    v_mfma_f32_16x16x32_bf16 v[184:187], v[116:119], v[108:111], v[184:187]
    v_add_f32 v20, v20, v90
    v_add_f32 v21, v21, v91
    v_mfma_f32_16x16x32_bf16 v[212:215], v[120:123], v[108:111], v[212:215]
    buffer_load_dwordx4 v7, s[4:7], s49 offen offset:1792 nt lds
    v_cvt_pk_bf16_f32 v105, v90, v91
    v_mfma_f32_16x16x32_bf16 v[240:243], v[124:127], v[108:111], v[240:243]
    v_exp_f32 v94, v94
    v_mfma_f32_16x16x32_bf16 a[124:127], v[128:131], v[108:111], a[124:127]
    v_exp_f32 v95, v95
    v_mfma_f32_16x16x32_bf16 a[152:155], v[132:135], v[108:111], a[152:155]
    v_add_f32 v20, v20, v92
    v_add_f32 v21, v21, v93
    v_mfma_f32_16x16x32_bf16 a[180:183], v[136:139], v[108:111], a[180:183]
    v_cvt_pk_bf16_f32 v106, v92, v93
    v_add_f32 v20, v20, v94
    v_mfma_f32_16x16x32_bf16 a[208:211], v[140:143], v[108:111], a[208:211]
    v_add_f32 v21, v21, v95
    v_cvt_pk_bf16_f32 v107, v94, v95
    s_waitcnt vmcnt(16) lgkmcnt(0)
    s_barrier
    v_mfma_f32_16x16x32_bf16 v[88:91], v[56:59], a[96:99], v[52:55]
    ds_read_b128 v[56:59], v8 offset:8448
    v_mfma_f32_16x16x32_bf16 v[88:91], v[60:63], a[100:103], v[88:91]
    ds_read_b128 v[60:63], v8 offset:8512
    v_exp_f32 v96, v96
    v_mfma_f32_16x16x32_bf16 v[88:91], v[64:67], a[104:107], v[88:91]
    ds_read_b128 v[64:67], v8 offset:8576
    v_exp_f32 v97, v97
    v_mfma_f32_16x16x32_bf16 v[88:91], v[68:71], a[108:111], v[88:91]
    ds_read_b128 v[68:71], v8 offset:8640
    v_exp_f32 v98, v98
    v_mfma_f32_16x16x32_bf16 v[92:95], v[84:87], a[108:111], v[52:55]
    ds_read_b128 v[84:87], v8 offset:9152
    v_exp_f32 v99, v99
    v_mfma_f32_16x16x32_bf16 v[92:95], v[80:83], a[104:107], v[92:95]
    ds_read_b128 v[80:83], v8 offset:9088
    v_add_f32 v22, v22, v96
    v_add_f32 v23, v23, v97
    v_mfma_f32_16x16x32_bf16 v[92:95], v[76:79], a[100:103], v[92:95]
    ds_read_b128 v[76:79], v8 offset:9024
    v_cvt_pk_bf16_f32 v108, v96, v97
    v_mfma_f32_16x16x32_bf16 v[92:95], v[72:75], a[96:99], v[92:95]
    ds_read_b128 v[72:75], v8 offset:8960
    v_exp_f32 v100, v100
    v_mfma_f32_16x16x32_bf16 v[160:163], v[112:115], v[104:107], v[160:163]
    v_exp_f32 v101, v101
    v_mfma_f32_16x16x32_bf16 v[188:191], v[116:119], v[104:107], v[188:191]
    v_add_f32 v22, v22, v98
    v_add_f32 v23, v23, v99
    v_mfma_f32_16x16x32_bf16 v[216:219], v[120:123], v[104:107], v[216:219]
    v_cvt_pk_bf16_f32 v109, v98, v99
    v_mfma_f32_16x16x32_bf16 v[244:247], v[124:127], v[104:107], v[244:247]
    v_exp_f32 v102, v102
    v_mfma_f32_16x16x32_bf16 a[128:131], v[128:131], v[104:107], a[128:131]
    v_exp_f32 v103, v103
    v_mfma_f32_16x16x32_bf16 a[156:159], v[132:135], v[104:107], a[156:159]
    v_add_f32 v22, v22, v100
    v_add_f32 v23, v23, v101
    v_mfma_f32_16x16x32_bf16 a[184:187], v[136:139], v[104:107], a[184:187]
    v_cvt_pk_bf16_f32 v110, v100, v101
    v_add_f32 v22, v22, v102
    v_mfma_f32_16x16x32_bf16 a[212:215], v[140:143], v[104:107], a[212:215]
    v_add_f32 v23, v23, v103
    v_cvt_pk_bf16_f32 v111, v102, v103
    s_waitcnt lgkmcnt(0)
    v_mfma_f32_16x16x32_bf16 v[96:99], v[56:59], a[0:3], v[28:31]
    v_mfma_f32_16x16x32_bf16 v[96:99], v[60:63], a[4:7], v[96:99]
    v_exp_f32 v88, v88
    v_mfma_f32_16x16x32_bf16 v[96:99], v[64:67], a[8:11], v[96:99]
    v_exp_f32 v89, v89
    v_mfma_f32_16x16x32_bf16 v[96:99], v[68:71], a[12:15], v[96:99]
    v_exp_f32 v90, v90
    v_mfma_f32_16x16x32_bf16 v[100:103], v[84:87], a[12:15], v[28:31]
    v_exp_f32 v91, v91
    v_mfma_f32_16x16x32_bf16 v[100:103], v[80:83], a[8:11], v[100:103]
    v_add_f32 v24, v24, v88
    v_add_f32 v25, v25, v89
    v_mfma_f32_16x16x32_bf16 v[100:103], v[76:79], a[4:7], v[100:103]
    v_cvt_pk_bf16_f32 v104, v88, v89
    v_mfma_f32_16x16x32_bf16 v[100:103], v[72:75], a[0:3], v[100:103]
    v_exp_f32 v92, v92
    v_mfma_f32_16x16x32_bf16 v[164:167], v[112:115], v[108:111], v[164:167]
    v_exp_f32 v93, v93
    v_mfma_f32_16x16x32_bf16 v[192:195], v[116:119], v[108:111], v[192:195]
    v_add_f32 v24, v24, v90
    v_add_f32 v25, v25, v91
    v_mfma_f32_16x16x32_bf16 v[220:223], v[120:123], v[108:111], v[220:223]
    v_cvt_pk_bf16_f32 v105, v90, v91
    v_mfma_f32_16x16x32_bf16 v[248:251], v[124:127], v[108:111], v[248:251]
    v_exp_f32 v94, v94
    v_mfma_f32_16x16x32_bf16 a[132:135], v[128:131], v[108:111], a[132:135]
    v_exp_f32 v95, v95
    v_mfma_f32_16x16x32_bf16 a[160:163], v[132:135], v[108:111], a[160:163]
    v_add_f32 v24, v24, v92
    v_add_f32 v25, v25, v93
    v_mfma_f32_16x16x32_bf16 a[188:191], v[136:139], v[108:111], a[188:191]
    v_cvt_pk_bf16_f32 v106, v92, v93
    v_add_f32 v24, v24, v94
    v_mfma_f32_16x16x32_bf16 a[216:219], v[140:143], v[108:111], a[216:219]
    v_add_f32 v25, v25, v95
    v_cvt_pk_bf16_f32 v107, v94, v95
    s_add_u32 s22, s22, 1
    s_cmp_lt_u32 s22, 7
    s_cbranch_scc1 L_at_loop
    s_add_u32 s21, s21, 1
    s_mul_i32 s50, s21, s52
    s_mov_b32 s101, s21
    s_add_u32 s50, s50, s55
    s_cmp_ge_u32 s21, 2
    s_cselect_b32 s28, 0x40000000, 0
    s_add_u32 s50, s50, s28
    s_mov_b32 s82, s26
    s_mul_i32 s28, s26, s51
    s_add_u32 s50, s50, s28
    s_cmp_eq_u32 s21, 2
    s_cbranch_scc1 L_at_wt0
L_at_wt0r:
    s_cmp_lg_u32 s69, 0
    s_cbranch_scc1 L_at_atailB
    v_mfma_f32_16x16x32_bf16 v[88:91], v[56:59], a[16:19], v[32:35]
    v_mfma_f32_16x16x32_bf16 v[88:91], v[60:63], a[20:23], v[88:91]
    v_exp_f32 v96, v96
    v_mfma_f32_16x16x32_bf16 v[88:91], v[64:67], a[24:27], v[88:91]
    v_exp_f32 v97, v97
    v_mfma_f32_16x16x32_bf16 v[88:91], v[68:71], a[28:31], v[88:91]
    v_exp_f32 v98, v98
    v_mfma_f32_16x16x32_bf16 v[92:95], v[84:87], a[28:31], v[32:35]
    v_exp_f32 v99, v99
    v_mfma_f32_16x16x32_bf16 v[92:95], v[80:83], a[24:27], v[92:95]
    v_add_f32 v12, v12, v96
    v_add_f32 v13, v13, v97
    v_mfma_f32_16x16x32_bf16 v[92:95], v[76:79], a[20:23], v[92:95]
    v_cvt_pk_bf16_f32 v108, v96, v97
    v_mfma_f32_16x16x32_bf16 v[92:95], v[72:75], a[16:19], v[92:95]
    v_exp_f32 v100, v100
    v_mfma_f32_16x16x32_bf16 v[168:171], v[112:115], v[104:107], v[168:171]
    ds_read_b64_tr_b16 v[112:113], v9 offset:8448
    ds_read_b64_tr_b16 v[114:115], v9 offset:8960
    v_exp_f32 v101, v101
    v_mfma_f32_16x16x32_bf16 v[196:199], v[116:119], v[104:107], v[196:199]
    ds_read_b64_tr_b16 v[116:117], v9 offset:8480
    ds_read_b64_tr_b16 v[118:119], v9 offset:8992
    v_add_f32 v12, v12, v98
    v_add_f32 v13, v13, v99
    v_mfma_f32_16x16x32_bf16 v[224:227], v[120:123], v[104:107], v[224:227]
    ds_read_b64_tr_b16 v[120:121], v9 offset:8512
    ds_read_b64_tr_b16 v[122:123], v9 offset:9024
    v_cvt_pk_bf16_f32 v109, v98, v99
    v_mfma_f32_16x16x32_bf16 v[252:255], v[124:127], v[104:107], v[252:255]
    ds_read_b64_tr_b16 v[124:125], v9 offset:8544
    ds_read_b64_tr_b16 v[126:127], v9 offset:9056
    v_exp_f32 v102, v102
    v_mfma_f32_16x16x32_bf16 a[136:139], v[128:131], v[104:107], a[136:139]
    ds_read_b64_tr_b16 v[128:129], v9 offset:8576
    ds_read_b64_tr_b16 v[130:131], v9 offset:9088
    v_exp_f32 v103, v103
    v_mfma_f32_16x16x32_bf16 a[164:167], v[132:135], v[104:107], a[164:167]
    ds_read_b64_tr_b16 v[132:133], v9 offset:8608
    ds_read_b64_tr_b16 v[134:135], v9 offset:9120
    v_add_f32 v12, v12, v100
    v_add_f32 v13, v13, v101
    v_mfma_f32_16x16x32_bf16 a[192:195], v[136:139], v[104:107], a[192:195]
    ds_read_b64_tr_b16 v[136:137], v9 offset:8640
    ds_read_b64_tr_b16 v[138:139], v9 offset:9152
    v_cvt_pk_bf16_f32 v110, v100, v101
    v_add_f32 v12, v12, v102
    v_mfma_f32_16x16x32_bf16 a[220:223], v[140:143], v[104:107], a[220:223]
    ds_read_b64_tr_b16 v[140:141], v9 offset:8672
    ds_read_b64_tr_b16 v[142:143], v9 offset:9184
    v_add_f32 v13, v13, v103
    v_cvt_pk_bf16_f32 v111, v102, v103
    v_mfma_f32_16x16x32_bf16 v[96:99], v[56:59], a[32:35], v[36:39]
    v_mfma_f32_16x16x32_bf16 v[96:99], v[60:63], a[36:39], v[96:99]
    s_add_u32 m0, s33, 0
    v_exp_f32 v88, v88
    v_mfma_f32_16x16x32_bf16 v[96:99], v[64:67], a[40:43], v[96:99]
    v_exp_f32 v89, v89
    v_mfma_f32_16x16x32_bf16 v[96:99], v[68:71], a[44:47], v[96:99]
    s_mov_b32 s49, s50
    v_exp_f32 v90, v90
    v_mfma_f32_16x16x32_bf16 v[100:103], v[84:87], a[44:47], v[36:39]
    v_exp_f32 v91, v91
    v_mfma_f32_16x16x32_bf16 v[100:103], v[80:83], a[40:43], v[100:103]
    s_add_u32 s28, s49, s88
    v_add_f32 v14, v14, v88
    v_add_f32 v15, v15, v89
    v_mfma_f32_16x16x32_bf16 v[100:103], v[76:79], a[36:39], v[100:103]
    v_cvt_pk_bf16_f32 v104, v88, v89
    v_mfma_f32_16x16x32_bf16 v[100:103], v[72:75], a[32:35], v[100:103]
    v_exp_f32 v92, v92
    s_waitcnt lgkmcnt(0)
    v_mfma_f32_16x16x32_bf16 v[144:147], v[112:115], v[108:111], v[144:147]
    buffer_load_dwordx4 v26, s[16:19], s28 offen lds
    v_exp_f32 v93, v93
    v_mfma_f32_16x16x32_bf16 v[172:175], v[116:119], v[108:111], v[172:175]
    v_add_f32 v14, v14, v90
    v_add_f32 v15, v15, v91
    v_mfma_f32_16x16x32_bf16 v[200:203], v[120:123], v[108:111], v[200:203]
    s_add_u32 m0, m0, s53
    v_cvt_pk_bf16_f32 v105, v90, v91
    v_mfma_f32_16x16x32_bf16 v[228:231], v[124:127], v[108:111], v[228:231]
    v_exp_f32 v94, v94
    v_mfma_f32_16x16x32_bf16 a[112:115], v[128:131], v[108:111], a[112:115]
    s_add_u32 s28, s49, s89
    v_exp_f32 v95, v95
    v_mfma_f32_16x16x32_bf16 a[140:143], v[132:135], v[108:111], a[140:143]
    v_add_f32 v14, v14, v92
    v_add_f32 v15, v15, v93
    v_mfma_f32_16x16x32_bf16 a[168:171], v[136:139], v[108:111], a[168:171]
    buffer_load_dwordx4 v26, s[16:19], s28 offen lds
    v_cvt_pk_bf16_f32 v106, v92, v93
    v_add_f32 v14, v14, v94
    v_mfma_f32_16x16x32_bf16 a[196:199], v[140:143], v[108:111], a[196:199]
    v_add_f32 v15, v15, v95
    v_cvt_pk_bf16_f32 v107, v94, v95
    v_mfma_f32_16x16x32_bf16 v[88:91], v[56:59], a[48:51], v[40:43]
    v_mfma_f32_16x16x32_bf16 v[88:91], v[60:63], a[52:55], v[88:91]
    s_add_u32 m0, m0, s53
    v_exp_f32 v96, v96
    v_mfma_f32_16x16x32_bf16 v[88:91], v[64:67], a[56:59], v[88:91]
    v_exp_f32 v97, v97
    v_mfma_f32_16x16x32_bf16 v[88:91], v[68:71], a[60:63], v[88:91]
    s_add_u32 s28, s49, s90
    v_exp_f32 v98, v98
    v_mfma_f32_16x16x32_bf16 v[92:95], v[84:87], a[60:63], v[40:43]
    v_exp_f32 v99, v99
    v_mfma_f32_16x16x32_bf16 v[92:95], v[80:83], a[56:59], v[92:95]
    buffer_load_dwordx4 v26, s[16:19], s28 offen lds
    v_add_f32 v16, v16, v96
    v_add_f32 v17, v17, v97
    v_mfma_f32_16x16x32_bf16 v[92:95], v[76:79], a[52:55], v[92:95]
    v_cvt_pk_bf16_f32 v108, v96, v97
    v_mfma_f32_16x16x32_bf16 v[92:95], v[72:75], a[48:51], v[92:95]
    v_exp_f32 v100, v100
    v_mfma_f32_16x16x32_bf16 v[148:151], v[112:115], v[104:107], v[148:151]
    s_add_u32 m0, m0, s53
    v_exp_f32 v101, v101
    v_mfma_f32_16x16x32_bf16 v[176:179], v[116:119], v[104:107], v[176:179]
    v_add_f32 v16, v16, v98
    v_add_f32 v17, v17, v99
    v_mfma_f32_16x16x32_bf16 v[204:207], v[120:123], v[104:107], v[204:207]
    s_add_u32 s28, s49, s91
    v_cvt_pk_bf16_f32 v109, v98, v99
    v_mfma_f32_16x16x32_bf16 v[232:235], v[124:127], v[104:107], v[232:235]
    v_exp_f32 v102, v102
    v_mfma_f32_16x16x32_bf16 a[116:119], v[128:131], v[104:107], a[116:119]
    buffer_load_dwordx4 v26, s[16:19], s28 offen lds
    v_exp_f32 v103, v103
    v_mfma_f32_16x16x32_bf16 a[144:147], v[132:135], v[104:107], a[144:147]
    v_add_f32 v16, v16, v100
    v_add_f32 v17, v17, v101
    v_mfma_f32_16x16x32_bf16 a[172:175], v[136:139], v[104:107], a[172:175]
    s_add_u32 m0, m0, s53
    v_cvt_pk_bf16_f32 v110, v100, v101
    v_add_f32 v16, v16, v102
    v_mfma_f32_16x16x32_bf16 a[200:203], v[140:143], v[104:107], a[200:203]
    v_add_f32 v17, v17, v103
    v_cvt_pk_bf16_f32 v111, v102, v103
    v_mfma_f32_16x16x32_bf16 v[96:99], v[56:59], a[64:67], v[44:47]
    v_mfma_f32_16x16x32_bf16 v[96:99], v[60:63], a[68:71], v[96:99]
    s_add_u32 s28, s49, s92
    v_exp_f32 v88, v88
    v_mfma_f32_16x16x32_bf16 v[96:99], v[64:67], a[72:75], v[96:99]
    v_exp_f32 v89, v89
    v_mfma_f32_16x16x32_bf16 v[96:99], v[68:71], a[76:79], v[96:99]
    buffer_load_dwordx4 v26, s[16:19], s28 offen lds
    v_exp_f32 v90, v90
    v_mfma_f32_16x16x32_bf16 v[100:103], v[84:87], a[76:79], v[44:47]
    v_exp_f32 v91, v91
    v_mfma_f32_16x16x32_bf16 v[100:103], v[80:83], a[72:75], v[100:103]
    s_add_u32 m0, m0, s53
    v_add_f32 v18, v18, v88
    v_add_f32 v19, v19, v89
    v_mfma_f32_16x16x32_bf16 v[100:103], v[76:79], a[68:71], v[100:103]
    v_cvt_pk_bf16_f32 v104, v88, v89
    v_mfma_f32_16x16x32_bf16 v[100:103], v[72:75], a[64:67], v[100:103]
    v_exp_f32 v92, v92
    v_mfma_f32_16x16x32_bf16 v[152:155], v[112:115], v[108:111], v[152:155]
    s_add_u32 s28, s49, s93
    v_exp_f32 v93, v93
    v_mfma_f32_16x16x32_bf16 v[180:183], v[116:119], v[108:111], v[180:183]
    v_add_f32 v18, v18, v90
    v_add_f32 v19, v19, v91
    v_mfma_f32_16x16x32_bf16 v[208:211], v[120:123], v[108:111], v[208:211]
    buffer_load_dwordx4 v26, s[16:19], s28 offen lds
    v_cvt_pk_bf16_f32 v105, v90, v91
    v_mfma_f32_16x16x32_bf16 v[236:239], v[124:127], v[108:111], v[236:239]
    v_exp_f32 v94, v94
    v_mfma_f32_16x16x32_bf16 a[120:123], v[128:131], v[108:111], a[120:123]
    s_add_u32 m0, m0, s53
    v_exp_f32 v95, v95
    v_mfma_f32_16x16x32_bf16 a[148:151], v[132:135], v[108:111], a[148:151]
    v_add_f32 v18, v18, v92
    v_add_f32 v19, v19, v93
    v_mfma_f32_16x16x32_bf16 a[176:179], v[136:139], v[108:111], a[176:179]
    s_add_u32 s28, s49, s94
    v_cvt_pk_bf16_f32 v106, v92, v93
    v_add_f32 v18, v18, v94
    v_mfma_f32_16x16x32_bf16 a[204:207], v[140:143], v[108:111], a[204:207]
    v_add_f32 v19, v19, v95
    v_cvt_pk_bf16_f32 v107, v94, v95
    v_mfma_f32_16x16x32_bf16 v[88:91], v[56:59], a[80:83], v[48:51]
    v_mfma_f32_16x16x32_bf16 v[88:91], v[60:63], a[84:87], v[88:91]
    buffer_load_dwordx4 v26, s[16:19], s28 offen lds
    v_exp_f32 v96, v96
    v_mfma_f32_16x16x32_bf16 v[88:91], v[64:67], a[88:91], v[88:91]
    v_exp_f32 v97, v97
    v_mfma_f32_16x16x32_bf16 v[88:91], v[68:71], a[92:95], v[88:91]
    s_add_u32 m0, m0, s53
    v_exp_f32 v98, v98
    v_mfma_f32_16x16x32_bf16 v[92:95], v[84:87], a[92:95], v[48:51]
    v_exp_f32 v99, v99
    v_mfma_f32_16x16x32_bf16 v[92:95], v[80:83], a[88:91], v[92:95]
    s_add_u32 s28, s49, s95
    v_add_f32 v20, v20, v96
    v_add_f32 v21, v21, v97
    v_mfma_f32_16x16x32_bf16 v[92:95], v[76:79], a[84:87], v[92:95]
    v_cvt_pk_bf16_f32 v108, v96, v97
    v_mfma_f32_16x16x32_bf16 v[92:95], v[72:75], a[80:83], v[92:95]
    v_exp_f32 v100, v100
    v_mfma_f32_16x16x32_bf16 v[156:159], v[112:115], v[104:107], v[156:159]
    buffer_load_dwordx4 v26, s[16:19], s28 offen lds
    v_exp_f32 v101, v101
    v_mfma_f32_16x16x32_bf16 v[184:187], v[116:119], v[104:107], v[184:187]
    v_add_f32 v20, v20, v98
    v_add_f32 v21, v21, v99
    v_mfma_f32_16x16x32_bf16 v[212:215], v[120:123], v[104:107], v[212:215]
    v_cvt_pk_bf16_f32 v109, v98, v99
    v_mfma_f32_16x16x32_bf16 v[240:243], v[124:127], v[104:107], v[240:243]
    v_exp_f32 v102, v102
    v_mfma_f32_16x16x32_bf16 a[124:127], v[128:131], v[104:107], a[124:127]
    v_exp_f32 v103, v103
    v_mfma_f32_16x16x32_bf16 a[152:155], v[132:135], v[104:107], a[152:155]
    v_add_f32 v20, v20, v100
    v_add_f32 v21, v21, v101
    v_mfma_f32_16x16x32_bf16 a[180:183], v[136:139], v[104:107], a[180:183]
    v_cvt_pk_bf16_f32 v110, v100, v101
    v_add_f32 v20, v20, v102
    v_mfma_f32_16x16x32_bf16 a[208:211], v[140:143], v[104:107], a[208:211]
    v_add_f32 v21, v21, v103
    v_cvt_pk_bf16_f32 v111, v102, v103
    s_waitcnt vmcnt(16) lgkmcnt(0)
    s_barrier
    v_mfma_f32_16x16x32_bf16 v[96:99], v[56:59], a[96:99], v[52:55]
    ds_read_b128 v[56:59], v8 offset:16896
    v_mfma_f32_16x16x32_bf16 v[96:99], v[60:63], a[100:103], v[96:99]
    ds_read_b128 v[60:63], v8 offset:16960
    v_exp_f32 v88, v88
    v_mfma_f32_16x16x32_bf16 v[96:99], v[64:67], a[104:107], v[96:99]
    ds_read_b128 v[64:67], v8 offset:17024
    v_exp_f32 v89, v89
    v_mfma_f32_16x16x32_bf16 v[96:99], v[68:71], a[108:111], v[96:99]
    ds_read_b128 v[68:71], v8 offset:17088
    v_exp_f32 v90, v90
    v_mfma_f32_16x16x32_bf16 v[100:103], v[84:87], a[108:111], v[52:55]
    ds_read_b128 v[84:87], v8 offset:17600
    v_exp_f32 v91, v91
    v_mfma_f32_16x16x32_bf16 v[100:103], v[80:83], a[104:107], v[100:103]
    ds_read_b128 v[80:83], v8 offset:17536
    v_add_f32 v22, v22, v88
    v_add_f32 v23, v23, v89
    v_mfma_f32_16x16x32_bf16 v[100:103], v[76:79], a[100:103], v[100:103]
    ds_read_b128 v[76:79], v8 offset:17472
    v_cvt_pk_bf16_f32 v104, v88, v89
    v_mfma_f32_16x16x32_bf16 v[100:103], v[72:75], a[96:99], v[100:103]
    ds_read_b128 v[72:75], v8 offset:17408
    v_exp_f32 v92, v92
    v_mfma_f32_16x16x32_bf16 v[160:163], v[112:115], v[108:111], v[160:163]
    v_exp_f32 v93, v93
    v_mfma_f32_16x16x32_bf16 v[188:191], v[116:119], v[108:111], v[188:191]
    v_add_f32 v22, v22, v90
    v_add_f32 v23, v23, v91
    v_mfma_f32_16x16x32_bf16 v[216:219], v[120:123], v[108:111], v[216:219]
    v_cvt_pk_bf16_f32 v105, v90, v91
    v_mfma_f32_16x16x32_bf16 v[244:247], v[124:127], v[108:111], v[244:247]
    v_exp_f32 v94, v94
    v_mfma_f32_16x16x32_bf16 a[128:131], v[128:131], v[108:111], a[128:131]
    v_exp_f32 v95, v95
    v_mfma_f32_16x16x32_bf16 a[156:159], v[132:135], v[108:111], a[156:159]
    v_add_f32 v22, v22, v92
    v_add_f32 v23, v23, v93
    v_mfma_f32_16x16x32_bf16 a[184:187], v[136:139], v[108:111], a[184:187]
    v_cvt_pk_bf16_f32 v106, v92, v93
    v_add_f32 v22, v22, v94
    v_mfma_f32_16x16x32_bf16 a[212:215], v[140:143], v[108:111], a[212:215]
    v_add_f32 v23, v23, v95
    v_cvt_pk_bf16_f32 v107, v94, v95
    s_waitcnt lgkmcnt(0)
    v_mfma_f32_16x16x32_bf16 v[88:91], v[56:59], a[0:3], v[28:31]
    v_mfma_f32_16x16x32_bf16 v[88:91], v[60:63], a[4:7], v[88:91]
    v_exp_f32 v96, v96
    v_mfma_f32_16x16x32_bf16 v[88:91], v[64:67], a[8:11], v[88:91]
    v_exp_f32 v97, v97
    v_mfma_f32_16x16x32_bf16 v[88:91], v[68:71], a[12:15], v[88:91]
    v_exp_f32 v98, v98
    v_mfma_f32_16x16x32_bf16 v[92:95], v[84:87], a[12:15], v[28:31]
    v_exp_f32 v99, v99
    v_mfma_f32_16x16x32_bf16 v[92:95], v[80:83], a[8:11], v[92:95]
    v_add_f32 v24, v24, v96
    v_add_f32 v25, v25, v97
    v_mfma_f32_16x16x32_bf16 v[92:95], v[76:79], a[4:7], v[92:95]
    v_cvt_pk_bf16_f32 v108, v96, v97
    v_mfma_f32_16x16x32_bf16 v[92:95], v[72:75], a[0:3], v[92:95]
    v_exp_f32 v100, v100
    v_mfma_f32_16x16x32_bf16 v[164:167], v[112:115], v[104:107], v[164:167]
    v_exp_f32 v101, v101
    v_mfma_f32_16x16x32_bf16 v[192:195], v[116:119], v[104:107], v[192:195]
    v_add_f32 v24, v24, v98
    v_add_f32 v25, v25, v99
    v_mfma_f32_16x16x32_bf16 v[220:223], v[120:123], v[104:107], v[220:223]
    v_cvt_pk_bf16_f32 v109, v98, v99
    v_mfma_f32_16x16x32_bf16 v[248:251], v[124:127], v[104:107], v[248:251]
    v_exp_f32 v102, v102
    v_mfma_f32_16x16x32_bf16 a[132:135], v[128:131], v[104:107], a[132:135]
    v_exp_f32 v103, v103
    v_mfma_f32_16x16x32_bf16 a[160:163], v[132:135], v[104:107], a[160:163]
    v_add_f32 v24, v24, v100
    v_add_f32 v25, v25, v101
    v_mfma_f32_16x16x32_bf16 a[188:191], v[136:139], v[104:107], a[188:191]
    v_cvt_pk_bf16_f32 v110, v100, v101
    v_add_f32 v24, v24, v102
    v_mfma_f32_16x16x32_bf16 a[216:219], v[140:143], v[104:107], a[216:219]
    v_add_f32 v25, v25, v103
    v_cvt_pk_bf16_f32 v111, v102, v103
    v_mfma_f32_16x16x32_bf16 v[96:99], v[56:59], a[16:19], v[32:35]
    v_mfma_f32_16x16x32_bf16 v[96:99], v[60:63], a[20:23], v[96:99]
    v_exp_f32 v88, v88
    v_mfma_f32_16x16x32_bf16 v[96:99], v[64:67], a[24:27], v[96:99]
    v_exp_f32 v89, v89
    v_mfma_f32_16x16x32_bf16 v[96:99], v[68:71], a[28:31], v[96:99]
    v_exp_f32 v90, v90
    v_mfma_f32_16x16x32_bf16 v[100:103], v[84:87], a[28:31], v[32:35]
    v_exp_f32 v91, v91
    v_mfma_f32_16x16x32_bf16 v[100:103], v[80:83], a[24:27], v[100:103]
    v_add_f32 v12, v12, v88
    v_add_f32 v13, v13, v89
    v_mfma_f32_16x16x32_bf16 v[100:103], v[76:79], a[20:23], v[100:103]
    v_cvt_pk_bf16_f32 v104, v88, v89
    v_mfma_f32_16x16x32_bf16 v[100:103], v[72:75], a[16:19], v[100:103]
    v_exp_f32 v92, v92
    v_mfma_f32_16x16x32_bf16 v[168:171], v[112:115], v[108:111], v[168:171]
    ds_read_b64_tr_b16 v[112:113], v9 offset:16896
    ds_read_b64_tr_b16 v[114:115], v9 offset:17408
    v_exp_f32 v93, v93
    v_mfma_f32_16x16x32_bf16 v[196:199], v[116:119], v[108:111], v[196:199]
    ds_read_b64_tr_b16 v[116:117], v9 offset:16928
    ds_read_b64_tr_b16 v[118:119], v9 offset:17440
    v_add_f32 v12, v12, v90
    v_add_f32 v13, v13, v91
    v_mfma_f32_16x16x32_bf16 v[224:227], v[120:123], v[108:111], v[224:227]
    ds_read_b64_tr_b16 v[120:121], v9 offset:16960
    ds_read_b64_tr_b16 v[122:123], v9 offset:17472
    v_cvt_pk_bf16_f32 v105, v90, v91
    v_mfma_f32_16x16x32_bf16 v[252:255], v[124:127], v[108:111], v[252:255]
    ds_read_b64_tr_b16 v[124:125], v9 offset:16992
    ds_read_b64_tr_b16 v[126:127], v9 offset:17504
    v_exp_f32 v94, v94
    v_mfma_f32_16x16x32_bf16 a[136:139], v[128:131], v[108:111], a[136:139]
    ds_read_b64_tr_b16 v[128:129], v9 offset:17024
    ds_read_b64_tr_b16 v[130:131], v9 offset:17536
    v_exp_f32 v95, v95
    v_mfma_f32_16x16x32_bf16 a[164:167], v[132:135], v[108:111], a[164:167]
    ds_read_b64_tr_b16 v[132:133], v9 offset:17056
    ds_read_b64_tr_b16 v[134:135], v9 offset:17568
    v_add_f32 v12, v12, v92
    v_add_f32 v13, v13, v93
    v_mfma_f32_16x16x32_bf16 a[192:195], v[136:139], v[108:111], a[192:195]
    ds_read_b64_tr_b16 v[136:137], v9 offset:17088
    ds_read_b64_tr_b16 v[138:139], v9 offset:17600
    v_cvt_pk_bf16_f32 v106, v92, v93
    v_add_f32 v12, v12, v94
    v_mfma_f32_16x16x32_bf16 a[220:223], v[140:143], v[108:111], a[220:223]
    ds_read_b64_tr_b16 v[140:141], v9 offset:17120
    ds_read_b64_tr_b16 v[142:143], v9 offset:17632
    v_add_f32 v13, v13, v95
    v_cvt_pk_bf16_f32 v107, v94, v95
    v_mfma_f32_16x16x32_bf16 v[88:91], v[56:59], a[32:35], v[36:39]
    v_mfma_f32_16x16x32_bf16 v[88:91], v[60:63], a[36:39], v[88:91]
    s_add_u32 m0, s33, 8448
    v_exp_f32 v96, v96
    v_mfma_f32_16x16x32_bf16 v[88:91], v[64:67], a[40:43], v[88:91]
    v_exp_f32 v97, v97
    v_mfma_f32_16x16x32_bf16 v[88:91], v[68:71], a[44:47], v[88:91]
    s_add_u32 s49, s50, s46
    v_exp_f32 v98, v98
    v_mfma_f32_16x16x32_bf16 v[92:95], v[84:87], a[44:47], v[36:39]
    v_exp_f32 v99, v99
    v_mfma_f32_16x16x32_bf16 v[92:95], v[80:83], a[40:43], v[92:95]
    s_lshl1_add_u32 s50, s51, s50
    v_add_f32 v14, v14, v96
    v_add_f32 v15, v15, v97
    v_mfma_f32_16x16x32_bf16 v[92:95], v[76:79], a[36:39], v[92:95]
    v_cvt_pk_bf16_f32 v108, v96, v97
    v_mfma_f32_16x16x32_bf16 v[92:95], v[72:75], a[32:35], v[92:95]
    s_add_u32 s82, s82, 2
    v_exp_f32 v100, v100
    s_waitcnt lgkmcnt(0)
    v_mfma_f32_16x16x32_bf16 v[144:147], v[112:115], v[104:107], v[144:147]
    v_exp_f32 v101, v101
    v_mfma_f32_16x16x32_bf16 v[172:175], v[116:119], v[104:107], v[172:175]
    s_cmp_eq_u32 s82, 20
    v_add_f32 v14, v14, v98
    v_add_f32 v15, v15, v99
    v_mfma_f32_16x16x32_bf16 v[200:203], v[120:123], v[104:107], v[200:203]
    v_cvt_pk_bf16_f32 v109, v98, v99
    v_mfma_f32_16x16x32_bf16 v[228:231], v[124:127], v[104:107], v[228:231]
    s_cselect_b32 s29, s83, 0
    v_exp_f32 v102, v102
    v_mfma_f32_16x16x32_bf16 a[112:115], v[128:131], v[104:107], a[112:115]
    v_exp_f32 v103, v103
    v_mfma_f32_16x16x32_bf16 a[140:143], v[132:135], v[104:107], a[140:143]
    s_sub_u32 s50, s50, s29
    v_add_f32 v14, v14, v100
    v_add_f32 v15, v15, v101
    v_mfma_f32_16x16x32_bf16 a[168:171], v[136:139], v[104:107], a[168:171]
    v_cvt_pk_bf16_f32 v110, v100, v101
    v_add_f32 v14, v14, v102
    v_mfma_f32_16x16x32_bf16 a[196:199], v[140:143], v[104:107], a[196:199]
    s_add_u32 s28, s49, s88
    v_add_f32 v15, v15, v103
    v_cvt_pk_bf16_f32 v111, v102, v103
    v_mfma_f32_16x16x32_bf16 v[96:99], v[56:59], a[48:51], v[40:43]
    v_mfma_f32_16x16x32_bf16 v[96:99], v[60:63], a[52:55], v[96:99]
    buffer_load_dwordx4 v26, s[16:19], s28 offen lds
    v_exp_f32 v88, v88
    v_mfma_f32_16x16x32_bf16 v[96:99], v[64:67], a[56:59], v[96:99]
    v_exp_f32 v89, v89
    v_mfma_f32_16x16x32_bf16 v[96:99], v[68:71], a[60:63], v[96:99]
    s_add_u32 m0, m0, s53
    v_exp_f32 v90, v90
    v_mfma_f32_16x16x32_bf16 v[100:103], v[84:87], a[60:63], v[40:43]
    v_exp_f32 v91, v91
    v_mfma_f32_16x16x32_bf16 v[100:103], v[80:83], a[56:59], v[100:103]
    s_add_u32 s28, s49, s89
    v_add_f32 v16, v16, v88
    v_add_f32 v17, v17, v89
    v_mfma_f32_16x16x32_bf16 v[100:103], v[76:79], a[52:55], v[100:103]
    v_cvt_pk_bf16_f32 v104, v88, v89
    v_mfma_f32_16x16x32_bf16 v[100:103], v[72:75], a[48:51], v[100:103]
    buffer_load_dwordx4 v26, s[16:19], s28 offen lds
    v_exp_f32 v92, v92
    v_mfma_f32_16x16x32_bf16 v[148:151], v[112:115], v[108:111], v[148:151]
    v_exp_f32 v93, v93
    v_mfma_f32_16x16x32_bf16 v[176:179], v[116:119], v[108:111], v[176:179]
    s_add_u32 m0, m0, s53
    v_add_f32 v16, v16, v90
    v_add_f32 v17, v17, v91
    v_mfma_f32_16x16x32_bf16 v[204:207], v[120:123], v[108:111], v[204:207]
    v_cvt_pk_bf16_f32 v105, v90, v91
    v_mfma_f32_16x16x32_bf16 v[232:235], v[124:127], v[108:111], v[232:235]
    s_add_u32 s28, s49, s90
    v_exp_f32 v94, v94
    v_mfma_f32_16x16x32_bf16 a[116:119], v[128:131], v[108:111], a[116:119]
    v_exp_f32 v95, v95
    v_mfma_f32_16x16x32_bf16 a[144:147], v[132:135], v[108:111], a[144:147]
    buffer_load_dwordx4 v26, s[16:19], s28 offen lds
    v_add_f32 v16, v16, v92
    v_add_f32 v17, v17, v93
    v_mfma_f32_16x16x32_bf16 a[172:175], v[136:139], v[108:111], a[172:175]
    v_cvt_pk_bf16_f32 v106, v92, v93
    v_add_f32 v16, v16, v94
    v_mfma_f32_16x16x32_bf16 a[200:203], v[140:143], v[108:111], a[200:203]
    s_add_u32 m0, m0, s53
    v_add_f32 v17, v17, v95
    v_cvt_pk_bf16_f32 v107, v94, v95
    v_mfma_f32_16x16x32_bf16 v[88:91], v[56:59], a[64:67], v[44:47]
    v_mfma_f32_16x16x32_bf16 v[88:91], v[60:63], a[68:71], v[88:91]
    s_add_u32 s28, s49, s91
    v_exp_f32 v96, v96
    v_mfma_f32_16x16x32_bf16 v[88:91], v[64:67], a[72:75], v[88:91]
    v_exp_f32 v97, v97
    v_mfma_f32_16x16x32_bf16 v[88:91], v[68:71], a[76:79], v[88:91]
    buffer_load_dwordx4 v26, s[16:19], s28 offen lds
    v_exp_f32 v98, v98
    v_mfma_f32_16x16x32_bf16 v[92:95], v[84:87], a[76:79], v[44:47]
    v_exp_f32 v99, v99
    v_mfma_f32_16x16x32_bf16 v[92:95], v[80:83], a[72:75], v[92:95]
    s_add_u32 m0, m0, s53
    v_add_f32 v18, v18, v96
    v_add_f32 v19, v19, v97
    v_mfma_f32_16x16x32_bf16 v[92:95], v[76:79], a[68:71], v[92:95]
    v_cvt_pk_bf16_f32 v108, v96, v97
    v_mfma_f32_16x16x32_bf16 v[92:95], v[72:75], a[64:67], v[92:95]
    s_add_u32 s28, s49, s92
    v_exp_f32 v100, v100
    v_mfma_f32_16x16x32_bf16 v[152:155], v[112:115], v[104:107], v[152:155]
    v_exp_f32 v101, v101
    v_mfma_f32_16x16x32_bf16 v[180:183], v[116:119], v[104:107], v[180:183]
    buffer_load_dwordx4 v26, s[16:19], s28 offen lds
    v_add_f32 v18, v18, v98
    v_add_f32 v19, v19, v99
    v_mfma_f32_16x16x32_bf16 v[208:211], v[120:123], v[104:107], v[208:211]
    v_cvt_pk_bf16_f32 v109, v98, v99
    v_mfma_f32_16x16x32_bf16 v[236:239], v[124:127], v[104:107], v[236:239]
    s_add_u32 m0, m0, s53
    v_exp_f32 v102, v102
    v_mfma_f32_16x16x32_bf16 a[120:123], v[128:131], v[104:107], a[120:123]
    v_exp_f32 v103, v103
    v_mfma_f32_16x16x32_bf16 a[148:151], v[132:135], v[104:107], a[148:151]
    s_add_u32 s28, s49, s93
    v_add_f32 v18, v18, v100
    v_add_f32 v19, v19, v101
    v_mfma_f32_16x16x32_bf16 a[176:179], v[136:139], v[104:107], a[176:179]
    v_cvt_pk_bf16_f32 v110, v100, v101
    v_add_f32 v18, v18, v102
    v_mfma_f32_16x16x32_bf16 a[204:207], v[140:143], v[104:107], a[204:207]
    buffer_load_dwordx4 v26, s[16:19], s28 offen lds
    v_add_f32 v19, v19, v103
    v_cvt_pk_bf16_f32 v111, v102, v103
    v_mfma_f32_16x16x32_bf16 v[96:99], v[56:59], a[80:83], v[48:51]
    v_mfma_f32_16x16x32_bf16 v[96:99], v[60:63], a[84:87], v[96:99]
    s_add_u32 m0, m0, s53
    v_exp_f32 v88, v88
    v_mfma_f32_16x16x32_bf16 v[96:99], v[64:67], a[88:91], v[96:99]
    v_exp_f32 v89, v89
    v_mfma_f32_16x16x32_bf16 v[96:99], v[68:71], a[92:95], v[96:99]
    s_add_u32 s28, s49, s47
    v_exp_f32 v90, v90
    v_mfma_f32_16x16x32_bf16 v[100:103], v[84:87], a[92:95], v[48:51]
    v_exp_f32 v91, v91
    v_mfma_f32_16x16x32_bf16 v[100:103], v[80:83], a[88:91], v[100:103]
    buffer_load_dwordx4 v26, s[16:19], s28 offen lds
    v_add_f32 v20, v20, v88
    v_add_f32 v21, v21, v89
    v_mfma_f32_16x16x32_bf16 v[100:103], v[76:79], a[84:87], v[100:103]
    v_cvt_pk_bf16_f32 v104, v88, v89
    v_mfma_f32_16x16x32_bf16 v[100:103], v[72:75], a[80:83], v[100:103]
    s_add_u32 m0, m0, s53
    v_exp_f32 v92, v92
    v_mfma_f32_16x16x32_bf16 v[156:159], v[112:115], v[108:111], v[156:159]
    v_exp_f32 v93, v93
    v_mfma_f32_16x16x32_bf16 v[184:187], v[116:119], v[108:111], v[184:187]
    s_add_u32 s28, s49, s98
    v_add_f32 v20, v20, v90
    v_add_f32 v21, v21, v91
    v_mfma_f32_16x16x32_bf16 v[212:215], v[120:123], v[108:111], v[212:215]
    v_cvt_pk_bf16_f32 v105, v90, v91
    v_mfma_f32_16x16x32_bf16 v[240:243], v[124:127], v[108:111], v[240:243]
    buffer_load_dwordx4 v26, s[16:19], s28 offen lds
    v_exp_f32 v94, v94
    v_mfma_f32_16x16x32_bf16 a[124:127], v[128:131], v[108:111], a[124:127]
    v_exp_f32 v95, v95
    v_mfma_f32_16x16x32_bf16 a[152:155], v[132:135], v[108:111], a[152:155]
    v_add_f32 v20, v20, v92
    v_add_f32 v21, v21, v93
    v_mfma_f32_16x16x32_bf16 a[180:183], v[136:139], v[108:111], a[180:183]
    v_cvt_pk_bf16_f32 v106, v92, v93
    v_add_f32 v20, v20, v94
    v_mfma_f32_16x16x32_bf16 a[208:211], v[140:143], v[108:111], a[208:211]
    v_add_f32 v21, v21, v95
    v_cvt_pk_bf16_f32 v107, v94, v95
    s_waitcnt vmcnt(16) lgkmcnt(0)
    s_barrier
    v_mfma_f32_16x16x32_bf16 v[88:91], v[56:59], a[96:99], v[52:55]
    ds_read_b128 v[56:59], v8 offset:25344
    v_mfma_f32_16x16x32_bf16 v[88:91], v[60:63], a[100:103], v[88:91]
    ds_read_b128 v[60:63], v8 offset:25408
    v_exp_f32 v96, v96
    v_mfma_f32_16x16x32_bf16 v[88:91], v[64:67], a[104:107], v[88:91]
    ds_read_b128 v[64:67], v8 offset:25472
    v_exp_f32 v97, v97
    v_mfma_f32_16x16x32_bf16 v[88:91], v[68:71], a[108:111], v[88:91]
    ds_read_b128 v[68:71], v8 offset:25536
    v_exp_f32 v98, v98
    v_mfma_f32_16x16x32_bf16 v[92:95], v[84:87], a[108:111], v[52:55]
    ds_read_b128 v[84:87], v8 offset:26048
    v_exp_f32 v99, v99
    v_mfma_f32_16x16x32_bf16 v[92:95], v[80:83], a[104:107], v[92:95]
    ds_read_b128 v[80:83], v8 offset:25984
    v_add_f32 v22, v22, v96
    v_add_f32 v23, v23, v97
    v_mfma_f32_16x16x32_bf16 v[92:95], v[76:79], a[100:103], v[92:95]
    ds_read_b128 v[76:79], v8 offset:25920
    v_cvt_pk_bf16_f32 v108, v96, v97
    v_mfma_f32_16x16x32_bf16 v[92:95], v[72:75], a[96:99], v[92:95]
    ds_read_b128 v[72:75], v8 offset:25856
    v_exp_f32 v100, v100
    v_mfma_f32_16x16x32_bf16 v[160:163], v[112:115], v[104:107], v[160:163]
    v_exp_f32 v101, v101
    v_mfma_f32_16x16x32_bf16 v[188:191], v[116:119], v[104:107], v[188:191]
    v_add_f32 v22, v22, v98
    v_add_f32 v23, v23, v99
    v_mfma_f32_16x16x32_bf16 v[216:219], v[120:123], v[104:107], v[216:219]
    v_cvt_pk_bf16_f32 v109, v98, v99
    v_mfma_f32_16x16x32_bf16 v[244:247], v[124:127], v[104:107], v[244:247]
    v_exp_f32 v102, v102
    v_mfma_f32_16x16x32_bf16 a[128:131], v[128:131], v[104:107], a[128:131]
    v_exp_f32 v103, v103
    v_mfma_f32_16x16x32_bf16 a[156:159], v[132:135], v[104:107], a[156:159]
    v_add_f32 v22, v22, v100
    v_add_f32 v23, v23, v101
    v_mfma_f32_16x16x32_bf16 a[184:187], v[136:139], v[104:107], a[184:187]
    v_cvt_pk_bf16_f32 v110, v100, v101
    v_add_f32 v22, v22, v102
    v_mfma_f32_16x16x32_bf16 a[212:215], v[140:143], v[104:107], a[212:215]
    v_add_f32 v23, v23, v103
    v_cvt_pk_bf16_f32 v111, v102, v103
    s_waitcnt lgkmcnt(0)
    v_mfma_f32_16x16x32_bf16 v[96:99], v[56:59], a[0:3], v[28:31]
    v_mfma_f32_16x16x32_bf16 v[96:99], v[60:63], a[4:7], v[96:99]
    v_exp_f32 v88, v88
    v_mfma_f32_16x16x32_bf16 v[96:99], v[64:67], a[8:11], v[96:99]
    v_exp_f32 v89, v89
    v_mfma_f32_16x16x32_bf16 v[96:99], v[68:71], a[12:15], v[96:99]
    v_exp_f32 v90, v90
    v_mfma_f32_16x16x32_bf16 v[100:103], v[84:87], a[12:15], v[28:31]
    v_exp_f32 v91, v91
    v_mfma_f32_16x16x32_bf16 v[100:103], v[80:83], a[8:11], v[100:103]
    v_add_f32 v24, v24, v88
    v_add_f32 v25, v25, v89
    v_mfma_f32_16x16x32_bf16 v[100:103], v[76:79], a[4:7], v[100:103]
    v_cvt_pk_bf16_f32 v104, v88, v89
    v_mfma_f32_16x16x32_bf16 v[100:103], v[72:75], a[0:3], v[100:103]
    v_exp_f32 v92, v92
    v_mfma_f32_16x16x32_bf16 v[164:167], v[112:115], v[108:111], v[164:167]
    v_exp_f32 v93, v93
    v_mfma_f32_16x16x32_bf16 v[192:195], v[116:119], v[108:111], v[192:195]
    v_add_f32 v24, v24, v90
    v_add_f32 v25, v25, v91
    v_mfma_f32_16x16x32_bf16 v[220:223], v[120:123], v[108:111], v[220:223]
    v_cvt_pk_bf16_f32 v105, v90, v91
    v_mfma_f32_16x16x32_bf16 v[248:251], v[124:127], v[108:111], v[248:251]
    v_exp_f32 v94, v94
    v_mfma_f32_16x16x32_bf16 a[132:135], v[128:131], v[108:111], a[132:135]
    v_exp_f32 v95, v95
    v_mfma_f32_16x16x32_bf16 a[160:163], v[132:135], v[108:111], a[160:163]
    v_add_f32 v24, v24, v92
    v_add_f32 v25, v25, v93
    v_mfma_f32_16x16x32_bf16 a[188:191], v[136:139], v[108:111], a[188:191]
    v_cvt_pk_bf16_f32 v106, v92, v93
    v_add_f32 v24, v24, v94
    v_mfma_f32_16x16x32_bf16 a[216:219], v[140:143], v[108:111], a[216:219]
    v_add_f32 v25, v25, v95
    v_cvt_pk_bf16_f32 v107, v94, v95
    v_mfma_f32_16x16x32_bf16 v[88:91], v[56:59], a[16:19], v[32:35]
    v_mfma_f32_16x16x32_bf16 v[88:91], v[60:63], a[20:23], v[88:91]
    v_exp_f32 v96, v96
    v_mfma_f32_16x16x32_bf16 v[88:91], v[64:67], a[24:27], v[88:91]
    v_exp_f32 v97, v97
    v_mfma_f32_16x16x32_bf16 v[88:91], v[68:71], a[28:31], v[88:91]
    v_exp_f32 v98, v98
    v_mfma_f32_16x16x32_bf16 v[92:95], v[84:87], a[28:31], v[32:35]
    v_exp_f32 v99, v99
    v_mfma_f32_16x16x32_bf16 v[92:95], v[80:83], a[24:27], v[92:95]
    v_add_f32 v12, v12, v96
    v_add_f32 v13, v13, v97
    v_mfma_f32_16x16x32_bf16 v[92:95], v[76:79], a[20:23], v[92:95]
    v_cvt_pk_bf16_f32 v108, v96, v97
    v_mfma_f32_16x16x32_bf16 v[92:95], v[72:75], a[16:19], v[92:95]
    v_exp_f32 v100, v100
    v_mfma_f32_16x16x32_bf16 v[168:171], v[112:115], v[104:107], v[168:171]
    ds_read_b64_tr_b16 v[112:113], v9 offset:25344
    ds_read_b64_tr_b16 v[114:115], v9 offset:25856
    v_exp_f32 v101, v101
    v_mfma_f32_16x16x32_bf16 v[196:199], v[116:119], v[104:107], v[196:199]
    ds_read_b64_tr_b16 v[116:117], v9 offset:25376
    ds_read_b64_tr_b16 v[118:119], v9 offset:25888
    v_add_f32 v12, v12, v98
    v_add_f32 v13, v13, v99
    v_mfma_f32_16x16x32_bf16 v[224:227], v[120:123], v[104:107], v[224:227]
    ds_read_b64_tr_b16 v[120:121], v9 offset:25408
    ds_read_b64_tr_b16 v[122:123], v9 offset:25920
    v_cvt_pk_bf16_f32 v109, v98, v99
    v_mfma_f32_16x16x32_bf16 v[252:255], v[124:127], v[104:107], v[252:255]
    ds_read_b64_tr_b16 v[124:125], v9 offset:25440
    ds_read_b64_tr_b16 v[126:127], v9 offset:25952
    v_exp_f32 v102, v102
    v_mfma_f32_16x16x32_bf16 a[136:139], v[128:131], v[104:107], a[136:139]
    ds_read_b64_tr_b16 v[128:129], v9 offset:25472
    ds_read_b64_tr_b16 v[130:131], v9 offset:25984
    v_exp_f32 v103, v103
    v_mfma_f32_16x16x32_bf16 a[164:167], v[132:135], v[104:107], a[164:167]
    ds_read_b64_tr_b16 v[132:133], v9 offset:25504
    ds_read_b64_tr_b16 v[134:135], v9 offset:26016
    v_add_f32 v12, v12, v100
    v_add_f32 v13, v13, v101
    v_mfma_f32_16x16x32_bf16 a[192:195], v[136:139], v[104:107], a[192:195]
    ds_read_b64_tr_b16 v[136:137], v9 offset:25536
    ds_read_b64_tr_b16 v[138:139], v9 offset:26048
    v_cvt_pk_bf16_f32 v110, v100, v101
    v_add_f32 v12, v12, v102
    v_mfma_f32_16x16x32_bf16 a[220:223], v[140:143], v[104:107], a[220:223]
    ds_read_b64_tr_b16 v[140:141], v9 offset:25568
    ds_read_b64_tr_b16 v[142:143], v9 offset:26080
    v_add_f32 v13, v13, v103
    v_cvt_pk_bf16_f32 v111, v102, v103
    v_mfma_f32_16x16x32_bf16 v[96:99], v[56:59], a[32:35], v[36:39]
    v_mfma_f32_16x16x32_bf16 v[96:99], v[60:63], a[36:39], v[96:99]
    s_add_u32 m0, s33, 16896
    v_exp_f32 v88, v88
    v_mfma_f32_16x16x32_bf16 v[96:99], v[64:67], a[40:43], v[96:99]
    v_exp_f32 v89, v89
    v_mfma_f32_16x16x32_bf16 v[96:99], v[68:71], a[44:47], v[96:99]
    s_mov_b32 s49, s50
    v_exp_f32 v90, v90
    v_mfma_f32_16x16x32_bf16 v[100:103], v[84:87], a[44:47], v[36:39]
    v_exp_f32 v91, v91
    v_mfma_f32_16x16x32_bf16 v[100:103], v[80:83], a[40:43], v[100:103]
    s_add_u32 s28, s49, s88
    v_add_f32 v14, v14, v88
    v_add_f32 v15, v15, v89
    v_mfma_f32_16x16x32_bf16 v[100:103], v[76:79], a[36:39], v[100:103]
    v_cvt_pk_bf16_f32 v104, v88, v89
    v_mfma_f32_16x16x32_bf16 v[100:103], v[72:75], a[32:35], v[100:103]
    v_exp_f32 v92, v92
    s_waitcnt lgkmcnt(0)
    v_mfma_f32_16x16x32_bf16 v[144:147], v[112:115], v[108:111], v[144:147]
    buffer_load_dwordx4 v26, s[16:19], s28 offen lds
    v_exp_f32 v93, v93
    v_mfma_f32_16x16x32_bf16 v[172:175], v[116:119], v[108:111], v[172:175]
    v_add_f32 v14, v14, v90
    v_add_f32 v15, v15, v91
    v_mfma_f32_16x16x32_bf16 v[200:203], v[120:123], v[108:111], v[200:203]
    s_add_u32 m0, m0, s53
    v_cvt_pk_bf16_f32 v105, v90, v91
    v_mfma_f32_16x16x32_bf16 v[228:231], v[124:127], v[108:111], v[228:231]
    v_exp_f32 v94, v94
    v_mfma_f32_16x16x32_bf16 a[112:115], v[128:131], v[108:111], a[112:115]
    s_add_u32 s28, s49, s89
    v_exp_f32 v95, v95
    v_mfma_f32_16x16x32_bf16 a[140:143], v[132:135], v[108:111], a[140:143]
    v_add_f32 v14, v14, v92
    v_add_f32 v15, v15, v93
    v_mfma_f32_16x16x32_bf16 a[168:171], v[136:139], v[108:111], a[168:171]
    buffer_load_dwordx4 v26, s[16:19], s28 offen lds
    v_cvt_pk_bf16_f32 v106, v92, v93
    v_add_f32 v14, v14, v94
    v_mfma_f32_16x16x32_bf16 a[196:199], v[140:143], v[108:111], a[196:199]
    v_add_f32 v15, v15, v95
    v_cvt_pk_bf16_f32 v107, v94, v95
    v_mfma_f32_16x16x32_bf16 v[88:91], v[56:59], a[48:51], v[40:43]
    v_mfma_f32_16x16x32_bf16 v[88:91], v[60:63], a[52:55], v[88:91]
    s_add_u32 m0, m0, s53
    v_exp_f32 v96, v96
    v_mfma_f32_16x16x32_bf16 v[88:91], v[64:67], a[56:59], v[88:91]
    v_exp_f32 v97, v97
    v_mfma_f32_16x16x32_bf16 v[88:91], v[68:71], a[60:63], v[88:91]
    s_add_u32 s28, s49, s90
    v_exp_f32 v98, v98
    v_mfma_f32_16x16x32_bf16 v[92:95], v[84:87], a[60:63], v[40:43]
    v_exp_f32 v99, v99
    v_mfma_f32_16x16x32_bf16 v[92:95], v[80:83], a[56:59], v[92:95]
    buffer_load_dwordx4 v26, s[16:19], s28 offen lds
    v_add_f32 v16, v16, v96
    v_add_f32 v17, v17, v97
    v_mfma_f32_16x16x32_bf16 v[92:95], v[76:79], a[52:55], v[92:95]
    v_cvt_pk_bf16_f32 v108, v96, v97
    v_mfma_f32_16x16x32_bf16 v[92:95], v[72:75], a[48:51], v[92:95]
    v_exp_f32 v100, v100
    v_mfma_f32_16x16x32_bf16 v[148:151], v[112:115], v[104:107], v[148:151]
    s_add_u32 m0, m0, s53
    v_exp_f32 v101, v101
    v_mfma_f32_16x16x32_bf16 v[176:179], v[116:119], v[104:107], v[176:179]
    v_add_f32 v16, v16, v98
    v_add_f32 v17, v17, v99
    v_mfma_f32_16x16x32_bf16 v[204:207], v[120:123], v[104:107], v[204:207]
    s_add_u32 s28, s49, s91
    v_cvt_pk_bf16_f32 v109, v98, v99
    v_mfma_f32_16x16x32_bf16 v[232:235], v[124:127], v[104:107], v[232:235]
    v_exp_f32 v102, v102
    v_mfma_f32_16x16x32_bf16 a[116:119], v[128:131], v[104:107], a[116:119]
    buffer_load_dwordx4 v26, s[16:19], s28 offen lds
    v_exp_f32 v103, v103
    v_mfma_f32_16x16x32_bf16 a[144:147], v[132:135], v[104:107], a[144:147]
    v_add_f32 v16, v16, v100
    v_add_f32 v17, v17, v101
    v_mfma_f32_16x16x32_bf16 a[172:175], v[136:139], v[104:107], a[172:175]
    s_add_u32 m0, m0, s53
    v_cvt_pk_bf16_f32 v110, v100, v101
    v_add_f32 v16, v16, v102
    v_mfma_f32_16x16x32_bf16 a[200:203], v[140:143], v[104:107], a[200:203]
    v_add_f32 v17, v17, v103
    v_cvt_pk_bf16_f32 v111, v102, v103
    v_mfma_f32_16x16x32_bf16 v[96:99], v[56:59], a[64:67], v[44:47]
    v_mfma_f32_16x16x32_bf16 v[96:99], v[60:63], a[68:71], v[96:99]
    s_add_u32 s28, s49, s92
    v_exp_f32 v88, v88
    v_mfma_f32_16x16x32_bf16 v[96:99], v[64:67], a[72:75], v[96:99]
    v_exp_f32 v89, v89
    v_mfma_f32_16x16x32_bf16 v[96:99], v[68:71], a[76:79], v[96:99]
    buffer_load_dwordx4 v26, s[16:19], s28 offen lds
    v_exp_f32 v90, v90
    v_mfma_f32_16x16x32_bf16 v[100:103], v[84:87], a[76:79], v[44:47]
    v_exp_f32 v91, v91
    v_mfma_f32_16x16x32_bf16 v[100:103], v[80:83], a[72:75], v[100:103]
    s_add_u32 m0, m0, s53
    v_add_f32 v18, v18, v88
    v_add_f32 v19, v19, v89
    v_mfma_f32_16x16x32_bf16 v[100:103], v[76:79], a[68:71], v[100:103]
    v_cvt_pk_bf16_f32 v104, v88, v89
    v_mfma_f32_16x16x32_bf16 v[100:103], v[72:75], a[64:67], v[100:103]
    v_exp_f32 v92, v92
    v_mfma_f32_16x16x32_bf16 v[152:155], v[112:115], v[108:111], v[152:155]
    s_add_u32 s28, s49, s93
    v_exp_f32 v93, v93
    v_mfma_f32_16x16x32_bf16 v[180:183], v[116:119], v[108:111], v[180:183]
    v_add_f32 v18, v18, v90
    v_add_f32 v19, v19, v91
    v_mfma_f32_16x16x32_bf16 v[208:211], v[120:123], v[108:111], v[208:211]
    buffer_load_dwordx4 v26, s[16:19], s28 offen lds
    v_cvt_pk_bf16_f32 v105, v90, v91
    v_mfma_f32_16x16x32_bf16 v[236:239], v[124:127], v[108:111], v[236:239]
    v_exp_f32 v94, v94
    v_mfma_f32_16x16x32_bf16 a[120:123], v[128:131], v[108:111], a[120:123]
    s_add_u32 m0, m0, s53
    v_exp_f32 v95, v95
    v_mfma_f32_16x16x32_bf16 a[148:151], v[132:135], v[108:111], a[148:151]
    v_add_f32 v18, v18, v92
    v_add_f32 v19, v19, v93
    v_mfma_f32_16x16x32_bf16 a[176:179], v[136:139], v[108:111], a[176:179]
    s_add_u32 s28, s49, s94
    v_cvt_pk_bf16_f32 v106, v92, v93
    v_add_f32 v18, v18, v94
    v_mfma_f32_16x16x32_bf16 a[204:207], v[140:143], v[108:111], a[204:207]
    v_add_f32 v19, v19, v95
    v_cvt_pk_bf16_f32 v107, v94, v95
    v_mfma_f32_16x16x32_bf16 v[88:91], v[56:59], a[80:83], v[48:51]
    v_mfma_f32_16x16x32_bf16 v[88:91], v[60:63], a[84:87], v[88:91]
    buffer_load_dwordx4 v26, s[16:19], s28 offen lds
    v_exp_f32 v96, v96
    v_mfma_f32_16x16x32_bf16 v[88:91], v[64:67], a[88:91], v[88:91]
    v_exp_f32 v97, v97
    v_mfma_f32_16x16x32_bf16 v[88:91], v[68:71], a[92:95], v[88:91]
    s_add_u32 m0, m0, s53
    v_exp_f32 v98, v98
    v_mfma_f32_16x16x32_bf16 v[92:95], v[84:87], a[92:95], v[48:51]
    v_exp_f32 v99, v99
    v_mfma_f32_16x16x32_bf16 v[92:95], v[80:83], a[88:91], v[92:95]
    s_add_u32 s28, s49, s95
    v_add_f32 v20, v20, v96
    v_add_f32 v21, v21, v97
    v_mfma_f32_16x16x32_bf16 v[92:95], v[76:79], a[84:87], v[92:95]
    v_cvt_pk_bf16_f32 v108, v96, v97
    v_mfma_f32_16x16x32_bf16 v[92:95], v[72:75], a[80:83], v[92:95]
    v_exp_f32 v100, v100
    v_mfma_f32_16x16x32_bf16 v[156:159], v[112:115], v[104:107], v[156:159]
    buffer_load_dwordx4 v26, s[16:19], s28 offen lds
    v_exp_f32 v101, v101
    v_mfma_f32_16x16x32_bf16 v[184:187], v[116:119], v[104:107], v[184:187]
    v_add_f32 v20, v20, v98
    v_add_f32 v21, v21, v99
    v_mfma_f32_16x16x32_bf16 v[212:215], v[120:123], v[104:107], v[212:215]
    v_cvt_pk_bf16_f32 v109, v98, v99
    v_mfma_f32_16x16x32_bf16 v[240:243], v[124:127], v[104:107], v[240:243]
    v_exp_f32 v102, v102
    v_mfma_f32_16x16x32_bf16 a[124:127], v[128:131], v[104:107], a[124:127]
    v_exp_f32 v103, v103
    v_mfma_f32_16x16x32_bf16 a[152:155], v[132:135], v[104:107], a[152:155]
    v_add_f32 v20, v20, v100
    v_add_f32 v21, v21, v101
    v_mfma_f32_16x16x32_bf16 a[180:183], v[136:139], v[104:107], a[180:183]
    v_cvt_pk_bf16_f32 v110, v100, v101
    v_add_f32 v20, v20, v102
    v_mfma_f32_16x16x32_bf16 a[208:211], v[140:143], v[104:107], a[208:211]
    v_add_f32 v21, v21, v103
    v_cvt_pk_bf16_f32 v111, v102, v103
    s_waitcnt vmcnt(8) lgkmcnt(0)
    s_barrier
    v_mfma_f32_16x16x32_bf16 v[96:99], v[56:59], a[96:99], v[52:55]
    s_add_u32 m0, s33, 25344
    v_mfma_f32_16x16x32_bf16 v[96:99], v[60:63], a[100:103], v[96:99]
    s_add_u32 s49, s50, s46
    v_exp_f32 v88, v88
    v_mfma_f32_16x16x32_bf16 v[96:99], v[64:67], a[104:107], v[96:99]
    s_lshl1_add_u32 s50, s51, s50
    v_exp_f32 v89, v89
    v_mfma_f32_16x16x32_bf16 v[96:99], v[68:71], a[108:111], v[96:99]
    s_add_u32 s82, s82, 2
    v_exp_f32 v90, v90
    v_mfma_f32_16x16x32_bf16 v[100:103], v[84:87], a[108:111], v[52:55]
    s_cmp_eq_u32 s82, 20
    v_exp_f32 v91, v91
    v_mfma_f32_16x16x32_bf16 v[100:103], v[80:83], a[104:107], v[100:103]
    s_cselect_b32 s29, s83, 0
    v_add_f32 v22, v22, v88
    v_add_f32 v23, v23, v89
    v_mfma_f32_16x16x32_bf16 v[100:103], v[76:79], a[100:103], v[100:103]
    s_sub_u32 s50, s50, s29
    v_cvt_pk_bf16_f32 v104, v88, v89
    v_mfma_f32_16x16x32_bf16 v[100:103], v[72:75], a[96:99], v[100:103]
    v_exp_f32 v92, v92
    v_mfma_f32_16x16x32_bf16 v[160:163], v[112:115], v[108:111], v[160:163]
    s_add_u32 s28, s49, s88
    v_exp_f32 v93, v93
    v_mfma_f32_16x16x32_bf16 v[188:191], v[116:119], v[108:111], v[188:191]
    buffer_load_dwordx4 v26, s[16:19], s28 offen lds
    v_add_f32 v22, v22, v90
    v_add_f32 v23, v23, v91
    v_mfma_f32_16x16x32_bf16 v[216:219], v[120:123], v[108:111], v[216:219]
    s_add_u32 m0, m0, s53
    v_cvt_pk_bf16_f32 v105, v90, v91
    v_mfma_f32_16x16x32_bf16 v[244:247], v[124:127], v[108:111], v[244:247]
    s_add_u32 s28, s49, s89
    v_exp_f32 v94, v94
    v_mfma_f32_16x16x32_bf16 a[128:131], v[128:131], v[108:111], a[128:131]
    buffer_load_dwordx4 v26, s[16:19], s28 offen lds
    v_exp_f32 v95, v95
    v_mfma_f32_16x16x32_bf16 a[156:159], v[132:135], v[108:111], a[156:159]
    s_add_u32 m0, m0, s53
    v_add_f32 v22, v22, v92
    v_add_f32 v23, v23, v93
    v_mfma_f32_16x16x32_bf16 a[184:187], v[136:139], v[108:111], a[184:187]
    s_add_u32 s28, s49, s90
    v_cvt_pk_bf16_f32 v106, v92, v93
    v_add_f32 v22, v22, v94
    v_mfma_f32_16x16x32_bf16 a[212:215], v[140:143], v[108:111], a[212:215]
    buffer_load_dwordx4 v26, s[16:19], s28 offen lds
    v_add_f32 v23, v23, v95
    v_cvt_pk_bf16_f32 v107, v94, v95
    s_nop 1
    v_mfma_f32_16x16x32_bf16 v[164:167], v[112:115], v[104:107], v[164:167]
    s_add_u32 m0, m0, s53
    s_add_u32 s28, s49, s91
    v_exp_f32 v96, v96
    v_mfma_f32_16x16x32_bf16 v[192:195], v[116:119], v[104:107], v[192:195]
    buffer_load_dwordx4 v26, s[16:19], s28 offen lds
    s_add_u32 m0, m0, s53
    v_exp_f32 v97, v97
    v_exp_f32 v98, v98
    v_mfma_f32_16x16x32_bf16 v[220:223], v[120:123], v[104:107], v[220:223]
    s_add_u32 s28, s49, s92
    buffer_load_dwordx4 v26, s[16:19], s28 offen lds
    v_exp_f32 v99, v99
    v_add_f32 v24, v24, v96
    v_add_f32 v25, v25, v97
    v_mfma_f32_16x16x32_bf16 v[248:251], v[124:127], v[104:107], v[248:251]
    s_add_u32 m0, m0, s53
    v_cvt_pk_bf16_f32 v108, v96, v97
    v_exp_f32 v100, v100
    v_mfma_f32_16x16x32_bf16 a[132:135], v[128:131], v[104:107], a[132:135]
    s_add_u32 s28, s49, s93
    buffer_load_dwordx4 v26, s[16:19], s28 offen lds
    v_exp_f32 v101, v101
    v_add_f32 v24, v24, v98
    v_add_f32 v25, v25, v99
    v_mfma_f32_16x16x32_bf16 a[160:163], v[132:135], v[104:107], a[160:163]
    s_add_u32 m0, m0, s53
    s_add_u32 s28, s49, s47
    v_cvt_pk_bf16_f32 v109, v98, v99
    v_exp_f32 v102, v102
    v_mfma_f32_16x16x32_bf16 a[188:191], v[136:139], v[104:107], a[188:191]
    buffer_load_dwordx4 v26, s[16:19], s28 offen lds
    s_add_u32 m0, m0, s53
    v_exp_f32 v103, v103
    v_add_f32 v24, v24, v100
    v_add_f32 v25, v25, v101
    v_mfma_f32_16x16x32_bf16 a[216:219], v[140:143], v[104:107], a[216:219]
    s_add_u32 s28, s49, s98
    buffer_load_dwordx4 v26, s[16:19], s28 offen lds
    v_cvt_pk_bf16_f32 v110, v100, v101
    v_add_f32 v24, v24, v102
    v_add_f32 v25, v25, v103
    v_cvt_pk_bf16_f32 v111, v102, v103
    s_branch L_at_aepi
L_at_atailB:
    v_mfma_f32_16x16x32_bf16 v[88:91], v[56:59], a[16:19], v[32:35]
    v_mfma_f32_16x16x32_bf16 v[88:91], v[60:63], a[20:23], v[88:91]
    v_exp_f32 v96, v96
    v_mfma_f32_16x16x32_bf16 v[88:91], v[64:67], a[24:27], v[88:91]
    v_exp_f32 v97, v97
    v_mfma_f32_16x16x32_bf16 v[88:91], v[68:71], a[28:31], v[88:91]
    v_exp_f32 v98, v98
    v_mfma_f32_16x16x32_bf16 v[92:95], v[84:87], a[28:31], v[32:35]
    v_exp_f32 v99, v99
    v_mfma_f32_16x16x32_bf16 v[92:95], v[80:83], a[24:27], v[92:95]
    v_add_f32 v12, v12, v96
    v_add_f32 v13, v13, v97
    v_mfma_f32_16x16x32_bf16 v[92:95], v[76:79], a[20:23], v[92:95]
    v_cvt_pk_bf16_f32 v108, v96, v97
    v_mfma_f32_16x16x32_bf16 v[92:95], v[72:75], a[16:19], v[92:95]
    v_exp_f32 v100, v100
    v_mfma_f32_16x16x32_bf16 v[168:171], v[112:115], v[104:107], v[168:171]
    ds_read_b64_tr_b16 v[112:113], v9 offset:8448
    ds_read_b64_tr_b16 v[114:115], v9 offset:8960
    v_exp_f32 v101, v101
    v_mfma_f32_16x16x32_bf16 v[196:199], v[116:119], v[104:107], v[196:199]
    ds_read_b64_tr_b16 v[116:117], v9 offset:8480
    ds_read_b64_tr_b16 v[118:119], v9 offset:8992
    v_add_f32 v12, v12, v98
    v_add_f32 v13, v13, v99
    v_mfma_f32_16x16x32_bf16 v[224:227], v[120:123], v[104:107], v[224:227]
    ds_read_b64_tr_b16 v[120:121], v9 offset:8512
    ds_read_b64_tr_b16 v[122:123], v9 offset:9024
    v_cvt_pk_bf16_f32 v109, v98, v99
    v_mfma_f32_16x16x32_bf16 v[252:255], v[124:127], v[104:107], v[252:255]
    ds_read_b64_tr_b16 v[124:125], v9 offset:8544
    ds_read_b64_tr_b16 v[126:127], v9 offset:9056
    v_exp_f32 v102, v102
    v_mfma_f32_16x16x32_bf16 a[136:139], v[128:131], v[104:107], a[136:139]
    ds_read_b64_tr_b16 v[128:129], v9 offset:8576
    ds_read_b64_tr_b16 v[130:131], v9 offset:9088
    v_exp_f32 v103, v103
    v_mfma_f32_16x16x32_bf16 a[164:167], v[132:135], v[104:107], a[164:167]
    ds_read_b64_tr_b16 v[132:133], v9 offset:8608
    ds_read_b64_tr_b16 v[134:135], v9 offset:9120
    v_add_f32 v12, v12, v100
    v_add_f32 v13, v13, v101
    v_mfma_f32_16x16x32_bf16 a[192:195], v[136:139], v[104:107], a[192:195]
    ds_read_b64_tr_b16 v[136:137], v9 offset:8640
    ds_read_b64_tr_b16 v[138:139], v9 offset:9152
    v_cvt_pk_bf16_f32 v110, v100, v101
    v_add_f32 v12, v12, v102
    v_mfma_f32_16x16x32_bf16 a[220:223], v[140:143], v[104:107], a[220:223]
    ds_read_b64_tr_b16 v[140:141], v9 offset:8672
    ds_read_b64_tr_b16 v[142:143], v9 offset:9184
    v_add_f32 v13, v13, v103
    v_cvt_pk_bf16_f32 v111, v102, v103
    v_mfma_f32_16x16x32_bf16 v[96:99], v[56:59], a[32:35], v[36:39]
    v_mfma_f32_16x16x32_bf16 v[96:99], v[60:63], a[36:39], v[96:99]
    s_add_u32 s29, s34, s100
    v_exp_f32 v88, v88
    v_mfma_f32_16x16x32_bf16 v[96:99], v[64:67], a[40:43], v[96:99]
    v_exp_f32 v89, v89
    v_mfma_f32_16x16x32_bf16 v[96:99], v[68:71], a[44:47], v[96:99]
    s_bfe_u32 s28, s29, 0x20003
    v_exp_f32 v90, v90
    v_mfma_f32_16x16x32_bf16 v[100:103], v[84:87], a[44:47], v[36:39]
    v_exp_f32 v91, v91
    v_mfma_f32_16x16x32_bf16 v[100:103], v[80:83], a[40:43], v[100:103]
    s_lshl_b32 s28, s28, 16
    v_add_f32 v14, v14, v88
    v_add_f32 v15, v15, v89
    v_mfma_f32_16x16x32_bf16 v[100:103], v[76:79], a[36:39], v[100:103]
    v_cvt_pk_bf16_f32 v104, v88, v89
    v_mfma_f32_16x16x32_bf16 v[100:103], v[72:75], a[32:35], v[100:103]
    v_exp_f32 v92, v92
    s_waitcnt lgkmcnt(0)
    v_mfma_f32_16x16x32_bf16 v[144:147], v[112:115], v[108:111], v[144:147]
    s_and_b32 s29, s29, 7
    v_exp_f32 v93, v93
    v_mfma_f32_16x16x32_bf16 v[172:175], v[116:119], v[108:111], v[172:175]
    v_add_f32 v14, v14, v90
    v_add_f32 v15, v15, v91
    v_mfma_f32_16x16x32_bf16 v[200:203], v[120:123], v[108:111], v[200:203]
    s_lshl_b32 s29, s29, 11
    v_cvt_pk_bf16_f32 v105, v90, v91
    v_mfma_f32_16x16x32_bf16 v[228:231], v[124:127], v[108:111], v[228:231]
    v_exp_f32 v94, v94
    v_mfma_f32_16x16x32_bf16 a[112:115], v[128:131], v[108:111], a[112:115]
    s_add_u32 s29, s28, s29
    v_exp_f32 v95, v95
    v_mfma_f32_16x16x32_bf16 a[140:143], v[132:135], v[108:111], a[140:143]
    v_add_f32 v14, v14, v92
    v_add_f32 v15, v15, v93
    v_mfma_f32_16x16x32_bf16 a[168:171], v[136:139], v[108:111], a[168:171]
    s_lshr_b32 s28, s34, 5
    v_cvt_pk_bf16_f32 v106, v92, v93
    v_add_f32 v14, v14, v94
    v_mfma_f32_16x16x32_bf16 a[196:199], v[140:143], v[108:111], a[196:199]
    v_add_f32 v15, v15, v95
    v_cvt_pk_bf16_f32 v107, v94, v95
    v_mfma_f32_16x16x32_bf16 v[88:91], v[56:59], a[48:51], v[40:43]
    v_mfma_f32_16x16x32_bf16 v[88:91], v[60:63], a[52:55], v[88:91]
    s_lshl_b32 s28, s28, 19
    v_exp_f32 v96, v96
    v_mfma_f32_16x16x32_bf16 v[88:91], v[64:67], a[56:59], v[88:91]
    v_exp_f32 v97, v97
    v_mfma_f32_16x16x32_bf16 v[88:91], v[68:71], a[60:63], v[88:91]
    s_add_u32 s49, s28, s29
    v_exp_f32 v98, v98
    v_mfma_f32_16x16x32_bf16 v[92:95], v[84:87], a[60:63], v[40:43]
    v_exp_f32 v99, v99
    v_mfma_f32_16x16x32_bf16 v[92:95], v[80:83], a[56:59], v[92:95]
    s_add_u32 m0, s33, 0
    v_add_f32 v16, v16, v96
    v_add_f32 v17, v17, v97
    v_mfma_f32_16x16x32_bf16 v[92:95], v[76:79], a[52:55], v[92:95]
    v_cvt_pk_bf16_f32 v108, v96, v97
    v_mfma_f32_16x16x32_bf16 v[92:95], v[72:75], a[48:51], v[92:95]
    v_exp_f32 v100, v100
    v_mfma_f32_16x16x32_bf16 v[148:151], v[112:115], v[104:107], v[148:151]
    s_add_u32 s34, s34, 1
    v_exp_f32 v101, v101
    v_mfma_f32_16x16x32_bf16 v[176:179], v[116:119], v[104:107], v[176:179]
    v_add_f32 v16, v16, v98
    v_add_f32 v17, v17, v99
    v_mfma_f32_16x16x32_bf16 v[204:207], v[120:123], v[104:107], v[204:207]
    buffer_load_dwordx4 v7, s[4:7], s49 offen offset:0 nt lds
    v_cvt_pk_bf16_f32 v109, v98, v99
    v_mfma_f32_16x16x32_bf16 v[232:235], v[124:127], v[104:107], v[232:235]
    v_exp_f32 v102, v102
    v_mfma_f32_16x16x32_bf16 a[116:119], v[128:131], v[104:107], a[116:119]
    s_add_u32 m0, m0, s96
    v_exp_f32 v103, v103
    v_mfma_f32_16x16x32_bf16 a[144:147], v[132:135], v[104:107], a[144:147]
    v_add_f32 v16, v16, v100
    v_add_f32 v17, v17, v101
    v_mfma_f32_16x16x32_bf16 a[172:175], v[136:139], v[104:107], a[172:175]
    buffer_load_dwordx4 v7, s[4:7], s49 offen offset:256 nt lds
    v_cvt_pk_bf16_f32 v110, v100, v101
    v_add_f32 v16, v16, v102
    v_mfma_f32_16x16x32_bf16 a[200:203], v[140:143], v[104:107], a[200:203]
    v_add_f32 v17, v17, v103
    v_cvt_pk_bf16_f32 v111, v102, v103
    v_mfma_f32_16x16x32_bf16 v[96:99], v[56:59], a[64:67], v[44:47]
    v_mfma_f32_16x16x32_bf16 v[96:99], v[60:63], a[68:71], v[96:99]
    s_add_u32 m0, m0, s97
    v_exp_f32 v88, v88
    v_mfma_f32_16x16x32_bf16 v[96:99], v[64:67], a[72:75], v[96:99]
    v_exp_f32 v89, v89
    v_mfma_f32_16x16x32_bf16 v[96:99], v[68:71], a[76:79], v[96:99]
    buffer_load_dwordx4 v7, s[4:7], s49 offen offset:512 nt lds
    v_exp_f32 v90, v90
    v_mfma_f32_16x16x32_bf16 v[100:103], v[84:87], a[76:79], v[44:47]
    v_exp_f32 v91, v91
    v_mfma_f32_16x16x32_bf16 v[100:103], v[80:83], a[72:75], v[100:103]
    s_add_u32 m0, m0, s96
    v_add_f32 v18, v18, v88
    v_add_f32 v19, v19, v89
    v_mfma_f32_16x16x32_bf16 v[100:103], v[76:79], a[68:71], v[100:103]
    v_cvt_pk_bf16_f32 v104, v88, v89
    v_mfma_f32_16x16x32_bf16 v[100:103], v[72:75], a[64:67], v[100:103]
    v_exp_f32 v92, v92
    v_mfma_f32_16x16x32_bf16 v[152:155], v[112:115], v[108:111], v[152:155]
    buffer_load_dwordx4 v7, s[4:7], s49 offen offset:768 nt lds
    v_exp_f32 v93, v93
    v_mfma_f32_16x16x32_bf16 v[180:183], v[116:119], v[108:111], v[180:183]
    v_add_f32 v18, v18, v90
    v_add_f32 v19, v19, v91
    v_mfma_f32_16x16x32_bf16 v[208:211], v[120:123], v[108:111], v[208:211]
    s_add_u32 m0, m0, s97
    v_cvt_pk_bf16_f32 v105, v90, v91
    v_mfma_f32_16x16x32_bf16 v[236:239], v[124:127], v[108:111], v[236:239]
    v_exp_f32 v94, v94
    v_mfma_f32_16x16x32_bf16 a[120:123], v[128:131], v[108:111], a[120:123]
    buffer_load_dwordx4 v7, s[4:7], s49 offen offset:1024 nt lds
    v_exp_f32 v95, v95
    v_mfma_f32_16x16x32_bf16 a[148:151], v[132:135], v[108:111], a[148:151]
    v_add_f32 v18, v18, v92
    v_add_f32 v19, v19, v93
    v_mfma_f32_16x16x32_bf16 a[176:179], v[136:139], v[108:111], a[176:179]
    s_add_u32 m0, m0, s96
    v_cvt_pk_bf16_f32 v106, v92, v93
    v_add_f32 v18, v18, v94
    v_mfma_f32_16x16x32_bf16 a[204:207], v[140:143], v[108:111], a[204:207]
    v_add_f32 v19, v19, v95
    v_cvt_pk_bf16_f32 v107, v94, v95
    v_mfma_f32_16x16x32_bf16 v[88:91], v[56:59], a[80:83], v[48:51]
    v_mfma_f32_16x16x32_bf16 v[88:91], v[60:63], a[84:87], v[88:91]
    buffer_load_dwordx4 v7, s[4:7], s49 offen offset:1280 nt lds
    v_exp_f32 v96, v96
    v_mfma_f32_16x16x32_bf16 v[88:91], v[64:67], a[88:91], v[88:91]
    v_exp_f32 v97, v97
    v_mfma_f32_16x16x32_bf16 v[88:91], v[68:71], a[92:95], v[88:91]
    s_add_u32 m0, m0, s97
    v_exp_f32 v98, v98
    v_mfma_f32_16x16x32_bf16 v[92:95], v[84:87], a[92:95], v[48:51]
    v_exp_f32 v99, v99
    v_mfma_f32_16x16x32_bf16 v[92:95], v[80:83], a[88:91], v[92:95]
    buffer_load_dwordx4 v7, s[4:7], s49 offen offset:1536 nt lds
    v_add_f32 v20, v20, v96
    v_add_f32 v21, v21, v97
    v_mfma_f32_16x16x32_bf16 v[92:95], v[76:79], a[84:87], v[92:95]
    v_cvt_pk_bf16_f32 v108, v96, v97
    v_mfma_f32_16x16x32_bf16 v[92:95], v[72:75], a[80:83], v[92:95]
    v_exp_f32 v100, v100
    v_mfma_f32_16x16x32_bf16 v[156:159], v[112:115], v[104:107], v[156:159]
    s_add_u32 m0, m0, s96
    v_exp_f32 v101, v101
    v_mfma_f32_16x16x32_bf16 v[184:187], v[116:119], v[104:107], v[184:187]
    v_add_f32 v20, v20, v98
    v_add_f32 v21, v21, v99
    v_mfma_f32_16x16x32_bf16 v[212:215], v[120:123], v[104:107], v[212:215]
    buffer_load_dwordx4 v7, s[4:7], s49 offen offset:1792 nt lds
    v_cvt_pk_bf16_f32 v109, v98, v99
    v_mfma_f32_16x16x32_bf16 v[240:243], v[124:127], v[104:107], v[240:243]
    v_exp_f32 v102, v102
    v_mfma_f32_16x16x32_bf16 a[124:127], v[128:131], v[104:107], a[124:127]
    v_exp_f32 v103, v103
    v_mfma_f32_16x16x32_bf16 a[152:155], v[132:135], v[104:107], a[152:155]
    v_add_f32 v20, v20, v100
    v_add_f32 v21, v21, v101
    v_mfma_f32_16x16x32_bf16 a[180:183], v[136:139], v[104:107], a[180:183]
    v_cvt_pk_bf16_f32 v110, v100, v101
    v_add_f32 v20, v20, v102
    v_mfma_f32_16x16x32_bf16 a[208:211], v[140:143], v[104:107], a[208:211]
    v_add_f32 v21, v21, v103
    v_cvt_pk_bf16_f32 v111, v102, v103
    s_waitcnt vmcnt(16) lgkmcnt(0)
    s_barrier
    v_mfma_f32_16x16x32_bf16 v[96:99], v[56:59], a[96:99], v[52:55]
    ds_read_b128 v[56:59], v8 offset:16896
    v_mfma_f32_16x16x32_bf16 v[96:99], v[60:63], a[100:103], v[96:99]
    ds_read_b128 v[60:63], v8 offset:16960
    v_exp_f32 v88, v88
    v_mfma_f32_16x16x32_bf16 v[96:99], v[64:67], a[104:107], v[96:99]
    ds_read_b128 v[64:67], v8 offset:17024
    v_exp_f32 v89, v89
    v_mfma_f32_16x16x32_bf16 v[96:99], v[68:71], a[108:111], v[96:99]
    ds_read_b128 v[68:71], v8 offset:17088
    v_exp_f32 v90, v90
    v_mfma_f32_16x16x32_bf16 v[100:103], v[84:87], a[108:111], v[52:55]
    ds_read_b128 v[84:87], v8 offset:17600
    v_exp_f32 v91, v91
    v_mfma_f32_16x16x32_bf16 v[100:103], v[80:83], a[104:107], v[100:103]
    ds_read_b128 v[80:83], v8 offset:17536
    v_add_f32 v22, v22, v88
    v_add_f32 v23, v23, v89
    v_mfma_f32_16x16x32_bf16 v[100:103], v[76:79], a[100:103], v[100:103]
    ds_read_b128 v[76:79], v8 offset:17472
    v_cvt_pk_bf16_f32 v104, v88, v89
    v_mfma_f32_16x16x32_bf16 v[100:103], v[72:75], a[96:99], v[100:103]
    ds_read_b128 v[72:75], v8 offset:17408
    v_exp_f32 v92, v92
    v_mfma_f32_16x16x32_bf16 v[160:163], v[112:115], v[108:111], v[160:163]
    v_exp_f32 v93, v93
    v_mfma_f32_16x16x32_bf16 v[188:191], v[116:119], v[108:111], v[188:191]
    v_add_f32 v22, v22, v90
    v_add_f32 v23, v23, v91
    v_mfma_f32_16x16x32_bf16 v[216:219], v[120:123], v[108:111], v[216:219]
    v_cvt_pk_bf16_f32 v105, v90, v91
    v_mfma_f32_16x16x32_bf16 v[244:247], v[124:127], v[108:111], v[244:247]
    v_exp_f32 v94, v94
    v_mfma_f32_16x16x32_bf16 a[128:131], v[128:131], v[108:111], a[128:131]
    v_exp_f32 v95, v95
    v_mfma_f32_16x16x32_bf16 a[156:159], v[132:135], v[108:111], a[156:159]
    v_add_f32 v22, v22, v92
    v_add_f32 v23, v23, v93
    v_mfma_f32_16x16x32_bf16 a[184:187], v[136:139], v[108:111], a[184:187]
    v_cvt_pk_bf16_f32 v106, v92, v93
    v_add_f32 v22, v22, v94
    v_mfma_f32_16x16x32_bf16 a[212:215], v[140:143], v[108:111], a[212:215]
    v_add_f32 v23, v23, v95
    v_cvt_pk_bf16_f32 v107, v94, v95
    s_waitcnt lgkmcnt(0)
    v_mfma_f32_16x16x32_bf16 v[88:91], v[56:59], a[0:3], v[28:31]
    v_mfma_f32_16x16x32_bf16 v[88:91], v[60:63], a[4:7], v[88:91]
    v_exp_f32 v96, v96
    v_mfma_f32_16x16x32_bf16 v[88:91], v[64:67], a[8:11], v[88:91]
    v_exp_f32 v97, v97
    v_mfma_f32_16x16x32_bf16 v[88:91], v[68:71], a[12:15], v[88:91]
    v_exp_f32 v98, v98
    v_mfma_f32_16x16x32_bf16 v[92:95], v[84:87], a[12:15], v[28:31]
    v_exp_f32 v99, v99
    v_mfma_f32_16x16x32_bf16 v[92:95], v[80:83], a[8:11], v[92:95]
    v_add_f32 v24, v24, v96
    v_add_f32 v25, v25, v97
    v_mfma_f32_16x16x32_bf16 v[92:95], v[76:79], a[4:7], v[92:95]
    v_cvt_pk_bf16_f32 v108, v96, v97
    v_mfma_f32_16x16x32_bf16 v[92:95], v[72:75], a[0:3], v[92:95]
    v_exp_f32 v100, v100
    v_mfma_f32_16x16x32_bf16 v[164:167], v[112:115], v[104:107], v[164:167]
    v_exp_f32 v101, v101
    v_mfma_f32_16x16x32_bf16 v[192:195], v[116:119], v[104:107], v[192:195]
    v_add_f32 v24, v24, v98
    v_add_f32 v25, v25, v99
    v_mfma_f32_16x16x32_bf16 v[220:223], v[120:123], v[104:107], v[220:223]
    v_cvt_pk_bf16_f32 v109, v98, v99
    v_mfma_f32_16x16x32_bf16 v[248:251], v[124:127], v[104:107], v[248:251]
    v_exp_f32 v102, v102
    v_mfma_f32_16x16x32_bf16 a[132:135], v[128:131], v[104:107], a[132:135]
    v_exp_f32 v103, v103
    v_mfma_f32_16x16x32_bf16 a[160:163], v[132:135], v[104:107], a[160:163]
    v_add_f32 v24, v24, v100
    v_add_f32 v25, v25, v101
    v_mfma_f32_16x16x32_bf16 a[188:191], v[136:139], v[104:107], a[188:191]
    v_cvt_pk_bf16_f32 v110, v100, v101
    v_add_f32 v24, v24, v102
    v_mfma_f32_16x16x32_bf16 a[216:219], v[140:143], v[104:107], a[216:219]
    v_add_f32 v25, v25, v103
    v_cvt_pk_bf16_f32 v111, v102, v103
    v_mfma_f32_16x16x32_bf16 v[96:99], v[56:59], a[16:19], v[32:35]
    v_mfma_f32_16x16x32_bf16 v[96:99], v[60:63], a[20:23], v[96:99]
    v_exp_f32 v88, v88
    v_mfma_f32_16x16x32_bf16 v[96:99], v[64:67], a[24:27], v[96:99]
    v_exp_f32 v89, v89
    v_mfma_f32_16x16x32_bf16 v[96:99], v[68:71], a[28:31], v[96:99]
    v_exp_f32 v90, v90
    v_mfma_f32_16x16x32_bf16 v[100:103], v[84:87], a[28:31], v[32:35]
    v_exp_f32 v91, v91
    v_mfma_f32_16x16x32_bf16 v[100:103], v[80:83], a[24:27], v[100:103]
    v_add_f32 v12, v12, v88
    v_add_f32 v13, v13, v89
    v_mfma_f32_16x16x32_bf16 v[100:103], v[76:79], a[20:23], v[100:103]
    v_cvt_pk_bf16_f32 v104, v88, v89
    v_mfma_f32_16x16x32_bf16 v[100:103], v[72:75], a[16:19], v[100:103]
    v_exp_f32 v92, v92
    v_mfma_f32_16x16x32_bf16 v[168:171], v[112:115], v[108:111], v[168:171]
    ds_read_b64_tr_b16 v[112:113], v9 offset:16896
    ds_read_b64_tr_b16 v[114:115], v9 offset:17408
    v_exp_f32 v93, v93
    v_mfma_f32_16x16x32_bf16 v[196:199], v[116:119], v[108:111], v[196:199]
    ds_read_b64_tr_b16 v[116:117], v9 offset:16928
    ds_read_b64_tr_b16 v[118:119], v9 offset:17440
    v_add_f32 v12, v12, v90
    v_add_f32 v13, v13, v91
    v_mfma_f32_16x16x32_bf16 v[224:227], v[120:123], v[108:111], v[224:227]
    ds_read_b64_tr_b16 v[120:121], v9 offset:16960
    ds_read_b64_tr_b16 v[122:123], v9 offset:17472
    v_cvt_pk_bf16_f32 v105, v90, v91
    v_mfma_f32_16x16x32_bf16 v[252:255], v[124:127], v[108:111], v[252:255]
    ds_read_b64_tr_b16 v[124:125], v9 offset:16992
    ds_read_b64_tr_b16 v[126:127], v9 offset:17504
    v_exp_f32 v94, v94
    v_mfma_f32_16x16x32_bf16 a[136:139], v[128:131], v[108:111], a[136:139]
    ds_read_b64_tr_b16 v[128:129], v9 offset:17024
    ds_read_b64_tr_b16 v[130:131], v9 offset:17536
    v_exp_f32 v95, v95
    v_mfma_f32_16x16x32_bf16 a[164:167], v[132:135], v[108:111], a[164:167]
    ds_read_b64_tr_b16 v[132:133], v9 offset:17056
    ds_read_b64_tr_b16 v[134:135], v9 offset:17568
    v_add_f32 v12, v12, v92
    v_add_f32 v13, v13, v93
    v_mfma_f32_16x16x32_bf16 a[192:195], v[136:139], v[108:111], a[192:195]
    ds_read_b64_tr_b16 v[136:137], v9 offset:17088
    ds_read_b64_tr_b16 v[138:139], v9 offset:17600
    v_cvt_pk_bf16_f32 v106, v92, v93
    v_add_f32 v12, v12, v94
    v_mfma_f32_16x16x32_bf16 a[220:223], v[140:143], v[108:111], a[220:223]
    ds_read_b64_tr_b16 v[140:141], v9 offset:17120
    ds_read_b64_tr_b16 v[142:143], v9 offset:17632
    v_add_f32 v13, v13, v95
    v_cvt_pk_bf16_f32 v107, v94, v95
    v_mfma_f32_16x16x32_bf16 v[88:91], v[56:59], a[32:35], v[36:39]
    v_mfma_f32_16x16x32_bf16 v[88:91], v[60:63], a[36:39], v[88:91]
    s_add_u32 s29, s34, s100
    v_exp_f32 v96, v96
    v_mfma_f32_16x16x32_bf16 v[88:91], v[64:67], a[40:43], v[88:91]
    v_exp_f32 v97, v97
    v_mfma_f32_16x16x32_bf16 v[88:91], v[68:71], a[44:47], v[88:91]
    s_bfe_u32 s28, s29, 0x20003
    v_exp_f32 v98, v98
    v_mfma_f32_16x16x32_bf16 v[92:95], v[84:87], a[44:47], v[36:39]
    v_exp_f32 v99, v99
    v_mfma_f32_16x16x32_bf16 v[92:95], v[80:83], a[40:43], v[92:95]
    s_lshl_b32 s28, s28, 16
    v_add_f32 v14, v14, v96
    v_add_f32 v15, v15, v97
    v_mfma_f32_16x16x32_bf16 v[92:95], v[76:79], a[36:39], v[92:95]
    v_cvt_pk_bf16_f32 v108, v96, v97
    v_mfma_f32_16x16x32_bf16 v[92:95], v[72:75], a[32:35], v[92:95]
    v_exp_f32 v100, v100
    s_waitcnt lgkmcnt(0)
    v_mfma_f32_16x16x32_bf16 v[144:147], v[112:115], v[104:107], v[144:147]
    s_and_b32 s29, s29, 7
    v_exp_f32 v101, v101
    v_mfma_f32_16x16x32_bf16 v[172:175], v[116:119], v[104:107], v[172:175]
    v_add_f32 v14, v14, v98
    v_add_f32 v15, v15, v99
    v_mfma_f32_16x16x32_bf16 v[200:203], v[120:123], v[104:107], v[200:203]
    s_lshl_b32 s29, s29, 11
    v_cvt_pk_bf16_f32 v109, v98, v99
    v_mfma_f32_16x16x32_bf16 v[228:231], v[124:127], v[104:107], v[228:231]
    v_exp_f32 v102, v102
    v_mfma_f32_16x16x32_bf16 a[112:115], v[128:131], v[104:107], a[112:115]
    s_add_u32 s29, s28, s29
    v_exp_f32 v103, v103
    v_mfma_f32_16x16x32_bf16 a[140:143], v[132:135], v[104:107], a[140:143]
    v_add_f32 v14, v14, v100
    v_add_f32 v15, v15, v101
    v_mfma_f32_16x16x32_bf16 a[168:171], v[136:139], v[104:107], a[168:171]
    s_lshr_b32 s28, s34, 5
    v_cvt_pk_bf16_f32 v110, v100, v101
    v_add_f32 v14, v14, v102
    v_mfma_f32_16x16x32_bf16 a[196:199], v[140:143], v[104:107], a[196:199]
    v_add_f32 v15, v15, v103
    v_cvt_pk_bf16_f32 v111, v102, v103
    v_mfma_f32_16x16x32_bf16 v[96:99], v[56:59], a[48:51], v[40:43]
    v_mfma_f32_16x16x32_bf16 v[96:99], v[60:63], a[52:55], v[96:99]
    s_lshl_b32 s28, s28, 19
    v_exp_f32 v88, v88
    v_mfma_f32_16x16x32_bf16 v[96:99], v[64:67], a[56:59], v[96:99]
    v_exp_f32 v89, v89
    v_mfma_f32_16x16x32_bf16 v[96:99], v[68:71], a[60:63], v[96:99]
    s_add_u32 s49, s28, s29
    v_exp_f32 v90, v90
    v_mfma_f32_16x16x32_bf16 v[100:103], v[84:87], a[60:63], v[40:43]
    v_exp_f32 v91, v91
    v_mfma_f32_16x16x32_bf16 v[100:103], v[80:83], a[56:59], v[100:103]
    s_add_u32 m0, s33, 8448
    v_add_f32 v16, v16, v88
    v_add_f32 v17, v17, v89
    v_mfma_f32_16x16x32_bf16 v[100:103], v[76:79], a[52:55], v[100:103]
    v_cvt_pk_bf16_f32 v104, v88, v89
    v_mfma_f32_16x16x32_bf16 v[100:103], v[72:75], a[48:51], v[100:103]
    v_exp_f32 v92, v92
    v_mfma_f32_16x16x32_bf16 v[148:151], v[112:115], v[108:111], v[148:151]
    s_add_u32 s34, s34, 1
    v_exp_f32 v93, v93
    v_mfma_f32_16x16x32_bf16 v[176:179], v[116:119], v[108:111], v[176:179]
    v_add_f32 v16, v16, v90
    v_add_f32 v17, v17, v91
    v_mfma_f32_16x16x32_bf16 v[204:207], v[120:123], v[108:111], v[204:207]
    buffer_load_dwordx4 v7, s[4:7], s49 offen offset:0 nt lds
    v_cvt_pk_bf16_f32 v105, v90, v91
    v_mfma_f32_16x16x32_bf16 v[232:235], v[124:127], v[108:111], v[232:235]
    v_exp_f32 v94, v94
    v_mfma_f32_16x16x32_bf16 a[116:119], v[128:131], v[108:111], a[116:119]
    s_add_u32 m0, m0, s96
    v_exp_f32 v95, v95
    v_mfma_f32_16x16x32_bf16 a[144:147], v[132:135], v[108:111], a[144:147]
    v_add_f32 v16, v16, v92
    v_add_f32 v17, v17, v93
    v_mfma_f32_16x16x32_bf16 a[172:175], v[136:139], v[108:111], a[172:175]
    buffer_load_dwordx4 v7, s[4:7], s49 offen offset:256 nt lds
    v_cvt_pk_bf16_f32 v106, v92, v93
    v_add_f32 v16, v16, v94
    v_mfma_f32_16x16x32_bf16 a[200:203], v[140:143], v[108:111], a[200:203]
    v_add_f32 v17, v17, v95
    v_cvt_pk_bf16_f32 v107, v94, v95
    v_mfma_f32_16x16x32_bf16 v[88:91], v[56:59], a[64:67], v[44:47]
    v_mfma_f32_16x16x32_bf16 v[88:91], v[60:63], a[68:71], v[88:91]
    s_add_u32 m0, m0, s97
    v_exp_f32 v96, v96
    v_mfma_f32_16x16x32_bf16 v[88:91], v[64:67], a[72:75], v[88:91]
    v_exp_f32 v97, v97
    v_mfma_f32_16x16x32_bf16 v[88:91], v[68:71], a[76:79], v[88:91]
    buffer_load_dwordx4 v7, s[4:7], s49 offen offset:512 nt lds
    v_exp_f32 v98, v98
    v_mfma_f32_16x16x32_bf16 v[92:95], v[84:87], a[76:79], v[44:47]
    v_exp_f32 v99, v99
    v_mfma_f32_16x16x32_bf16 v[92:95], v[80:83], a[72:75], v[92:95]
    s_add_u32 m0, m0, s96
    v_add_f32 v18, v18, v96
    v_add_f32 v19, v19, v97
    v_mfma_f32_16x16x32_bf16 v[92:95], v[76:79], a[68:71], v[92:95]
    v_cvt_pk_bf16_f32 v108, v96, v97
    v_mfma_f32_16x16x32_bf16 v[92:95], v[72:75], a[64:67], v[92:95]
    v_exp_f32 v100, v100
    v_mfma_f32_16x16x32_bf16 v[152:155], v[112:115], v[104:107], v[152:155]
    buffer_load_dwordx4 v7, s[4:7], s49 offen offset:768 nt lds
    v_exp_f32 v101, v101
    v_mfma_f32_16x16x32_bf16 v[180:183], v[116:119], v[104:107], v[180:183]
    v_add_f32 v18, v18, v98
    v_add_f32 v19, v19, v99
    v_mfma_f32_16x16x32_bf16 v[208:211], v[120:123], v[104:107], v[208:211]
    s_add_u32 m0, m0, s97
    v_cvt_pk_bf16_f32 v109, v98, v99
    v_mfma_f32_16x16x32_bf16 v[236:239], v[124:127], v[104:107], v[236:239]
    v_exp_f32 v102, v102
    v_mfma_f32_16x16x32_bf16 a[120:123], v[128:131], v[104:107], a[120:123]
    buffer_load_dwordx4 v7, s[4:7], s49 offen offset:1024 nt lds
    v_exp_f32 v103, v103
    v_mfma_f32_16x16x32_bf16 a[148:151], v[132:135], v[104:107], a[148:151]
    v_add_f32 v18, v18, v100
    v_add_f32 v19, v19, v101
    v_mfma_f32_16x16x32_bf16 a[176:179], v[136:139], v[104:107], a[176:179]
    s_add_u32 m0, m0, s96
    v_cvt_pk_bf16_f32 v110, v100, v101
    v_add_f32 v18, v18, v102
    v_mfma_f32_16x16x32_bf16 a[204:207], v[140:143], v[104:107], a[204:207]
    v_add_f32 v19, v19, v103
    v_cvt_pk_bf16_f32 v111, v102, v103
    v_mfma_f32_16x16x32_bf16 v[96:99], v[56:59], a[80:83], v[48:51]
    v_mfma_f32_16x16x32_bf16 v[96:99], v[60:63], a[84:87], v[96:99]
    buffer_load_dwordx4 v7, s[4:7], s49 offen offset:1280 nt lds
    v_exp_f32 v88, v88
    v_mfma_f32_16x16x32_bf16 v[96:99], v[64:67], a[88:91], v[96:99]
    v_exp_f32 v89, v89
    v_mfma_f32_16x16x32_bf16 v[96:99], v[68:71], a[92:95], v[96:99]
    s_add_u32 m0, m0, s97
    v_exp_f32 v90, v90
    v_mfma_f32_16x16x32_bf16 v[100:103], v[84:87], a[92:95], v[48:51]
    v_exp_f32 v91, v91
    v_mfma_f32_16x16x32_bf16 v[100:103], v[80:83], a[88:91], v[100:103]
    buffer_load_dwordx4 v7, s[4:7], s49 offen offset:1536 nt lds
    v_add_f32 v20, v20, v88
    v_add_f32 v21, v21, v89
    v_mfma_f32_16x16x32_bf16 v[100:103], v[76:79], a[84:87], v[100:103]
    v_cvt_pk_bf16_f32 v104, v88, v89
    v_mfma_f32_16x16x32_bf16 v[100:103], v[72:75], a[80:83], v[100:103]
    v_exp_f32 v92, v92
    v_mfma_f32_16x16x32_bf16 v[156:159], v[112:115], v[108:111], v[156:159]
    s_add_u32 m0, m0, s96
    v_exp_f32 v93, v93
    v_mfma_f32_16x16x32_bf16 v[184:187], v[116:119], v[108:111], v[184:187]
    v_add_f32 v20, v20, v90
    v_add_f32 v21, v21, v91
    v_mfma_f32_16x16x32_bf16 v[212:215], v[120:123], v[108:111], v[212:215]
    buffer_load_dwordx4 v7, s[4:7], s49 offen offset:1792 nt lds
    v_cvt_pk_bf16_f32 v105, v90, v91
    v_mfma_f32_16x16x32_bf16 v[240:243], v[124:127], v[108:111], v[240:243]
    v_exp_f32 v94, v94
    v_mfma_f32_16x16x32_bf16 a[124:127], v[128:131], v[108:111], a[124:127]
    v_exp_f32 v95, v95
    v_mfma_f32_16x16x32_bf16 a[152:155], v[132:135], v[108:111], a[152:155]
    v_add_f32 v20, v20, v92
    v_add_f32 v21, v21, v93
    v_mfma_f32_16x16x32_bf16 a[180:183], v[136:139], v[108:111], a[180:183]
    v_cvt_pk_bf16_f32 v106, v92, v93
    v_add_f32 v20, v20, v94
    v_mfma_f32_16x16x32_bf16 a[208:211], v[140:143], v[108:111], a[208:211]
    v_add_f32 v21, v21, v95
    v_cvt_pk_bf16_f32 v107, v94, v95
    s_waitcnt vmcnt(16) lgkmcnt(0)
    s_barrier
    v_mfma_f32_16x16x32_bf16 v[88:91], v[56:59], a[96:99], v[52:55]
    ds_read_b128 v[56:59], v8 offset:25344
    v_mfma_f32_16x16x32_bf16 v[88:91], v[60:63], a[100:103], v[88:91]
    ds_read_b128 v[60:63], v8 offset:25408
    v_exp_f32 v96, v96
    v_mfma_f32_16x16x32_bf16 v[88:91], v[64:67], a[104:107], v[88:91]
    ds_read_b128 v[64:67], v8 offset:25472
    v_exp_f32 v97, v97
    v_mfma_f32_16x16x32_bf16 v[88:91], v[68:71], a[108:111], v[88:91]
    ds_read_b128 v[68:71], v8 offset:25536
    v_exp_f32 v98, v98
    v_mfma_f32_16x16x32_bf16 v[92:95], v[84:87], a[108:111], v[52:55]
    ds_read_b128 v[84:87], v8 offset:26048
    v_exp_f32 v99, v99
    v_mfma_f32_16x16x32_bf16 v[92:95], v[80:83], a[104:107], v[92:95]
    ds_read_b128 v[80:83], v8 offset:25984
    v_add_f32 v22, v22, v96
    v_add_f32 v23, v23, v97
    v_mfma_f32_16x16x32_bf16 v[92:95], v[76:79], a[100:103], v[92:95]
    ds_read_b128 v[76:79], v8 offset:25920
    v_cvt_pk_bf16_f32 v108, v96, v97
    v_mfma_f32_16x16x32_bf16 v[92:95], v[72:75], a[96:99], v[92:95]
    ds_read_b128 v[72:75], v8 offset:25856
    v_exp_f32 v100, v100
    v_mfma_f32_16x16x32_bf16 v[160:163], v[112:115], v[104:107], v[160:163]
    v_exp_f32 v101, v101
    v_mfma_f32_16x16x32_bf16 v[188:191], v[116:119], v[104:107], v[188:191]
    v_add_f32 v22, v22, v98
    v_add_f32 v23, v23, v99
    v_mfma_f32_16x16x32_bf16 v[216:219], v[120:123], v[104:107], v[216:219]
    v_cvt_pk_bf16_f32 v109, v98, v99
    v_mfma_f32_16x16x32_bf16 v[244:247], v[124:127], v[104:107], v[244:247]
    v_exp_f32 v102, v102
    v_mfma_f32_16x16x32_bf16 a[128:131], v[128:131], v[104:107], a[128:131]
    v_exp_f32 v103, v103
    v_mfma_f32_16x16x32_bf16 a[156:159], v[132:135], v[104:107], a[156:159]
    v_add_f32 v22, v22, v100
    v_add_f32 v23, v23, v101
    v_mfma_f32_16x16x32_bf16 a[184:187], v[136:139], v[104:107], a[184:187]
    v_cvt_pk_bf16_f32 v110, v100, v101
    v_add_f32 v22, v22, v102
    v_mfma_f32_16x16x32_bf16 a[212:215], v[140:143], v[104:107], a[212:215]
    v_add_f32 v23, v23, v103
    v_cvt_pk_bf16_f32 v111, v102, v103
    s_waitcnt lgkmcnt(0)
    v_mfma_f32_16x16x32_bf16 v[96:99], v[56:59], a[0:3], v[28:31]
    v_mfma_f32_16x16x32_bf16 v[96:99], v[60:63], a[4:7], v[96:99]
    v_exp_f32 v88, v88
    v_mfma_f32_16x16x32_bf16 v[96:99], v[64:67], a[8:11], v[96:99]
    v_exp_f32 v89, v89
    v_mfma_f32_16x16x32_bf16 v[96:99], v[68:71], a[12:15], v[96:99]
    v_exp_f32 v90, v90
    v_mfma_f32_16x16x32_bf16 v[100:103], v[84:87], a[12:15], v[28:31]
    v_exp_f32 v91, v91
    v_mfma_f32_16x16x32_bf16 v[100:103], v[80:83], a[8:11], v[100:103]
    v_add_f32 v24, v24, v88
    v_add_f32 v25, v25, v89
    v_mfma_f32_16x16x32_bf16 v[100:103], v[76:79], a[4:7], v[100:103]
    v_cvt_pk_bf16_f32 v104, v88, v89
    v_mfma_f32_16x16x32_bf16 v[100:103], v[72:75], a[0:3], v[100:103]
    v_exp_f32 v92, v92
    v_mfma_f32_16x16x32_bf16 v[164:167], v[112:115], v[108:111], v[164:167]
    v_exp_f32 v93, v93
    v_mfma_f32_16x16x32_bf16 v[192:195], v[116:119], v[108:111], v[192:195]
    v_add_f32 v24, v24, v90
    v_add_f32 v25, v25, v91
    v_mfma_f32_16x16x32_bf16 v[220:223], v[120:123], v[108:111], v[220:223]
    v_cvt_pk_bf16_f32 v105, v90, v91
    v_mfma_f32_16x16x32_bf16 v[248:251], v[124:127], v[108:111], v[248:251]
    v_exp_f32 v94, v94
    v_mfma_f32_16x16x32_bf16 a[132:135], v[128:131], v[108:111], a[132:135]
    v_exp_f32 v95, v95
    v_mfma_f32_16x16x32_bf16 a[160:163], v[132:135], v[108:111], a[160:163]
    v_add_f32 v24, v24, v92
    v_add_f32 v25, v25, v93
    v_mfma_f32_16x16x32_bf16 a[188:191], v[136:139], v[108:111], a[188:191]
    v_cvt_pk_bf16_f32 v106, v92, v93
    v_add_f32 v24, v24, v94
    v_mfma_f32_16x16x32_bf16 a[216:219], v[140:143], v[108:111], a[216:219]
    v_add_f32 v25, v25, v95
    v_cvt_pk_bf16_f32 v107, v94, v95
    v_mfma_f32_16x16x32_bf16 v[88:91], v[56:59], a[16:19], v[32:35]
    v_mfma_f32_16x16x32_bf16 v[88:91], v[60:63], a[20:23], v[88:91]
    v_exp_f32 v96, v96
    v_mfma_f32_16x16x32_bf16 v[88:91], v[64:67], a[24:27], v[88:91]
    v_exp_f32 v97, v97
    v_mfma_f32_16x16x32_bf16 v[88:91], v[68:71], a[28:31], v[88:91]
    v_exp_f32 v98, v98
    v_mfma_f32_16x16x32_bf16 v[92:95], v[84:87], a[28:31], v[32:35]
    v_exp_f32 v99, v99
    v_mfma_f32_16x16x32_bf16 v[92:95], v[80:83], a[24:27], v[92:95]
    v_add_f32 v12, v12, v96
    v_add_f32 v13, v13, v97
    v_mfma_f32_16x16x32_bf16 v[92:95], v[76:79], a[20:23], v[92:95]
    v_cvt_pk_bf16_f32 v108, v96, v97
    v_mfma_f32_16x16x32_bf16 v[92:95], v[72:75], a[16:19], v[92:95]
    v_exp_f32 v100, v100
    v_mfma_f32_16x16x32_bf16 v[168:171], v[112:115], v[104:107], v[168:171]
    ds_read_b64_tr_b16 v[112:113], v9 offset:25344
    ds_read_b64_tr_b16 v[114:115], v9 offset:25856
    v_exp_f32 v101, v101
    v_mfma_f32_16x16x32_bf16 v[196:199], v[116:119], v[104:107], v[196:199]
    ds_read_b64_tr_b16 v[116:117], v9 offset:25376
    ds_read_b64_tr_b16 v[118:119], v9 offset:25888
    v_add_f32 v12, v12, v98
    v_add_f32 v13, v13, v99
    v_mfma_f32_16x16x32_bf16 v[224:227], v[120:123], v[104:107], v[224:227]
    ds_read_b64_tr_b16 v[120:121], v9 offset:25408
    ds_read_b64_tr_b16 v[122:123], v9 offset:25920
    v_cvt_pk_bf16_f32 v109, v98, v99
    v_mfma_f32_16x16x32_bf16 v[252:255], v[124:127], v[104:107], v[252:255]
    ds_read_b64_tr_b16 v[124:125], v9 offset:25440
    ds_read_b64_tr_b16 v[126:127], v9 offset:25952
    v_exp_f32 v102, v102
    v_mfma_f32_16x16x32_bf16 a[136:139], v[128:131], v[104:107], a[136:139]
    ds_read_b64_tr_b16 v[128:129], v9 offset:25472
    ds_read_b64_tr_b16 v[130:131], v9 offset:25984
    v_exp_f32 v103, v103
    v_mfma_f32_16x16x32_bf16 a[164:167], v[132:135], v[104:107], a[164:167]
    ds_read_b64_tr_b16 v[132:133], v9 offset:25504
    ds_read_b64_tr_b16 v[134:135], v9 offset:26016
    v_add_f32 v12, v12, v100
    v_add_f32 v13, v13, v101
    v_mfma_f32_16x16x32_bf16 a[192:195], v[136:139], v[104:107], a[192:195]
    ds_read_b64_tr_b16 v[136:137], v9 offset:25536
    ds_read_b64_tr_b16 v[138:139], v9 offset:26048
    v_cvt_pk_bf16_f32 v110, v100, v101
    v_add_f32 v12, v12, v102
    v_mfma_f32_16x16x32_bf16 a[220:223], v[140:143], v[104:107], a[220:223]
    ds_read_b64_tr_b16 v[140:141], v9 offset:25568
    ds_read_b64_tr_b16 v[142:143], v9 offset:26080
    v_add_f32 v13, v13, v103
    v_cvt_pk_bf16_f32 v111, v102, v103
    v_mfma_f32_16x16x32_bf16 v[96:99], v[56:59], a[32:35], v[36:39]
    v_mfma_f32_16x16x32_bf16 v[96:99], v[60:63], a[36:39], v[96:99]
    s_add_u32 s29, s34, s100
    v_exp_f32 v88, v88
    v_mfma_f32_16x16x32_bf16 v[96:99], v[64:67], a[40:43], v[96:99]
    v_exp_f32 v89, v89
    v_mfma_f32_16x16x32_bf16 v[96:99], v[68:71], a[44:47], v[96:99]
    s_bfe_u32 s28, s29, 0x20003
    v_exp_f32 v90, v90
    v_mfma_f32_16x16x32_bf16 v[100:103], v[84:87], a[44:47], v[36:39]
    v_exp_f32 v91, v91
    v_mfma_f32_16x16x32_bf16 v[100:103], v[80:83], a[40:43], v[100:103]
    s_lshl_b32 s28, s28, 16
    v_add_f32 v14, v14, v88
    v_add_f32 v15, v15, v89
    v_mfma_f32_16x16x32_bf16 v[100:103], v[76:79], a[36:39], v[100:103]
    v_cvt_pk_bf16_f32 v104, v88, v89
    v_mfma_f32_16x16x32_bf16 v[100:103], v[72:75], a[32:35], v[100:103]
    v_exp_f32 v92, v92
    s_waitcnt lgkmcnt(0)
    v_mfma_f32_16x16x32_bf16 v[144:147], v[112:115], v[108:111], v[144:147]
    s_and_b32 s29, s29, 7
    v_exp_f32 v93, v93
    v_mfma_f32_16x16x32_bf16 v[172:175], v[116:119], v[108:111], v[172:175]
    v_add_f32 v14, v14, v90
    v_add_f32 v15, v15, v91
    v_mfma_f32_16x16x32_bf16 v[200:203], v[120:123], v[108:111], v[200:203]
    s_lshl_b32 s29, s29, 11
    v_cvt_pk_bf16_f32 v105, v90, v91
    v_mfma_f32_16x16x32_bf16 v[228:231], v[124:127], v[108:111], v[228:231]
    v_exp_f32 v94, v94
    v_mfma_f32_16x16x32_bf16 a[112:115], v[128:131], v[108:111], a[112:115]
    s_add_u32 s29, s28, s29
    v_exp_f32 v95, v95
    v_mfma_f32_16x16x32_bf16 a[140:143], v[132:135], v[108:111], a[140:143]
    v_add_f32 v14, v14, v92
    v_add_f32 v15, v15, v93
    v_mfma_f32_16x16x32_bf16 a[168:171], v[136:139], v[108:111], a[168:171]
    s_lshr_b32 s28, s34, 5
    v_cvt_pk_bf16_f32 v106, v92, v93
    v_add_f32 v14, v14, v94
    v_mfma_f32_16x16x32_bf16 a[196:199], v[140:143], v[108:111], a[196:199]
    v_add_f32 v15, v15, v95
    v_cvt_pk_bf16_f32 v107, v94, v95
    v_mfma_f32_16x16x32_bf16 v[88:91], v[56:59], a[48:51], v[40:43]
    v_mfma_f32_16x16x32_bf16 v[88:91], v[60:63], a[52:55], v[88:91]
    s_lshl_b32 s28, s28, 19
    v_exp_f32 v96, v96
    v_mfma_f32_16x16x32_bf16 v[88:91], v[64:67], a[56:59], v[88:91]
    v_exp_f32 v97, v97
    v_mfma_f32_16x16x32_bf16 v[88:91], v[68:71], a[60:63], v[88:91]
    s_add_u32 s49, s28, s29
    v_exp_f32 v98, v98
    v_mfma_f32_16x16x32_bf16 v[92:95], v[84:87], a[60:63], v[40:43]
    v_exp_f32 v99, v99
    v_mfma_f32_16x16x32_bf16 v[92:95], v[80:83], a[56:59], v[92:95]
    s_add_u32 m0, s33, 16896
    v_add_f32 v16, v16, v96
    v_add_f32 v17, v17, v97
    v_mfma_f32_16x16x32_bf16 v[92:95], v[76:79], a[52:55], v[92:95]
    v_cvt_pk_bf16_f32 v108, v96, v97
    v_mfma_f32_16x16x32_bf16 v[92:95], v[72:75], a[48:51], v[92:95]
    v_exp_f32 v100, v100
    v_mfma_f32_16x16x32_bf16 v[148:151], v[112:115], v[104:107], v[148:151]
    s_add_u32 s34, s34, 1
    v_exp_f32 v101, v101
    v_mfma_f32_16x16x32_bf16 v[176:179], v[116:119], v[104:107], v[176:179]
    v_add_f32 v16, v16, v98
    v_add_f32 v17, v17, v99
    v_mfma_f32_16x16x32_bf16 v[204:207], v[120:123], v[104:107], v[204:207]
    buffer_load_dwordx4 v7, s[4:7], s49 offen offset:0 nt lds
    v_cvt_pk_bf16_f32 v109, v98, v99
    v_mfma_f32_16x16x32_bf16 v[232:235], v[124:127], v[104:107], v[232:235]
    v_exp_f32 v102, v102
    v_mfma_f32_16x16x32_bf16 a[116:119], v[128:131], v[104:107], a[116:119]
    s_add_u32 m0, m0, s96
    v_exp_f32 v103, v103
    v_mfma_f32_16x16x32_bf16 a[144:147], v[132:135], v[104:107], a[144:147]
    v_add_f32 v16, v16, v100
    v_add_f32 v17, v17, v101
    v_mfma_f32_16x16x32_bf16 a[172:175], v[136:139], v[104:107], a[172:175]
    buffer_load_dwordx4 v7, s[4:7], s49 offen offset:256 nt lds
    v_cvt_pk_bf16_f32 v110, v100, v101
    v_add_f32 v16, v16, v102
    v_mfma_f32_16x16x32_bf16 a[200:203], v[140:143], v[104:107], a[200:203]
    v_add_f32 v17, v17, v103
    v_cvt_pk_bf16_f32 v111, v102, v103
    v_mfma_f32_16x16x32_bf16 v[96:99], v[56:59], a[64:67], v[44:47]
    v_mfma_f32_16x16x32_bf16 v[96:99], v[60:63], a[68:71], v[96:99]
    s_add_u32 m0, m0, s97
    v_exp_f32 v88, v88
    v_mfma_f32_16x16x32_bf16 v[96:99], v[64:67], a[72:75], v[96:99]
    v_exp_f32 v89, v89
    v_mfma_f32_16x16x32_bf16 v[96:99], v[68:71], a[76:79], v[96:99]
    buffer_load_dwordx4 v7, s[4:7], s49 offen offset:512 nt lds
    v_exp_f32 v90, v90
    v_mfma_f32_16x16x32_bf16 v[100:103], v[84:87], a[76:79], v[44:47]
    v_exp_f32 v91, v91
    v_mfma_f32_16x16x32_bf16 v[100:103], v[80:83], a[72:75], v[100:103]
    s_add_u32 m0, m0, s96
    v_add_f32 v18, v18, v88
    v_add_f32 v19, v19, v89
    v_mfma_f32_16x16x32_bf16 v[100:103], v[76:79], a[68:71], v[100:103]
    v_cvt_pk_bf16_f32 v104, v88, v89
    v_mfma_f32_16x16x32_bf16 v[100:103], v[72:75], a[64:67], v[100:103]
    v_exp_f32 v92, v92
    v_mfma_f32_16x16x32_bf16 v[152:155], v[112:115], v[108:111], v[152:155]
    buffer_load_dwordx4 v7, s[4:7], s49 offen offset:768 nt lds
    v_exp_f32 v93, v93
    v_mfma_f32_16x16x32_bf16 v[180:183], v[116:119], v[108:111], v[180:183]
    v_add_f32 v18, v18, v90
    v_add_f32 v19, v19, v91
    v_mfma_f32_16x16x32_bf16 v[208:211], v[120:123], v[108:111], v[208:211]
    s_add_u32 m0, m0, s97
    v_cvt_pk_bf16_f32 v105, v90, v91
    v_mfma_f32_16x16x32_bf16 v[236:239], v[124:127], v[108:111], v[236:239]
    v_exp_f32 v94, v94
    v_mfma_f32_16x16x32_bf16 a[120:123], v[128:131], v[108:111], a[120:123]
    buffer_load_dwordx4 v7, s[4:7], s49 offen offset:1024 nt lds
    v_exp_f32 v95, v95
    v_mfma_f32_16x16x32_bf16 a[148:151], v[132:135], v[108:111], a[148:151]
    v_add_f32 v18, v18, v92
    v_add_f32 v19, v19, v93
    v_mfma_f32_16x16x32_bf16 a[176:179], v[136:139], v[108:111], a[176:179]
    s_add_u32 m0, m0, s96
    v_cvt_pk_bf16_f32 v106, v92, v93
    v_add_f32 v18, v18, v94
    v_mfma_f32_16x16x32_bf16 a[204:207], v[140:143], v[108:111], a[204:207]
    v_add_f32 v19, v19, v95
    v_cvt_pk_bf16_f32 v107, v94, v95
    v_mfma_f32_16x16x32_bf16 v[88:91], v[56:59], a[80:83], v[48:51]
    v_mfma_f32_16x16x32_bf16 v[88:91], v[60:63], a[84:87], v[88:91]
    buffer_load_dwordx4 v7, s[4:7], s49 offen offset:1280 nt lds
    v_exp_f32 v96, v96
    v_mfma_f32_16x16x32_bf16 v[88:91], v[64:67], a[88:91], v[88:91]
    v_exp_f32 v97, v97
    v_mfma_f32_16x16x32_bf16 v[88:91], v[68:71], a[92:95], v[88:91]
    s_add_u32 m0, m0, s97
    v_exp_f32 v98, v98
    v_mfma_f32_16x16x32_bf16 v[92:95], v[84:87], a[92:95], v[48:51]
    v_exp_f32 v99, v99
    v_mfma_f32_16x16x32_bf16 v[92:95], v[80:83], a[88:91], v[92:95]
    buffer_load_dwordx4 v7, s[4:7], s49 offen offset:1536 nt lds
    v_add_f32 v20, v20, v96
    v_add_f32 v21, v21, v97
    v_mfma_f32_16x16x32_bf16 v[92:95], v[76:79], a[84:87], v[92:95]
    v_cvt_pk_bf16_f32 v108, v96, v97
    v_mfma_f32_16x16x32_bf16 v[92:95], v[72:75], a[80:83], v[92:95]
    v_exp_f32 v100, v100
    v_mfma_f32_16x16x32_bf16 v[156:159], v[112:115], v[104:107], v[156:159]
    s_add_u32 m0, m0, s96
    v_exp_f32 v101, v101
    v_mfma_f32_16x16x32_bf16 v[184:187], v[116:119], v[104:107], v[184:187]
    v_add_f32 v20, v20, v98
    v_add_f32 v21, v21, v99
    v_mfma_f32_16x16x32_bf16 v[212:215], v[120:123], v[104:107], v[212:215]
    buffer_load_dwordx4 v7, s[4:7], s49 offen offset:1792 nt lds
    v_cvt_pk_bf16_f32 v109, v98, v99
    v_mfma_f32_16x16x32_bf16 v[240:243], v[124:127], v[104:107], v[240:243]
    v_exp_f32 v102, v102
    v_mfma_f32_16x16x32_bf16 a[124:127], v[128:131], v[104:107], a[124:127]
    v_exp_f32 v103, v103
    v_mfma_f32_16x16x32_bf16 a[152:155], v[132:135], v[104:107], a[152:155]
    v_add_f32 v20, v20, v100
    v_add_f32 v21, v21, v101
    v_mfma_f32_16x16x32_bf16 a[180:183], v[136:139], v[104:107], a[180:183]
    v_cvt_pk_bf16_f32 v110, v100, v101
    v_add_f32 v20, v20, v102
    v_mfma_f32_16x16x32_bf16 a[208:211], v[140:143], v[104:107], a[208:211]
    v_add_f32 v21, v21, v103
    v_cvt_pk_bf16_f32 v111, v102, v103
    s_waitcnt vmcnt(16) lgkmcnt(0)
    s_barrier
    v_mfma_f32_16x16x32_bf16 v[96:99], v[56:59], a[96:99], v[52:55]
    ds_read_b128 v[56:59], v8 offset:0
    s_add_u32 s29, s34, s100
    v_mfma_f32_16x16x32_bf16 v[96:99], v[60:63], a[100:103], v[96:99]
    ds_read_b128 v[60:63], v8 offset:64
    s_bfe_u32 s28, s29, 0x20003
    v_exp_f32 v88, v88
    v_mfma_f32_16x16x32_bf16 v[96:99], v[64:67], a[104:107], v[96:99]
    ds_read_b128 v[64:67], v8 offset:128
    s_lshl_b32 s28, s28, 16
    v_exp_f32 v89, v89
    v_mfma_f32_16x16x32_bf16 v[96:99], v[68:71], a[108:111], v[96:99]
    ds_read_b128 v[68:71], v8 offset:192
    s_and_b32 s29, s29, 7
    v_exp_f32 v90, v90
    v_mfma_f32_16x16x32_bf16 v[100:103], v[84:87], a[108:111], v[52:55]
    ds_read_b128 v[84:87], v8 offset:704
    s_lshl_b32 s29, s29, 11
    v_exp_f32 v91, v91
    v_mfma_f32_16x16x32_bf16 v[100:103], v[80:83], a[104:107], v[100:103]
    ds_read_b128 v[80:83], v8 offset:640
    s_add_u32 s29, s28, s29
    v_add_f32 v22, v22, v88
    v_add_f32 v23, v23, v89
    v_mfma_f32_16x16x32_bf16 v[100:103], v[76:79], a[100:103], v[100:103]
    ds_read_b128 v[76:79], v8 offset:576
    s_lshr_b32 s28, s34, 5
    v_cvt_pk_bf16_f32 v104, v88, v89
    v_mfma_f32_16x16x32_bf16 v[100:103], v[72:75], a[96:99], v[100:103]
    ds_read_b128 v[72:75], v8 offset:512
    s_lshl_b32 s28, s28, 19
    v_exp_f32 v92, v92
    v_mfma_f32_16x16x32_bf16 v[160:163], v[112:115], v[108:111], v[160:163]
    s_add_u32 s49, s28, s29
    s_add_u32 m0, s33, 25344
    v_exp_f32 v93, v93
    v_mfma_f32_16x16x32_bf16 v[188:191], v[116:119], v[108:111], v[188:191]
    s_add_u32 s34, s34, 1
    v_add_f32 v22, v22, v90
    v_add_f32 v23, v23, v91
    v_mfma_f32_16x16x32_bf16 v[216:219], v[120:123], v[108:111], v[216:219]
    s_nop 0
    v_cvt_pk_bf16_f32 v105, v90, v91
    v_mfma_f32_16x16x32_bf16 v[244:247], v[124:127], v[108:111], v[244:247]
    buffer_load_dwordx4 v7, s[4:7], s49 offen offset:0 nt lds
    v_exp_f32 v94, v94
    v_mfma_f32_16x16x32_bf16 a[128:131], v[128:131], v[108:111], a[128:131]
    s_add_u32 m0, m0, s96
    v_exp_f32 v95, v95
    v_mfma_f32_16x16x32_bf16 a[156:159], v[132:135], v[108:111], a[156:159]
    s_nop 0
    v_add_f32 v22, v22, v92
    v_add_f32 v23, v23, v93
    v_mfma_f32_16x16x32_bf16 a[184:187], v[136:139], v[108:111], a[184:187]
    buffer_load_dwordx4 v7, s[4:7], s49 offen offset:256 nt lds
    v_cvt_pk_bf16_f32 v106, v92, v93
    v_add_f32 v22, v22, v94
    v_mfma_f32_16x16x32_bf16 a[212:215], v[140:143], v[108:111], a[212:215]
    s_add_u32 m0, m0, s97
    v_add_f32 v23, v23, v95
    v_cvt_pk_bf16_f32 v107, v94, v95
    s_lshl_b32 s30, s2, 2
    s_add_u32 s30, s30, s20
    s_mul_i32 s30, s30, 28672
    v_lshlrev_b32 v4, 4, v1
    buffer_load_dwordx4 a[0:3], v4, s[12:15], s30 offen offset:0
    buffer_load_dwordx4 a[4:7], v4, s[12:15], s30 offen offset:1024
    buffer_load_dwordx4 a[8:11], v4, s[12:15], s30 offen offset:2048
    buffer_load_dwordx4 a[12:15], v4, s[12:15], s30 offen offset:3072
    s_add_u32 s30, s30, 4096
    buffer_load_dwordx4 a[16:19], v4, s[12:15], s30 offen offset:0
    buffer_load_dwordx4 a[20:23], v4, s[12:15], s30 offen offset:1024
    buffer_load_dwordx4 a[24:27], v4, s[12:15], s30 offen offset:2048
    buffer_load_dwordx4 a[28:31], v4, s[12:15], s30 offen offset:3072
    s_add_u32 s30, s30, 4096
    buffer_load_dwordx4 a[32:35], v4, s[12:15], s30 offen offset:0
    buffer_load_dwordx4 a[36:39], v4, s[12:15], s30 offen offset:1024
    buffer_load_dwordx4 a[40:43], v4, s[12:15], s30 offen offset:2048
    buffer_load_dwordx4 a[44:47], v4, s[12:15], s30 offen offset:3072
    s_add_u32 s30, s30, 4096
    buffer_load_dwordx4 a[48:51], v4, s[12:15], s30 offen offset:0
    buffer_load_dwordx4 a[52:55], v4, s[12:15], s30 offen offset:1024
    buffer_load_dwordx4 a[56:59], v4, s[12:15], s30 offen offset:2048
    buffer_load_dwordx4 a[60:63], v4, s[12:15], s30 offen offset:3072
    s_add_u32 s30, s30, 4096
    buffer_load_dwordx4 a[64:67], v4, s[12:15], s30 offen offset:0
    buffer_load_dwordx4 a[68:71], v4, s[12:15], s30 offen offset:1024
    buffer_load_dwordx4 a[72:75], v4, s[12:15], s30 offen offset:2048
    buffer_load_dwordx4 a[76:79], v4, s[12:15], s30 offen offset:3072
    s_add_u32 s30, s30, 4096
    buffer_load_dwordx4 a[80:83], v4, s[12:15], s30 offen offset:0
    buffer_load_dwordx4 a[84:87], v4, s[12:15], s30 offen offset:1024
    buffer_load_dwordx4 a[88:91], v4, s[12:15], s30 offen offset:2048
    buffer_load_dwordx4 a[92:95], v4, s[12:15], s30 offen offset:3072
    s_add_u32 s30, s30, 4096
    buffer_load_dwordx4 a[96:99], v4, s[12:15], s30 offen offset:0
    buffer_load_dwordx4 a[100:103], v4, s[12:15], s30 offen offset:1024
    buffer_load_dwordx4 a[104:107], v4, s[12:15], s30 offen offset:2048
    buffer_load_dwordx4 a[108:111], v4, s[12:15], s30 offen offset:3072
    s_nop 1
    v_mfma_f32_16x16x32_bf16 v[164:167], v[112:115], v[104:107], v[164:167]
    s_nop 0
    buffer_load_dwordx4 v7, s[4:7], s49 offen offset:512 nt lds
    v_exp_f32 v96, v96
    v_mfma_f32_16x16x32_bf16 v[192:195], v[116:119], v[104:107], v[192:195]
    s_add_u32 m0, m0, s96
    s_nop 0
    v_exp_f32 v97, v97
    v_exp_f32 v98, v98
    v_mfma_f32_16x16x32_bf16 v[220:223], v[120:123], v[104:107], v[220:223]
    buffer_load_dwordx4 v7, s[4:7], s49 offen offset:768 nt lds
    s_add_u32 m0, m0, s97
    v_exp_f32 v99, v99
    v_add_f32 v24, v24, v96
    v_add_f32 v25, v25, v97
    v_mfma_f32_16x16x32_bf16 v[248:251], v[124:127], v[104:107], v[248:251]
    s_nop 0
    buffer_load_dwordx4 v7, s[4:7], s49 offen offset:1024 nt lds
    v_cvt_pk_bf16_f32 v108, v96, v97
    v_exp_f32 v100, v100
    v_mfma_f32_16x16x32_bf16 a[132:135], v[128:131], v[104:107], a[132:135]
    s_add_u32 m0, m0, s96
    s_nop 0
    buffer_load_dwordx4 v7, s[4:7], s49 offen offset:1280 nt lds
    v_exp_f32 v101, v101
    v_add_f32 v24, v24, v98
    v_add_f32 v25, v25, v99
    v_mfma_f32_16x16x32_bf16 a[160:163], v[132:135], v[104:107], a[160:163]
    s_add_u32 m0, m0, s97
    s_nop 0
    v_cvt_pk_bf16_f32 v109, v98, v99
    v_exp_f32 v102, v102
    v_mfma_f32_16x16x32_bf16 a[188:191], v[136:139], v[104:107], a[188:191]
    buffer_load_dwordx4 v7, s[4:7], s49 offen offset:1536 nt lds
    s_add_u32 m0, m0, s96
    v_exp_f32 v103, v103
    v_add_f32 v24, v24, v100
    v_add_f32 v25, v25, v101
    v_mfma_f32_16x16x32_bf16 a[216:219], v[140:143], v[104:107], a[216:219]
    s_nop 0
    buffer_load_dwordx4 v7, s[4:7], s49 offen offset:1792 nt lds
    v_cvt_pk_bf16_f32 v110, v100, v101
    v_add_f32 v24, v24, v102
    v_add_f32 v25, v25, v103
    v_cvt_pk_bf16_f32 v111, v102, v103
L_at_aepi:
    s_nop 1
    s_waitcnt lgkmcnt(0)
    v_mfma_f32_16x16x32_bf16 v[168:171], v[112:115], v[108:111], v[168:171]
    v_add_f32 v12, v12, v13
    v_add_f32 v14, v14, v15
    v_add_f32 v16, v16, v17
    v_add_f32 v18, v18, v19
    v_add_f32 v20, v20, v21
    v_add_f32 v22, v22, v23
    v_mfma_f32_16x16x32_bf16 v[196:199], v[116:119], v[108:111], v[196:199]
    v_add_f32 v24, v24, v25
    v_mov_b32 v88, v12
    v_mov_b32 v89, v14
    v_mov_b32 v90, v16
    v_mov_b32 v91, v18
    v_mov_b32 v92, v20
    v_mfma_f32_16x16x32_bf16 v[224:227], v[120:123], v[108:111], v[224:227]
    v_mov_b32 v93, v22
    v_mov_b32 v94, v24
    v_permlane16_swap_b32 v12, v88
    v_permlane16_swap_b32 v14, v89
    v_permlane16_swap_b32 v16, v90
    v_permlane16_swap_b32 v18, v91
    v_mfma_f32_16x16x32_bf16 v[252:255], v[124:127], v[108:111], v[252:255]
    v_permlane16_swap_b32 v20, v92
    v_permlane16_swap_b32 v22, v93
    v_permlane16_swap_b32 v24, v94
    v_add_f32 v12, v12, v88
    v_add_f32 v14, v14, v89
    v_add_f32 v16, v16, v90
    v_mfma_f32_16x16x32_bf16 a[136:139], v[128:131], v[108:111], a[136:139]
    v_add_f32 v18, v18, v91
    v_add_f32 v20, v20, v92
    v_add_f32 v22, v22, v93
    v_add_f32 v24, v24, v94
    v_mov_b32 v88, v12
    v_mov_b32 v89, v14
    v_mfma_f32_16x16x32_bf16 a[164:167], v[132:135], v[108:111], a[164:167]
    v_mov_b32 v90, v16
    v_mov_b32 v91, v18
    v_mov_b32 v92, v20
    v_mov_b32 v93, v22
    v_mov_b32 v94, v24
    v_permlane32_swap_b32 v12, v88
    v_mfma_f32_16x16x32_bf16 a[192:195], v[136:139], v[108:111], a[192:195]
    v_permlane32_swap_b32 v14, v89
    v_permlane32_swap_b32 v16, v90
    v_permlane32_swap_b32 v18, v91
    v_permlane32_swap_b32 v20, v92
    v_permlane32_swap_b32 v22, v93
    v_permlane32_swap_b32 v24, v94
    v_mfma_f32_16x16x32_bf16 a[220:223], v[140:143], v[108:111], a[220:223]
    v_add_f32 v12, v12, v88
    v_add_f32 v14, v14, v89
    v_add_f32 v16, v16, v90
    v_add_f32 v18, v18, v91
    v_add_f32 v20, v20, v92
    v_add_f32 v22, v22, v93
    v_add_f32 v24, v24, v94
    v_rcp_f32 v28, v12
    v_rcp_f32 v32, v14
    v_rcp_f32 v36, v16
    v_rcp_f32 v40, v18
    v_rcp_f32 v44, v20
    v_rcp_f32 v48, v22
    v_rcp_f32 v52, v24
    v_add_f32 v90, v12, v14
    v_add_f32 v91, v16, v18
    v_add_f32 v92, v20, v22
    v_add_f32 v90, v90, v24
    v_add_f32 v91, v91, v92
    v_add_f32 v90, v90, v91
    v_cmp_nge_f32 vcc, s32, v90
    v_mov_b32 v12, 0xff800000
    v_mov_b32 v14, 0xff800000
    v_mov_b32 v16, 0xff800000
    v_mov_b32 v18, 0xff800000
    v_mov_b32 v20, 0xff800000
    v_mov_b32 v22, 0xff800000
    v_mov_b32 v24, 0xff800000
    s_cmp_eq_u64 vcc, 0
    s_cbranch_scc1 L_at_noflag
    s_lshl_b32 s29, s21, 2
    s_add_u32 s29, s29, 75996
    v_mov_b32 v90, s29
    v_mov_b32 v91, 1
    ds_write_b32 v90, v91
L_at_noflag:
    s_mul_i32 s31, s21, 114688
    s_add_u32 s31, s31, s24
    s_sub_u32 s31, s31, 114688
    v_pk_mul_f32 v[144:145], v[144:145], v[28:29] op_sel_hi:[1,0]
    v_pk_mul_f32 v[146:147], v[146:147], v[28:29] op_sel_hi:[1,0]
    v_pk_mul_f32 v[148:149], v[148:149], v[32:33] op_sel_hi:[1,0]
    v_pk_mul_f32 v[150:151], v[150:151], v[32:33] op_sel_hi:[1,0]
    v_pk_mul_f32 v[152:153], v[152:153], v[36:37] op_sel_hi:[1,0]
    v_pk_mul_f32 v[154:155], v[154:155], v[36:37] op_sel_hi:[1,0]
    v_pk_mul_f32 v[156:157], v[156:157], v[40:41] op_sel_hi:[1,0]
    v_pk_mul_f32 v[158:159], v[158:159], v[40:41] op_sel_hi:[1,0]
    v_pk_mul_f32 v[160:161], v[160:161], v[44:45] op_sel_hi:[1,0]
    v_pk_mul_f32 v[162:163], v[162:163], v[44:45] op_sel_hi:[1,0]
    v_pk_mul_f32 v[164:165], v[164:165], v[48:49] op_sel_hi:[1,0]
    v_pk_mul_f32 v[166:167], v[166:167], v[48:49] op_sel_hi:[1,0]
    v_pk_mul_f32 v[168:169], v[168:169], v[52:53] op_sel_hi:[1,0]
    v_pk_mul_f32 v[170:171], v[170:171], v[52:53] op_sel_hi:[1,0]
    v_pk_mul_f32 v[172:173], v[172:173], v[28:29] op_sel_hi:[1,0]
    v_pk_mul_f32 v[174:175], v[174:175], v[28:29] op_sel_hi:[1,0]
    v_pk_mul_f32 v[176:177], v[176:177], v[32:33] op_sel_hi:[1,0]
    v_pk_mul_f32 v[178:179], v[178:179], v[32:33] op_sel_hi:[1,0]
    v_pk_mul_f32 v[180:181], v[180:181], v[36:37] op_sel_hi:[1,0]
    v_pk_mul_f32 v[182:183], v[182:183], v[36:37] op_sel_hi:[1,0]
    v_pk_mul_f32 v[184:185], v[184:185], v[40:41] op_sel_hi:[1,0]
    v_pk_mul_f32 v[186:187], v[186:187], v[40:41] op_sel_hi:[1,0]
    v_pk_mul_f32 v[188:189], v[188:189], v[44:45] op_sel_hi:[1,0]
    v_pk_mul_f32 v[190:191], v[190:191], v[44:45] op_sel_hi:[1,0]
    v_pk_mul_f32 v[192:193], v[192:193], v[48:49] op_sel_hi:[1,0]
    v_pk_mul_f32 v[194:195], v[194:195], v[48:49] op_sel_hi:[1,0]
    v_pk_mul_f32 v[196:197], v[196:197], v[52:53] op_sel_hi:[1,0]
    v_pk_mul_f32 v[198:199], v[198:199], v[52:53] op_sel_hi:[1,0]
    v_cvt_pk_bf16_f32 v88, v144, v145
    v_cvt_pk_bf16_f32 v89, v146, v147
    v_cvt_pk_bf16_f32 v90, v172, v173
    v_cvt_pk_bf16_f32 v91, v174, v175
    v_cvt_pk_bf16_f32 v92, v148, v149
    v_cvt_pk_bf16_f32 v93, v150, v151
    v_cvt_pk_bf16_f32 v94, v176, v177
    v_cvt_pk_bf16_f32 v95, v178, v179
    v_cvt_pk_bf16_f32 v96, v152, v153
    v_cvt_pk_bf16_f32 v97, v154, v155
    v_cvt_pk_bf16_f32 v98, v180, v181
    v_cvt_pk_bf16_f32 v99, v182, v183
    v_cvt_pk_bf16_f32 v100, v156, v157
    v_cvt_pk_bf16_f32 v101, v158, v159
    v_cvt_pk_bf16_f32 v102, v184, v185
    v_cvt_pk_bf16_f32 v103, v186, v187
    v_cvt_pk_bf16_f32 v104, v160, v161
    v_cvt_pk_bf16_f32 v105, v162, v163
    v_cvt_pk_bf16_f32 v106, v188, v189
    v_cvt_pk_bf16_f32 v107, v190, v191
    v_cvt_pk_bf16_f32 v108, v164, v165
    v_cvt_pk_bf16_f32 v109, v166, v167
    v_cvt_pk_bf16_f32 v110, v192, v193
    v_cvt_pk_bf16_f32 v111, v194, v195
    v_cvt_pk_bf16_f32 v112, v168, v169
    v_cvt_pk_bf16_f32 v113, v170, v171
    v_cvt_pk_bf16_f32 v114, v196, v197
    v_cvt_pk_bf16_f32 v115, v198, v199
    s_nop 1
    v_permlane16_swap_b32 v88, v90
    v_permlane16_swap_b32 v89, v91
    v_permlane16_swap_b32 v92, v94
    v_permlane16_swap_b32 v93, v95
    v_permlane16_swap_b32 v96, v98
    v_permlane16_swap_b32 v97, v99
    v_permlane16_swap_b32 v100, v102
    v_permlane16_swap_b32 v101, v103
    v_permlane16_swap_b32 v104, v106
    v_permlane16_swap_b32 v105, v107
    v_permlane16_swap_b32 v108, v110
    v_permlane16_swap_b32 v109, v111
    v_permlane16_swap_b32 v112, v114
    v_permlane16_swap_b32 v113, v115
    s_mov_b32 s28, s31
    buffer_store_dwordx4 v[88:91], v10, s[12:15], s28 offen offset:0 sc0 sc1
    s_add_u32 s28, s28, 4096
    buffer_store_dwordx4 v[92:95], v10, s[12:15], s28 offen offset:0 sc0 sc1
    s_add_u32 s28, s28, 4096
    buffer_store_dwordx4 v[96:99], v10, s[12:15], s28 offen offset:0 sc0 sc1
    s_add_u32 s28, s28, 4096
    buffer_store_dwordx4 v[100:103], v10, s[12:15], s28 offen offset:0 sc0 sc1
    s_add_u32 s28, s28, 4096
    buffer_store_dwordx4 v[104:107], v10, s[12:15], s28 offen offset:0 sc0 sc1
    s_add_u32 s28, s28, 4096
    buffer_store_dwordx4 v[108:111], v10, s[12:15], s28 offen offset:0 sc0 sc1
    s_add_u32 s28, s28, 4096
    buffer_store_dwordx4 v[112:115], v10, s[12:15], s28 offen offset:0 sc0 sc1
    v_pk_mul_f32 v[200:201], v[200:201], v[28:29] op_sel_hi:[1,0]
    v_pk_mul_f32 v[202:203], v[202:203], v[28:29] op_sel_hi:[1,0]
    v_pk_mul_f32 v[204:205], v[204:205], v[32:33] op_sel_hi:[1,0]
    v_pk_mul_f32 v[206:207], v[206:207], v[32:33] op_sel_hi:[1,0]
    v_pk_mul_f32 v[208:209], v[208:209], v[36:37] op_sel_hi:[1,0]
    v_pk_mul_f32 v[210:211], v[210:211], v[36:37] op_sel_hi:[1,0]
    v_pk_mul_f32 v[212:213], v[212:213], v[40:41] op_sel_hi:[1,0]
    v_pk_mul_f32 v[214:215], v[214:215], v[40:41] op_sel_hi:[1,0]
    v_pk_mul_f32 v[216:217], v[216:217], v[44:45] op_sel_hi:[1,0]
    v_pk_mul_f32 v[218:219], v[218:219], v[44:45] op_sel_hi:[1,0]
    v_pk_mul_f32 v[220:221], v[220:221], v[48:49] op_sel_hi:[1,0]
    v_pk_mul_f32 v[222:223], v[222:223], v[48:49] op_sel_hi:[1,0]
    v_pk_mul_f32 v[224:225], v[224:225], v[52:53] op_sel_hi:[1,0]
    v_pk_mul_f32 v[226:227], v[226:227], v[52:53] op_sel_hi:[1,0]
    v_pk_mul_f32 v[228:229], v[228:229], v[28:29] op_sel_hi:[1,0]
    v_pk_mul_f32 v[230:231], v[230:231], v[28:29] op_sel_hi:[1,0]
    v_pk_mul_f32 v[232:233], v[232:233], v[32:33] op_sel_hi:[1,0]
    v_pk_mul_f32 v[234:235], v[234:235], v[32:33] op_sel_hi:[1,0]
    v_pk_mul_f32 v[236:237], v[236:237], v[36:37] op_sel_hi:[1,0]
    v_pk_mul_f32 v[238:239], v[238:239], v[36:37] op_sel_hi:[1,0]
    v_pk_mul_f32 v[240:241], v[240:241], v[40:41] op_sel_hi:[1,0]
    v_pk_mul_f32 v[242:243], v[242:243], v[40:41] op_sel_hi:[1,0]
    v_pk_mul_f32 v[244:245], v[244:245], v[44:45] op_sel_hi:[1,0]
    v_pk_mul_f32 v[246:247], v[246:247], v[44:45] op_sel_hi:[1,0]
    v_pk_mul_f32 v[248:249], v[248:249], v[48:49] op_sel_hi:[1,0]
    v_pk_mul_f32 v[250:251], v[250:251], v[48:49] op_sel_hi:[1,0]
    v_pk_mul_f32 v[252:253], v[252:253], v[52:53] op_sel_hi:[1,0]
    v_pk_mul_f32 v[254:255], v[254:255], v[52:53] op_sel_hi:[1,0]
    v_cvt_pk_bf16_f32 v116, v200, v201
    v_cvt_pk_bf16_f32 v117, v202, v203
    v_cvt_pk_bf16_f32 v118, v228, v229
    v_cvt_pk_bf16_f32 v119, v230, v231
    v_cvt_pk_bf16_f32 v120, v204, v205
    v_cvt_pk_bf16_f32 v121, v206, v207
    v_cvt_pk_bf16_f32 v122, v232, v233
    v_cvt_pk_bf16_f32 v123, v234, v235
    v_cvt_pk_bf16_f32 v124, v208, v209
    v_cvt_pk_bf16_f32 v125, v210, v211
    v_cvt_pk_bf16_f32 v126, v236, v237
    v_cvt_pk_bf16_f32 v127, v238, v239
    v_cvt_pk_bf16_f32 v128, v212, v213
    v_cvt_pk_bf16_f32 v129, v214, v215
    v_cvt_pk_bf16_f32 v130, v240, v241
    v_cvt_pk_bf16_f32 v131, v242, v243
    v_cvt_pk_bf16_f32 v132, v216, v217
    v_cvt_pk_bf16_f32 v133, v218, v219
    v_cvt_pk_bf16_f32 v134, v244, v245
    v_cvt_pk_bf16_f32 v135, v246, v247
    v_cvt_pk_bf16_f32 v136, v220, v221
    v_cvt_pk_bf16_f32 v137, v222, v223
    v_cvt_pk_bf16_f32 v138, v248, v249
    v_cvt_pk_bf16_f32 v139, v250, v251
    v_cvt_pk_bf16_f32 v140, v224, v225
    v_cvt_pk_bf16_f32 v141, v226, v227
    v_cvt_pk_bf16_f32 v142, v252, v253
    v_cvt_pk_bf16_f32 v143, v254, v255
    s_nop 1
    v_permlane16_swap_b32 v116, v118
    v_permlane16_swap_b32 v117, v119
    v_permlane16_swap_b32 v120, v122
    v_permlane16_swap_b32 v121, v123
    v_permlane16_swap_b32 v124, v126
    v_permlane16_swap_b32 v125, v127
    v_permlane16_swap_b32 v128, v130
    v_permlane16_swap_b32 v129, v131
    v_permlane16_swap_b32 v132, v134
    v_permlane16_swap_b32 v133, v135
    v_permlane16_swap_b32 v136, v138
    v_permlane16_swap_b32 v137, v139
    v_permlane16_swap_b32 v140, v142
    v_permlane16_swap_b32 v141, v143
    s_mov_b32 s28, s31
    buffer_store_dwordx4 v[116:119], v10, s[12:15], s28 offen offset:1024 sc0 sc1
    s_add_u32 s28, s28, 4096
    buffer_store_dwordx4 v[120:123], v10, s[12:15], s28 offen offset:1024 sc0 sc1
    s_add_u32 s28, s28, 4096
    buffer_store_dwordx4 v[124:127], v10, s[12:15], s28 offen offset:1024 sc0 sc1
    s_add_u32 s28, s28, 4096
    buffer_store_dwordx4 v[128:131], v10, s[12:15], s28 offen offset:1024 sc0 sc1
    s_add_u32 s28, s28, 4096
    buffer_store_dwordx4 v[132:135], v10, s[12:15], s28 offen offset:1024 sc0 sc1
    s_add_u32 s28, s28, 4096
    buffer_store_dwordx4 v[136:139], v10, s[12:15], s28 offen offset:1024 sc0 sc1
    s_add_u32 s28, s28, 4096
    buffer_store_dwordx4 v[140:143], v10, s[12:15], s28 offen offset:1024 sc0 sc1
    v_accvgpr_read_b32 v144, a112
    v_accvgpr_read_b32 v145, a113
    v_accvgpr_read_b32 v146, a114
    v_accvgpr_read_b32 v147, a115
    v_accvgpr_read_b32 v148, a116
    v_accvgpr_read_b32 v149, a117
    v_accvgpr_read_b32 v150, a118
    v_accvgpr_read_b32 v151, a119
    v_accvgpr_read_b32 v152, a120
    v_accvgpr_read_b32 v153, a121
    v_accvgpr_read_b32 v154, a122
    v_accvgpr_read_b32 v155, a123
    v_accvgpr_read_b32 v156, a124
    v_accvgpr_read_b32 v157, a125
    v_accvgpr_read_b32 v158, a126
    v_accvgpr_read_b32 v159, a127
    v_accvgpr_read_b32 v160, a128
    v_accvgpr_read_b32 v161, a129
    v_accvgpr_read_b32 v162, a130
    v_accvgpr_read_b32 v163, a131
    v_accvgpr_read_b32 v164, a132
    v_accvgpr_read_b32 v165, a133
    v_accvgpr_read_b32 v166, a134
    v_accvgpr_read_b32 v167, a135
    v_accvgpr_read_b32 v168, a136
    v_accvgpr_read_b32 v169, a137
    v_accvgpr_read_b32 v170, a138
    v_accvgpr_read_b32 v171, a139
    v_accvgpr_read_b32 v172, a140
    v_accvgpr_read_b32 v173, a141
    v_accvgpr_read_b32 v174, a142
    v_accvgpr_read_b32 v175, a143
    v_accvgpr_read_b32 v176, a144
    v_accvgpr_read_b32 v177, a145
    v_accvgpr_read_b32 v178, a146
    v_accvgpr_read_b32 v179, a147
    v_accvgpr_read_b32 v180, a148
    v_accvgpr_read_b32 v181, a149
    v_accvgpr_read_b32 v182, a150
    v_accvgpr_read_b32 v183, a151
    v_accvgpr_read_b32 v184, a152
    v_accvgpr_read_b32 v185, a153
    v_accvgpr_read_b32 v186, a154
    v_accvgpr_read_b32 v187, a155
    v_accvgpr_read_b32 v188, a156
    v_accvgpr_read_b32 v189, a157
    v_accvgpr_read_b32 v190, a158
    v_accvgpr_read_b32 v191, a159
    v_accvgpr_read_b32 v192, a160
    v_accvgpr_read_b32 v193, a161
    v_accvgpr_read_b32 v194, a162
    v_accvgpr_read_b32 v195, a163
    v_accvgpr_read_b32 v196, a164
    v_accvgpr_read_b32 v197, a165
    v_accvgpr_read_b32 v198, a166
    v_accvgpr_read_b32 v199, a167
    v_pk_mul_f32 v[144:145], v[144:145], v[28:29] op_sel_hi:[1,0]
    v_pk_mul_f32 v[146:147], v[146:147], v[28:29] op_sel_hi:[1,0]
    v_pk_mul_f32 v[148:149], v[148:149], v[32:33] op_sel_hi:[1,0]
    v_pk_mul_f32 v[150:151], v[150:151], v[32:33] op_sel_hi:[1,0]
    v_pk_mul_f32 v[152:153], v[152:153], v[36:37] op_sel_hi:[1,0]
    v_pk_mul_f32 v[154:155], v[154:155], v[36:37] op_sel_hi:[1,0]
    v_pk_mul_f32 v[156:157], v[156:157], v[40:41] op_sel_hi:[1,0]
    v_pk_mul_f32 v[158:159], v[158:159], v[40:41] op_sel_hi:[1,0]
    v_pk_mul_f32 v[160:161], v[160:161], v[44:45] op_sel_hi:[1,0]
    v_pk_mul_f32 v[162:163], v[162:163], v[44:45] op_sel_hi:[1,0]
    v_pk_mul_f32 v[164:165], v[164:165], v[48:49] op_sel_hi:[1,0]
    v_pk_mul_f32 v[166:167], v[166:167], v[48:49] op_sel_hi:[1,0]
    v_pk_mul_f32 v[168:169], v[168:169], v[52:53] op_sel_hi:[1,0]
    v_pk_mul_f32 v[170:171], v[170:171], v[52:53] op_sel_hi:[1,0]
    v_pk_mul_f32 v[172:173], v[172:173], v[28:29] op_sel_hi:[1,0]
    v_pk_mul_f32 v[174:175], v[174:175], v[28:29] op_sel_hi:[1,0]
    v_pk_mul_f32 v[176:177], v[176:177], v[32:33] op_sel_hi:[1,0]
    v_pk_mul_f32 v[178:179], v[178:179], v[32:33] op_sel_hi:[1,0]
    v_pk_mul_f32 v[180:181], v[180:181], v[36:37] op_sel_hi:[1,0]
    v_pk_mul_f32 v[182:183], v[182:183], v[36:37] op_sel_hi:[1,0]
    v_pk_mul_f32 v[184:185], v[184:185], v[40:41] op_sel_hi:[1,0]
    v_pk_mul_f32 v[186:187], v[186:187], v[40:41] op_sel_hi:[1,0]
    v_pk_mul_f32 v[188:189], v[188:189], v[44:45] op_sel_hi:[1,0]
    v_pk_mul_f32 v[190:191], v[190:191], v[44:45] op_sel_hi:[1,0]
    v_pk_mul_f32 v[192:193], v[192:193], v[48:49] op_sel_hi:[1,0]
    v_pk_mul_f32 v[194:195], v[194:195], v[48:49] op_sel_hi:[1,0]
    v_pk_mul_f32 v[196:197], v[196:197], v[52:53] op_sel_hi:[1,0]
    v_pk_mul_f32 v[198:199], v[198:199], v[52:53] op_sel_hi:[1,0]
    v_cvt_pk_bf16_f32 v88, v144, v145
    v_cvt_pk_bf16_f32 v89, v146, v147
    v_cvt_pk_bf16_f32 v90, v172, v173
    v_cvt_pk_bf16_f32 v91, v174, v175
    v_cvt_pk_bf16_f32 v92, v148, v149
    v_cvt_pk_bf16_f32 v93, v150, v151
    v_cvt_pk_bf16_f32 v94, v176, v177
    v_cvt_pk_bf16_f32 v95, v178, v179
    v_cvt_pk_bf16_f32 v96, v152, v153
    v_cvt_pk_bf16_f32 v97, v154, v155
    v_cvt_pk_bf16_f32 v98, v180, v181
    v_cvt_pk_bf16_f32 v99, v182, v183
    v_cvt_pk_bf16_f32 v100, v156, v157
    v_cvt_pk_bf16_f32 v101, v158, v159
    v_cvt_pk_bf16_f32 v102, v184, v185
    v_cvt_pk_bf16_f32 v103, v186, v187
    v_cvt_pk_bf16_f32 v104, v160, v161
    v_cvt_pk_bf16_f32 v105, v162, v163
    v_cvt_pk_bf16_f32 v106, v188, v189
    v_cvt_pk_bf16_f32 v107, v190, v191
    v_cvt_pk_bf16_f32 v108, v164, v165
    v_cvt_pk_bf16_f32 v109, v166, v167
    v_cvt_pk_bf16_f32 v110, v192, v193
    v_cvt_pk_bf16_f32 v111, v194, v195
    v_cvt_pk_bf16_f32 v112, v168, v169
    v_cvt_pk_bf16_f32 v113, v170, v171
    v_cvt_pk_bf16_f32 v114, v196, v197
    v_cvt_pk_bf16_f32 v115, v198, v199
    s_nop 1
    v_permlane16_swap_b32 v88, v90
    v_permlane16_swap_b32 v89, v91
    v_permlane16_swap_b32 v92, v94
    v_permlane16_swap_b32 v93, v95
    v_permlane16_swap_b32 v96, v98
    v_permlane16_swap_b32 v97, v99
    v_permlane16_swap_b32 v100, v102
    v_permlane16_swap_b32 v101, v103
    v_permlane16_swap_b32 v104, v106
    v_permlane16_swap_b32 v105, v107
    v_permlane16_swap_b32 v108, v110
    v_permlane16_swap_b32 v109, v111
    v_permlane16_swap_b32 v112, v114
    v_permlane16_swap_b32 v113, v115
    s_mov_b32 s28, s31
    buffer_store_dwordx4 v[88:91], v10, s[12:15], s28 offen offset:2048 sc0 sc1
    s_add_u32 s28, s28, 4096
    buffer_store_dwordx4 v[92:95], v10, s[12:15], s28 offen offset:2048 sc0 sc1
    s_add_u32 s28, s28, 4096
    buffer_store_dwordx4 v[96:99], v10, s[12:15], s28 offen offset:2048 sc0 sc1
    s_add_u32 s28, s28, 4096
    buffer_store_dwordx4 v[100:103], v10, s[12:15], s28 offen offset:2048 sc0 sc1
    s_add_u32 s28, s28, 4096
    buffer_store_dwordx4 v[104:107], v10, s[12:15], s28 offen offset:2048 sc0 sc1
    s_add_u32 s28, s28, 4096
    buffer_store_dwordx4 v[108:111], v10, s[12:15], s28 offen offset:2048 sc0 sc1
    s_add_u32 s28, s28, 4096
    buffer_store_dwordx4 v[112:115], v10, s[12:15], s28 offen offset:2048 sc0 sc1
    v_accvgpr_read_b32 v200, a168
    v_accvgpr_read_b32 v201, a169
    v_accvgpr_read_b32 v202, a170
    v_accvgpr_read_b32 v203, a171
    v_accvgpr_read_b32 v204, a172
    v_accvgpr_read_b32 v205, a173
    v_accvgpr_read_b32 v206, a174
    v_accvgpr_read_b32 v207, a175
    v_accvgpr_read_b32 v208, a176
    v_accvgpr_read_b32 v209, a177
    v_accvgpr_read_b32 v210, a178
    v_accvgpr_read_b32 v211, a179
    v_accvgpr_read_b32 v212, a180
    v_accvgpr_read_b32 v213, a181
    v_accvgpr_read_b32 v214, a182
    v_accvgpr_read_b32 v215, a183
    v_accvgpr_read_b32 v216, a184
    v_accvgpr_read_b32 v217, a185
    v_accvgpr_read_b32 v218, a186
    v_accvgpr_read_b32 v219, a187
    v_accvgpr_read_b32 v220, a188
    v_accvgpr_read_b32 v221, a189
    v_accvgpr_read_b32 v222, a190
    v_accvgpr_read_b32 v223, a191
    v_accvgpr_read_b32 v224, a192
    v_accvgpr_read_b32 v225, a193
    v_accvgpr_read_b32 v226, a194
    v_accvgpr_read_b32 v227, a195
    v_accvgpr_read_b32 v228, a196
    v_accvgpr_read_b32 v229, a197
    v_accvgpr_read_b32 v230, a198
    v_accvgpr_read_b32 v231, a199
    v_accvgpr_read_b32 v232, a200
    v_accvgpr_read_b32 v233, a201
    v_accvgpr_read_b32 v234, a202
    v_accvgpr_read_b32 v235, a203
    v_accvgpr_read_b32 v236, a204
    v_accvgpr_read_b32 v237, a205
    v_accvgpr_read_b32 v238, a206
    v_accvgpr_read_b32 v239, a207
    v_accvgpr_read_b32 v240, a208
    v_accvgpr_read_b32 v241, a209
    v_accvgpr_read_b32 v242, a210
    v_accvgpr_read_b32 v243, a211
    v_accvgpr_read_b32 v244, a212
    v_accvgpr_read_b32 v245, a213
    v_accvgpr_read_b32 v246, a214
    v_accvgpr_read_b32 v247, a215
    v_accvgpr_read_b32 v248, a216
    v_accvgpr_read_b32 v249, a217
    v_accvgpr_read_b32 v250, a218
    v_accvgpr_read_b32 v251, a219
    v_accvgpr_read_b32 v252, a220
    v_accvgpr_read_b32 v253, a221
    v_accvgpr_read_b32 v254, a222
    v_accvgpr_read_b32 v255, a223
    v_pk_mul_f32 v[200:201], v[200:201], v[28:29] op_sel_hi:[1,0]
    v_pk_mul_f32 v[202:203], v[202:203], v[28:29] op_sel_hi:[1,0]
    v_pk_mul_f32 v[204:205], v[204:205], v[32:33] op_sel_hi:[1,0]
    v_pk_mul_f32 v[206:207], v[206:207], v[32:33] op_sel_hi:[1,0]
    v_pk_mul_f32 v[208:209], v[208:209], v[36:37] op_sel_hi:[1,0]
    v_pk_mul_f32 v[210:211], v[210:211], v[36:37] op_sel_hi:[1,0]
    v_pk_mul_f32 v[212:213], v[212:213], v[40:41] op_sel_hi:[1,0]
    v_pk_mul_f32 v[214:215], v[214:215], v[40:41] op_sel_hi:[1,0]
    v_pk_mul_f32 v[216:217], v[216:217], v[44:45] op_sel_hi:[1,0]
    v_pk_mul_f32 v[218:219], v[218:219], v[44:45] op_sel_hi:[1,0]
    v_pk_mul_f32 v[220:221], v[220:221], v[48:49] op_sel_hi:[1,0]
    v_pk_mul_f32 v[222:223], v[222:223], v[48:49] op_sel_hi:[1,0]
    v_pk_mul_f32 v[224:225], v[224:225], v[52:53] op_sel_hi:[1,0]
    v_pk_mul_f32 v[226:227], v[226:227], v[52:53] op_sel_hi:[1,0]
    v_pk_mul_f32 v[228:229], v[228:229], v[28:29] op_sel_hi:[1,0]
    v_pk_mul_f32 v[230:231], v[230:231], v[28:29] op_sel_hi:[1,0]
    v_pk_mul_f32 v[232:233], v[232:233], v[32:33] op_sel_hi:[1,0]
    v_pk_mul_f32 v[234:235], v[234:235], v[32:33] op_sel_hi:[1,0]
    v_pk_mul_f32 v[236:237], v[236:237], v[36:37] op_sel_hi:[1,0]
    v_pk_mul_f32 v[238:239], v[238:239], v[36:37] op_sel_hi:[1,0]
    v_pk_mul_f32 v[240:241], v[240:241], v[40:41] op_sel_hi:[1,0]
    v_pk_mul_f32 v[242:243], v[242:243], v[40:41] op_sel_hi:[1,0]
    v_pk_mul_f32 v[244:245], v[244:245], v[44:45] op_sel_hi:[1,0]
    v_pk_mul_f32 v[246:247], v[246:247], v[44:45] op_sel_hi:[1,0]
    v_pk_mul_f32 v[248:249], v[248:249], v[48:49] op_sel_hi:[1,0]
    v_pk_mul_f32 v[250:251], v[250:251], v[48:49] op_sel_hi:[1,0]
    v_pk_mul_f32 v[252:253], v[252:253], v[52:53] op_sel_hi:[1,0]
    v_pk_mul_f32 v[254:255], v[254:255], v[52:53] op_sel_hi:[1,0]
    v_cvt_pk_bf16_f32 v116, v200, v201
    v_cvt_pk_bf16_f32 v117, v202, v203
    v_cvt_pk_bf16_f32 v118, v228, v229
    v_cvt_pk_bf16_f32 v119, v230, v231
    v_cvt_pk_bf16_f32 v120, v204, v205
    v_cvt_pk_bf16_f32 v121, v206, v207
    v_cvt_pk_bf16_f32 v122, v232, v233
    v_cvt_pk_bf16_f32 v123, v234, v235
    v_cvt_pk_bf16_f32 v124, v208, v209
    v_cvt_pk_bf16_f32 v125, v210, v211
    v_cvt_pk_bf16_f32 v126, v236, v237
    v_cvt_pk_bf16_f32 v127, v238, v239
    v_cvt_pk_bf16_f32 v128, v212, v213
    v_cvt_pk_bf16_f32 v129, v214, v215
    v_cvt_pk_bf16_f32 v130, v240, v241
    v_cvt_pk_bf16_f32 v131, v242, v243
    v_cvt_pk_bf16_f32 v132, v216, v217
    v_cvt_pk_bf16_f32 v133, v218, v219
    v_cvt_pk_bf16_f32 v134, v244, v245
    v_cvt_pk_bf16_f32 v135, v246, v247
    v_cvt_pk_bf16_f32 v136, v220, v221
    v_cvt_pk_bf16_f32 v137, v222, v223
    v_cvt_pk_bf16_f32 v138, v248, v249
    v_cvt_pk_bf16_f32 v139, v250, v251
    v_cvt_pk_bf16_f32 v140, v224, v225
    v_cvt_pk_bf16_f32 v141, v226, v227
    v_cvt_pk_bf16_f32 v142, v252, v253
    v_cvt_pk_bf16_f32 v143, v254, v255
    s_nop 1
    v_permlane16_swap_b32 v116, v118
    v_permlane16_swap_b32 v117, v119
    v_permlane16_swap_b32 v120, v122
    v_permlane16_swap_b32 v121, v123
    v_permlane16_swap_b32 v124, v126
    v_permlane16_swap_b32 v125, v127
    v_permlane16_swap_b32 v128, v130
    v_permlane16_swap_b32 v129, v131
    v_permlane16_swap_b32 v132, v134
    v_permlane16_swap_b32 v133, v135
    v_permlane16_swap_b32 v136, v138
    v_permlane16_swap_b32 v137, v139
    v_permlane16_swap_b32 v140, v142
    v_permlane16_swap_b32 v141, v143
    s_mov_b32 s28, s31
    buffer_store_dwordx4 v[116:119], v10, s[12:15], s28 offen offset:3072 sc0 sc1
    s_add_u32 s28, s28, 4096
    buffer_store_dwordx4 v[120:123], v10, s[12:15], s28 offen offset:3072 sc0 sc1
    s_add_u32 s28, s28, 4096
    buffer_store_dwordx4 v[124:127], v10, s[12:15], s28 offen offset:3072 sc0 sc1
    s_add_u32 s28, s28, 4096
    buffer_store_dwordx4 v[128:131], v10, s[12:15], s28 offen offset:3072 sc0 sc1
    s_add_u32 s28, s28, 4096
    buffer_store_dwordx4 v[132:135], v10, s[12:15], s28 offen offset:3072 sc0 sc1
    s_add_u32 s28, s28, 4096
    buffer_store_dwordx4 v[136:139], v10, s[12:15], s28 offen offset:3072 sc0 sc1
    s_add_u32 s28, s28, 4096
    buffer_store_dwordx4 v[140:143], v10, s[12:15], s28 offen offset:3072 sc0 sc1
    s_nop 1
L_at_nowo2:
    s_mov_b32 s68, 3
    s_cmp_ge_u32 s21, 2
    s_cbranch_scc1 L_at_fin
    s_cmp_eq_u32 s69, 0
    s_cbranch_scc1 L_at_round
    s_waitcnt vmcnt(28)
    s_branch L_at_pre
L_at_fin:
    s_waitcnt lgkmcnt(0)
    s_barrier
    s_cmp_le_u32 s21, s27
    s_cbranch_scc1 L_at_nofb_6989
    s_sub_u32 s28, s21, 1
    s_cmp_eq_u32 s28, s23
    s_cbranch_scc1 L_at_nofb_6989
    s_lshl_b32 s29, s28, 2
    s_add_u32 s29, s29, 76000
    v_mov_b32 v4, s29
    ds_read_b32 v4, v4
    s_waitcnt lgkmcnt(0)
    v_readfirstlane_b32 s29, v4
    s_nop 3
    s_cmp_lg_u32 s29, 0
    s_cbranch_scc1 L_at_fallback
L_at_nofb_6989:
    s_branch L_at_end
L_bw1_452:
    s_sub_u32 s68, s68, 1
    s_waitcnt vmcnt(44) lgkmcnt(0)
    s_branch L_bw2_452
L_bw1_575:
    s_sub_u32 s68, s68, 1
    s_waitcnt vmcnt(36) lgkmcnt(0)
    s_branch L_bw2_575
L_bw1_692:
    s_sub_u32 s68, s68, 1
    s_waitcnt vmcnt(44) lgkmcnt(0)
    s_branch L_bw2_692
L_bw1_3108:
    s_sub_u32 s68, s68, 1
    s_waitcnt vmcnt(44) lgkmcnt(0)
    s_branch L_bw2_3108
L_bw1_3490:
    s_sub_u32 s68, s68, 1
    s_waitcnt vmcnt(44) lgkmcnt(0)
    s_branch L_bw2_3490
L_bw1_3799:
    s_sub_u32 s68, s68, 1
    s_waitcnt vmcnt(44) lgkmcnt(0)
    s_branch L_bw2_3799
L_at_wt0:
    s_and_b32 s28, s2, 127
    s_mul_i32 s28, s28, 40960
    s_mul_i32 s29, s20, 10240
    s_add_u32 s28, s28, s29
    v_lshlrev_b32 v4, 7, v1
    v_and_b32 v5, 15, v1
    v_lshlrev_b32 v5, 7, v5
    buffer_load_dword a250, v4, s[84:87], s28 offen
    s_add_u32 s28, s28, 8192
    buffer_load_dword a251, v5, s[84:87], s28 offen
    s_branch L_at_wt0r
L_at_fallback:
    s_sub_u32 s27, s21, 1
    s_mov_b32 s23, s27
    s_mov_b32 s25, 1
    s_mov_b32 s69, 0
    s_mov_b32 s70, 0
    s_mov_b32 s68, 0
    v_mov_b32 v12, 0xff800000
    v_mov_b32 v14, 0xff800000
    v_mov_b32 v16, 0xff800000
    v_mov_b32 v18, 0xff800000
    v_mov_b32 v20, 0xff800000
    v_mov_b32 v22, 0xff800000
    v_mov_b32 v24, 0xff800000
    s_waitcnt vmcnt(0) lgkmcnt(0)
    s_barrier
    s_branch L_at_start
L_at_maxpass:
    s_mov_b32 s25, 0
    s_waitcnt lgkmcnt(0)
    v_and_b32 v2, 15, v1
    v_lshlrev_b32 v2, 8, v2
    v_bfe_u32 v3, v1, 4, 1
    v_lshl_add_u32 v2, v3, 5, v2
    v_bfe_u32 v3, v1, 5, 1
    v_lshl_add_u32 v4, v3, 4, v2
    v_add_u32 v5, 4096, v4
    s_lshl_b32 s29, s21, 19
    s_mov_b32 s22, 0
L_at_mp:
    buffer_load_dwordx4 v[112:115], v4, s[8:11], s29 offen offset:0
    buffer_load_dwordx4 v[116:119], v4, s[8:11], s29 offen offset:64
    buffer_load_dwordx4 v[120:123], v4, s[8:11], s29 offen offset:128
    buffer_load_dwordx4 v[124:127], v4, s[8:11], s29 offen offset:192
    buffer_load_dwordx4 v[128:131], v5, s[8:11], s29 offen offset:0
    buffer_load_dwordx4 v[132:135], v5, s[8:11], s29 offen offset:64
    buffer_load_dwordx4 v[136:139], v5, s[8:11], s29 offen offset:128
    buffer_load_dwordx4 v[140:143], v5, s[8:11], s29 offen offset:192
    s_waitcnt vmcnt(0)
    v_mfma_f32_16x16x32_bf16 v[88:91], v[112:115], a[0:3], 0
    v_mfma_f32_16x16x32_bf16 v[88:91], v[116:119], a[4:7], v[88:91]
    v_mfma_f32_16x16x32_bf16 v[88:91], v[120:123], a[8:11], v[88:91]
    v_mfma_f32_16x16x32_bf16 v[88:91], v[124:127], a[12:15], v[88:91]
    v_mfma_f32_16x16x32_bf16 v[92:95], v[128:131], a[0:3], 0
    v_mfma_f32_16x16x32_bf16 v[92:95], v[132:135], a[4:7], v[92:95]
    v_mfma_f32_16x16x32_bf16 v[92:95], v[136:139], a[8:11], v[92:95]
    v_mfma_f32_16x16x32_bf16 v[92:95], v[140:143], a[12:15], v[92:95]
    s_nop 9
    v_max3_f32 v12, v88, v89, v12
    v_max3_f32 v12, v90, v91, v12
    v_max3_f32 v12, v92, v93, v12
    v_max3_f32 v12, v94, v95, v12
    s_nop 3
    v_mfma_f32_16x16x32_bf16 v[88:91], v[112:115], a[16:19], 0
    v_mfma_f32_16x16x32_bf16 v[88:91], v[116:119], a[20:23], v[88:91]
    v_mfma_f32_16x16x32_bf16 v[88:91], v[120:123], a[24:27], v[88:91]
    v_mfma_f32_16x16x32_bf16 v[88:91], v[124:127], a[28:31], v[88:91]
    v_mfma_f32_16x16x32_bf16 v[92:95], v[128:131], a[16:19], 0
    v_mfma_f32_16x16x32_bf16 v[92:95], v[132:135], a[20:23], v[92:95]
    v_mfma_f32_16x16x32_bf16 v[92:95], v[136:139], a[24:27], v[92:95]
    v_mfma_f32_16x16x32_bf16 v[92:95], v[140:143], a[28:31], v[92:95]
    s_nop 9
    v_max3_f32 v14, v88, v89, v14
    v_max3_f32 v14, v90, v91, v14
    v_max3_f32 v14, v92, v93, v14
    v_max3_f32 v14, v94, v95, v14
    s_nop 3
    v_mfma_f32_16x16x32_bf16 v[88:91], v[112:115], a[32:35], 0
    v_mfma_f32_16x16x32_bf16 v[88:91], v[116:119], a[36:39], v[88:91]
    v_mfma_f32_16x16x32_bf16 v[88:91], v[120:123], a[40:43], v[88:91]
    v_mfma_f32_16x16x32_bf16 v[88:91], v[124:127], a[44:47], v[88:91]
    v_mfma_f32_16x16x32_bf16 v[92:95], v[128:131], a[32:35], 0
    v_mfma_f32_16x16x32_bf16 v[92:95], v[132:135], a[36:39], v[92:95]
    v_mfma_f32_16x16x32_bf16 v[92:95], v[136:139], a[40:43], v[92:95]
    v_mfma_f32_16x16x32_bf16 v[92:95], v[140:143], a[44:47], v[92:95]
    s_nop 9
    v_max3_f32 v16, v88, v89, v16
    v_max3_f32 v16, v90, v91, v16
    v_max3_f32 v16, v92, v93, v16
    v_max3_f32 v16, v94, v95, v16
    s_nop 3
    v_mfma_f32_16x16x32_bf16 v[88:91], v[112:115], a[48:51], 0
    v_mfma_f32_16x16x32_bf16 v[88:91], v[116:119], a[52:55], v[88:91]
    v_mfma_f32_16x16x32_bf16 v[88:91], v[120:123], a[56:59], v[88:91]
    v_mfma_f32_16x16x32_bf16 v[88:91], v[124:127], a[60:63], v[88:91]
    v_mfma_f32_16x16x32_bf16 v[92:95], v[128:131], a[48:51], 0
    v_mfma_f32_16x16x32_bf16 v[92:95], v[132:135], a[52:55], v[92:95]
    v_mfma_f32_16x16x32_bf16 v[92:95], v[136:139], a[56:59], v[92:95]
    v_mfma_f32_16x16x32_bf16 v[92:95], v[140:143], a[60:63], v[92:95]
    s_nop 9
    v_max3_f32 v18, v88, v89, v18
    v_max3_f32 v18, v90, v91, v18
    v_max3_f32 v18, v92, v93, v18
    v_max3_f32 v18, v94, v95, v18
    s_nop 3
    v_mfma_f32_16x16x32_bf16 v[88:91], v[112:115], a[64:67], 0
    v_mfma_f32_16x16x32_bf16 v[88:91], v[116:119], a[68:71], v[88:91]
    v_mfma_f32_16x16x32_bf16 v[88:91], v[120:123], a[72:75], v[88:91]
    v_mfma_f32_16x16x32_bf16 v[88:91], v[124:127], a[76:79], v[88:91]
    v_mfma_f32_16x16x32_bf16 v[92:95], v[128:131], a[64:67], 0
    v_mfma_f32_16x16x32_bf16 v[92:95], v[132:135], a[68:71], v[92:95]
    v_mfma_f32_16x16x32_bf16 v[92:95], v[136:139], a[72:75], v[92:95]
    v_mfma_f32_16x16x32_bf16 v[92:95], v[140:143], a[76:79], v[92:95]
    s_nop 9
    v_max3_f32 v20, v88, v89, v20
    v_max3_f32 v20, v90, v91, v20
    v_max3_f32 v20, v92, v93, v20
    v_max3_f32 v20, v94, v95, v20
    s_nop 3
    v_mfma_f32_16x16x32_bf16 v[88:91], v[112:115], a[80:83], 0
    v_mfma_f32_16x16x32_bf16 v[88:91], v[116:119], a[84:87], v[88:91]
    v_mfma_f32_16x16x32_bf16 v[88:91], v[120:123], a[88:91], v[88:91]
    v_mfma_f32_16x16x32_bf16 v[88:91], v[124:127], a[92:95], v[88:91]
    v_mfma_f32_16x16x32_bf16 v[92:95], v[128:131], a[80:83], 0
    v_mfma_f32_16x16x32_bf16 v[92:95], v[132:135], a[84:87], v[92:95]
    v_mfma_f32_16x16x32_bf16 v[92:95], v[136:139], a[88:91], v[92:95]
    v_mfma_f32_16x16x32_bf16 v[92:95], v[140:143], a[92:95], v[92:95]
    s_nop 9
    v_max3_f32 v22, v88, v89, v22
    v_max3_f32 v22, v90, v91, v22
    v_max3_f32 v22, v92, v93, v22
    v_max3_f32 v22, v94, v95, v22
    s_nop 3
    v_mfma_f32_16x16x32_bf16 v[88:91], v[112:115], a[96:99], 0
    v_mfma_f32_16x16x32_bf16 v[88:91], v[116:119], a[100:103], v[88:91]
    v_mfma_f32_16x16x32_bf16 v[88:91], v[120:123], a[104:107], v[88:91]
    v_mfma_f32_16x16x32_bf16 v[88:91], v[124:127], a[108:111], v[88:91]
    v_mfma_f32_16x16x32_bf16 v[92:95], v[128:131], a[96:99], 0
    v_mfma_f32_16x16x32_bf16 v[92:95], v[132:135], a[100:103], v[92:95]
    v_mfma_f32_16x16x32_bf16 v[92:95], v[136:139], a[104:107], v[92:95]
    v_mfma_f32_16x16x32_bf16 v[92:95], v[140:143], a[108:111], v[92:95]
    s_nop 9
    v_max3_f32 v24, v88, v89, v24
    v_max3_f32 v24, v90, v91, v24
    v_max3_f32 v24, v92, v93, v24
    v_max3_f32 v24, v94, v95, v24
    s_nop 3
    s_add_u32 s29, s29, 8192
    s_add_u32 s22, s22, 1
    s_cmp_lt_u32 s22, 32
    s_cbranch_scc1 L_at_mp
    s_branch L_at_pre
L_at_end:
    s_endpgm
.globl op_kernel
.p2align 8
.type op_kernel,@function
op_kernel:
    s_cmp_ge_u32 s2, 256
    s_cbranch_scc1 L_op_end
    s_and_b32 s3, s2, 7
    s_lshl_b32 s3, s3, 5
    s_lshr_b32 s30, s2, 3
    s_add_u32 s3, s3, s30
    s_cmp_ge_u32 s3, 250
    s_cbranch_scc1 L_op_end
    s_load_dwordx2 s[36:37], s[0:1], 32
    s_load_dwordx2 s[38:39], s[0:1], 72
    s_load_dwordx2 s[40:41], s[0:1], 80
    s_load_dwordx2 s[44:45], s[0:1], 96
    v_and_b32 v1, 63, v0
    v_lshrrev_b32 v2, 6, v0
    s_nop 0
    v_readfirstlane_b32 s20, v2
    s_mul_i32 s28, s3, 13108
    s_lshr_b32 s28, s28, 16
    s_mul_i32 s22, s28, 5
    s_sub_u32 s29, s3, s22
    s_mov_b32 s61, s28
    s_cmp_ge_u32 s28, 25
    s_cselect_b32 s30, 1, 0
    s_cselect_b32 s22, 25, 0
    s_sub_u32 s28, s28, s22
    s_mul_i32 s31, s28, 9
    s_lshl_b32 s24, s20, 10
    s_add_u32 s24, s24, 58720256
    s_mul_i32 s23, s30, 29360128
    s_add_u32 s24, s24, s23
    s_cmp_lt_u32 s20, 2
    s_cselect_b32 s58, 5, 0
    s_add_u32 s22, s31, 0
    s_add_u32 s22, s22, s58
    s_mul_i32 s23, s22, 4682
    s_lshr_b32 s23, s23, 16
    s_mul_i32 s62, s23, 1777664
    s_lshl_b32 s48, s22, 12
    s_add_u32 s48, s48, s62
    s_add_u32 s48, s48, s24
    s_add_u32 s22, s31, 1
    s_add_u32 s22, s22, s58
    s_mul_i32 s23, s22, 4682
    s_lshr_b32 s23, s23, 16
    s_mul_i32 s62, s23, 1777664
    s_lshl_b32 s49, s22, 12
    s_add_u32 s49, s49, s62
    s_add_u32 s49, s49, s24
    s_add_u32 s22, s31, 2
    s_add_u32 s22, s22, s58
    s_mul_i32 s23, s22, 4682
    s_lshr_b32 s23, s23, 16
    s_mul_i32 s62, s23, 1777664
    s_lshl_b32 s50, s22, 12
    s_add_u32 s50, s50, s62
    s_add_u32 s50, s50, s24
    s_add_u32 s22, s31, 3
    s_add_u32 s22, s22, s58
    s_mul_i32 s23, s22, 4682
    s_lshr_b32 s23, s23, 16
    s_mul_i32 s62, s23, 1777664
    s_lshl_b32 s51, s22, 12
    s_add_u32 s51, s51, s62
    s_add_u32 s51, s51, s24
    s_cmp_ge_u32 s22, 224
    s_cselect_b32 s62, 0x40000000, 0
    s_add_u32 s51, s51, s62
    s_add_u32 s22, s31, 4
    s_mul_i32 s23, s22, 4682
    s_lshr_b32 s23, s23, 16
    s_mul_i32 s62, s23, 1777664
    s_lshl_b32 s52, s22, 12
    s_add_u32 s52, s52, s62
    s_add_u32 s52, s52, s24
    s_add_u32 s22, s31, 5
    s_sub_u32 s22, s22, s58
    s_mul_i32 s23, s22, 4682
    s_lshr_b32 s23, s23, 16
    s_mul_i32 s62, s23, 1777664
    s_lshl_b32 s53, s22, 12
    s_add_u32 s53, s53, s62
    s_add_u32 s53, s53, s24
    s_add_u32 s22, s31, 6
    s_sub_u32 s22, s22, s58
    s_mul_i32 s23, s22, 4682
    s_lshr_b32 s23, s23, 16
    s_mul_i32 s62, s23, 1777664
    s_lshl_b32 s54, s22, 12
    s_add_u32 s54, s54, s62
    s_add_u32 s54, s54, s24
    s_add_u32 s22, s31, 7
    s_sub_u32 s22, s22, s58
    s_mul_i32 s23, s22, 4682
    s_lshr_b32 s23, s23, 16
    s_mul_i32 s62, s23, 1777664
    s_lshl_b32 s55, s22, 12
    s_add_u32 s55, s55, s62
    s_add_u32 s55, s55, s24
    s_add_u32 s22, s31, 8
    s_sub_u32 s22, s22, s58
    s_mul_i32 s23, s22, 4682
    s_lshr_b32 s23, s23, 16
    s_mul_i32 s62, s23, 1777664
    s_lshl_b32 s56, s22, 12
    s_add_u32 s56, s56, s62
    s_add_u32 s56, s56, s24
    s_cmp_ge_u32 s22, 224
    s_cselect_b32 s62, 0x40000000, 0
    s_add_u32 s56, s56, s62
    v_lshlrev_b32 v6, 4, v1
    v_lshrrev_b32 v2, 4, v1
    v_and_b32 v3, 15, v1
    v_lshlrev_b32 v4, 1, v2
    v_xor_b32 v3, v3, v4
    v_lshlrev_b32 v3, 4, v3
    v_mul_u32_u24 v4, 1280, v2
    v_add_u32 v5, v4, v3
    v_xor_b32 v3, 128, v3
    v_add_u32 v4, v4, v3
    v_add_u32 v10, 0, v5
    v_add_u32 v11, 4096, v5
    v_add_u32 v12, 8192, v4
    v_add_u32 v13, 12288, v4
    v_add_u32 v14, 20480, v5
    v_add_u32 v15, 24576, v5
    v_add_u32 v16, 28672, v4
    v_add_u32 v17, 32768, v4
    s_mul_i32 s27, s20, 40960
    s_waitcnt lgkmcnt(0)
    s_cmp_lg_u32 s30, 0
    s_cselect_b32 s8, s38, s36
    s_cselect_b32 s9, s39, s37
    s_mov_b32 s10, 5242880
    s_mov_b32 s11, 0x20000
    s_mov_b32 s4, s44
    s_mov_b32 s5, s45
    s_mov_b32 s6, 127926272
    s_mov_b32 s7, 0x20000
    s_mov_b32 s12, s40
    s_mov_b32 s13, s41
    s_mov_b32 s14, 9175040
    s_mov_b32 s15, 0x20000
    s_mul_i32 s22, s20, 40960
    s_lshl_b32 s23, s29, 8
    s_add_u32 s26, s22, s23
    s_mov_b32 s25, 0
    v_add_u32 v7, s25, v6
    s_add_u32 m0, s27, 0
    s_nop 0
    buffer_load_dwordx4 v10, s[8:11], s26 offen offset:0 lds
    buffer_load_dwordx4 v11, s[8:11], s26 offen offset:1024 lds
    buffer_load_dwordx4 v12, s[8:11], s26 offen offset:2048 lds
    buffer_load_dwordx4 v13, s[8:11], s26 offen offset:3072 lds
    s_add_u32 m0, s27, 4096
    s_nop 0
    buffer_load_dwordx4 v14, s[8:11], s26 offen offset:0 lds
    buffer_load_dwordx4 v15, s[8:11], s26 offen offset:1024 lds
    buffer_load_dwordx4 v16, s[8:11], s26 offen offset:2048 lds
    buffer_load_dwordx4 v17, s[8:11], s26 offen offset:3072 lds
    s_add_u32 s26, s26, 163840
    buffer_load_dwordx4 v[92:95], v7, s[4:7], s48 offen
    buffer_load_dwordx4 v[96:99], v7, s[4:7], s49 offen
    buffer_load_dwordx4 v[100:103], v7, s[4:7], s50 offen
    buffer_load_dwordx4 v[104:107], v7, s[4:7], s51 offen
    buffer_load_dwordx4 v[108:111], v7, s[4:7], s52 offen
    buffer_load_dwordx4 v[112:115], v7, s[4:7], s53 offen
    buffer_load_dwordx4 v[116:119], v7, s[4:7], s54 offen
    buffer_load_dwordx4 v[120:123], v7, s[4:7], s55 offen
    buffer_load_dwordx4 v[124:127], v7, s[4:7], s56 offen
    v_add_u32 v7, 57344, v7
    s_add_u32 m0, s27, 8192
    s_nop 0
    buffer_load_dwordx4 v10, s[8:11], s26 offen offset:0 lds
    buffer_load_dwordx4 v11, s[8:11], s26 offen offset:1024 lds
    buffer_load_dwordx4 v12, s[8:11], s26 offen offset:2048 lds
    buffer_load_dwordx4 v13, s[8:11], s26 offen offset:3072 lds
    s_add_u32 m0, s27, 12288
    s_nop 0
    buffer_load_dwordx4 v14, s[8:11], s26 offen offset:0 lds
    buffer_load_dwordx4 v15, s[8:11], s26 offen offset:1024 lds
    buffer_load_dwordx4 v16, s[8:11], s26 offen offset:2048 lds
    buffer_load_dwordx4 v17, s[8:11], s26 offen offset:3072 lds
    s_add_u32 s26, s26, 163840
    v_lshrrev_b32 v2, 4, v1
    v_bfe_u32 v3, v1, 2, 2
    v_lshl_add_u32 v4, v2, 3, v3
    v_lshlrev_b32 v4, 8, v4
    v_and_b32 v2, 1, v2
    v_lshl_add_u32 v3, v2, 2, v3
    v_lshl_add_u32 v4, v3, 5, v4
    v_and_b32 v3, 3, v1
    v_lshl_add_u32 v4, v3, 3, v4
    v_add_u32 v4, s27, v4
    s_and_b32 s62, s20, 1
    s_lshl_b32 s62, s62, 1
    s_lshr_b32 s59, s20, 1
    s_add_u32 s59, s59, s62
    s_lshl_b32 s59, s59, 6
    s_xor_b32 s62, s59, 192
    v_xor_b32 v18, s62, v4
    s_xor_b32 s62, s59, 224
    v_xor_b32 v19, s62, v4
    s_xor_b32 s62, s59, 128
    v_xor_b32 v20, s62, v4
    s_xor_b32 s62, s59, 160
    v_xor_b32 v21, s62, v4
    s_xor_b32 s62, s59, 64
    v_xor_b32 v22, s62, v4
    s_xor_b32 s62, s59, 96
    v_xor_b32 v23, s62, v4
    s_xor_b32 s62, s59, 0
    v_xor_b32 v24, s62, v4
    s_xor_b32 s62, s59, 32
    v_xor_b32 v25, s62, v4
    v_add_u32 v8, s27, v6
    v_bfe_u32 v4, v1, 4, 1
    v_lshlrev_b32 v4, 5, v4
    v_and_b32 v2, 15, v1
    v_mul_u32_u24 v2, 2560, v2
    v_add_u32 v2, v2, v4
    v_bfe_u32 v4, v1, 5, 1
    v_lshl_add_u32 v9, v4, 4, v2
    s_xor_b32 s22, s20, 3
    s_mul_i32 s22, s22, 40960
    v_add_u32 v2, s22, v6
    s_xor_b32 s22, s20, 1
    s_mul_i32 s22, s22, 40960
    v_add_u32 v3, s22, v6
    s_xor_b32 s22, s20, 2
    s_mul_i32 s22, s22, 40960
    v_add_u32 v4, s22, v6
    v_and_b32 v26, 7, v1
    v_mul_u32_u24 v26, 2560, v26
    v_bfe_u32 v27, v1, 3, 1
    s_lshr_b32 s22, s20, 1
    s_xor_b32 s22, s22, 1
    v_xor_b32 v27, s22, v27
    v_lshl_add_u32 v26, v27, 6, v26
    v_bfe_u32 v27, v1, 4, 1
    v_lshl_add_u32 v26, v27, 5, v26
    v_bfe_u32 v27, v1, 5, 1
    v_lshl_add_u32 v26, v27, 4, v26
    v_xor_b32 v27, 64, v26
    v_add_u32 v27, 20480, v27
    s_mov_b32 s64, 0x00ff00ff
    s_mov_b32 s65, 0x00ff00ff
    s_mov_b32 s66, 0xff00ff00
    s_mov_b32 s67, 0xff00ff00
    s_mul_i32 s22, s28, 368640
    s_mul_i32 s23, s30, 1280
    s_add_u32 s22, s22, s23
    s_lshl_b32 s23, s29, 8
    s_add_u32 s24, s22, s23
    s_waitcnt vmcnt(17)
    ds_read_b64_tr_b16 v[60:61], v18 offset:0
    ds_read_b64_tr_b16 v[62:63], v18 offset:1024
    ds_read_b64_tr_b16 v[64:65], v19 offset:0
    ds_read_b64_tr_b16 v[66:67], v19 offset:1024
    ds_read_b64_tr_b16 v[68:69], v20 offset:0
    ds_read_b64_tr_b16 v[70:71], v20 offset:1024
    ds_read_b64_tr_b16 v[72:73], v21 offset:0
    ds_read_b64_tr_b16 v[74:75], v21 offset:1024
    ds_read_b64_tr_b16 v[76:77], v22 offset:0
    ds_read_b64_tr_b16 v[78:79], v22 offset:1024
    ds_read_b64_tr_b16 v[80:81], v23 offset:0
    ds_read_b64_tr_b16 v[82:83], v23 offset:1024
    ds_read_b64_tr_b16 v[84:85], v24 offset:0
    ds_read_b64_tr_b16 v[86:87], v24 offset:1024
    ds_read_b64_tr_b16 v[88:89], v25 offset:0
    ds_read_b64_tr_b16 v[90:91], v25 offset:1024
    s_waitcnt vmcnt(0) lgkmcnt(12)
    v_mfma_f32_16x16x32_bf16 a[0:3], v[60:63], v[92:95], 0
    buffer_load_dwordx4 v[128:131], v7, s[4:7], s48 offen
    v_mfma_f32_16x16x32_bf16 a[4:7], v[60:63], v[96:99], 0
    buffer_load_dwordx4 v[132:135], v7, s[4:7], s49 offen
    v_mfma_f32_16x16x32_bf16 a[8:11], v[60:63], v[100:103], 0
    buffer_load_dwordx4 v[136:139], v7, s[4:7], s50 offen
    v_mfma_f32_16x16x32_bf16 a[12:15], v[60:63], v[104:107], 0
    buffer_load_dwordx4 v[140:143], v7, s[4:7], s51 offen
    v_mfma_f32_16x16x32_bf16 a[16:19], v[60:63], v[108:111], 0
    buffer_load_dwordx4 v[144:147], v7, s[4:7], s52 offen
    v_mfma_f32_16x16x32_bf16 a[20:23], v[60:63], v[112:115], 0
    buffer_load_dwordx4 v[148:151], v7, s[4:7], s53 offen
    v_mfma_f32_16x16x32_bf16 a[24:27], v[60:63], v[116:119], 0
    buffer_load_dwordx4 v[152:155], v7, s[4:7], s54 offen
    v_mfma_f32_16x16x32_bf16 a[28:31], v[60:63], v[120:123], 0
    buffer_load_dwordx4 v[156:159], v7, s[4:7], s55 offen
    v_mfma_f32_16x16x32_bf16 a[32:35], v[60:63], v[124:127], 0
    ds_read_b64_tr_b16 v[60:61], v18 offset:8192
    ds_read_b64_tr_b16 v[62:63], v18 offset:9216
    v_mfma_f32_16x16x32_bf16 a[36:39], v[64:67], v[92:95], 0
    buffer_load_dwordx4 v[160:163], v7, s[4:7], s56 offen
    v_mfma_f32_16x16x32_bf16 a[40:43], v[64:67], v[96:99], 0
    v_add_u32 v7, 57344, v7
    v_mfma_f32_16x16x32_bf16 a[44:47], v[64:67], v[100:103], 0
    s_add_u32 m0, s27, 16384
    v_mfma_f32_16x16x32_bf16 a[48:51], v[64:67], v[104:107], 0
    s_nop 0
    v_mfma_f32_16x16x32_bf16 a[52:55], v[64:67], v[108:111], 0
    buffer_load_dwordx4 v10, s[8:11], s26 offen offset:0 lds
    v_mfma_f32_16x16x32_bf16 a[56:59], v[64:67], v[112:115], 0
    buffer_load_dwordx4 v11, s[8:11], s26 offen offset:1024 lds
    v_mfma_f32_16x16x32_bf16 a[60:63], v[64:67], v[116:119], 0
    buffer_load_dwordx4 v12, s[8:11], s26 offen offset:2048 lds
    v_mfma_f32_16x16x32_bf16 a[64:67], v[64:67], v[120:123], 0
    buffer_load_dwordx4 v13, s[8:11], s26 offen offset:3072 lds
    v_mfma_f32_16x16x32_bf16 a[68:71], v[64:67], v[124:127], 0
    ds_read_b64_tr_b16 v[64:65], v19 offset:8192
    ds_read_b64_tr_b16 v[66:67], v19 offset:9216
    s_waitcnt lgkmcnt(4)
    v_mfma_f32_16x16x32_bf16 a[72:75], v[68:71], v[92:95], 0
    s_add_u32 m0, s27, 20480
    v_mfma_f32_16x16x32_bf16 a[76:79], v[68:71], v[96:99], 0
    s_nop 0
    v_mfma_f32_16x16x32_bf16 a[80:83], v[68:71], v[100:103], 0
    buffer_load_dwordx4 v14, s[8:11], s26 offen offset:0 lds
    v_mfma_f32_16x16x32_bf16 a[84:87], v[68:71], v[104:107], 0
    buffer_load_dwordx4 v15, s[8:11], s26 offen offset:1024 lds
    v_mfma_f32_16x16x32_bf16 a[88:91], v[68:71], v[108:111], 0
    buffer_load_dwordx4 v16, s[8:11], s26 offen offset:2048 lds
    v_mfma_f32_16x16x32_bf16 a[92:95], v[68:71], v[112:115], 0
    buffer_load_dwordx4 v17, s[8:11], s26 offen offset:3072 lds
    v_mfma_f32_16x16x32_bf16 a[96:99], v[68:71], v[116:119], 0
    s_add_u32 s26, s26, 163840
    v_mfma_f32_16x16x32_bf16 a[100:103], v[68:71], v[120:123], 0
    s_add_u32 m0, s27, 24576
    v_mfma_f32_16x16x32_bf16 a[104:107], v[68:71], v[124:127], 0
    ds_read_b64_tr_b16 v[68:69], v20 offset:8192
    ds_read_b64_tr_b16 v[70:71], v20 offset:9216
    v_mfma_f32_16x16x32_bf16 a[108:111], v[72:75], v[92:95], 0
    s_nop 0
    v_mfma_f32_16x16x32_bf16 a[112:115], v[72:75], v[96:99], 0
    buffer_load_dwordx4 v10, s[8:11], s26 offen offset:0 lds
    v_mfma_f32_16x16x32_bf16 a[116:119], v[72:75], v[100:103], 0
    buffer_load_dwordx4 v11, s[8:11], s26 offen offset:1024 lds
    v_mfma_f32_16x16x32_bf16 a[120:123], v[72:75], v[104:107], 0
    buffer_load_dwordx4 v12, s[8:11], s26 offen offset:2048 lds
    v_mfma_f32_16x16x32_bf16 a[124:127], v[72:75], v[108:111], 0
    buffer_load_dwordx4 v13, s[8:11], s26 offen offset:3072 lds
    v_mfma_f32_16x16x32_bf16 a[128:131], v[72:75], v[112:115], 0
    s_add_u32 m0, s27, 28672
    v_mfma_f32_16x16x32_bf16 a[132:135], v[72:75], v[116:119], 0
    s_nop 0
    v_mfma_f32_16x16x32_bf16 a[136:139], v[72:75], v[120:123], 0
    buffer_load_dwordx4 v14, s[8:11], s26 offen offset:0 lds
    v_mfma_f32_16x16x32_bf16 a[140:143], v[72:75], v[124:127], 0
    ds_read_b64_tr_b16 v[72:73], v21 offset:8192
    ds_read_b64_tr_b16 v[74:75], v21 offset:9216
    v_mfma_f32_16x16x32_bf16 a[144:147], v[76:79], v[92:95], 0
    buffer_load_dwordx4 v15, s[8:11], s26 offen offset:1024 lds
    v_mfma_f32_16x16x32_bf16 a[148:151], v[76:79], v[96:99], 0
    buffer_load_dwordx4 v16, s[8:11], s26 offen offset:2048 lds
    v_mfma_f32_16x16x32_bf16 a[152:155], v[76:79], v[100:103], 0
    buffer_load_dwordx4 v17, s[8:11], s26 offen offset:3072 lds
    v_mfma_f32_16x16x32_bf16 a[156:159], v[76:79], v[104:107], 0
    s_add_u32 s26, s26, 163840
    v_mfma_f32_16x16x32_bf16 a[160:163], v[76:79], v[108:111], 0
    buffer_load_dwordx4 v[164:167], v7, s[4:7], s48 offen
    v_mfma_f32_16x16x32_bf16 a[164:167], v[76:79], v[112:115], 0
    buffer_load_dwordx4 v[168:171], v7, s[4:7], s49 offen
    v_mfma_f32_16x16x32_bf16 a[168:171], v[76:79], v[116:119], 0
    buffer_load_dwordx4 v[172:175], v7, s[4:7], s50 offen
    v_mfma_f32_16x16x32_bf16 v[36:39], v[76:79], v[120:123], 0
    buffer_load_dwordx4 v[176:179], v7, s[4:7], s51 offen
    v_mfma_f32_16x16x32_bf16 v[52:55], v[76:79], v[124:127], 0
    ds_read_b64_tr_b16 v[76:77], v22 offset:8192
    ds_read_b64_tr_b16 v[78:79], v22 offset:9216
    v_mfma_f32_16x16x32_bf16 a[172:175], v[80:83], v[92:95], 0
    buffer_load_dwordx4 v[180:183], v7, s[4:7], s52 offen
    v_mfma_f32_16x16x32_bf16 a[176:179], v[80:83], v[96:99], 0
    buffer_load_dwordx4 v[184:187], v7, s[4:7], s53 offen
    v_mfma_f32_16x16x32_bf16 a[180:183], v[80:83], v[100:103], 0
    buffer_load_dwordx4 v[188:191], v7, s[4:7], s54 offen
    v_mfma_f32_16x16x32_bf16 a[184:187], v[80:83], v[104:107], 0
    buffer_load_dwordx4 v[192:195], v7, s[4:7], s55 offen
    v_mfma_f32_16x16x32_bf16 a[188:191], v[80:83], v[108:111], 0
    buffer_load_dwordx4 v[196:199], v7, s[4:7], s56 offen
    v_mfma_f32_16x16x32_bf16 a[192:195], v[80:83], v[112:115], 0
    v_add_u32 v7, 57344, v7
    v_mfma_f32_16x16x32_bf16 a[196:199], v[80:83], v[116:119], 0
    buffer_load_dwordx4 v[200:203], v7, s[4:7], s48 offen
    v_mfma_f32_16x16x32_bf16 v[40:43], v[80:83], v[120:123], 0
    buffer_load_dwordx4 v[204:207], v7, s[4:7], s49 offen
    v_mfma_f32_16x16x32_bf16 v[56:59], v[80:83], v[124:127], 0
    ds_read_b64_tr_b16 v[80:81], v23 offset:8192
    ds_read_b64_tr_b16 v[82:83], v23 offset:9216
    v_mfma_f32_16x16x32_bf16 a[200:203], v[84:87], v[92:95], 0
    buffer_load_dwordx4 v[208:211], v7, s[4:7], s50 offen
    v_mfma_f32_16x16x32_bf16 a[204:207], v[84:87], v[96:99], 0
    buffer_load_dwordx4 v[212:215], v7, s[4:7], s51 offen
    v_mfma_f32_16x16x32_bf16 a[208:211], v[84:87], v[100:103], 0
    buffer_load_dwordx4 v[216:219], v7, s[4:7], s52 offen
    v_mfma_f32_16x16x32_bf16 a[212:215], v[84:87], v[104:107], 0
    buffer_load_dwordx4 v[220:223], v7, s[4:7], s53 offen
    v_mfma_f32_16x16x32_bf16 v[244:247], v[84:87], v[108:111], 0
    buffer_load_dwordx4 v[224:227], v7, s[4:7], s54 offen
    v_mfma_f32_16x16x32_bf16 a[216:219], v[84:87], v[112:115], 0
    buffer_load_dwordx4 v[228:231], v7, s[4:7], s55 offen
    v_mfma_f32_16x16x32_bf16 v[28:31], v[84:87], v[116:119], 0
    buffer_load_dwordx4 v[232:235], v7, s[4:7], s56 offen
    v_mfma_f32_16x16x32_bf16 v[44:47], v[84:87], v[120:123], 0
    v_add_u32 v7, 57344, v7
    v_mfma_f32_16x16x32_bf16 v[236:239], v[84:87], v[124:127], 0
    ds_read_b64_tr_b16 v[84:85], v24 offset:8192
    ds_read_b64_tr_b16 v[86:87], v24 offset:9216
    v_mfma_f32_16x16x32_bf16 a[220:223], v[88:91], v[92:95], 0
    v_mfma_f32_16x16x32_bf16 a[224:227], v[88:91], v[96:99], 0
    v_mfma_f32_16x16x32_bf16 a[228:231], v[88:91], v[100:103], 0
    v_mfma_f32_16x16x32_bf16 a[232:235], v[88:91], v[104:107], 0
    v_mfma_f32_16x16x32_bf16 v[248:251], v[88:91], v[108:111], 0
    v_mfma_f32_16x16x32_bf16 a[236:239], v[88:91], v[112:115], 0
    v_mfma_f32_16x16x32_bf16 v[32:35], v[88:91], v[116:119], 0
    v_mfma_f32_16x16x32_bf16 v[48:51], v[88:91], v[120:123], 0
    v_mfma_f32_16x16x32_bf16 v[240:243], v[88:91], v[124:127], 0
    ds_read_b64_tr_b16 v[88:89], v25 offset:8192
    ds_read_b64_tr_b16 v[90:91], v25 offset:9216
    s_waitcnt vmcnt(34) lgkmcnt(12)
    v_mfma_f32_16x16x32_bf16 a[0:3], v[60:63], v[128:131], a[0:3]
    v_mfma_f32_16x16x32_bf16 a[4:7], v[60:63], v[132:135], a[4:7]
    v_mfma_f32_16x16x32_bf16 a[8:11], v[60:63], v[136:139], a[8:11]
    v_mfma_f32_16x16x32_bf16 a[12:15], v[60:63], v[140:143], a[12:15]
    v_mfma_f32_16x16x32_bf16 a[16:19], v[60:63], v[144:147], a[16:19]
    v_mfma_f32_16x16x32_bf16 a[20:23], v[60:63], v[148:151], a[20:23]
    v_mfma_f32_16x16x32_bf16 a[24:27], v[60:63], v[152:155], a[24:27]
    v_mfma_f32_16x16x32_bf16 a[28:31], v[60:63], v[156:159], a[28:31]
    v_mfma_f32_16x16x32_bf16 a[32:35], v[60:63], v[160:163], a[32:35]
    v_mfma_f32_16x16x32_bf16 a[36:39], v[64:67], v[128:131], a[36:39]
    v_mfma_f32_16x16x32_bf16 a[40:43], v[64:67], v[132:135], a[40:43]
    v_mfma_f32_16x16x32_bf16 a[44:47], v[64:67], v[136:139], a[44:47]
    v_mfma_f32_16x16x32_bf16 a[48:51], v[64:67], v[140:143], a[48:51]
    v_mfma_f32_16x16x32_bf16 a[52:55], v[64:67], v[144:147], a[52:55]
    v_mfma_f32_16x16x32_bf16 a[56:59], v[64:67], v[148:151], a[56:59]
    v_mfma_f32_16x16x32_bf16 a[60:63], v[64:67], v[152:155], a[60:63]
    v_mfma_f32_16x16x32_bf16 a[64:67], v[64:67], v[156:159], a[64:67]
    v_mfma_f32_16x16x32_bf16 a[68:71], v[64:67], v[160:163], a[68:71]
    s_waitcnt vmcnt(18)
    ds_read_b64_tr_b16 v[60:61], v18 offset:16384
    ds_read_b64_tr_b16 v[62:63], v18 offset:17408
    ds_read_b64_tr_b16 v[64:65], v18 offset:24576
    ds_read_b64_tr_b16 v[66:67], v18 offset:25600
    s_waitcnt lgkmcnt(4)
    v_mfma_f32_16x16x32_bf16 a[72:75], v[68:71], v[128:131], a[72:75]
    s_add_u32 m0, s27, 0
    v_mfma_f32_16x16x32_bf16 a[76:79], v[68:71], v[132:135], a[76:79]
    s_nop 0
    v_mfma_f32_16x16x32_bf16 a[80:83], v[68:71], v[136:139], a[80:83]
    buffer_load_dwordx4 v10, s[8:11], s26 offen offset:0 lds
    v_mfma_f32_16x16x32_bf16 a[84:87], v[68:71], v[140:143], a[84:87]
    buffer_load_dwordx4 v11, s[8:11], s26 offen offset:1024 lds
    v_mfma_f32_16x16x32_bf16 a[88:91], v[68:71], v[144:147], a[88:91]
    buffer_load_dwordx4 v12, s[8:11], s26 offen offset:2048 lds
    v_mfma_f32_16x16x32_bf16 a[92:95], v[68:71], v[148:151], a[92:95]
    buffer_load_dwordx4 v13, s[8:11], s26 offen offset:3072 lds
    v_mfma_f32_16x16x32_bf16 a[96:99], v[68:71], v[152:155], a[96:99]
    s_add_u32 m0, s27, 4096
    v_mfma_f32_16x16x32_bf16 a[100:103], v[68:71], v[156:159], a[100:103]
    s_nop 0
    v_mfma_f32_16x16x32_bf16 a[104:107], v[68:71], v[160:163], a[104:107]
    buffer_load_dwordx4 v14, s[8:11], s26 offen offset:0 lds
    v_mfma_f32_16x16x32_bf16 a[108:111], v[72:75], v[128:131], a[108:111]
    buffer_load_dwordx4 v15, s[8:11], s26 offen offset:1024 lds
    v_mfma_f32_16x16x32_bf16 a[112:115], v[72:75], v[132:135], a[112:115]
    buffer_load_dwordx4 v16, s[8:11], s26 offen offset:2048 lds
    v_mfma_f32_16x16x32_bf16 a[116:119], v[72:75], v[136:139], a[116:119]
    buffer_load_dwordx4 v17, s[8:11], s26 offen offset:3072 lds
    v_mfma_f32_16x16x32_bf16 a[120:123], v[72:75], v[140:143], a[120:123]
    s_add_u32 s26, s26, 163840
    v_mfma_f32_16x16x32_bf16 a[124:127], v[72:75], v[144:147], a[124:127]
    s_add_u32 m0, s27, 8192
    v_mfma_f32_16x16x32_bf16 a[128:131], v[72:75], v[148:151], a[128:131]
    s_nop 0
    v_mfma_f32_16x16x32_bf16 a[132:135], v[72:75], v[152:155], a[132:135]
    buffer_load_dwordx4 v10, s[8:11], s26 offen offset:0 lds
    v_mfma_f32_16x16x32_bf16 a[136:139], v[72:75], v[156:159], a[136:139]
    buffer_load_dwordx4 v11, s[8:11], s26 offen offset:1024 lds
    v_mfma_f32_16x16x32_bf16 a[140:143], v[72:75], v[160:163], a[140:143]
    ds_read_b64_tr_b16 v[68:69], v19 offset:16384
    ds_read_b64_tr_b16 v[70:71], v19 offset:17408
    ds_read_b64_tr_b16 v[72:73], v19 offset:24576
    ds_read_b64_tr_b16 v[74:75], v19 offset:25600
    v_mfma_f32_16x16x32_bf16 a[144:147], v[76:79], v[128:131], a[144:147]
    buffer_load_dwordx4 v12, s[8:11], s26 offen offset:2048 lds
    v_mfma_f32_16x16x32_bf16 a[148:151], v[76:79], v[132:135], a[148:151]
    buffer_load_dwordx4 v13, s[8:11], s26 offen offset:3072 lds
    v_mfma_f32_16x16x32_bf16 a[152:155], v[76:79], v[136:139], a[152:155]
    s_add_u32 m0, s27, 12288
    v_mfma_f32_16x16x32_bf16 a[156:159], v[76:79], v[140:143], a[156:159]
    s_nop 0
    v_mfma_f32_16x16x32_bf16 a[160:163], v[76:79], v[144:147], a[160:163]
    buffer_load_dwordx4 v14, s[8:11], s26 offen offset:0 lds
    v_mfma_f32_16x16x32_bf16 a[164:167], v[76:79], v[148:151], a[164:167]
    buffer_load_dwordx4 v15, s[8:11], s26 offen offset:1024 lds
    v_mfma_f32_16x16x32_bf16 a[168:171], v[76:79], v[152:155], a[168:171]
    buffer_load_dwordx4 v16, s[8:11], s26 offen offset:2048 lds
    v_mfma_f32_16x16x32_bf16 v[36:39], v[76:79], v[156:159], v[36:39]
    buffer_load_dwordx4 v17, s[8:11], s26 offen offset:3072 lds
    v_mfma_f32_16x16x32_bf16 v[52:55], v[76:79], v[160:163], v[52:55]
    s_add_u32 s26, s26, 163840
    v_mfma_f32_16x16x32_bf16 a[172:175], v[80:83], v[128:131], a[172:175]
    v_mfma_f32_16x16x32_bf16 a[176:179], v[80:83], v[132:135], a[176:179]
    v_mfma_f32_16x16x32_bf16 a[180:183], v[80:83], v[136:139], a[180:183]
    v_mfma_f32_16x16x32_bf16 a[184:187], v[80:83], v[140:143], a[184:187]
    v_mfma_f32_16x16x32_bf16 a[188:191], v[80:83], v[144:147], a[188:191]
    v_mfma_f32_16x16x32_bf16 a[192:195], v[80:83], v[148:151], a[192:195]
    v_mfma_f32_16x16x32_bf16 a[196:199], v[80:83], v[152:155], a[196:199]
    v_mfma_f32_16x16x32_bf16 v[40:43], v[80:83], v[156:159], v[40:43]
    v_mfma_f32_16x16x32_bf16 v[56:59], v[80:83], v[160:163], v[56:59]
    ds_read_b64_tr_b16 v[76:77], v20 offset:16384
    ds_read_b64_tr_b16 v[78:79], v20 offset:17408
    ds_read_b64_tr_b16 v[80:81], v20 offset:24576
    ds_read_b64_tr_b16 v[82:83], v20 offset:25600
    v_mfma_f32_16x16x32_bf16 a[200:203], v[84:87], v[128:131], a[200:203]
    v_mfma_f32_16x16x32_bf16 a[204:207], v[84:87], v[132:135], a[204:207]
    v_mfma_f32_16x16x32_bf16 a[208:211], v[84:87], v[136:139], a[208:211]
    v_mfma_f32_16x16x32_bf16 a[212:215], v[84:87], v[140:143], a[212:215]
    v_mfma_f32_16x16x32_bf16 v[244:247], v[84:87], v[144:147], v[244:247]
    v_mfma_f32_16x16x32_bf16 a[216:219], v[84:87], v[148:151], a[216:219]
    v_mfma_f32_16x16x32_bf16 v[28:31], v[84:87], v[152:155], v[28:31]
    v_mfma_f32_16x16x32_bf16 v[44:47], v[84:87], v[156:159], v[44:47]
    v_mfma_f32_16x16x32_bf16 v[236:239], v[84:87], v[160:163], v[236:239]
    v_mfma_f32_16x16x32_bf16 a[220:223], v[88:91], v[128:131], a[220:223]
    v_mfma_f32_16x16x32_bf16 a[224:227], v[88:91], v[132:135], a[224:227]
    v_mfma_f32_16x16x32_bf16 a[228:231], v[88:91], v[136:139], a[228:231]
    v_mfma_f32_16x16x32_bf16 a[232:235], v[88:91], v[140:143], a[232:235]
    v_mfma_f32_16x16x32_bf16 v[248:251], v[88:91], v[144:147], v[248:251]
    v_mfma_f32_16x16x32_bf16 a[236:239], v[88:91], v[148:151], a[236:239]
    v_mfma_f32_16x16x32_bf16 v[32:35], v[88:91], v[152:155], v[32:35]
    v_mfma_f32_16x16x32_bf16 v[48:51], v[88:91], v[156:159], v[48:51]
    v_mfma_f32_16x16x32_bf16 v[240:243], v[88:91], v[160:163], v[240:243]
    ds_read_b64_tr_b16 v[84:85], v21 offset:16384
    ds_read_b64_tr_b16 v[86:87], v21 offset:17408
    ds_read_b64_tr_b16 v[88:89], v21 offset:24576
    ds_read_b64_tr_b16 v[90:91], v21 offset:25600
    s_waitcnt vmcnt(16) lgkmcnt(12)
    v_mfma_f32_16x16x32_bf16 a[0:3], v[60:63], v[164:167], a[0:3]
    buffer_load_dwordx4 v[92:95], v7, s[4:7], s48 offen
    v_mfma_f32_16x16x32_bf16 a[0:3], v[64:67], v[200:203], a[0:3]
    buffer_load_dwordx4 v[96:99], v7, s[4:7], s49 offen
    v_mfma_f32_16x16x32_bf16 a[4:7], v[60:63], v[168:171], a[4:7]
    buffer_load_dwordx4 v[100:103], v7, s[4:7], s50 offen
    v_mfma_f32_16x16x32_bf16 a[4:7], v[64:67], v[204:207], a[4:7]
    buffer_load_dwordx4 v[104:107], v7, s[4:7], s51 offen
    v_mfma_f32_16x16x32_bf16 a[8:11], v[60:63], v[172:175], a[8:11]
    buffer_load_dwordx4 v[108:111], v7, s[4:7], s52 offen
    v_mfma_f32_16x16x32_bf16 a[8:11], v[64:67], v[208:211], a[8:11]
    buffer_load_dwordx4 v[112:115], v7, s[4:7], s53 offen
    v_mfma_f32_16x16x32_bf16 a[12:15], v[60:63], v[176:179], a[12:15]
    buffer_load_dwordx4 v[116:119], v7, s[4:7], s54 offen
    v_mfma_f32_16x16x32_bf16 a[12:15], v[64:67], v[212:215], a[12:15]
    buffer_load_dwordx4 v[120:123], v7, s[4:7], s55 offen
    v_mfma_f32_16x16x32_bf16 a[16:19], v[60:63], v[180:183], a[16:19]
    buffer_load_dwordx4 v[124:127], v7, s[4:7], s56 offen
    v_mfma_f32_16x16x32_bf16 a[16:19], v[64:67], v[216:219], a[16:19]
    v_add_u32 v7, 57344, v7
    v_mfma_f32_16x16x32_bf16 a[20:23], v[60:63], v[184:187], a[20:23]
    buffer_load_dwordx4 v[128:131], v7, s[4:7], s48 offen
    v_mfma_f32_16x16x32_bf16 a[20:23], v[64:67], v[220:223], a[20:23]
    buffer_load_dwordx4 v[132:135], v7, s[4:7], s49 offen
    v_mfma_f32_16x16x32_bf16 a[24:27], v[60:63], v[188:191], a[24:27]
    buffer_load_dwordx4 v[136:139], v7, s[4:7], s50 offen
    v_mfma_f32_16x16x32_bf16 a[24:27], v[64:67], v[224:227], a[24:27]
    buffer_load_dwordx4 v[140:143], v7, s[4:7], s51 offen
    v_mfma_f32_16x16x32_bf16 a[28:31], v[60:63], v[192:195], a[28:31]
    buffer_load_dwordx4 v[144:147], v7, s[4:7], s52 offen
    v_mfma_f32_16x16x32_bf16 a[28:31], v[64:67], v[228:231], a[28:31]
    buffer_load_dwordx4 v[148:151], v7, s[4:7], s53 offen
    v_mfma_f32_16x16x32_bf16 a[32:35], v[60:63], v[196:199], a[32:35]
    buffer_load_dwordx4 v[152:155], v7, s[4:7], s54 offen
    v_mfma_f32_16x16x32_bf16 a[32:35], v[64:67], v[232:235], a[32:35]
    ds_read_b64_tr_b16 v[60:61], v22 offset:16384
    ds_read_b64_tr_b16 v[62:63], v22 offset:17408
    ds_read_b64_tr_b16 v[64:65], v22 offset:24576
    ds_read_b64_tr_b16 v[66:67], v22 offset:25600
    s_waitcnt lgkmcnt(12)
    v_mfma_f32_16x16x32_bf16 a[36:39], v[68:71], v[164:167], a[36:39]
    buffer_load_dwordx4 v[156:159], v7, s[4:7], s55 offen
    v_mfma_f32_16x16x32_bf16 a[36:39], v[72:75], v[200:203], a[36:39]
    buffer_load_dwordx4 v[160:163], v7, s[4:7], s56 offen
    v_mfma_f32_16x16x32_bf16 a[40:43], v[68:71], v[168:171], a[40:43]
    v_add_u32 v7, 57344, v7
    v_mfma_f32_16x16x32_bf16 a[40:43], v[72:75], v[204:207], a[40:43]
    v_mfma_f32_16x16x32_bf16 a[44:47], v[68:71], v[172:175], a[44:47]
    v_mfma_f32_16x16x32_bf16 a[44:47], v[72:75], v[208:211], a[44:47]
    v_mfma_f32_16x16x32_bf16 a[48:51], v[68:71], v[176:179], a[48:51]
    v_mfma_f32_16x16x32_bf16 a[48:51], v[72:75], v[212:215], a[48:51]
    v_mfma_f32_16x16x32_bf16 a[52:55], v[68:71], v[180:183], a[52:55]
    v_mfma_f32_16x16x32_bf16 a[52:55], v[72:75], v[216:219], a[52:55]
    v_mfma_f32_16x16x32_bf16 a[56:59], v[68:71], v[184:187], a[56:59]
    v_mfma_f32_16x16x32_bf16 a[56:59], v[72:75], v[220:223], a[56:59]
    v_mfma_f32_16x16x32_bf16 a[60:63], v[68:71], v[188:191], a[60:63]
    v_mfma_f32_16x16x32_bf16 a[60:63], v[72:75], v[224:227], a[60:63]
    v_mfma_f32_16x16x32_bf16 a[64:67], v[68:71], v[192:195], a[64:67]
    v_mfma_f32_16x16x32_bf16 a[64:67], v[72:75], v[228:231], a[64:67]
    v_mfma_f32_16x16x32_bf16 a[68:71], v[68:71], v[196:199], a[68:71]
    v_mfma_f32_16x16x32_bf16 a[68:71], v[72:75], v[232:235], a[68:71]
    ds_read_b64_tr_b16 v[68:69], v23 offset:16384
    ds_read_b64_tr_b16 v[70:71], v23 offset:17408
    ds_read_b64_tr_b16 v[72:73], v23 offset:24576
    ds_read_b64_tr_b16 v[74:75], v23 offset:25600
    s_waitcnt lgkmcnt(12)
    v_mfma_f32_16x16x32_bf16 a[72:75], v[76:79], v[164:167], a[72:75]
    v_mfma_f32_16x16x32_bf16 a[72:75], v[80:83], v[200:203], a[72:75]
    v_mfma_f32_16x16x32_bf16 a[76:79], v[76:79], v[168:171], a[76:79]
    v_mfma_f32_16x16x32_bf16 a[76:79], v[80:83], v[204:207], a[76:79]
    v_mfma_f32_16x16x32_bf16 a[80:83], v[76:79], v[172:175], a[80:83]
    v_mfma_f32_16x16x32_bf16 a[80:83], v[80:83], v[208:211], a[80:83]
    v_mfma_f32_16x16x32_bf16 a[84:87], v[76:79], v[176:179], a[84:87]
    v_mfma_f32_16x16x32_bf16 a[84:87], v[80:83], v[212:215], a[84:87]
    v_mfma_f32_16x16x32_bf16 a[88:91], v[76:79], v[180:183], a[88:91]
    v_mfma_f32_16x16x32_bf16 a[88:91], v[80:83], v[216:219], a[88:91]
    v_mfma_f32_16x16x32_bf16 a[92:95], v[76:79], v[184:187], a[92:95]
    v_mfma_f32_16x16x32_bf16 a[92:95], v[80:83], v[220:223], a[92:95]
    v_mfma_f32_16x16x32_bf16 a[96:99], v[76:79], v[188:191], a[96:99]
    v_mfma_f32_16x16x32_bf16 a[96:99], v[80:83], v[224:227], a[96:99]
    v_mfma_f32_16x16x32_bf16 a[100:103], v[76:79], v[192:195], a[100:103]
    v_mfma_f32_16x16x32_bf16 a[100:103], v[80:83], v[228:231], a[100:103]
    v_mfma_f32_16x16x32_bf16 a[104:107], v[76:79], v[196:199], a[104:107]
    v_mfma_f32_16x16x32_bf16 a[104:107], v[80:83], v[232:235], a[104:107]
    ds_read_b64_tr_b16 v[76:77], v24 offset:16384
    ds_read_b64_tr_b16 v[78:79], v24 offset:17408
    ds_read_b64_tr_b16 v[80:81], v24 offset:24576
    ds_read_b64_tr_b16 v[82:83], v24 offset:25600
    s_waitcnt lgkmcnt(12)
    v_mfma_f32_16x16x32_bf16 a[108:111], v[84:87], v[164:167], a[108:111]
    v_mfma_f32_16x16x32_bf16 a[108:111], v[88:91], v[200:203], a[108:111]
    v_mfma_f32_16x16x32_bf16 a[112:115], v[84:87], v[168:171], a[112:115]
    v_mfma_f32_16x16x32_bf16 a[112:115], v[88:91], v[204:207], a[112:115]
    v_mfma_f32_16x16x32_bf16 a[116:119], v[84:87], v[172:175], a[116:119]
    v_mfma_f32_16x16x32_bf16 a[116:119], v[88:91], v[208:211], a[116:119]
    v_mfma_f32_16x16x32_bf16 a[120:123], v[84:87], v[176:179], a[120:123]
    v_mfma_f32_16x16x32_bf16 a[120:123], v[88:91], v[212:215], a[120:123]
    v_mfma_f32_16x16x32_bf16 a[124:127], v[84:87], v[180:183], a[124:127]
    v_mfma_f32_16x16x32_bf16 a[124:127], v[88:91], v[216:219], a[124:127]
    v_mfma_f32_16x16x32_bf16 a[128:131], v[84:87], v[184:187], a[128:131]
    v_mfma_f32_16x16x32_bf16 a[128:131], v[88:91], v[220:223], a[128:131]
    v_mfma_f32_16x16x32_bf16 a[132:135], v[84:87], v[188:191], a[132:135]
    v_mfma_f32_16x16x32_bf16 a[132:135], v[88:91], v[224:227], a[132:135]
    v_mfma_f32_16x16x32_bf16 a[136:139], v[84:87], v[192:195], a[136:139]
    v_mfma_f32_16x16x32_bf16 a[136:139], v[88:91], v[228:231], a[136:139]
    v_mfma_f32_16x16x32_bf16 a[140:143], v[84:87], v[196:199], a[140:143]
    v_mfma_f32_16x16x32_bf16 a[140:143], v[88:91], v[232:235], a[140:143]
    ds_read_b64_tr_b16 v[84:85], v25 offset:16384
    ds_read_b64_tr_b16 v[86:87], v25 offset:17408
    ds_read_b64_tr_b16 v[88:89], v25 offset:24576
    ds_read_b64_tr_b16 v[90:91], v25 offset:25600
    s_waitcnt lgkmcnt(12)
    v_mfma_f32_16x16x32_bf16 a[144:147], v[60:63], v[164:167], a[144:147]
    v_mfma_f32_16x16x32_bf16 a[144:147], v[64:67], v[200:203], a[144:147]
    v_mfma_f32_16x16x32_bf16 a[148:151], v[60:63], v[168:171], a[148:151]
    v_mfma_f32_16x16x32_bf16 a[148:151], v[64:67], v[204:207], a[148:151]
    v_mfma_f32_16x16x32_bf16 a[152:155], v[60:63], v[172:175], a[152:155]
    v_mfma_f32_16x16x32_bf16 a[152:155], v[64:67], v[208:211], a[152:155]
    v_mfma_f32_16x16x32_bf16 a[156:159], v[60:63], v[176:179], a[156:159]
    v_mfma_f32_16x16x32_bf16 a[156:159], v[64:67], v[212:215], a[156:159]
    v_mfma_f32_16x16x32_bf16 a[160:163], v[60:63], v[180:183], a[160:163]
    v_mfma_f32_16x16x32_bf16 a[160:163], v[64:67], v[216:219], a[160:163]
    v_mfma_f32_16x16x32_bf16 a[164:167], v[60:63], v[184:187], a[164:167]
    v_mfma_f32_16x16x32_bf16 a[164:167], v[64:67], v[220:223], a[164:167]
    v_mfma_f32_16x16x32_bf16 a[168:171], v[60:63], v[188:191], a[168:171]
    v_mfma_f32_16x16x32_bf16 a[168:171], v[64:67], v[224:227], a[168:171]
    v_mfma_f32_16x16x32_bf16 v[36:39], v[60:63], v[192:195], v[36:39]
    v_mfma_f32_16x16x32_bf16 v[36:39], v[64:67], v[228:231], v[36:39]
    v_mfma_f32_16x16x32_bf16 v[52:55], v[60:63], v[196:199], v[52:55]
    v_mfma_f32_16x16x32_bf16 v[52:55], v[64:67], v[232:235], v[52:55]
    s_waitcnt vmcnt(18)
    ds_read_b64_tr_b16 v[60:61], v18 offset:0
    ds_read_b64_tr_b16 v[62:63], v18 offset:1024
    ds_read_b64_tr_b16 v[64:65], v18 offset:8192
    ds_read_b64_tr_b16 v[66:67], v18 offset:9216
    s_waitcnt lgkmcnt(4)
    v_mfma_f32_16x16x32_bf16 a[172:175], v[68:71], v[164:167], a[172:175]
    s_add_u32 m0, s27, 16384
    v_mfma_f32_16x16x32_bf16 a[172:175], v[72:75], v[200:203], a[172:175]
    s_nop 0
    v_mfma_f32_16x16x32_bf16 a[176:179], v[68:71], v[168:171], a[176:179]
    buffer_load_dwordx4 v10, s[8:11], s26 offen offset:0 lds
    v_mfma_f32_16x16x32_bf16 a[176:179], v[72:75], v[204:207], a[176:179]
    buffer_load_dwordx4 v11, s[8:11], s26 offen offset:1024 lds
    v_mfma_f32_16x16x32_bf16 a[180:183], v[68:71], v[172:175], a[180:183]
    buffer_load_dwordx4 v12, s[8:11], s26 offen offset:2048 lds
    v_mfma_f32_16x16x32_bf16 a[180:183], v[72:75], v[208:211], a[180:183]
    buffer_load_dwordx4 v13, s[8:11], s26 offen offset:3072 lds
    v_mfma_f32_16x16x32_bf16 a[184:187], v[68:71], v[176:179], a[184:187]
    s_add_u32 m0, s27, 20480
    v_mfma_f32_16x16x32_bf16 a[184:187], v[72:75], v[212:215], a[184:187]
    s_nop 0
    v_mfma_f32_16x16x32_bf16 a[188:191], v[68:71], v[180:183], a[188:191]
    buffer_load_dwordx4 v14, s[8:11], s26 offen offset:0 lds
    v_mfma_f32_16x16x32_bf16 a[188:191], v[72:75], v[216:219], a[188:191]
    buffer_load_dwordx4 v15, s[8:11], s26 offen offset:1024 lds
    v_mfma_f32_16x16x32_bf16 a[192:195], v[68:71], v[184:187], a[192:195]
    buffer_load_dwordx4 v16, s[8:11], s26 offen offset:2048 lds
    v_mfma_f32_16x16x32_bf16 a[192:195], v[72:75], v[220:223], a[192:195]
    buffer_load_dwordx4 v17, s[8:11], s26 offen offset:3072 lds
    v_mfma_f32_16x16x32_bf16 a[196:199], v[68:71], v[188:191], a[196:199]
    s_add_u32 s26, s26, 163840
    v_mfma_f32_16x16x32_bf16 a[196:199], v[72:75], v[224:227], a[196:199]
    s_add_u32 m0, s27, 24576
    v_mfma_f32_16x16x32_bf16 v[40:43], v[68:71], v[192:195], v[40:43]
    s_nop 0
    v_mfma_f32_16x16x32_bf16 v[40:43], v[72:75], v[228:231], v[40:43]
    buffer_load_dwordx4 v10, s[8:11], s26 offen offset:0 lds
    v_mfma_f32_16x16x32_bf16 v[56:59], v[68:71], v[196:199], v[56:59]
    buffer_load_dwordx4 v11, s[8:11], s26 offen offset:1024 lds
    v_mfma_f32_16x16x32_bf16 v[56:59], v[72:75], v[232:235], v[56:59]
    ds_read_b64_tr_b16 v[68:69], v19 offset:0
    ds_read_b64_tr_b16 v[70:71], v19 offset:1024
    ds_read_b64_tr_b16 v[72:73], v19 offset:8192
    ds_read_b64_tr_b16 v[74:75], v19 offset:9216
    s_waitcnt lgkmcnt(12)
    v_mfma_f32_16x16x32_bf16 a[200:203], v[76:79], v[164:167], a[200:203]
    buffer_load_dwordx4 v12, s[8:11], s26 offen offset:2048 lds
    v_mfma_f32_16x16x32_bf16 a[200:203], v[80:83], v[200:203], a[200:203]
    buffer_load_dwordx4 v13, s[8:11], s26 offen offset:3072 lds
    v_mfma_f32_16x16x32_bf16 a[204:207], v[76:79], v[168:171], a[204:207]
    s_add_u32 m0, s27, 28672
    v_mfma_f32_16x16x32_bf16 a[204:207], v[80:83], v[204:207], a[204:207]
    s_nop 0
    v_mfma_f32_16x16x32_bf16 a[208:211], v[76:79], v[172:175], a[208:211]
    buffer_load_dwordx4 v14, s[8:11], s26 offen offset:0 lds
    v_mfma_f32_16x16x32_bf16 a[208:211], v[80:83], v[208:211], a[208:211]
    buffer_load_dwordx4 v15, s[8:11], s26 offen offset:1024 lds
    v_mfma_f32_16x16x32_bf16 a[212:215], v[76:79], v[176:179], a[212:215]
    buffer_load_dwordx4 v16, s[8:11], s26 offen offset:2048 lds
    v_mfma_f32_16x16x32_bf16 a[212:215], v[80:83], v[212:215], a[212:215]
    buffer_load_dwordx4 v17, s[8:11], s26 offen offset:3072 lds
    v_mfma_f32_16x16x32_bf16 v[244:247], v[76:79], v[180:183], v[244:247]
    s_add_u32 s26, s26, 163840
    v_mfma_f32_16x16x32_bf16 v[244:247], v[80:83], v[216:219], v[244:247]
    v_mfma_f32_16x16x32_bf16 a[216:219], v[76:79], v[184:187], a[216:219]
    v_mfma_f32_16x16x32_bf16 a[216:219], v[80:83], v[220:223], a[216:219]
    v_mfma_f32_16x16x32_bf16 v[28:31], v[76:79], v[188:191], v[28:31]
    v_mfma_f32_16x16x32_bf16 v[28:31], v[80:83], v[224:227], v[28:31]
    v_mfma_f32_16x16x32_bf16 v[44:47], v[76:79], v[192:195], v[44:47]
    v_mfma_f32_16x16x32_bf16 v[44:47], v[80:83], v[228:231], v[44:47]
    v_mfma_f32_16x16x32_bf16 v[236:239], v[76:79], v[196:199], v[236:239]
    v_mfma_f32_16x16x32_bf16 v[236:239], v[80:83], v[232:235], v[236:239]
    ds_read_b64_tr_b16 v[76:77], v20 offset:0
    ds_read_b64_tr_b16 v[78:79], v20 offset:1024
    ds_read_b64_tr_b16 v[80:81], v20 offset:8192
    ds_read_b64_tr_b16 v[82:83], v20 offset:9216
    s_waitcnt lgkmcnt(12)
    v_mfma_f32_16x16x32_bf16 a[220:223], v[84:87], v[164:167], a[220:223]
    v_mfma_f32_16x16x32_bf16 a[220:223], v[88:91], v[200:203], a[220:223]
    v_mfma_f32_16x16x32_bf16 a[224:227], v[84:87], v[168:171], a[224:227]
    v_mfma_f32_16x16x32_bf16 a[224:227], v[88:91], v[204:207], a[224:227]
    v_mfma_f32_16x16x32_bf16 a[228:231], v[84:87], v[172:175], a[228:231]
    v_mfma_f32_16x16x32_bf16 a[228:231], v[88:91], v[208:211], a[228:231]
    v_mfma_f32_16x16x32_bf16 a[232:235], v[84:87], v[176:179], a[232:235]
    v_mfma_f32_16x16x32_bf16 a[232:235], v[88:91], v[212:215], a[232:235]
    v_mfma_f32_16x16x32_bf16 v[248:251], v[84:87], v[180:183], v[248:251]
    v_mfma_f32_16x16x32_bf16 v[248:251], v[88:91], v[216:219], v[248:251]
    v_mfma_f32_16x16x32_bf16 a[236:239], v[84:87], v[184:187], a[236:239]
    v_mfma_f32_16x16x32_bf16 a[236:239], v[88:91], v[220:223], a[236:239]
    v_mfma_f32_16x16x32_bf16 v[32:35], v[84:87], v[188:191], v[32:35]
    v_mfma_f32_16x16x32_bf16 v[32:35], v[88:91], v[224:227], v[32:35]
    v_mfma_f32_16x16x32_bf16 v[48:51], v[84:87], v[192:195], v[48:51]
    v_mfma_f32_16x16x32_bf16 v[48:51], v[88:91], v[228:231], v[48:51]
    v_mfma_f32_16x16x32_bf16 v[240:243], v[84:87], v[196:199], v[240:243]
    v_mfma_f32_16x16x32_bf16 v[240:243], v[88:91], v[232:235], v[240:243]
    ds_read_b64_tr_b16 v[84:85], v21 offset:0
    ds_read_b64_tr_b16 v[86:87], v21 offset:1024
    ds_read_b64_tr_b16 v[88:89], v21 offset:8192
    ds_read_b64_tr_b16 v[90:91], v21 offset:9216
    s_mov_b32 s21, 0
L_op_loop:
    s_waitcnt vmcnt(16) lgkmcnt(12)
    v_mfma_f32_16x16x32_bf16 a[0:3], v[60:63], v[92:95], a[0:3]
    buffer_load_dwordx4 v[164:167], v7, s[4:7], s48 offen
    v_mfma_f32_16x16x32_bf16 a[0:3], v[64:67], v[128:131], a[0:3]
    buffer_load_dwordx4 v[168:171], v7, s[4:7], s49 offen
    v_mfma_f32_16x16x32_bf16 a[4:7], v[60:63], v[96:99], a[4:7]
    buffer_load_dwordx4 v[172:175], v7, s[4:7], s50 offen
    v_mfma_f32_16x16x32_bf16 a[4:7], v[64:67], v[132:135], a[4:7]
    buffer_load_dwordx4 v[176:179], v7, s[4:7], s51 offen
    v_mfma_f32_16x16x32_bf16 a[8:11], v[60:63], v[100:103], a[8:11]
    buffer_load_dwordx4 v[180:183], v7, s[4:7], s52 offen
    v_mfma_f32_16x16x32_bf16 a[8:11], v[64:67], v[136:139], a[8:11]
    buffer_load_dwordx4 v[184:187], v7, s[4:7], s53 offen
    v_mfma_f32_16x16x32_bf16 a[12:15], v[60:63], v[104:107], a[12:15]
    buffer_load_dwordx4 v[188:191], v7, s[4:7], s54 offen
    v_mfma_f32_16x16x32_bf16 a[12:15], v[64:67], v[140:143], a[12:15]
    buffer_load_dwordx4 v[192:195], v7, s[4:7], s55 offen
    v_mfma_f32_16x16x32_bf16 a[16:19], v[60:63], v[108:111], a[16:19]
    buffer_load_dwordx4 v[196:199], v7, s[4:7], s56 offen
    v_mfma_f32_16x16x32_bf16 a[16:19], v[64:67], v[144:147], a[16:19]
    v_add_u32 v7, 57344, v7
    v_mfma_f32_16x16x32_bf16 a[20:23], v[60:63], v[112:115], a[20:23]
    buffer_load_dwordx4 v[200:203], v7, s[4:7], s48 offen
    v_mfma_f32_16x16x32_bf16 a[20:23], v[64:67], v[148:151], a[20:23]
    buffer_load_dwordx4 v[204:207], v7, s[4:7], s49 offen
    v_mfma_f32_16x16x32_bf16 a[24:27], v[60:63], v[116:119], a[24:27]
    buffer_load_dwordx4 v[208:211], v7, s[4:7], s50 offen
    v_mfma_f32_16x16x32_bf16 a[24:27], v[64:67], v[152:155], a[24:27]
    buffer_load_dwordx4 v[212:215], v7, s[4:7], s51 offen
    v_mfma_f32_16x16x32_bf16 a[28:31], v[60:63], v[120:123], a[28:31]
    buffer_load_dwordx4 v[216:219], v7, s[4:7], s52 offen
    v_mfma_f32_16x16x32_bf16 a[28:31], v[64:67], v[156:159], a[28:31]
    buffer_load_dwordx4 v[220:223], v7, s[4:7], s53 offen
    v_mfma_f32_16x16x32_bf16 a[32:35], v[60:63], v[124:127], a[32:35]
    buffer_load_dwordx4 v[224:227], v7, s[4:7], s54 offen
    v_mfma_f32_16x16x32_bf16 a[32:35], v[64:67], v[160:163], a[32:35]
    ds_read_b64_tr_b16 v[60:61], v22 offset:0
    ds_read_b64_tr_b16 v[62:63], v22 offset:1024
    ds_read_b64_tr_b16 v[64:65], v22 offset:8192
    ds_read_b64_tr_b16 v[66:67], v22 offset:9216
    s_waitcnt lgkmcnt(12)
    v_mfma_f32_16x16x32_bf16 a[36:39], v[68:71], v[92:95], a[36:39]
    buffer_load_dwordx4 v[228:231], v7, s[4:7], s55 offen
    v_mfma_f32_16x16x32_bf16 a[36:39], v[72:75], v[128:131], a[36:39]
    buffer_load_dwordx4 v[232:235], v7, s[4:7], s56 offen
    v_mfma_f32_16x16x32_bf16 a[40:43], v[68:71], v[96:99], a[40:43]
    v_add_u32 v7, 57344, v7
    v_mfma_f32_16x16x32_bf16 a[40:43], v[72:75], v[132:135], a[40:43]
    v_mfma_f32_16x16x32_bf16 a[44:47], v[68:71], v[100:103], a[44:47]
    v_mfma_f32_16x16x32_bf16 a[44:47], v[72:75], v[136:139], a[44:47]
    v_mfma_f32_16x16x32_bf16 a[48:51], v[68:71], v[104:107], a[48:51]
    v_mfma_f32_16x16x32_bf16 a[48:51], v[72:75], v[140:143], a[48:51]
    v_mfma_f32_16x16x32_bf16 a[52:55], v[68:71], v[108:111], a[52:55]
    v_mfma_f32_16x16x32_bf16 a[52:55], v[72:75], v[144:147], a[52:55]
    v_mfma_f32_16x16x32_bf16 a[56:59], v[68:71], v[112:115], a[56:59]
    v_mfma_f32_16x16x32_bf16 a[56:59], v[72:75], v[148:151], a[56:59]
    v_mfma_f32_16x16x32_bf16 a[60:63], v[68:71], v[116:119], a[60:63]
    v_mfma_f32_16x16x32_bf16 a[60:63], v[72:75], v[152:155], a[60:63]
    v_mfma_f32_16x16x32_bf16 a[64:67], v[68:71], v[120:123], a[64:67]
    v_mfma_f32_16x16x32_bf16 a[64:67], v[72:75], v[156:159], a[64:67]
    v_mfma_f32_16x16x32_bf16 a[68:71], v[68:71], v[124:127], a[68:71]
    v_mfma_f32_16x16x32_bf16 a[68:71], v[72:75], v[160:163], a[68:71]
    ds_read_b64_tr_b16 v[68:69], v23 offset:0
    ds_read_b64_tr_b16 v[70:71], v23 offset:1024
    ds_read_b64_tr_b16 v[72:73], v23 offset:8192
    ds_read_b64_tr_b16 v[74:75], v23 offset:9216
    s_waitcnt lgkmcnt(12)
    v_mfma_f32_16x16x32_bf16 a[72:75], v[76:79], v[92:95], a[72:75]
    v_mfma_f32_16x16x32_bf16 a[72:75], v[80:83], v[128:131], a[72:75]
    v_mfma_f32_16x16x32_bf16 a[76:79], v[76:79], v[96:99], a[76:79]
    v_mfma_f32_16x16x32_bf16 a[76:79], v[80:83], v[132:135], a[76:79]
    v_mfma_f32_16x16x32_bf16 a[80:83], v[76:79], v[100:103], a[80:83]
    v_mfma_f32_16x16x32_bf16 a[80:83], v[80:83], v[136:139], a[80:83]
    v_mfma_f32_16x16x32_bf16 a[84:87], v[76:79], v[104:107], a[84:87]
    v_mfma_f32_16x16x32_bf16 a[84:87], v[80:83], v[140:143], a[84:87]
    v_mfma_f32_16x16x32_bf16 a[88:91], v[76:79], v[108:111], a[88:91]
    v_mfma_f32_16x16x32_bf16 a[88:91], v[80:83], v[144:147], a[88:91]
    v_mfma_f32_16x16x32_bf16 a[92:95], v[76:79], v[112:115], a[92:95]
    v_mfma_f32_16x16x32_bf16 a[92:95], v[80:83], v[148:151], a[92:95]
    v_mfma_f32_16x16x32_bf16 a[96:99], v[76:79], v[116:119], a[96:99]
    v_mfma_f32_16x16x32_bf16 a[96:99], v[80:83], v[152:155], a[96:99]
    v_mfma_f32_16x16x32_bf16 a[100:103], v[76:79], v[120:123], a[100:103]
    v_mfma_f32_16x16x32_bf16 a[100:103], v[80:83], v[156:159], a[100:103]
    v_mfma_f32_16x16x32_bf16 a[104:107], v[76:79], v[124:127], a[104:107]
    v_mfma_f32_16x16x32_bf16 a[104:107], v[80:83], v[160:163], a[104:107]
    ds_read_b64_tr_b16 v[76:77], v24 offset:0
    ds_read_b64_tr_b16 v[78:79], v24 offset:1024
    ds_read_b64_tr_b16 v[80:81], v24 offset:8192
    ds_read_b64_tr_b16 v[82:83], v24 offset:9216
    s_waitcnt lgkmcnt(12)
    v_mfma_f32_16x16x32_bf16 a[108:111], v[84:87], v[92:95], a[108:111]
    v_mfma_f32_16x16x32_bf16 a[108:111], v[88:91], v[128:131], a[108:111]
    v_mfma_f32_16x16x32_bf16 a[112:115], v[84:87], v[96:99], a[112:115]
    v_mfma_f32_16x16x32_bf16 a[112:115], v[88:91], v[132:135], a[112:115]
    v_mfma_f32_16x16x32_bf16 a[116:119], v[84:87], v[100:103], a[116:119]
    v_mfma_f32_16x16x32_bf16 a[116:119], v[88:91], v[136:139], a[116:119]
    v_mfma_f32_16x16x32_bf16 a[120:123], v[84:87], v[104:107], a[120:123]
    v_mfma_f32_16x16x32_bf16 a[120:123], v[88:91], v[140:143], a[120:123]
    v_mfma_f32_16x16x32_bf16 a[124:127], v[84:87], v[108:111], a[124:127]
    v_mfma_f32_16x16x32_bf16 a[124:127], v[88:91], v[144:147], a[124:127]
    v_mfma_f32_16x16x32_bf16 a[128:131], v[84:87], v[112:115], a[128:131]
    v_mfma_f32_16x16x32_bf16 a[128:131], v[88:91], v[148:151], a[128:131]
    v_mfma_f32_16x16x32_bf16 a[132:135], v[84:87], v[116:119], a[132:135]
    v_mfma_f32_16x16x32_bf16 a[132:135], v[88:91], v[152:155], a[132:135]
    v_mfma_f32_16x16x32_bf16 a[136:139], v[84:87], v[120:123], a[136:139]
    v_mfma_f32_16x16x32_bf16 a[136:139], v[88:91], v[156:159], a[136:139]
    v_mfma_f32_16x16x32_bf16 a[140:143], v[84:87], v[124:127], a[140:143]
    v_mfma_f32_16x16x32_bf16 a[140:143], v[88:91], v[160:163], a[140:143]
    ds_read_b64_tr_b16 v[84:85], v25 offset:0
    ds_read_b64_tr_b16 v[86:87], v25 offset:1024
    ds_read_b64_tr_b16 v[88:89], v25 offset:8192
    ds_read_b64_tr_b16 v[90:91], v25 offset:9216
    s_waitcnt lgkmcnt(12)
    v_mfma_f32_16x16x32_bf16 a[144:147], v[60:63], v[92:95], a[144:147]
    v_mfma_f32_16x16x32_bf16 a[144:147], v[64:67], v[128:131], a[144:147]
    v_mfma_f32_16x16x32_bf16 a[148:151], v[60:63], v[96:99], a[148:151]
    v_mfma_f32_16x16x32_bf16 a[148:151], v[64:67], v[132:135], a[148:151]
    v_mfma_f32_16x16x32_bf16 a[152:155], v[60:63], v[100:103], a[152:155]
    v_mfma_f32_16x16x32_bf16 a[152:155], v[64:67], v[136:139], a[152:155]
    v_mfma_f32_16x16x32_bf16 a[156:159], v[60:63], v[104:107], a[156:159]
    v_mfma_f32_16x16x32_bf16 a[156:159], v[64:67], v[140:143], a[156:159]
    v_mfma_f32_16x16x32_bf16 a[160:163], v[60:63], v[108:111], a[160:163]
    v_mfma_f32_16x16x32_bf16 a[160:163], v[64:67], v[144:147], a[160:163]
    v_mfma_f32_16x16x32_bf16 a[164:167], v[60:63], v[112:115], a[164:167]
    v_mfma_f32_16x16x32_bf16 a[164:167], v[64:67], v[148:151], a[164:167]
    v_mfma_f32_16x16x32_bf16 a[168:171], v[60:63], v[116:119], a[168:171]
    v_mfma_f32_16x16x32_bf16 a[168:171], v[64:67], v[152:155], a[168:171]
    v_mfma_f32_16x16x32_bf16 v[36:39], v[60:63], v[120:123], v[36:39]
    v_mfma_f32_16x16x32_bf16 v[36:39], v[64:67], v[156:159], v[36:39]
    v_mfma_f32_16x16x32_bf16 v[52:55], v[60:63], v[124:127], v[52:55]
    v_mfma_f32_16x16x32_bf16 v[52:55], v[64:67], v[160:163], v[52:55]
    s_waitcnt vmcnt(18)
    ds_read_b64_tr_b16 v[60:61], v18 offset:16384
    ds_read_b64_tr_b16 v[62:63], v18 offset:17408
    ds_read_b64_tr_b16 v[64:65], v18 offset:24576
    ds_read_b64_tr_b16 v[66:67], v18 offset:25600
    s_waitcnt lgkmcnt(4)
    v_mfma_f32_16x16x32_bf16 a[172:175], v[68:71], v[92:95], a[172:175]
    s_add_u32 m0, s27, 0
    v_mfma_f32_16x16x32_bf16 a[172:175], v[72:75], v[128:131], a[172:175]
    s_nop 0
    v_mfma_f32_16x16x32_bf16 a[176:179], v[68:71], v[96:99], a[176:179]
    buffer_load_dwordx4 v10, s[8:11], s26 offen offset:0 lds
    v_mfma_f32_16x16x32_bf16 a[176:179], v[72:75], v[132:135], a[176:179]
    buffer_load_dwordx4 v11, s[8:11], s26 offen offset:1024 lds
    v_mfma_f32_16x16x32_bf16 a[180:183], v[68:71], v[100:103], a[180:183]
    buffer_load_dwordx4 v12, s[8:11], s26 offen offset:2048 lds
    v_mfma_f32_16x16x32_bf16 a[180:183], v[72:75], v[136:139], a[180:183]
    buffer_load_dwordx4 v13, s[8:11], s26 offen offset:3072 lds
    v_mfma_f32_16x16x32_bf16 a[184:187], v[68:71], v[104:107], a[184:187]
    s_add_u32 m0, s27, 4096
    v_mfma_f32_16x16x32_bf16 a[184:187], v[72:75], v[140:143], a[184:187]
    s_nop 0
    v_mfma_f32_16x16x32_bf16 a[188:191], v[68:71], v[108:111], a[188:191]
    buffer_load_dwordx4 v14, s[8:11], s26 offen offset:0 lds
    v_mfma_f32_16x16x32_bf16 a[188:191], v[72:75], v[144:147], a[188:191]
    buffer_load_dwordx4 v15, s[8:11], s26 offen offset:1024 lds
    v_mfma_f32_16x16x32_bf16 a[192:195], v[68:71], v[112:115], a[192:195]
    buffer_load_dwordx4 v16, s[8:11], s26 offen offset:2048 lds
    v_mfma_f32_16x16x32_bf16 a[192:195], v[72:75], v[148:151], a[192:195]
    buffer_load_dwordx4 v17, s[8:11], s26 offen offset:3072 lds
    v_mfma_f32_16x16x32_bf16 a[196:199], v[68:71], v[116:119], a[196:199]
    s_add_u32 s26, s26, 163840
    v_mfma_f32_16x16x32_bf16 a[196:199], v[72:75], v[152:155], a[196:199]
    s_add_u32 m0, s27, 8192
    v_mfma_f32_16x16x32_bf16 v[40:43], v[68:71], v[120:123], v[40:43]
    s_nop 0
    v_mfma_f32_16x16x32_bf16 v[40:43], v[72:75], v[156:159], v[40:43]
    buffer_load_dwordx4 v10, s[8:11], s26 offen offset:0 lds
    v_mfma_f32_16x16x32_bf16 v[56:59], v[68:71], v[124:127], v[56:59]
    buffer_load_dwordx4 v11, s[8:11], s26 offen offset:1024 lds
    v_mfma_f32_16x16x32_bf16 v[56:59], v[72:75], v[160:163], v[56:59]
    ds_read_b64_tr_b16 v[68:69], v19 offset:16384
    ds_read_b64_tr_b16 v[70:71], v19 offset:17408
    ds_read_b64_tr_b16 v[72:73], v19 offset:24576
    ds_read_b64_tr_b16 v[74:75], v19 offset:25600
    s_waitcnt lgkmcnt(12)
    v_mfma_f32_16x16x32_bf16 a[200:203], v[76:79], v[92:95], a[200:203]
    buffer_load_dwordx4 v12, s[8:11], s26 offen offset:2048 lds
    v_mfma_f32_16x16x32_bf16 a[200:203], v[80:83], v[128:131], a[200:203]
    buffer_load_dwordx4 v13, s[8:11], s26 offen offset:3072 lds
    v_mfma_f32_16x16x32_bf16 a[204:207], v[76:79], v[96:99], a[204:207]
    s_add_u32 m0, s27, 12288
    v_mfma_f32_16x16x32_bf16 a[204:207], v[80:83], v[132:135], a[204:207]
    s_nop 0
    v_mfma_f32_16x16x32_bf16 a[208:211], v[76:79], v[100:103], a[208:211]
    buffer_load_dwordx4 v14, s[8:11], s26 offen offset:0 lds
    v_mfma_f32_16x16x32_bf16 a[208:211], v[80:83], v[136:139], a[208:211]
    buffer_load_dwordx4 v15, s[8:11], s26 offen offset:1024 lds
    v_mfma_f32_16x16x32_bf16 a[212:215], v[76:79], v[104:107], a[212:215]
    buffer_load_dwordx4 v16, s[8:11], s26 offen offset:2048 lds
    v_mfma_f32_16x16x32_bf16 a[212:215], v[80:83], v[140:143], a[212:215]
    buffer_load_dwordx4 v17, s[8:11], s26 offen offset:3072 lds
    v_mfma_f32_16x16x32_bf16 v[244:247], v[76:79], v[108:111], v[244:247]
    s_add_u32 s26, s26, 163840
    v_mfma_f32_16x16x32_bf16 v[244:247], v[80:83], v[144:147], v[244:247]
    v_mfma_f32_16x16x32_bf16 a[216:219], v[76:79], v[112:115], a[216:219]
    v_mfma_f32_16x16x32_bf16 a[216:219], v[80:83], v[148:151], a[216:219]
    v_mfma_f32_16x16x32_bf16 v[28:31], v[76:79], v[116:119], v[28:31]
    v_mfma_f32_16x16x32_bf16 v[28:31], v[80:83], v[152:155], v[28:31]
    v_mfma_f32_16x16x32_bf16 v[44:47], v[76:79], v[120:123], v[44:47]
    v_mfma_f32_16x16x32_bf16 v[44:47], v[80:83], v[156:159], v[44:47]
    v_mfma_f32_16x16x32_bf16 v[236:239], v[76:79], v[124:127], v[236:239]
    v_mfma_f32_16x16x32_bf16 v[236:239], v[80:83], v[160:163], v[236:239]
    ds_read_b64_tr_b16 v[76:77], v20 offset:16384
    ds_read_b64_tr_b16 v[78:79], v20 offset:17408
    ds_read_b64_tr_b16 v[80:81], v20 offset:24576
    ds_read_b64_tr_b16 v[82:83], v20 offset:25600
    s_waitcnt lgkmcnt(12)
    v_mfma_f32_16x16x32_bf16 a[220:223], v[84:87], v[92:95], a[220:223]
    v_mfma_f32_16x16x32_bf16 a[220:223], v[88:91], v[128:131], a[220:223]
    v_mfma_f32_16x16x32_bf16 a[224:227], v[84:87], v[96:99], a[224:227]
    v_mfma_f32_16x16x32_bf16 a[224:227], v[88:91], v[132:135], a[224:227]
    v_mfma_f32_16x16x32_bf16 a[228:231], v[84:87], v[100:103], a[228:231]
    v_mfma_f32_16x16x32_bf16 a[228:231], v[88:91], v[136:139], a[228:231]
    v_mfma_f32_16x16x32_bf16 a[232:235], v[84:87], v[104:107], a[232:235]
    v_mfma_f32_16x16x32_bf16 a[232:235], v[88:91], v[140:143], a[232:235]
    v_mfma_f32_16x16x32_bf16 v[248:251], v[84:87], v[108:111], v[248:251]
    v_mfma_f32_16x16x32_bf16 v[248:251], v[88:91], v[144:147], v[248:251]
    v_mfma_f32_16x16x32_bf16 a[236:239], v[84:87], v[112:115], a[236:239]
    v_mfma_f32_16x16x32_bf16 a[236:239], v[88:91], v[148:151], a[236:239]
    v_mfma_f32_16x16x32_bf16 v[32:35], v[84:87], v[116:119], v[32:35]
    v_mfma_f32_16x16x32_bf16 v[32:35], v[88:91], v[152:155], v[32:35]
    v_mfma_f32_16x16x32_bf16 v[48:51], v[84:87], v[120:123], v[48:51]
    v_mfma_f32_16x16x32_bf16 v[48:51], v[88:91], v[156:159], v[48:51]
    v_mfma_f32_16x16x32_bf16 v[240:243], v[84:87], v[124:127], v[240:243]
    v_mfma_f32_16x16x32_bf16 v[240:243], v[88:91], v[160:163], v[240:243]
    ds_read_b64_tr_b16 v[84:85], v21 offset:16384
    ds_read_b64_tr_b16 v[86:87], v21 offset:17408
    ds_read_b64_tr_b16 v[88:89], v21 offset:24576
    ds_read_b64_tr_b16 v[90:91], v21 offset:25600
    s_waitcnt vmcnt(16) lgkmcnt(12)
    v_mfma_f32_16x16x32_bf16 a[0:3], v[60:63], v[164:167], a[0:3]
    buffer_load_dwordx4 v[92:95], v7, s[4:7], s48 offen
    v_mfma_f32_16x16x32_bf16 a[0:3], v[64:67], v[200:203], a[0:3]
    buffer_load_dwordx4 v[96:99], v7, s[4:7], s49 offen
    v_mfma_f32_16x16x32_bf16 a[4:7], v[60:63], v[168:171], a[4:7]
    buffer_load_dwordx4 v[100:103], v7, s[4:7], s50 offen
    v_mfma_f32_16x16x32_bf16 a[4:7], v[64:67], v[204:207], a[4:7]
    buffer_load_dwordx4 v[104:107], v7, s[4:7], s51 offen
    v_mfma_f32_16x16x32_bf16 a[8:11], v[60:63], v[172:175], a[8:11]
    buffer_load_dwordx4 v[108:111], v7, s[4:7], s52 offen
    v_mfma_f32_16x16x32_bf16 a[8:11], v[64:67], v[208:211], a[8:11]
    buffer_load_dwordx4 v[112:115], v7, s[4:7], s53 offen
    v_mfma_f32_16x16x32_bf16 a[12:15], v[60:63], v[176:179], a[12:15]
    buffer_load_dwordx4 v[116:119], v7, s[4:7], s54 offen
    v_mfma_f32_16x16x32_bf16 a[12:15], v[64:67], v[212:215], a[12:15]
    buffer_load_dwordx4 v[120:123], v7, s[4:7], s55 offen
    v_mfma_f32_16x16x32_bf16 a[16:19], v[60:63], v[180:183], a[16:19]
    buffer_load_dwordx4 v[124:127], v7, s[4:7], s56 offen
    v_mfma_f32_16x16x32_bf16 a[16:19], v[64:67], v[216:219], a[16:19]
    v_add_u32 v7, 57344, v7
    v_mfma_f32_16x16x32_bf16 a[20:23], v[60:63], v[184:187], a[20:23]
    buffer_load_dwordx4 v[128:131], v7, s[4:7], s48 offen
    v_mfma_f32_16x16x32_bf16 a[20:23], v[64:67], v[220:223], a[20:23]
    buffer_load_dwordx4 v[132:135], v7, s[4:7], s49 offen
    v_mfma_f32_16x16x32_bf16 a[24:27], v[60:63], v[188:191], a[24:27]
    buffer_load_dwordx4 v[136:139], v7, s[4:7], s50 offen
    v_mfma_f32_16x16x32_bf16 a[24:27], v[64:67], v[224:227], a[24:27]
    buffer_load_dwordx4 v[140:143], v7, s[4:7], s51 offen
    v_mfma_f32_16x16x32_bf16 a[28:31], v[60:63], v[192:195], a[28:31]
    buffer_load_dwordx4 v[144:147], v7, s[4:7], s52 offen
    v_mfma_f32_16x16x32_bf16 a[28:31], v[64:67], v[228:231], a[28:31]
    buffer_load_dwordx4 v[148:151], v7, s[4:7], s53 offen
    v_mfma_f32_16x16x32_bf16 a[32:35], v[60:63], v[196:199], a[32:35]
    buffer_load_dwordx4 v[152:155], v7, s[4:7], s54 offen
    v_mfma_f32_16x16x32_bf16 a[32:35], v[64:67], v[232:235], a[32:35]
    ds_read_b64_tr_b16 v[60:61], v22 offset:16384
    ds_read_b64_tr_b16 v[62:63], v22 offset:17408
    ds_read_b64_tr_b16 v[64:65], v22 offset:24576
    ds_read_b64_tr_b16 v[66:67], v22 offset:25600
    s_waitcnt lgkmcnt(12)
    v_mfma_f32_16x16x32_bf16 a[36:39], v[68:71], v[164:167], a[36:39]
    buffer_load_dwordx4 v[156:159], v7, s[4:7], s55 offen
    v_mfma_f32_16x16x32_bf16 a[36:39], v[72:75], v[200:203], a[36:39]
    buffer_load_dwordx4 v[160:163], v7, s[4:7], s56 offen
    v_mfma_f32_16x16x32_bf16 a[40:43], v[68:71], v[168:171], a[40:43]
    v_add_u32 v7, 57344, v7
    v_mfma_f32_16x16x32_bf16 a[40:43], v[72:75], v[204:207], a[40:43]
    v_mfma_f32_16x16x32_bf16 a[44:47], v[68:71], v[172:175], a[44:47]
    v_mfma_f32_16x16x32_bf16 a[44:47], v[72:75], v[208:211], a[44:47]
    v_mfma_f32_16x16x32_bf16 a[48:51], v[68:71], v[176:179], a[48:51]
    v_mfma_f32_16x16x32_bf16 a[48:51], v[72:75], v[212:215], a[48:51]
    v_mfma_f32_16x16x32_bf16 a[52:55], v[68:71], v[180:183], a[52:55]
    v_mfma_f32_16x16x32_bf16 a[52:55], v[72:75], v[216:219], a[52:55]
    v_mfma_f32_16x16x32_bf16 a[56:59], v[68:71], v[184:187], a[56:59]
    v_mfma_f32_16x16x32_bf16 a[56:59], v[72:75], v[220:223], a[56:59]
    v_mfma_f32_16x16x32_bf16 a[60:63], v[68:71], v[188:191], a[60:63]
    v_mfma_f32_16x16x32_bf16 a[60:63], v[72:75], v[224:227], a[60:63]
    v_mfma_f32_16x16x32_bf16 a[64:67], v[68:71], v[192:195], a[64:67]
    v_mfma_f32_16x16x32_bf16 a[64:67], v[72:75], v[228:231], a[64:67]
    v_mfma_f32_16x16x32_bf16 a[68:71], v[68:71], v[196:199], a[68:71]
    v_mfma_f32_16x16x32_bf16 a[68:71], v[72:75], v[232:235], a[68:71]
    ds_read_b64_tr_b16 v[68:69], v23 offset:16384
    ds_read_b64_tr_b16 v[70:71], v23 offset:17408
    ds_read_b64_tr_b16 v[72:73], v23 offset:24576
    ds_read_b64_tr_b16 v[74:75], v23 offset:25600
    s_waitcnt lgkmcnt(12)
    v_mfma_f32_16x16x32_bf16 a[72:75], v[76:79], v[164:167], a[72:75]
    v_mfma_f32_16x16x32_bf16 a[72:75], v[80:83], v[200:203], a[72:75]
    v_mfma_f32_16x16x32_bf16 a[76:79], v[76:79], v[168:171], a[76:79]
    v_mfma_f32_16x16x32_bf16 a[76:79], v[80:83], v[204:207], a[76:79]
    v_mfma_f32_16x16x32_bf16 a[80:83], v[76:79], v[172:175], a[80:83]
    v_mfma_f32_16x16x32_bf16 a[80:83], v[80:83], v[208:211], a[80:83]
    v_mfma_f32_16x16x32_bf16 a[84:87], v[76:79], v[176:179], a[84:87]
    v_mfma_f32_16x16x32_bf16 a[84:87], v[80:83], v[212:215], a[84:87]
    v_mfma_f32_16x16x32_bf16 a[88:91], v[76:79], v[180:183], a[88:91]
    v_mfma_f32_16x16x32_bf16 a[88:91], v[80:83], v[216:219], a[88:91]
    v_mfma_f32_16x16x32_bf16 a[92:95], v[76:79], v[184:187], a[92:95]
    v_mfma_f32_16x16x32_bf16 a[92:95], v[80:83], v[220:223], a[92:95]
    v_mfma_f32_16x16x32_bf16 a[96:99], v[76:79], v[188:191], a[96:99]
    v_mfma_f32_16x16x32_bf16 a[96:99], v[80:83], v[224:227], a[96:99]
    v_mfma_f32_16x16x32_bf16 a[100:103], v[76:79], v[192:195], a[100:103]
    v_mfma_f32_16x16x32_bf16 a[100:103], v[80:83], v[228:231], a[100:103]
    v_mfma_f32_16x16x32_bf16 a[104:107], v[76:79], v[196:199], a[104:107]
    v_mfma_f32_16x16x32_bf16 a[104:107], v[80:83], v[232:235], a[104:107]
    ds_read_b64_tr_b16 v[76:77], v24 offset:16384
    ds_read_b64_tr_b16 v[78:79], v24 offset:17408
    ds_read_b64_tr_b16 v[80:81], v24 offset:24576
    ds_read_b64_tr_b16 v[82:83], v24 offset:25600
    s_waitcnt lgkmcnt(12)
    v_mfma_f32_16x16x32_bf16 a[108:111], v[84:87], v[164:167], a[108:111]
    v_mfma_f32_16x16x32_bf16 a[108:111], v[88:91], v[200:203], a[108:111]
    v_mfma_f32_16x16x32_bf16 a[112:115], v[84:87], v[168:171], a[112:115]
    v_mfma_f32_16x16x32_bf16 a[112:115], v[88:91], v[204:207], a[112:115]
    v_mfma_f32_16x16x32_bf16 a[116:119], v[84:87], v[172:175], a[116:119]
    v_mfma_f32_16x16x32_bf16 a[116:119], v[88:91], v[208:211], a[116:119]
    v_mfma_f32_16x16x32_bf16 a[120:123], v[84:87], v[176:179], a[120:123]
    v_mfma_f32_16x16x32_bf16 a[120:123], v[88:91], v[212:215], a[120:123]
    v_mfma_f32_16x16x32_bf16 a[124:127], v[84:87], v[180:183], a[124:127]
    v_mfma_f32_16x16x32_bf16 a[124:127], v[88:91], v[216:219], a[124:127]
    v_mfma_f32_16x16x32_bf16 a[128:131], v[84:87], v[184:187], a[128:131]
    v_mfma_f32_16x16x32_bf16 a[128:131], v[88:91], v[220:223], a[128:131]
    v_mfma_f32_16x16x32_bf16 a[132:135], v[84:87], v[188:191], a[132:135]
    v_mfma_f32_16x16x32_bf16 a[132:135], v[88:91], v[224:227], a[132:135]
    v_mfma_f32_16x16x32_bf16 a[136:139], v[84:87], v[192:195], a[136:139]
    v_mfma_f32_16x16x32_bf16 a[136:139], v[88:91], v[228:231], a[136:139]
    v_mfma_f32_16x16x32_bf16 a[140:143], v[84:87], v[196:199], a[140:143]
    v_mfma_f32_16x16x32_bf16 a[140:143], v[88:91], v[232:235], a[140:143]
    ds_read_b64_tr_b16 v[84:85], v25 offset:16384
    ds_read_b64_tr_b16 v[86:87], v25 offset:17408
    ds_read_b64_tr_b16 v[88:89], v25 offset:24576
    ds_read_b64_tr_b16 v[90:91], v25 offset:25600
    s_waitcnt lgkmcnt(12)
    v_mfma_f32_16x16x32_bf16 a[144:147], v[60:63], v[164:167], a[144:147]
    v_mfma_f32_16x16x32_bf16 a[144:147], v[64:67], v[200:203], a[144:147]
    v_mfma_f32_16x16x32_bf16 a[148:151], v[60:63], v[168:171], a[148:151]
    v_mfma_f32_16x16x32_bf16 a[148:151], v[64:67], v[204:207], a[148:151]
    v_mfma_f32_16x16x32_bf16 a[152:155], v[60:63], v[172:175], a[152:155]
    v_mfma_f32_16x16x32_bf16 a[152:155], v[64:67], v[208:211], a[152:155]
    v_mfma_f32_16x16x32_bf16 a[156:159], v[60:63], v[176:179], a[156:159]
    v_mfma_f32_16x16x32_bf16 a[156:159], v[64:67], v[212:215], a[156:159]
    v_mfma_f32_16x16x32_bf16 a[160:163], v[60:63], v[180:183], a[160:163]
    v_mfma_f32_16x16x32_bf16 a[160:163], v[64:67], v[216:219], a[160:163]
    v_mfma_f32_16x16x32_bf16 a[164:167], v[60:63], v[184:187], a[164:167]
    v_mfma_f32_16x16x32_bf16 a[164:167], v[64:67], v[220:223], a[164:167]
    v_mfma_f32_16x16x32_bf16 a[168:171], v[60:63], v[188:191], a[168:171]
    v_mfma_f32_16x16x32_bf16 a[168:171], v[64:67], v[224:227], a[168:171]
    v_mfma_f32_16x16x32_bf16 v[36:39], v[60:63], v[192:195], v[36:39]
    v_mfma_f32_16x16x32_bf16 v[36:39], v[64:67], v[228:231], v[36:39]
    v_mfma_f32_16x16x32_bf16 v[52:55], v[60:63], v[196:199], v[52:55]
    v_mfma_f32_16x16x32_bf16 v[52:55], v[64:67], v[232:235], v[52:55]
    s_waitcnt vmcnt(18)
    ds_read_b64_tr_b16 v[60:61], v18 offset:0
    ds_read_b64_tr_b16 v[62:63], v18 offset:1024
    ds_read_b64_tr_b16 v[64:65], v18 offset:8192
    ds_read_b64_tr_b16 v[66:67], v18 offset:9216
    s_waitcnt lgkmcnt(4)
    v_mfma_f32_16x16x32_bf16 a[172:175], v[68:71], v[164:167], a[172:175]
    s_add_u32 m0, s27, 16384
    v_mfma_f32_16x16x32_bf16 a[172:175], v[72:75], v[200:203], a[172:175]
    s_nop 0
    v_mfma_f32_16x16x32_bf16 a[176:179], v[68:71], v[168:171], a[176:179]
    buffer_load_dwordx4 v10, s[8:11], s26 offen offset:0 lds
    v_mfma_f32_16x16x32_bf16 a[176:179], v[72:75], v[204:207], a[176:179]
    buffer_load_dwordx4 v11, s[8:11], s26 offen offset:1024 lds
    v_mfma_f32_16x16x32_bf16 a[180:183], v[68:71], v[172:175], a[180:183]
    buffer_load_dwordx4 v12, s[8:11], s26 offen offset:2048 lds
    v_mfma_f32_16x16x32_bf16 a[180:183], v[72:75], v[208:211], a[180:183]
    buffer_load_dwordx4 v13, s[8:11], s26 offen offset:3072 lds
    v_mfma_f32_16x16x32_bf16 a[184:187], v[68:71], v[176:179], a[184:187]
    s_add_u32 m0, s27, 20480
    v_mfma_f32_16x16x32_bf16 a[184:187], v[72:75], v[212:215], a[184:187]
    s_nop 0
    v_mfma_f32_16x16x32_bf16 a[188:191], v[68:71], v[180:183], a[188:191]
    buffer_load_dwordx4 v14, s[8:11], s26 offen offset:0 lds
    v_mfma_f32_16x16x32_bf16 a[188:191], v[72:75], v[216:219], a[188:191]
    buffer_load_dwordx4 v15, s[8:11], s26 offen offset:1024 lds
    v_mfma_f32_16x16x32_bf16 a[192:195], v[68:71], v[184:187], a[192:195]
    buffer_load_dwordx4 v16, s[8:11], s26 offen offset:2048 lds
    v_mfma_f32_16x16x32_bf16 a[192:195], v[72:75], v[220:223], a[192:195]
    buffer_load_dwordx4 v17, s[8:11], s26 offen offset:3072 lds
    v_mfma_f32_16x16x32_bf16 a[196:199], v[68:71], v[188:191], a[196:199]
    s_add_u32 s26, s26, 163840
    v_mfma_f32_16x16x32_bf16 a[196:199], v[72:75], v[224:227], a[196:199]
    s_add_u32 m0, s27, 24576
    v_mfma_f32_16x16x32_bf16 v[40:43], v[68:71], v[192:195], v[40:43]
    s_nop 0
    v_mfma_f32_16x16x32_bf16 v[40:43], v[72:75], v[228:231], v[40:43]
    buffer_load_dwordx4 v10, s[8:11], s26 offen offset:0 lds
    v_mfma_f32_16x16x32_bf16 v[56:59], v[68:71], v[196:199], v[56:59]
    buffer_load_dwordx4 v11, s[8:11], s26 offen offset:1024 lds
    v_mfma_f32_16x16x32_bf16 v[56:59], v[72:75], v[232:235], v[56:59]
    ds_read_b64_tr_b16 v[68:69], v19 offset:0
    ds_read_b64_tr_b16 v[70:71], v19 offset:1024
    ds_read_b64_tr_b16 v[72:73], v19 offset:8192
    ds_read_b64_tr_b16 v[74:75], v19 offset:9216
    s_waitcnt lgkmcnt(12)
    v_mfma_f32_16x16x32_bf16 a[200:203], v[76:79], v[164:167], a[200:203]
    buffer_load_dwordx4 v12, s[8:11], s26 offen offset:2048 lds
    v_mfma_f32_16x16x32_bf16 a[200:203], v[80:83], v[200:203], a[200:203]
    buffer_load_dwordx4 v13, s[8:11], s26 offen offset:3072 lds
    v_mfma_f32_16x16x32_bf16 a[204:207], v[76:79], v[168:171], a[204:207]
    s_add_u32 m0, s27, 28672
    v_mfma_f32_16x16x32_bf16 a[204:207], v[80:83], v[204:207], a[204:207]
    s_nop 0
    v_mfma_f32_16x16x32_bf16 a[208:211], v[76:79], v[172:175], a[208:211]
    buffer_load_dwordx4 v14, s[8:11], s26 offen offset:0 lds
    v_mfma_f32_16x16x32_bf16 a[208:211], v[80:83], v[208:211], a[208:211]
    buffer_load_dwordx4 v15, s[8:11], s26 offen offset:1024 lds
    v_mfma_f32_16x16x32_bf16 a[212:215], v[76:79], v[176:179], a[212:215]
    buffer_load_dwordx4 v16, s[8:11], s26 offen offset:2048 lds
    v_mfma_f32_16x16x32_bf16 a[212:215], v[80:83], v[212:215], a[212:215]
    buffer_load_dwordx4 v17, s[8:11], s26 offen offset:3072 lds
    v_mfma_f32_16x16x32_bf16 v[244:247], v[76:79], v[180:183], v[244:247]
    s_add_u32 s26, s26, 163840
    v_mfma_f32_16x16x32_bf16 v[244:247], v[80:83], v[216:219], v[244:247]
    v_mfma_f32_16x16x32_bf16 a[216:219], v[76:79], v[184:187], a[216:219]
    v_mfma_f32_16x16x32_bf16 a[216:219], v[80:83], v[220:223], a[216:219]
    v_mfma_f32_16x16x32_bf16 v[28:31], v[76:79], v[188:191], v[28:31]
    v_mfma_f32_16x16x32_bf16 v[28:31], v[80:83], v[224:227], v[28:31]
    v_mfma_f32_16x16x32_bf16 v[44:47], v[76:79], v[192:195], v[44:47]
    v_mfma_f32_16x16x32_bf16 v[44:47], v[80:83], v[228:231], v[44:47]
    v_mfma_f32_16x16x32_bf16 v[236:239], v[76:79], v[196:199], v[236:239]
    v_mfma_f32_16x16x32_bf16 v[236:239], v[80:83], v[232:235], v[236:239]
    ds_read_b64_tr_b16 v[76:77], v20 offset:0
    ds_read_b64_tr_b16 v[78:79], v20 offset:1024
    ds_read_b64_tr_b16 v[80:81], v20 offset:8192
    ds_read_b64_tr_b16 v[82:83], v20 offset:9216
    s_waitcnt lgkmcnt(12)
    v_mfma_f32_16x16x32_bf16 a[220:223], v[84:87], v[164:167], a[220:223]
    v_mfma_f32_16x16x32_bf16 a[220:223], v[88:91], v[200:203], a[220:223]
    v_mfma_f32_16x16x32_bf16 a[224:227], v[84:87], v[168:171], a[224:227]
    v_mfma_f32_16x16x32_bf16 a[224:227], v[88:91], v[204:207], a[224:227]
    v_mfma_f32_16x16x32_bf16 a[228:231], v[84:87], v[172:175], a[228:231]
    v_mfma_f32_16x16x32_bf16 a[228:231], v[88:91], v[208:211], a[228:231]
    v_mfma_f32_16x16x32_bf16 a[232:235], v[84:87], v[176:179], a[232:235]
    v_mfma_f32_16x16x32_bf16 a[232:235], v[88:91], v[212:215], a[232:235]
    v_mfma_f32_16x16x32_bf16 v[248:251], v[84:87], v[180:183], v[248:251]
    v_mfma_f32_16x16x32_bf16 v[248:251], v[88:91], v[216:219], v[248:251]
    v_mfma_f32_16x16x32_bf16 a[236:239], v[84:87], v[184:187], a[236:239]
    v_mfma_f32_16x16x32_bf16 a[236:239], v[88:91], v[220:223], a[236:239]
    v_mfma_f32_16x16x32_bf16 v[32:35], v[84:87], v[188:191], v[32:35]
    v_mfma_f32_16x16x32_bf16 v[32:35], v[88:91], v[224:227], v[32:35]
    v_mfma_f32_16x16x32_bf16 v[48:51], v[84:87], v[192:195], v[48:51]
    v_mfma_f32_16x16x32_bf16 v[48:51], v[88:91], v[228:231], v[48:51]
    v_mfma_f32_16x16x32_bf16 v[240:243], v[84:87], v[196:199], v[240:243]
    v_mfma_f32_16x16x32_bf16 v[240:243], v[88:91], v[232:235], v[240:243]
    ds_read_b64_tr_b16 v[84:85], v21 offset:0
    ds_read_b64_tr_b16 v[86:87], v21 offset:1024
    ds_read_b64_tr_b16 v[88:89], v21 offset:8192
    ds_read_b64_tr_b16 v[90:91], v21 offset:9216
    s_add_u32 s21, s21, 1
    s_cmp_lt_u32 s21, 6
    s_cbranch_scc1 L_op_loop
    s_waitcnt vmcnt(16) lgkmcnt(12)
    v_mfma_f32_16x16x32_bf16 a[0:3], v[60:63], v[92:95], a[0:3]
    buffer_load_dwordx4 v[164:167], v7, s[4:7], s48 offen
    v_mfma_f32_16x16x32_bf16 a[0:3], v[64:67], v[128:131], a[0:3]
    buffer_load_dwordx4 v[168:171], v7, s[4:7], s49 offen
    v_mfma_f32_16x16x32_bf16 a[4:7], v[60:63], v[96:99], a[4:7]
    buffer_load_dwordx4 v[172:175], v7, s[4:7], s50 offen
    v_mfma_f32_16x16x32_bf16 a[4:7], v[64:67], v[132:135], a[4:7]
    buffer_load_dwordx4 v[176:179], v7, s[4:7], s51 offen
    v_mfma_f32_16x16x32_bf16 a[8:11], v[60:63], v[100:103], a[8:11]
    buffer_load_dwordx4 v[180:183], v7, s[4:7], s52 offen
    v_mfma_f32_16x16x32_bf16 a[8:11], v[64:67], v[136:139], a[8:11]
    buffer_load_dwordx4 v[184:187], v7, s[4:7], s53 offen
    v_mfma_f32_16x16x32_bf16 a[12:15], v[60:63], v[104:107], a[12:15]
    buffer_load_dwordx4 v[188:191], v7, s[4:7], s54 offen
    v_mfma_f32_16x16x32_bf16 a[12:15], v[64:67], v[140:143], a[12:15]
    buffer_load_dwordx4 v[192:195], v7, s[4:7], s55 offen
    v_mfma_f32_16x16x32_bf16 a[16:19], v[60:63], v[108:111], a[16:19]
    buffer_load_dwordx4 v[196:199], v7, s[4:7], s56 offen
    v_mfma_f32_16x16x32_bf16 a[16:19], v[64:67], v[144:147], a[16:19]
    v_add_u32 v7, 57344, v7
    v_mfma_f32_16x16x32_bf16 a[20:23], v[60:63], v[112:115], a[20:23]
    buffer_load_dwordx4 v[200:203], v7, s[4:7], s48 offen
    v_mfma_f32_16x16x32_bf16 a[20:23], v[64:67], v[148:151], a[20:23]
    buffer_load_dwordx4 v[204:207], v7, s[4:7], s49 offen
    v_mfma_f32_16x16x32_bf16 a[24:27], v[60:63], v[116:119], a[24:27]
    buffer_load_dwordx4 v[208:211], v7, s[4:7], s50 offen
    v_mfma_f32_16x16x32_bf16 a[24:27], v[64:67], v[152:155], a[24:27]
    buffer_load_dwordx4 v[212:215], v7, s[4:7], s51 offen
    v_mfma_f32_16x16x32_bf16 a[28:31], v[60:63], v[120:123], a[28:31]
    buffer_load_dwordx4 v[216:219], v7, s[4:7], s52 offen
    v_mfma_f32_16x16x32_bf16 a[28:31], v[64:67], v[156:159], a[28:31]
    buffer_load_dwordx4 v[220:223], v7, s[4:7], s53 offen
    v_mfma_f32_16x16x32_bf16 a[32:35], v[60:63], v[124:127], a[32:35]
    buffer_load_dwordx4 v[224:227], v7, s[4:7], s54 offen
    v_mfma_f32_16x16x32_bf16 a[32:35], v[64:67], v[160:163], a[32:35]
    ds_read_b64_tr_b16 v[60:61], v22 offset:0
    ds_read_b64_tr_b16 v[62:63], v22 offset:1024
    ds_read_b64_tr_b16 v[64:65], v22 offset:8192
    ds_read_b64_tr_b16 v[66:67], v22 offset:9216
    s_waitcnt lgkmcnt(12)
    v_mfma_f32_16x16x32_bf16 a[36:39], v[68:71], v[92:95], a[36:39]
    buffer_load_dwordx4 v[228:231], v7, s[4:7], s55 offen
    v_mfma_f32_16x16x32_bf16 a[36:39], v[72:75], v[128:131], a[36:39]
    buffer_load_dwordx4 v[232:235], v7, s[4:7], s56 offen
    v_mfma_f32_16x16x32_bf16 a[40:43], v[68:71], v[96:99], a[40:43]
    v_add_u32 v7, 57344, v7
    v_mfma_f32_16x16x32_bf16 a[40:43], v[72:75], v[132:135], a[40:43]
    v_mfma_f32_16x16x32_bf16 a[44:47], v[68:71], v[100:103], a[44:47]
    v_mfma_f32_16x16x32_bf16 a[44:47], v[72:75], v[136:139], a[44:47]
    v_mfma_f32_16x16x32_bf16 a[48:51], v[68:71], v[104:107], a[48:51]
    v_mfma_f32_16x16x32_bf16 a[48:51], v[72:75], v[140:143], a[48:51]
    v_mfma_f32_16x16x32_bf16 a[52:55], v[68:71], v[108:111], a[52:55]
    v_mfma_f32_16x16x32_bf16 a[52:55], v[72:75], v[144:147], a[52:55]
    v_mfma_f32_16x16x32_bf16 a[56:59], v[68:71], v[112:115], a[56:59]
    v_mfma_f32_16x16x32_bf16 a[56:59], v[72:75], v[148:151], a[56:59]
    v_mfma_f32_16x16x32_bf16 a[60:63], v[68:71], v[116:119], a[60:63]
    v_mfma_f32_16x16x32_bf16 a[60:63], v[72:75], v[152:155], a[60:63]
    v_mfma_f32_16x16x32_bf16 a[64:67], v[68:71], v[120:123], a[64:67]
    v_mfma_f32_16x16x32_bf16 a[64:67], v[72:75], v[156:159], a[64:67]
    v_mfma_f32_16x16x32_bf16 a[68:71], v[68:71], v[124:127], a[68:71]
    v_mfma_f32_16x16x32_bf16 a[68:71], v[72:75], v[160:163], a[68:71]
    ds_read_b64_tr_b16 v[68:69], v23 offset:0
    ds_read_b64_tr_b16 v[70:71], v23 offset:1024
    ds_read_b64_tr_b16 v[72:73], v23 offset:8192
    ds_read_b64_tr_b16 v[74:75], v23 offset:9216
    s_waitcnt lgkmcnt(12)
    v_mfma_f32_16x16x32_bf16 a[72:75], v[76:79], v[92:95], a[72:75]
    v_mfma_f32_16x16x32_bf16 a[72:75], v[80:83], v[128:131], a[72:75]
    v_mfma_f32_16x16x32_bf16 a[76:79], v[76:79], v[96:99], a[76:79]
    v_mfma_f32_16x16x32_bf16 a[76:79], v[80:83], v[132:135], a[76:79]
    v_mfma_f32_16x16x32_bf16 a[80:83], v[76:79], v[100:103], a[80:83]
    v_mfma_f32_16x16x32_bf16 a[80:83], v[80:83], v[136:139], a[80:83]
    v_mfma_f32_16x16x32_bf16 a[84:87], v[76:79], v[104:107], a[84:87]
    v_mfma_f32_16x16x32_bf16 a[84:87], v[80:83], v[140:143], a[84:87]
    v_mfma_f32_16x16x32_bf16 a[88:91], v[76:79], v[108:111], a[88:91]
    v_mfma_f32_16x16x32_bf16 a[88:91], v[80:83], v[144:147], a[88:91]
    v_mfma_f32_16x16x32_bf16 a[92:95], v[76:79], v[112:115], a[92:95]
    v_mfma_f32_16x16x32_bf16 a[92:95], v[80:83], v[148:151], a[92:95]
    v_mfma_f32_16x16x32_bf16 a[96:99], v[76:79], v[116:119], a[96:99]
    v_mfma_f32_16x16x32_bf16 a[96:99], v[80:83], v[152:155], a[96:99]
    v_mfma_f32_16x16x32_bf16 a[100:103], v[76:79], v[120:123], a[100:103]
    v_mfma_f32_16x16x32_bf16 a[100:103], v[80:83], v[156:159], a[100:103]
    v_mfma_f32_16x16x32_bf16 a[104:107], v[76:79], v[124:127], a[104:107]
    v_mfma_f32_16x16x32_bf16 a[104:107], v[80:83], v[160:163], a[104:107]
    ds_read_b64_tr_b16 v[76:77], v24 offset:0
    ds_read_b64_tr_b16 v[78:79], v24 offset:1024
    ds_read_b64_tr_b16 v[80:81], v24 offset:8192
    ds_read_b64_tr_b16 v[82:83], v24 offset:9216
    s_waitcnt lgkmcnt(12)
    v_mfma_f32_16x16x32_bf16 a[108:111], v[84:87], v[92:95], a[108:111]
    v_mfma_f32_16x16x32_bf16 a[108:111], v[88:91], v[128:131], a[108:111]
    v_mfma_f32_16x16x32_bf16 a[112:115], v[84:87], v[96:99], a[112:115]
    v_mfma_f32_16x16x32_bf16 a[112:115], v[88:91], v[132:135], a[112:115]
    v_mfma_f32_16x16x32_bf16 a[116:119], v[84:87], v[100:103], a[116:119]
    v_mfma_f32_16x16x32_bf16 a[116:119], v[88:91], v[136:139], a[116:119]
    v_mfma_f32_16x16x32_bf16 a[120:123], v[84:87], v[104:107], a[120:123]
    v_mfma_f32_16x16x32_bf16 a[120:123], v[88:91], v[140:143], a[120:123]
    v_mfma_f32_16x16x32_bf16 a[124:127], v[84:87], v[108:111], a[124:127]
    v_mfma_f32_16x16x32_bf16 a[124:127], v[88:91], v[144:147], a[124:127]
    v_mfma_f32_16x16x32_bf16 a[128:131], v[84:87], v[112:115], a[128:131]
    v_mfma_f32_16x16x32_bf16 a[128:131], v[88:91], v[148:151], a[128:131]
    v_mfma_f32_16x16x32_bf16 a[132:135], v[84:87], v[116:119], a[132:135]
    v_mfma_f32_16x16x32_bf16 a[132:135], v[88:91], v[152:155], a[132:135]
    v_mfma_f32_16x16x32_bf16 a[136:139], v[84:87], v[120:123], a[136:139]
    v_mfma_f32_16x16x32_bf16 a[136:139], v[88:91], v[156:159], a[136:139]
    v_mfma_f32_16x16x32_bf16 a[140:143], v[84:87], v[124:127], a[140:143]
    v_mfma_f32_16x16x32_bf16 a[140:143], v[88:91], v[160:163], a[140:143]
    ds_read_b64_tr_b16 v[84:85], v25 offset:0
    ds_read_b64_tr_b16 v[86:87], v25 offset:1024
    ds_read_b64_tr_b16 v[88:89], v25 offset:8192
    ds_read_b64_tr_b16 v[90:91], v25 offset:9216
    s_waitcnt lgkmcnt(12)
    v_mfma_f32_16x16x32_bf16 a[144:147], v[60:63], v[92:95], a[144:147]
    v_mfma_f32_16x16x32_bf16 a[144:147], v[64:67], v[128:131], a[144:147]
    v_mfma_f32_16x16x32_bf16 a[148:151], v[60:63], v[96:99], a[148:151]
    v_mfma_f32_16x16x32_bf16 a[148:151], v[64:67], v[132:135], a[148:151]
    v_mfma_f32_16x16x32_bf16 a[152:155], v[60:63], v[100:103], a[152:155]
    v_mfma_f32_16x16x32_bf16 a[152:155], v[64:67], v[136:139], a[152:155]
    v_mfma_f32_16x16x32_bf16 a[156:159], v[60:63], v[104:107], a[156:159]
    v_mfma_f32_16x16x32_bf16 a[156:159], v[64:67], v[140:143], a[156:159]
    v_mfma_f32_16x16x32_bf16 a[160:163], v[60:63], v[108:111], a[160:163]
    v_mfma_f32_16x16x32_bf16 a[160:163], v[64:67], v[144:147], a[160:163]
    v_mfma_f32_16x16x32_bf16 a[164:167], v[60:63], v[112:115], a[164:167]
    v_mfma_f32_16x16x32_bf16 a[164:167], v[64:67], v[148:151], a[164:167]
    v_mfma_f32_16x16x32_bf16 a[168:171], v[60:63], v[116:119], a[168:171]
    v_mfma_f32_16x16x32_bf16 a[168:171], v[64:67], v[152:155], a[168:171]
    v_mfma_f32_16x16x32_bf16 v[36:39], v[60:63], v[120:123], v[36:39]
    v_mfma_f32_16x16x32_bf16 v[36:39], v[64:67], v[156:159], v[36:39]
    v_mfma_f32_16x16x32_bf16 v[52:55], v[60:63], v[124:127], v[52:55]
    v_mfma_f32_16x16x32_bf16 v[52:55], v[64:67], v[160:163], v[52:55]
    s_waitcnt vmcnt(18)
    ds_read_b64_tr_b16 v[60:61], v18 offset:16384
    ds_read_b64_tr_b16 v[62:63], v18 offset:17408
    ds_read_b64_tr_b16 v[64:65], v18 offset:24576
    ds_read_b64_tr_b16 v[66:67], v18 offset:25600
    s_waitcnt lgkmcnt(12)
    v_mfma_f32_16x16x32_bf16 a[172:175], v[68:71], v[92:95], a[172:175]
    v_mfma_f32_16x16x32_bf16 a[172:175], v[72:75], v[128:131], a[172:175]
    v_mfma_f32_16x16x32_bf16 a[176:179], v[68:71], v[96:99], a[176:179]
    v_mfma_f32_16x16x32_bf16 a[176:179], v[72:75], v[132:135], a[176:179]
    v_mfma_f32_16x16x32_bf16 a[180:183], v[68:71], v[100:103], a[180:183]
    v_mfma_f32_16x16x32_bf16 a[180:183], v[72:75], v[136:139], a[180:183]
    v_mfma_f32_16x16x32_bf16 a[184:187], v[68:71], v[104:107], a[184:187]
    v_mfma_f32_16x16x32_bf16 a[184:187], v[72:75], v[140:143], a[184:187]
    v_mfma_f32_16x16x32_bf16 a[188:191], v[68:71], v[108:111], a[188:191]
    v_mfma_f32_16x16x32_bf16 a[188:191], v[72:75], v[144:147], a[188:191]
    v_mfma_f32_16x16x32_bf16 a[192:195], v[68:71], v[112:115], a[192:195]
    v_mfma_f32_16x16x32_bf16 a[192:195], v[72:75], v[148:151], a[192:195]
    v_mfma_f32_16x16x32_bf16 a[196:199], v[68:71], v[116:119], a[196:199]
    v_mfma_f32_16x16x32_bf16 a[196:199], v[72:75], v[152:155], a[196:199]
    v_mfma_f32_16x16x32_bf16 v[40:43], v[68:71], v[120:123], v[40:43]
    v_mfma_f32_16x16x32_bf16 v[40:43], v[72:75], v[156:159], v[40:43]
    v_mfma_f32_16x16x32_bf16 v[56:59], v[68:71], v[124:127], v[56:59]
    v_mfma_f32_16x16x32_bf16 v[56:59], v[72:75], v[160:163], v[56:59]
    ds_read_b64_tr_b16 v[68:69], v19 offset:16384
    ds_read_b64_tr_b16 v[70:71], v19 offset:17408
    ds_read_b64_tr_b16 v[72:73], v19 offset:24576
    ds_read_b64_tr_b16 v[74:75], v19 offset:25600
    s_waitcnt lgkmcnt(12)
    v_mfma_f32_16x16x32_bf16 a[200:203], v[76:79], v[92:95], a[200:203]
    v_mfma_f32_16x16x32_bf16 a[200:203], v[80:83], v[128:131], a[200:203]
    v_mfma_f32_16x16x32_bf16 a[204:207], v[76:79], v[96:99], a[204:207]
    v_mfma_f32_16x16x32_bf16 a[204:207], v[80:83], v[132:135], a[204:207]
    v_mfma_f32_16x16x32_bf16 a[208:211], v[76:79], v[100:103], a[208:211]
    v_mfma_f32_16x16x32_bf16 a[208:211], v[80:83], v[136:139], a[208:211]
    v_mfma_f32_16x16x32_bf16 a[212:215], v[76:79], v[104:107], a[212:215]
    v_mfma_f32_16x16x32_bf16 a[212:215], v[80:83], v[140:143], a[212:215]
    v_mfma_f32_16x16x32_bf16 v[244:247], v[76:79], v[108:111], v[244:247]
    v_mfma_f32_16x16x32_bf16 v[244:247], v[80:83], v[144:147], v[244:247]
    v_mfma_f32_16x16x32_bf16 a[216:219], v[76:79], v[112:115], a[216:219]
    v_mfma_f32_16x16x32_bf16 a[216:219], v[80:83], v[148:151], a[216:219]
    v_mfma_f32_16x16x32_bf16 v[28:31], v[76:79], v[116:119], v[28:31]
    v_mfma_f32_16x16x32_bf16 v[28:31], v[80:83], v[152:155], v[28:31]
    v_mfma_f32_16x16x32_bf16 v[44:47], v[76:79], v[120:123], v[44:47]
    v_mfma_f32_16x16x32_bf16 v[44:47], v[80:83], v[156:159], v[44:47]
    v_mfma_f32_16x16x32_bf16 v[236:239], v[76:79], v[124:127], v[236:239]
    v_mfma_f32_16x16x32_bf16 v[236:239], v[80:83], v[160:163], v[236:239]
    ds_read_b64_tr_b16 v[76:77], v20 offset:16384
    ds_read_b64_tr_b16 v[78:79], v20 offset:17408
    ds_read_b64_tr_b16 v[80:81], v20 offset:24576
    ds_read_b64_tr_b16 v[82:83], v20 offset:25600
    s_waitcnt lgkmcnt(12)
    v_mfma_f32_16x16x32_bf16 a[220:223], v[84:87], v[92:95], a[220:223]
    v_mfma_f32_16x16x32_bf16 a[220:223], v[88:91], v[128:131], a[220:223]
    v_mfma_f32_16x16x32_bf16 a[224:227], v[84:87], v[96:99], a[224:227]
    v_mfma_f32_16x16x32_bf16 a[224:227], v[88:91], v[132:135], a[224:227]
    v_mfma_f32_16x16x32_bf16 a[228:231], v[84:87], v[100:103], a[228:231]
    v_mfma_f32_16x16x32_bf16 a[228:231], v[88:91], v[136:139], a[228:231]
    v_mfma_f32_16x16x32_bf16 a[232:235], v[84:87], v[104:107], a[232:235]
    v_mfma_f32_16x16x32_bf16 a[232:235], v[88:91], v[140:143], a[232:235]
    v_mfma_f32_16x16x32_bf16 v[248:251], v[84:87], v[108:111], v[248:251]
    v_mfma_f32_16x16x32_bf16 v[248:251], v[88:91], v[144:147], v[248:251]
    v_mfma_f32_16x16x32_bf16 a[236:239], v[84:87], v[112:115], a[236:239]
    v_mfma_f32_16x16x32_bf16 a[236:239], v[88:91], v[148:151], a[236:239]
    v_mfma_f32_16x16x32_bf16 v[32:35], v[84:87], v[116:119], v[32:35]
    v_mfma_f32_16x16x32_bf16 v[32:35], v[88:91], v[152:155], v[32:35]
    v_mfma_f32_16x16x32_bf16 v[48:51], v[84:87], v[120:123], v[48:51]
    v_mfma_f32_16x16x32_bf16 v[48:51], v[88:91], v[156:159], v[48:51]
    v_mfma_f32_16x16x32_bf16 v[240:243], v[84:87], v[124:127], v[240:243]
    v_mfma_f32_16x16x32_bf16 v[240:243], v[88:91], v[160:163], v[240:243]
    ds_read_b64_tr_b16 v[84:85], v21 offset:16384
    ds_read_b64_tr_b16 v[86:87], v21 offset:17408
    ds_read_b64_tr_b16 v[88:89], v21 offset:24576
    ds_read_b64_tr_b16 v[90:91], v21 offset:25600
    s_waitcnt vmcnt(0) lgkmcnt(12)
    v_mfma_f32_16x16x32_bf16 a[0:3], v[60:63], v[164:167], a[0:3]
    ds_read_b64_tr_b16 v[92:93], v22 offset:16384
    ds_read_b64_tr_b16 v[94:95], v22 offset:17408
    v_mfma_f32_16x16x32_bf16 a[0:3], v[64:67], v[200:203], a[0:3]
    ds_read_b64_tr_b16 v[96:97], v22 offset:24576
    ds_read_b64_tr_b16 v[98:99], v22 offset:25600
    v_mfma_f32_16x16x32_bf16 a[4:7], v[60:63], v[168:171], a[4:7]
    ds_read_b64_tr_b16 v[100:101], v23 offset:16384
    ds_read_b64_tr_b16 v[102:103], v23 offset:17408
    v_mfma_f32_16x16x32_bf16 a[4:7], v[64:67], v[204:207], a[4:7]
    ds_read_b64_tr_b16 v[104:105], v23 offset:24576
    ds_read_b64_tr_b16 v[106:107], v23 offset:25600
    v_mfma_f32_16x16x32_bf16 a[8:11], v[60:63], v[172:175], a[8:11]
    ds_read_b64_tr_b16 v[108:109], v24 offset:16384
    ds_read_b64_tr_b16 v[110:111], v24 offset:17408
    v_mfma_f32_16x16x32_bf16 a[8:11], v[64:67], v[208:211], a[8:11]
    ds_read_b64_tr_b16 v[112:113], v24 offset:24576
    ds_read_b64_tr_b16 v[114:115], v24 offset:25600
    v_mfma_f32_16x16x32_bf16 a[20:23], v[60:63], v[184:187], a[20:23]
    ds_read_b64_tr_b16 v[116:117], v25 offset:16384
    ds_read_b64_tr_b16 v[118:119], v25 offset:17408
    v_mfma_f32_16x16x32_bf16 a[20:23], v[64:67], v[220:223], a[20:23]
    ds_read_b64_tr_b16 v[120:121], v25 offset:24576
    ds_read_b64_tr_b16 v[122:123], v25 offset:25600
    v_mfma_f32_16x16x32_bf16 a[24:27], v[60:63], v[188:191], a[24:27]
    ds_write_b128 v8, a[0:3] offset:2048
    v_mfma_f32_16x16x32_bf16 a[24:27], v[64:67], v[224:227], a[24:27]
    v_mfma_f32_16x16x32_bf16 a[28:31], v[60:63], v[192:195], a[28:31]
    v_mfma_f32_16x16x32_bf16 a[28:31], v[64:67], v[228:231], a[28:31]
    ds_write_b128 v8, a[4:7] offset:6144
    v_mfma_f32_16x16x32_bf16 a[32:35], v[60:63], v[196:199], a[32:35]
    v_mfma_f32_16x16x32_bf16 a[32:35], v[64:67], v[232:235], a[32:35]
    s_waitcnt lgkmcnt(15)
    v_mfma_f32_16x16x32_bf16 a[36:39], v[68:71], v[164:167], a[36:39]
    ds_write_b128 v8, a[8:11] offset:10240
    v_mfma_f32_16x16x32_bf16 a[36:39], v[72:75], v[200:203], a[36:39]
    v_mfma_f32_16x16x32_bf16 a[40:43], v[68:71], v[168:171], a[40:43]
    v_mfma_f32_16x16x32_bf16 a[40:43], v[72:75], v[204:207], a[40:43]
    ds_write_b128 v8, a[20:23] offset:14336
    v_mfma_f32_16x16x32_bf16 a[44:47], v[68:71], v[172:175], a[44:47]
    v_mfma_f32_16x16x32_bf16 a[44:47], v[72:75], v[208:211], a[44:47]
    v_mfma_f32_16x16x32_bf16 a[56:59], v[68:71], v[184:187], a[56:59]
    ds_write_b128 v8, a[24:27] offset:18432
    v_mfma_f32_16x16x32_bf16 a[56:59], v[72:75], v[220:223], a[56:59]
    v_mfma_f32_16x16x32_bf16 a[60:63], v[68:71], v[188:191], a[60:63]
    v_mfma_f32_16x16x32_bf16 a[60:63], v[72:75], v[224:227], a[60:63]
    ds_write_b128 v8, a[28:31] offset:22528
    v_mfma_f32_16x16x32_bf16 a[64:67], v[68:71], v[192:195], a[64:67]
    v_mfma_f32_16x16x32_bf16 a[64:67], v[72:75], v[228:231], a[64:67]
    v_mfma_f32_16x16x32_bf16 a[72:75], v[76:79], v[164:167], a[72:75]
    ds_write_b128 v8, a[32:35] offset:26624
    v_mfma_f32_16x16x32_bf16 a[72:75], v[80:83], v[200:203], a[72:75]
    v_mfma_f32_16x16x32_bf16 a[76:79], v[76:79], v[168:171], a[76:79]
    v_mfma_f32_16x16x32_bf16 a[76:79], v[80:83], v[204:207], a[76:79]
    ds_write_b128 v8, a[36:39] offset:3072
    v_mfma_f32_16x16x32_bf16 a[80:83], v[76:79], v[172:175], a[80:83]
    v_mfma_f32_16x16x32_bf16 a[80:83], v[80:83], v[208:211], a[80:83]
    v_mfma_f32_16x16x32_bf16 a[84:87], v[76:79], v[176:179], a[84:87]
    ds_write_b128 v8, a[40:43] offset:7168
    v_mfma_f32_16x16x32_bf16 a[84:87], v[80:83], v[212:215], a[84:87]
    v_mfma_f32_16x16x32_bf16 a[92:95], v[76:79], v[184:187], a[92:95]
    v_mfma_f32_16x16x32_bf16 a[92:95], v[80:83], v[220:223], a[92:95]
    ds_write_b128 v8, a[44:47] offset:11264
    v_mfma_f32_16x16x32_bf16 a[96:99], v[76:79], v[188:191], a[96:99]
    v_mfma_f32_16x16x32_bf16 a[96:99], v[80:83], v[224:227], a[96:99]
    v_mfma_f32_16x16x32_bf16 a[100:103], v[76:79], v[192:195], a[100:103]
    ds_write_b128 v8, a[56:59] offset:15360
    v_mfma_f32_16x16x32_bf16 a[100:103], v[80:83], v[228:231], a[100:103]
    v_mfma_f32_16x16x32_bf16 a[108:111], v[84:87], v[164:167], a[108:111]
    v_mfma_f32_16x16x32_bf16 a[108:111], v[88:91], v[200:203], a[108:111]
    ds_write_b128 v8, a[60:63] offset:19456
    v_mfma_f32_16x16x32_bf16 a[112:115], v[84:87], v[168:171], a[112:115]
    v_mfma_f32_16x16x32_bf16 a[112:115], v[88:91], v[204:207], a[112:115]
    v_mfma_f32_16x16x32_bf16 a[116:119], v[84:87], v[172:175], a[116:119]
    ds_write_b128 v8, a[64:67] offset:23552
    v_mfma_f32_16x16x32_bf16 a[116:119], v[88:91], v[208:211], a[116:119]
    v_mfma_f32_16x16x32_bf16 a[120:123], v[84:87], v[176:179], a[120:123]
    v_mfma_f32_16x16x32_bf16 a[120:123], v[88:91], v[212:215], a[120:123]
    ds_write_b128 v8, a[72:75] offset:0
    v_mfma_f32_16x16x32_bf16 a[128:131], v[84:87], v[184:187], a[128:131]
    v_mfma_f32_16x16x32_bf16 a[128:131], v[88:91], v[220:223], a[128:131]
    v_mfma_f32_16x16x32_bf16 a[132:135], v[84:87], v[188:191], a[132:135]
    ds_write_b128 v8, a[76:79] offset:4096
    v_mfma_f32_16x16x32_bf16 a[132:135], v[88:91], v[224:227], a[132:135]
    v_mfma_f32_16x16x32_bf16 a[136:139], v[84:87], v[192:195], a[136:139]
    v_mfma_f32_16x16x32_bf16 a[136:139], v[88:91], v[228:231], a[136:139]
    ds_write_b128 v8, a[80:83] offset:8192
    s_waitcnt lgkmcnt(15)
    v_mfma_f32_16x16x32_bf16 a[200:203], v[108:111], v[164:167], a[200:203]
    v_mfma_f32_16x16x32_bf16 a[200:203], v[112:115], v[200:203], a[200:203]
    v_mfma_f32_16x16x32_bf16 a[220:223], v[116:119], v[164:167], a[220:223]
    ds_write_b128 v8, a[84:87] offset:12288
    v_mfma_f32_16x16x32_bf16 a[220:223], v[120:123], v[200:203], a[220:223]
    v_mfma_f32_16x16x32_bf16 a[144:147], v[92:95], v[164:167], a[144:147]
    v_mfma_f32_16x16x32_bf16 a[144:147], v[96:99], v[200:203], a[144:147]
    ds_write_b128 v8, a[92:95] offset:16384
    v_mfma_f32_16x16x32_bf16 a[172:175], v[100:103], v[164:167], a[172:175]
    v_mfma_f32_16x16x32_bf16 a[172:175], v[104:107], v[200:203], a[172:175]
    v_mfma_f32_16x16x32_bf16 a[204:207], v[108:111], v[168:171], a[204:207]
    ds_write_b128 v8, a[96:99] offset:20480
    v_mfma_f32_16x16x32_bf16 a[204:207], v[112:115], v[204:207], a[204:207]
    v_mfma_f32_16x16x32_bf16 a[224:227], v[116:119], v[168:171], a[224:227]
    v_mfma_f32_16x16x32_bf16 a[224:227], v[120:123], v[204:207], a[224:227]
    ds_write_b128 v8, a[100:103] offset:24576
    v_mfma_f32_16x16x32_bf16 a[148:151], v[92:95], v[168:171], a[148:151]
    v_mfma_f32_16x16x32_bf16 a[148:151], v[96:99], v[204:207], a[148:151]
    v_mfma_f32_16x16x32_bf16 a[176:179], v[100:103], v[168:171], a[176:179]
    ds_write_b128 v8, a[108:111] offset:1024
    v_mfma_f32_16x16x32_bf16 a[176:179], v[104:107], v[204:207], a[176:179]
    v_mfma_f32_16x16x32_bf16 a[208:211], v[108:111], v[172:175], a[208:211]
    v_mfma_f32_16x16x32_bf16 a[208:211], v[112:115], v[208:211], a[208:211]
    ds_write_b128 v8, a[112:115] offset:5120
    v_mfma_f32_16x16x32_bf16 a[228:231], v[116:119], v[172:175], a[228:231]
    v_mfma_f32_16x16x32_bf16 a[228:231], v[120:123], v[208:211], a[228:231]
    v_mfma_f32_16x16x32_bf16 a[152:155], v[92:95], v[172:175], a[152:155]
    ds_write_b128 v8, a[116:119] offset:9216
    v_mfma_f32_16x16x32_bf16 a[152:155], v[96:99], v[208:211], a[152:155]
    v_mfma_f32_16x16x32_bf16 a[180:183], v[100:103], v[172:175], a[180:183]
    v_mfma_f32_16x16x32_bf16 a[180:183], v[104:107], v[208:211], a[180:183]
    ds_write_b128 v8, a[120:123] offset:13312
    v_mfma_f32_16x16x32_bf16 a[212:215], v[108:111], v[176:179], a[212:215]
    v_mfma_f32_16x16x32_bf16 a[212:215], v[112:115], v[212:215], a[212:215]
    v_mfma_f32_16x16x32_bf16 a[12:15], v[60:63], v[176:179], a[12:15]
    ds_write_b128 v8, a[128:131] offset:17408
    v_mfma_f32_16x16x32_bf16 a[12:15], v[64:67], v[212:215], a[12:15]
    v_mfma_f32_16x16x32_bf16 a[48:51], v[68:71], v[176:179], a[48:51]
    v_mfma_f32_16x16x32_bf16 a[48:51], v[72:75], v[212:215], a[48:51]
    ds_write_b128 v8, a[132:135] offset:21504
    v_mfma_f32_16x16x32_bf16 a[16:19], v[60:63], v[180:183], a[16:19]
    v_mfma_f32_16x16x32_bf16 a[16:19], v[64:67], v[216:219], a[16:19]
    v_mfma_f32_16x16x32_bf16 a[52:55], v[68:71], v[180:183], a[52:55]
    ds_write_b128 v8, a[136:139] offset:25600
    v_mfma_f32_16x16x32_bf16 a[52:55], v[72:75], v[216:219], a[52:55]
    v_mfma_f32_16x16x32_bf16 a[68:71], v[68:71], v[196:199], a[68:71]
    v_mfma_f32_16x16x32_bf16 a[68:71], v[72:75], v[232:235], a[68:71]
    ds_write_b128 v8, a[200:203] offset:27648
    v_mfma_f32_16x16x32_bf16 a[104:107], v[76:79], v[196:199], a[104:107]
    v_mfma_f32_16x16x32_bf16 a[104:107], v[80:83], v[232:235], a[104:107]
    v_mfma_f32_16x16x32_bf16 a[140:143], v[84:87], v[196:199], a[140:143]
    ds_write_b128 v8, a[220:223] offset:28672
    v_mfma_f32_16x16x32_bf16 a[140:143], v[88:91], v[232:235], a[140:143]
    v_mfma_f32_16x16x32_bf16 a[88:91], v[76:79], v[180:183], a[88:91]
    v_mfma_f32_16x16x32_bf16 a[88:91], v[80:83], v[216:219], a[88:91]
    ds_write_b128 v8, a[144:147] offset:29696
    v_mfma_f32_16x16x32_bf16 a[124:127], v[84:87], v[180:183], a[124:127]
    v_mfma_f32_16x16x32_bf16 a[124:127], v[88:91], v[216:219], a[124:127]
    v_mfma_f32_16x16x32_bf16 a[232:235], v[116:119], v[176:179], a[232:235]
    ds_write_b128 v8, a[172:175] offset:30720
    v_mfma_f32_16x16x32_bf16 a[232:235], v[120:123], v[212:215], a[232:235]
    v_mfma_f32_16x16x32_bf16 a[156:159], v[92:95], v[176:179], a[156:159]
    v_mfma_f32_16x16x32_bf16 a[156:159], v[96:99], v[212:215], a[156:159]
    ds_write_b128 v8, a[204:207] offset:31744
    v_mfma_f32_16x16x32_bf16 a[184:187], v[100:103], v[176:179], a[184:187]
    v_mfma_f32_16x16x32_bf16 a[184:187], v[104:107], v[212:215], a[184:187]
    v_mfma_f32_16x16x32_bf16 a[160:163], v[92:95], v[180:183], a[160:163]
    ds_write_b128 v8, a[224:227] offset:32768
    v_mfma_f32_16x16x32_bf16 a[160:163], v[96:99], v[216:219], a[160:163]
    v_mfma_f32_16x16x32_bf16 a[188:191], v[100:103], v[180:183], a[188:191]
    v_mfma_f32_16x16x32_bf16 a[188:191], v[104:107], v[216:219], a[188:191]
    ds_write_b128 v8, a[148:151] offset:33792
    v_mfma_f32_16x16x32_bf16 a[164:167], v[92:95], v[184:187], a[164:167]
    v_mfma_f32_16x16x32_bf16 a[164:167], v[96:99], v[220:223], a[164:167]
    v_mfma_f32_16x16x32_bf16 a[192:195], v[100:103], v[184:187], a[192:195]
    ds_write_b128 v8, a[176:179] offset:34816
    v_mfma_f32_16x16x32_bf16 a[192:195], v[104:107], v[220:223], a[192:195]
    v_mfma_f32_16x16x32_bf16 a[216:219], v[108:111], v[184:187], a[216:219]
    v_mfma_f32_16x16x32_bf16 a[216:219], v[112:115], v[220:223], a[216:219]
    ds_write_b128 v8, a[208:211] offset:35840
    v_mfma_f32_16x16x32_bf16 a[236:239], v[116:119], v[184:187], a[236:239]
    v_mfma_f32_16x16x32_bf16 a[236:239], v[120:123], v[220:223], a[236:239]
    v_mfma_f32_16x16x32_bf16 a[168:171], v[92:95], v[188:191], a[168:171]
    ds_write_b128 v8, a[228:231] offset:36864
    v_mfma_f32_16x16x32_bf16 a[168:171], v[96:99], v[224:227], a[168:171]
    v_mfma_f32_16x16x32_bf16 a[196:199], v[100:103], v[188:191], a[196:199]
    v_mfma_f32_16x16x32_bf16 a[196:199], v[104:107], v[224:227], a[196:199]
    ds_write_b128 v8, a[152:155] offset:37888
    v_mfma_f32_16x16x32_bf16 v[28:31], v[108:111], v[188:191], v[28:31]
    v_mfma_f32_16x16x32_bf16 v[28:31], v[112:115], v[224:227], v[28:31]
    v_mfma_f32_16x16x32_bf16 v[32:35], v[116:119], v[188:191], v[32:35]
    ds_write_b128 v8, a[180:183] offset:38912
    v_mfma_f32_16x16x32_bf16 v[32:35], v[120:123], v[224:227], v[32:35]
    v_mfma_f32_16x16x32_bf16 v[36:39], v[92:95], v[192:195], v[36:39]
    v_mfma_f32_16x16x32_bf16 v[36:39], v[96:99], v[228:231], v[36:39]
    ds_write_b128 v8, a[212:215] offset:39936
    v_mfma_f32_16x16x32_bf16 v[40:43], v[100:103], v[192:195], v[40:43]
    v_mfma_f32_16x16x32_bf16 v[40:43], v[104:107], v[228:231], v[40:43]
    v_mfma_f32_16x16x32_bf16 v[44:47], v[108:111], v[192:195], v[44:47]
    v_mfma_f32_16x16x32_bf16 v[44:47], v[112:115], v[228:231], v[44:47]
    v_mfma_f32_16x16x32_bf16 v[48:51], v[116:119], v[192:195], v[48:51]
    v_mfma_f32_16x16x32_bf16 v[48:51], v[120:123], v[228:231], v[48:51]
    v_mfma_f32_16x16x32_bf16 v[52:55], v[92:95], v[196:199], v[52:55]
    v_mfma_f32_16x16x32_bf16 v[52:55], v[96:99], v[232:235], v[52:55]
    v_mfma_f32_16x16x32_bf16 v[56:59], v[100:103], v[196:199], v[56:59]
    v_mfma_f32_16x16x32_bf16 v[56:59], v[104:107], v[232:235], v[56:59]
    v_mfma_f32_16x16x32_bf16 v[236:239], v[108:111], v[196:199], v[236:239]
    v_mfma_f32_16x16x32_bf16 v[236:239], v[112:115], v[232:235], v[236:239]
    v_mfma_f32_16x16x32_bf16 v[240:243], v[116:119], v[196:199], v[240:243]
    v_mfma_f32_16x16x32_bf16 v[240:243], v[120:123], v[232:235], v[240:243]
    v_mfma_f32_16x16x32_bf16 v[244:247], v[108:111], v[180:183], v[244:247]
    v_mfma_f32_16x16x32_bf16 v[244:247], v[112:115], v[216:219], v[244:247]
    v_mfma_f32_16x16x32_bf16 v[248:251], v[116:119], v[180:183], v[248:251]
    v_mfma_f32_16x16x32_bf16 v[248:251], v[120:123], v[216:219], v[248:251]
    s_and_b32 s62, s20, 1
    s_lshl_b32 s62, s62, 7
    s_add_u32 s23, s24, s62
    s_lshr_b32 s62, s20, 1
    s_lshl_b32 s59, s62, 6
    s_add_u32 s59, s59, s23
    s_add_u32 s59, s59, 163840
    s_mul_i32 s62, s62, 5
    s_mul_i32 s22, s62, 40960
    s_add_u32 s23, s23, s22
    s_add_u32 s62, s62, s31
    s_add_u32 s62, s62, 3
    s_cmp_ge_u32 s62, 224
    s_cselect_b32 s22, 0x40000000, 0
    s_add_u32 s22, s22, 122880
    s_add_u32 s22, s22, s23
    s_waitcnt lgkmcnt(0)
    s_barrier
    ds_read_b128 v[60:63], v2 offset:0
    ds_read_b128 v[64:67], v2 offset:1024
    ds_read_b128 v[68:71], v2 offset:2048
    ds_read_b128 v[72:75], v2 offset:3072
    ds_read_b128 v[76:79], v3 offset:14336
    ds_read_b128 v[80:83], v3 offset:15360
    ds_read_b128 v[84:87], v3 offset:16384
    ds_read_b128 v[88:91], v3 offset:17408
    ds_read_b128 v[92:95], v4 offset:27648
    ds_read_b128 v[96:99], v4 offset:28672
    ds_read_b128 v[100:103], v4 offset:29696
    ds_read_b128 v[104:107], v4 offset:30720
    v_accvgpr_read_b32 v220, a164
    v_accvgpr_read_b32 v221, a165
    v_accvgpr_read_b32 v222, a166
    v_accvgpr_read_b32 v223, a167
    v_accvgpr_read_b32 v224, a192
    v_accvgpr_read_b32 v225, a193
    v_accvgpr_read_b32 v226, a194
    v_accvgpr_read_b32 v227, a195
    v_accvgpr_read_b32 v228, a216
    v_accvgpr_read_b32 v229, a217
    v_accvgpr_read_b32 v230, a218
    v_accvgpr_read_b32 v231, a219
    v_accvgpr_read_b32 v232, a236
    v_accvgpr_read_b32 v233, a237
    v_accvgpr_read_b32 v234, a238
    v_accvgpr_read_b32 v235, a239
    v_accvgpr_read_b32 v10, a168
    v_accvgpr_read_b32 v11, a169
    v_accvgpr_read_b32 v12, a170
    v_accvgpr_read_b32 v13, a171
    v_accvgpr_read_b32 v14, a196
    v_accvgpr_read_b32 v15, a197
    v_accvgpr_read_b32 v16, a198
    v_accvgpr_read_b32 v17, a199
    ds_read_b128 v[108:111], v2 offset:4096
    ds_read_b128 v[112:115], v2 offset:5120
    ds_read_b128 v[116:119], v2 offset:6144
    ds_read_b128 v[120:123], v2 offset:7168
    ds_read_b128 v[124:127], v3 offset:18432
    ds_read_b128 v[128:131], v3 offset:19456
    ds_read_b128 v[132:135], v3 offset:20480
    ds_read_b128 v[136:139], v3 offset:21504
    ds_read_b128 v[140:143], v4 offset:31744
    ds_read_b128 v[144:147], v4 offset:32768
    ds_read_b128 v[148:151], v4 offset:33792
    ds_read_b128 v[152:155], v4 offset:34816
    s_waitcnt lgkmcnt(12)
    v_pk_add_f32 v[76:77], v[76:77], v[92:93]
    v_pk_add_f32 v[78:79], v[78:79], v[94:95]
    ds_read_b128 v[156:159], v2 offset:8192
    v_pk_add_f32 v[80:81], v[80:81], v[96:97]
    v_pk_add_f32 v[82:83], v[82:83], v[98:99]
    ds_read_b128 v[160:163], v2 offset:9216
    v_pk_add_f32 v[84:85], v[84:85], v[100:101]
    v_pk_add_f32 v[86:87], v[86:87], v[102:103]
    ds_read_b128 v[164:167], v2 offset:10240
    v_pk_add_f32 v[88:89], v[88:89], v[104:105]
    v_pk_add_f32 v[90:91], v[90:91], v[106:107]
    ds_read_b128 v[168:171], v2 offset:11264
    v_pk_add_f32 v[220:221], v[220:221], v[60:61]
    v_pk_add_f32 v[222:223], v[222:223], v[62:63]
    ds_read_b128 v[172:175], v3 offset:22528
    v_pk_add_f32 v[224:225], v[224:225], v[64:65]
    v_pk_add_f32 v[226:227], v[226:227], v[66:67]
    ds_read_b128 v[176:179], v3 offset:23552
    v_pk_add_f32 v[228:229], v[228:229], v[68:69]
    v_pk_add_f32 v[230:231], v[230:231], v[70:71]
    ds_read_b128 v[180:183], v3 offset:24576
    v_pk_add_f32 v[232:233], v[232:233], v[72:73]
    v_pk_add_f32 v[234:235], v[234:235], v[74:75]
    ds_read_b128 v[184:187], v3 offset:25600
    v_pk_add_f32 v[220:221], v[220:221], v[76:77]
    v_pk_add_f32 v[222:223], v[222:223], v[78:79]
    ds_read_b128 v[188:191], v4 offset:35840
    v_pk_add_f32 v[224:225], v[224:225], v[80:81]
    v_pk_add_f32 v[226:227], v[226:227], v[82:83]
    ds_read_b128 v[192:195], v4 offset:36864
    v_pk_add_f32 v[228:229], v[228:229], v[84:85]
    v_pk_add_f32 v[230:231], v[230:231], v[86:87]
    ds_read_b128 v[196:199], v4 offset:37888
    v_pk_add_f32 v[232:233], v[232:233], v[88:89]
    v_pk_add_f32 v[234:235], v[234:235], v[90:91]
    ds_read_b128 v[200:203], v4 offset:38912
    v_cvt_pk_bf16_f32 v60, v220, v221
    v_cvt_pk_bf16_f32 v61, v222, v223
    v_cvt_pk_bf16_f32 v62, v224, v225
    ds_read_b128 v[204:207], v2 offset:12288
    v_cvt_pk_bf16_f32 v63, v226, v227
    v_cvt_pk_bf16_f32 v64, v228, v229
    v_cvt_pk_bf16_f32 v65, v230, v231
    ds_read_b128 v[208:211], v3 offset:26624
    v_cvt_pk_bf16_f32 v66, v232, v233
    v_cvt_pk_bf16_f32 v67, v234, v235
    s_add_u32 s62, s23, 0
    ds_read_b128 v[212:215], v4 offset:39936
    v_permlane16_swap_b32 v60, v62
    v_permlane16_swap_b32 v61, v63
    v_permlane16_swap_b32 v64, v66
    ds_read_b128 v[216:219], v2 offset:13312
    v_permlane16_swap_b32 v65, v67
    s_mov_b64 vcc, s[64:65]
    s_nop 0
    v_cndmask_b32_dpp v68, v64, v60, vcc row_ror:8 row_mask:0xf bank_mask:0xf
    v_cndmask_b32_dpp v69, v65, v61, vcc row_ror:8 row_mask:0xf bank_mask:0xf
    v_cndmask_b32_dpp v70, v66, v62, vcc row_ror:8 row_mask:0xf bank_mask:0xf
    v_cndmask_b32_dpp v71, v67, v63, vcc row_ror:8 row_mask:0xf bank_mask:0xf
    s_mov_b64 vcc, s[66:67]
    buffer_store_dwordx4 v[68:71], v26, s[12:15], s62 offen sc0 sc1
    v_cndmask_b32_dpp v72, v64, v60, vcc row_ror:8 row_mask:0xf bank_mask:0xf
    v_cndmask_b32_dpp v73, v65, v61, vcc row_ror:8 row_mask:0xf bank_mask:0xf
    v_cndmask_b32_dpp v74, v66, v62, vcc row_ror:8 row_mask:0xf bank_mask:0xf
    v_cndmask_b32_dpp v75, v67, v63, vcc row_ror:8 row_mask:0xf bank_mask:0xf
    buffer_store_dwordx4 v[72:75], v27, s[12:15], s62 offen sc0 sc1
    s_waitcnt lgkmcnt(15)
    v_pk_add_f32 v[124:125], v[124:125], v[140:141]
    v_pk_add_f32 v[126:127], v[126:127], v[142:143]
    v_pk_add_f32 v[128:129], v[128:129], v[144:145]
    ds_write_b128 v2, a[12:15] offset:0
    v_pk_add_f32 v[130:131], v[130:131], v[146:147]
    v_pk_add_f32 v[132:133], v[132:133], v[148:149]
    v_pk_add_f32 v[134:135], v[134:135], v[150:151]
    ds_write_b128 v2, a[48:51] offset:1024
    v_pk_add_f32 v[136:137], v[136:137], v[152:153]
    v_pk_add_f32 v[138:139], v[138:139], v[154:155]
    v_pk_add_f32 v[10:11], v[10:11], v[108:109]
    ds_write_b128 v2, a[16:19] offset:2048
    v_pk_add_f32 v[12:13], v[12:13], v[110:111]
    v_pk_add_f32 v[14:15], v[14:15], v[112:113]
    v_pk_add_f32 v[16:17], v[16:17], v[114:115]
    ds_write_b128 v2, a[52:55] offset:3072
    v_pk_add_f32 v[28:29], v[28:29], v[116:117]
    v_pk_add_f32 v[30:31], v[30:31], v[118:119]
    v_pk_add_f32 v[32:33], v[32:33], v[120:121]
    ds_write_b128 v2, a[68:71] offset:4096
    v_pk_add_f32 v[34:35], v[34:35], v[122:123]
    v_pk_add_f32 v[10:11], v[10:11], v[124:125]
    v_pk_add_f32 v[12:13], v[12:13], v[126:127]
    ds_write_b128 v2, a[104:107] offset:5120
    v_pk_add_f32 v[14:15], v[14:15], v[128:129]
    v_pk_add_f32 v[16:17], v[16:17], v[130:131]
    v_pk_add_f32 v[28:29], v[28:29], v[132:133]
    ds_write_b128 v2, a[140:143] offset:6144
    v_pk_add_f32 v[30:31], v[30:31], v[134:135]
    v_pk_add_f32 v[32:33], v[32:33], v[136:137]
    v_pk_add_f32 v[34:35], v[34:35], v[138:139]
    ds_write_b128 v2, a[88:91] offset:7168
    v_cvt_pk_bf16_f32 v108, v10, v11
    v_cvt_pk_bf16_f32 v109, v12, v13
    v_cvt_pk_bf16_f32 v110, v14, v15
    ds_write_b128 v2, a[124:127] offset:8192
    v_cvt_pk_bf16_f32 v111, v16, v17
    v_cvt_pk_bf16_f32 v112, v28, v29
    v_cvt_pk_bf16_f32 v113, v30, v31
    ds_write_b128 v2, a[232:235] offset:9216
    v_cvt_pk_bf16_f32 v114, v32, v33
    v_cvt_pk_bf16_f32 v115, v34, v35
    s_add_u32 s62, s23, 40960
    ds_write_b128 v2, a[156:159] offset:10240
    v_permlane16_swap_b32 v108, v110
    v_permlane16_swap_b32 v109, v111
    v_permlane16_swap_b32 v112, v114
    ds_write_b128 v2, a[184:187] offset:11264
    v_permlane16_swap_b32 v113, v115
    s_mov_b64 vcc, s[64:65]
    s_nop 0
    ds_write_b128 v2, a[160:163] offset:12288
    v_cndmask_b32_dpp v116, v112, v108, vcc row_ror:8 row_mask:0xf bank_mask:0xf
    v_cndmask_b32_dpp v117, v113, v109, vcc row_ror:8 row_mask:0xf bank_mask:0xf
    v_cndmask_b32_dpp v118, v114, v110, vcc row_ror:8 row_mask:0xf bank_mask:0xf
    ds_write_b128 v2, a[188:191] offset:13312
    v_cndmask_b32_dpp v119, v115, v111, vcc row_ror:8 row_mask:0xf bank_mask:0xf
    s_mov_b64 vcc, s[66:67]
    buffer_store_dwordx4 v[116:119], v26, s[12:15], s62 offen sc0 sc1
    v_cndmask_b32_dpp v120, v112, v108, vcc row_ror:8 row_mask:0xf bank_mask:0xf
    v_cndmask_b32_dpp v121, v113, v109, vcc row_ror:8 row_mask:0xf bank_mask:0xf
    v_cndmask_b32_dpp v122, v114, v110, vcc row_ror:8 row_mask:0xf bank_mask:0xf
    v_cndmask_b32_dpp v123, v115, v111, vcc row_ror:8 row_mask:0xf bank_mask:0xf
    buffer_store_dwordx4 v[120:123], v27, s[12:15], s62 offen sc0 sc1
    s_waitcnt lgkmcnt(15)
    v_pk_add_f32 v[172:173], v[172:173], v[188:189]
    v_pk_add_f32 v[174:175], v[174:175], v[190:191]
    v_pk_add_f32 v[176:177], v[176:177], v[192:193]
    v_pk_add_f32 v[178:179], v[178:179], v[194:195]
    v_pk_add_f32 v[180:181], v[180:181], v[196:197]
    v_pk_add_f32 v[182:183], v[182:183], v[198:199]
    v_pk_add_f32 v[184:185], v[184:185], v[200:201]
    v_pk_add_f32 v[186:187], v[186:187], v[202:203]
    v_pk_add_f32 v[36:37], v[36:37], v[156:157]
    v_pk_add_f32 v[38:39], v[38:39], v[158:159]
    v_pk_add_f32 v[40:41], v[40:41], v[160:161]
    v_pk_add_f32 v[42:43], v[42:43], v[162:163]
    v_pk_add_f32 v[44:45], v[44:45], v[164:165]
    v_pk_add_f32 v[46:47], v[46:47], v[166:167]
    v_pk_add_f32 v[48:49], v[48:49], v[168:169]
    v_pk_add_f32 v[50:51], v[50:51], v[170:171]
    v_pk_add_f32 v[36:37], v[36:37], v[172:173]
    v_pk_add_f32 v[38:39], v[38:39], v[174:175]
    v_pk_add_f32 v[40:41], v[40:41], v[176:177]
    v_pk_add_f32 v[42:43], v[42:43], v[178:179]
    v_pk_add_f32 v[44:45], v[44:45], v[180:181]
    v_pk_add_f32 v[46:47], v[46:47], v[182:183]
    v_pk_add_f32 v[48:49], v[48:49], v[184:185]
    v_pk_add_f32 v[50:51], v[50:51], v[186:187]
    v_cvt_pk_bf16_f32 v156, v36, v37
    v_cvt_pk_bf16_f32 v157, v38, v39
    v_cvt_pk_bf16_f32 v158, v40, v41
    v_cvt_pk_bf16_f32 v159, v42, v43
    v_cvt_pk_bf16_f32 v160, v44, v45
    v_cvt_pk_bf16_f32 v161, v46, v47
    v_cvt_pk_bf16_f32 v162, v48, v49
    v_cvt_pk_bf16_f32 v163, v50, v51
    s_add_u32 s62, s23, 81920
    v_permlane16_swap_b32 v156, v158
    v_permlane16_swap_b32 v157, v159
    v_permlane16_swap_b32 v160, v162
    v_permlane16_swap_b32 v161, v163
    s_mov_b64 vcc, s[64:65]
    s_nop 0
    v_cndmask_b32_dpp v164, v160, v156, vcc row_ror:8 row_mask:0xf bank_mask:0xf
    v_cndmask_b32_dpp v165, v161, v157, vcc row_ror:8 row_mask:0xf bank_mask:0xf
    v_cndmask_b32_dpp v166, v162, v158, vcc row_ror:8 row_mask:0xf bank_mask:0xf
    v_cndmask_b32_dpp v167, v163, v159, vcc row_ror:8 row_mask:0xf bank_mask:0xf
    s_mov_b64 vcc, s[66:67]
    buffer_store_dwordx4 v[164:167], v26, s[12:15], s62 offen sc0 sc1
    v_cndmask_b32_dpp v168, v160, v156, vcc row_ror:8 row_mask:0xf bank_mask:0xf
    v_cndmask_b32_dpp v169, v161, v157, vcc row_ror:8 row_mask:0xf bank_mask:0xf
    v_cndmask_b32_dpp v170, v162, v158, vcc row_ror:8 row_mask:0xf bank_mask:0xf
    v_cndmask_b32_dpp v171, v163, v159, vcc row_ror:8 row_mask:0xf bank_mask:0xf
    buffer_store_dwordx4 v[168:171], v27, s[12:15], s62 offen sc0 sc1
    s_waitcnt lgkmcnt(14)
    v_pk_add_f32 v[208:209], v[208:209], v[212:213]
    v_pk_add_f32 v[210:211], v[210:211], v[214:215]
    v_pk_add_f32 v[52:53], v[52:53], v[204:205]
    v_pk_add_f32 v[54:55], v[54:55], v[206:207]
    v_pk_add_f32 v[52:53], v[52:53], v[208:209]
    v_pk_add_f32 v[54:55], v[54:55], v[210:211]
    v_pk_add_f32 v[56:57], v[56:57], v[216:217]
    v_pk_add_f32 v[58:59], v[58:59], v[218:219]
    s_waitcnt lgkmcnt(0)
    s_barrier
    ds_read_b128 v[76:79], v4 offset:4096
    ds_read_b128 v[80:83], v3 offset:9216
    ds_read_b128 v[84:87], v8 offset:0
    ds_read_b128 v[88:91], v4 offset:5120
    ds_read_b128 v[92:95], v3 offset:10240
    ds_read_b128 v[96:99], v8 offset:1024
    ds_read_b128 v[100:103], v4 offset:6144
    ds_read_b128 v[104:107], v3 offset:11264
    ds_read_b128 v[124:127], v8 offset:2048
    ds_read_b128 v[128:131], v4 offset:7168
    ds_read_b128 v[132:135], v3 offset:12288
    ds_read_b128 v[136:139], v8 offset:3072
    ds_read_b128 v[140:143], v4 offset:8192
    ds_read_b128 v[144:147], v3 offset:13312
    s_waitcnt lgkmcnt(6)
    v_pk_add_f32 v[76:77], v[76:77], v[80:81]
    v_pk_add_f32 v[78:79], v[78:79], v[82:83]
    v_pk_add_f32 v[56:57], v[56:57], v[76:77]
    v_pk_add_f32 v[58:59], v[58:59], v[78:79]
    v_pk_add_f32 v[88:89], v[88:89], v[92:93]
    v_pk_add_f32 v[90:91], v[90:91], v[94:95]
    v_pk_add_f32 v[100:101], v[100:101], v[104:105]
    v_pk_add_f32 v[102:103], v[102:103], v[106:107]
    v_pk_add_f32 v[236:237], v[236:237], v[84:85]
    v_pk_add_f32 v[238:239], v[238:239], v[86:87]
    v_pk_add_f32 v[240:241], v[240:241], v[96:97]
    v_pk_add_f32 v[242:243], v[242:243], v[98:99]
    v_pk_add_f32 v[236:237], v[236:237], v[88:89]
    v_pk_add_f32 v[238:239], v[238:239], v[90:91]
    v_pk_add_f32 v[240:241], v[240:241], v[100:101]
    v_pk_add_f32 v[242:243], v[242:243], v[102:103]
    v_cvt_pk_bf16_f32 v204, v52, v53
    v_cvt_pk_bf16_f32 v205, v54, v55
    v_cvt_pk_bf16_f32 v206, v56, v57
    v_cvt_pk_bf16_f32 v207, v58, v59
    v_cvt_pk_bf16_f32 v208, v236, v237
    v_cvt_pk_bf16_f32 v209, v238, v239
    v_cvt_pk_bf16_f32 v210, v240, v241
    v_cvt_pk_bf16_f32 v211, v242, v243
    s_mov_b32 s62, s22
    v_permlane16_swap_b32 v204, v206
    v_permlane16_swap_b32 v205, v207
    v_permlane16_swap_b32 v208, v210
    v_permlane16_swap_b32 v209, v211
    s_mov_b64 vcc, s[64:65]
    s_nop 0
    v_cndmask_b32_dpp v212, v208, v204, vcc row_ror:8 row_mask:0xf bank_mask:0xf
    v_cndmask_b32_dpp v213, v209, v205, vcc row_ror:8 row_mask:0xf bank_mask:0xf
    v_cndmask_b32_dpp v214, v210, v206, vcc row_ror:8 row_mask:0xf bank_mask:0xf
    v_cndmask_b32_dpp v215, v211, v207, vcc row_ror:8 row_mask:0xf bank_mask:0xf
    s_mov_b64 vcc, s[66:67]
    buffer_store_dwordx4 v[212:215], v26, s[12:15], s62 offen sc0 sc1
    v_cndmask_b32_dpp v216, v208, v204, vcc row_ror:8 row_mask:0xf bank_mask:0xf
    v_cndmask_b32_dpp v217, v209, v205, vcc row_ror:8 row_mask:0xf bank_mask:0xf
    v_cndmask_b32_dpp v218, v210, v206, vcc row_ror:8 row_mask:0xf bank_mask:0xf
    v_cndmask_b32_dpp v219, v211, v207, vcc row_ror:8 row_mask:0xf bank_mask:0xf
    buffer_store_dwordx4 v[216:219], v27, s[12:15], s62 offen sc0 sc1
    s_waitcnt lgkmcnt(0)
    v_pk_add_f32 v[128:129], v[128:129], v[132:133]
    v_pk_add_f32 v[130:131], v[130:131], v[134:135]
    v_pk_add_f32 v[140:141], v[140:141], v[144:145]
    v_pk_add_f32 v[142:143], v[142:143], v[146:147]
    v_pk_add_f32 v[244:245], v[244:245], v[124:125]
    v_pk_add_f32 v[246:247], v[246:247], v[126:127]
    v_pk_add_f32 v[248:249], v[248:249], v[136:137]
    v_pk_add_f32 v[250:251], v[250:251], v[138:139]
    v_pk_add_f32 v[244:245], v[244:245], v[128:129]
    v_pk_add_f32 v[246:247], v[246:247], v[130:131]
    v_pk_add_f32 v[248:249], v[248:249], v[140:141]
    v_pk_add_f32 v[250:251], v[250:251], v[142:143]
    v_cvt_pk_bf16_f32 v60, v244, v245
    v_cvt_pk_bf16_f32 v61, v246, v247
    v_cvt_pk_bf16_f32 v62, v248, v249
    v_cvt_pk_bf16_f32 v63, v250, v251
    s_nop 1
    v_permlane16_swap_b32 v60, v62
    v_permlane16_swap_b32 v61, v63
    buffer_store_dwordx4 v[60:63], v9, s[12:15], s59 offen sc0 sc1
L_op_end:
    s_endpgm
L_code_end:
.section .rodata,"a"
.p2align 6
.amdhsa_kernel fused_kernel
  .amdhsa_next_free_vgpr 512
  .amdhsa_next_free_sgpr 102
  .amdhsa_accum_offset 256
  .amdhsa_group_segment_fixed_size 0
  .amdhsa_kernarg_size 104
  .amdhsa_user_sgpr_count 2
  .amdhsa_user_sgpr_kernarg_segment_ptr 1
  .amdhsa_system_sgpr_workgroup_id_x 1
.end_amdhsa_kernel
.p2align 6
.amdhsa_kernel op_kernel
  .amdhsa_next_free_vgpr 512
  .amdhsa_next_free_sgpr 102
  .amdhsa_accum_offset 256
  .amdhsa_group_segment_fixed_size 0
  .amdhsa_kernarg_size 104
  .amdhsa_user_sgpr_count 2
  .amdhsa_user_sgpr_kernarg_segment_ptr 1
  .amdhsa_system_sgpr_workgroup_id_x 1
.end_amdhsa_kernel
```

```asm
; @launch kernel=fused_kernel grid=(256,1,1) block=(256,1,1) lds=163840
; @launch kernel=op_kernel grid=(256,1,1) block=(256,1,1) lds=163840
.amdgcn_target "amdgcn-amd-amdhsa--gfx950"
.text
.globl fused_kernel
.p2align 8
.type fused_kernel,@function
fused_kernel:
    s_cmp_ge_u32 s2, 256
    s_cbranch_scc1 L_at_end
    s_and_b32 s3, s2, 7
    s_lshl_b32 s3, s3, 5
    s_lshr_b32 s36, s2, 6
    s_lshl_b32 s36, s36, 3
    s_or_b32 s3, s3, s36
    s_bfe_u32 s36, s2, 0x30003
    s_or_b32 s2, s3, s36
    s_load_dwordx8 s[36:43], s[0:1], 0
    s_load_dwordx8 s[56:63], s[0:1], 40
    s_load_dwordx2 s[44:45], s[0:1], 96
    s_load_dwordx2 s[84:85], s[0:1], 32
    s_load_dwordx2 s[86:87], s[0:1], 72
    s_getpc_b64 s[72:73]
L_pc0:
    v_lshlrev_b32 v105, 7, v0
    v_add_u32 v104, 0, v105
    v_min_u32 v104, L_code_end - L_pc0 - 4, v104
    v_mov_b32 v107, s73
    v_add_co_u32 v106, vcc, s72, v104
    v_addc_co_u32 v107, vcc, 0, v107, vcc
    global_load_dword v108, v[106:107], off
    v_add_u32 v104, 32768, v105
    v_min_u32 v104, L_code_end - L_pc0 - 4, v104
    v_mov_b32 v107, s73
    v_add_co_u32 v106, vcc, s72, v104
    v_addc_co_u32 v107, vcc, 0, v107, vcc
    global_load_dword v108, v[106:107], off
    v_add_u32 v104, 65536, v105
    v_min_u32 v104, L_code_end - L_pc0 - 4, v104
    v_mov_b32 v107, s73
    v_add_co_u32 v106, vcc, s72, v104
    v_addc_co_u32 v107, vcc, 0, v107, vcc
    global_load_dword v108, v[106:107], off
    v_and_b32 v1, 63, v0
    v_lshrrev_b32 v2, 6, v0
    s_nop 0
    v_readfirstlane_b32 s20, v2
    s_waitcnt lgkmcnt(0)
    s_and_b32 s48, s20, 1
    s_lshr_b32 s35, s20, 1
    s_cmp_ge_u32 s2, 128
    s_cselect_b32 s36, s56, s36
    s_cselect_b32 s37, s57, s37
    s_cselect_b32 s38, s58, s38
    s_cselect_b32 s39, s59, s39
    s_cselect_b32 s40, s60, s40
    s_cselect_b32 s41, s61, s41
    s_cselect_b32 s42, s62, s42
    s_cselect_b32 s43, s63, s43
    s_cselect_b32 s84, s86, s84
    s_cselect_b32 s85, s87, s85
    s_mov_b32 s86, 5242880
    s_mov_b32 s87, 0x20000
    s_and_b32 s28, s2, 127
    s_lshl_b32 s29, s28, 20
    s_lshl_b32 s30, s35, 18
    s_add_u32 s29, s29, s30
    s_add_u32 s38, s38, s29
    s_addc_u32 s39, s39, 0
    s_add_u32 s40, s40, s29
    s_addc_u32 s41, s41, 0
    s_sub_u32 s30, 0x100000, s30
    s_mov_b32 s8, s38
    s_mov_b32 s9, s39
    s_mov_b32 s10, s30
    s_mov_b32 s11, 0x20000
    s_cmp_eq_u32 s48, 0
    s_cselect_b32 s4, s38, s40
    s_cselect_b32 s5, s39, s41
    s_mov_b32 s6, s30
    s_mov_b32 s7, 0x20000
    s_cselect_b32 s16, s42, s36
    s_cselect_b32 s17, s43, s37
    s_mov_b32 s28, 5242880
    s_mov_b32 s29, 4587520
    s_cselect_b32 s18, s28, s29
    s_mov_b32 s19, 0x20000
    s_mov_b32 s28, 262144
    s_mov_b32 s29, 64
    s_cselect_b32 s51, s28, s29
    s_cselect_b32 s52, 512, 0
    s_mov_b32 s28, 81920
    s_cselect_b32 s46, 128, s28
    s_mov_b32 s28, 81920
    s_cselect_b32 s47, s28, 0x40000000
    s_mov_b32 s28, 90112
    s_cselect_b32 s98, s28, 0x40000000
    s_mov_b32 s28, 1056
    s_mov_b32 s29, 1024
    s_cselect_b32 s53, s28, s29
    s_mov_b32 s28, 0
    s_mov_b32 s29, 0
    s_cselect_b32 s88, s28, s29
    s_mov_b32 s28, 8192
    s_mov_b32 s29, 10240
    s_cselect_b32 s89, s28, s29
    s_mov_b32 s28, 16384
    s_mov_b32 s29, 20480
    s_cselect_b32 s90, s28, s29
    s_mov_b32 s28, 24576
    s_mov_b32 s29, 30720
    s_cselect_b32 s91, s28, s29
    s_mov_b32 s28, 65536
    s_mov_b32 s29, 40960
    s_cselect_b32 s92, s28, s29
    s_mov_b32 s28, 73728
    s_mov_b32 s29, 51200
    s_cselect_b32 s93, s28, s29
    s_mov_b32 s28, 81920
    s_mov_b32 s29, 61440
    s_cselect_b32 s94, s28, s29
    s_mov_b32 s28, 90112
    s_mov_b32 s29, 71680
    s_cselect_b32 s95, s28, s29
    s_and_b32 s28, s2, 7
    s_lshl_b32 s28, s28, 2
    s_add_u32 s28, s28, s35
    s_lshl_b32 s28, s28, 8
    s_bfe_u32 s29, s2, 262147
    s_lshl_b32 s29, s29, 1
    s_add_u32 s29, s29, s35
    s_mul_i32 s29, s29, 143360
    s_cmp_eq_u32 s48, 0
    s_cselect_b32 s55, s28, s29
    s_add_u32 s12, s44, 0
    s_addc_u32 s13, s45, 0
    s_mov_b32 s14, 127926272
    s_mov_b32 s15, 0x20000
    s_lshl_b32 s28, s2, 2
    s_add_u32 s28, s28, s35
    s_mul_i32 s24, s28, 57344
    s_mul_i32 s28, s48, 28672
    s_add_u32 s24, s24, s28
    s_add_u32 s24, s24, 58720256
    s_mov_b32 s23, -1
    s_mov_b32 s60, s42
    s_mov_b32 s61, s43
    s_mov_b32 s62, 5242880
    s_mov_b32 s63, 0x20000
    s_mov_b32 s27, 0
    s_mov_b32 s25, 0
    s_mov_b32 s68, 0
    s_mov_b32 s71, 0
    s_lshr_b32 s26, s2, 3
    s_lshr_b32 s28, s2, 1
    s_add_u32 s26, s26, s28
    s_and_b32 s26, s26, 3
    s_mul_i32 s26, s26, 5
    s_and_b32 s26, s26, 30
    s_mul_i32 s83, s51, 20
    s_and_b32 s69, s2, 1
    s_min_u32 s69, s69, 1
    s_bfe_u32 s3, s2, 0x10005
    s_xor_b32 s3, s3, 1
    s_and_b32 s69, s2, s3
    s_nop 0
    s_mov_b32 s70, s69
    s_mov_b32 s32, 0x4e800000
    s_mov_b32 s54, 0x3e0293ee
    s_lshl_b32 s28, s48, 1
    s_add_u32 s28, s28, s35
    s_mul_i32 s33, s28, 33792
    v_lshlrev_b32 v6, 4, v1
    v_lshrrev_b32 v2, 4, v1
    v_and_b32 v3, 15, v1
    v_lshlrev_b32 v4, 4, v3
    v_lshl_add_u32 v7, v2, 14, v4
    v_and_b32 v26, 7, v1
    v_lshlrev_b32 v26, 4, v26
    v_bfe_u32 v5, v1, 3, 1
    v_lshl_add_u32 v26, v5, 15, v26
    v_bfe_u32 v5, v1, 4, 1
    v_lshl_add_u32 v26, v5, 17, v26
    v_bfe_u32 v5, v1, 5, 1
    v_lshl_add_u32 v26, v5, 18, v26
    v_mul_u32_u24 v27, 1280, v3
    v_lshl_add_u32 v27, v2, 4, v27
    v_lshrrev_b32 v5, 3, v1
    v_and_b32 v27, 6, v5
    v_xor_b32 v27, v27, v1
    v_and_b32 v27, 7, v27
    v_lshlrev_b32 v27, 4, v27
    v_mul_u32_u24 v5, 1280, v5
    v_add_u32 v27, v27, v5
    s_cmp_eq_u32 s48, 0
    s_cselect_b64 vcc, -1, 0
    s_nop 1
    v_cndmask_b32 v26, v27, v26, vcc
    s_add_u32 s28, s48, 2
    s_mul_i32 s28, s28, 33792
    v_and_b32 v27, 6, v3
    v_xor_b32 v27, v27, v2
    v_lshlrev_b32 v27, 4, v27
    v_and_b32 v5, 7, v3
    v_lshl_add_u32 v27, v5, 7, v27
    v_lshrrev_b32 v5, 3, v3
    v_lshl_add_u32 v27, v5, 10, v27
    v_add_u32 v27, s28, v27
    v_lshl_add_u32 v10, v2, 8, v4
    v_and_b32 v4, 7, v3
    v_lshlrev_b32 v8, 10, v4
    v_and_b32 v5, 1, v3
    v_lshl_add_u32 v8, v5, 4, v8
    v_bfe_u32 v5, v3, 1, 2
    v_lshl_add_u32 v8, v5, 6, v8
    v_lshrrev_b32 v5, 3, v3
    v_lshl_add_u32 v8, v5, 8, v8
    v_bfe_u32 v5, v1, 4, 1
    v_lshl_add_u32 v8, v5, 5, v8
    v_bfe_u32 v5, v1, 5, 1
    v_lshl_add_u32 v8, v5, 4, v8
    s_mul_i32 s28, s35, 33792
    v_add_u32 v8, s28, v8
    v_bfe_u32 v3, v1, 2, 2
    v_bfe_u32 v5, v1, 4, 1
    v_lshl_add_u32 v4, v5, 2, v3
    v_mul_u32_u24 v4, 1056, v4
    v_bfe_u32 v5, v1, 5, 1
    v_lshl_add_u32 v4, v5, 8, v4
    v_and_b32 v5, 3, v1
    v_lshl_add_u32 v4, v5, 3, v4
    v_add_u32 v11, s28, v4
    v_lshl_add_u32 v3, v2, 2, v3
    v_and_b32 v4, 7, v3
    v_mul_u32_u24 v4, 1056, v4
    v_lshrrev_b32 v5, 3, v3
    v_lshl_add_u32 v4, v5, 8, v4
    v_and_b32 v5, 3, v1
    v_lshl_add_u32 v4, v5, 3, v4
    s_add_u32 s28, s28, 67584
    v_add_u32 v9, s28, v4
    v_mov_b32 v12, 0xff800000
    v_mov_b32 v14, 0xff800000
    v_mov_b32 v16, 0xff800000
    v_mov_b32 v18, 0xff800000
    v_mov_b32 v20, 0xff800000
    v_mov_b32 v22, 0xff800000
    v_mov_b32 v24, 0xff800000
    v_mov_b32 v2, 0x3f803f80
    v_accvgpr_write_b32 a252, v2
    v_accvgpr_write_b32 a253, v2
    v_accvgpr_write_b32 a254, v2
    v_accvgpr_write_b32 a255, v2
    v_and_b32 v2, 3, v1
    v_lshlrev_b32 v2, 2, v2
    v_add_u32 v2, 76000, v2
    v_mov_b32 v3, 0
    ds_write_b32 v2, v3
    s_cmp_eq_u32 s48, 0
    s_mov_b32 s28, 784
    s_mov_b32 s29, 800
    s_cselect_b32 s96, s28, s29
    s_mov_b32 s28, 816
    s_cselect_b32 s97, s28, s29
    v_lshrrev_b32 v2, 1, v1
    v_lshlrev_b32 v2, 13, v2
    v_and_b32 v3, 1, v1
    v_lshl_add_u32 v2, v3, 7, v2
    v_lshlrev_b32 v3, 7, v1
    s_bfe_u32 s28, s2, 0x20003
    s_lshl_b32 s28, s28, 18
    s_and_b32 s29, s2, 7
    s_mul_i32 s29, s29, 17920
    s_cmp_eq_u32 s48, 0
    s_cselect_b64 vcc, -1, 0
    s_cselect_b32 s100, s28, s29
    s_add_u32 s100, s100, s55
    s_cmp_eq_u32 s48, 0
    s_mov_b32 s28, 1048576
    s_mov_b32 s29, 8192
    s_cselect_b32 s99, s28, s29
    v_cndmask_b32 v6, v3, v2, vcc
    v_xor_b32 v6, 64, v27
    s_mul_i32 s100, s2, 11
    s_lshr_b32 s28, s2, 5
    s_mul_i32 s28, s28, 7
    s_add_u32 s100, s100, s28
    s_lshl_b32 s28, s35, 4
    s_add_u32 s100, s100, s28
    s_and_b32 s100, s100, 31
L_at_start:
    s_mov_b32 s21, s27
    s_lshl_b32 s34, s27, 5
    s_add_u32 s31, s21, s70
    s_mul_i32 s50, s31, s52
    s_mov_b32 s101, s31
    s_add_u32 s50, s50, s55
    s_cmp_ge_u32 s31, 2
    s_cselect_b32 s28, 0x40000000, 0
    s_add_u32 s50, s50, s28
    s_mov_b32 s82, s26
    s_mul_i32 s28, s26, s51
    s_add_u32 s50, s50, s28
    s_add_u32 m0, s33, 0
    s_mov_b32 s49, s50
    s_add_u32 s28, s49, s88
    buffer_load_dwordx4 v26, s[16:19], s28 offen lds
    s_add_u32 m0, m0, s53
    s_add_u32 s28, s49, s89
    buffer_load_dwordx4 v26, s[16:19], s28 offen lds
    s_add_u32 m0, m0, s53
    s_add_u32 s28, s49, s90
    buffer_load_dwordx4 v26, s[16:19], s28 offen lds
    s_add_u32 m0, m0, s53
    s_add_u32 s28, s49, s91
    buffer_load_dwordx4 v26, s[16:19], s28 offen lds
    s_add_u32 m0, m0, s53
    s_add_u32 s28, s49, s92
    buffer_load_dwordx4 v26, s[16:19], s28 offen lds
    s_add_u32 m0, m0, s53
    s_add_u32 s28, s49, s93
    buffer_load_dwordx4 v26, s[16:19], s28 offen lds
    s_add_u32 m0, m0, s53
    s_add_u32 s28, s49, s94
    buffer_load_dwordx4 v26, s[16:19], s28 offen lds
    s_add_u32 m0, m0, s53
    s_add_u32 s28, s49, s95
    buffer_load_dwordx4 v26, s[16:19], s28 offen lds
    s_add_u32 m0, s33, 8448
    s_add_u32 s49, s50, s46
    s_lshl1_add_u32 s50, s51, s50
    s_add_u32 s82, s82, 2
    s_cmp_eq_u32 s82, 20
    s_cselect_b32 s29, s83, 0
    s_sub_u32 s50, s50, s29
    s_add_u32 s28, s49, s88
    buffer_load_dwordx4 v26, s[16:19], s28 offen lds
    s_add_u32 m0, m0, s53
    s_add_u32 s28, s49, s89
    buffer_load_dwordx4 v26, s[16:19], s28 offen lds
    s_add_u32 m0, m0, s53
    s_add_u32 s28, s49, s90
    buffer_load_dwordx4 v26, s[16:19], s28 offen lds
    s_add_u32 m0, m0, s53
    s_add_u32 s28, s49, s91
    buffer_load_dwordx4 v26, s[16:19], s28 offen lds
    s_add_u32 m0, m0, s53
    s_add_u32 s28, s49, s92
    buffer_load_dwordx4 v26, s[16:19], s28 offen lds
    s_add_u32 m0, m0, s53
    s_add_u32 s28, s49, s93
    buffer_load_dwordx4 v26, s[16:19], s28 offen lds
    s_add_u32 m0, m0, s53
    s_add_u32 s28, s49, s47
    buffer_load_dwordx4 v26, s[16:19], s28 offen lds
    s_add_u32 m0, m0, s53
    s_add_u32 s28, s49, s98
    buffer_load_dwordx4 v26, s[16:19], s28 offen lds
    s_add_u32 m0, s33, 16896
    s_mov_b32 s49, s50
    s_add_u32 s28, s49, s88
    buffer_load_dwordx4 v26, s[16:19], s28 offen lds
    s_add_u32 m0, m0, s53
    s_add_u32 s28, s49, s89
    buffer_load_dwordx4 v26, s[16:19], s28 offen lds
    s_add_u32 m0, m0, s53
    s_add_u32 s28, s49, s90
    buffer_load_dwordx4 v26, s[16:19], s28 offen lds
    s_add_u32 m0, m0, s53
    s_add_u32 s28, s49, s91
    buffer_load_dwordx4 v26, s[16:19], s28 offen lds
    s_add_u32 m0, m0, s53
    s_add_u32 s28, s49, s92
    buffer_load_dwordx4 v26, s[16:19], s28 offen lds
    s_add_u32 m0, m0, s53
    s_add_u32 s28, s49, s93
    buffer_load_dwordx4 v26, s[16:19], s28 offen lds
    s_add_u32 m0, m0, s53
    s_add_u32 s28, s49, s94
    buffer_load_dwordx4 v26, s[16:19], s28 offen lds
    s_add_u32 m0, m0, s53
    s_add_u32 s28, s49, s95
    buffer_load_dwordx4 v26, s[16:19], s28 offen lds
    s_add_u32 m0, s33, 25344
    s_add_u32 s49, s50, s46
    s_lshl1_add_u32 s50, s51, s50
    s_add_u32 s82, s82, 2
    s_cmp_eq_u32 s82, 20
    s_cselect_b32 s29, s83, 0
    s_sub_u32 s50, s50, s29
    s_add_u32 s28, s49, s88
    buffer_load_dwordx4 v26, s[16:19], s28 offen lds
    s_add_u32 m0, m0, s53
    s_add_u32 s28, s49, s89
    buffer_load_dwordx4 v26, s[16:19], s28 offen lds
    s_add_u32 m0, m0, s53
    s_add_u32 s28, s49, s90
    buffer_load_dwordx4 v26, s[16:19], s28 offen lds
    s_add_u32 m0, m0, s53
    s_add_u32 s28, s49, s91
    buffer_load_dwordx4 v26, s[16:19], s28 offen lds
    s_add_u32 m0, m0, s53
    s_add_u32 s28, s49, s92
    buffer_load_dwordx4 v26, s[16:19], s28 offen lds
    s_add_u32 m0, m0, s53
    s_add_u32 s28, s49, s93
    buffer_load_dwordx4 v26, s[16:19], s28 offen lds
    s_add_u32 m0, m0, s53
    s_add_u32 s28, s49, s47
    buffer_load_dwordx4 v26, s[16:19], s28 offen lds
    s_add_u32 m0, m0, s53
    s_add_u32 s28, s49, s98
    buffer_load_dwordx4 v26, s[16:19], s28 offen lds
    s_waitcnt vmcnt(16) lgkmcnt(0)
    s_barrier
L_at_round:
    ds_read_b64_tr_b16 v[112:113], v11 offset:0
    ds_read_b64_tr_b16 v[114:115], v11 offset:128
    ds_read_b64_tr_b16 v[116:117], v11 offset:512
    ds_read_b64_tr_b16 v[118:119], v11 offset:640
    ds_read_b64_tr_b16 v[120:121], v11 offset:32
    ds_read_b64_tr_b16 v[122:123], v11 offset:160
    ds_read_b64_tr_b16 v[124:125], v11 offset:544
    ds_read_b64_tr_b16 v[126:127], v11 offset:672
    ds_read_b64_tr_b16 v[128:129], v11 offset:64
    ds_read_b64_tr_b16 v[130:131], v11 offset:192
    ds_read_b64_tr_b16 v[132:133], v11 offset:576
    ds_read_b64_tr_b16 v[134:135], v11 offset:704
    ds_read_b64_tr_b16 v[136:137], v11 offset:96
    ds_read_b64_tr_b16 v[138:139], v11 offset:224
    ds_read_b64_tr_b16 v[140:141], v11 offset:608
    ds_read_b64_tr_b16 v[142:143], v11 offset:736
    ds_read_b128 v[28:31], v27 offset:0
    ds_read_b128 v[32:35], v27 offset:2048
    ds_read_b128 v[36:39], v27 offset:4096
    ds_read_b128 v[40:43], v27 offset:6144
    ds_read_b128 v[44:47], v27 offset:8448
    ds_read_b128 v[48:51], v27 offset:10496
    ds_read_b128 v[52:55], v27 offset:12544
    ds_read_b128 v[56:59], v6 offset:0
    ds_read_b128 v[60:63], v6 offset:2048
    ds_read_b128 v[64:67], v6 offset:4096
    ds_read_b128 v[68:71], v6 offset:6144
    ds_read_b128 v[72:75], v6 offset:8448
    ds_read_b128 v[76:79], v6 offset:10496
    ds_read_b128 v[80:83], v6 offset:12544
    s_waitcnt lgkmcnt(0)
    s_waitcnt lgkmcnt(8)
    v_mfma_f32_16x16x32_bf16 v[144:147], v[112:115], v[28:31], 0
    s_add_u32 m0, s33, 0
    v_mfma_f32_16x16x32_bf16 v[144:147], v[116:119], v[56:59], v[144:147]
    s_mov_b32 s49, s50
    v_mfma_f32_16x16x32_bf16 v[148:151], v[112:115], v[32:35], 0
    v_mfma_f32_16x16x32_bf16 v[148:151], v[116:119], v[60:63], v[148:151]
    v_mfma_f32_16x16x32_bf16 v[152:155], v[112:115], v[36:39], 0
    v_mfma_f32_16x16x32_bf16 v[152:155], v[116:119], v[64:67], v[152:155]
    v_mfma_f32_16x16x32_bf16 v[156:159], v[112:115], v[40:43], 0
    s_cmp_eq_u32 s68, 0
    s_cbranch_scc0 L_bw1_449
    s_waitcnt vmcnt(16) lgkmcnt(0)
L_bw2_449:
    s_barrier
    s_cmp_le_u32 s21, s27
    s_cbranch_scc1 L_at_nofb_454
    s_sub_u32 s28, s21, 1
    s_cmp_eq_u32 s28, s23
    s_cbranch_scc1 L_at_nofb_454
    s_lshl_b32 s29, s28, 2
    s_add_u32 s29, s29, 76000
    v_mov_b32 v4, s29
    ds_read_b32 v4, v4
    s_waitcnt lgkmcnt(0)
    v_readfirstlane_b32 s29, v4
    s_nop 3
    s_cmp_lg_u32 s29, 0
    s_cbranch_scc1 L_at_fallback
L_at_nofb_454:
    v_mfma_f32_16x16x32_bf16 v[156:159], v[116:119], v[68:71], v[156:159]
    v_mfma_f32_16x16x32_bf16 v[160:163], v[112:115], v[44:47], 0
    v_mfma_f32_16x16x32_bf16 v[160:163], v[116:119], v[72:75], v[160:163]
    s_add_u32 s28, s49, s88
    buffer_load_dwordx4 v26, s[16:19], s28 offen lds
    v_mfma_f32_16x16x32_bf16 v[164:167], v[112:115], v[48:51], 0
    s_add_u32 m0, m0, s53
    v_mfma_f32_16x16x32_bf16 v[164:167], v[116:119], v[76:79], v[164:167]
    v_mfma_f32_16x16x32_bf16 v[168:171], v[112:115], v[52:55], 0
    v_mfma_f32_16x16x32_bf16 v[168:171], v[116:119], v[80:83], v[168:171]
    ds_read_b64_tr_b16 v[112:113], v11 offset:8448
    v_mfma_f32_16x16x32_bf16 v[172:175], v[120:123], v[28:31], 0
    ds_read_b64_tr_b16 v[114:115], v11 offset:8576
    v_mfma_f32_16x16x32_bf16 v[172:175], v[124:127], v[56:59], v[172:175]
    s_add_u32 s28, s49, s89
    buffer_load_dwordx4 v26, s[16:19], s28 offen lds
    v_mfma_f32_16x16x32_bf16 v[176:179], v[120:123], v[32:35], 0
    s_add_u32 m0, m0, s53
    ds_read_b64_tr_b16 v[116:117], v11 offset:8960
    v_mfma_f32_16x16x32_bf16 v[176:179], v[124:127], v[60:63], v[176:179]
    ds_read_b64_tr_b16 v[118:119], v11 offset:9088
    v_mfma_f32_16x16x32_bf16 v[180:183], v[120:123], v[36:39], 0
    v_mfma_f32_16x16x32_bf16 v[180:183], v[124:127], v[64:67], v[180:183]
    v_mfma_f32_16x16x32_bf16 v[184:187], v[120:123], v[40:43], 0
    v_mfma_f32_16x16x32_bf16 v[184:187], v[124:127], v[68:71], v[184:187]
    s_add_u32 s28, s49, s90
    buffer_load_dwordx4 v26, s[16:19], s28 offen lds
    v_mfma_f32_16x16x32_bf16 v[188:191], v[120:123], v[44:47], 0
    s_add_u32 m0, m0, s53
    v_mfma_f32_16x16x32_bf16 v[188:191], v[124:127], v[72:75], v[188:191]
    v_mfma_f32_16x16x32_bf16 v[192:195], v[120:123], v[48:51], 0
    v_mfma_f32_16x16x32_bf16 v[192:195], v[124:127], v[76:79], v[192:195]
    v_mfma_f32_16x16x32_bf16 v[196:199], v[120:123], v[52:55], 0
    v_mfma_f32_16x16x32_bf16 v[196:199], v[124:127], v[80:83], v[196:199]
    s_add_u32 s28, s49, s91
    buffer_load_dwordx4 v26, s[16:19], s28 offen lds
    v_mfma_f32_16x16x32_bf16 v[200:203], v[128:131], v[28:31], 0
    s_add_u32 m0, m0, s53
    ds_read_b64_tr_b16 v[120:121], v11 offset:8480
    v_mfma_f32_16x16x32_bf16 v[200:203], v[132:135], v[56:59], v[200:203]
    ds_read_b64_tr_b16 v[122:123], v11 offset:8608
    v_mfma_f32_16x16x32_bf16 v[204:207], v[128:131], v[32:35], 0
    ds_read_b64_tr_b16 v[124:125], v11 offset:8992
    v_mfma_f32_16x16x32_bf16 v[204:207], v[132:135], v[60:63], v[204:207]
    ds_read_b64_tr_b16 v[126:127], v11 offset:9120
    v_mfma_f32_16x16x32_bf16 v[208:211], v[128:131], v[36:39], 0
    v_mfma_f32_16x16x32_bf16 v[208:211], v[132:135], v[64:67], v[208:211]
    s_add_u32 s28, s49, s92
    buffer_load_dwordx4 v26, s[16:19], s28 offen lds
    v_mfma_f32_16x16x32_bf16 v[212:215], v[128:131], v[40:43], 0
    s_add_u32 m0, m0, s53
    v_mfma_f32_16x16x32_bf16 v[212:215], v[132:135], v[68:71], v[212:215]
    v_mfma_f32_16x16x32_bf16 v[216:219], v[128:131], v[44:47], 0
    v_mfma_f32_16x16x32_bf16 v[216:219], v[132:135], v[72:75], v[216:219]
    v_mfma_f32_16x16x32_bf16 v[220:223], v[128:131], v[48:51], 0
    v_mfma_f32_16x16x32_bf16 v[220:223], v[132:135], v[76:79], v[220:223]
    s_add_u32 s28, s49, s93
    buffer_load_dwordx4 v26, s[16:19], s28 offen lds
    v_mfma_f32_16x16x32_bf16 v[224:227], v[128:131], v[52:55], 0
    s_add_u32 m0, m0, s53
    v_mfma_f32_16x16x32_bf16 v[224:227], v[132:135], v[80:83], v[224:227]
    ds_read_b64_tr_b16 v[128:129], v11 offset:8512
    v_mfma_f32_16x16x32_bf16 v[228:231], v[136:139], v[28:31], 0
    ds_read_b64_tr_b16 v[130:131], v11 offset:8640
    v_mfma_f32_16x16x32_bf16 v[228:231], v[140:143], v[56:59], v[228:231]
    ds_read_b64_tr_b16 v[132:133], v11 offset:9024
    v_mfma_f32_16x16x32_bf16 v[232:235], v[136:139], v[32:35], 0
    ds_read_b64_tr_b16 v[134:135], v11 offset:9152
    v_mfma_f32_16x16x32_bf16 v[232:235], v[140:143], v[60:63], v[232:235]
    s_add_u32 s28, s49, s94
    buffer_load_dwordx4 v26, s[16:19], s28 offen lds
    v_mfma_f32_16x16x32_bf16 v[236:239], v[136:139], v[36:39], 0
    s_add_u32 m0, m0, s53
    v_mfma_f32_16x16x32_bf16 v[236:239], v[140:143], v[64:67], v[236:239]
    v_mfma_f32_16x16x32_bf16 v[240:243], v[136:139], v[40:43], 0
    v_mfma_f32_16x16x32_bf16 v[240:243], v[140:143], v[68:71], v[240:243]
    v_mfma_f32_16x16x32_bf16 v[244:247], v[136:139], v[44:47], 0
    v_mfma_f32_16x16x32_bf16 v[244:247], v[140:143], v[72:75], v[244:247]
    s_add_u32 s28, s49, s95
    buffer_load_dwordx4 v26, s[16:19], s28 offen lds
    v_mfma_f32_16x16x32_bf16 v[248:251], v[136:139], v[48:51], 0
    v_mfma_f32_16x16x32_bf16 v[248:251], v[140:143], v[76:79], v[248:251]
    v_mfma_f32_16x16x32_bf16 v[252:255], v[136:139], v[52:55], 0
    v_mfma_f32_16x16x32_bf16 v[252:255], v[140:143], v[80:83], v[252:255]
    ds_read_b64_tr_b16 v[136:137], v11 offset:8544
    ds_read_b64_tr_b16 v[138:139], v11 offset:8672
    ds_read_b64_tr_b16 v[140:141], v11 offset:9056
    ds_read_b64_tr_b16 v[142:143], v11 offset:9184
    s_waitcnt lgkmcnt(8)
    v_mfma_f32_16x16x32_bf16 a[112:115], v[112:115], v[28:31], 0
    s_add_u32 m0, s33, 8448
    v_mfma_f32_16x16x32_bf16 a[112:115], v[116:119], v[56:59], a[112:115]
    s_add_u32 s49, s50, s46
    v_mfma_f32_16x16x32_bf16 a[116:119], v[112:115], v[32:35], 0
    s_lshl1_add_u32 s50, s51, s50
    v_mfma_f32_16x16x32_bf16 a[116:119], v[116:119], v[60:63], a[116:119]
    s_add_u32 s82, s82, 2
    v_mfma_f32_16x16x32_bf16 a[120:123], v[112:115], v[36:39], 0
    s_cmp_eq_u32 s82, 20
    v_mfma_f32_16x16x32_bf16 a[120:123], v[116:119], v[64:67], a[120:123]
    s_cselect_b32 s29, s83, 0
    v_mfma_f32_16x16x32_bf16 a[124:127], v[112:115], v[40:43], 0
    s_sub_u32 s50, s50, s29
    s_cmp_eq_u32 s68, 0
    s_cbranch_scc0 L_bw1_572
    s_waitcnt vmcnt(8) lgkmcnt(0)
L_bw2_572:
    s_barrier
    ds_read_b128 a[0:3], v27 offset:16896
    v_mfma_f32_16x16x32_bf16 a[124:127], v[116:119], v[68:71], a[124:127]
    ds_read_b128 a[4:7], v27 offset:18944
    v_mfma_f32_16x16x32_bf16 a[128:131], v[112:115], v[44:47], 0
    ds_read_b128 a[8:11], v27 offset:20992
    v_mfma_f32_16x16x32_bf16 a[128:131], v[116:119], v[72:75], a[128:131]
    s_add_u32 s28, s49, s88
    buffer_load_dwordx4 v26, s[16:19], s28 offen lds
    v_mfma_f32_16x16x32_bf16 a[132:135], v[112:115], v[48:51], 0
    s_add_u32 m0, m0, s53
    ds_read_b128 a[12:15], v27 offset:23040
    v_mfma_f32_16x16x32_bf16 a[132:135], v[116:119], v[76:79], a[132:135]
    ds_read_b128 a[16:19], v27 offset:25344
    v_mfma_f32_16x16x32_bf16 a[136:139], v[112:115], v[52:55], 0
    ds_read_b128 a[20:23], v27 offset:27392
    v_mfma_f32_16x16x32_bf16 a[136:139], v[116:119], v[80:83], a[136:139]
    ds_read_b128 a[24:27], v27 offset:29440
    v_mfma_f32_16x16x32_bf16 a[140:143], v[120:123], v[28:31], 0
    ds_read_b128 a[28:31], v6 offset:16896
    v_mfma_f32_16x16x32_bf16 a[140:143], v[124:127], v[56:59], a[140:143]
    s_add_u32 s28, s49, s89
    buffer_load_dwordx4 v26, s[16:19], s28 offen lds
    v_mfma_f32_16x16x32_bf16 a[144:147], v[120:123], v[32:35], 0
    s_add_u32 m0, m0, s53
    ds_read_b128 a[32:35], v6 offset:18944
    v_mfma_f32_16x16x32_bf16 a[144:147], v[124:127], v[60:63], a[144:147]
    ds_read_b128 a[36:39], v6 offset:20992
    v_mfma_f32_16x16x32_bf16 a[148:151], v[120:123], v[36:39], 0
    ds_read_b128 a[40:43], v6 offset:23040
    v_mfma_f32_16x16x32_bf16 a[148:151], v[124:127], v[64:67], a[148:151]
    ds_read_b128 a[44:47], v6 offset:25344
    v_mfma_f32_16x16x32_bf16 a[152:155], v[120:123], v[40:43], 0
    ds_read_b128 a[48:51], v6 offset:27392
    v_mfma_f32_16x16x32_bf16 a[152:155], v[124:127], v[68:71], a[152:155]
    s_add_u32 s28, s49, s90
    buffer_load_dwordx4 v26, s[16:19], s28 offen lds
    v_mfma_f32_16x16x32_bf16 a[156:159], v[120:123], v[44:47], 0
    s_add_u32 m0, m0, s53
    ds_read_b128 a[52:55], v6 offset:29440
    v_mfma_f32_16x16x32_bf16 a[156:159], v[124:127], v[72:75], a[156:159]
    ds_read_b64_tr_b16 v[112:113], v11 offset:16896
    v_mfma_f32_16x16x32_bf16 a[160:163], v[120:123], v[48:51], 0
    ds_read_b64_tr_b16 v[114:115], v11 offset:17024
    v_mfma_f32_16x16x32_bf16 a[160:163], v[124:127], v[76:79], a[160:163]
    ds_read_b64_tr_b16 v[116:117], v11 offset:17408
    v_mfma_f32_16x16x32_bf16 a[164:167], v[120:123], v[52:55], 0
    ds_read_b64_tr_b16 v[118:119], v11 offset:17536
    v_mfma_f32_16x16x32_bf16 a[164:167], v[124:127], v[80:83], a[164:167]
    s_add_u32 s28, s49, s91
    buffer_load_dwordx4 v26, s[16:19], s28 offen lds
    v_mfma_f32_16x16x32_bf16 a[168:171], v[128:131], v[28:31], 0
    s_add_u32 m0, m0, s53
    ds_read_b64_tr_b16 v[120:121], v11 offset:16928
    v_mfma_f32_16x16x32_bf16 a[168:171], v[132:135], v[56:59], a[168:171]
    ds_read_b64_tr_b16 v[122:123], v11 offset:17056
    v_mfma_f32_16x16x32_bf16 a[172:175], v[128:131], v[32:35], 0
    ds_read_b64_tr_b16 v[124:125], v11 offset:17440
    v_mfma_f32_16x16x32_bf16 a[172:175], v[132:135], v[60:63], a[172:175]
    ds_read_b64_tr_b16 v[126:127], v11 offset:17568
    v_mfma_f32_16x16x32_bf16 a[176:179], v[128:131], v[36:39], 0
    v_mfma_f32_16x16x32_bf16 a[176:179], v[132:135], v[64:67], a[176:179]
    s_add_u32 s28, s49, s92
    buffer_load_dwordx4 v26, s[16:19], s28 offen lds
    v_mfma_f32_16x16x32_bf16 a[180:183], v[128:131], v[40:43], 0
    s_add_u32 m0, m0, s53
    v_mfma_f32_16x16x32_bf16 a[180:183], v[132:135], v[68:71], a[180:183]
    v_mfma_f32_16x16x32_bf16 a[184:187], v[128:131], v[44:47], 0
    v_mfma_f32_16x16x32_bf16 a[184:187], v[132:135], v[72:75], a[184:187]
    v_mfma_f32_16x16x32_bf16 a[188:191], v[128:131], v[48:51], 0
    v_mfma_f32_16x16x32_bf16 a[188:191], v[132:135], v[76:79], a[188:191]
    s_add_u32 s28, s49, s93
    buffer_load_dwordx4 v26, s[16:19], s28 offen lds
    v_mfma_f32_16x16x32_bf16 a[192:195], v[128:131], v[52:55], 0
    s_add_u32 m0, m0, s53
    v_mfma_f32_16x16x32_bf16 a[192:195], v[132:135], v[80:83], a[192:195]
    ds_read_b64_tr_b16 v[128:129], v11 offset:16960
    v_mfma_f32_16x16x32_bf16 a[196:199], v[136:139], v[28:31], 0
    ds_read_b64_tr_b16 v[130:131], v11 offset:17088
    v_mfma_f32_16x16x32_bf16 a[196:199], v[140:143], v[56:59], a[196:199]
    ds_read_b64_tr_b16 v[132:133], v11 offset:17472
    v_mfma_f32_16x16x32_bf16 a[200:203], v[136:139], v[32:35], 0
    ds_read_b64_tr_b16 v[134:135], v11 offset:17600
    v_mfma_f32_16x16x32_bf16 a[200:203], v[140:143], v[60:63], a[200:203]
    s_add_u32 s28, s49, s47
    buffer_load_dwordx4 v26, s[16:19], s28 offen lds
    v_mfma_f32_16x16x32_bf16 a[204:207], v[136:139], v[36:39], 0
    s_add_u32 m0, m0, s53
    v_mfma_f32_16x16x32_bf16 a[204:207], v[140:143], v[64:67], a[204:207]
    v_mfma_f32_16x16x32_bf16 a[208:211], v[136:139], v[40:43], 0
    v_mfma_f32_16x16x32_bf16 a[208:211], v[140:143], v[68:71], a[208:211]
    v_mfma_f32_16x16x32_bf16 a[212:215], v[136:139], v[44:47], 0
    v_mfma_f32_16x16x32_bf16 a[212:215], v[140:143], v[72:75], a[212:215]
    s_add_u32 s28, s49, s98
    buffer_load_dwordx4 v26, s[16:19], s28 offen lds
    v_mfma_f32_16x16x32_bf16 a[216:219], v[136:139], v[48:51], 0
    v_mfma_f32_16x16x32_bf16 a[216:219], v[140:143], v[76:79], a[216:219]
    v_mfma_f32_16x16x32_bf16 a[220:223], v[136:139], v[52:55], 0
    v_mfma_f32_16x16x32_bf16 a[220:223], v[140:143], v[80:83], a[220:223]
    ds_read_b64_tr_b16 v[136:137], v11 offset:16992
    ds_read_b64_tr_b16 v[138:139], v11 offset:17120
    ds_read_b64_tr_b16 v[140:141], v11 offset:17504
    ds_read_b64_tr_b16 v[142:143], v11 offset:17632
    s_waitcnt lgkmcnt(8)
    v_mfma_f32_16x16x32_bf16 v[144:147], v[112:115], a[0:3], v[144:147]
    s_add_u32 m0, s33, 16896
    v_mfma_f32_16x16x32_bf16 v[144:147], v[116:119], a[28:31], v[144:147]
    s_mov_b32 s49, s50
    v_mfma_f32_16x16x32_bf16 v[148:151], v[112:115], a[4:7], v[148:151]
    v_mfma_f32_16x16x32_bf16 v[148:151], v[116:119], a[32:35], v[148:151]
    v_mfma_f32_16x16x32_bf16 v[152:155], v[112:115], a[8:11], v[152:155]
    v_mfma_f32_16x16x32_bf16 v[152:155], v[116:119], a[36:39], v[152:155]
    v_mfma_f32_16x16x32_bf16 v[156:159], v[112:115], a[12:15], v[156:159]
    s_cmp_eq_u32 s68, 0
    s_cbranch_scc0 L_bw1_689
    s_waitcnt vmcnt(16) lgkmcnt(0)
L_bw2_689:
    s_barrier
    v_mfma_f32_16x16x32_bf16 v[156:159], v[116:119], a[40:43], v[156:159]
    v_mfma_f32_16x16x32_bf16 v[160:163], v[112:115], a[16:19], v[160:163]
    v_mfma_f32_16x16x32_bf16 v[160:163], v[116:119], a[44:47], v[160:163]
    s_add_u32 s28, s49, s88
    buffer_load_dwordx4 v26, s[16:19], s28 offen lds
    v_mfma_f32_16x16x32_bf16 v[164:167], v[112:115], a[20:23], v[164:167]
    s_add_u32 m0, m0, s53
    v_mfma_f32_16x16x32_bf16 v[164:167], v[116:119], a[48:51], v[164:167]
    v_mfma_f32_16x16x32_bf16 v[168:171], v[112:115], a[24:27], v[168:171]
    v_mfma_f32_16x16x32_bf16 v[168:171], v[116:119], a[52:55], v[168:171]
    ds_read_b64_tr_b16 v[112:113], v11 offset:25344
    v_mfma_f32_16x16x32_bf16 v[172:175], v[120:123], a[0:3], v[172:175]
    ds_read_b64_tr_b16 v[114:115], v11 offset:25472
    v_mfma_f32_16x16x32_bf16 v[172:175], v[124:127], a[28:31], v[172:175]
    s_add_u32 s28, s49, s89
    buffer_load_dwordx4 v26, s[16:19], s28 offen lds
    v_mfma_f32_16x16x32_bf16 v[176:179], v[120:123], a[4:7], v[176:179]
    s_add_u32 m0, m0, s53
    ds_read_b64_tr_b16 v[116:117], v11 offset:25856
    v_mfma_f32_16x16x32_bf16 v[176:179], v[124:127], a[32:35], v[176:179]
    ds_read_b64_tr_b16 v[118:119], v11 offset:25984
    v_mfma_f32_16x16x32_bf16 v[180:183], v[120:123], a[8:11], v[180:183]
    v_mfma_f32_16x16x32_bf16 v[180:183], v[124:127], a[36:39], v[180:183]
    v_mfma_f32_16x16x32_bf16 v[184:187], v[120:123], a[12:15], v[184:187]
    v_mfma_f32_16x16x32_bf16 v[184:187], v[124:127], a[40:43], v[184:187]
    s_add_u32 s28, s49, s90
    buffer_load_dwordx4 v26, s[16:19], s28 offen lds
    v_mfma_f32_16x16x32_bf16 v[188:191], v[120:123], a[16:19], v[188:191]
    s_add_u32 m0, m0, s53
    v_mfma_f32_16x16x32_bf16 v[188:191], v[124:127], a[44:47], v[188:191]
    v_mfma_f32_16x16x32_bf16 v[192:195], v[120:123], a[20:23], v[192:195]
    v_mfma_f32_16x16x32_bf16 v[192:195], v[124:127], a[48:51], v[192:195]
    v_mfma_f32_16x16x32_bf16 v[196:199], v[120:123], a[24:27], v[196:199]
    v_mfma_f32_16x16x32_bf16 v[196:199], v[124:127], a[52:55], v[196:199]
    s_add_u32 s28, s49, s91
    buffer_load_dwordx4 v26, s[16:19], s28 offen lds
    v_mfma_f32_16x16x32_bf16 v[200:203], v[128:131], a[0:3], v[200:203]
    s_add_u32 m0, m0, s53
    ds_read_b64_tr_b16 v[120:121], v11 offset:25376
    v_mfma_f32_16x16x32_bf16 v[200:203], v[132:135], a[28:31], v[200:203]
    ds_read_b64_tr_b16 v[122:123], v11 offset:25504
    v_mfma_f32_16x16x32_bf16 v[204:207], v[128:131], a[4:7], v[204:207]
    ds_read_b64_tr_b16 v[124:125], v11 offset:25888
    v_mfma_f32_16x16x32_bf16 v[204:207], v[132:135], a[32:35], v[204:207]
    ds_read_b64_tr_b16 v[126:127], v11 offset:26016
    v_mfma_f32_16x16x32_bf16 v[208:211], v[128:131], a[8:11], v[208:211]
    v_mfma_f32_16x16x32_bf16 v[208:211], v[132:135], a[36:39], v[208:211]
    s_add_u32 s28, s49, s92
    buffer_load_dwordx4 v26, s[16:19], s28 offen lds
    v_mfma_f32_16x16x32_bf16 v[212:215], v[128:131], a[12:15], v[212:215]
    s_add_u32 m0, m0, s53
    v_mfma_f32_16x16x32_bf16 v[212:215], v[132:135], a[40:43], v[212:215]
    v_mfma_f32_16x16x32_bf16 v[216:219], v[128:131], a[16:19], v[216:219]
    v_mfma_f32_16x16x32_bf16 v[216:219], v[132:135], a[44:47], v[216:219]
    v_mfma_f32_16x16x32_bf16 v[220:223], v[128:131], a[20:23], v[220:223]
    v_mfma_f32_16x16x32_bf16 v[220:223], v[132:135], a[48:51], v[220:223]
    s_add_u32 s28, s49, s93
    buffer_load_dwordx4 v26, s[16:19], s28 offen lds
    v_mfma_f32_16x16x32_bf16 v[224:227], v[128:131], a[24:27], v[224:227]
    s_add_u32 m0, m0, s53
    v_mfma_f32_16x16x32_bf16 v[224:227], v[132:135], a[52:55], v[224:227]
    ds_read_b64_tr_b16 v[128:129], v11 offset:25408
    v_mfma_f32_16x16x32_bf16 v[228:231], v[136:139], a[0:3], v[228:231]
    ds_read_b64_tr_b16 v[130:131], v11 offset:25536
    v_mfma_f32_16x16x32_bf16 v[228:231], v[140:143], a[28:31], v[228:231]
    ds_read_b64_tr_b16 v[132:133], v11 offset:25920
    v_mfma_f32_16x16x32_bf16 v[232:235], v[136:139], a[4:7], v[232:235]
    ds_read_b64_tr_b16 v[134:135], v11 offset:26048
    v_mfma_f32_16x16x32_bf16 v[232:235], v[140:143], a[32:35], v[232:235]
    s_add_u32 s28, s49, s94
    buffer_load_dwordx4 v26, s[16:19], s28 offen lds
    v_mfma_f32_16x16x32_bf16 v[236:239], v[136:139], a[8:11], v[236:239]
    s_add_u32 m0, m0, s53
    v_mfma_f32_16x16x32_bf16 v[236:239], v[140:143], a[36:39], v[236:239]
    v_mfma_f32_16x16x32_bf16 v[240:243], v[136:139], a[12:15], v[240:243]
    v_mfma_f32_16x16x32_bf16 v[240:243], v[140:143], a[40:43], v[240:243]
    v_mfma_f32_16x16x32_bf16 v[244:247], v[136:139], a[16:19], v[244:247]
    v_mfma_f32_16x16x32_bf16 v[244:247], v[140:143], a[44:47], v[244:247]
    s_add_u32 s28, s49, s95
    buffer_load_dwordx4 v26, s[16:19], s28 offen lds
    v_mfma_f32_16x16x32_bf16 v[248:251], v[136:139], a[20:23], v[248:251]
    v_mfma_f32_16x16x32_bf16 v[248:251], v[140:143], a[48:51], v[248:251]
    v_mfma_f32_16x16x32_bf16 v[252:255], v[136:139], a[24:27], v[252:255]
    v_mfma_f32_16x16x32_bf16 v[252:255], v[140:143], a[52:55], v[252:255]
    ds_read_b64_tr_b16 v[136:137], v11 offset:25440
    ds_read_b64_tr_b16 v[138:139], v11 offset:25568
    ds_read_b64_tr_b16 v[140:141], v11 offset:25952
    ds_read_b64_tr_b16 v[142:143], v11 offset:26080
    s_waitcnt lgkmcnt(8)
    v_mfma_f32_16x16x32_bf16 a[112:115], v[112:115], a[0:3], a[112:115]
    s_add_u32 m0, s33, 25344
    v_mfma_f32_16x16x32_bf16 a[112:115], v[116:119], a[28:31], a[112:115]
    s_add_u32 s49, s50, s46
    v_mfma_f32_16x16x32_bf16 a[116:119], v[112:115], a[4:7], a[116:119]
    s_lshl1_add_u32 s50, s51, s50
    v_mfma_f32_16x16x32_bf16 a[116:119], v[116:119], a[32:35], a[116:119]
    s_add_u32 s82, s82, 2
    v_mfma_f32_16x16x32_bf16 a[120:123], v[112:115], a[8:11], a[120:123]
    s_cmp_eq_u32 s82, 20
    v_mfma_f32_16x16x32_bf16 a[120:123], v[116:119], a[36:39], a[120:123]
    s_cselect_b32 s29, s83, 0
    v_mfma_f32_16x16x32_bf16 a[124:127], v[112:115], a[12:15], a[124:127]
    s_sub_u32 s50, s50, s29
    s_waitcnt vmcnt(8) lgkmcnt(0)
    s_barrier
    ds_read_b128 v[28:31], v27 offset:0
    v_mfma_f32_16x16x32_bf16 a[124:127], v[116:119], a[40:43], a[124:127]
    ds_read_b128 v[32:35], v27 offset:2048
    v_mfma_f32_16x16x32_bf16 a[128:131], v[112:115], a[16:19], a[128:131]
    ds_read_b128 v[36:39], v27 offset:4096
    v_mfma_f32_16x16x32_bf16 a[128:131], v[116:119], a[44:47], a[128:131]
    s_add_u32 s28, s49, s88
    buffer_load_dwordx4 v26, s[16:19], s28 offen lds
    v_mfma_f32_16x16x32_bf16 a[132:135], v[112:115], a[20:23], a[132:135]
    s_add_u32 m0, m0, s53
    ds_read_b128 v[40:43], v27 offset:6144
    v_mfma_f32_16x16x32_bf16 a[132:135], v[116:119], a[48:51], a[132:135]
    ds_read_b128 v[44:47], v27 offset:8448
    v_mfma_f32_16x16x32_bf16 a[136:139], v[112:115], a[24:27], a[136:139]
    ds_read_b128 v[48:51], v27 offset:10496
    v_mfma_f32_16x16x32_bf16 a[136:139], v[116:119], a[52:55], a[136:139]
    ds_read_b128 v[52:55], v27 offset:12544
    v_mfma_f32_16x16x32_bf16 a[140:143], v[120:123], a[0:3], a[140:143]
    ds_read_b128 v[56:59], v6 offset:0
    v_mfma_f32_16x16x32_bf16 a[140:143], v[124:127], a[28:31], a[140:143]
    s_add_u32 s28, s49, s89
    buffer_load_dwordx4 v26, s[16:19], s28 offen lds
    v_mfma_f32_16x16x32_bf16 a[144:147], v[120:123], a[4:7], a[144:147]
    s_add_u32 m0, m0, s53
    ds_read_b128 v[60:63], v6 offset:2048
    v_mfma_f32_16x16x32_bf16 a[144:147], v[124:127], a[32:35], a[144:147]
    ds_read_b128 v[64:67], v6 offset:4096
    v_mfma_f32_16x16x32_bf16 a[148:151], v[120:123], a[8:11], a[148:151]
    ds_read_b128 v[68:71], v6 offset:6144
    v_mfma_f32_16x16x32_bf16 a[148:151], v[124:127], a[36:39], a[148:151]
    ds_read_b128 v[72:75], v6 offset:8448
    v_mfma_f32_16x16x32_bf16 a[152:155], v[120:123], a[12:15], a[152:155]
    ds_read_b128 v[76:79], v6 offset:10496
    v_mfma_f32_16x16x32_bf16 a[152:155], v[124:127], a[40:43], a[152:155]
    s_add_u32 s28, s49, s90
    buffer_load_dwordx4 v26, s[16:19], s28 offen lds
    v_mfma_f32_16x16x32_bf16 a[156:159], v[120:123], a[16:19], a[156:159]
    s_add_u32 m0, m0, s53
    ds_read_b128 v[80:83], v6 offset:12544
    v_mfma_f32_16x16x32_bf16 a[156:159], v[124:127], a[44:47], a[156:159]
    ds_read_b64_tr_b16 v[112:113], v11 offset:0
    v_mfma_f32_16x16x32_bf16 a[160:163], v[120:123], a[20:23], a[160:163]
    ds_read_b64_tr_b16 v[114:115], v11 offset:128
    v_mfma_f32_16x16x32_bf16 a[160:163], v[124:127], a[48:51], a[160:163]
    ds_read_b64_tr_b16 v[116:117], v11 offset:512
    v_mfma_f32_16x16x32_bf16 a[164:167], v[120:123], a[24:27], a[164:167]
    ds_read_b64_tr_b16 v[118:119], v11 offset:640
    v_mfma_f32_16x16x32_bf16 a[164:167], v[124:127], a[52:55], a[164:167]
    s_add_u32 s28, s49, s91
    buffer_load_dwordx4 v26, s[16:19], s28 offen lds
    v_mfma_f32_16x16x32_bf16 a[168:171], v[128:131], a[0:3], a[168:171]
    s_add_u32 m0, m0, s53
    ds_read_b64_tr_b16 v[120:121], v11 offset:32
    v_mfma_f32_16x16x32_bf16 a[168:171], v[132:135], a[28:31], a[168:171]
    ds_read_b64_tr_b16 v[122:123], v11 offset:160
    v_mfma_f32_16x16x32_bf16 a[172:175], v[128:131], a[4:7], a[172:175]
    ds_read_b64_tr_b16 v[124:125], v11 offset:544
    v_mfma_f32_16x16x32_bf16 a[172:175], v[132:135], a[32:35], a[172:175]
    ds_read_b64_tr_b16 v[126:127], v11 offset:672
    v_mfma_f32_16x16x32_bf16 a[176:179], v[128:131], a[8:11], a[176:179]
    v_mfma_f32_16x16x32_bf16 a[176:179], v[132:135], a[36:39], a[176:179]
    s_add_u32 s28, s49, s92
    buffer_load_dwordx4 v26, s[16:19], s28 offen lds
    v_mfma_f32_16x16x32_bf16 a[180:183], v[128:131], a[12:15], a[180:183]
    s_add_u32 m0, m0, s53
    v_mfma_f32_16x16x32_bf16 a[180:183], v[132:135], a[40:43], a[180:183]
    v_mfma_f32_16x16x32_bf16 a[184:187], v[128:131], a[16:19], a[184:187]
    v_mfma_f32_16x16x32_bf16 a[184:187], v[132:135], a[44:47], a[184:187]
    v_mfma_f32_16x16x32_bf16 a[188:191], v[128:131], a[20:23], a[188:191]
    v_mfma_f32_16x16x32_bf16 a[188:191], v[132:135], a[48:51], a[188:191]
    s_add_u32 s28, s49, s93
    buffer_load_dwordx4 v26, s[16:19], s28 offen lds
    v_mfma_f32_16x16x32_bf16 a[192:195], v[128:131], a[24:27], a[192:195]
    s_add_u32 m0, m0, s53
    v_mfma_f32_16x16x32_bf16 a[192:195], v[132:135], a[52:55], a[192:195]
    ds_read_b64_tr_b16 v[128:129], v11 offset:64
    v_mfma_f32_16x16x32_bf16 a[196:199], v[136:139], a[0:3], a[196:199]
    ds_read_b64_tr_b16 v[130:131], v11 offset:192
    v_mfma_f32_16x16x32_bf16 a[196:199], v[140:143], a[28:31], a[196:199]
    ds_read_b64_tr_b16 v[132:133], v11 offset:576
    v_mfma_f32_16x16x32_bf16 a[200:203], v[136:139], a[4:7], a[200:203]
    ds_read_b64_tr_b16 v[134:135], v11 offset:704
    v_mfma_f32_16x16x32_bf16 a[200:203], v[140:143], a[32:35], a[200:203]
    s_add_u32 s28, s49, s47
    buffer_load_dwordx4 v26, s[16:19], s28 offen lds
    v_mfma_f32_16x16x32_bf16 a[204:207], v[136:139], a[8:11], a[204:207]
    s_add_u32 m0, m0, s53
    v_mfma_f32_16x16x32_bf16 a[204:207], v[140:143], a[36:39], a[204:207]
    v_mfma_f32_16x16x32_bf16 a[208:211], v[136:139], a[12:15], a[208:211]
    v_mfma_f32_16x16x32_bf16 a[208:211], v[140:143], a[40:43], a[208:211]
    v_mfma_f32_16x16x32_bf16 a[212:215], v[136:139], a[16:19], a[212:215]
    v_mfma_f32_16x16x32_bf16 a[212:215], v[140:143], a[44:47], a[212:215]
    s_add_u32 s28, s49, s98
    buffer_load_dwordx4 v26, s[16:19], s28 offen lds
    v_mfma_f32_16x16x32_bf16 a[216:219], v[136:139], a[20:23], a[216:219]
    v_mfma_f32_16x16x32_bf16 a[216:219], v[140:143], a[48:51], a[216:219]
    v_mfma_f32_16x16x32_bf16 a[220:223], v[136:139], a[24:27], a[220:223]
    v_mfma_f32_16x16x32_bf16 a[220:223], v[140:143], a[52:55], a[220:223]
    ds_read_b64_tr_b16 v[136:137], v11 offset:96
    ds_read_b64_tr_b16 v[138:139], v11 offset:224
    ds_read_b64_tr_b16 v[140:141], v11 offset:608
    ds_read_b64_tr_b16 v[142:143], v11 offset:736
    s_mov_b32 s22, 0
L_at_qploop:
    s_waitcnt lgkmcnt(8)
    v_mfma_f32_16x16x32_bf16 v[144:147], v[112:115], v[28:31], v[144:147]
    s_add_u32 m0, s33, 0
    v_mfma_f32_16x16x32_bf16 v[144:147], v[116:119], v[56:59], v[144:147]
    s_mov_b32 s49, s50
    v_mfma_f32_16x16x32_bf16 v[148:151], v[112:115], v[32:35], v[148:151]
    v_mfma_f32_16x16x32_bf16 v[148:151], v[116:119], v[60:63], v[148:151]
    v_mfma_f32_16x16x32_bf16 v[152:155], v[112:115], v[36:39], v[152:155]
    v_mfma_f32_16x16x32_bf16 v[152:155], v[116:119], v[64:67], v[152:155]
    v_mfma_f32_16x16x32_bf16 v[156:159], v[112:115], v[40:43], v[156:159]
    s_waitcnt vmcnt(16) lgkmcnt(0)
    s_barrier
    v_mfma_f32_16x16x32_bf16 v[156:159], v[116:119], v[68:71], v[156:159]
    v_mfma_f32_16x16x32_bf16 v[160:163], v[112:115], v[44:47], v[160:163]
    v_mfma_f32_16x16x32_bf16 v[160:163], v[116:119], v[72:75], v[160:163]
    s_add_u32 s28, s49, s88
    buffer_load_dwordx4 v26, s[16:19], s28 offen lds
    v_mfma_f32_16x16x32_bf16 v[164:167], v[112:115], v[48:51], v[164:167]
    s_add_u32 m0, m0, s53
    v_mfma_f32_16x16x32_bf16 v[164:167], v[116:119], v[76:79], v[164:167]
    v_mfma_f32_16x16x32_bf16 v[168:171], v[112:115], v[52:55], v[168:171]
    v_mfma_f32_16x16x32_bf16 v[168:171], v[116:119], v[80:83], v[168:171]
    ds_read_b64_tr_b16 v[112:113], v11 offset:8448
    v_mfma_f32_16x16x32_bf16 v[172:175], v[120:123], v[28:31], v[172:175]
    ds_read_b64_tr_b16 v[114:115], v11 offset:8576
    v_mfma_f32_16x16x32_bf16 v[172:175], v[124:127], v[56:59], v[172:175]
    s_add_u32 s28, s49, s89
    buffer_load_dwordx4 v26, s[16:19], s28 offen lds
    v_mfma_f32_16x16x32_bf16 v[176:179], v[120:123], v[32:35], v[176:179]
    s_add_u32 m0, m0, s53
    ds_read_b64_tr_b16 v[116:117], v11 offset:8960
    v_mfma_f32_16x16x32_bf16 v[176:179], v[124:127], v[60:63], v[176:179]
    ds_read_b64_tr_b16 v[118:119], v11 offset:9088
    v_mfma_f32_16x16x32_bf16 v[180:183], v[120:123], v[36:39], v[180:183]
    v_mfma_f32_16x16x32_bf16 v[180:183], v[124:127], v[64:67], v[180:183]
    v_mfma_f32_16x16x32_bf16 v[184:187], v[120:123], v[40:43], v[184:187]
    v_mfma_f32_16x16x32_bf16 v[184:187], v[124:127], v[68:71], v[184:187]
    s_add_u32 s28, s49, s90
    buffer_load_dwordx4 v26, s[16:19], s28 offen lds
    v_mfma_f32_16x16x32_bf16 v[188:191], v[120:123], v[44:47], v[188:191]
    s_add_u32 m0, m0, s53
    v_mfma_f32_16x16x32_bf16 v[188:191], v[124:127], v[72:75], v[188:191]
    v_mfma_f32_16x16x32_bf16 v[192:195], v[120:123], v[48:51], v[192:195]
    v_mfma_f32_16x16x32_bf16 v[192:195], v[124:127], v[76:79], v[192:195]
    v_mfma_f32_16x16x32_bf16 v[196:199], v[120:123], v[52:55], v[196:199]
    v_mfma_f32_16x16x32_bf16 v[196:199], v[124:127], v[80:83], v[196:199]
    s_add_u32 s28, s49, s91
    buffer_load_dwordx4 v26, s[16:19], s28 offen lds
    v_mfma_f32_16x16x32_bf16 v[200:203], v[128:131], v[28:31], v[200:203]
    s_add_u32 m0, m0, s53
    ds_read_b64_tr_b16 v[120:121], v11 offset:8480
    v_mfma_f32_16x16x32_bf16 v[200:203], v[132:135], v[56:59], v[200:203]
    ds_read_b64_tr_b16 v[122:123], v11 offset:8608
    v_mfma_f32_16x16x32_bf16 v[204:207], v[128:131], v[32:35], v[204:207]
    ds_read_b64_tr_b16 v[124:125], v11 offset:8992
    v_mfma_f32_16x16x32_bf16 v[204:207], v[132:135], v[60:63], v[204:207]
    ds_read_b64_tr_b16 v[126:127], v11 offset:9120
    v_mfma_f32_16x16x32_bf16 v[208:211], v[128:131], v[36:39], v[208:211]
    v_mfma_f32_16x16x32_bf16 v[208:211], v[132:135], v[64:67], v[208:211]
    s_add_u32 s28, s49, s92
    buffer_load_dwordx4 v26, s[16:19], s28 offen lds
    v_mfma_f32_16x16x32_bf16 v[212:215], v[128:131], v[40:43], v[212:215]
    s_add_u32 m0, m0, s53
    v_mfma_f32_16x16x32_bf16 v[212:215], v[132:135], v[68:71], v[212:215]
    v_mfma_f32_16x16x32_bf16 v[216:219], v[128:131], v[44:47], v[216:219]
    v_mfma_f32_16x16x32_bf16 v[216:219], v[132:135], v[72:75], v[216:219]
    v_mfma_f32_16x16x32_bf16 v[220:223], v[128:131], v[48:51], v[220:223]
    v_mfma_f32_16x16x32_bf16 v[220:223], v[132:135], v[76:79], v[220:223]
    s_add_u32 s28, s49, s93
    buffer_load_dwordx4 v26, s[16:19], s28 offen lds
    v_mfma_f32_16x16x32_bf16 v[224:227], v[128:131], v[52:55], v[224:227]
    s_add_u32 m0, m0, s53
    v_mfma_f32_16x16x32_bf16 v[224:227], v[132:135], v[80:83], v[224:227]
    ds_read_b64_tr_b16 v[128:129], v11 offset:8512
    v_mfma_f32_16x16x32_bf16 v[228:231], v[136:139], v[28:31], v[228:231]
    ds_read_b64_tr_b16 v[130:131], v11 offset:8640
    v_mfma_f32_16x16x32_bf16 v[228:231], v[140:143], v[56:59], v[228:231]
    ds_read_b64_tr_b16 v[132:133], v11 offset:9024
    v_mfma_f32_16x16x32_bf16 v[232:235], v[136:139], v[32:35], v[232:235]
    ds_read_b64_tr_b16 v[134:135], v11 offset:9152
    v_mfma_f32_16x16x32_bf16 v[232:235], v[140:143], v[60:63], v[232:235]
    s_add_u32 s28, s49, s94
    buffer_load_dwordx4 v26, s[16:19], s28 offen lds
    v_mfma_f32_16x16x32_bf16 v[236:239], v[136:139], v[36:39], v[236:239]
    s_add_u32 m0, m0, s53
    v_mfma_f32_16x16x32_bf16 v[236:239], v[140:143], v[64:67], v[236:239]
    v_mfma_f32_16x16x32_bf16 v[240:243], v[136:139], v[40:43], v[240:243]
    v_mfma_f32_16x16x32_bf16 v[240:243], v[140:143], v[68:71], v[240:243]
    v_mfma_f32_16x16x32_bf16 v[244:247], v[136:139], v[44:47], v[244:247]
    v_mfma_f32_16x16x32_bf16 v[244:247], v[140:143], v[72:75], v[244:247]
    s_add_u32 s28, s49, s95
    buffer_load_dwordx4 v26, s[16:19], s28 offen lds
    v_mfma_f32_16x16x32_bf16 v[248:251], v[136:139], v[48:51], v[248:251]
    v_mfma_f32_16x16x32_bf16 v[248:251], v[140:143], v[76:79], v[248:251]
    v_mfma_f32_16x16x32_bf16 v[252:255], v[136:139], v[52:55], v[252:255]
    v_mfma_f32_16x16x32_bf16 v[252:255], v[140:143], v[80:83], v[252:255]
    ds_read_b64_tr_b16 v[136:137], v11 offset:8544
    ds_read_b64_tr_b16 v[138:139], v11 offset:8672
    ds_read_b64_tr_b16 v[140:141], v11 offset:9056
    ds_read_b64_tr_b16 v[142:143], v11 offset:9184
    s_waitcnt lgkmcnt(8)
    v_mfma_f32_16x16x32_bf16 a[112:115], v[112:115], v[28:31], a[112:115]
    s_add_u32 m0, s33, 8448
    v_mfma_f32_16x16x32_bf16 a[112:115], v[116:119], v[56:59], a[112:115]
    s_add_u32 s49, s50, s46
    v_mfma_f32_16x16x32_bf16 a[116:119], v[112:115], v[32:35], a[116:119]
    s_lshl1_add_u32 s50, s51, s50
    v_mfma_f32_16x16x32_bf16 a[116:119], v[116:119], v[60:63], a[116:119]
    s_add_u32 s82, s82, 2
    v_mfma_f32_16x16x32_bf16 a[120:123], v[112:115], v[36:39], a[120:123]
    s_cmp_eq_u32 s82, 20
    v_mfma_f32_16x16x32_bf16 a[120:123], v[116:119], v[64:67], a[120:123]
    s_cselect_b32 s29, s83, 0
    v_mfma_f32_16x16x32_bf16 a[124:127], v[112:115], v[40:43], a[124:127]
    s_sub_u32 s50, s50, s29
    s_waitcnt vmcnt(8) lgkmcnt(0)
    s_barrier
    ds_read_b128 a[0:3], v27 offset:16896
    v_mfma_f32_16x16x32_bf16 a[124:127], v[116:119], v[68:71], a[124:127]
    ds_read_b128 a[4:7], v27 offset:18944
    v_mfma_f32_16x16x32_bf16 a[128:131], v[112:115], v[44:47], a[128:131]
    ds_read_b128 a[8:11], v27 offset:20992
    v_mfma_f32_16x16x32_bf16 a[128:131], v[116:119], v[72:75], a[128:131]
    s_add_u32 s28, s49, s88
    buffer_load_dwordx4 v26, s[16:19], s28 offen lds
    v_mfma_f32_16x16x32_bf16 a[132:135], v[112:115], v[48:51], a[132:135]
    s_add_u32 m0, m0, s53
    ds_read_b128 a[12:15], v27 offset:23040
    v_mfma_f32_16x16x32_bf16 a[132:135], v[116:119], v[76:79], a[132:135]
    ds_read_b128 a[16:19], v27 offset:25344
    v_mfma_f32_16x16x32_bf16 a[136:139], v[112:115], v[52:55], a[136:139]
    ds_read_b128 a[20:23], v27 offset:27392
    v_mfma_f32_16x16x32_bf16 a[136:139], v[116:119], v[80:83], a[136:139]
    ds_read_b128 a[24:27], v27 offset:29440
    v_mfma_f32_16x16x32_bf16 a[140:143], v[120:123], v[28:31], a[140:143]
    ds_read_b128 a[28:31], v6 offset:16896
    v_mfma_f32_16x16x32_bf16 a[140:143], v[124:127], v[56:59], a[140:143]
    s_add_u32 s28, s49, s89
    buffer_load_dwordx4 v26, s[16:19], s28 offen lds
    v_mfma_f32_16x16x32_bf16 a[144:147], v[120:123], v[32:35], a[144:147]
    s_add_u32 m0, m0, s53
    ds_read_b128 a[32:35], v6 offset:18944
    v_mfma_f32_16x16x32_bf16 a[144:147], v[124:127], v[60:63], a[144:147]
    ds_read_b128 a[36:39], v6 offset:20992
    v_mfma_f32_16x16x32_bf16 a[148:151], v[120:123], v[36:39], a[148:151]
    ds_read_b128 a[40:43], v6 offset:23040
    v_mfma_f32_16x16x32_bf16 a[148:151], v[124:127], v[64:67], a[148:151]
    ds_read_b128 a[44:47], v6 offset:25344
    v_mfma_f32_16x16x32_bf16 a[152:155], v[120:123], v[40:43], a[152:155]
    ds_read_b128 a[48:51], v6 offset:27392
    v_mfma_f32_16x16x32_bf16 a[152:155], v[124:127], v[68:71], a[152:155]
    s_add_u32 s28, s49, s90
    buffer_load_dwordx4 v26, s[16:19], s28 offen lds
    v_mfma_f32_16x16x32_bf16 a[156:159], v[120:123], v[44:47], a[156:159]
    s_add_u32 m0, m0, s53
    ds_read_b128 a[52:55], v6 offset:29440
    v_mfma_f32_16x16x32_bf16 a[156:159], v[124:127], v[72:75], a[156:159]
    ds_read_b64_tr_b16 v[112:113], v11 offset:16896
    v_mfma_f32_16x16x32_bf16 a[160:163], v[120:123], v[48:51], a[160:163]
    ds_read_b64_tr_b16 v[114:115], v11 offset:17024
    v_mfma_f32_16x16x32_bf16 a[160:163], v[124:127], v[76:79], a[160:163]
    ds_read_b64_tr_b16 v[116:117], v11 offset:17408
    v_mfma_f32_16x16x32_bf16 a[164:167], v[120:123], v[52:55], a[164:167]
    ds_read_b64_tr_b16 v[118:119], v11 offset:17536
    v_mfma_f32_16x16x32_bf16 a[164:167], v[124:127], v[80:83], a[164:167]
    s_add_u32 s28, s49, s91
    buffer_load_dwordx4 v26, s[16:19], s28 offen lds
    v_mfma_f32_16x16x32_bf16 a[168:171], v[128:131], v[28:31], a[168:171]
    s_add_u32 m0, m0, s53
    ds_read_b64_tr_b16 v[120:121], v11 offset:16928
    v_mfma_f32_16x16x32_bf16 a[168:171], v[132:135], v[56:59], a[168:171]
    ds_read_b64_tr_b16 v[122:123], v11 offset:17056
    v_mfma_f32_16x16x32_bf16 a[172:175], v[128:131], v[32:35], a[172:175]
    ds_read_b64_tr_b16 v[124:125], v11 offset:17440
    v_mfma_f32_16x16x32_bf16 a[172:175], v[132:135], v[60:63], a[172:175]
    ds_read_b64_tr_b16 v[126:127], v11 offset:17568
    v_mfma_f32_16x16x32_bf16 a[176:179], v[128:131], v[36:39], a[176:179]
    v_mfma_f32_16x16x32_bf16 a[176:179], v[132:135], v[64:67], a[176:179]
    s_add_u32 s28, s49, s92
    buffer_load_dwordx4 v26, s[16:19], s28 offen lds
    v_mfma_f32_16x16x32_bf16 a[180:183], v[128:131], v[40:43], a[180:183]
    s_add_u32 m0, m0, s53
    v_mfma_f32_16x16x32_bf16 a[180:183], v[132:135], v[68:71], a[180:183]
    v_mfma_f32_16x16x32_bf16 a[184:187], v[128:131], v[44:47], a[184:187]
    v_mfma_f32_16x16x32_bf16 a[184:187], v[132:135], v[72:75], a[184:187]
    v_mfma_f32_16x16x32_bf16 a[188:191], v[128:131], v[48:51], a[188:191]
    v_mfma_f32_16x16x32_bf16 a[188:191], v[132:135], v[76:79], a[188:191]
    s_add_u32 s28, s49, s93
    buffer_load_dwordx4 v26, s[16:19], s28 offen lds
    v_mfma_f32_16x16x32_bf16 a[192:195], v[128:131], v[52:55], a[192:195]
    s_add_u32 m0, m0, s53
    v_mfma_f32_16x16x32_bf16 a[192:195], v[132:135], v[80:83], a[192:195]
    ds_read_b64_tr_b16 v[128:129], v11 offset:16960
    v_mfma_f32_16x16x32_bf16 a[196:199], v[136:139], v[28:31], a[196:199]
    ds_read_b64_tr_b16 v[130:131], v11 offset:17088
    v_mfma_f32_16x16x32_bf16 a[196:199], v[140:143], v[56:59], a[196:199]
    ds_read_b64_tr_b16 v[132:133], v11 offset:17472
    v_mfma_f32_16x16x32_bf16 a[200:203], v[136:139], v[32:35], a[200:203]
    ds_read_b64_tr_b16 v[134:135], v11 offset:17600
    v_mfma_f32_16x16x32_bf16 a[200:203], v[140:143], v[60:63], a[200:203]
    s_add_u32 s28, s49, s47
    buffer_load_dwordx4 v26, s[16:19], s28 offen lds
    v_mfma_f32_16x16x32_bf16 a[204:207], v[136:139], v[36:39], a[204:207]
    s_add_u32 m0, m0, s53
    v_mfma_f32_16x16x32_bf16 a[204:207], v[140:143], v[64:67], a[204:207]
    v_mfma_f32_16x16x32_bf16 a[208:211], v[136:139], v[40:43], a[208:211]
    v_mfma_f32_16x16x32_bf16 a[208:211], v[140:143], v[68:71], a[208:211]
    v_mfma_f32_16x16x32_bf16 a[212:215], v[136:139], v[44:47], a[212:215]
    v_mfma_f32_16x16x32_bf16 a[212:215], v[140:143], v[72:75], a[212:215]
    s_add_u32 s28, s49, s98
    buffer_load_dwordx4 v26, s[16:19], s28 offen lds
    v_mfma_f32_16x16x32_bf16 a[216:219], v[136:139], v[48:51], a[216:219]
    v_mfma_f32_16x16x32_bf16 a[216:219], v[140:143], v[76:79], a[216:219]
    v_mfma_f32_16x16x32_bf16 a[220:223], v[136:139], v[52:55], a[220:223]
    v_mfma_f32_16x16x32_bf16 a[220:223], v[140:143], v[80:83], a[220:223]
    ds_read_b64_tr_b16 v[136:137], v11 offset:16992
    ds_read_b64_tr_b16 v[138:139], v11 offset:17120
    ds_read_b64_tr_b16 v[140:141], v11 offset:17504
    ds_read_b64_tr_b16 v[142:143], v11 offset:17632
    s_waitcnt lgkmcnt(8)
    v_mfma_f32_16x16x32_bf16 v[144:147], v[112:115], a[0:3], v[144:147]
    s_add_u32 m0, s33, 16896
    v_mfma_f32_16x16x32_bf16 v[144:147], v[116:119], a[28:31], v[144:147]
    s_mov_b32 s49, s50
    v_mfma_f32_16x16x32_bf16 v[148:151], v[112:115], a[4:7], v[148:151]
    v_mfma_f32_16x16x32_bf16 v[148:151], v[116:119], a[32:35], v[148:151]
    v_mfma_f32_16x16x32_bf16 v[152:155], v[112:115], a[8:11], v[152:155]
    v_mfma_f32_16x16x32_bf16 v[152:155], v[116:119], a[36:39], v[152:155]
    v_mfma_f32_16x16x32_bf16 v[156:159], v[112:115], a[12:15], v[156:159]
    s_waitcnt vmcnt(16) lgkmcnt(0)
    s_barrier
    v_mfma_f32_16x16x32_bf16 v[156:159], v[116:119], a[40:43], v[156:159]
    v_mfma_f32_16x16x32_bf16 v[160:163], v[112:115], a[16:19], v[160:163]
    v_mfma_f32_16x16x32_bf16 v[160:163], v[116:119], a[44:47], v[160:163]
    s_add_u32 s28, s49, s88
    buffer_load_dwordx4 v26, s[16:19], s28 offen lds
    v_mfma_f32_16x16x32_bf16 v[164:167], v[112:115], a[20:23], v[164:167]
    s_add_u32 m0, m0, s53
    v_mfma_f32_16x16x32_bf16 v[164:167], v[116:119], a[48:51], v[164:167]
    v_mfma_f32_16x16x32_bf16 v[168:171], v[112:115], a[24:27], v[168:171]
    v_mfma_f32_16x16x32_bf16 v[168:171], v[116:119], a[52:55], v[168:171]
    ds_read_b64_tr_b16 v[112:113], v11 offset:25344
    v_mfma_f32_16x16x32_bf16 v[172:175], v[120:123], a[0:3], v[172:175]
    ds_read_b64_tr_b16 v[114:115], v11 offset:25472
    v_mfma_f32_16x16x32_bf16 v[172:175], v[124:127], a[28:31], v[172:175]
    s_add_u32 s28, s49, s89
    buffer_load_dwordx4 v26, s[16:19], s28 offen lds
    v_mfma_f32_16x16x32_bf16 v[176:179], v[120:123], a[4:7], v[176:179]
    s_add_u32 m0, m0, s53
    ds_read_b64_tr_b16 v[116:117], v11 offset:25856
    v_mfma_f32_16x16x32_bf16 v[176:179], v[124:127], a[32:35], v[176:179]
    ds_read_b64_tr_b16 v[118:119], v11 offset:25984
    v_mfma_f32_16x16x32_bf16 v[180:183], v[120:123], a[8:11], v[180:183]
    v_mfma_f32_16x16x32_bf16 v[180:183], v[124:127], a[36:39], v[180:183]
    v_mfma_f32_16x16x32_bf16 v[184:187], v[120:123], a[12:15], v[184:187]
    v_mfma_f32_16x16x32_bf16 v[184:187], v[124:127], a[40:43], v[184:187]
    s_add_u32 s28, s49, s90
    buffer_load_dwordx4 v26, s[16:19], s28 offen lds
    v_mfma_f32_16x16x32_bf16 v[188:191], v[120:123], a[16:19], v[188:191]
    s_add_u32 m0, m0, s53
    v_mfma_f32_16x16x32_bf16 v[188:191], v[124:127], a[44:47], v[188:191]
    v_mfma_f32_16x16x32_bf16 v[192:195], v[120:123], a[20:23], v[192:195]
    v_mfma_f32_16x16x32_bf16 v[192:195], v[124:127], a[48:51], v[192:195]
    v_mfma_f32_16x16x32_bf16 v[196:199], v[120:123], a[24:27], v[196:199]
    v_mfma_f32_16x16x32_bf16 v[196:199], v[124:127], a[52:55], v[196:199]
    s_add_u32 s28, s49, s91
    buffer_load_dwordx4 v26, s[16:19], s28 offen lds
    v_mfma_f32_16x16x32_bf16 v[200:203], v[128:131], a[0:3], v[200:203]
    s_add_u32 m0, m0, s53
    ds_read_b64_tr_b16 v[120:121], v11 offset:25376
    v_mfma_f32_16x16x32_bf16 v[200:203], v[132:135], a[28:31], v[200:203]
    ds_read_b64_tr_b16 v[122:123], v11 offset:25504
    v_mfma_f32_16x16x32_bf16 v[204:207], v[128:131], a[4:7], v[204:207]
    ds_read_b64_tr_b16 v[124:125], v11 offset:25888
    v_mfma_f32_16x16x32_bf16 v[204:207], v[132:135], a[32:35], v[204:207]
    ds_read_b64_tr_b16 v[126:127], v11 offset:26016
    v_mfma_f32_16x16x32_bf16 v[208:211], v[128:131], a[8:11], v[208:211]
    v_mfma_f32_16x16x32_bf16 v[208:211], v[132:135], a[36:39], v[208:211]
    s_add_u32 s28, s49, s92
    buffer_load_dwordx4 v26, s[16:19], s28 offen lds
    v_mfma_f32_16x16x32_bf16 v[212:215], v[128:131], a[12:15], v[212:215]
    s_add_u32 m0, m0, s53
    v_mfma_f32_16x16x32_bf16 v[212:215], v[132:135], a[40:43], v[212:215]
    v_mfma_f32_16x16x32_bf16 v[216:219], v[128:131], a[16:19], v[216:219]
    v_mfma_f32_16x16x32_bf16 v[216:219], v[132:135], a[44:47], v[216:219]
    v_mfma_f32_16x16x32_bf16 v[220:223], v[128:131], a[20:23], v[220:223]
    v_mfma_f32_16x16x32_bf16 v[220:223], v[132:135], a[48:51], v[220:223]
    s_add_u32 s28, s49, s93
    buffer_load_dwordx4 v26, s[16:19], s28 offen lds
    v_mfma_f32_16x16x32_bf16 v[224:227], v[128:131], a[24:27], v[224:227]
    s_add_u32 m0, m0, s53
    v_mfma_f32_16x16x32_bf16 v[224:227], v[132:135], a[52:55], v[224:227]
    ds_read_b64_tr_b16 v[128:129], v11 offset:25408
    v_mfma_f32_16x16x32_bf16 v[228:231], v[136:139], a[0:3], v[228:231]
    ds_read_b64_tr_b16 v[130:131], v11 offset:25536
    v_mfma_f32_16x16x32_bf16 v[228:231], v[140:143], a[28:31], v[228:231]
    ds_read_b64_tr_b16 v[132:133], v11 offset:25920
    v_mfma_f32_16x16x32_bf16 v[232:235], v[136:139], a[4:7], v[232:235]
    ds_read_b64_tr_b16 v[134:135], v11 offset:26048
    v_mfma_f32_16x16x32_bf16 v[232:235], v[140:143], a[32:35], v[232:235]
    s_add_u32 s28, s49, s94
    buffer_load_dwordx4 v26, s[16:19], s28 offen lds
    v_mfma_f32_16x16x32_bf16 v[236:239], v[136:139], a[8:11], v[236:239]
    s_add_u32 m0, m0, s53
    v_mfma_f32_16x16x32_bf16 v[236:239], v[140:143], a[36:39], v[236:239]
    v_mfma_f32_16x16x32_bf16 v[240:243], v[136:139], a[12:15], v[240:243]
    v_mfma_f32_16x16x32_bf16 v[240:243], v[140:143], a[40:43], v[240:243]
    v_mfma_f32_16x16x32_bf16 v[244:247], v[136:139], a[16:19], v[244:247]
    v_mfma_f32_16x16x32_bf16 v[244:247], v[140:143], a[44:47], v[244:247]
    s_add_u32 s28, s49, s95
    buffer_load_dwordx4 v26, s[16:19], s28 offen lds
    v_mfma_f32_16x16x32_bf16 v[248:251], v[136:139], a[20:23], v[248:251]
    v_mfma_f32_16x16x32_bf16 v[248:251], v[140:143], a[48:51], v[248:251]
    v_mfma_f32_16x16x32_bf16 v[252:255], v[136:139], a[24:27], v[252:255]
    v_mfma_f32_16x16x32_bf16 v[252:255], v[140:143], a[52:55], v[252:255]
    ds_read_b64_tr_b16 v[136:137], v11 offset:25440
    ds_read_b64_tr_b16 v[138:139], v11 offset:25568
    ds_read_b64_tr_b16 v[140:141], v11 offset:25952
    ds_read_b64_tr_b16 v[142:143], v11 offset:26080
    s_waitcnt lgkmcnt(8)
    v_mfma_f32_16x16x32_bf16 a[112:115], v[112:115], a[0:3], a[112:115]
    s_add_u32 m0, s33, 25344
    v_mfma_f32_16x16x32_bf16 a[112:115], v[116:119], a[28:31], a[112:115]
    s_add_u32 s49, s50, s46
    v_mfma_f32_16x16x32_bf16 a[116:119], v[112:115], a[4:7], a[116:119]
    s_lshl1_add_u32 s50, s51, s50
    v_mfma_f32_16x16x32_bf16 a[116:119], v[116:119], a[32:35], a[116:119]
    s_add_u32 s82, s82, 2
    v_mfma_f32_16x16x32_bf16 a[120:123], v[112:115], a[8:11], a[120:123]
    s_cmp_eq_u32 s82, 20
    v_mfma_f32_16x16x32_bf16 a[120:123], v[116:119], a[36:39], a[120:123]
    s_cselect_b32 s29, s83, 0
    v_mfma_f32_16x16x32_bf16 a[124:127], v[112:115], a[12:15], a[124:127]
    s_sub_u32 s50, s50, s29
    s_waitcnt vmcnt(8) lgkmcnt(0)
    s_barrier
    ds_read_b128 v[28:31], v27 offset:0
    v_mfma_f32_16x16x32_bf16 a[124:127], v[116:119], a[40:43], a[124:127]
    ds_read_b128 v[32:35], v27 offset:2048
    v_mfma_f32_16x16x32_bf16 a[128:131], v[112:115], a[16:19], a[128:131]
    ds_read_b128 v[36:39], v27 offset:4096
    v_mfma_f32_16x16x32_bf16 a[128:131], v[116:119], a[44:47], a[128:131]
    s_add_u32 s28, s49, s88
    buffer_load_dwordx4 v26, s[16:19], s28 offen lds
    v_mfma_f32_16x16x32_bf16 a[132:135], v[112:115], a[20:23], a[132:135]
    s_add_u32 m0, m0, s53
    ds_read_b128 v[40:43], v27 offset:6144
    v_mfma_f32_16x16x32_bf16 a[132:135], v[116:119], a[48:51], a[132:135]
    ds_read_b128 v[44:47], v27 offset:8448
    v_mfma_f32_16x16x32_bf16 a[136:139], v[112:115], a[24:27], a[136:139]
    ds_read_b128 v[48:51], v27 offset:10496
    v_mfma_f32_16x16x32_bf16 a[136:139], v[116:119], a[52:55], a[136:139]
    ds_read_b128 v[52:55], v27 offset:12544
    v_mfma_f32_16x16x32_bf16 a[140:143], v[120:123], a[0:3], a[140:143]
    ds_read_b128 v[56:59], v6 offset:0
    v_mfma_f32_16x16x32_bf16 a[140:143], v[124:127], a[28:31], a[140:143]
    s_add_u32 s28, s49, s89
    buffer_load_dwordx4 v26, s[16:19], s28 offen lds
    v_mfma_f32_16x16x32_bf16 a[144:147], v[120:123], a[4:7], a[144:147]
    s_add_u32 m0, m0, s53
    ds_read_b128 v[60:63], v6 offset:2048
    v_mfma_f32_16x16x32_bf16 a[144:147], v[124:127], a[32:35], a[144:147]
    ds_read_b128 v[64:67], v6 offset:4096
    v_mfma_f32_16x16x32_bf16 a[148:151], v[120:123], a[8:11], a[148:151]
    ds_read_b128 v[68:71], v6 offset:6144
    v_mfma_f32_16x16x32_bf16 a[148:151], v[124:127], a[36:39], a[148:151]
    ds_read_b128 v[72:75], v6 offset:8448
    v_mfma_f32_16x16x32_bf16 a[152:155], v[120:123], a[12:15], a[152:155]
    ds_read_b128 v[76:79], v6 offset:10496
    v_mfma_f32_16x16x32_bf16 a[152:155], v[124:127], a[40:43], a[152:155]
    s_add_u32 s28, s49, s90
    buffer_load_dwordx4 v26, s[16:19], s28 offen lds
    v_mfma_f32_16x16x32_bf16 a[156:159], v[120:123], a[16:19], a[156:159]
    s_add_u32 m0, m0, s53
    ds_read_b128 v[80:83], v6 offset:12544
    v_mfma_f32_16x16x32_bf16 a[156:159], v[124:127], a[44:47], a[156:159]
    ds_read_b64_tr_b16 v[112:113], v11 offset:0
    v_mfma_f32_16x16x32_bf16 a[160:163], v[120:123], a[20:23], a[160:163]
    ds_read_b64_tr_b16 v[114:115], v11 offset:128
    v_mfma_f32_16x16x32_bf16 a[160:163], v[124:127], a[48:51], a[160:163]
    ds_read_b64_tr_b16 v[116:117], v11 offset:512
    v_mfma_f32_16x16x32_bf16 a[164:167], v[120:123], a[24:27], a[164:167]
    ds_read_b64_tr_b16 v[118:119], v11 offset:640
    v_mfma_f32_16x16x32_bf16 a[164:167], v[124:127], a[52:55], a[164:167]
    s_add_u32 s28, s49, s91
    buffer_load_dwordx4 v26, s[16:19], s28 offen lds
    v_mfma_f32_16x16x32_bf16 a[168:171], v[128:131], a[0:3], a[168:171]
    s_add_u32 m0, m0, s53
    ds_read_b64_tr_b16 v[120:121], v11 offset:32
    v_mfma_f32_16x16x32_bf16 a[168:171], v[132:135], a[28:31], a[168:171]
    ds_read_b64_tr_b16 v[122:123], v11 offset:160
    v_mfma_f32_16x16x32_bf16 a[172:175], v[128:131], a[4:7], a[172:175]
    ds_read_b64_tr_b16 v[124:125], v11 offset:544
    v_mfma_f32_16x16x32_bf16 a[172:175], v[132:135], a[32:35], a[172:175]
    ds_read_b64_tr_b16 v[126:127], v11 offset:672
    v_mfma_f32_16x16x32_bf16 a[176:179], v[128:131], a[8:11], a[176:179]
    v_mfma_f32_16x16x32_bf16 a[176:179], v[132:135], a[36:39], a[176:179]
    s_add_u32 s28, s49, s92
    buffer_load_dwordx4 v26, s[16:19], s28 offen lds
    v_mfma_f32_16x16x32_bf16 a[180:183], v[128:131], a[12:15], a[180:183]
    s_add_u32 m0, m0, s53
    v_mfma_f32_16x16x32_bf16 a[180:183], v[132:135], a[40:43], a[180:183]
    v_mfma_f32_16x16x32_bf16 a[184:187], v[128:131], a[16:19], a[184:187]
    v_mfma_f32_16x16x32_bf16 a[184:187], v[132:135], a[44:47], a[184:187]
    v_mfma_f32_16x16x32_bf16 a[188:191], v[128:131], a[20:23], a[188:191]
    v_mfma_f32_16x16x32_bf16 a[188:191], v[132:135], a[48:51], a[188:191]
    s_add_u32 s28, s49, s93
    buffer_load_dwordx4 v26, s[16:19], s28 offen lds
    v_mfma_f32_16x16x32_bf16 a[192:195], v[128:131], a[24:27], a[192:195]
    s_add_u32 m0, m0, s53
    v_mfma_f32_16x16x32_bf16 a[192:195], v[132:135], a[52:55], a[192:195]
    ds_read_b64_tr_b16 v[128:129], v11 offset:64
    v_mfma_f32_16x16x32_bf16 a[196:199], v[136:139], a[0:3], a[196:199]
    ds_read_b64_tr_b16 v[130:131], v11 offset:192
    v_mfma_f32_16x16x32_bf16 a[196:199], v[140:143], a[28:31], a[196:199]
    ds_read_b64_tr_b16 v[132:133], v11 offset:576
    v_mfma_f32_16x16x32_bf16 a[200:203], v[136:139], a[4:7], a[200:203]
    ds_read_b64_tr_b16 v[134:135], v11 offset:704
    v_mfma_f32_16x16x32_bf16 a[200:203], v[140:143], a[32:35], a[200:203]
    s_add_u32 s28, s49, s47
    buffer_load_dwordx4 v26, s[16:19], s28 offen lds
    v_mfma_f32_16x16x32_bf16 a[204:207], v[136:139], a[8:11], a[204:207]
    s_add_u32 m0, m0, s53
    v_mfma_f32_16x16x32_bf16 a[204:207], v[140:143], a[36:39], a[204:207]
    v_mfma_f32_16x16x32_bf16 a[208:211], v[136:139], a[12:15], a[208:211]
    v_mfma_f32_16x16x32_bf16 a[208:211], v[140:143], a[40:43], a[208:211]
    v_mfma_f32_16x16x32_bf16 a[212:215], v[136:139], a[16:19], a[212:215]
    v_mfma_f32_16x16x32_bf16 a[212:215], v[140:143], a[44:47], a[212:215]
    s_add_u32 s28, s49, s98
    buffer_load_dwordx4 v26, s[16:19], s28 offen lds
    v_mfma_f32_16x16x32_bf16 a[216:219], v[136:139], a[20:23], a[216:219]
    v_mfma_f32_16x16x32_bf16 a[216:219], v[140:143], a[48:51], a[216:219]
    v_mfma_f32_16x16x32_bf16 a[220:223], v[136:139], a[24:27], a[220:223]
    v_mfma_f32_16x16x32_bf16 a[220:223], v[140:143], a[52:55], a[220:223]
    ds_read_b64_tr_b16 v[136:137], v11 offset:96
    ds_read_b64_tr_b16 v[138:139], v11 offset:224
    ds_read_b64_tr_b16 v[140:141], v11 offset:608
    ds_read_b64_tr_b16 v[142:143], v11 offset:736
    s_add_u32 s22, s22, 1
    s_cmp_lt_u32 s22, 3
    s_cbranch_scc1 L_at_qploop
    s_cmp_lg_u32 s70, 0
    s_cbranch_scc1 L_at_qptailB
    s_waitcnt lgkmcnt(8)
    v_mfma_f32_16x16x32_bf16 v[144:147], v[112:115], v[28:31], v[144:147]
    s_add_u32 s29, s34, s100
    v_mfma_f32_16x16x32_bf16 v[144:147], v[116:119], v[56:59], v[144:147]
    s_bfe_u32 s28, s29, 0x20003
    v_mfma_f32_16x16x32_bf16 v[148:151], v[112:115], v[32:35], v[148:151]
    s_lshl_b32 s28, s28, 16
    v_mfma_f32_16x16x32_bf16 v[148:151], v[116:119], v[60:63], v[148:151]
    s_and_b32 s29, s29, 7
    v_mfma_f32_16x16x32_bf16 v[152:155], v[112:115], v[36:39], v[152:155]
    s_lshl_b32 s29, s29, 11
    v_mfma_f32_16x16x32_bf16 v[152:155], v[116:119], v[64:67], v[152:155]
    s_add_u32 s29, s28, s29
    v_mfma_f32_16x16x32_bf16 v[156:159], v[112:115], v[40:43], v[156:159]
    s_lshr_b32 s28, s34, 5
    s_waitcnt vmcnt(16) lgkmcnt(0)
    s_barrier
    v_mfma_f32_16x16x32_bf16 v[156:159], v[116:119], v[68:71], v[156:159]
    s_lshl_b32 s28, s28, 19
    v_mfma_f32_16x16x32_bf16 v[160:163], v[112:115], v[44:47], v[160:163]
    s_add_u32 s49, s28, s29
    v_mfma_f32_16x16x32_bf16 v[160:163], v[116:119], v[72:75], v[160:163]
    s_add_u32 m0, s33, 0
    v_mfma_f32_16x16x32_bf16 v[164:167], v[112:115], v[48:51], v[164:167]
    s_add_u32 s34, s34, 1
    v_mfma_f32_16x16x32_bf16 v[164:167], v[116:119], v[76:79], v[164:167]
    buffer_load_dwordx4 v7, s[4:7], s49 offen offset:0 nt lds
    v_mfma_f32_16x16x32_bf16 v[168:171], v[112:115], v[52:55], v[168:171]
    s_add_u32 m0, m0, s96
    v_mfma_f32_16x16x32_bf16 v[168:171], v[116:119], v[80:83], v[168:171]
    ds_read_b64_tr_b16 v[112:113], v11 offset:8448
    v_mfma_f32_16x16x32_bf16 v[172:175], v[120:123], v[28:31], v[172:175]
    ds_read_b64_tr_b16 v[114:115], v11 offset:8576
    v_mfma_f32_16x16x32_bf16 v[172:175], v[124:127], v[56:59], v[172:175]
    buffer_load_dwordx4 v7, s[4:7], s49 offen offset:256 nt lds
    v_mfma_f32_16x16x32_bf16 v[176:179], v[120:123], v[32:35], v[176:179]
    s_add_u32 m0, m0, s97
    ds_read_b64_tr_b16 v[116:117], v11 offset:8960
    v_mfma_f32_16x16x32_bf16 v[176:179], v[124:127], v[60:63], v[176:179]
    ds_read_b64_tr_b16 v[118:119], v11 offset:9088
    v_mfma_f32_16x16x32_bf16 v[180:183], v[120:123], v[36:39], v[180:183]
    v_mfma_f32_16x16x32_bf16 v[180:183], v[124:127], v[64:67], v[180:183]
    v_mfma_f32_16x16x32_bf16 v[184:187], v[120:123], v[40:43], v[184:187]
    v_mfma_f32_16x16x32_bf16 v[184:187], v[124:127], v[68:71], v[184:187]
    buffer_load_dwordx4 v7, s[4:7], s49 offen offset:512 nt lds
    v_mfma_f32_16x16x32_bf16 v[188:191], v[120:123], v[44:47], v[188:191]
    s_add_u32 m0, m0, s96
    v_mfma_f32_16x16x32_bf16 v[188:191], v[124:127], v[72:75], v[188:191]
    v_mfma_f32_16x16x32_bf16 v[192:195], v[120:123], v[48:51], v[192:195]
    v_mfma_f32_16x16x32_bf16 v[192:195], v[124:127], v[76:79], v[192:195]
    v_mfma_f32_16x16x32_bf16 v[196:199], v[120:123], v[52:55], v[196:199]
    v_mfma_f32_16x16x32_bf16 v[196:199], v[124:127], v[80:83], v[196:199]
    buffer_load_dwordx4 v7, s[4:7], s49 offen offset:768 nt lds
    v_mfma_f32_16x16x32_bf16 v[200:203], v[128:131], v[28:31], v[200:203]
    s_add_u32 m0, m0, s97
    ds_read_b64_tr_b16 v[120:121], v11 offset:8480
    v_mfma_f32_16x16x32_bf16 v[200:203], v[132:135], v[56:59], v[200:203]
    ds_read_b64_tr_b16 v[122:123], v11 offset:8608
    v_mfma_f32_16x16x32_bf16 v[204:207], v[128:131], v[32:35], v[204:207]
    ds_read_b64_tr_b16 v[124:125], v11 offset:8992
    v_mfma_f32_16x16x32_bf16 v[204:207], v[132:135], v[60:63], v[204:207]
    ds_read_b64_tr_b16 v[126:127], v11 offset:9120
    v_mfma_f32_16x16x32_bf16 v[208:211], v[128:131], v[36:39], v[208:211]
    v_mfma_f32_16x16x32_bf16 v[208:211], v[132:135], v[64:67], v[208:211]
    buffer_load_dwordx4 v7, s[4:7], s49 offen offset:1024 nt lds
    v_mfma_f32_16x16x32_bf16 v[212:215], v[128:131], v[40:43], v[212:215]
    s_add_u32 m0, m0, s96
    v_mfma_f32_16x16x32_bf16 v[212:215], v[132:135], v[68:71], v[212:215]
    v_mfma_f32_16x16x32_bf16 v[216:219], v[128:131], v[44:47], v[216:219]
    v_mfma_f32_16x16x32_bf16 v[216:219], v[132:135], v[72:75], v[216:219]
    v_mfma_f32_16x16x32_bf16 v[220:223], v[128:131], v[48:51], v[220:223]
    v_mfma_f32_16x16x32_bf16 v[220:223], v[132:135], v[76:79], v[220:223]
    buffer_load_dwordx4 v7, s[4:7], s49 offen offset:1280 nt lds
    v_mfma_f32_16x16x32_bf16 v[224:227], v[128:131], v[52:55], v[224:227]
    s_add_u32 m0, m0, s97
    v_mfma_f32_16x16x32_bf16 v[224:227], v[132:135], v[80:83], v[224:227]
    ds_read_b64_tr_b16 v[128:129], v11 offset:8512
    v_mfma_f32_16x16x32_bf16 v[228:231], v[136:139], v[28:31], v[228:231]
    ds_read_b64_tr_b16 v[130:131], v11 offset:8640
    v_mfma_f32_16x16x32_bf16 v[228:231], v[140:143], v[56:59], v[228:231]
    ds_read_b64_tr_b16 v[132:133], v11 offset:9024
    v_mfma_f32_16x16x32_bf16 v[232:235], v[136:139], v[32:35], v[232:235]
    ds_read_b64_tr_b16 v[134:135], v11 offset:9152
    v_mfma_f32_16x16x32_bf16 v[232:235], v[140:143], v[60:63], v[232:235]
    buffer_load_dwordx4 v7, s[4:7], s49 offen offset:1536 nt lds
    v_mfma_f32_16x16x32_bf16 v[236:239], v[136:139], v[36:39], v[236:239]
    s_add_u32 m0, m0, s96
    v_mfma_f32_16x16x32_bf16 v[236:239], v[140:143], v[64:67], v[236:239]
    v_mfma_f32_16x16x32_bf16 v[240:243], v[136:139], v[40:43], v[240:243]
    v_mfma_f32_16x16x32_bf16 v[240:243], v[140:143], v[68:71], v[240:243]
    v_mfma_f32_16x16x32_bf16 v[244:247], v[136:139], v[44:47], v[244:247]
    v_mfma_f32_16x16x32_bf16 v[244:247], v[140:143], v[72:75], v[244:247]
    buffer_load_dwordx4 v7, s[4:7], s49 offen offset:1792 nt lds
    v_mfma_f32_16x16x32_bf16 v[248:251], v[136:139], v[48:51], v[248:251]
    v_mfma_f32_16x16x32_bf16 v[248:251], v[140:143], v[76:79], v[248:251]
    v_mfma_f32_16x16x32_bf16 v[252:255], v[136:139], v[52:55], v[252:255]
    v_mfma_f32_16x16x32_bf16 v[252:255], v[140:143], v[80:83], v[252:255]
    ds_read_b64_tr_b16 v[136:137], v11 offset:8544
    ds_read_b64_tr_b16 v[138:139], v11 offset:8672
    ds_read_b64_tr_b16 v[140:141], v11 offset:9056
    ds_read_b64_tr_b16 v[142:143], v11 offset:9184
    s_waitcnt lgkmcnt(8)
    v_mfma_f32_16x16x32_bf16 a[112:115], v[112:115], v[28:31], a[112:115]
    s_add_u32 s29, s34, s100
    v_mfma_f32_16x16x32_bf16 a[112:115], v[116:119], v[56:59], a[112:115]
    s_bfe_u32 s28, s29, 0x20003
    v_mfma_f32_16x16x32_bf16 a[116:119], v[112:115], v[32:35], a[116:119]
    s_lshl_b32 s28, s28, 16
    v_mfma_f32_16x16x32_bf16 a[116:119], v[116:119], v[60:63], a[116:119]
    s_and_b32 s29, s29, 7
    v_mfma_f32_16x16x32_bf16 a[120:123], v[112:115], v[36:39], a[120:123]
    s_lshl_b32 s29, s29, 11
    v_mfma_f32_16x16x32_bf16 a[120:123], v[116:119], v[64:67], a[120:123]
    s_add_u32 s29, s28, s29
    v_mfma_f32_16x16x32_bf16 a[124:127], v[112:115], v[40:43], a[124:127]
    s_lshr_b32 s28, s34, 5
    s_waitcnt vmcnt(8) lgkmcnt(0)
    s_barrier
    ds_read_b128 a[0:3], v27 offset:16896
    v_mfma_f32_16x16x32_bf16 a[124:127], v[116:119], v[68:71], a[124:127]
    s_lshl_b32 s28, s28, 19
    ds_read_b128 a[4:7], v27 offset:18944
    v_mfma_f32_16x16x32_bf16 a[128:131], v[112:115], v[44:47], a[128:131]
    s_add_u32 s49, s28, s29
    ds_read_b128 a[8:11], v27 offset:20992
    v_mfma_f32_16x16x32_bf16 a[128:131], v[116:119], v[72:75], a[128:131]
    s_add_u32 m0, s33, 8448
    ds_read_b128 a[12:15], v27 offset:23040
    v_mfma_f32_16x16x32_bf16 a[132:135], v[112:115], v[48:51], a[132:135]
    s_add_u32 s34, s34, 1
    ds_read_b128 a[16:19], v27 offset:25344
    v_mfma_f32_16x16x32_bf16 a[132:135], v[116:119], v[76:79], a[132:135]
    buffer_load_dwordx4 v7, s[4:7], s49 offen offset:0 nt lds
    v_mfma_f32_16x16x32_bf16 a[136:139], v[112:115], v[52:55], a[136:139]
    s_add_u32 m0, m0, s96
    ds_read_b128 a[20:23], v27 offset:27392
    v_mfma_f32_16x16x32_bf16 a[136:139], v[116:119], v[80:83], a[136:139]
    ds_read_b128 a[24:27], v27 offset:29440
    v_mfma_f32_16x16x32_bf16 a[140:143], v[120:123], v[28:31], a[140:143]
    ds_read_b128 a[28:31], v6 offset:16896
    v_mfma_f32_16x16x32_bf16 a[140:143], v[124:127], v[56:59], a[140:143]
    buffer_load_dwordx4 v7, s[4:7], s49 offen offset:256 nt lds
    v_mfma_f32_16x16x32_bf16 a[144:147], v[120:123], v[32:35], a[144:147]
    s_add_u32 m0, m0, s97
    ds_read_b128 a[32:35], v6 offset:18944
    v_mfma_f32_16x16x32_bf16 a[144:147], v[124:127], v[60:63], a[144:147]
    ds_read_b128 a[36:39], v6 offset:20992
    v_mfma_f32_16x16x32_bf16 a[148:151], v[120:123], v[36:39], a[148:151]
    ds_read_b128 a[40:43], v6 offset:23040
    v_mfma_f32_16x16x32_bf16 a[148:151], v[124:127], v[64:67], a[148:151]
    ds_read_b128 a[44:47], v6 offset:25344
    v_mfma_f32_16x16x32_bf16 a[152:155], v[120:123], v[40:43], a[152:155]
    ds_read_b128 a[48:51], v6 offset:27392
    v_mfma_f32_16x16x32_bf16 a[152:155], v[124:127], v[68:71], a[152:155]
    buffer_load_dwordx4 v7, s[4:7], s49 offen offset:512 nt lds
    v_mfma_f32_16x16x32_bf16 a[156:159], v[120:123], v[44:47], a[156:159]
    s_add_u32 m0, m0, s96
    ds_read_b128 a[52:55], v6 offset:29440
    v_mfma_f32_16x16x32_bf16 a[156:159], v[124:127], v[72:75], a[156:159]
    ds_read_b64_tr_b16 v[112:113], v11 offset:16896
    v_mfma_f32_16x16x32_bf16 a[160:163], v[120:123], v[48:51], a[160:163]
    ds_read_b64_tr_b16 v[114:115], v11 offset:17024
    v_mfma_f32_16x16x32_bf16 a[160:163], v[124:127], v[76:79], a[160:163]
    ds_read_b64_tr_b16 v[116:117], v11 offset:17408
    v_mfma_f32_16x16x32_bf16 a[164:167], v[120:123], v[52:55], a[164:167]
    ds_read_b64_tr_b16 v[118:119], v11 offset:17536
    v_mfma_f32_16x16x32_bf16 a[164:167], v[124:127], v[80:83], a[164:167]
    buffer_load_dwordx4 v7, s[4:7], s49 offen offset:768 nt lds
    v_mfma_f32_16x16x32_bf16 a[168:171], v[128:131], v[28:31], a[168:171]
    s_add_u32 m0, m0, s97
    ds_read_b64_tr_b16 v[120:121], v11 offset:16928
    v_mfma_f32_16x16x32_bf16 a[168:171], v[132:135], v[56:59], a[168:171]
    ds_read_b64_tr_b16 v[122:123], v11 offset:17056
    v_mfma_f32_16x16x32_bf16 a[172:175], v[128:131], v[32:35], a[172:175]
    ds_read_b64_tr_b16 v[124:125], v11 offset:17440
    v_mfma_f32_16x16x32_bf16 a[172:175], v[132:135], v[60:63], a[172:175]
    ds_read_b64_tr_b16 v[126:127], v11 offset:17568
    v_mfma_f32_16x16x32_bf16 a[176:179], v[128:131], v[36:39], a[176:179]
    v_mfma_f32_16x16x32_bf16 a[176:179], v[132:135], v[64:67], a[176:179]
    buffer_load_dwordx4 v7, s[4:7], s49 offen offset:1024 nt lds
    v_mfma_f32_16x16x32_bf16 a[180:183], v[128:131], v[40:43], a[180:183]
    s_add_u32 m0, m0, s96
    v_mfma_f32_16x16x32_bf16 a[180:183], v[132:135], v[68:71], a[180:183]
    v_mfma_f32_16x16x32_bf16 a[184:187], v[128:131], v[44:47], a[184:187]
    v_mfma_f32_16x16x32_bf16 a[184:187], v[132:135], v[72:75], a[184:187]
    v_mfma_f32_16x16x32_bf16 a[188:191], v[128:131], v[48:51], a[188:191]
    v_mfma_f32_16x16x32_bf16 a[188:191], v[132:135], v[76:79], a[188:191]
    buffer_load_dwordx4 v7, s[4:7], s49 offen offset:1280 nt lds
    v_mfma_f32_16x16x32_bf16 a[192:195], v[128:131], v[52:55], a[192:195]
    s_add_u32 m0, m0, s97
    v_mfma_f32_16x16x32_bf16 a[192:195], v[132:135], v[80:83], a[192:195]
    ds_read_b64_tr_b16 v[128:129], v11 offset:16960
    v_mfma_f32_16x16x32_bf16 a[196:199], v[136:139], v[28:31], a[196:199]
    ds_read_b64_tr_b16 v[130:131], v11 offset:17088
    v_mfma_f32_16x16x32_bf16 a[196:199], v[140:143], v[56:59], a[196:199]
    ds_read_b64_tr_b16 v[132:133], v11 offset:17472
    v_mfma_f32_16x16x32_bf16 a[200:203], v[136:139], v[32:35], a[200:203]
    ds_read_b64_tr_b16 v[134:135], v11 offset:17600
    v_mfma_f32_16x16x32_bf16 a[200:203], v[140:143], v[60:63], a[200:203]
    buffer_load_dwordx4 v7, s[4:7], s49 offen offset:1536 nt lds
    v_mfma_f32_16x16x32_bf16 a[204:207], v[136:139], v[36:39], a[204:207]
    s_add_u32 m0, m0, s96
    v_mfma_f32_16x16x32_bf16 a[204:207], v[140:143], v[64:67], a[204:207]
    v_mfma_f32_16x16x32_bf16 a[208:211], v[136:139], v[40:43], a[208:211]
    v_mfma_f32_16x16x32_bf16 a[208:211], v[140:143], v[68:71], a[208:211]
    v_mfma_f32_16x16x32_bf16 a[212:215], v[136:139], v[44:47], a[212:215]
    v_mfma_f32_16x16x32_bf16 a[212:215], v[140:143], v[72:75], a[212:215]
    buffer_load_dwordx4 v7, s[4:7], s49 offen offset:1792 nt lds
    v_mfma_f32_16x16x32_bf16 a[216:219], v[136:139], v[48:51], a[216:219]
    v_mfma_f32_16x16x32_bf16 a[216:219], v[140:143], v[76:79], a[216:219]
    v_mfma_f32_16x16x32_bf16 a[220:223], v[136:139], v[52:55], a[220:223]
    v_mfma_f32_16x16x32_bf16 a[220:223], v[140:143], v[80:83], a[220:223]
    ds_read_b64_tr_b16 v[136:137], v11 offset:16992
    ds_read_b64_tr_b16 v[138:139], v11 offset:17120
    ds_read_b64_tr_b16 v[140:141], v11 offset:17504
    ds_read_b64_tr_b16 v[142:143], v11 offset:17632
    s_waitcnt lgkmcnt(8)
    v_mfma_f32_16x16x32_bf16 v[144:147], v[112:115], a[0:3], v[144:147]
    s_add_u32 s29, s34, s100
    v_mfma_f32_16x16x32_bf16 v[144:147], v[116:119], a[28:31], v[144:147]
    s_bfe_u32 s28, s29, 0x20003
    v_mfma_f32_16x16x32_bf16 v[148:151], v[112:115], a[4:7], v[148:151]
    s_lshl_b32 s28, s28, 16
    v_mfma_f32_16x16x32_bf16 v[148:151], v[116:119], a[32:35], v[148:151]
    s_and_b32 s29, s29, 7
    v_mfma_f32_16x16x32_bf16 v[152:155], v[112:115], a[8:11], v[152:155]
    s_lshl_b32 s29, s29, 11
    v_mfma_f32_16x16x32_bf16 v[152:155], v[116:119], a[36:39], v[152:155]
    s_add_u32 s29, s28, s29
    v_mfma_f32_16x16x32_bf16 v[156:159], v[112:115], a[12:15], v[156:159]
    s_lshr_b32 s28, s34, 5
    s_waitcnt vmcnt(16) lgkmcnt(0)
    s_barrier
    v_mfma_f32_16x16x32_bf16 v[156:159], v[116:119], a[40:43], v[156:159]
    s_lshl_b32 s28, s28, 19
    v_mfma_f32_16x16x32_bf16 v[160:163], v[112:115], a[16:19], v[160:163]
    s_add_u32 s49, s28, s29
    v_mfma_f32_16x16x32_bf16 v[160:163], v[116:119], a[44:47], v[160:163]
    s_add_u32 m0, s33, 16896
    v_mfma_f32_16x16x32_bf16 v[164:167], v[112:115], a[20:23], v[164:167]
    s_add_u32 s34, s34, 1
    v_mfma_f32_16x16x32_bf16 v[164:167], v[116:119], a[48:51], v[164:167]
    buffer_load_dwordx4 v7, s[4:7], s49 offen offset:0 nt lds
    v_mfma_f32_16x16x32_bf16 v[168:171], v[112:115], a[24:27], v[168:171]
    s_add_u32 m0, m0, s96
    v_mfma_f32_16x16x32_bf16 v[168:171], v[116:119], a[52:55], v[168:171]
    ds_read_b64_tr_b16 v[112:113], v11 offset:25344
    v_mfma_f32_16x16x32_bf16 v[172:175], v[120:123], a[0:3], v[172:175]
    ds_read_b64_tr_b16 v[114:115], v11 offset:25472
    v_mfma_f32_16x16x32_bf16 v[172:175], v[124:127], a[28:31], v[172:175]
    buffer_load_dwordx4 v7, s[4:7], s49 offen offset:256 nt lds
    v_mfma_f32_16x16x32_bf16 v[176:179], v[120:123], a[4:7], v[176:179]
    s_add_u32 m0, m0, s97
    ds_read_b64_tr_b16 v[116:117], v11 offset:25856
    v_mfma_f32_16x16x32_bf16 v[176:179], v[124:127], a[32:35], v[176:179]
    ds_read_b64_tr_b16 v[118:119], v11 offset:25984
    v_mfma_f32_16x16x32_bf16 v[180:183], v[120:123], a[8:11], v[180:183]
    v_mfma_f32_16x16x32_bf16 v[180:183], v[124:127], a[36:39], v[180:183]
    v_mfma_f32_16x16x32_bf16 v[184:187], v[120:123], a[12:15], v[184:187]
    v_mfma_f32_16x16x32_bf16 v[184:187], v[124:127], a[40:43], v[184:187]
    buffer_load_dwordx4 v7, s[4:7], s49 offen offset:512 nt lds
    v_mfma_f32_16x16x32_bf16 v[188:191], v[120:123], a[16:19], v[188:191]
    s_add_u32 m0, m0, s96
    v_mfma_f32_16x16x32_bf16 v[188:191], v[124:127], a[44:47], v[188:191]
    v_mfma_f32_16x16x32_bf16 v[192:195], v[120:123], a[20:23], v[192:195]
    v_mfma_f32_16x16x32_bf16 v[192:195], v[124:127], a[48:51], v[192:195]
    v_mfma_f32_16x16x32_bf16 v[196:199], v[120:123], a[24:27], v[196:199]
    v_mfma_f32_16x16x32_bf16 v[196:199], v[124:127], a[52:55], v[196:199]
    buffer_load_dwordx4 v7, s[4:7], s49 offen offset:768 nt lds
    v_mfma_f32_16x16x32_bf16 v[200:203], v[128:131], a[0:3], v[200:203]
    s_add_u32 m0, m0, s97
    ds_read_b64_tr_b16 v[120:121], v11 offset:25376
    v_mfma_f32_16x16x32_bf16 v[200:203], v[132:135], a[28:31], v[200:203]
    ds_read_b64_tr_b16 v[122:123], v11 offset:25504
    v_mfma_f32_16x16x32_bf16 v[204:207], v[128:131], a[4:7], v[204:207]
    ds_read_b64_tr_b16 v[124:125], v11 offset:25888
    v_mfma_f32_16x16x32_bf16 v[204:207], v[132:135], a[32:35], v[204:207]
    ds_read_b64_tr_b16 v[126:127], v11 offset:26016
    v_mfma_f32_16x16x32_bf16 v[208:211], v[128:131], a[8:11], v[208:211]
    v_mfma_f32_16x16x32_bf16 v[208:211], v[132:135], a[36:39], v[208:211]
    buffer_load_dwordx4 v7, s[4:7], s49 offen offset:1024 nt lds
    v_mfma_f32_16x16x32_bf16 v[212:215], v[128:131], a[12:15], v[212:215]
    s_add_u32 m0, m0, s96
    v_mfma_f32_16x16x32_bf16 v[212:215], v[132:135], a[40:43], v[212:215]
    v_mfma_f32_16x16x32_bf16 v[216:219], v[128:131], a[16:19], v[216:219]
    v_mfma_f32_16x16x32_bf16 v[216:219], v[132:135], a[44:47], v[216:219]
    v_mfma_f32_16x16x32_bf16 v[220:223], v[128:131], a[20:23], v[220:223]
    v_mfma_f32_16x16x32_bf16 v[220:223], v[132:135], a[48:51], v[220:223]
    buffer_load_dwordx4 v7, s[4:7], s49 offen offset:1280 nt lds
    v_mfma_f32_16x16x32_bf16 v[224:227], v[128:131], a[24:27], v[224:227]
    s_add_u32 m0, m0, s97
    v_mfma_f32_16x16x32_bf16 v[224:227], v[132:135], a[52:55], v[224:227]
    ds_read_b64_tr_b16 v[128:129], v11 offset:25408
    v_mfma_f32_16x16x32_bf16 v[228:231], v[136:139], a[0:3], v[228:231]
    ds_read_b64_tr_b16 v[130:131], v11 offset:25536
    v_mfma_f32_16x16x32_bf16 v[228:231], v[140:143], a[28:31], v[228:231]
    ds_read_b64_tr_b16 v[132:133], v11 offset:25920
    v_mfma_f32_16x16x32_bf16 v[232:235], v[136:139], a[4:7], v[232:235]
    ds_read_b64_tr_b16 v[134:135], v11 offset:26048
    v_mfma_f32_16x16x32_bf16 v[232:235], v[140:143], a[32:35], v[232:235]
    buffer_load_dwordx4 v7, s[4:7], s49 offen offset:1536 nt lds
    v_mfma_f32_16x16x32_bf16 v[236:239], v[136:139], a[8:11], v[236:239]
    s_add_u32 m0, m0, s96
    v_mfma_f32_16x16x32_bf16 v[236:239], v[140:143], a[36:39], v[236:239]
    v_mfma_f32_16x16x32_bf16 v[240:243], v[136:139], a[12:15], v[240:243]
    v_mfma_f32_16x16x32_bf16 v[240:243], v[140:143], a[40:43], v[240:243]
    v_mfma_f32_16x16x32_bf16 v[244:247], v[136:139], a[16:19], v[244:247]
    v_mfma_f32_16x16x32_bf16 v[244:247], v[140:143], a[44:47], v[244:247]
    buffer_load_dwordx4 v7, s[4:7], s49 offen offset:1792 nt lds
    v_mfma_f32_16x16x32_bf16 v[248:251], v[136:139], a[20:23], v[248:251]
    v_mfma_f32_16x16x32_bf16 v[248:251], v[140:143], a[48:51], v[248:251]
    v_mfma_f32_16x16x32_bf16 v[252:255], v[136:139], a[24:27], v[252:255]
    v_mfma_f32_16x16x32_bf16 v[252:255], v[140:143], a[52:55], v[252:255]
    ds_read_b64_tr_b16 v[136:137], v11 offset:25440
    ds_read_b64_tr_b16 v[138:139], v11 offset:25568
    ds_read_b64_tr_b16 v[140:141], v11 offset:25952
    ds_read_b64_tr_b16 v[142:143], v11 offset:26080
    s_waitcnt lgkmcnt(8)
    v_mfma_f32_16x16x32_bf16 a[112:115], v[112:115], a[0:3], a[112:115]
    s_add_u32 s29, s34, s100
    v_mfma_f32_16x16x32_bf16 a[112:115], v[116:119], a[28:31], a[112:115]
    s_bfe_u32 s28, s29, 0x20003
    v_mfma_f32_16x16x32_bf16 a[116:119], v[112:115], a[4:7], a[116:119]
    s_lshl_b32 s28, s28, 16
    v_mfma_f32_16x16x32_bf16 a[116:119], v[116:119], a[32:35], a[116:119]
    s_and_b32 s29, s29, 7
    v_mfma_f32_16x16x32_bf16 a[120:123], v[112:115], a[8:11], a[120:123]
    s_lshl_b32 s29, s29, 11
    v_mfma_f32_16x16x32_bf16 a[120:123], v[116:119], a[36:39], a[120:123]
    s_add_u32 s29, s28, s29
    v_mfma_f32_16x16x32_bf16 a[124:127], v[112:115], a[12:15], a[124:127]
    s_lshr_b32 s28, s34, 5
    s_waitcnt vmcnt(16) lgkmcnt(0)
    s_barrier
    ds_read_b128 v[56:59], v8 offset:0
    v_mfma_f32_16x16x32_bf16 a[124:127], v[116:119], a[40:43], a[124:127]
    s_lshl_b32 s28, s28, 19
    ds_read_b128 v[60:63], v8 offset:64
    v_mfma_f32_16x16x32_bf16 a[128:131], v[112:115], a[16:19], a[128:131]
    s_add_u32 s49, s28, s29
    ds_read_b128 v[64:67], v8 offset:128
    v_mfma_f32_16x16x32_bf16 a[128:131], v[116:119], a[44:47], a[128:131]
    s_add_u32 m0, s33, 25344
    ds_read_b128 v[68:71], v8 offset:192
    v_mfma_f32_16x16x32_bf16 a[132:135], v[112:115], a[20:23], a[132:135]
    s_add_u32 s34, s34, 1
    ds_read_b128 v[72:75], v8 offset:512
    v_mfma_f32_16x16x32_bf16 a[132:135], v[116:119], a[48:51], a[132:135]
    buffer_load_dwordx4 v7, s[4:7], s49 offen offset:0 nt lds
    v_mfma_f32_16x16x32_bf16 a[136:139], v[112:115], a[24:27], a[136:139]
    s_add_u32 m0, m0, s96
    ds_read_b128 v[76:79], v8 offset:576
    v_mfma_f32_16x16x32_bf16 a[136:139], v[116:119], a[52:55], a[136:139]
    ds_read_b128 v[80:83], v8 offset:640
    v_mfma_f32_16x16x32_bf16 a[140:143], v[120:123], a[0:3], a[140:143]
    ds_read_b128 v[84:87], v8 offset:704
    v_mfma_f32_16x16x32_bf16 a[140:143], v[124:127], a[28:31], a[140:143]
    buffer_load_dwordx4 v7, s[4:7], s49 offen offset:256 nt lds
    v_mfma_f32_16x16x32_bf16 a[144:147], v[120:123], a[4:7], a[144:147]
    s_add_u32 m0, m0, s97
    v_mfma_f32_16x16x32_bf16 a[144:147], v[124:127], a[32:35], a[144:147]
    v_mfma_f32_16x16x32_bf16 a[148:151], v[120:123], a[8:11], a[148:151]
    v_mfma_f32_16x16x32_bf16 a[148:151], v[124:127], a[36:39], a[148:151]
    v_mfma_f32_16x16x32_bf16 a[152:155], v[120:123], a[12:15], a[152:155]
    v_mfma_f32_16x16x32_bf16 a[152:155], v[124:127], a[40:43], a[152:155]
    buffer_load_dwordx4 v7, s[4:7], s49 offen offset:512 nt lds
    v_mfma_f32_16x16x32_bf16 a[156:159], v[120:123], a[16:19], a[156:159]
    s_add_u32 m0, m0, s96
    v_mfma_f32_16x16x32_bf16 a[156:159], v[124:127], a[44:47], a[156:159]
    v_mfma_f32_16x16x32_bf16 a[160:163], v[120:123], a[20:23], a[160:163]
    v_mfma_f32_16x16x32_bf16 a[160:163], v[124:127], a[48:51], a[160:163]
    v_mfma_f32_16x16x32_bf16 a[164:167], v[120:123], a[24:27], a[164:167]
    v_mfma_f32_16x16x32_bf16 a[164:167], v[124:127], a[52:55], a[164:167]
    buffer_load_dwordx4 v7, s[4:7], s49 offen offset:768 nt lds
    v_mfma_f32_16x16x32_bf16 a[168:171], v[128:131], a[0:3], a[168:171]
    s_add_u32 m0, m0, s97
    v_mfma_f32_16x16x32_bf16 a[168:171], v[132:135], a[28:31], a[168:171]
    v_mfma_f32_16x16x32_bf16 a[172:175], v[128:131], a[4:7], a[172:175]
    v_mfma_f32_16x16x32_bf16 a[172:175], v[132:135], a[32:35], a[172:175]
    v_mfma_f32_16x16x32_bf16 a[176:179], v[128:131], a[8:11], a[176:179]
    v_mfma_f32_16x16x32_bf16 a[176:179], v[132:135], a[36:39], a[176:179]
    buffer_load_dwordx4 v7, s[4:7], s49 offen offset:1024 nt lds
    v_mfma_f32_16x16x32_bf16 a[180:183], v[128:131], a[12:15], a[180:183]
    s_add_u32 m0, m0, s96
    v_mfma_f32_16x16x32_bf16 a[180:183], v[132:135], a[40:43], a[180:183]
    v_mfma_f32_16x16x32_bf16 a[184:187], v[128:131], a[16:19], a[184:187]
    v_mfma_f32_16x16x32_bf16 a[184:187], v[132:135], a[44:47], a[184:187]
    v_mfma_f32_16x16x32_bf16 a[188:191], v[128:131], a[20:23], a[188:191]
    v_mfma_f32_16x16x32_bf16 a[188:191], v[132:135], a[48:51], a[188:191]
    buffer_load_dwordx4 v7, s[4:7], s49 offen offset:1280 nt lds
    v_mfma_f32_16x16x32_bf16 a[192:195], v[128:131], a[24:27], a[192:195]
    s_add_u32 m0, m0, s97
    v_mfma_f32_16x16x32_bf16 a[192:195], v[132:135], a[52:55], a[192:195]
    v_mfma_f32_16x16x32_bf16 a[196:199], v[136:139], a[0:3], a[196:199]
    v_mfma_f32_16x16x32_bf16 a[196:199], v[140:143], a[28:31], a[196:199]
    v_mfma_f32_16x16x32_bf16 a[200:203], v[136:139], a[4:7], a[200:203]
    v_mfma_f32_16x16x32_bf16 a[200:203], v[140:143], a[32:35], a[200:203]
    buffer_load_dwordx4 v7, s[4:7], s49 offen offset:1536 nt lds
    v_mfma_f32_16x16x32_bf16 a[204:207], v[136:139], a[8:11], a[204:207]
    s_add_u32 m0, m0, s96
    v_mfma_f32_16x16x32_bf16 a[204:207], v[140:143], a[36:39], a[204:207]
    v_mfma_f32_16x16x32_bf16 a[208:211], v[136:139], a[12:15], a[208:211]
    v_mfma_f32_16x16x32_bf16 a[208:211], v[140:143], a[40:43], a[208:211]
    v_mfma_f32_16x16x32_bf16 a[212:215], v[136:139], a[16:19], a[212:215]
    v_mfma_f32_16x16x32_bf16 a[212:215], v[140:143], a[44:47], a[212:215]
    buffer_load_dwordx4 v7, s[4:7], s49 offen offset:1792 nt lds
    v_mfma_f32_16x16x32_bf16 a[216:219], v[136:139], a[20:23], a[216:219]
    v_mfma_f32_16x16x32_bf16 a[216:219], v[140:143], a[48:51], a[216:219]
    v_mfma_f32_16x16x32_bf16 a[220:223], v[136:139], a[24:27], a[220:223]
    v_mfma_f32_16x16x32_bf16 a[220:223], v[140:143], a[52:55], a[220:223]
    s_branch L_at_qpepi
L_at_qptailB:
    s_mul_i32 s50, s21, s52
    s_mov_b32 s101, s21
    s_add_u32 s50, s50, s55
    s_cmp_ge_u32 s21, 2
    s_cselect_b32 s28, 0x40000000, 0
    s_add_u32 s50, s50, s28
    s_mov_b32 s82, s26
    s_mul_i32 s28, s26, s51
    s_add_u32 s50, s50, s28
    s_waitcnt lgkmcnt(8)
    v_mfma_f32_16x16x32_bf16 v[144:147], v[112:115], v[28:31], v[144:147]
    s_add_u32 m0, s33, 0
    v_mfma_f32_16x16x32_bf16 v[144:147], v[116:119], v[56:59], v[144:147]
    s_mov_b32 s49, s50
    v_mfma_f32_16x16x32_bf16 v[148:151], v[112:115], v[32:35], v[148:151]
    v_mfma_f32_16x16x32_bf16 v[148:151], v[116:119], v[60:63], v[148:151]
    v_mfma_f32_16x16x32_bf16 v[152:155], v[112:115], v[36:39], v[152:155]
    v_mfma_f32_16x16x32_bf16 v[152:155], v[116:119], v[64:67], v[152:155]
    v_mfma_f32_16x16x32_bf16 v[156:159], v[112:115], v[40:43], v[156:159]
    s_waitcnt vmcnt(16) lgkmcnt(0)
    s_barrier
    v_mfma_f32_16x16x32_bf16 v[156:159], v[116:119], v[68:71], v[156:159]
    v_mfma_f32_16x16x32_bf16 v[160:163], v[112:115], v[44:47], v[160:163]
    v_mfma_f32_16x16x32_bf16 v[160:163], v[116:119], v[72:75], v[160:163]
    s_add_u32 s28, s49, s88
    buffer_load_dwordx4 v26, s[16:19], s28 offen lds
    v_mfma_f32_16x16x32_bf16 v[164:167], v[112:115], v[48:51], v[164:167]
    s_add_u32 m0, m0, s53
    v_mfma_f32_16x16x32_bf16 v[164:167], v[116:119], v[76:79], v[164:167]
    v_mfma_f32_16x16x32_bf16 v[168:171], v[112:115], v[52:55], v[168:171]
    v_mfma_f32_16x16x32_bf16 v[168:171], v[116:119], v[80:83], v[168:171]
    ds_read_b64_tr_b16 v[112:113], v11 offset:8448
    v_mfma_f32_16x16x32_bf16 v[172:175], v[120:123], v[28:31], v[172:175]
    ds_read_b64_tr_b16 v[114:115], v11 offset:8576
    v_mfma_f32_16x16x32_bf16 v[172:175], v[124:127], v[56:59], v[172:175]
    s_add_u32 s28, s49, s89
    buffer_load_dwordx4 v26, s[16:19], s28 offen lds
    v_mfma_f32_16x16x32_bf16 v[176:179], v[120:123], v[32:35], v[176:179]
    s_add_u32 m0, m0, s53
    ds_read_b64_tr_b16 v[116:117], v11 offset:8960
    v_mfma_f32_16x16x32_bf16 v[176:179], v[124:127], v[60:63], v[176:179]
    ds_read_b64_tr_b16 v[118:119], v11 offset:9088
    v_mfma_f32_16x16x32_bf16 v[180:183], v[120:123], v[36:39], v[180:183]
    v_mfma_f32_16x16x32_bf16 v[180:183], v[124:127], v[64:67], v[180:183]
    v_mfma_f32_16x16x32_bf16 v[184:187], v[120:123], v[40:43], v[184:187]
    v_mfma_f32_16x16x32_bf16 v[184:187], v[124:127], v[68:71], v[184:187]
    s_add_u32 s28, s49, s90
    buffer_load_dwordx4 v26, s[16:19], s28 offen lds
    v_mfma_f32_16x16x32_bf16 v[188:191], v[120:123], v[44:47], v[188:191]
    s_add_u32 m0, m0, s53
    v_mfma_f32_16x16x32_bf16 v[188:191], v[124:127], v[72:75], v[188:191]
    v_mfma_f32_16x16x32_bf16 v[192:195], v[120:123], v[48:51], v[192:195]
    v_mfma_f32_16x16x32_bf16 v[192:195], v[124:127], v[76:79], v[192:195]
    v_mfma_f32_16x16x32_bf16 v[196:199], v[120:123], v[52:55], v[196:199]
    v_mfma_f32_16x16x32_bf16 v[196:199], v[124:127], v[80:83], v[196:199]
    s_add_u32 s28, s49, s91
    buffer_load_dwordx4 v26, s[16:19], s28 offen lds
    v_mfma_f32_16x16x32_bf16 v[200:203], v[128:131], v[28:31], v[200:203]
    s_add_u32 m0, m0, s53
    ds_read_b64_tr_b16 v[120:121], v11 offset:8480
    v_mfma_f32_16x16x32_bf16 v[200:203], v[132:135], v[56:59], v[200:203]
    ds_read_b64_tr_b16 v[122:123], v11 offset:8608
    v_mfma_f32_16x16x32_bf16 v[204:207], v[128:131], v[32:35], v[204:207]
    ds_read_b64_tr_b16 v[124:125], v11 offset:8992
    v_mfma_f32_16x16x32_bf16 v[204:207], v[132:135], v[60:63], v[204:207]
    ds_read_b64_tr_b16 v[126:127], v11 offset:9120
    v_mfma_f32_16x16x32_bf16 v[208:211], v[128:131], v[36:39], v[208:211]
    v_mfma_f32_16x16x32_bf16 v[208:211], v[132:135], v[64:67], v[208:211]
    s_add_u32 s28, s49, s92
    buffer_load_dwordx4 v26, s[16:19], s28 offen lds
    v_mfma_f32_16x16x32_bf16 v[212:215], v[128:131], v[40:43], v[212:215]
    s_add_u32 m0, m0, s53
    v_mfma_f32_16x16x32_bf16 v[212:215], v[132:135], v[68:71], v[212:215]
    v_mfma_f32_16x16x32_bf16 v[216:219], v[128:131], v[44:47], v[216:219]
    v_mfma_f32_16x16x32_bf16 v[216:219], v[132:135], v[72:75], v[216:219]
    v_mfma_f32_16x16x32_bf16 v[220:223], v[128:131], v[48:51], v[220:223]
    v_mfma_f32_16x16x32_bf16 v[220:223], v[132:135], v[76:79], v[220:223]
    s_add_u32 s28, s49, s93
    buffer_load_dwordx4 v26, s[16:19], s28 offen lds
    v_mfma_f32_16x16x32_bf16 v[224:227], v[128:131], v[52:55], v[224:227]
    s_add_u32 m0, m0, s53
    v_mfma_f32_16x16x32_bf16 v[224:227], v[132:135], v[80:83], v[224:227]
    ds_read_b64_tr_b16 v[128:129], v11 offset:8512
    v_mfma_f32_16x16x32_bf16 v[228:231], v[136:139], v[28:31], v[228:231]
    ds_read_b64_tr_b16 v[130:131], v11 offset:8640
    v_mfma_f32_16x16x32_bf16 v[228:231], v[140:143], v[56:59], v[228:231]
    ds_read_b64_tr_b16 v[132:133], v11 offset:9024
    v_mfma_f32_16x16x32_bf16 v[232:235], v[136:139], v[32:35], v[232:235]
    ds_read_b64_tr_b16 v[134:135], v11 offset:9152
    v_mfma_f32_16x16x32_bf16 v[232:235], v[140:143], v[60:63], v[232:235]
    s_add_u32 s28, s49, s94
    buffer_load_dwordx4 v26, s[16:19], s28 offen lds
    v_mfma_f32_16x16x32_bf16 v[236:239], v[136:139], v[36:39], v[236:239]
    s_add_u32 m0, m0, s53
    v_mfma_f32_16x16x32_bf16 v[236:239], v[140:143], v[64:67], v[236:239]
    v_mfma_f32_16x16x32_bf16 v[240:243], v[136:139], v[40:43], v[240:243]
    v_mfma_f32_16x16x32_bf16 v[240:243], v[140:143], v[68:71], v[240:243]
    v_mfma_f32_16x16x32_bf16 v[244:247], v[136:139], v[44:47], v[244:247]
    v_mfma_f32_16x16x32_bf16 v[244:247], v[140:143], v[72:75], v[244:247]
    s_add_u32 s28, s49, s95
    buffer_load_dwordx4 v26, s[16:19], s28 offen lds
    v_mfma_f32_16x16x32_bf16 v[248:251], v[136:139], v[48:51], v[248:251]
    v_mfma_f32_16x16x32_bf16 v[248:251], v[140:143], v[76:79], v[248:251]
    v_mfma_f32_16x16x32_bf16 v[252:255], v[136:139], v[52:55], v[252:255]
    v_mfma_f32_16x16x32_bf16 v[252:255], v[140:143], v[80:83], v[252:255]
    ds_read_b64_tr_b16 v[136:137], v11 offset:8544
    ds_read_b64_tr_b16 v[138:139], v11 offset:8672
    ds_read_b64_tr_b16 v[140:141], v11 offset:9056
    ds_read_b64_tr_b16 v[142:143], v11 offset:9184
    s_waitcnt lgkmcnt(8)
    v_mfma_f32_16x16x32_bf16 a[112:115], v[112:115], v[28:31], a[112:115]
    s_add_u32 m0, s33, 8448
    v_mfma_f32_16x16x32_bf16 a[112:115], v[116:119], v[56:59], a[112:115]
    s_add_u32 s49, s50, s46
    v_mfma_f32_16x16x32_bf16 a[116:119], v[112:115], v[32:35], a[116:119]
    s_lshl1_add_u32 s50, s51, s50
    v_mfma_f32_16x16x32_bf16 a[116:119], v[116:119], v[60:63], a[116:119]
    s_add_u32 s82, s82, 2
    v_mfma_f32_16x16x32_bf16 a[120:123], v[112:115], v[36:39], a[120:123]
    s_cmp_eq_u32 s82, 20
    v_mfma_f32_16x16x32_bf16 a[120:123], v[116:119], v[64:67], a[120:123]
    s_cselect_b32 s29, s83, 0
    v_mfma_f32_16x16x32_bf16 a[124:127], v[112:115], v[40:43], a[124:127]
    s_sub_u32 s50, s50, s29
    s_waitcnt vmcnt(8) lgkmcnt(0)
    s_barrier
    ds_read_b128 a[0:3], v27 offset:16896
    v_mfma_f32_16x16x32_bf16 a[124:127], v[116:119], v[68:71], a[124:127]
    ds_read_b128 a[4:7], v27 offset:18944
    v_mfma_f32_16x16x32_bf16 a[128:131], v[112:115], v[44:47], a[128:131]
    ds_read_b128 a[8:11], v27 offset:20992
    v_mfma_f32_16x16x32_bf16 a[128:131], v[116:119], v[72:75], a[128:131]
    s_add_u32 s28, s49, s88
    buffer_load_dwordx4 v26, s[16:19], s28 offen lds
    v_mfma_f32_16x16x32_bf16 a[132:135], v[112:115], v[48:51], a[132:135]
    s_add_u32 m0, m0, s53
    ds_read_b128 a[12:15], v27 offset:23040
    v_mfma_f32_16x16x32_bf16 a[132:135], v[116:119], v[76:79], a[132:135]
    ds_read_b128 a[16:19], v27 offset:25344
    v_mfma_f32_16x16x32_bf16 a[136:139], v[112:115], v[52:55], a[136:139]
    ds_read_b128 a[20:23], v27 offset:27392
    v_mfma_f32_16x16x32_bf16 a[136:139], v[116:119], v[80:83], a[136:139]
    ds_read_b128 a[24:27], v27 offset:29440
    v_mfma_f32_16x16x32_bf16 a[140:143], v[120:123], v[28:31], a[140:143]
    ds_read_b128 a[28:31], v6 offset:16896
    v_mfma_f32_16x16x32_bf16 a[140:143], v[124:127], v[56:59], a[140:143]
    s_add_u32 s28, s49, s89
    buffer_load_dwordx4 v26, s[16:19], s28 offen lds
    v_mfma_f32_16x16x32_bf16 a[144:147], v[120:123], v[32:35], a[144:147]
    s_add_u32 m0, m0, s53
    ds_read_b128 a[32:35], v6 offset:18944
    v_mfma_f32_16x16x32_bf16 a[144:147], v[124:127], v[60:63], a[144:147]
    ds_read_b128 a[36:39], v6 offset:20992
    v_mfma_f32_16x16x32_bf16 a[148:151], v[120:123], v[36:39], a[148:151]
    ds_read_b128 a[40:43], v6 offset:23040
    v_mfma_f32_16x16x32_bf16 a[148:151], v[124:127], v[64:67], a[148:151]
    ds_read_b128 a[44:47], v6 offset:25344
    v_mfma_f32_16x16x32_bf16 a[152:155], v[120:123], v[40:43], a[152:155]
    ds_read_b128 a[48:51], v6 offset:27392
    v_mfma_f32_16x16x32_bf16 a[152:155], v[124:127], v[68:71], a[152:155]
    s_add_u32 s28, s49, s90
    buffer_load_dwordx4 v26, s[16:19], s28 offen lds
    v_mfma_f32_16x16x32_bf16 a[156:159], v[120:123], v[44:47], a[156:159]
    s_add_u32 m0, m0, s53
    ds_read_b128 a[52:55], v6 offset:29440
    v_mfma_f32_16x16x32_bf16 a[156:159], v[124:127], v[72:75], a[156:159]
    ds_read_b64_tr_b16 v[112:113], v11 offset:16896
    v_mfma_f32_16x16x32_bf16 a[160:163], v[120:123], v[48:51], a[160:163]
    ds_read_b64_tr_b16 v[114:115], v11 offset:17024
    v_mfma_f32_16x16x32_bf16 a[160:163], v[124:127], v[76:79], a[160:163]
    ds_read_b64_tr_b16 v[116:117], v11 offset:17408
    v_mfma_f32_16x16x32_bf16 a[164:167], v[120:123], v[52:55], a[164:167]
    ds_read_b64_tr_b16 v[118:119], v11 offset:17536
    v_mfma_f32_16x16x32_bf16 a[164:167], v[124:127], v[80:83], a[164:167]
    s_add_u32 s28, s49, s91
    buffer_load_dwordx4 v26, s[16:19], s28 offen lds
    v_mfma_f32_16x16x32_bf16 a[168:171], v[128:131], v[28:31], a[168:171]
    s_add_u32 m0, m0, s53
    ds_read_b64_tr_b16 v[120:121], v11 offset:16928
    v_mfma_f32_16x16x32_bf16 a[168:171], v[132:135], v[56:59], a[168:171]
    ds_read_b64_tr_b16 v[122:123], v11 offset:17056
    v_mfma_f32_16x16x32_bf16 a[172:175], v[128:131], v[32:35], a[172:175]
    ds_read_b64_tr_b16 v[124:125], v11 offset:17440
    v_mfma_f32_16x16x32_bf16 a[172:175], v[132:135], v[60:63], a[172:175]
    ds_read_b64_tr_b16 v[126:127], v11 offset:17568
    v_mfma_f32_16x16x32_bf16 a[176:179], v[128:131], v[36:39], a[176:179]
    v_mfma_f32_16x16x32_bf16 a[176:179], v[132:135], v[64:67], a[176:179]
    s_add_u32 s28, s49, s92
    buffer_load_dwordx4 v26, s[16:19], s28 offen lds
    v_mfma_f32_16x16x32_bf16 a[180:183], v[128:131], v[40:43], a[180:183]
    s_add_u32 m0, m0, s53
    v_mfma_f32_16x16x32_bf16 a[180:183], v[132:135], v[68:71], a[180:183]
    v_mfma_f32_16x16x32_bf16 a[184:187], v[128:131], v[44:47], a[184:187]
    v_mfma_f32_16x16x32_bf16 a[184:187], v[132:135], v[72:75], a[184:187]
    v_mfma_f32_16x16x32_bf16 a[188:191], v[128:131], v[48:51], a[188:191]
    v_mfma_f32_16x16x32_bf16 a[188:191], v[132:135], v[76:79], a[188:191]
    s_add_u32 s28, s49, s93
    buffer_load_dwordx4 v26, s[16:19], s28 offen lds
    v_mfma_f32_16x16x32_bf16 a[192:195], v[128:131], v[52:55], a[192:195]
    s_add_u32 m0, m0, s53
    v_mfma_f32_16x16x32_bf16 a[192:195], v[132:135], v[80:83], a[192:195]
    ds_read_b64_tr_b16 v[128:129], v11 offset:16960
    v_mfma_f32_16x16x32_bf16 a[196:199], v[136:139], v[28:31], a[196:199]
    ds_read_b64_tr_b16 v[130:131], v11 offset:17088
    v_mfma_f32_16x16x32_bf16 a[196:199], v[140:143], v[56:59], a[196:199]
    ds_read_b64_tr_b16 v[132:133], v11 offset:17472
    v_mfma_f32_16x16x32_bf16 a[200:203], v[136:139], v[32:35], a[200:203]
    ds_read_b64_tr_b16 v[134:135], v11 offset:17600
    v_mfma_f32_16x16x32_bf16 a[200:203], v[140:143], v[60:63], a[200:203]
    s_add_u32 s28, s49, s47
    buffer_load_dwordx4 v26, s[16:19], s28 offen lds
    v_mfma_f32_16x16x32_bf16 a[204:207], v[136:139], v[36:39], a[204:207]
    s_add_u32 m0, m0, s53
    v_mfma_f32_16x16x32_bf16 a[204:207], v[140:143], v[64:67], a[204:207]
    v_mfma_f32_16x16x32_bf16 a[208:211], v[136:139], v[40:43], a[208:211]
    v_mfma_f32_16x16x32_bf16 a[208:211], v[140:143], v[68:71], a[208:211]
    v_mfma_f32_16x16x32_bf16 a[212:215], v[136:139], v[44:47], a[212:215]
    v_mfma_f32_16x16x32_bf16 a[212:215], v[140:143], v[72:75], a[212:215]
    s_add_u32 s28, s49, s98
    buffer_load_dwordx4 v26, s[16:19], s28 offen lds
    v_mfma_f32_16x16x32_bf16 a[216:219], v[136:139], v[48:51], a[216:219]
    v_mfma_f32_16x16x32_bf16 a[216:219], v[140:143], v[76:79], a[216:219]
    v_mfma_f32_16x16x32_bf16 a[220:223], v[136:139], v[52:55], a[220:223]
    v_mfma_f32_16x16x32_bf16 a[220:223], v[140:143], v[80:83], a[220:223]
    ds_read_b64_tr_b16 v[136:137], v11 offset:16992
    ds_read_b64_tr_b16 v[138:139], v11 offset:17120
    ds_read_b64_tr_b16 v[140:141], v11 offset:17504
    ds_read_b64_tr_b16 v[142:143], v11 offset:17632
    s_waitcnt lgkmcnt(8)
    v_mfma_f32_16x16x32_bf16 v[144:147], v[112:115], a[0:3], v[144:147]
    s_add_u32 m0, s33, 16896
    v_mfma_f32_16x16x32_bf16 v[144:147], v[116:119], a[28:31], v[144:147]
    s_mov_b32 s49, s50
    v_mfma_f32_16x16x32_bf16 v[148:151], v[112:115], a[4:7], v[148:151]
    v_mfma_f32_16x16x32_bf16 v[148:151], v[116:119], a[32:35], v[148:151]
    v_mfma_f32_16x16x32_bf16 v[152:155], v[112:115], a[8:11], v[152:155]
    v_mfma_f32_16x16x32_bf16 v[152:155], v[116:119], a[36:39], v[152:155]
    v_mfma_f32_16x16x32_bf16 v[156:159], v[112:115], a[12:15], v[156:159]
    s_waitcnt vmcnt(16) lgkmcnt(0)
    s_barrier
    v_mfma_f32_16x16x32_bf16 v[156:159], v[116:119], a[40:43], v[156:159]
    v_mfma_f32_16x16x32_bf16 v[160:163], v[112:115], a[16:19], v[160:163]
    v_mfma_f32_16x16x32_bf16 v[160:163], v[116:119], a[44:47], v[160:163]
    s_add_u32 s28, s49, s88
    buffer_load_dwordx4 v26, s[16:19], s28 offen lds
    v_mfma_f32_16x16x32_bf16 v[164:167], v[112:115], a[20:23], v[164:167]
    s_add_u32 m0, m0, s53
    v_mfma_f32_16x16x32_bf16 v[164:167], v[116:119], a[48:51], v[164:167]
    v_mfma_f32_16x16x32_bf16 v[168:171], v[112:115], a[24:27], v[168:171]
    v_mfma_f32_16x16x32_bf16 v[168:171], v[116:119], a[52:55], v[168:171]
    ds_read_b64_tr_b16 v[112:113], v11 offset:25344
    v_mfma_f32_16x16x32_bf16 v[172:175], v[120:123], a[0:3], v[172:175]
    ds_read_b64_tr_b16 v[114:115], v11 offset:25472
    v_mfma_f32_16x16x32_bf16 v[172:175], v[124:127], a[28:31], v[172:175]
    s_add_u32 s28, s49, s89
    buffer_load_dwordx4 v26, s[16:19], s28 offen lds
    v_mfma_f32_16x16x32_bf16 v[176:179], v[120:123], a[4:7], v[176:179]
    s_add_u32 m0, m0, s53
    ds_read_b64_tr_b16 v[116:117], v11 offset:25856
    v_mfma_f32_16x16x32_bf16 v[176:179], v[124:127], a[32:35], v[176:179]
    ds_read_b64_tr_b16 v[118:119], v11 offset:25984
    v_mfma_f32_16x16x32_bf16 v[180:183], v[120:123], a[8:11], v[180:183]
    v_mfma_f32_16x16x32_bf16 v[180:183], v[124:127], a[36:39], v[180:183]
    v_mfma_f32_16x16x32_bf16 v[184:187], v[120:123], a[12:15], v[184:187]
    v_mfma_f32_16x16x32_bf16 v[184:187], v[124:127], a[40:43], v[184:187]
    s_add_u32 s28, s49, s90
    buffer_load_dwordx4 v26, s[16:19], s28 offen lds
    v_mfma_f32_16x16x32_bf16 v[188:191], v[120:123], a[16:19], v[188:191]
    s_add_u32 m0, m0, s53
    v_mfma_f32_16x16x32_bf16 v[188:191], v[124:127], a[44:47], v[188:191]
    v_mfma_f32_16x16x32_bf16 v[192:195], v[120:123], a[20:23], v[192:195]
    v_mfma_f32_16x16x32_bf16 v[192:195], v[124:127], a[48:51], v[192:195]
    v_mfma_f32_16x16x32_bf16 v[196:199], v[120:123], a[24:27], v[196:199]
    v_mfma_f32_16x16x32_bf16 v[196:199], v[124:127], a[52:55], v[196:199]
    s_add_u32 s28, s49, s91
    buffer_load_dwordx4 v26, s[16:19], s28 offen lds
    v_mfma_f32_16x16x32_bf16 v[200:203], v[128:131], a[0:3], v[200:203]
    s_add_u32 m0, m0, s53
    ds_read_b64_tr_b16 v[120:121], v11 offset:25376
    v_mfma_f32_16x16x32_bf16 v[200:203], v[132:135], a[28:31], v[200:203]
    ds_read_b64_tr_b16 v[122:123], v11 offset:25504
    v_mfma_f32_16x16x32_bf16 v[204:207], v[128:131], a[4:7], v[204:207]
    ds_read_b64_tr_b16 v[124:125], v11 offset:25888
    v_mfma_f32_16x16x32_bf16 v[204:207], v[132:135], a[32:35], v[204:207]
    ds_read_b64_tr_b16 v[126:127], v11 offset:26016
    v_mfma_f32_16x16x32_bf16 v[208:211], v[128:131], a[8:11], v[208:211]
    v_mfma_f32_16x16x32_bf16 v[208:211], v[132:135], a[36:39], v[208:211]
    s_add_u32 s28, s49, s92
    buffer_load_dwordx4 v26, s[16:19], s28 offen lds
    v_mfma_f32_16x16x32_bf16 v[212:215], v[128:131], a[12:15], v[212:215]
    s_add_u32 m0, m0, s53
    v_mfma_f32_16x16x32_bf16 v[212:215], v[132:135], a[40:43], v[212:215]
    v_mfma_f32_16x16x32_bf16 v[216:219], v[128:131], a[16:19], v[216:219]
    v_mfma_f32_16x16x32_bf16 v[216:219], v[132:135], a[44:47], v[216:219]
    v_mfma_f32_16x16x32_bf16 v[220:223], v[128:131], a[20:23], v[220:223]
    v_mfma_f32_16x16x32_bf16 v[220:223], v[132:135], a[48:51], v[220:223]
    s_add_u32 s28, s49, s93
    buffer_load_dwordx4 v26, s[16:19], s28 offen lds
    v_mfma_f32_16x16x32_bf16 v[224:227], v[128:131], a[24:27], v[224:227]
    s_add_u32 m0, m0, s53
    v_mfma_f32_16x16x32_bf16 v[224:227], v[132:135], a[52:55], v[224:227]
    ds_read_b64_tr_b16 v[128:129], v11 offset:25408
    v_mfma_f32_16x16x32_bf16 v[228:231], v[136:139], a[0:3], v[228:231]
    ds_read_b64_tr_b16 v[130:131], v11 offset:25536
    v_mfma_f32_16x16x32_bf16 v[228:231], v[140:143], a[28:31], v[228:231]
    ds_read_b64_tr_b16 v[132:133], v11 offset:25920
    v_mfma_f32_16x16x32_bf16 v[232:235], v[136:139], a[4:7], v[232:235]
    ds_read_b64_tr_b16 v[134:135], v11 offset:26048
    v_mfma_f32_16x16x32_bf16 v[232:235], v[140:143], a[32:35], v[232:235]
    s_add_u32 s28, s49, s94
    buffer_load_dwordx4 v26, s[16:19], s28 offen lds
    v_mfma_f32_16x16x32_bf16 v[236:239], v[136:139], a[8:11], v[236:239]
    s_add_u32 m0, m0, s53
    v_mfma_f32_16x16x32_bf16 v[236:239], v[140:143], a[36:39], v[236:239]
    v_mfma_f32_16x16x32_bf16 v[240:243], v[136:139], a[12:15], v[240:243]
    v_mfma_f32_16x16x32_bf16 v[240:243], v[140:143], a[40:43], v[240:243]
    v_mfma_f32_16x16x32_bf16 v[244:247], v[136:139], a[16:19], v[244:247]
    v_mfma_f32_16x16x32_bf16 v[244:247], v[140:143], a[44:47], v[244:247]
    s_add_u32 s28, s49, s95
    buffer_load_dwordx4 v26, s[16:19], s28 offen lds
    v_mfma_f32_16x16x32_bf16 v[248:251], v[136:139], a[20:23], v[248:251]
    v_mfma_f32_16x16x32_bf16 v[248:251], v[140:143], a[48:51], v[248:251]
    v_mfma_f32_16x16x32_bf16 v[252:255], v[136:139], a[24:27], v[252:255]
    v_mfma_f32_16x16x32_bf16 v[252:255], v[140:143], a[52:55], v[252:255]
    ds_read_b64_tr_b16 v[136:137], v11 offset:25440
    ds_read_b64_tr_b16 v[138:139], v11 offset:25568
    ds_read_b64_tr_b16 v[140:141], v11 offset:25952
    ds_read_b64_tr_b16 v[142:143], v11 offset:26080
    s_waitcnt lgkmcnt(8)
    v_mfma_f32_16x16x32_bf16 a[112:115], v[112:115], a[0:3], a[112:115]
    s_add_u32 m0, s33, 25344
    v_mfma_f32_16x16x32_bf16 a[112:115], v[116:119], a[28:31], a[112:115]
    s_add_u32 s49, s50, s46
    v_mfma_f32_16x16x32_bf16 a[116:119], v[112:115], a[4:7], a[116:119]
    s_lshl1_add_u32 s50, s51, s50
    v_mfma_f32_16x16x32_bf16 a[116:119], v[116:119], a[32:35], a[116:119]
    s_add_u32 s82, s82, 2
    v_mfma_f32_16x16x32_bf16 a[120:123], v[112:115], a[8:11], a[120:123]
    s_cmp_eq_u32 s82, 20
    v_mfma_f32_16x16x32_bf16 a[120:123], v[116:119], a[36:39], a[120:123]
    s_cselect_b32 s29, s83, 0
    v_mfma_f32_16x16x32_bf16 a[124:127], v[112:115], a[12:15], a[124:127]
    s_sub_u32 s50, s50, s29
    s_waitcnt vmcnt(8) lgkmcnt(0)
    s_barrier
    v_mfma_f32_16x16x32_bf16 a[124:127], v[116:119], a[40:43], a[124:127]
    v_mfma_f32_16x16x32_bf16 a[128:131], v[112:115], a[16:19], a[128:131]
    v_mfma_f32_16x16x32_bf16 a[128:131], v[116:119], a[44:47], a[128:131]
    s_add_u32 s28, s49, s88
    buffer_load_dwordx4 v26, s[16:19], s28 offen lds
    v_mfma_f32_16x16x32_bf16 a[132:135], v[112:115], a[20:23], a[132:135]
    s_add_u32 m0, m0, s53
    v_mfma_f32_16x16x32_bf16 a[132:135], v[116:119], a[48:51], a[132:135]
    v_mfma_f32_16x16x32_bf16 a[136:139], v[112:115], a[24:27], a[136:139]
    v_mfma_f32_16x16x32_bf16 a[136:139], v[116:119], a[52:55], a[136:139]
    v_mfma_f32_16x16x32_bf16 a[140:143], v[120:123], a[0:3], a[140:143]
    v_mfma_f32_16x16x32_bf16 a[140:143], v[124:127], a[28:31], a[140:143]
    s_add_u32 s28, s49, s89
    buffer_load_dwordx4 v26, s[16:19], s28 offen lds
    v_mfma_f32_16x16x32_bf16 a[144:147], v[120:123], a[4:7], a[144:147]
    s_add_u32 m0, m0, s53
    v_mfma_f32_16x16x32_bf16 a[144:147], v[124:127], a[32:35], a[144:147]
    v_mfma_f32_16x16x32_bf16 a[148:151], v[120:123], a[8:11], a[148:151]
    v_mfma_f32_16x16x32_bf16 a[148:151], v[124:127], a[36:39], a[148:151]
    v_mfma_f32_16x16x32_bf16 a[152:155], v[120:123], a[12:15], a[152:155]
    v_mfma_f32_16x16x32_bf16 a[152:155], v[124:127], a[40:43], a[152:155]
    s_add_u32 s28, s49, s90
    buffer_load_dwordx4 v26, s[16:19], s28 offen lds
    v_mfma_f32_16x16x32_bf16 a[156:159], v[120:123], a[16:19], a[156:159]
    s_add_u32 m0, m0, s53
    v_mfma_f32_16x16x32_bf16 a[156:159], v[124:127], a[44:47], a[156:159]
    v_mfma_f32_16x16x32_bf16 a[160:163], v[120:123], a[20:23], a[160:163]
    v_mfma_f32_16x16x32_bf16 a[160:163], v[124:127], a[48:51], a[160:163]
    v_mfma_f32_16x16x32_bf16 a[164:167], v[120:123], a[24:27], a[164:167]
    v_mfma_f32_16x16x32_bf16 a[164:167], v[124:127], a[52:55], a[164:167]
    s_add_u32 s28, s49, s91
    buffer_load_dwordx4 v26, s[16:19], s28 offen lds
    v_mfma_f32_16x16x32_bf16 a[168:171], v[128:131], a[0:3], a[168:171]
    s_add_u32 m0, m0, s53
    v_mfma_f32_16x16x32_bf16 a[168:171], v[132:135], a[28:31], a[168:171]
    v_mfma_f32_16x16x32_bf16 a[172:175], v[128:131], a[4:7], a[172:175]
    v_mfma_f32_16x16x32_bf16 a[172:175], v[132:135], a[32:35], a[172:175]
    v_mfma_f32_16x16x32_bf16 a[176:179], v[128:131], a[8:11], a[176:179]
    v_mfma_f32_16x16x32_bf16 a[176:179], v[132:135], a[36:39], a[176:179]
    s_add_u32 s28, s49, s92
    buffer_load_dwordx4 v26, s[16:19], s28 offen lds
    v_mfma_f32_16x16x32_bf16 a[180:183], v[128:131], a[12:15], a[180:183]
    s_add_u32 m0, m0, s53
    v_mfma_f32_16x16x32_bf16 a[180:183], v[132:135], a[40:43], a[180:183]
    v_mfma_f32_16x16x32_bf16 a[184:187], v[128:131], a[16:19], a[184:187]
    v_mfma_f32_16x16x32_bf16 a[184:187], v[132:135], a[44:47], a[184:187]
    v_mfma_f32_16x16x32_bf16 a[188:191], v[128:131], a[20:23], a[188:191]
    v_mfma_f32_16x16x32_bf16 a[188:191], v[132:135], a[48:51], a[188:191]
    s_add_u32 s28, s49, s93
    buffer_load_dwordx4 v26, s[16:19], s28 offen lds
    v_mfma_f32_16x16x32_bf16 a[192:195], v[128:131], a[24:27], a[192:195]
    s_add_u32 m0, m0, s53
    v_mfma_f32_16x16x32_bf16 a[192:195], v[132:135], a[52:55], a[192:195]
    v_mfma_f32_16x16x32_bf16 a[196:199], v[136:139], a[0:3], a[196:199]
    v_mfma_f32_16x16x32_bf16 a[196:199], v[140:143], a[28:31], a[196:199]
    v_mfma_f32_16x16x32_bf16 a[200:203], v[136:139], a[4:7], a[200:203]
    v_mfma_f32_16x16x32_bf16 a[200:203], v[140:143], a[32:35], a[200:203]
    s_add_u32 s28, s49, s47
    buffer_load_dwordx4 v26, s[16:19], s28 offen lds
    v_mfma_f32_16x16x32_bf16 a[204:207], v[136:139], a[8:11], a[204:207]
    s_add_u32 m0, m0, s53
    v_mfma_f32_16x16x32_bf16 a[204:207], v[140:143], a[36:39], a[204:207]
    v_mfma_f32_16x16x32_bf16 a[208:211], v[136:139], a[12:15], a[208:211]
    v_mfma_f32_16x16x32_bf16 a[208:211], v[140:143], a[40:43], a[208:211]
    v_mfma_f32_16x16x32_bf16 a[212:215], v[136:139], a[16:19], a[212:215]
    v_mfma_f32_16x16x32_bf16 a[212:215], v[140:143], a[44:47], a[212:215]
    s_add_u32 s28, s49, s98
    buffer_load_dwordx4 v26, s[16:19], s28 offen lds
    v_mfma_f32_16x16x32_bf16 a[216:219], v[136:139], a[20:23], a[216:219]
    v_mfma_f32_16x16x32_bf16 a[216:219], v[140:143], a[48:51], a[216:219]
    v_mfma_f32_16x16x32_bf16 a[220:223], v[136:139], a[24:27], a[220:223]
    v_mfma_f32_16x16x32_bf16 a[220:223], v[140:143], a[52:55], a[220:223]
L_at_qpepi:
    v_mov_b32 v4, s54
    v_mov_b32 v5, s54
    s_nop 6
    v_pk_mul_f32 v[144:145], v[144:145], v[4:5]
    v_pk_mul_f32 v[146:147], v[146:147], v[4:5]
    v_pk_mul_f32 v[148:149], v[148:149], v[4:5]
    v_pk_mul_f32 v[150:151], v[150:151], v[4:5]
    v_pk_mul_f32 v[152:153], v[152:153], v[4:5]
    v_pk_mul_f32 v[154:155], v[154:155], v[4:5]
    v_pk_mul_f32 v[156:157], v[156:157], v[4:5]
    v_pk_mul_f32 v[158:159], v[158:159], v[4:5]
    v_pk_mul_f32 v[160:161], v[160:161], v[4:5]
    v_pk_mul_f32 v[162:163], v[162:163], v[4:5]
    v_pk_mul_f32 v[164:165], v[164:165], v[4:5]
    v_pk_mul_f32 v[166:167], v[166:167], v[4:5]
    v_pk_mul_f32 v[168:169], v[168:169], v[4:5]
    v_pk_mul_f32 v[170:171], v[170:171], v[4:5]
    v_pk_mul_f32 v[172:173], v[172:173], v[4:5]
    v_pk_mul_f32 v[174:175], v[174:175], v[4:5]
    v_pk_mul_f32 v[176:177], v[176:177], v[4:5]
    v_pk_mul_f32 v[178:179], v[178:179], v[4:5]
    v_pk_mul_f32 v[180:181], v[180:181], v[4:5]
    v_pk_mul_f32 v[182:183], v[182:183], v[4:5]
    v_pk_mul_f32 v[184:185], v[184:185], v[4:5]
    v_pk_mul_f32 v[186:187], v[186:187], v[4:5]
    v_pk_mul_f32 v[188:189], v[188:189], v[4:5]
    v_pk_mul_f32 v[190:191], v[190:191], v[4:5]
    v_pk_mul_f32 v[192:193], v[192:193], v[4:5]
    v_pk_mul_f32 v[194:195], v[194:195], v[4:5]
    v_pk_mul_f32 v[196:197], v[196:197], v[4:5]
    v_pk_mul_f32 v[198:199], v[198:199], v[4:5]
    v_cvt_pk_bf16_f32 v88, v144, v145
    v_cvt_pk_bf16_f32 v89, v146, v147
    v_cvt_pk_bf16_f32 v90, v172, v173
    v_cvt_pk_bf16_f32 v91, v174, v175
    v_cvt_pk_bf16_f32 v92, v148, v149
    v_cvt_pk_bf16_f32 v93, v150, v151
    v_cvt_pk_bf16_f32 v94, v176, v177
    v_cvt_pk_bf16_f32 v95, v178, v179
    v_cvt_pk_bf16_f32 v96, v152, v153
    v_cvt_pk_bf16_f32 v97, v154, v155
    v_cvt_pk_bf16_f32 v98, v180, v181
    v_cvt_pk_bf16_f32 v99, v182, v183
    v_cvt_pk_bf16_f32 v100, v156, v157
    v_cvt_pk_bf16_f32 v101, v158, v159
    v_cvt_pk_bf16_f32 v102, v184, v185
    v_cvt_pk_bf16_f32 v103, v186, v187
    v_cvt_pk_bf16_f32 v104, v160, v161
    v_cvt_pk_bf16_f32 v105, v162, v163
    v_cvt_pk_bf16_f32 v106, v188, v189
    v_cvt_pk_bf16_f32 v107, v190, v191
    v_cvt_pk_bf16_f32 v108, v164, v165
    v_cvt_pk_bf16_f32 v109, v166, v167
    v_cvt_pk_bf16_f32 v110, v192, v193
    v_cvt_pk_bf16_f32 v111, v194, v195
    v_cvt_pk_bf16_f32 v112, v168, v169
    v_cvt_pk_bf16_f32 v113, v170, v171
    v_cvt_pk_bf16_f32 v114, v196, v197
    v_cvt_pk_bf16_f32 v115, v198, v199
    s_nop 1
    v_permlane16_swap_b32 v88, v90
    v_permlane16_swap_b32 v89, v91
    v_permlane16_swap_b32 v92, v94
    v_permlane16_swap_b32 v93, v95
    v_permlane16_swap_b32 v96, v98
    v_permlane16_swap_b32 v97, v99
    v_permlane16_swap_b32 v100, v102
    v_permlane16_swap_b32 v101, v103
    v_permlane16_swap_b32 v104, v106
    v_permlane16_swap_b32 v105, v107
    v_permlane16_swap_b32 v108, v110
    v_permlane16_swap_b32 v109, v111
    v_permlane16_swap_b32 v112, v114
    v_permlane16_swap_b32 v113, v115
    v_accvgpr_write_b32 a0, v88
    v_accvgpr_write_b32 a1, v89
    v_accvgpr_write_b32 a2, v90
    v_accvgpr_write_b32 a3, v91
    v_accvgpr_write_b32 a16, v92
    v_accvgpr_write_b32 a17, v93
    v_accvgpr_write_b32 a18, v94
    v_accvgpr_write_b32 a19, v95
    v_accvgpr_write_b32 a32, v96
    v_accvgpr_write_b32 a33, v97
    v_accvgpr_write_b32 a34, v98
    v_accvgpr_write_b32 a35, v99
    v_accvgpr_write_b32 a48, v100
    v_accvgpr_write_b32 a49, v101
    v_accvgpr_write_b32 a50, v102
    v_accvgpr_write_b32 a51, v103
    v_accvgpr_write_b32 a64, v104
    v_accvgpr_write_b32 a65, v105
    v_accvgpr_write_b32 a66, v106
    v_accvgpr_write_b32 a67, v107
    v_accvgpr_write_b32 a80, v108
    v_accvgpr_write_b32 a81, v109
    v_accvgpr_write_b32 a82, v110
    v_accvgpr_write_b32 a83, v111
    v_accvgpr_write_b32 a96, v112
    v_accvgpr_write_b32 a97, v113
    v_accvgpr_write_b32 a98, v114
    v_accvgpr_write_b32 a99, v115
    v_pk_mul_f32 v[200:201], v[200:201], v[4:5]
    v_pk_mul_f32 v[202:203], v[202:203], v[4:5]
    v_pk_mul_f32 v[204:205], v[204:205], v[4:5]
    v_pk_mul_f32 v[206:207], v[206:207], v[4:5]
    v_pk_mul_f32 v[208:209], v[208:209], v[4:5]
    v_pk_mul_f32 v[210:211], v[210:211], v[4:5]
    v_pk_mul_f32 v[212:213], v[212:213], v[4:5]
    v_pk_mul_f32 v[214:215], v[214:215], v[4:5]
    v_pk_mul_f32 v[216:217], v[216:217], v[4:5]
    v_pk_mul_f32 v[218:219], v[218:219], v[4:5]
    v_pk_mul_f32 v[220:221], v[220:221], v[4:5]
    v_pk_mul_f32 v[222:223], v[222:223], v[4:5]
    v_pk_mul_f32 v[224:225], v[224:225], v[4:5]
    v_pk_mul_f32 v[226:227], v[226:227], v[4:5]
    v_pk_mul_f32 v[228:229], v[228:229], v[4:5]
    v_pk_mul_f32 v[230:231], v[230:231], v[4:5]
    v_pk_mul_f32 v[232:233], v[232:233], v[4:5]
    v_pk_mul_f32 v[234:235], v[234:235], v[4:5]
    v_pk_mul_f32 v[236:237], v[236:237], v[4:5]
    v_pk_mul_f32 v[238:239], v[238:239], v[4:5]
    v_pk_mul_f32 v[240:241], v[240:241], v[4:5]
    v_pk_mul_f32 v[242:243], v[242:243], v[4:5]
    v_pk_mul_f32 v[244:245], v[244:245], v[4:5]
    v_pk_mul_f32 v[246:247], v[246:247], v[4:5]
    v_pk_mul_f32 v[248:249], v[248:249], v[4:5]
    v_pk_mul_f32 v[250:251], v[250:251], v[4:5]
    v_pk_mul_f32 v[252:253], v[252:253], v[4:5]
    v_pk_mul_f32 v[254:255], v[254:255], v[4:5]
    v_cvt_pk_bf16_f32 v116, v200, v201
    v_cvt_pk_bf16_f32 v117, v202, v203
    v_cvt_pk_bf16_f32 v118, v228, v229
    v_cvt_pk_bf16_f32 v119, v230, v231
    v_cvt_pk_bf16_f32 v120, v204, v205
    v_cvt_pk_bf16_f32 v121, v206, v207
    v_cvt_pk_bf16_f32 v122, v232, v233
    v_cvt_pk_bf16_f32 v123, v234, v235
    v_cvt_pk_bf16_f32 v124, v208, v209
    v_cvt_pk_bf16_f32 v125, v210, v211
    v_cvt_pk_bf16_f32 v126, v236, v237
    v_cvt_pk_bf16_f32 v127, v238, v239
    v_cvt_pk_bf16_f32 v128, v212, v213
    v_cvt_pk_bf16_f32 v129, v214, v215
    v_cvt_pk_bf16_f32 v130, v240, v241
    v_cvt_pk_bf16_f32 v131, v242, v243
    v_cvt_pk_bf16_f32 v132, v216, v217
    v_cvt_pk_bf16_f32 v133, v218, v219
    v_cvt_pk_bf16_f32 v134, v244, v245
    v_cvt_pk_bf16_f32 v135, v246, v247
    v_cvt_pk_bf16_f32 v136, v220, v221
    v_cvt_pk_bf16_f32 v137, v222, v223
    v_cvt_pk_bf16_f32 v138, v248, v249
    v_cvt_pk_bf16_f32 v139, v250, v251
    v_cvt_pk_bf16_f32 v140, v224, v225
    v_cvt_pk_bf16_f32 v141, v226, v227
    v_cvt_pk_bf16_f32 v142, v252, v253
    v_cvt_pk_bf16_f32 v143, v254, v255
    s_nop 1
    v_permlane16_swap_b32 v116, v118
    v_permlane16_swap_b32 v117, v119
    v_permlane16_swap_b32 v120, v122
    v_permlane16_swap_b32 v121, v123
    v_permlane16_swap_b32 v124, v126
    v_permlane16_swap_b32 v125, v127
    v_permlane16_swap_b32 v128, v130
    v_permlane16_swap_b32 v129, v131
    v_permlane16_swap_b32 v132, v134
    v_permlane16_swap_b32 v133, v135
    v_permlane16_swap_b32 v136, v138
    v_permlane16_swap_b32 v137, v139
    v_permlane16_swap_b32 v140, v142
    v_permlane16_swap_b32 v141, v143
    v_accvgpr_write_b32 a4, v116
    v_accvgpr_write_b32 a5, v117
    v_accvgpr_write_b32 a6, v118
    v_accvgpr_write_b32 a7, v119
    v_accvgpr_write_b32 a20, v120
    v_accvgpr_write_b32 a21, v121
    v_accvgpr_write_b32 a22, v122
    v_accvgpr_write_b32 a23, v123
    v_accvgpr_write_b32 a36, v124
    v_accvgpr_write_b32 a37, v125
    v_accvgpr_write_b32 a38, v126
    v_accvgpr_write_b32 a39, v127
    v_accvgpr_write_b32 a52, v128
    v_accvgpr_write_b32 a53, v129
    v_accvgpr_write_b32 a54, v130
    v_accvgpr_write_b32 a55, v131
    v_accvgpr_write_b32 a68, v132
    v_accvgpr_write_b32 a69, v133
    v_accvgpr_write_b32 a70, v134
    v_accvgpr_write_b32 a71, v135
    v_accvgpr_write_b32 a84, v136
    v_accvgpr_write_b32 a85, v137
    v_accvgpr_write_b32 a86, v138
    v_accvgpr_write_b32 a87, v139
    v_accvgpr_write_b32 a100, v140
    v_accvgpr_write_b32 a101, v141
    v_accvgpr_write_b32 a102, v142
    v_accvgpr_write_b32 a103, v143
    v_accvgpr_read_b32 v144, a112
    v_accvgpr_read_b32 v145, a113
    v_accvgpr_read_b32 v146, a114
    v_accvgpr_read_b32 v147, a115
    v_accvgpr_read_b32 v148, a116
    v_accvgpr_read_b32 v149, a117
    v_accvgpr_read_b32 v150, a118
    v_accvgpr_read_b32 v151, a119
    v_accvgpr_read_b32 v152, a120
    v_accvgpr_read_b32 v153, a121
    v_accvgpr_read_b32 v154, a122
    v_accvgpr_read_b32 v155, a123
    v_accvgpr_read_b32 v156, a124
    v_accvgpr_read_b32 v157, a125
    v_accvgpr_read_b32 v158, a126
    v_accvgpr_read_b32 v159, a127
    v_accvgpr_read_b32 v160, a128
    v_accvgpr_read_b32 v161, a129
    v_accvgpr_read_b32 v162, a130
    v_accvgpr_read_b32 v163, a131
    v_accvgpr_read_b32 v164, a132
    v_accvgpr_read_b32 v165, a133
    v_accvgpr_read_b32 v166, a134
    v_accvgpr_read_b32 v167, a135
    v_accvgpr_read_b32 v168, a136
    v_accvgpr_read_b32 v169, a137
    v_accvgpr_read_b32 v170, a138
    v_accvgpr_read_b32 v171, a139
    v_accvgpr_read_b32 v172, a140
    v_accvgpr_read_b32 v173, a141
    v_accvgpr_read_b32 v174, a142
    v_accvgpr_read_b32 v175, a143
    v_accvgpr_read_b32 v176, a144
    v_accvgpr_read_b32 v177, a145
    v_accvgpr_read_b32 v178, a146
    v_accvgpr_read_b32 v179, a147
    v_accvgpr_read_b32 v180, a148
    v_accvgpr_read_b32 v181, a149
    v_accvgpr_read_b32 v182, a150
    v_accvgpr_read_b32 v183, a151
    v_accvgpr_read_b32 v184, a152
    v_accvgpr_read_b32 v185, a153
    v_accvgpr_read_b32 v186, a154
    v_accvgpr_read_b32 v187, a155
    v_accvgpr_read_b32 v188, a156
    v_accvgpr_read_b32 v189, a157
    v_accvgpr_read_b32 v190, a158
    v_accvgpr_read_b32 v191, a159
    v_accvgpr_read_b32 v192, a160
    v_accvgpr_read_b32 v193, a161
    v_accvgpr_read_b32 v194, a162
    v_accvgpr_read_b32 v195, a163
    v_accvgpr_read_b32 v196, a164
    v_accvgpr_read_b32 v197, a165
    v_accvgpr_read_b32 v198, a166
    v_accvgpr_read_b32 v199, a167
    v_pk_mul_f32 v[144:145], v[144:145], v[4:5]
    v_pk_mul_f32 v[146:147], v[146:147], v[4:5]
    v_pk_mul_f32 v[148:149], v[148:149], v[4:5]
    v_pk_mul_f32 v[150:151], v[150:151], v[4:5]
    v_pk_mul_f32 v[152:153], v[152:153], v[4:5]
    v_pk_mul_f32 v[154:155], v[154:155], v[4:5]
    v_pk_mul_f32 v[156:157], v[156:157], v[4:5]
    v_pk_mul_f32 v[158:159], v[158:159], v[4:5]
    v_pk_mul_f32 v[160:161], v[160:161], v[4:5]
    v_pk_mul_f32 v[162:163], v[162:163], v[4:5]
    v_pk_mul_f32 v[164:165], v[164:165], v[4:5]
    v_pk_mul_f32 v[166:167], v[166:167], v[4:5]
    v_pk_mul_f32 v[168:169], v[168:169], v[4:5]
    v_pk_mul_f32 v[170:171], v[170:171], v[4:5]
    v_pk_mul_f32 v[172:173], v[172:173], v[4:5]
    v_pk_mul_f32 v[174:175], v[174:175], v[4:5]
    v_pk_mul_f32 v[176:177], v[176:177], v[4:5]
    v_pk_mul_f32 v[178:179], v[178:179], v[4:5]
    v_pk_mul_f32 v[180:181], v[180:181], v[4:5]
    v_pk_mul_f32 v[182:183], v[182:183], v[4:5]
    v_pk_mul_f32 v[184:185], v[184:185], v[4:5]
    v_pk_mul_f32 v[186:187], v[186:187], v[4:5]
    v_pk_mul_f32 v[188:189], v[188:189], v[4:5]
    v_pk_mul_f32 v[190:191], v[190:191], v[4:5]
    v_pk_mul_f32 v[192:193], v[192:193], v[4:5]
    v_pk_mul_f32 v[194:195], v[194:195], v[4:5]
    v_pk_mul_f32 v[196:197], v[196:197], v[4:5]
    v_pk_mul_f32 v[198:199], v[198:199], v[4:5]
    v_cvt_pk_bf16_f32 v88, v144, v145
    v_cvt_pk_bf16_f32 v89, v146, v147
    v_cvt_pk_bf16_f32 v90, v172, v173
    v_cvt_pk_bf16_f32 v91, v174, v175
    v_cvt_pk_bf16_f32 v92, v148, v149
    v_cvt_pk_bf16_f32 v93, v150, v151
    v_cvt_pk_bf16_f32 v94, v176, v177
    v_cvt_pk_bf16_f32 v95, v178, v179
    v_cvt_pk_bf16_f32 v96, v152, v153
    v_cvt_pk_bf16_f32 v97, v154, v155
    v_cvt_pk_bf16_f32 v98, v180, v181
    v_cvt_pk_bf16_f32 v99, v182, v183
    v_cvt_pk_bf16_f32 v100, v156, v157
    v_cvt_pk_bf16_f32 v101, v158, v159
    v_cvt_pk_bf16_f32 v102, v184, v185
    v_cvt_pk_bf16_f32 v103, v186, v187
    v_cvt_pk_bf16_f32 v104, v160, v161
    v_cvt_pk_bf16_f32 v105, v162, v163
    v_cvt_pk_bf16_f32 v106, v188, v189
    v_cvt_pk_bf16_f32 v107, v190, v191
    v_cvt_pk_bf16_f32 v108, v164, v165
    v_cvt_pk_bf16_f32 v109, v166, v167
    v_cvt_pk_bf16_f32 v110, v192, v193
    v_cvt_pk_bf16_f32 v111, v194, v195
    v_cvt_pk_bf16_f32 v112, v168, v169
    v_cvt_pk_bf16_f32 v113, v170, v171
    v_cvt_pk_bf16_f32 v114, v196, v197
    v_cvt_pk_bf16_f32 v115, v198, v199
    s_nop 1
    v_permlane16_swap_b32 v88, v90
    v_permlane16_swap_b32 v89, v91
    v_permlane16_swap_b32 v92, v94
    v_permlane16_swap_b32 v93, v95
    v_permlane16_swap_b32 v96, v98
    v_permlane16_swap_b32 v97, v99
    v_permlane16_swap_b32 v100, v102
    v_permlane16_swap_b32 v101, v103
    v_permlane16_swap_b32 v104, v106
    v_permlane16_swap_b32 v105, v107
    v_permlane16_swap_b32 v108, v110
    v_permlane16_swap_b32 v109, v111
    v_permlane16_swap_b32 v112, v114
    v_permlane16_swap_b32 v113, v115
    v_accvgpr_write_b32 a8, v88
    v_accvgpr_write_b32 a9, v89
    v_accvgpr_write_b32 a10, v90
    v_accvgpr_write_b32 a11, v91
    v_accvgpr_write_b32 a24, v92
    v_accvgpr_write_b32 a25, v93
    v_accvgpr_write_b32 a26, v94
    v_accvgpr_write_b32 a27, v95
    v_accvgpr_write_b32 a40, v96
    v_accvgpr_write_b32 a41, v97
    v_accvgpr_write_b32 a42, v98
    v_accvgpr_write_b32 a43, v99
    v_accvgpr_write_b32 a56, v100
    v_accvgpr_write_b32 a57, v101
    v_accvgpr_write_b32 a58, v102
    v_accvgpr_write_b32 a59, v103
    v_accvgpr_write_b32 a72, v104
    v_accvgpr_write_b32 a73, v105
    v_accvgpr_write_b32 a74, v106
    v_accvgpr_write_b32 a75, v107
    v_accvgpr_write_b32 a88, v108
    v_accvgpr_write_b32 a89, v109
    v_accvgpr_write_b32 a90, v110
    v_accvgpr_write_b32 a91, v111
    v_accvgpr_write_b32 a104, v112
    v_accvgpr_write_b32 a105, v113
    v_accvgpr_write_b32 a106, v114
    v_accvgpr_write_b32 a107, v115
    v_accvgpr_read_b32 v200, a168
    v_accvgpr_read_b32 v201, a169
    v_accvgpr_read_b32 v202, a170
    v_accvgpr_read_b32 v203, a171
    v_accvgpr_read_b32 v204, a172
    v_accvgpr_read_b32 v205, a173
    v_accvgpr_read_b32 v206, a174
    v_accvgpr_read_b32 v207, a175
    v_accvgpr_read_b32 v208, a176
    v_accvgpr_read_b32 v209, a177
    v_accvgpr_read_b32 v210, a178
    v_accvgpr_read_b32 v211, a179
    v_accvgpr_read_b32 v212, a180
    v_accvgpr_read_b32 v213, a181
    v_accvgpr_read_b32 v214, a182
    v_accvgpr_read_b32 v215, a183
    v_accvgpr_read_b32 v216, a184
    v_accvgpr_read_b32 v217, a185
    v_accvgpr_read_b32 v218, a186
    v_accvgpr_read_b32 v219, a187
    v_accvgpr_read_b32 v220, a188
    v_accvgpr_read_b32 v221, a189
    v_accvgpr_read_b32 v222, a190
    v_accvgpr_read_b32 v223, a191
    v_accvgpr_read_b32 v224, a192
    v_accvgpr_read_b32 v225, a193
    v_accvgpr_read_b32 v226, a194
    v_accvgpr_read_b32 v227, a195
    v_accvgpr_read_b32 v228, a196
    v_accvgpr_read_b32 v229, a197
    v_accvgpr_read_b32 v230, a198
    v_accvgpr_read_b32 v231, a199
    v_accvgpr_read_b32 v232, a200
    v_accvgpr_read_b32 v233, a201
    v_accvgpr_read_b32 v234, a202
    v_accvgpr_read_b32 v235, a203
    v_accvgpr_read_b32 v236, a204
    v_accvgpr_read_b32 v237, a205
    v_accvgpr_read_b32 v238, a206
    v_accvgpr_read_b32 v239, a207
    v_accvgpr_read_b32 v240, a208
    v_accvgpr_read_b32 v241, a209
    v_accvgpr_read_b32 v242, a210
    v_accvgpr_read_b32 v243, a211
    v_accvgpr_read_b32 v244, a212
    v_accvgpr_read_b32 v245, a213
    v_accvgpr_read_b32 v246, a214
    v_accvgpr_read_b32 v247, a215
    v_accvgpr_read_b32 v248, a216
    v_accvgpr_read_b32 v249, a217
    v_accvgpr_read_b32 v250, a218
    v_accvgpr_read_b32 v251, a219
    v_accvgpr_read_b32 v252, a220
    v_accvgpr_read_b32 v253, a221
    v_accvgpr_read_b32 v254, a222
    v_accvgpr_read_b32 v255, a223
    v_pk_mul_f32 v[200:201], v[200:201], v[4:5]
    v_pk_mul_f32 v[202:203], v[202:203], v[4:5]
    v_pk_mul_f32 v[204:205], v[204:205], v[4:5]
    v_pk_mul_f32 v[206:207], v[206:207], v[4:5]
    v_pk_mul_f32 v[208:209], v[208:209], v[4:5]
    v_pk_mul_f32 v[210:211], v[210:211], v[4:5]
    v_pk_mul_f32 v[212:213], v[212:213], v[4:5]
    v_pk_mul_f32 v[214:215], v[214:215], v[4:5]
    v_pk_mul_f32 v[216:217], v[216:217], v[4:5]
    v_pk_mul_f32 v[218:219], v[218:219], v[4:5]
    v_pk_mul_f32 v[220:221], v[220:221], v[4:5]
    v_pk_mul_f32 v[222:223], v[222:223], v[4:5]
    v_pk_mul_f32 v[224:225], v[224:225], v[4:5]
    v_pk_mul_f32 v[226:227], v[226:227], v[4:5]
    v_pk_mul_f32 v[228:229], v[228:229], v[4:5]
    v_pk_mul_f32 v[230:231], v[230:231], v[4:5]
    v_pk_mul_f32 v[232:233], v[232:233], v[4:5]
    v_pk_mul_f32 v[234:235], v[234:235], v[4:5]
    v_pk_mul_f32 v[236:237], v[236:237], v[4:5]
    v_pk_mul_f32 v[238:239], v[238:239], v[4:5]
    v_pk_mul_f32 v[240:241], v[240:241], v[4:5]
    v_pk_mul_f32 v[242:243], v[242:243], v[4:5]
    v_pk_mul_f32 v[244:245], v[244:245], v[4:5]
    v_pk_mul_f32 v[246:247], v[246:247], v[4:5]
    v_pk_mul_f32 v[248:249], v[248:249], v[4:5]
    v_pk_mul_f32 v[250:251], v[250:251], v[4:5]
    v_pk_mul_f32 v[252:253], v[252:253], v[4:5]
    v_pk_mul_f32 v[254:255], v[254:255], v[4:5]
    v_cvt_pk_bf16_f32 v116, v200, v201
    v_cvt_pk_bf16_f32 v117, v202, v203
    v_cvt_pk_bf16_f32 v118, v228, v229
    v_cvt_pk_bf16_f32 v119, v230, v231
    v_cvt_pk_bf16_f32 v120, v204, v205
    v_cvt_pk_bf16_f32 v121, v206, v207
    v_cvt_pk_bf16_f32 v122, v232, v233
    v_cvt_pk_bf16_f32 v123, v234, v235
    v_cvt_pk_bf16_f32 v124, v208, v209
    v_cvt_pk_bf16_f32 v125, v210, v211
    v_cvt_pk_bf16_f32 v126, v236, v237
    v_cvt_pk_bf16_f32 v127, v238, v239
    v_cvt_pk_bf16_f32 v128, v212, v213
    v_cvt_pk_bf16_f32 v129, v214, v215
    v_cvt_pk_bf16_f32 v130, v240, v241
    v_cvt_pk_bf16_f32 v131, v242, v243
    v_cvt_pk_bf16_f32 v132, v216, v217
    v_cvt_pk_bf16_f32 v133, v218, v219
    v_cvt_pk_bf16_f32 v134, v244, v245
    v_cvt_pk_bf16_f32 v135, v246, v247
    v_cvt_pk_bf16_f32 v136, v220, v221
    v_cvt_pk_bf16_f32 v137, v222, v223
    v_cvt_pk_bf16_f32 v138, v248, v249
    v_cvt_pk_bf16_f32 v139, v250, v251
    v_cvt_pk_bf16_f32 v140, v224, v225
    v_cvt_pk_bf16_f32 v141, v226, v227
    v_cvt_pk_bf16_f32 v142, v252, v253
    v_cvt_pk_bf16_f32 v143, v254, v255
    s_nop 1
    v_permlane16_swap_b32 v116, v118
    v_permlane16_swap_b32 v117, v119
    v_permlane16_swap_b32 v120, v122
    v_permlane16_swap_b32 v121, v123
    v_permlane16_swap_b32 v124, v126
    v_permlane16_swap_b32 v125, v127
    v_permlane16_swap_b32 v128, v130
    v_permlane16_swap_b32 v129, v131
    v_permlane16_swap_b32 v132, v134
    v_permlane16_swap_b32 v133, v135
    v_permlane16_swap_b32 v136, v138
    v_permlane16_swap_b32 v137, v139
    v_permlane16_swap_b32 v140, v142
    v_permlane16_swap_b32 v141, v143
    v_accvgpr_write_b32 a12, v116
    v_accvgpr_write_b32 a13, v117
    v_accvgpr_write_b32 a14, v118
    v_accvgpr_write_b32 a15, v119
    v_accvgpr_write_b32 a28, v120
    v_accvgpr_write_b32 a29, v121
    v_accvgpr_write_b32 a30, v122
    v_accvgpr_write_b32 a31, v123
    v_accvgpr_write_b32 a44, v124
    v_accvgpr_write_b32 a45, v125
    v_accvgpr_write_b32 a46, v126
    v_accvgpr_write_b32 a47, v127
    v_accvgpr_write_b32 a60, v128
    v_accvgpr_write_b32 a61, v129
    v_accvgpr_write_b32 a62, v130
    v_accvgpr_write_b32 a63, v131
    v_accvgpr_write_b32 a76, v132
    v_accvgpr_write_b32 a77, v133
    v_accvgpr_write_b32 a78, v134
    v_accvgpr_write_b32 a79, v135
    v_accvgpr_write_b32 a92, v136
    v_accvgpr_write_b32 a93, v137
    v_accvgpr_write_b32 a94, v138
    v_accvgpr_write_b32 a95, v139
    v_accvgpr_write_b32 a108, v140
    v_accvgpr_write_b32 a109, v141
    v_accvgpr_write_b32 a110, v142
    v_accvgpr_write_b32 a111, v143
    s_cmp_eq_u32 s70, 0
    s_cbranch_scc1 L_at_nostash
    s_mov_b32 s70, 0
    s_lshl_b32 s30, s2, 2
    s_add_u32 s30, s30, s20
    s_mul_i32 s30, s30, 28672
    v_lshlrev_b32 v4, 4, v1
    buffer_store_dwordx4 a[0:3], v4, s[12:15], s30 offen offset:0
    buffer_store_dwordx4 a[4:7], v4, s[12:15], s30 offen offset:1024
    buffer_store_dwordx4 a[8:11], v4, s[12:15], s30 offen offset:2048
    buffer_store_dwordx4 a[12:15], v4, s[12:15], s30 offen offset:3072
    s_add_u32 s30, s30, 4096
    buffer_store_dwordx4 a[16:19], v4, s[12:15], s30 offen offset:0
    buffer_store_dwordx4 a[20:23], v4, s[12:15], s30 offen offset:1024
    buffer_store_dwordx4 a[24:27], v4, s[12:15], s30 offen offset:2048
    buffer_store_dwordx4 a[28:31], v4, s[12:15], s30 offen offset:3072
    s_add_u32 s30, s30, 4096
    buffer_store_dwordx4 a[32:35], v4, s[12:15], s30 offen offset:0
    buffer_store_dwordx4 a[36:39], v4, s[12:15], s30 offen offset:1024
    buffer_store_dwordx4 a[40:43], v4, s[12:15], s30 offen offset:2048
    buffer_store_dwordx4 a[44:47], v4, s[12:15], s30 offen offset:3072
    s_add_u32 s30, s30, 4096
    buffer_store_dwordx4 a[48:51], v4, s[12:15], s30 offen offset:0
    buffer_store_dwordx4 a[52:55], v4, s[12:15], s30 offen offset:1024
    buffer_store_dwordx4 a[56:59], v4, s[12:15], s30 offen offset:2048
    buffer_store_dwordx4 a[60:63], v4, s[12:15], s30 offen offset:3072
    s_add_u32 s30, s30, 4096
    buffer_store_dwordx4 a[64:67], v4, s[12:15], s30 offen offset:0
    buffer_store_dwordx4 a[68:71], v4, s[12:15], s30 offen offset:1024
    buffer_store_dwordx4 a[72:75], v4, s[12:15], s30 offen offset:2048
    buffer_store_dwordx4 a[76:79], v4, s[12:15], s30 offen offset:3072
    s_add_u32 s30, s30, 4096
    buffer_store_dwordx4 a[80:83], v4, s[12:15], s30 offen offset:0
    buffer_store_dwordx4 a[84:87], v4, s[12:15], s30 offen offset:1024
    buffer_store_dwordx4 a[88:91], v4, s[12:15], s30 offen offset:2048
    buffer_store_dwordx4 a[92:95], v4, s[12:15], s30 offen offset:3072
    s_add_u32 s30, s30, 4096
    buffer_store_dwordx4 a[96:99], v4, s[12:15], s30 offen offset:0
    buffer_store_dwordx4 a[100:103], v4, s[12:15], s30 offen offset:1024
    buffer_store_dwordx4 a[104:107], v4, s[12:15], s30 offen offset:2048
    buffer_store_dwordx4 a[108:111], v4, s[12:15], s30 offen offset:3072
    s_mov_b32 s68, 3
    s_branch L_at_round
L_at_nostash:
    s_cmp_lg_u32 s25, 0
    s_cbranch_scc1 L_at_maxpass
L_at_pre:
L_at_nowo1:
    s_waitcnt lgkmcnt(0)
    v_mfma_f32_16x16x32_bf16 v[88:91], v[56:59], a[0:3], 0
    v_mov_b32 v168, 0
    v_mov_b32 v169, 0
    v_mfma_f32_16x16x32_bf16 v[88:91], v[60:63], a[4:7], v[88:91]
    v_mov_b32 v170, 0
    v_mov_b32 v171, 0
    v_mfma_f32_16x16x32_bf16 v[88:91], v[64:67], a[8:11], v[88:91]
    v_mov_b32 v196, 0
    v_mov_b32 v197, 0
    v_mfma_f32_16x16x32_bf16 v[88:91], v[68:71], a[12:15], v[88:91]
    v_mov_b32 v198, 0
    v_mov_b32 v199, 0
    v_mfma_f32_16x16x32_bf16 v[92:95], v[84:87], a[12:15], 0
    v_mov_b32 v224, 0
    v_mov_b32 v225, 0
    v_mfma_f32_16x16x32_bf16 v[92:95], v[80:83], a[8:11], v[92:95]
    v_mov_b32 v226, 0
    v_mov_b32 v227, 0
    v_mfma_f32_16x16x32_bf16 v[92:95], v[76:79], a[4:7], v[92:95]
    v_mov_b32 v252, 0
    v_mov_b32 v253, 0
    v_mfma_f32_16x16x32_bf16 v[92:95], v[72:75], a[0:3], v[92:95]
    v_mov_b32 v254, 0
    v_mov_b32 v255, 0
    v_accvgpr_write_b32 a136, 0
    v_accvgpr_write_b32 a137, 0
    v_accvgpr_write_b32 a138, 0
    v_accvgpr_write_b32 a139, 0
    v_accvgpr_write_b32 a164, 0
    v_accvgpr_write_b32 a165, 0
    v_accvgpr_write_b32 a166, 0
    v_accvgpr_write_b32 a167, 0
    v_accvgpr_write_b32 a192, 0
    v_accvgpr_write_b32 a193, 0
    v_accvgpr_write_b32 a194, 0
    v_accvgpr_write_b32 a195, 0
    v_accvgpr_write_b32 a220, 0
    v_accvgpr_write_b32 a221, 0
    v_accvgpr_write_b32 a222, 0
    v_accvgpr_write_b32 a223, 0
    v_mfma_f32_16x16x32_bf16 v[96:99], v[56:59], a[16:19], 0
    v_max3_f32 v2, v88, v89, v12
    v_max3_f32 v3, v90, v91, v92
    v_max3_f32 v2, v93, v94, v2
    v_mfma_f32_16x16x32_bf16 v[96:99], v[60:63], a[20:23], v[96:99]
    v_max3_f32 v2, v95, v2, v3
    v_mov_b32 v3, v2
    s_nop 1
    v_permlane16_swap_b32 v2, v3
    v_mfma_f32_16x16x32_bf16 v[96:99], v[64:67], a[24:27], v[96:99]
    s_nop 1
    v_max_f32 v2, v2, v3
    v_mov_b32 v3, v2
    v_mfma_f32_16x16x32_bf16 v[96:99], v[68:71], a[28:31], v[96:99]
    s_nop 1
    v_permlane32_swap_b32 v2, v3
    s_nop 1
    v_max_f32 v2, v2, v3
    v_mfma_f32_16x16x32_bf16 v[100:103], v[84:87], a[28:31], 0
    v_mov_b32 v12, 0
    v_mov_b32 v13, 0
    v_sub_f32 v88, v88, v2
    v_mfma_f32_16x16x32_bf16 v[100:103], v[80:83], a[24:27], v[100:103]
    v_sub_f32 v89, v89, v2
    v_sub_f32 v90, v90, v2
    v_sub_f32 v91, v91, v2
    v_sub_f32 v92, v92, v2
    v_mfma_f32_16x16x32_bf16 v[100:103], v[76:79], a[20:23], v[100:103]
    v_sub_f32 v93, v93, v2
    v_sub_f32 v94, v94, v2
    v_sub_f32 v95, v95, v2
    v_mfma_f32_16x16x32_bf16 v[100:103], v[72:75], a[16:19], v[100:103]
    v_sub_f32 v28, 0, v2
    v_sub_f32 v29, 0, v2
    v_sub_f32 v30, 0, v2
    v_sub_f32 v31, 0, v2
    ds_read_b64_tr_b16 v[112:113], v9 offset:0
    ds_read_b64_tr_b16 v[114:115], v9 offset:512
    v_exp_f32 v88, v88
    ds_read_b64_tr_b16 v[116:117], v9 offset:32
    ds_read_b64_tr_b16 v[118:119], v9 offset:544
    v_exp_f32 v89, v89
    v_exp_f32 v90, v90
    ds_read_b64_tr_b16 v[120:121], v9 offset:64
    ds_read_b64_tr_b16 v[122:123], v9 offset:576
    v_exp_f32 v91, v91
    v_add_f32 v12, v12, v88
    v_add_f32 v13, v13, v89
    ds_read_b64_tr_b16 v[124:125], v9 offset:96
    ds_read_b64_tr_b16 v[126:127], v9 offset:608
    v_cvt_pk_bf16_f32 v104, v88, v89
    v_exp_f32 v92, v92
    ds_read_b64_tr_b16 v[128:129], v9 offset:128
    ds_read_b64_tr_b16 v[130:131], v9 offset:640
    v_exp_f32 v93, v93
    v_add_f32 v12, v12, v90
    v_add_f32 v13, v13, v91
    ds_read_b64_tr_b16 v[132:133], v9 offset:160
    ds_read_b64_tr_b16 v[134:135], v9 offset:672
    v_cvt_pk_bf16_f32 v105, v90, v91
    v_exp_f32 v94, v94
    ds_read_b64_tr_b16 v[136:137], v9 offset:192
    ds_read_b64_tr_b16 v[138:139], v9 offset:704
    v_exp_f32 v95, v95
    v_add_f32 v12, v12, v92
    v_add_f32 v13, v13, v93
    ds_read_b64_tr_b16 v[140:141], v9 offset:224
    ds_read_b64_tr_b16 v[142:143], v9 offset:736
    v_cvt_pk_bf16_f32 v106, v92, v93
    v_add_f32 v12, v12, v94
    v_add_f32 v13, v13, v95
    v_cvt_pk_bf16_f32 v107, v94, v95
    v_mfma_f32_16x16x32_bf16 v[88:91], v[56:59], a[32:35], 0
    v_max3_f32 v2, v96, v97, v14
    v_max3_f32 v3, v98, v99, v100
    v_max3_f32 v2, v101, v102, v2
    v_mfma_f32_16x16x32_bf16 v[88:91], v[60:63], a[36:39], v[88:91]
    v_max3_f32 v2, v103, v2, v3
    v_mov_b32 v3, v2
    s_nop 1
    v_permlane16_swap_b32 v2, v3
    v_mfma_f32_16x16x32_bf16 v[88:91], v[64:67], a[40:43], v[88:91]
    s_nop 1
    v_max_f32 v2, v2, v3
    v_mov_b32 v3, v2
    v_mfma_f32_16x16x32_bf16 v[88:91], v[68:71], a[44:47], v[88:91]
    s_nop 1
    v_permlane32_swap_b32 v2, v3
    s_nop 1
    v_max_f32 v2, v2, v3
    v_mfma_f32_16x16x32_bf16 v[92:95], v[84:87], a[44:47], 0
    v_mov_b32 v14, 0
    v_mov_b32 v15, 0
    v_sub_f32 v96, v96, v2
    v_mfma_f32_16x16x32_bf16 v[92:95], v[80:83], a[40:43], v[92:95]
    v_sub_f32 v97, v97, v2
    v_sub_f32 v98, v98, v2
    v_sub_f32 v99, v99, v2
    v_sub_f32 v100, v100, v2
    v_mfma_f32_16x16x32_bf16 v[92:95], v[76:79], a[36:39], v[92:95]
    v_sub_f32 v101, v101, v2
    v_sub_f32 v102, v102, v2
    v_sub_f32 v103, v103, v2
    v_mfma_f32_16x16x32_bf16 v[92:95], v[72:75], a[32:35], v[92:95]
    v_sub_f32 v32, 0, v2
    v_sub_f32 v33, 0, v2
    v_sub_f32 v34, 0, v2
    v_sub_f32 v35, 0, v2
    s_waitcnt lgkmcnt(0)
    v_mfma_f32_16x16x32_bf16 v[144:147], v[112:115], v[104:107], 0
    v_exp_f32 v96, v96
    v_mfma_f32_16x16x32_bf16 v[172:175], v[116:119], v[104:107], 0
    v_exp_f32 v97, v97
    v_exp_f32 v98, v98
    v_mfma_f32_16x16x32_bf16 v[200:203], v[120:123], v[104:107], 0
    v_exp_f32 v99, v99
    v_add_f32 v14, v14, v96
    v_add_f32 v15, v15, v97
    v_mfma_f32_16x16x32_bf16 v[228:231], v[124:127], v[104:107], 0
    v_cvt_pk_bf16_f32 v108, v96, v97
    v_exp_f32 v100, v100
    v_mfma_f32_16x16x32_bf16 a[112:115], v[128:131], v[104:107], 0
    v_exp_f32 v101, v101
    v_add_f32 v14, v14, v98
    v_add_f32 v15, v15, v99
    v_mfma_f32_16x16x32_bf16 a[140:143], v[132:135], v[104:107], 0
    v_cvt_pk_bf16_f32 v109, v98, v99
    v_exp_f32 v102, v102
    v_mfma_f32_16x16x32_bf16 a[168:171], v[136:139], v[104:107], 0
    v_exp_f32 v103, v103
    v_add_f32 v14, v14, v100
    v_add_f32 v15, v15, v101
    v_mfma_f32_16x16x32_bf16 a[196:199], v[140:143], v[104:107], 0
    v_cvt_pk_bf16_f32 v110, v100, v101
    v_add_f32 v14, v14, v102
    v_add_f32 v15, v15, v103
    v_cvt_pk_bf16_f32 v111, v102, v103
    v_mfma_f32_16x16x32_bf16 v[96:99], v[56:59], a[48:51], 0
    v_max3_f32 v2, v88, v89, v16
    v_max3_f32 v3, v90, v91, v92
    v_max3_f32 v2, v93, v94, v2
    v_mfma_f32_16x16x32_bf16 v[96:99], v[60:63], a[52:55], v[96:99]
    v_max3_f32 v2, v95, v2, v3
    v_mov_b32 v3, v2
    s_nop 1
    v_permlane16_swap_b32 v2, v3
    v_mfma_f32_16x16x32_bf16 v[96:99], v[64:67], a[56:59], v[96:99]
    s_nop 1
    v_max_f32 v2, v2, v3
    v_mov_b32 v3, v2
    v_mfma_f32_16x16x32_bf16 v[96:99], v[68:71], a[60:63], v[96:99]
    s_nop 1
    v_permlane32_swap_b32 v2, v3
    s_nop 1
    v_max_f32 v2, v2, v3
    v_mfma_f32_16x16x32_bf16 v[100:103], v[84:87], a[60:63], 0
    v_mov_b32 v16, 0
    v_mov_b32 v17, 0
    v_sub_f32 v88, v88, v2
    v_mfma_f32_16x16x32_bf16 v[100:103], v[80:83], a[56:59], v[100:103]
    v_sub_f32 v89, v89, v2
    v_sub_f32 v90, v90, v2
    v_sub_f32 v91, v91, v2
    v_sub_f32 v92, v92, v2
    v_mfma_f32_16x16x32_bf16 v[100:103], v[76:79], a[52:55], v[100:103]
    v_sub_f32 v93, v93, v2
    v_sub_f32 v94, v94, v2
    v_sub_f32 v95, v95, v2
    v_mfma_f32_16x16x32_bf16 v[100:103], v[72:75], a[48:51], v[100:103]
    v_sub_f32 v36, 0, v2
    v_sub_f32 v37, 0, v2
    v_sub_f32 v38, 0, v2
    v_sub_f32 v39, 0, v2
    v_mfma_f32_16x16x32_bf16 v[148:151], v[112:115], v[108:111], 0
    v_exp_f32 v88, v88
    v_mfma_f32_16x16x32_bf16 v[176:179], v[116:119], v[108:111], 0
    v_exp_f32 v89, v89
    v_exp_f32 v90, v90
    v_mfma_f32_16x16x32_bf16 v[204:207], v[120:123], v[108:111], 0
    v_exp_f32 v91, v91
    v_add_f32 v16, v16, v88
    v_add_f32 v17, v17, v89
    v_mfma_f32_16x16x32_bf16 v[232:235], v[124:127], v[108:111], 0
    v_cvt_pk_bf16_f32 v104, v88, v89
    v_exp_f32 v92, v92
    v_mfma_f32_16x16x32_bf16 a[116:119], v[128:131], v[108:111], 0
    v_exp_f32 v93, v93
    v_add_f32 v16, v16, v90
    v_add_f32 v17, v17, v91
    v_mfma_f32_16x16x32_bf16 a[144:147], v[132:135], v[108:111], 0
    v_cvt_pk_bf16_f32 v105, v90, v91
    v_exp_f32 v94, v94
    v_mfma_f32_16x16x32_bf16 a[172:175], v[136:139], v[108:111], 0
    v_exp_f32 v95, v95
    v_add_f32 v16, v16, v92
    v_add_f32 v17, v17, v93
    v_mfma_f32_16x16x32_bf16 a[200:203], v[140:143], v[108:111], 0
    v_cvt_pk_bf16_f32 v106, v92, v93
    v_add_f32 v16, v16, v94
    v_add_f32 v17, v17, v95
    v_cvt_pk_bf16_f32 v107, v94, v95
    v_mfma_f32_16x16x32_bf16 v[88:91], v[56:59], a[64:67], 0
    v_max3_f32 v2, v96, v97, v18
    v_max3_f32 v3, v98, v99, v100
    v_max3_f32 v2, v101, v102, v2
    v_mfma_f32_16x16x32_bf16 v[88:91], v[60:63], a[68:71], v[88:91]
    v_max3_f32 v2, v103, v2, v3
    v_mov_b32 v3, v2
    s_nop 1
    v_permlane16_swap_b32 v2, v3
    v_mfma_f32_16x16x32_bf16 v[88:91], v[64:67], a[72:75], v[88:91]
    s_nop 1
    v_max_f32 v2, v2, v3
    v_mov_b32 v3, v2
    v_mfma_f32_16x16x32_bf16 v[88:91], v[68:71], a[76:79], v[88:91]
    s_nop 1
    v_permlane32_swap_b32 v2, v3
    s_nop 1
    v_max_f32 v2, v2, v3
    v_mfma_f32_16x16x32_bf16 v[92:95], v[84:87], a[76:79], 0
    v_mov_b32 v18, 0
    v_mov_b32 v19, 0
    v_sub_f32 v96, v96, v2
    v_mfma_f32_16x16x32_bf16 v[92:95], v[80:83], a[72:75], v[92:95]
    v_sub_f32 v97, v97, v2
    v_sub_f32 v98, v98, v2
    v_sub_f32 v99, v99, v2
    v_sub_f32 v100, v100, v2
    v_mfma_f32_16x16x32_bf16 v[92:95], v[76:79], a[68:71], v[92:95]
    v_sub_f32 v101, v101, v2
    v_sub_f32 v102, v102, v2
    v_sub_f32 v103, v103, v2
    v_mfma_f32_16x16x32_bf16 v[92:95], v[72:75], a[64:67], v[92:95]
    v_sub_f32 v40, 0, v2
    v_sub_f32 v41, 0, v2
    v_sub_f32 v42, 0, v2
    v_sub_f32 v43, 0, v2
    v_mfma_f32_16x16x32_bf16 v[152:155], v[112:115], v[104:107], 0
    v_exp_f32 v96, v96
    v_mfma_f32_16x16x32_bf16 v[180:183], v[116:119], v[104:107], 0
    v_exp_f32 v97, v97
    v_exp_f32 v98, v98
    v_mfma_f32_16x16x32_bf16 v[208:211], v[120:123], v[104:107], 0
    v_exp_f32 v99, v99
    v_add_f32 v18, v18, v96
    v_add_f32 v19, v19, v97
    v_mfma_f32_16x16x32_bf16 v[236:239], v[124:127], v[104:107], 0
    v_cvt_pk_bf16_f32 v108, v96, v97
    v_exp_f32 v100, v100
    v_mfma_f32_16x16x32_bf16 a[120:123], v[128:131], v[104:107], 0
    v_exp_f32 v101, v101
    v_add_f32 v18, v18, v98
    v_add_f32 v19, v19, v99
    v_mfma_f32_16x16x32_bf16 a[148:151], v[132:135], v[104:107], 0
    v_cvt_pk_bf16_f32 v109, v98, v99
    v_exp_f32 v102, v102
    v_mfma_f32_16x16x32_bf16 a[176:179], v[136:139], v[104:107], 0
    v_exp_f32 v103, v103
    v_add_f32 v18, v18, v100
    v_add_f32 v19, v19, v101
    v_mfma_f32_16x16x32_bf16 a[204:207], v[140:143], v[104:107], 0
    v_cvt_pk_bf16_f32 v110, v100, v101
    v_add_f32 v18, v18, v102
    v_add_f32 v19, v19, v103
    v_cvt_pk_bf16_f32 v111, v102, v103
    v_mfma_f32_16x16x32_bf16 v[96:99], v[56:59], a[80:83], 0
    v_max3_f32 v2, v88, v89, v20
    v_max3_f32 v3, v90, v91, v92
    v_max3_f32 v2, v93, v94, v2
    v_mfma_f32_16x16x32_bf16 v[96:99], v[60:63], a[84:87], v[96:99]
    v_max3_f32 v2, v95, v2, v3
    v_mov_b32 v3, v2
    s_nop 1
    v_permlane16_swap_b32 v2, v3
    v_mfma_f32_16x16x32_bf16 v[96:99], v[64:67], a[88:91], v[96:99]
    s_nop 1
    v_max_f32 v2, v2, v3
    v_mov_b32 v3, v2
    v_mfma_f32_16x16x32_bf16 v[96:99], v[68:71], a[92:95], v[96:99]
    s_nop 1
    v_permlane32_swap_b32 v2, v3
    s_nop 1
    v_max_f32 v2, v2, v3
    v_mfma_f32_16x16x32_bf16 v[100:103], v[84:87], a[92:95], 0
    v_mov_b32 v20, 0
    v_mov_b32 v21, 0
    v_sub_f32 v88, v88, v2
    v_mfma_f32_16x16x32_bf16 v[100:103], v[80:83], a[88:91], v[100:103]
    v_sub_f32 v89, v89, v2
    v_sub_f32 v90, v90, v2
    v_sub_f32 v91, v91, v2
    v_sub_f32 v92, v92, v2
    v_mfma_f32_16x16x32_bf16 v[100:103], v[76:79], a[84:87], v[100:103]
    v_sub_f32 v93, v93, v2
    v_sub_f32 v94, v94, v2
    v_sub_f32 v95, v95, v2
    v_mfma_f32_16x16x32_bf16 v[100:103], v[72:75], a[80:83], v[100:103]
    v_sub_f32 v44, 0, v2
    v_sub_f32 v45, 0, v2
    v_sub_f32 v46, 0, v2
    v_sub_f32 v47, 0, v2
    v_mfma_f32_16x16x32_bf16 v[156:159], v[112:115], v[108:111], 0
    v_exp_f32 v88, v88
    v_mfma_f32_16x16x32_bf16 v[184:187], v[116:119], v[108:111], 0
    v_exp_f32 v89, v89
    v_exp_f32 v90, v90
    v_mfma_f32_16x16x32_bf16 v[212:215], v[120:123], v[108:111], 0
    v_exp_f32 v91, v91
    v_add_f32 v20, v20, v88
    v_add_f32 v21, v21, v89
    v_mfma_f32_16x16x32_bf16 v[240:243], v[124:127], v[108:111], 0
    v_cvt_pk_bf16_f32 v104, v88, v89
    v_exp_f32 v92, v92
    v_mfma_f32_16x16x32_bf16 a[124:127], v[128:131], v[108:111], 0
    v_exp_f32 v93, v93
    v_add_f32 v20, v20, v90
    v_add_f32 v21, v21, v91
    v_mfma_f32_16x16x32_bf16 a[152:155], v[132:135], v[108:111], 0
    v_cvt_pk_bf16_f32 v105, v90, v91
    v_exp_f32 v94, v94
    v_mfma_f32_16x16x32_bf16 a[180:183], v[136:139], v[108:111], 0
    v_exp_f32 v95, v95
    v_add_f32 v20, v20, v92
    v_add_f32 v21, v21, v93
    v_mfma_f32_16x16x32_bf16 a[208:211], v[140:143], v[108:111], 0
    v_cvt_pk_bf16_f32 v106, v92, v93
    v_add_f32 v20, v20, v94
    v_add_f32 v21, v21, v95
    v_cvt_pk_bf16_f32 v107, v94, v95
    s_cmp_eq_u32 s68, 0
    s_cbranch_scc0 L_bw1_3105
    s_waitcnt vmcnt(16) lgkmcnt(0)
L_bw2_3105:
    s_barrier
    s_cmp_le_u32 s21, s27
    s_cbranch_scc1 L_at_nofb_3110
    s_sub_u32 s28, s21, 1
    s_cmp_eq_u32 s28, s23
    s_cbranch_scc1 L_at_nofb_3110
    s_lshl_b32 s29, s28, 2
    s_add_u32 s29, s29, 76000
    v_mov_b32 v4, s29
    ds_read_b32 v4, v4
    s_waitcnt lgkmcnt(0)
    v_readfirstlane_b32 s29, v4
    s_nop 3
    s_cmp_lg_u32 s29, 0
    s_cbranch_scc1 L_at_fallback
L_at_nofb_3110:
    v_mfma_f32_16x16x32_bf16 v[88:91], v[56:59], a[96:99], 0
    ds_read_b128 v[56:59], v8 offset:8448
    v_max3_f32 v2, v96, v97, v22
    v_max3_f32 v3, v98, v99, v100
    v_max3_f32 v2, v101, v102, v2
    v_mfma_f32_16x16x32_bf16 v[88:91], v[60:63], a[100:103], v[88:91]
    ds_read_b128 v[60:63], v8 offset:8512
    v_max3_f32 v2, v103, v2, v3
    v_mov_b32 v3, v2
    s_nop 1
    v_permlane16_swap_b32 v2, v3
    v_mfma_f32_16x16x32_bf16 v[88:91], v[64:67], a[104:107], v[88:91]
    ds_read_b128 v[64:67], v8 offset:8576
    s_nop 1
    v_max_f32 v2, v2, v3
    v_mov_b32 v3, v2
    v_mfma_f32_16x16x32_bf16 v[88:91], v[68:71], a[108:111], v[88:91]
    ds_read_b128 v[68:71], v8 offset:8640
    s_nop 1
    v_permlane32_swap_b32 v2, v3
    s_nop 1
    v_max_f32 v2, v2, v3
    v_mfma_f32_16x16x32_bf16 v[92:95], v[84:87], a[108:111], 0
    ds_read_b128 v[84:87], v8 offset:9152
    v_mov_b32 v22, 0
    v_mov_b32 v23, 0
    v_sub_f32 v96, v96, v2
    v_mfma_f32_16x16x32_bf16 v[92:95], v[80:83], a[104:107], v[92:95]
    ds_read_b128 v[80:83], v8 offset:9088
    v_sub_f32 v97, v97, v2
    v_sub_f32 v98, v98, v2
    v_sub_f32 v99, v99, v2
    v_sub_f32 v100, v100, v2
    v_mfma_f32_16x16x32_bf16 v[92:95], v[76:79], a[100:103], v[92:95]
    ds_read_b128 v[76:79], v8 offset:9024
    v_sub_f32 v101, v101, v2
    v_sub_f32 v102, v102, v2
    v_sub_f32 v103, v103, v2
    v_mfma_f32_16x16x32_bf16 v[92:95], v[72:75], a[96:99], v[92:95]
    ds_read_b128 v[72:75], v8 offset:8960
    v_sub_f32 v48, 0, v2
    v_sub_f32 v49, 0, v2
    v_sub_f32 v50, 0, v2
    v_sub_f32 v51, 0, v2
    v_mfma_f32_16x16x32_bf16 v[160:163], v[112:115], v[104:107], 0
    v_exp_f32 v96, v96
    v_mfma_f32_16x16x32_bf16 v[188:191], v[116:119], v[104:107], 0
    v_exp_f32 v97, v97
    v_exp_f32 v98, v98
    v_mfma_f32_16x16x32_bf16 v[216:219], v[120:123], v[104:107], 0
    v_exp_f32 v99, v99
    v_add_f32 v22, v22, v96
    v_add_f32 v23, v23, v97
    v_mfma_f32_16x16x32_bf16 v[244:247], v[124:127], v[104:107], 0
    v_cvt_pk_bf16_f32 v108, v96, v97
    v_exp_f32 v100, v100
    v_mfma_f32_16x16x32_bf16 a[128:131], v[128:131], v[104:107], 0
    v_exp_f32 v101, v101
    v_add_f32 v22, v22, v98
    v_add_f32 v23, v23, v99
    v_mfma_f32_16x16x32_bf16 a[156:159], v[132:135], v[104:107], 0
    v_cvt_pk_bf16_f32 v109, v98, v99
    v_exp_f32 v102, v102
    v_mfma_f32_16x16x32_bf16 a[184:187], v[136:139], v[104:107], 0
    v_exp_f32 v103, v103
    v_add_f32 v22, v22, v100
    v_add_f32 v23, v23, v101
    v_mfma_f32_16x16x32_bf16 a[212:215], v[140:143], v[104:107], 0
    v_cvt_pk_bf16_f32 v110, v100, v101
    v_add_f32 v22, v22, v102
    v_add_f32 v23, v23, v103
    v_cvt_pk_bf16_f32 v111, v102, v103
    s_waitcnt lgkmcnt(0)
    v_mfma_f32_16x16x32_bf16 v[96:99], v[56:59], a[0:3], v[28:31]
    v_max3_f32 v2, v88, v89, v24
    v_max3_f32 v3, v90, v91, v92
    v_max3_f32 v2, v93, v94, v2
    v_mfma_f32_16x16x32_bf16 v[96:99], v[60:63], a[4:7], v[96:99]
    v_max3_f32 v2, v95, v2, v3
    v_mov_b32 v3, v2
    s_nop 1
    v_permlane16_swap_b32 v2, v3
    v_mfma_f32_16x16x32_bf16 v[96:99], v[64:67], a[8:11], v[96:99]
    s_nop 1
    v_max_f32 v2, v2, v3
    v_mov_b32 v3, v2
    v_mfma_f32_16x16x32_bf16 v[96:99], v[68:71], a[12:15], v[96:99]
    s_nop 1
    v_permlane32_swap_b32 v2, v3
    s_nop 1
    v_max_f32 v2, v2, v3
    v_mfma_f32_16x16x32_bf16 v[100:103], v[84:87], a[12:15], v[28:31]
    v_mov_b32 v24, 0
    v_mov_b32 v25, 0
    v_sub_f32 v88, v88, v2
    v_mfma_f32_16x16x32_bf16 v[100:103], v[80:83], a[8:11], v[100:103]
    v_sub_f32 v89, v89, v2
    v_sub_f32 v90, v90, v2
    v_sub_f32 v91, v91, v2
    v_sub_f32 v92, v92, v2
    v_mfma_f32_16x16x32_bf16 v[100:103], v[76:79], a[4:7], v[100:103]
    v_sub_f32 v93, v93, v2
    v_sub_f32 v94, v94, v2
    v_sub_f32 v95, v95, v2
    v_mfma_f32_16x16x32_bf16 v[100:103], v[72:75], a[0:3], v[100:103]
    v_sub_f32 v52, 0, v2
    v_sub_f32 v53, 0, v2
    v_sub_f32 v54, 0, v2
    v_sub_f32 v55, 0, v2
    v_mfma_f32_16x16x32_bf16 v[164:167], v[112:115], v[108:111], 0
    v_exp_f32 v88, v88
    v_mfma_f32_16x16x32_bf16 v[192:195], v[116:119], v[108:111], 0
    v_exp_f32 v89, v89
    v_exp_f32 v90, v90
    v_mfma_f32_16x16x32_bf16 v[220:223], v[120:123], v[108:111], 0
    v_exp_f32 v91, v91
    v_add_f32 v24, v24, v88
    v_add_f32 v25, v25, v89
    v_mfma_f32_16x16x32_bf16 v[248:251], v[124:127], v[108:111], 0
    v_cvt_pk_bf16_f32 v104, v88, v89
    v_exp_f32 v92, v92
    v_mfma_f32_16x16x32_bf16 a[132:135], v[128:131], v[108:111], 0
    v_exp_f32 v93, v93
    v_add_f32 v24, v24, v90
    v_add_f32 v25, v25, v91
    v_mfma_f32_16x16x32_bf16 a[160:163], v[132:135], v[108:111], 0
    v_cvt_pk_bf16_f32 v105, v90, v91
    v_exp_f32 v94, v94
    v_mfma_f32_16x16x32_bf16 a[188:191], v[136:139], v[108:111], 0
    v_exp_f32 v95, v95
    v_add_f32 v24, v24, v92
    v_add_f32 v25, v25, v93
    v_mfma_f32_16x16x32_bf16 a[216:219], v[140:143], v[108:111], 0
    v_cvt_pk_bf16_f32 v106, v92, v93
    v_add_f32 v24, v24, v94
    v_add_f32 v25, v25, v95
    v_cvt_pk_bf16_f32 v107, v94, v95
    s_mov_b32 s22, 0
L_at_loop:
    v_mfma_f32_16x16x32_bf16 v[88:91], v[56:59], a[16:19], v[32:35]
    v_mfma_f32_16x16x32_bf16 v[88:91], v[60:63], a[20:23], v[88:91]
    v_exp_f32 v96, v96
    v_mfma_f32_16x16x32_bf16 v[88:91], v[64:67], a[24:27], v[88:91]
    v_exp_f32 v97, v97
    v_mfma_f32_16x16x32_bf16 v[88:91], v[68:71], a[28:31], v[88:91]
    v_exp_f32 v98, v98
    v_mfma_f32_16x16x32_bf16 v[92:95], v[84:87], a[28:31], v[32:35]
    v_exp_f32 v99, v99
    v_mfma_f32_16x16x32_bf16 v[92:95], v[80:83], a[24:27], v[92:95]
    v_add_f32 v12, v12, v96
    v_add_f32 v13, v13, v97
    v_mfma_f32_16x16x32_bf16 v[92:95], v[76:79], a[20:23], v[92:95]
    v_cvt_pk_bf16_f32 v108, v96, v97
    v_mfma_f32_16x16x32_bf16 v[92:95], v[72:75], a[16:19], v[92:95]
    v_exp_f32 v100, v100
    v_mfma_f32_16x16x32_bf16 v[168:171], v[112:115], v[104:107], v[168:171]
    ds_read_b64_tr_b16 v[112:113], v9 offset:8448
    ds_read_b64_tr_b16 v[114:115], v9 offset:8960
    v_exp_f32 v101, v101
    v_mfma_f32_16x16x32_bf16 v[196:199], v[116:119], v[104:107], v[196:199]
    ds_read_b64_tr_b16 v[116:117], v9 offset:8480
    ds_read_b64_tr_b16 v[118:119], v9 offset:8992
    v_add_f32 v12, v12, v98
    v_add_f32 v13, v13, v99
    v_mfma_f32_16x16x32_bf16 v[224:227], v[120:123], v[104:107], v[224:227]
    ds_read_b64_tr_b16 v[120:121], v9 offset:8512
    ds_read_b64_tr_b16 v[122:123], v9 offset:9024
    v_cvt_pk_bf16_f32 v109, v98, v99
    v_mfma_f32_16x16x32_bf16 v[252:255], v[124:127], v[104:107], v[252:255]
    ds_read_b64_tr_b16 v[124:125], v9 offset:8544
    ds_read_b64_tr_b16 v[126:127], v9 offset:9056
    v_exp_f32 v102, v102
    v_mfma_f32_16x16x32_bf16 a[136:139], v[128:131], v[104:107], a[136:139]
    ds_read_b64_tr_b16 v[128:129], v9 offset:8576
    ds_read_b64_tr_b16 v[130:131], v9 offset:9088
    v_exp_f32 v103, v103
    v_mfma_f32_16x16x32_bf16 a[164:167], v[132:135], v[104:107], a[164:167]
    ds_read_b64_tr_b16 v[132:133], v9 offset:8608
    ds_read_b64_tr_b16 v[134:135], v9 offset:9120
    v_add_f32 v12, v12, v100
    v_add_f32 v13, v13, v101
    v_mfma_f32_16x16x32_bf16 a[192:195], v[136:139], v[104:107], a[192:195]
    ds_read_b64_tr_b16 v[136:137], v9 offset:8640
    ds_read_b64_tr_b16 v[138:139], v9 offset:9152
    v_cvt_pk_bf16_f32 v110, v100, v101
    v_add_f32 v12, v12, v102
    v_mfma_f32_16x16x32_bf16 a[220:223], v[140:143], v[104:107], a[220:223]
    ds_read_b64_tr_b16 v[140:141], v9 offset:8672
    ds_read_b64_tr_b16 v[142:143], v9 offset:9184
    v_add_f32 v13, v13, v103
    v_cvt_pk_bf16_f32 v111, v102, v103
    v_mfma_f32_16x16x32_bf16 v[96:99], v[56:59], a[32:35], v[36:39]
    v_mfma_f32_16x16x32_bf16 v[96:99], v[60:63], a[36:39], v[96:99]
    s_add_u32 s29, s34, s100
    v_exp_f32 v88, v88
    v_mfma_f32_16x16x32_bf16 v[96:99], v[64:67], a[40:43], v[96:99]
    v_exp_f32 v89, v89
    v_mfma_f32_16x16x32_bf16 v[96:99], v[68:71], a[44:47], v[96:99]
    s_bfe_u32 s28, s29, 0x20003
    v_exp_f32 v90, v90
    v_mfma_f32_16x16x32_bf16 v[100:103], v[84:87], a[44:47], v[36:39]
    v_exp_f32 v91, v91
    v_mfma_f32_16x16x32_bf16 v[100:103], v[80:83], a[40:43], v[100:103]
    s_lshl_b32 s28, s28, 16
    v_add_f32 v14, v14, v88
    v_add_f32 v15, v15, v89
    v_mfma_f32_16x16x32_bf16 v[100:103], v[76:79], a[36:39], v[100:103]
    v_cvt_pk_bf16_f32 v104, v88, v89
    v_mfma_f32_16x16x32_bf16 v[100:103], v[72:75], a[32:35], v[100:103]
    v_exp_f32 v92, v92
    s_waitcnt lgkmcnt(0)
    v_mfma_f32_16x16x32_bf16 v[144:147], v[112:115], v[108:111], v[144:147]
    s_and_b32 s29, s29, 7
    v_exp_f32 v93, v93
    v_mfma_f32_16x16x32_bf16 v[172:175], v[116:119], v[108:111], v[172:175]
    v_add_f32 v14, v14, v90
    v_add_f32 v15, v15, v91
    v_mfma_f32_16x16x32_bf16 v[200:203], v[120:123], v[108:111], v[200:203]
    s_lshl_b32 s29, s29, 11
    v_cvt_pk_bf16_f32 v105, v90, v91
    v_mfma_f32_16x16x32_bf16 v[228:231], v[124:127], v[108:111], v[228:231]
    v_exp_f32 v94, v94
    v_mfma_f32_16x16x32_bf16 a[112:115], v[128:131], v[108:111], a[112:115]
    s_add_u32 s29, s28, s29
    v_exp_f32 v95, v95
    v_mfma_f32_16x16x32_bf16 a[140:143], v[132:135], v[108:111], a[140:143]
    v_add_f32 v14, v14, v92
    v_add_f32 v15, v15, v93
    v_mfma_f32_16x16x32_bf16 a[168:171], v[136:139], v[108:111], a[168:171]
    s_lshr_b32 s28, s34, 5
    v_cvt_pk_bf16_f32 v106, v92, v93
    v_add_f32 v14, v14, v94
    v_mfma_f32_16x16x32_bf16 a[196:199], v[140:143], v[108:111], a[196:199]
    v_add_f32 v15, v15, v95
    v_cvt_pk_bf16_f32 v107, v94, v95
    v_mfma_f32_16x16x32_bf16 v[88:91], v[56:59], a[48:51], v[40:43]
    v_mfma_f32_16x16x32_bf16 v[88:91], v[60:63], a[52:55], v[88:91]
    s_lshl_b32 s28, s28, 19
    v_exp_f32 v96, v96
    v_mfma_f32_16x16x32_bf16 v[88:91], v[64:67], a[56:59], v[88:91]
    v_exp_f32 v97, v97
    v_mfma_f32_16x16x32_bf16 v[88:91], v[68:71], a[60:63], v[88:91]
    s_add_u32 s49, s28, s29
    v_exp_f32 v98, v98
    v_mfma_f32_16x16x32_bf16 v[92:95], v[84:87], a[60:63], v[40:43]
    v_exp_f32 v99, v99
    v_mfma_f32_16x16x32_bf16 v[92:95], v[80:83], a[56:59], v[92:95]
    s_add_u32 m0, s33, 0
    v_add_f32 v16, v16, v96
    v_add_f32 v17, v17, v97
    v_mfma_f32_16x16x32_bf16 v[92:95], v[76:79], a[52:55], v[92:95]
    v_cvt_pk_bf16_f32 v108, v96, v97
    v_mfma_f32_16x16x32_bf16 v[92:95], v[72:75], a[48:51], v[92:95]
    v_exp_f32 v100, v100
    v_mfma_f32_16x16x32_bf16 v[148:151], v[112:115], v[104:107], v[148:151]
    s_add_u32 s34, s34, 1
    v_exp_f32 v101, v101
    v_mfma_f32_16x16x32_bf16 v[176:179], v[116:119], v[104:107], v[176:179]
    v_add_f32 v16, v16, v98
    v_add_f32 v17, v17, v99
    v_mfma_f32_16x16x32_bf16 v[204:207], v[120:123], v[104:107], v[204:207]
    buffer_load_dwordx4 v7, s[4:7], s49 offen offset:0 nt lds
    v_cvt_pk_bf16_f32 v109, v98, v99
    v_mfma_f32_16x16x32_bf16 v[232:235], v[124:127], v[104:107], v[232:235]
    v_exp_f32 v102, v102
    v_mfma_f32_16x16x32_bf16 a[116:119], v[128:131], v[104:107], a[116:119]
    s_add_u32 m0, m0, s96
    v_exp_f32 v103, v103
    v_mfma_f32_16x16x32_bf16 a[144:147], v[132:135], v[104:107], a[144:147]
    v_add_f32 v16, v16, v100
    v_add_f32 v17, v17, v101
    v_mfma_f32_16x16x32_bf16 a[172:175], v[136:139], v[104:107], a[172:175]
    buffer_load_dwordx4 v7, s[4:7], s49 offen offset:256 nt lds
    v_cvt_pk_bf16_f32 v110, v100, v101
    v_add_f32 v16, v16, v102
    v_mfma_f32_16x16x32_bf16 a[200:203], v[140:143], v[104:107], a[200:203]
    v_add_f32 v17, v17, v103
    v_cvt_pk_bf16_f32 v111, v102, v103
    v_mfma_f32_16x16x32_bf16 v[96:99], v[56:59], a[64:67], v[44:47]
    v_mfma_f32_16x16x32_bf16 v[96:99], v[60:63], a[68:71], v[96:99]
    s_add_u32 m0, m0, s97
    v_exp_f32 v88, v88
    v_mfma_f32_16x16x32_bf16 v[96:99], v[64:67], a[72:75], v[96:99]
    v_exp_f32 v89, v89
    v_mfma_f32_16x16x32_bf16 v[96:99], v[68:71], a[76:79], v[96:99]
    buffer_load_dwordx4 v7, s[4:7], s49 offen offset:512 nt lds
    v_exp_f32 v90, v90
    v_mfma_f32_16x16x32_bf16 v[100:103], v[84:87], a[76:79], v[44:47]
    v_exp_f32 v91, v91
    v_mfma_f32_16x16x32_bf16 v[100:103], v[80:83], a[72:75], v[100:103]
    s_add_u32 m0, m0, s96
    v_add_f32 v18, v18, v88
    v_add_f32 v19, v19, v89
    v_mfma_f32_16x16x32_bf16 v[100:103], v[76:79], a[68:71], v[100:103]
    v_cvt_pk_bf16_f32 v104, v88, v89
    v_mfma_f32_16x16x32_bf16 v[100:103], v[72:75], a[64:67], v[100:103]
    v_exp_f32 v92, v92
    v_mfma_f32_16x16x32_bf16 v[152:155], v[112:115], v[108:111], v[152:155]
    buffer_load_dwordx4 v7, s[4:7], s49 offen offset:768 nt lds
    v_exp_f32 v93, v93
    v_mfma_f32_16x16x32_bf16 v[180:183], v[116:119], v[108:111], v[180:183]
    v_add_f32 v18, v18, v90
    v_add_f32 v19, v19, v91
    v_mfma_f32_16x16x32_bf16 v[208:211], v[120:123], v[108:111], v[208:211]
    s_add_u32 m0, m0, s97
    v_cvt_pk_bf16_f32 v105, v90, v91
    v_mfma_f32_16x16x32_bf16 v[236:239], v[124:127], v[108:111], v[236:239]
    v_exp_f32 v94, v94
    v_mfma_f32_16x16x32_bf16 a[120:123], v[128:131], v[108:111], a[120:123]
    buffer_load_dwordx4 v7, s[4:7], s49 offen offset:1024 nt lds
    v_exp_f32 v95, v95
    v_mfma_f32_16x16x32_bf16 a[148:151], v[132:135], v[108:111], a[148:151]
    v_add_f32 v18, v18, v92
    v_add_f32 v19, v19, v93
    v_mfma_f32_16x16x32_bf16 a[176:179], v[136:139], v[108:111], a[176:179]
    s_add_u32 m0, m0, s96
    v_cvt_pk_bf16_f32 v106, v92, v93
    v_add_f32 v18, v18, v94
    v_mfma_f32_16x16x32_bf16 a[204:207], v[140:143], v[108:111], a[204:207]
    v_add_f32 v19, v19, v95
    v_cvt_pk_bf16_f32 v107, v94, v95
    v_mfma_f32_16x16x32_bf16 v[88:91], v[56:59], a[80:83], v[48:51]
    v_mfma_f32_16x16x32_bf16 v[88:91], v[60:63], a[84:87], v[88:91]
    buffer_load_dwordx4 v7, s[4:7], s49 offen offset:1280 nt lds
    v_exp_f32 v96, v96
    v_mfma_f32_16x16x32_bf16 v[88:91], v[64:67], a[88:91], v[88:91]
    v_exp_f32 v97, v97
    v_mfma_f32_16x16x32_bf16 v[88:91], v[68:71], a[92:95], v[88:91]
    s_add_u32 m0, m0, s97
    v_exp_f32 v98, v98
    v_mfma_f32_16x16x32_bf16 v[92:95], v[84:87], a[92:95], v[48:51]
    v_exp_f32 v99, v99
    v_mfma_f32_16x16x32_bf16 v[92:95], v[80:83], a[88:91], v[92:95]
    buffer_load_dwordx4 v7, s[4:7], s49 offen offset:1536 nt lds
    v_add_f32 v20, v20, v96
    v_add_f32 v21, v21, v97
    v_mfma_f32_16x16x32_bf16 v[92:95], v[76:79], a[84:87], v[92:95]
    v_cvt_pk_bf16_f32 v108, v96, v97
    v_mfma_f32_16x16x32_bf16 v[92:95], v[72:75], a[80:83], v[92:95]
    v_exp_f32 v100, v100
    v_mfma_f32_16x16x32_bf16 v[156:159], v[112:115], v[104:107], v[156:159]
    s_add_u32 m0, m0, s96
    v_exp_f32 v101, v101
    v_mfma_f32_16x16x32_bf16 v[184:187], v[116:119], v[104:107], v[184:187]
    v_add_f32 v20, v20, v98
    v_add_f32 v21, v21, v99
    v_mfma_f32_16x16x32_bf16 v[212:215], v[120:123], v[104:107], v[212:215]
    buffer_load_dwordx4 v7, s[4:7], s49 offen offset:1792 nt lds
    v_cvt_pk_bf16_f32 v109, v98, v99
    v_mfma_f32_16x16x32_bf16 v[240:243], v[124:127], v[104:107], v[240:243]
    v_exp_f32 v102, v102
    v_mfma_f32_16x16x32_bf16 a[124:127], v[128:131], v[104:107], a[124:127]
    v_exp_f32 v103, v103
    v_mfma_f32_16x16x32_bf16 a[152:155], v[132:135], v[104:107], a[152:155]
    v_add_f32 v20, v20, v100
    v_add_f32 v21, v21, v101
    v_mfma_f32_16x16x32_bf16 a[180:183], v[136:139], v[104:107], a[180:183]
    v_cvt_pk_bf16_f32 v110, v100, v101
    v_add_f32 v20, v20, v102
    v_mfma_f32_16x16x32_bf16 a[208:211], v[140:143], v[104:107], a[208:211]
    v_add_f32 v21, v21, v103
    v_cvt_pk_bf16_f32 v111, v102, v103
    s_cmp_eq_u32 s68, 0
    s_cbranch_scc0 L_bw1_3487
    s_waitcnt vmcnt(16) lgkmcnt(0)
L_bw2_3487:
    s_barrier
    v_mfma_f32_16x16x32_bf16 v[96:99], v[56:59], a[96:99], v[52:55]
    ds_read_b128 v[56:59], v8 offset:16896
    v_mfma_f32_16x16x32_bf16 v[96:99], v[60:63], a[100:103], v[96:99]
    ds_read_b128 v[60:63], v8 offset:16960
    v_exp_f32 v88, v88
    v_mfma_f32_16x16x32_bf16 v[96:99], v[64:67], a[104:107], v[96:99]
    ds_read_b128 v[64:67], v8 offset:17024
    v_exp_f32 v89, v89
    v_mfma_f32_16x16x32_bf16 v[96:99], v[68:71], a[108:111], v[96:99]
    ds_read_b128 v[68:71], v8 offset:17088
    v_exp_f32 v90, v90
    v_mfma_f32_16x16x32_bf16 v[100:103], v[84:87], a[108:111], v[52:55]
    ds_read_b128 v[84:87], v8 offset:17600
    v_exp_f32 v91, v91
    v_mfma_f32_16x16x32_bf16 v[100:103], v[80:83], a[104:107], v[100:103]
    ds_read_b128 v[80:83], v8 offset:17536
    v_add_f32 v22, v22, v88
    v_add_f32 v23, v23, v89
    v_mfma_f32_16x16x32_bf16 v[100:103], v[76:79], a[100:103], v[100:103]
    ds_read_b128 v[76:79], v8 offset:17472
    v_cvt_pk_bf16_f32 v104, v88, v89
    v_mfma_f32_16x16x32_bf16 v[100:103], v[72:75], a[96:99], v[100:103]
    ds_read_b128 v[72:75], v8 offset:17408
    v_exp_f32 v92, v92
    v_mfma_f32_16x16x32_bf16 v[160:163], v[112:115], v[108:111], v[160:163]
    v_exp_f32 v93, v93
    v_mfma_f32_16x16x32_bf16 v[188:191], v[116:119], v[108:111], v[188:191]
    v_add_f32 v22, v22, v90
    v_add_f32 v23, v23, v91
    v_mfma_f32_16x16x32_bf16 v[216:219], v[120:123], v[108:111], v[216:219]
    v_cvt_pk_bf16_f32 v105, v90, v91
    v_mfma_f32_16x16x32_bf16 v[244:247], v[124:127], v[108:111], v[244:247]
    v_exp_f32 v94, v94
    v_mfma_f32_16x16x32_bf16 a[128:131], v[128:131], v[108:111], a[128:131]
    v_exp_f32 v95, v95
    v_mfma_f32_16x16x32_bf16 a[156:159], v[132:135], v[108:111], a[156:159]
    v_add_f32 v22, v22, v92
    v_add_f32 v23, v23, v93
    v_mfma_f32_16x16x32_bf16 a[184:187], v[136:139], v[108:111], a[184:187]
    v_cvt_pk_bf16_f32 v106, v92, v93
    v_add_f32 v22, v22, v94
    v_mfma_f32_16x16x32_bf16 a[212:215], v[140:143], v[108:111], a[212:215]
    v_add_f32 v23, v23, v95
    v_cvt_pk_bf16_f32 v107, v94, v95
    s_waitcnt lgkmcnt(0)
    v_mfma_f32_16x16x32_bf16 v[88:91], v[56:59], a[0:3], v[28:31]
    v_mfma_f32_16x16x32_bf16 v[88:91], v[60:63], a[4:7], v[88:91]
    v_exp_f32 v96, v96
    v_mfma_f32_16x16x32_bf16 v[88:91], v[64:67], a[8:11], v[88:91]
    v_exp_f32 v97, v97
    v_mfma_f32_16x16x32_bf16 v[88:91], v[68:71], a[12:15], v[88:91]
    v_exp_f32 v98, v98
    v_mfma_f32_16x16x32_bf16 v[92:95], v[84:87], a[12:15], v[28:31]
    v_exp_f32 v99, v99
    v_mfma_f32_16x16x32_bf16 v[92:95], v[80:83], a[8:11], v[92:95]
    v_add_f32 v24, v24, v96
    v_add_f32 v25, v25, v97
    v_mfma_f32_16x16x32_bf16 v[92:95], v[76:79], a[4:7], v[92:95]
    v_cvt_pk_bf16_f32 v108, v96, v97
    v_mfma_f32_16x16x32_bf16 v[92:95], v[72:75], a[0:3], v[92:95]
    v_exp_f32 v100, v100
    v_mfma_f32_16x16x32_bf16 v[164:167], v[112:115], v[104:107], v[164:167]
    v_exp_f32 v101, v101
    v_mfma_f32_16x16x32_bf16 v[192:195], v[116:119], v[104:107], v[192:195]
    v_add_f32 v24, v24, v98
    v_add_f32 v25, v25, v99
    v_mfma_f32_16x16x32_bf16 v[220:223], v[120:123], v[104:107], v[220:223]
    v_cvt_pk_bf16_f32 v109, v98, v99
    v_mfma_f32_16x16x32_bf16 v[248:251], v[124:127], v[104:107], v[248:251]
    v_exp_f32 v102, v102
    v_mfma_f32_16x16x32_bf16 a[132:135], v[128:131], v[104:107], a[132:135]
    v_exp_f32 v103, v103
    v_mfma_f32_16x16x32_bf16 a[160:163], v[132:135], v[104:107], a[160:163]
    v_add_f32 v24, v24, v100
    v_add_f32 v25, v25, v101
    v_mfma_f32_16x16x32_bf16 a[188:191], v[136:139], v[104:107], a[188:191]
    v_cvt_pk_bf16_f32 v110, v100, v101
    v_add_f32 v24, v24, v102
    v_mfma_f32_16x16x32_bf16 a[216:219], v[140:143], v[104:107], a[216:219]
    v_add_f32 v25, v25, v103
    v_cvt_pk_bf16_f32 v111, v102, v103
    v_mfma_f32_16x16x32_bf16 v[96:99], v[56:59], a[16:19], v[32:35]
    v_mfma_f32_16x16x32_bf16 v[96:99], v[60:63], a[20:23], v[96:99]
    v_exp_f32 v88, v88
    v_mfma_f32_16x16x32_bf16 v[96:99], v[64:67], a[24:27], v[96:99]
    v_exp_f32 v89, v89
    v_mfma_f32_16x16x32_bf16 v[96:99], v[68:71], a[28:31], v[96:99]
    v_exp_f32 v90, v90
    v_mfma_f32_16x16x32_bf16 v[100:103], v[84:87], a[28:31], v[32:35]
    v_exp_f32 v91, v91
    v_mfma_f32_16x16x32_bf16 v[100:103], v[80:83], a[24:27], v[100:103]
    v_add_f32 v12, v12, v88
    v_add_f32 v13, v13, v89
    v_mfma_f32_16x16x32_bf16 v[100:103], v[76:79], a[20:23], v[100:103]
    v_cvt_pk_bf16_f32 v104, v88, v89
    v_mfma_f32_16x16x32_bf16 v[100:103], v[72:75], a[16:19], v[100:103]
    v_exp_f32 v92, v92
    v_mfma_f32_16x16x32_bf16 v[168:171], v[112:115], v[108:111], v[168:171]
    ds_read_b64_tr_b16 v[112:113], v9 offset:16896
    ds_read_b64_tr_b16 v[114:115], v9 offset:17408
    v_exp_f32 v93, v93
    v_mfma_f32_16x16x32_bf16 v[196:199], v[116:119], v[108:111], v[196:199]
    ds_read_b64_tr_b16 v[116:117], v9 offset:16928
    ds_read_b64_tr_b16 v[118:119], v9 offset:17440
    v_add_f32 v12, v12, v90
    v_add_f32 v13, v13, v91
    v_mfma_f32_16x16x32_bf16 v[224:227], v[120:123], v[108:111], v[224:227]
    ds_read_b64_tr_b16 v[120:121], v9 offset:16960
    ds_read_b64_tr_b16 v[122:123], v9 offset:17472
    v_cvt_pk_bf16_f32 v105, v90, v91
    v_mfma_f32_16x16x32_bf16 v[252:255], v[124:127], v[108:111], v[252:255]
    ds_read_b64_tr_b16 v[124:125], v9 offset:16992
    ds_read_b64_tr_b16 v[126:127], v9 offset:17504
    v_exp_f32 v94, v94
    v_mfma_f32_16x16x32_bf16 a[136:139], v[128:131], v[108:111], a[136:139]
    ds_read_b64_tr_b16 v[128:129], v9 offset:17024
    ds_read_b64_tr_b16 v[130:131], v9 offset:17536
    v_exp_f32 v95, v95
    v_mfma_f32_16x16x32_bf16 a[164:167], v[132:135], v[108:111], a[164:167]
    ds_read_b64_tr_b16 v[132:133], v9 offset:17056
    ds_read_b64_tr_b16 v[134:135], v9 offset:17568
    v_add_f32 v12, v12, v92
    v_add_f32 v13, v13, v93
    v_mfma_f32_16x16x32_bf16 a[192:195], v[136:139], v[108:111], a[192:195]
    ds_read_b64_tr_b16 v[136:137], v9 offset:17088
    ds_read_b64_tr_b16 v[138:139], v9 offset:17600
    v_cvt_pk_bf16_f32 v106, v92, v93
    v_add_f32 v12, v12, v94
    v_mfma_f32_16x16x32_bf16 a[220:223], v[140:143], v[108:111], a[220:223]
    ds_read_b64_tr_b16 v[140:141], v9 offset:17120
    ds_read_b64_tr_b16 v[142:143], v9 offset:17632
    v_add_f32 v13, v13, v95
    v_cvt_pk_bf16_f32 v107, v94, v95
    v_mfma_f32_16x16x32_bf16 v[88:91], v[56:59], a[32:35], v[36:39]
    v_mfma_f32_16x16x32_bf16 v[88:91], v[60:63], a[36:39], v[88:91]
    s_add_u32 s29, s34, s100
    v_exp_f32 v96, v96
    v_mfma_f32_16x16x32_bf16 v[88:91], v[64:67], a[40:43], v[88:91]
    v_exp_f32 v97, v97
    v_mfma_f32_16x16x32_bf16 v[88:91], v[68:71], a[44:47], v[88:91]
    s_bfe_u32 s28, s29, 0x20003
    v_exp_f32 v98, v98
    v_mfma_f32_16x16x32_bf16 v[92:95], v[84:87], a[44:47], v[36:39]
    v_exp_f32 v99, v99
    v_mfma_f32_16x16x32_bf16 v[92:95], v[80:83], a[40:43], v[92:95]
    s_lshl_b32 s28, s28, 16
    v_add_f32 v14, v14, v96
    v_add_f32 v15, v15, v97
    v_mfma_f32_16x16x32_bf16 v[92:95], v[76:79], a[36:39], v[92:95]
    v_cvt_pk_bf16_f32 v108, v96, v97
    v_mfma_f32_16x16x32_bf16 v[92:95], v[72:75], a[32:35], v[92:95]
    v_exp_f32 v100, v100
    s_waitcnt lgkmcnt(0)
    v_mfma_f32_16x16x32_bf16 v[144:147], v[112:115], v[104:107], v[144:147]
    s_and_b32 s29, s29, 7
    v_exp_f32 v101, v101
    v_mfma_f32_16x16x32_bf16 v[172:175], v[116:119], v[104:107], v[172:175]
    v_add_f32 v14, v14, v98
    v_add_f32 v15, v15, v99
    v_mfma_f32_16x16x32_bf16 v[200:203], v[120:123], v[104:107], v[200:203]
    s_lshl_b32 s29, s29, 11
    v_cvt_pk_bf16_f32 v109, v98, v99
    v_mfma_f32_16x16x32_bf16 v[228:231], v[124:127], v[104:107], v[228:231]
    v_exp_f32 v102, v102
    v_mfma_f32_16x16x32_bf16 a[112:115], v[128:131], v[104:107], a[112:115]
    s_add_u32 s29, s28, s29
    v_exp_f32 v103, v103
    v_mfma_f32_16x16x32_bf16 a[140:143], v[132:135], v[104:107], a[140:143]
    v_add_f32 v14, v14, v100
    v_add_f32 v15, v15, v101
    v_mfma_f32_16x16x32_bf16 a[168:171], v[136:139], v[104:107], a[168:171]
    s_lshr_b32 s28, s34, 5
    v_cvt_pk_bf16_f32 v110, v100, v101
    v_add_f32 v14, v14, v102
    v_mfma_f32_16x16x32_bf16 a[196:199], v[140:143], v[104:107], a[196:199]
    v_add_f32 v15, v15, v103
    v_cvt_pk_bf16_f32 v111, v102, v103
    v_mfma_f32_16x16x32_bf16 v[96:99], v[56:59], a[48:51], v[40:43]
    v_mfma_f32_16x16x32_bf16 v[96:99], v[60:63], a[52:55], v[96:99]
    s_lshl_b32 s28, s28, 19
    v_exp_f32 v88, v88
    v_mfma_f32_16x16x32_bf16 v[96:99], v[64:67], a[56:59], v[96:99]
    v_exp_f32 v89, v89
    v_mfma_f32_16x16x32_bf16 v[96:99], v[68:71], a[60:63], v[96:99]
    s_add_u32 s49, s28, s29
    v_exp_f32 v90, v90
    v_mfma_f32_16x16x32_bf16 v[100:103], v[84:87], a[60:63], v[40:43]
    v_exp_f32 v91, v91
    v_mfma_f32_16x16x32_bf16 v[100:103], v[80:83], a[56:59], v[100:103]
    s_add_u32 m0, s33, 8448
    v_add_f32 v16, v16, v88
    v_add_f32 v17, v17, v89
    v_mfma_f32_16x16x32_bf16 v[100:103], v[76:79], a[52:55], v[100:103]
    v_cvt_pk_bf16_f32 v104, v88, v89
    v_mfma_f32_16x16x32_bf16 v[100:103], v[72:75], a[48:51], v[100:103]
    v_exp_f32 v92, v92
    v_mfma_f32_16x16x32_bf16 v[148:151], v[112:115], v[108:111], v[148:151]
    s_add_u32 s34, s34, 1
    v_exp_f32 v93, v93
    v_mfma_f32_16x16x32_bf16 v[176:179], v[116:119], v[108:111], v[176:179]
    v_add_f32 v16, v16, v90
    v_add_f32 v17, v17, v91
    v_mfma_f32_16x16x32_bf16 v[204:207], v[120:123], v[108:111], v[204:207]
    buffer_load_dwordx4 v7, s[4:7], s49 offen offset:0 nt lds
    v_cvt_pk_bf16_f32 v105, v90, v91
    v_mfma_f32_16x16x32_bf16 v[232:235], v[124:127], v[108:111], v[232:235]
    v_exp_f32 v94, v94
    v_mfma_f32_16x16x32_bf16 a[116:119], v[128:131], v[108:111], a[116:119]
    s_add_u32 m0, m0, s96
    v_exp_f32 v95, v95
    v_mfma_f32_16x16x32_bf16 a[144:147], v[132:135], v[108:111], a[144:147]
    v_add_f32 v16, v16, v92
    v_add_f32 v17, v17, v93
    v_mfma_f32_16x16x32_bf16 a[172:175], v[136:139], v[108:111], a[172:175]
    buffer_load_dwordx4 v7, s[4:7], s49 offen offset:256 nt lds
    v_cvt_pk_bf16_f32 v106, v92, v93
    v_add_f32 v16, v16, v94
    v_mfma_f32_16x16x32_bf16 a[200:203], v[140:143], v[108:111], a[200:203]
    v_add_f32 v17, v17, v95
    v_cvt_pk_bf16_f32 v107, v94, v95
    v_mfma_f32_16x16x32_bf16 v[88:91], v[56:59], a[64:67], v[44:47]
    v_mfma_f32_16x16x32_bf16 v[88:91], v[60:63], a[68:71], v[88:91]
    s_add_u32 m0, m0, s97
    v_exp_f32 v96, v96
    v_mfma_f32_16x16x32_bf16 v[88:91], v[64:67], a[72:75], v[88:91]
    v_exp_f32 v97, v97
    v_mfma_f32_16x16x32_bf16 v[88:91], v[68:71], a[76:79], v[88:91]
    buffer_load_dwordx4 v7, s[4:7], s49 offen offset:512 nt lds
    v_exp_f32 v98, v98
    v_mfma_f32_16x16x32_bf16 v[92:95], v[84:87], a[76:79], v[44:47]
    v_exp_f32 v99, v99
    v_mfma_f32_16x16x32_bf16 v[92:95], v[80:83], a[72:75], v[92:95]
    s_add_u32 m0, m0, s96
    v_add_f32 v18, v18, v96
    v_add_f32 v19, v19, v97
    v_mfma_f32_16x16x32_bf16 v[92:95], v[76:79], a[68:71], v[92:95]
    v_cvt_pk_bf16_f32 v108, v96, v97
    v_mfma_f32_16x16x32_bf16 v[92:95], v[72:75], a[64:67], v[92:95]
    v_exp_f32 v100, v100
    v_mfma_f32_16x16x32_bf16 v[152:155], v[112:115], v[104:107], v[152:155]
    buffer_load_dwordx4 v7, s[4:7], s49 offen offset:768 nt lds
    v_exp_f32 v101, v101
    v_mfma_f32_16x16x32_bf16 v[180:183], v[116:119], v[104:107], v[180:183]
    v_add_f32 v18, v18, v98
    v_add_f32 v19, v19, v99
    v_mfma_f32_16x16x32_bf16 v[208:211], v[120:123], v[104:107], v[208:211]
    s_add_u32 m0, m0, s97
    v_cvt_pk_bf16_f32 v109, v98, v99
    v_mfma_f32_16x16x32_bf16 v[236:239], v[124:127], v[104:107], v[236:239]
    v_exp_f32 v102, v102
    v_mfma_f32_16x16x32_bf16 a[120:123], v[128:131], v[104:107], a[120:123]
    buffer_load_dwordx4 v7, s[4:7], s49 offen offset:1024 nt lds
    v_exp_f32 v103, v103
    v_mfma_f32_16x16x32_bf16 a[148:151], v[132:135], v[104:107], a[148:151]
    v_add_f32 v18, v18, v100
    v_add_f32 v19, v19, v101
    v_mfma_f32_16x16x32_bf16 a[176:179], v[136:139], v[104:107], a[176:179]
    s_add_u32 m0, m0, s96
    v_cvt_pk_bf16_f32 v110, v100, v101
    v_add_f32 v18, v18, v102
    v_mfma_f32_16x16x32_bf16 a[204:207], v[140:143], v[104:107], a[204:207]
    v_add_f32 v19, v19, v103
    v_cvt_pk_bf16_f32 v111, v102, v103
    v_mfma_f32_16x16x32_bf16 v[96:99], v[56:59], a[80:83], v[48:51]
    v_mfma_f32_16x16x32_bf16 v[96:99], v[60:63], a[84:87], v[96:99]
    buffer_load_dwordx4 v7, s[4:7], s49 offen offset:1280 nt lds
    v_exp_f32 v88, v88
    v_mfma_f32_16x16x32_bf16 v[96:99], v[64:67], a[88:91], v[96:99]
    v_exp_f32 v89, v89
    v_mfma_f32_16x16x32_bf16 v[96:99], v[68:71], a[92:95], v[96:99]
    s_add_u32 m0, m0, s97
    v_exp_f32 v90, v90
    v_mfma_f32_16x16x32_bf16 v[100:103], v[84:87], a[92:95], v[48:51]
    v_exp_f32 v91, v91
    v_mfma_f32_16x16x32_bf16 v[100:103], v[80:83], a[88:91], v[100:103]
    buffer_load_dwordx4 v7, s[4:7], s49 offen offset:1536 nt lds
    v_add_f32 v20, v20, v88
    v_add_f32 v21, v21, v89
    v_mfma_f32_16x16x32_bf16 v[100:103], v[76:79], a[84:87], v[100:103]
    v_cvt_pk_bf16_f32 v104, v88, v89
    v_mfma_f32_16x16x32_bf16 v[100:103], v[72:75], a[80:83], v[100:103]
    v_exp_f32 v92, v92
    v_mfma_f32_16x16x32_bf16 v[156:159], v[112:115], v[108:111], v[156:159]
    s_add_u32 m0, m0, s96
    v_exp_f32 v93, v93
    v_mfma_f32_16x16x32_bf16 v[184:187], v[116:119], v[108:111], v[184:187]
    v_add_f32 v20, v20, v90
    v_add_f32 v21, v21, v91
    v_mfma_f32_16x16x32_bf16 v[212:215], v[120:123], v[108:111], v[212:215]
    buffer_load_dwordx4 v7, s[4:7], s49 offen offset:1792 nt lds
    v_cvt_pk_bf16_f32 v105, v90, v91
    v_mfma_f32_16x16x32_bf16 v[240:243], v[124:127], v[108:111], v[240:243]
    v_exp_f32 v94, v94
    v_mfma_f32_16x16x32_bf16 a[124:127], v[128:131], v[108:111], a[124:127]
    v_exp_f32 v95, v95
    v_mfma_f32_16x16x32_bf16 a[152:155], v[132:135], v[108:111], a[152:155]
    v_add_f32 v20, v20, v92
    v_add_f32 v21, v21, v93
    v_mfma_f32_16x16x32_bf16 a[180:183], v[136:139], v[108:111], a[180:183]
    v_cvt_pk_bf16_f32 v106, v92, v93
    v_add_f32 v20, v20, v94
    v_mfma_f32_16x16x32_bf16 a[208:211], v[140:143], v[108:111], a[208:211]
    v_add_f32 v21, v21, v95
    v_cvt_pk_bf16_f32 v107, v94, v95
    s_cmp_eq_u32 s68, 0
    s_cbranch_scc0 L_bw1_3796
    s_waitcnt vmcnt(16) lgkmcnt(0)
L_bw2_3796:
    s_barrier
    v_mfma_f32_16x16x32_bf16 v[88:91], v[56:59], a[96:99], v[52:55]
    ds_read_b128 v[56:59], v8 offset:25344
    v_mfma_f32_16x16x32_bf16 v[88:91], v[60:63], a[100:103], v[88:91]
    ds_read_b128 v[60:63], v8 offset:25408
    v_exp_f32 v96, v96
    v_mfma_f32_16x16x32_bf16 v[88:91], v[64:67], a[104:107], v[88:91]
    ds_read_b128 v[64:67], v8 offset:25472
    v_exp_f32 v97, v97
    v_mfma_f32_16x16x32_bf16 v[88:91], v[68:71], a[108:111], v[88:91]
    ds_read_b128 v[68:71], v8 offset:25536
    v_exp_f32 v98, v98
    v_mfma_f32_16x16x32_bf16 v[92:95], v[84:87], a[108:111], v[52:55]
    ds_read_b128 v[84:87], v8 offset:26048
    v_exp_f32 v99, v99
    v_mfma_f32_16x16x32_bf16 v[92:95], v[80:83], a[104:107], v[92:95]
    ds_read_b128 v[80:83], v8 offset:25984
    v_add_f32 v22, v22, v96
    v_add_f32 v23, v23, v97
    v_mfma_f32_16x16x32_bf16 v[92:95], v[76:79], a[100:103], v[92:95]
    ds_read_b128 v[76:79], v8 offset:25920
    v_cvt_pk_bf16_f32 v108, v96, v97
    v_mfma_f32_16x16x32_bf16 v[92:95], v[72:75], a[96:99], v[92:95]
    ds_read_b128 v[72:75], v8 offset:25856
    v_exp_f32 v100, v100
    v_mfma_f32_16x16x32_bf16 v[160:163], v[112:115], v[104:107], v[160:163]
    v_exp_f32 v101, v101
    v_mfma_f32_16x16x32_bf16 v[188:191], v[116:119], v[104:107], v[188:191]
    v_add_f32 v22, v22, v98
    v_add_f32 v23, v23, v99
    v_mfma_f32_16x16x32_bf16 v[216:219], v[120:123], v[104:107], v[216:219]
    v_cvt_pk_bf16_f32 v109, v98, v99
    v_mfma_f32_16x16x32_bf16 v[244:247], v[124:127], v[104:107], v[244:247]
    v_exp_f32 v102, v102
    v_mfma_f32_16x16x32_bf16 a[128:131], v[128:131], v[104:107], a[128:131]
    v_exp_f32 v103, v103
    v_mfma_f32_16x16x32_bf16 a[156:159], v[132:135], v[104:107], a[156:159]
    v_add_f32 v22, v22, v100
    v_add_f32 v23, v23, v101
    v_mfma_f32_16x16x32_bf16 a[184:187], v[136:139], v[104:107], a[184:187]
    v_cvt_pk_bf16_f32 v110, v100, v101
    v_add_f32 v22, v22, v102
    v_mfma_f32_16x16x32_bf16 a[212:215], v[140:143], v[104:107], a[212:215]
    v_add_f32 v23, v23, v103
    v_cvt_pk_bf16_f32 v111, v102, v103
    s_waitcnt lgkmcnt(0)
    v_mfma_f32_16x16x32_bf16 v[96:99], v[56:59], a[0:3], v[28:31]
    v_mfma_f32_16x16x32_bf16 v[96:99], v[60:63], a[4:7], v[96:99]
    v_exp_f32 v88, v88
    v_mfma_f32_16x16x32_bf16 v[96:99], v[64:67], a[8:11], v[96:99]
    v_exp_f32 v89, v89
    v_mfma_f32_16x16x32_bf16 v[96:99], v[68:71], a[12:15], v[96:99]
    v_exp_f32 v90, v90
    v_mfma_f32_16x16x32_bf16 v[100:103], v[84:87], a[12:15], v[28:31]
    v_exp_f32 v91, v91
    v_mfma_f32_16x16x32_bf16 v[100:103], v[80:83], a[8:11], v[100:103]
    v_add_f32 v24, v24, v88
    v_add_f32 v25, v25, v89
    v_mfma_f32_16x16x32_bf16 v[100:103], v[76:79], a[4:7], v[100:103]
    v_cvt_pk_bf16_f32 v104, v88, v89
    v_mfma_f32_16x16x32_bf16 v[100:103], v[72:75], a[0:3], v[100:103]
    v_exp_f32 v92, v92
    v_mfma_f32_16x16x32_bf16 v[164:167], v[112:115], v[108:111], v[164:167]
    v_exp_f32 v93, v93
    v_mfma_f32_16x16x32_bf16 v[192:195], v[116:119], v[108:111], v[192:195]
    v_add_f32 v24, v24, v90
    v_add_f32 v25, v25, v91
    v_mfma_f32_16x16x32_bf16 v[220:223], v[120:123], v[108:111], v[220:223]
    v_cvt_pk_bf16_f32 v105, v90, v91
    v_mfma_f32_16x16x32_bf16 v[248:251], v[124:127], v[108:111], v[248:251]
    v_exp_f32 v94, v94
    v_mfma_f32_16x16x32_bf16 a[132:135], v[128:131], v[108:111], a[132:135]
    v_exp_f32 v95, v95
    v_mfma_f32_16x16x32_bf16 a[160:163], v[132:135], v[108:111], a[160:163]
    v_add_f32 v24, v24, v92
    v_add_f32 v25, v25, v93
    v_mfma_f32_16x16x32_bf16 a[188:191], v[136:139], v[108:111], a[188:191]
    v_cvt_pk_bf16_f32 v106, v92, v93
    v_add_f32 v24, v24, v94
    v_mfma_f32_16x16x32_bf16 a[216:219], v[140:143], v[108:111], a[216:219]
    v_add_f32 v25, v25, v95
    v_cvt_pk_bf16_f32 v107, v94, v95
    v_mfma_f32_16x16x32_bf16 v[88:91], v[56:59], a[16:19], v[32:35]
    v_mfma_f32_16x16x32_bf16 v[88:91], v[60:63], a[20:23], v[88:91]
    v_exp_f32 v96, v96
    v_mfma_f32_16x16x32_bf16 v[88:91], v[64:67], a[24:27], v[88:91]
    v_exp_f32 v97, v97
    v_mfma_f32_16x16x32_bf16 v[88:91], v[68:71], a[28:31], v[88:91]
    v_exp_f32 v98, v98
    v_mfma_f32_16x16x32_bf16 v[92:95], v[84:87], a[28:31], v[32:35]
    v_exp_f32 v99, v99
    v_mfma_f32_16x16x32_bf16 v[92:95], v[80:83], a[24:27], v[92:95]
    v_add_f32 v12, v12, v96
    v_add_f32 v13, v13, v97
    v_mfma_f32_16x16x32_bf16 v[92:95], v[76:79], a[20:23], v[92:95]
    v_cvt_pk_bf16_f32 v108, v96, v97
    v_mfma_f32_16x16x32_bf16 v[92:95], v[72:75], a[16:19], v[92:95]
    v_exp_f32 v100, v100
    v_mfma_f32_16x16x32_bf16 v[168:171], v[112:115], v[104:107], v[168:171]
    ds_read_b64_tr_b16 v[112:113], v9 offset:25344
    ds_read_b64_tr_b16 v[114:115], v9 offset:25856
    v_exp_f32 v101, v101
    v_mfma_f32_16x16x32_bf16 v[196:199], v[116:119], v[104:107], v[196:199]
    ds_read_b64_tr_b16 v[116:117], v9 offset:25376
    ds_read_b64_tr_b16 v[118:119], v9 offset:25888
    v_add_f32 v12, v12, v98
    v_add_f32 v13, v13, v99
    v_mfma_f32_16x16x32_bf16 v[224:227], v[120:123], v[104:107], v[224:227]
    ds_read_b64_tr_b16 v[120:121], v9 offset:25408
    ds_read_b64_tr_b16 v[122:123], v9 offset:25920
    v_cvt_pk_bf16_f32 v109, v98, v99
    v_mfma_f32_16x16x32_bf16 v[252:255], v[124:127], v[104:107], v[252:255]
    ds_read_b64_tr_b16 v[124:125], v9 offset:25440
    ds_read_b64_tr_b16 v[126:127], v9 offset:25952
    v_exp_f32 v102, v102
    v_mfma_f32_16x16x32_bf16 a[136:139], v[128:131], v[104:107], a[136:139]
    ds_read_b64_tr_b16 v[128:129], v9 offset:25472
    ds_read_b64_tr_b16 v[130:131], v9 offset:25984
    v_exp_f32 v103, v103
    v_mfma_f32_16x16x32_bf16 a[164:167], v[132:135], v[104:107], a[164:167]
    ds_read_b64_tr_b16 v[132:133], v9 offset:25504
    ds_read_b64_tr_b16 v[134:135], v9 offset:26016
    v_add_f32 v12, v12, v100
    v_add_f32 v13, v13, v101
    v_mfma_f32_16x16x32_bf16 a[192:195], v[136:139], v[104:107], a[192:195]
    ds_read_b64_tr_b16 v[136:137], v9 offset:25536
    ds_read_b64_tr_b16 v[138:139], v9 offset:26048
    v_cvt_pk_bf16_f32 v110, v100, v101
    v_add_f32 v12, v12, v102
    v_mfma_f32_16x16x32_bf16 a[220:223], v[140:143], v[104:107], a[220:223]
    ds_read_b64_tr_b16 v[140:141], v9 offset:25568
    ds_read_b64_tr_b16 v[142:143], v9 offset:26080
    v_add_f32 v13, v13, v103
    v_cvt_pk_bf16_f32 v111, v102, v103
    v_mfma_f32_16x16x32_bf16 v[96:99], v[56:59], a[32:35], v[36:39]
    v_mfma_f32_16x16x32_bf16 v[96:99], v[60:63], a[36:39], v[96:99]
    s_add_u32 s29, s34, s100
    v_exp_f32 v88, v88
    v_mfma_f32_16x16x32_bf16 v[96:99], v[64:67], a[40:43], v[96:99]
    v_exp_f32 v89, v89
    v_mfma_f32_16x16x32_bf16 v[96:99], v[68:71], a[44:47], v[96:99]
    s_bfe_u32 s28, s29, 0x20003
    v_exp_f32 v90, v90
    v_mfma_f32_16x16x32_bf16 v[100:103], v[84:87], a[44:47], v[36:39]
    v_exp_f32 v91, v91
    v_mfma_f32_16x16x32_bf16 v[100:103], v[80:83], a[40:43], v[100:103]
    s_lshl_b32 s28, s28, 16
    v_add_f32 v14, v14, v88
    v_add_f32 v15, v15, v89
    v_mfma_f32_16x16x32_bf16 v[100:103], v[76:79], a[36:39], v[100:103]
    v_cvt_pk_bf16_f32 v104, v88, v89
    v_mfma_f32_16x16x32_bf16 v[100:103], v[72:75], a[32:35], v[100:103]
    v_exp_f32 v92, v92
    s_waitcnt lgkmcnt(0)
    v_mfma_f32_16x16x32_bf16 v[144:147], v[112:115], v[108:111], v[144:147]
    s_and_b32 s29, s29, 7
    v_exp_f32 v93, v93
    v_mfma_f32_16x16x32_bf16 v[172:175], v[116:119], v[108:111], v[172:175]
    v_add_f32 v14, v14, v90
    v_add_f32 v15, v15, v91
    v_mfma_f32_16x16x32_bf16 v[200:203], v[120:123], v[108:111], v[200:203]
    s_lshl_b32 s29, s29, 11
    v_cvt_pk_bf16_f32 v105, v90, v91
    v_mfma_f32_16x16x32_bf16 v[228:231], v[124:127], v[108:111], v[228:231]
    v_exp_f32 v94, v94
    v_mfma_f32_16x16x32_bf16 a[112:115], v[128:131], v[108:111], a[112:115]
    s_add_u32 s29, s28, s29
    v_exp_f32 v95, v95
    v_mfma_f32_16x16x32_bf16 a[140:143], v[132:135], v[108:111], a[140:143]
    v_add_f32 v14, v14, v92
    v_add_f32 v15, v15, v93
    v_mfma_f32_16x16x32_bf16 a[168:171], v[136:139], v[108:111], a[168:171]
    s_lshr_b32 s28, s34, 5
    v_cvt_pk_bf16_f32 v106, v92, v93
    v_add_f32 v14, v14, v94
    v_mfma_f32_16x16x32_bf16 a[196:199], v[140:143], v[108:111], a[196:199]
    v_add_f32 v15, v15, v95
    v_cvt_pk_bf16_f32 v107, v94, v95
    v_mfma_f32_16x16x32_bf16 v[88:91], v[56:59], a[48:51], v[40:43]
    v_mfma_f32_16x16x32_bf16 v[88:91], v[60:63], a[52:55], v[88:91]
    s_lshl_b32 s28, s28, 19
    v_exp_f32 v96, v96
    v_mfma_f32_16x16x32_bf16 v[88:91], v[64:67], a[56:59], v[88:91]
    v_exp_f32 v97, v97
    v_mfma_f32_16x16x32_bf16 v[88:91], v[68:71], a[60:63], v[88:91]
    s_add_u32 s49, s28, s29
    v_exp_f32 v98, v98
    v_mfma_f32_16x16x32_bf16 v[92:95], v[84:87], a[60:63], v[40:43]
    v_exp_f32 v99, v99
    v_mfma_f32_16x16x32_bf16 v[92:95], v[80:83], a[56:59], v[92:95]
    s_add_u32 m0, s33, 16896
    v_add_f32 v16, v16, v96
    v_add_f32 v17, v17, v97
    v_mfma_f32_16x16x32_bf16 v[92:95], v[76:79], a[52:55], v[92:95]
    v_cvt_pk_bf16_f32 v108, v96, v97
    v_mfma_f32_16x16x32_bf16 v[92:95], v[72:75], a[48:51], v[92:95]
    v_exp_f32 v100, v100
    v_mfma_f32_16x16x32_bf16 v[148:151], v[112:115], v[104:107], v[148:151]
    s_add_u32 s34, s34, 1
    v_exp_f32 v101, v101
    v_mfma_f32_16x16x32_bf16 v[176:179], v[116:119], v[104:107], v[176:179]
    v_add_f32 v16, v16, v98
    v_add_f32 v17, v17, v99
    v_mfma_f32_16x16x32_bf16 v[204:207], v[120:123], v[104:107], v[204:207]
    buffer_load_dwordx4 v7, s[4:7], s49 offen offset:0 nt lds
    v_cvt_pk_bf16_f32 v109, v98, v99
    v_mfma_f32_16x16x32_bf16 v[232:235], v[124:127], v[104:107], v[232:235]
    v_exp_f32 v102, v102
    v_mfma_f32_16x16x32_bf16 a[116:119], v[128:131], v[104:107], a[116:119]
    s_add_u32 m0, m0, s96
    v_exp_f32 v103, v103
    v_mfma_f32_16x16x32_bf16 a[144:147], v[132:135], v[104:107], a[144:147]
    v_add_f32 v16, v16, v100
    v_add_f32 v17, v17, v101
    v_mfma_f32_16x16x32_bf16 a[172:175], v[136:139], v[104:107], a[172:175]
    buffer_load_dwordx4 v7, s[4:7], s49 offen offset:256 nt lds
    v_cvt_pk_bf16_f32 v110, v100, v101
    v_add_f32 v16, v16, v102
    v_mfma_f32_16x16x32_bf16 a[200:203], v[140:143], v[104:107], a[200:203]
    v_add_f32 v17, v17, v103
    v_cvt_pk_bf16_f32 v111, v102, v103
    v_mfma_f32_16x16x32_bf16 v[96:99], v[56:59], a[64:67], v[44:47]
    v_mfma_f32_16x16x32_bf16 v[96:99], v[60:63], a[68:71], v[96:99]
    s_add_u32 m0, m0, s97
    v_exp_f32 v88, v88
    v_mfma_f32_16x16x32_bf16 v[96:99], v[64:67], a[72:75], v[96:99]
    v_exp_f32 v89, v89
    v_mfma_f32_16x16x32_bf16 v[96:99], v[68:71], a[76:79], v[96:99]
    buffer_load_dwordx4 v7, s[4:7], s49 offen offset:512 nt lds
    v_exp_f32 v90, v90
    v_mfma_f32_16x16x32_bf16 v[100:103], v[84:87], a[76:79], v[44:47]
    v_exp_f32 v91, v91
    v_mfma_f32_16x16x32_bf16 v[100:103], v[80:83], a[72:75], v[100:103]
    s_add_u32 m0, m0, s96
    v_add_f32 v18, v18, v88
    v_add_f32 v19, v19, v89
    v_mfma_f32_16x16x32_bf16 v[100:103], v[76:79], a[68:71], v[100:103]
    v_cvt_pk_bf16_f32 v104, v88, v89
    v_mfma_f32_16x16x32_bf16 v[100:103], v[72:75], a[64:67], v[100:103]
    v_exp_f32 v92, v92
    v_mfma_f32_16x16x32_bf16 v[152:155], v[112:115], v[108:111], v[152:155]
    buffer_load_dwordx4 v7, s[4:7], s49 offen offset:768 nt lds
    v_exp_f32 v93, v93
    v_mfma_f32_16x16x32_bf16 v[180:183], v[116:119], v[108:111], v[180:183]
    v_add_f32 v18, v18, v90
    v_add_f32 v19, v19, v91
    v_mfma_f32_16x16x32_bf16 v[208:211], v[120:123], v[108:111], v[208:211]
    s_add_u32 m0, m0, s97
    v_cvt_pk_bf16_f32 v105, v90, v91
    v_mfma_f32_16x16x32_bf16 v[236:239], v[124:127], v[108:111], v[236:239]
    v_exp_f32 v94, v94
    v_mfma_f32_16x16x32_bf16 a[120:123], v[128:131], v[108:111], a[120:123]
    buffer_load_dwordx4 v7, s[4:7], s49 offen offset:1024 nt lds
    v_exp_f32 v95, v95
    v_mfma_f32_16x16x32_bf16 a[148:151], v[132:135], v[108:111], a[148:151]
    v_add_f32 v18, v18, v92
    v_add_f32 v19, v19, v93
    v_mfma_f32_16x16x32_bf16 a[176:179], v[136:139], v[108:111], a[176:179]
    s_add_u32 m0, m0, s96
    v_cvt_pk_bf16_f32 v106, v92, v93
    v_add_f32 v18, v18, v94
    v_mfma_f32_16x16x32_bf16 a[204:207], v[140:143], v[108:111], a[204:207]
    v_add_f32 v19, v19, v95
    v_cvt_pk_bf16_f32 v107, v94, v95
    v_mfma_f32_16x16x32_bf16 v[88:91], v[56:59], a[80:83], v[48:51]
    v_mfma_f32_16x16x32_bf16 v[88:91], v[60:63], a[84:87], v[88:91]
    buffer_load_dwordx4 v7, s[4:7], s49 offen offset:1280 nt lds
    v_exp_f32 v96, v96
    v_mfma_f32_16x16x32_bf16 v[88:91], v[64:67], a[88:91], v[88:91]
    v_exp_f32 v97, v97
    v_mfma_f32_16x16x32_bf16 v[88:91], v[68:71], a[92:95], v[88:91]
    s_add_u32 m0, m0, s97
    v_exp_f32 v98, v98
    v_mfma_f32_16x16x32_bf16 v[92:95], v[84:87], a[92:95], v[48:51]
    v_exp_f32 v99, v99
    v_mfma_f32_16x16x32_bf16 v[92:95], v[80:83], a[88:91], v[92:95]
    buffer_load_dwordx4 v7, s[4:7], s49 offen offset:1536 nt lds
    v_add_f32 v20, v20, v96
    v_add_f32 v21, v21, v97
    v_mfma_f32_16x16x32_bf16 v[92:95], v[76:79], a[84:87], v[92:95]
    v_cvt_pk_bf16_f32 v108, v96, v97
    v_mfma_f32_16x16x32_bf16 v[92:95], v[72:75], a[80:83], v[92:95]
    v_exp_f32 v100, v100
    v_mfma_f32_16x16x32_bf16 v[156:159], v[112:115], v[104:107], v[156:159]
    s_add_u32 m0, m0, s96
    v_exp_f32 v101, v101
    v_mfma_f32_16x16x32_bf16 v[184:187], v[116:119], v[104:107], v[184:187]
    v_add_f32 v20, v20, v98
    v_add_f32 v21, v21, v99
    v_mfma_f32_16x16x32_bf16 v[212:215], v[120:123], v[104:107], v[212:215]
    buffer_load_dwordx4 v7, s[4:7], s49 offen offset:1792 nt lds
    v_cvt_pk_bf16_f32 v109, v98, v99
    v_mfma_f32_16x16x32_bf16 v[240:243], v[124:127], v[104:107], v[240:243]
    v_exp_f32 v102, v102
    v_mfma_f32_16x16x32_bf16 a[124:127], v[128:131], v[104:107], a[124:127]
    v_exp_f32 v103, v103
    v_mfma_f32_16x16x32_bf16 a[152:155], v[132:135], v[104:107], a[152:155]
    v_add_f32 v20, v20, v100
    v_add_f32 v21, v21, v101
    v_mfma_f32_16x16x32_bf16 a[180:183], v[136:139], v[104:107], a[180:183]
    v_cvt_pk_bf16_f32 v110, v100, v101
    v_add_f32 v20, v20, v102
    v_mfma_f32_16x16x32_bf16 a[208:211], v[140:143], v[104:107], a[208:211]
    v_add_f32 v21, v21, v103
    v_cvt_pk_bf16_f32 v111, v102, v103
    s_waitcnt vmcnt(16) lgkmcnt(0)
    s_barrier
    v_mfma_f32_16x16x32_bf16 v[96:99], v[56:59], a[96:99], v[52:55]
    ds_read_b128 v[56:59], v8 offset:0
    v_mfma_f32_16x16x32_bf16 v[96:99], v[60:63], a[100:103], v[96:99]
    ds_read_b128 v[60:63], v8 offset:64
    v_exp_f32 v88, v88
    v_mfma_f32_16x16x32_bf16 v[96:99], v[64:67], a[104:107], v[96:99]
    ds_read_b128 v[64:67], v8 offset:128
    v_exp_f32 v89, v89
    v_mfma_f32_16x16x32_bf16 v[96:99], v[68:71], a[108:111], v[96:99]
    ds_read_b128 v[68:71], v8 offset:192
    v_exp_f32 v90, v90
    v_mfma_f32_16x16x32_bf16 v[100:103], v[84:87], a[108:111], v[52:55]
    ds_read_b128 v[84:87], v8 offset:704
    v_exp_f32 v91, v91
    v_mfma_f32_16x16x32_bf16 v[100:103], v[80:83], a[104:107], v[100:103]
    ds_read_b128 v[80:83], v8 offset:640
    v_add_f32 v22, v22, v88
    v_add_f32 v23, v23, v89
    v_mfma_f32_16x16x32_bf16 v[100:103], v[76:79], a[100:103], v[100:103]
    ds_read_b128 v[76:79], v8 offset:576
    v_cvt_pk_bf16_f32 v104, v88, v89
    v_mfma_f32_16x16x32_bf16 v[100:103], v[72:75], a[96:99], v[100:103]
    ds_read_b128 v[72:75], v8 offset:512
    v_exp_f32 v92, v92
    v_mfma_f32_16x16x32_bf16 v[160:163], v[112:115], v[108:111], v[160:163]
    v_exp_f32 v93, v93
    v_mfma_f32_16x16x32_bf16 v[188:191], v[116:119], v[108:111], v[188:191]
    v_add_f32 v22, v22, v90
    v_add_f32 v23, v23, v91
    v_mfma_f32_16x16x32_bf16 v[216:219], v[120:123], v[108:111], v[216:219]
    v_cvt_pk_bf16_f32 v105, v90, v91
    v_mfma_f32_16x16x32_bf16 v[244:247], v[124:127], v[108:111], v[244:247]
    v_exp_f32 v94, v94
    v_mfma_f32_16x16x32_bf16 a[128:131], v[128:131], v[108:111], a[128:131]
    v_exp_f32 v95, v95
    v_mfma_f32_16x16x32_bf16 a[156:159], v[132:135], v[108:111], a[156:159]
    v_add_f32 v22, v22, v92
    v_add_f32 v23, v23, v93
    v_mfma_f32_16x16x32_bf16 a[184:187], v[136:139], v[108:111], a[184:187]
    v_cvt_pk_bf16_f32 v106, v92, v93
    v_add_f32 v22, v22, v94
    v_mfma_f32_16x16x32_bf16 a[212:215], v[140:143], v[108:111], a[212:215]
    v_add_f32 v23, v23, v95
    v_cvt_pk_bf16_f32 v107, v94, v95
    s_waitcnt lgkmcnt(0)
    v_mfma_f32_16x16x32_bf16 v[88:91], v[56:59], a[0:3], v[28:31]
    v_mfma_f32_16x16x32_bf16 v[88:91], v[60:63], a[4:7], v[88:91]
    v_exp_f32 v96, v96
    v_mfma_f32_16x16x32_bf16 v[88:91], v[64:67], a[8:11], v[88:91]
    v_exp_f32 v97, v97
    v_mfma_f32_16x16x32_bf16 v[88:91], v[68:71], a[12:15], v[88:91]
    v_exp_f32 v98, v98
    v_mfma_f32_16x16x32_bf16 v[92:95], v[84:87], a[12:15], v[28:31]
    v_exp_f32 v99, v99
    v_mfma_f32_16x16x32_bf16 v[92:95], v[80:83], a[8:11], v[92:95]
    v_add_f32 v24, v24, v96
    v_add_f32 v25, v25, v97
    v_mfma_f32_16x16x32_bf16 v[92:95], v[76:79], a[4:7], v[92:95]
    v_cvt_pk_bf16_f32 v108, v96, v97
    v_mfma_f32_16x16x32_bf16 v[92:95], v[72:75], a[0:3], v[92:95]
    v_exp_f32 v100, v100
    v_mfma_f32_16x16x32_bf16 v[164:167], v[112:115], v[104:107], v[164:167]
    v_exp_f32 v101, v101
    v_mfma_f32_16x16x32_bf16 v[192:195], v[116:119], v[104:107], v[192:195]
    v_add_f32 v24, v24, v98
    v_add_f32 v25, v25, v99
    v_mfma_f32_16x16x32_bf16 v[220:223], v[120:123], v[104:107], v[220:223]
    v_cvt_pk_bf16_f32 v109, v98, v99
    v_mfma_f32_16x16x32_bf16 v[248:251], v[124:127], v[104:107], v[248:251]
    v_exp_f32 v102, v102
    v_mfma_f32_16x16x32_bf16 a[132:135], v[128:131], v[104:107], a[132:135]
    v_exp_f32 v103, v103
    v_mfma_f32_16x16x32_bf16 a[160:163], v[132:135], v[104:107], a[160:163]
    v_add_f32 v24, v24, v100
    v_add_f32 v25, v25, v101
    v_mfma_f32_16x16x32_bf16 a[188:191], v[136:139], v[104:107], a[188:191]
    v_cvt_pk_bf16_f32 v110, v100, v101
    v_add_f32 v24, v24, v102
    v_mfma_f32_16x16x32_bf16 a[216:219], v[140:143], v[104:107], a[216:219]
    v_add_f32 v25, v25, v103
    v_cvt_pk_bf16_f32 v111, v102, v103
    v_mfma_f32_16x16x32_bf16 v[96:99], v[56:59], a[16:19], v[32:35]
    v_mfma_f32_16x16x32_bf16 v[96:99], v[60:63], a[20:23], v[96:99]
    v_exp_f32 v88, v88
    v_mfma_f32_16x16x32_bf16 v[96:99], v[64:67], a[24:27], v[96:99]
    v_exp_f32 v89, v89
    v_mfma_f32_16x16x32_bf16 v[96:99], v[68:71], a[28:31], v[96:99]
    v_exp_f32 v90, v90
    v_mfma_f32_16x16x32_bf16 v[100:103], v[84:87], a[28:31], v[32:35]
    v_exp_f32 v91, v91
    v_mfma_f32_16x16x32_bf16 v[100:103], v[80:83], a[24:27], v[100:103]
    v_add_f32 v12, v12, v88
    v_add_f32 v13, v13, v89
    v_mfma_f32_16x16x32_bf16 v[100:103], v[76:79], a[20:23], v[100:103]
    v_cvt_pk_bf16_f32 v104, v88, v89
    v_mfma_f32_16x16x32_bf16 v[100:103], v[72:75], a[16:19], v[100:103]
    v_exp_f32 v92, v92
    v_mfma_f32_16x16x32_bf16 v[168:171], v[112:115], v[108:111], v[168:171]
    ds_read_b64_tr_b16 v[112:113], v9 offset:0
    ds_read_b64_tr_b16 v[114:115], v9 offset:512
    v_exp_f32 v93, v93
    v_mfma_f32_16x16x32_bf16 v[196:199], v[116:119], v[108:111], v[196:199]
    ds_read_b64_tr_b16 v[116:117], v9 offset:32
    ds_read_b64_tr_b16 v[118:119], v9 offset:544
    v_add_f32 v12, v12, v90
    v_add_f32 v13, v13, v91
    v_mfma_f32_16x16x32_bf16 v[224:227], v[120:123], v[108:111], v[224:227]
    ds_read_b64_tr_b16 v[120:121], v9 offset:64
    ds_read_b64_tr_b16 v[122:123], v9 offset:576
    v_cvt_pk_bf16_f32 v105, v90, v91
    v_mfma_f32_16x16x32_bf16 v[252:255], v[124:127], v[108:111], v[252:255]
    ds_read_b64_tr_b16 v[124:125], v9 offset:96
    ds_read_b64_tr_b16 v[126:127], v9 offset:608
    v_exp_f32 v94, v94
    v_mfma_f32_16x16x32_bf16 a[136:139], v[128:131], v[108:111], a[136:139]
    ds_read_b64_tr_b16 v[128:129], v9 offset:128
    ds_read_b64_tr_b16 v[130:131], v9 offset:640
    v_exp_f32 v95, v95
    v_mfma_f32_16x16x32_bf16 a[164:167], v[132:135], v[108:111], a[164:167]
    ds_read_b64_tr_b16 v[132:133], v9 offset:160
    ds_read_b64_tr_b16 v[134:135], v9 offset:672
    v_add_f32 v12, v12, v92
    v_add_f32 v13, v13, v93
    v_mfma_f32_16x16x32_bf16 a[192:195], v[136:139], v[108:111], a[192:195]
    ds_read_b64_tr_b16 v[136:137], v9 offset:192
    ds_read_b64_tr_b16 v[138:139], v9 offset:704
    v_cvt_pk_bf16_f32 v106, v92, v93
    v_add_f32 v12, v12, v94
    v_mfma_f32_16x16x32_bf16 a[220:223], v[140:143], v[108:111], a[220:223]
    ds_read_b64_tr_b16 v[140:141], v9 offset:224
    ds_read_b64_tr_b16 v[142:143], v9 offset:736
    v_add_f32 v13, v13, v95
    v_cvt_pk_bf16_f32 v107, v94, v95
    v_mfma_f32_16x16x32_bf16 v[88:91], v[56:59], a[32:35], v[36:39]
    v_mfma_f32_16x16x32_bf16 v[88:91], v[60:63], a[36:39], v[88:91]
    s_add_u32 s29, s34, s100
    v_exp_f32 v96, v96
    v_mfma_f32_16x16x32_bf16 v[88:91], v[64:67], a[40:43], v[88:91]
    v_exp_f32 v97, v97
    v_mfma_f32_16x16x32_bf16 v[88:91], v[68:71], a[44:47], v[88:91]
    s_bfe_u32 s28, s29, 0x20003
    v_exp_f32 v98, v98
    v_mfma_f32_16x16x32_bf16 v[92:95], v[84:87], a[44:47], v[36:39]
    v_exp_f32 v99, v99
    v_mfma_f32_16x16x32_bf16 v[92:95], v[80:83], a[40:43], v[92:95]
    s_lshl_b32 s28, s28, 16
    v_add_f32 v14, v14, v96
    v_add_f32 v15, v15, v97
    v_mfma_f32_16x16x32_bf16 v[92:95], v[76:79], a[36:39], v[92:95]
    v_cvt_pk_bf16_f32 v108, v96, v97
    v_mfma_f32_16x16x32_bf16 v[92:95], v[72:75], a[32:35], v[92:95]
    v_exp_f32 v100, v100
    s_waitcnt lgkmcnt(0)
    v_mfma_f32_16x16x32_bf16 v[144:147], v[112:115], v[104:107], v[144:147]
    s_and_b32 s29, s29, 7
    v_exp_f32 v101, v101
    v_mfma_f32_16x16x32_bf16 v[172:175], v[116:119], v[104:107], v[172:175]
    v_add_f32 v14, v14, v98
    v_add_f32 v15, v15, v99
    v_mfma_f32_16x16x32_bf16 v[200:203], v[120:123], v[104:107], v[200:203]
    s_lshl_b32 s29, s29, 11
    v_cvt_pk_bf16_f32 v109, v98, v99
    v_mfma_f32_16x16x32_bf16 v[228:231], v[124:127], v[104:107], v[228:231]
    v_exp_f32 v102, v102
    v_mfma_f32_16x16x32_bf16 a[112:115], v[128:131], v[104:107], a[112:115]
    s_add_u32 s29, s28, s29
    v_exp_f32 v103, v103
    v_mfma_f32_16x16x32_bf16 a[140:143], v[132:135], v[104:107], a[140:143]
    v_add_f32 v14, v14, v100
    v_add_f32 v15, v15, v101
    v_mfma_f32_16x16x32_bf16 a[168:171], v[136:139], v[104:107], a[168:171]
    s_lshr_b32 s28, s34, 5
    v_cvt_pk_bf16_f32 v110, v100, v101
    v_add_f32 v14, v14, v102
    v_mfma_f32_16x16x32_bf16 a[196:199], v[140:143], v[104:107], a[196:199]
    v_add_f32 v15, v15, v103
    v_cvt_pk_bf16_f32 v111, v102, v103
    v_mfma_f32_16x16x32_bf16 v[96:99], v[56:59], a[48:51], v[40:43]
    v_mfma_f32_16x16x32_bf16 v[96:99], v[60:63], a[52:55], v[96:99]
    s_lshl_b32 s28, s28, 19
    v_exp_f32 v88, v88
    v_mfma_f32_16x16x32_bf16 v[96:99], v[64:67], a[56:59], v[96:99]
    v_exp_f32 v89, v89
    v_mfma_f32_16x16x32_bf16 v[96:99], v[68:71], a[60:63], v[96:99]
    s_add_u32 s49, s28, s29
    v_exp_f32 v90, v90
    v_mfma_f32_16x16x32_bf16 v[100:103], v[84:87], a[60:63], v[40:43]
    v_exp_f32 v91, v91
    v_mfma_f32_16x16x32_bf16 v[100:103], v[80:83], a[56:59], v[100:103]
    s_add_u32 m0, s33, 25344
    v_add_f32 v16, v16, v88
    v_add_f32 v17, v17, v89
    v_mfma_f32_16x16x32_bf16 v[100:103], v[76:79], a[52:55], v[100:103]
    v_cvt_pk_bf16_f32 v104, v88, v89
    v_mfma_f32_16x16x32_bf16 v[100:103], v[72:75], a[48:51], v[100:103]
    v_exp_f32 v92, v92
    v_mfma_f32_16x16x32_bf16 v[148:151], v[112:115], v[108:111], v[148:151]
    s_add_u32 s34, s34, 1
    v_exp_f32 v93, v93
    v_mfma_f32_16x16x32_bf16 v[176:179], v[116:119], v[108:111], v[176:179]
    v_add_f32 v16, v16, v90
    v_add_f32 v17, v17, v91
    v_mfma_f32_16x16x32_bf16 v[204:207], v[120:123], v[108:111], v[204:207]
    buffer_load_dwordx4 v7, s[4:7], s49 offen offset:0 nt lds
    v_cvt_pk_bf16_f32 v105, v90, v91
    v_mfma_f32_16x16x32_bf16 v[232:235], v[124:127], v[108:111], v[232:235]
    v_exp_f32 v94, v94
    v_mfma_f32_16x16x32_bf16 a[116:119], v[128:131], v[108:111], a[116:119]
    s_add_u32 m0, m0, s96
    v_exp_f32 v95, v95
    v_mfma_f32_16x16x32_bf16 a[144:147], v[132:135], v[108:111], a[144:147]
    v_add_f32 v16, v16, v92
    v_add_f32 v17, v17, v93
    v_mfma_f32_16x16x32_bf16 a[172:175], v[136:139], v[108:111], a[172:175]
    buffer_load_dwordx4 v7, s[4:7], s49 offen offset:256 nt lds
    v_cvt_pk_bf16_f32 v106, v92, v93
    v_add_f32 v16, v16, v94
    v_mfma_f32_16x16x32_bf16 a[200:203], v[140:143], v[108:111], a[200:203]
    v_add_f32 v17, v17, v95
    v_cvt_pk_bf16_f32 v107, v94, v95
    v_mfma_f32_16x16x32_bf16 v[88:91], v[56:59], a[64:67], v[44:47]
    v_mfma_f32_16x16x32_bf16 v[88:91], v[60:63], a[68:71], v[88:91]
    s_add_u32 m0, m0, s97
    v_exp_f32 v96, v96
    v_mfma_f32_16x16x32_bf16 v[88:91], v[64:67], a[72:75], v[88:91]
    v_exp_f32 v97, v97
    v_mfma_f32_16x16x32_bf16 v[88:91], v[68:71], a[76:79], v[88:91]
    buffer_load_dwordx4 v7, s[4:7], s49 offen offset:512 nt lds
    v_exp_f32 v98, v98
    v_mfma_f32_16x16x32_bf16 v[92:95], v[84:87], a[76:79], v[44:47]
    v_exp_f32 v99, v99
    v_mfma_f32_16x16x32_bf16 v[92:95], v[80:83], a[72:75], v[92:95]
    s_add_u32 m0, m0, s96
    v_add_f32 v18, v18, v96
    v_add_f32 v19, v19, v97
    v_mfma_f32_16x16x32_bf16 v[92:95], v[76:79], a[68:71], v[92:95]
    v_cvt_pk_bf16_f32 v108, v96, v97
    v_mfma_f32_16x16x32_bf16 v[92:95], v[72:75], a[64:67], v[92:95]
    v_exp_f32 v100, v100
    v_mfma_f32_16x16x32_bf16 v[152:155], v[112:115], v[104:107], v[152:155]
    buffer_load_dwordx4 v7, s[4:7], s49 offen offset:768 nt lds
    v_exp_f32 v101, v101
    v_mfma_f32_16x16x32_bf16 v[180:183], v[116:119], v[104:107], v[180:183]
    v_add_f32 v18, v18, v98
    v_add_f32 v19, v19, v99
    v_mfma_f32_16x16x32_bf16 v[208:211], v[120:123], v[104:107], v[208:211]
    s_add_u32 m0, m0, s97
    v_cvt_pk_bf16_f32 v109, v98, v99
    v_mfma_f32_16x16x32_bf16 v[236:239], v[124:127], v[104:107], v[236:239]
    v_exp_f32 v102, v102
    v_mfma_f32_16x16x32_bf16 a[120:123], v[128:131], v[104:107], a[120:123]
    buffer_load_dwordx4 v7, s[4:7], s49 offen offset:1024 nt lds
    v_exp_f32 v103, v103
    v_mfma_f32_16x16x32_bf16 a[148:151], v[132:135], v[104:107], a[148:151]
    v_add_f32 v18, v18, v100
    v_add_f32 v19, v19, v101
    v_mfma_f32_16x16x32_bf16 a[176:179], v[136:139], v[104:107], a[176:179]
    s_add_u32 m0, m0, s96
    v_cvt_pk_bf16_f32 v110, v100, v101
    v_add_f32 v18, v18, v102
    v_mfma_f32_16x16x32_bf16 a[204:207], v[140:143], v[104:107], a[204:207]
    v_add_f32 v19, v19, v103
    v_cvt_pk_bf16_f32 v111, v102, v103
    v_mfma_f32_16x16x32_bf16 v[96:99], v[56:59], a[80:83], v[48:51]
    v_mfma_f32_16x16x32_bf16 v[96:99], v[60:63], a[84:87], v[96:99]
    buffer_load_dwordx4 v7, s[4:7], s49 offen offset:1280 nt lds
    v_exp_f32 v88, v88
    v_mfma_f32_16x16x32_bf16 v[96:99], v[64:67], a[88:91], v[96:99]
    v_exp_f32 v89, v89
    v_mfma_f32_16x16x32_bf16 v[96:99], v[68:71], a[92:95], v[96:99]
    s_add_u32 m0, m0, s97
    v_exp_f32 v90, v90
    v_mfma_f32_16x16x32_bf16 v[100:103], v[84:87], a[92:95], v[48:51]
    v_exp_f32 v91, v91
    v_mfma_f32_16x16x32_bf16 v[100:103], v[80:83], a[88:91], v[100:103]
    buffer_load_dwordx4 v7, s[4:7], s49 offen offset:1536 nt lds
    v_add_f32 v20, v20, v88
    v_add_f32 v21, v21, v89
    v_mfma_f32_16x16x32_bf16 v[100:103], v[76:79], a[84:87], v[100:103]
    v_cvt_pk_bf16_f32 v104, v88, v89
    v_mfma_f32_16x16x32_bf16 v[100:103], v[72:75], a[80:83], v[100:103]
    v_exp_f32 v92, v92
    v_mfma_f32_16x16x32_bf16 v[156:159], v[112:115], v[108:111], v[156:159]
    s_add_u32 m0, m0, s96
    v_exp_f32 v93, v93
    v_mfma_f32_16x16x32_bf16 v[184:187], v[116:119], v[108:111], v[184:187]
    v_add_f32 v20, v20, v90
    v_add_f32 v21, v21, v91
    v_mfma_f32_16x16x32_bf16 v[212:215], v[120:123], v[108:111], v[212:215]
    buffer_load_dwordx4 v7, s[4:7], s49 offen offset:1792 nt lds
    v_cvt_pk_bf16_f32 v105, v90, v91
    v_mfma_f32_16x16x32_bf16 v[240:243], v[124:127], v[108:111], v[240:243]
    v_exp_f32 v94, v94
    v_mfma_f32_16x16x32_bf16 a[124:127], v[128:131], v[108:111], a[124:127]
    v_exp_f32 v95, v95
    v_mfma_f32_16x16x32_bf16 a[152:155], v[132:135], v[108:111], a[152:155]
    v_add_f32 v20, v20, v92
    v_add_f32 v21, v21, v93
    v_mfma_f32_16x16x32_bf16 a[180:183], v[136:139], v[108:111], a[180:183]
    v_cvt_pk_bf16_f32 v106, v92, v93
    v_add_f32 v20, v20, v94
    v_mfma_f32_16x16x32_bf16 a[208:211], v[140:143], v[108:111], a[208:211]
    v_add_f32 v21, v21, v95
    v_cvt_pk_bf16_f32 v107, v94, v95
    s_waitcnt vmcnt(16) lgkmcnt(0)
    s_barrier
    v_mfma_f32_16x16x32_bf16 v[88:91], v[56:59], a[96:99], v[52:55]
    ds_read_b128 v[56:59], v8 offset:8448
    v_mfma_f32_16x16x32_bf16 v[88:91], v[60:63], a[100:103], v[88:91]
    ds_read_b128 v[60:63], v8 offset:8512
    v_exp_f32 v96, v96
    v_mfma_f32_16x16x32_bf16 v[88:91], v[64:67], a[104:107], v[88:91]
    ds_read_b128 v[64:67], v8 offset:8576
    v_exp_f32 v97, v97
    v_mfma_f32_16x16x32_bf16 v[88:91], v[68:71], a[108:111], v[88:91]
    ds_read_b128 v[68:71], v8 offset:8640
    v_exp_f32 v98, v98
    v_mfma_f32_16x16x32_bf16 v[92:95], v[84:87], a[108:111], v[52:55]
    ds_read_b128 v[84:87], v8 offset:9152
    v_exp_f32 v99, v99
    v_mfma_f32_16x16x32_bf16 v[92:95], v[80:83], a[104:107], v[92:95]
    ds_read_b128 v[80:83], v8 offset:9088
    v_add_f32 v22, v22, v96
    v_add_f32 v23, v23, v97
    v_mfma_f32_16x16x32_bf16 v[92:95], v[76:79], a[100:103], v[92:95]
    ds_read_b128 v[76:79], v8 offset:9024
    v_cvt_pk_bf16_f32 v108, v96, v97
    v_mfma_f32_16x16x32_bf16 v[92:95], v[72:75], a[96:99], v[92:95]
    ds_read_b128 v[72:75], v8 offset:8960
    v_exp_f32 v100, v100
    v_mfma_f32_16x16x32_bf16 v[160:163], v[112:115], v[104:107], v[160:163]
    v_exp_f32 v101, v101
    v_mfma_f32_16x16x32_bf16 v[188:191], v[116:119], v[104:107], v[188:191]
    v_add_f32 v22, v22, v98
    v_add_f32 v23, v23, v99
    v_mfma_f32_16x16x32_bf16 v[216:219], v[120:123], v[104:107], v[216:219]
    v_cvt_pk_bf16_f32 v109, v98, v99
    v_mfma_f32_16x16x32_bf16 v[244:247], v[124:127], v[104:107], v[244:247]
    v_exp_f32 v102, v102
    v_mfma_f32_16x16x32_bf16 a[128:131], v[128:131], v[104:107], a[128:131]
    v_exp_f32 v103, v103
    v_mfma_f32_16x16x32_bf16 a[156:159], v[132:135], v[104:107], a[156:159]
    v_add_f32 v22, v22, v100
    v_add_f32 v23, v23, v101
    v_mfma_f32_16x16x32_bf16 a[184:187], v[136:139], v[104:107], a[184:187]
    v_cvt_pk_bf16_f32 v110, v100, v101
    v_add_f32 v22, v22, v102
    v_mfma_f32_16x16x32_bf16 a[212:215], v[140:143], v[104:107], a[212:215]
    v_add_f32 v23, v23, v103
    v_cvt_pk_bf16_f32 v111, v102, v103
    s_waitcnt lgkmcnt(0)
    v_mfma_f32_16x16x32_bf16 v[96:99], v[56:59], a[0:3], v[28:31]
    v_mfma_f32_16x16x32_bf16 v[96:99], v[60:63], a[4:7], v[96:99]
    v_exp_f32 v88, v88
    v_mfma_f32_16x16x32_bf16 v[96:99], v[64:67], a[8:11], v[96:99]
    v_exp_f32 v89, v89
    v_mfma_f32_16x16x32_bf16 v[96:99], v[68:71], a[12:15], v[96:99]
    v_exp_f32 v90, v90
    v_mfma_f32_16x16x32_bf16 v[100:103], v[84:87], a[12:15], v[28:31]
    v_exp_f32 v91, v91
    v_mfma_f32_16x16x32_bf16 v[100:103], v[80:83], a[8:11], v[100:103]
    v_add_f32 v24, v24, v88
    v_add_f32 v25, v25, v89
    v_mfma_f32_16x16x32_bf16 v[100:103], v[76:79], a[4:7], v[100:103]
    v_cvt_pk_bf16_f32 v104, v88, v89
    v_mfma_f32_16x16x32_bf16 v[100:103], v[72:75], a[0:3], v[100:103]
    v_exp_f32 v92, v92
    v_mfma_f32_16x16x32_bf16 v[164:167], v[112:115], v[108:111], v[164:167]
    v_exp_f32 v93, v93
    v_mfma_f32_16x16x32_bf16 v[192:195], v[116:119], v[108:111], v[192:195]
    v_add_f32 v24, v24, v90
    v_add_f32 v25, v25, v91
    v_mfma_f32_16x16x32_bf16 v[220:223], v[120:123], v[108:111], v[220:223]
    v_cvt_pk_bf16_f32 v105, v90, v91
    v_mfma_f32_16x16x32_bf16 v[248:251], v[124:127], v[108:111], v[248:251]
    v_exp_f32 v94, v94
    v_mfma_f32_16x16x32_bf16 a[132:135], v[128:131], v[108:111], a[132:135]
    v_exp_f32 v95, v95
    v_mfma_f32_16x16x32_bf16 a[160:163], v[132:135], v[108:111], a[160:163]
    v_add_f32 v24, v24, v92
    v_add_f32 v25, v25, v93
    v_mfma_f32_16x16x32_bf16 a[188:191], v[136:139], v[108:111], a[188:191]
    v_cvt_pk_bf16_f32 v106, v92, v93
    v_add_f32 v24, v24, v94
    v_mfma_f32_16x16x32_bf16 a[216:219], v[140:143], v[108:111], a[216:219]
    v_add_f32 v25, v25, v95
    v_cvt_pk_bf16_f32 v107, v94, v95
    s_add_u32 s22, s22, 1
    s_cmp_lt_u32 s22, 7
    s_cbranch_scc1 L_at_loop
    s_add_u32 s21, s21, 1
    s_mul_i32 s50, s21, s52
    s_mov_b32 s101, s21
    s_add_u32 s50, s50, s55
    s_cmp_ge_u32 s21, 2
    s_cselect_b32 s28, 0x40000000, 0
    s_add_u32 s50, s50, s28
    s_mov_b32 s82, s26
    s_mul_i32 s28, s26, s51
    s_add_u32 s50, s50, s28
    s_cmp_eq_u32 s21, 2
    s_cbranch_scc1 L_at_wt0
L_at_wt0r:
    s_cmp_lg_u32 s69, 0
    s_cbranch_scc1 L_at_atailB
    v_mfma_f32_16x16x32_bf16 v[88:91], v[56:59], a[16:19], v[32:35]
    v_mfma_f32_16x16x32_bf16 v[88:91], v[60:63], a[20:23], v[88:91]
    v_exp_f32 v96, v96
    v_mfma_f32_16x16x32_bf16 v[88:91], v[64:67], a[24:27], v[88:91]
    v_exp_f32 v97, v97
    v_mfma_f32_16x16x32_bf16 v[88:91], v[68:71], a[28:31], v[88:91]
    v_exp_f32 v98, v98
    v_mfma_f32_16x16x32_bf16 v[92:95], v[84:87], a[28:31], v[32:35]
    v_exp_f32 v99, v99
    v_mfma_f32_16x16x32_bf16 v[92:95], v[80:83], a[24:27], v[92:95]
    v_add_f32 v12, v12, v96
    v_add_f32 v13, v13, v97
    v_mfma_f32_16x16x32_bf16 v[92:95], v[76:79], a[20:23], v[92:95]
    v_cvt_pk_bf16_f32 v108, v96, v97
    v_mfma_f32_16x16x32_bf16 v[92:95], v[72:75], a[16:19], v[92:95]
    v_exp_f32 v100, v100
    v_mfma_f32_16x16x32_bf16 v[168:171], v[112:115], v[104:107], v[168:171]
    ds_read_b64_tr_b16 v[112:113], v9 offset:8448
    ds_read_b64_tr_b16 v[114:115], v9 offset:8960
    v_exp_f32 v101, v101
    v_mfma_f32_16x16x32_bf16 v[196:199], v[116:119], v[104:107], v[196:199]
    ds_read_b64_tr_b16 v[116:117], v9 offset:8480
    ds_read_b64_tr_b16 v[118:119], v9 offset:8992
    v_add_f32 v12, v12, v98
    v_add_f32 v13, v13, v99
    v_mfma_f32_16x16x32_bf16 v[224:227], v[120:123], v[104:107], v[224:227]
    ds_read_b64_tr_b16 v[120:121], v9 offset:8512
    ds_read_b64_tr_b16 v[122:123], v9 offset:9024
    v_cvt_pk_bf16_f32 v109, v98, v99
    v_mfma_f32_16x16x32_bf16 v[252:255], v[124:127], v[104:107], v[252:255]
    ds_read_b64_tr_b16 v[124:125], v9 offset:8544
    ds_read_b64_tr_b16 v[126:127], v9 offset:9056
    v_exp_f32 v102, v102
    v_mfma_f32_16x16x32_bf16 a[136:139], v[128:131], v[104:107], a[136:139]
    ds_read_b64_tr_b16 v[128:129], v9 offset:8576
    ds_read_b64_tr_b16 v[130:131], v9 offset:9088
    v_exp_f32 v103, v103
    v_mfma_f32_16x16x32_bf16 a[164:167], v[132:135], v[104:107], a[164:167]
    ds_read_b64_tr_b16 v[132:133], v9 offset:8608
    ds_read_b64_tr_b16 v[134:135], v9 offset:9120
    v_add_f32 v12, v12, v100
    v_add_f32 v13, v13, v101
    v_mfma_f32_16x16x32_bf16 a[192:195], v[136:139], v[104:107], a[192:195]
    ds_read_b64_tr_b16 v[136:137], v9 offset:8640
    ds_read_b64_tr_b16 v[138:139], v9 offset:9152
    v_cvt_pk_bf16_f32 v110, v100, v101
    v_add_f32 v12, v12, v102
    v_mfma_f32_16x16x32_bf16 a[220:223], v[140:143], v[104:107], a[220:223]
    ds_read_b64_tr_b16 v[140:141], v9 offset:8672
    ds_read_b64_tr_b16 v[142:143], v9 offset:9184
    v_add_f32 v13, v13, v103
    v_cvt_pk_bf16_f32 v111, v102, v103
    v_mfma_f32_16x16x32_bf16 v[96:99], v[56:59], a[32:35], v[36:39]
    v_mfma_f32_16x16x32_bf16 v[96:99], v[60:63], a[36:39], v[96:99]
    s_add_u32 m0, s33, 0
    v_exp_f32 v88, v88
    v_mfma_f32_16x16x32_bf16 v[96:99], v[64:67], a[40:43], v[96:99]
    v_exp_f32 v89, v89
    v_mfma_f32_16x16x32_bf16 v[96:99], v[68:71], a[44:47], v[96:99]
    s_mov_b32 s49, s50
    v_exp_f32 v90, v90
    v_mfma_f32_16x16x32_bf16 v[100:103], v[84:87], a[44:47], v[36:39]
    v_exp_f32 v91, v91
    v_mfma_f32_16x16x32_bf16 v[100:103], v[80:83], a[40:43], v[100:103]
    s_add_u32 s28, s49, s88
    v_add_f32 v14, v14, v88
    v_add_f32 v15, v15, v89
    v_mfma_f32_16x16x32_bf16 v[100:103], v[76:79], a[36:39], v[100:103]
    v_cvt_pk_bf16_f32 v104, v88, v89
    v_mfma_f32_16x16x32_bf16 v[100:103], v[72:75], a[32:35], v[100:103]
    v_exp_f32 v92, v92
    s_waitcnt lgkmcnt(0)
    v_mfma_f32_16x16x32_bf16 v[144:147], v[112:115], v[108:111], v[144:147]
    buffer_load_dwordx4 v26, s[16:19], s28 offen lds
    v_exp_f32 v93, v93
    v_mfma_f32_16x16x32_bf16 v[172:175], v[116:119], v[108:111], v[172:175]
    v_add_f32 v14, v14, v90
    v_add_f32 v15, v15, v91
    v_mfma_f32_16x16x32_bf16 v[200:203], v[120:123], v[108:111], v[200:203]
    s_add_u32 m0, m0, s53
    v_cvt_pk_bf16_f32 v105, v90, v91
    v_mfma_f32_16x16x32_bf16 v[228:231], v[124:127], v[108:111], v[228:231]
    v_exp_f32 v94, v94
    v_mfma_f32_16x16x32_bf16 a[112:115], v[128:131], v[108:111], a[112:115]
    s_add_u32 s28, s49, s89
    v_exp_f32 v95, v95
    v_mfma_f32_16x16x32_bf16 a[140:143], v[132:135], v[108:111], a[140:143]
    v_add_f32 v14, v14, v92
    v_add_f32 v15, v15, v93
    v_mfma_f32_16x16x32_bf16 a[168:171], v[136:139], v[108:111], a[168:171]
    buffer_load_dwordx4 v26, s[16:19], s28 offen lds
    v_cvt_pk_bf16_f32 v106, v92, v93
    v_add_f32 v14, v14, v94
    v_mfma_f32_16x16x32_bf16 a[196:199], v[140:143], v[108:111], a[196:199]
    v_add_f32 v15, v15, v95
    v_cvt_pk_bf16_f32 v107, v94, v95
    v_mfma_f32_16x16x32_bf16 v[88:91], v[56:59], a[48:51], v[40:43]
    v_mfma_f32_16x16x32_bf16 v[88:91], v[60:63], a[52:55], v[88:91]
    s_add_u32 m0, m0, s53
    v_exp_f32 v96, v96
    v_mfma_f32_16x16x32_bf16 v[88:91], v[64:67], a[56:59], v[88:91]
    v_exp_f32 v97, v97
    v_mfma_f32_16x16x32_bf16 v[88:91], v[68:71], a[60:63], v[88:91]
    s_add_u32 s28, s49, s90
    v_exp_f32 v98, v98
    v_mfma_f32_16x16x32_bf16 v[92:95], v[84:87], a[60:63], v[40:43]
    v_exp_f32 v99, v99
    v_mfma_f32_16x16x32_bf16 v[92:95], v[80:83], a[56:59], v[92:95]
    buffer_load_dwordx4 v26, s[16:19], s28 offen lds
    v_add_f32 v16, v16, v96
    v_add_f32 v17, v17, v97
    v_mfma_f32_16x16x32_bf16 v[92:95], v[76:79], a[52:55], v[92:95]
    v_cvt_pk_bf16_f32 v108, v96, v97
    v_mfma_f32_16x16x32_bf16 v[92:95], v[72:75], a[48:51], v[92:95]
    v_exp_f32 v100, v100
    v_mfma_f32_16x16x32_bf16 v[148:151], v[112:115], v[104:107], v[148:151]
    s_add_u32 m0, m0, s53
    v_exp_f32 v101, v101
    v_mfma_f32_16x16x32_bf16 v[176:179], v[116:119], v[104:107], v[176:179]
    v_add_f32 v16, v16, v98
    v_add_f32 v17, v17, v99
    v_mfma_f32_16x16x32_bf16 v[204:207], v[120:123], v[104:107], v[204:207]
    s_add_u32 s28, s49, s91
    v_cvt_pk_bf16_f32 v109, v98, v99
    v_mfma_f32_16x16x32_bf16 v[232:235], v[124:127], v[104:107], v[232:235]
    v_exp_f32 v102, v102
    v_mfma_f32_16x16x32_bf16 a[116:119], v[128:131], v[104:107], a[116:119]
    buffer_load_dwordx4 v26, s[16:19], s28 offen lds
    v_exp_f32 v103, v103
    v_mfma_f32_16x16x32_bf16 a[144:147], v[132:135], v[104:107], a[144:147]
    v_add_f32 v16, v16, v100
    v_add_f32 v17, v17, v101
    v_mfma_f32_16x16x32_bf16 a[172:175], v[136:139], v[104:107], a[172:175]
    s_add_u32 m0, m0, s53
    v_cvt_pk_bf16_f32 v110, v100, v101
    v_add_f32 v16, v16, v102
    v_mfma_f32_16x16x32_bf16 a[200:203], v[140:143], v[104:107], a[200:203]
    v_add_f32 v17, v17, v103
    v_cvt_pk_bf16_f32 v111, v102, v103
    v_mfma_f32_16x16x32_bf16 v[96:99], v[56:59], a[64:67], v[44:47]
    v_mfma_f32_16x16x32_bf16 v[96:99], v[60:63], a[68:71], v[96:99]
    s_add_u32 s28, s49, s92
    v_exp_f32 v88, v88
    v_mfma_f32_16x16x32_bf16 v[96:99], v[64:67], a[72:75], v[96:99]
    v_exp_f32 v89, v89
    v_mfma_f32_16x16x32_bf16 v[96:99], v[68:71], a[76:79], v[96:99]
    buffer_load_dwordx4 v26, s[16:19], s28 offen lds
    v_exp_f32 v90, v90
    v_mfma_f32_16x16x32_bf16 v[100:103], v[84:87], a[76:79], v[44:47]
    v_exp_f32 v91, v91
    v_mfma_f32_16x16x32_bf16 v[100:103], v[80:83], a[72:75], v[100:103]
    s_add_u32 m0, m0, s53
    v_add_f32 v18, v18, v88
    v_add_f32 v19, v19, v89
    v_mfma_f32_16x16x32_bf16 v[100:103], v[76:79], a[68:71], v[100:103]
    v_cvt_pk_bf16_f32 v104, v88, v89
    v_mfma_f32_16x16x32_bf16 v[100:103], v[72:75], a[64:67], v[100:103]
    v_exp_f32 v92, v92
    v_mfma_f32_16x16x32_bf16 v[152:155], v[112:115], v[108:111], v[152:155]
    s_add_u32 s28, s49, s93
    v_exp_f32 v93, v93
    v_mfma_f32_16x16x32_bf16 v[180:183], v[116:119], v[108:111], v[180:183]
    v_add_f32 v18, v18, v90
    v_add_f32 v19, v19, v91
    v_mfma_f32_16x16x32_bf16 v[208:211], v[120:123], v[108:111], v[208:211]
    buffer_load_dwordx4 v26, s[16:19], s28 offen lds
    v_cvt_pk_bf16_f32 v105, v90, v91
    v_mfma_f32_16x16x32_bf16 v[236:239], v[124:127], v[108:111], v[236:239]
    v_exp_f32 v94, v94
    v_mfma_f32_16x16x32_bf16 a[120:123], v[128:131], v[108:111], a[120:123]
    s_add_u32 m0, m0, s53
    v_exp_f32 v95, v95
    v_mfma_f32_16x16x32_bf16 a[148:151], v[132:135], v[108:111], a[148:151]
    v_add_f32 v18, v18, v92
    v_add_f32 v19, v19, v93
    v_mfma_f32_16x16x32_bf16 a[176:179], v[136:139], v[108:111], a[176:179]
    s_add_u32 s28, s49, s94
    v_cvt_pk_bf16_f32 v106, v92, v93
    v_add_f32 v18, v18, v94
    v_mfma_f32_16x16x32_bf16 a[204:207], v[140:143], v[108:111], a[204:207]
    v_add_f32 v19, v19, v95
    v_cvt_pk_bf16_f32 v107, v94, v95
    v_mfma_f32_16x16x32_bf16 v[88:91], v[56:59], a[80:83], v[48:51]
    v_mfma_f32_16x16x32_bf16 v[88:91], v[60:63], a[84:87], v[88:91]
    buffer_load_dwordx4 v26, s[16:19], s28 offen lds
    v_exp_f32 v96, v96
    v_mfma_f32_16x16x32_bf16 v[88:91], v[64:67], a[88:91], v[88:91]
    v_exp_f32 v97, v97
    v_mfma_f32_16x16x32_bf16 v[88:91], v[68:71], a[92:95], v[88:91]
    s_add_u32 m0, m0, s53
    v_exp_f32 v98, v98
    v_mfma_f32_16x16x32_bf16 v[92:95], v[84:87], a[92:95], v[48:51]
    v_exp_f32 v99, v99
    v_mfma_f32_16x16x32_bf16 v[92:95], v[80:83], a[88:91], v[92:95]
    s_add_u32 s28, s49, s95
    v_add_f32 v20, v20, v96
    v_add_f32 v21, v21, v97
    v_mfma_f32_16x16x32_bf16 v[92:95], v[76:79], a[84:87], v[92:95]
    v_cvt_pk_bf16_f32 v108, v96, v97
    v_mfma_f32_16x16x32_bf16 v[92:95], v[72:75], a[80:83], v[92:95]
    v_exp_f32 v100, v100
    v_mfma_f32_16x16x32_bf16 v[156:159], v[112:115], v[104:107], v[156:159]
    buffer_load_dwordx4 v26, s[16:19], s28 offen lds
    v_exp_f32 v101, v101
    v_mfma_f32_16x16x32_bf16 v[184:187], v[116:119], v[104:107], v[184:187]
    v_add_f32 v20, v20, v98
    v_add_f32 v21, v21, v99
    v_mfma_f32_16x16x32_bf16 v[212:215], v[120:123], v[104:107], v[212:215]
    v_cvt_pk_bf16_f32 v109, v98, v99
    v_mfma_f32_16x16x32_bf16 v[240:243], v[124:127], v[104:107], v[240:243]
    v_exp_f32 v102, v102
    v_mfma_f32_16x16x32_bf16 a[124:127], v[128:131], v[104:107], a[124:127]
    v_exp_f32 v103, v103
    v_mfma_f32_16x16x32_bf16 a[152:155], v[132:135], v[104:107], a[152:155]
    v_add_f32 v20, v20, v100
    v_add_f32 v21, v21, v101
    v_mfma_f32_16x16x32_bf16 a[180:183], v[136:139], v[104:107], a[180:183]
    v_cvt_pk_bf16_f32 v110, v100, v101
    v_add_f32 v20, v20, v102
    v_mfma_f32_16x16x32_bf16 a[208:211], v[140:143], v[104:107], a[208:211]
    v_add_f32 v21, v21, v103
    v_cvt_pk_bf16_f32 v111, v102, v103
    s_waitcnt vmcnt(16) lgkmcnt(0)
    s_barrier
    v_mfma_f32_16x16x32_bf16 v[96:99], v[56:59], a[96:99], v[52:55]
    ds_read_b128 v[56:59], v8 offset:16896
    v_mfma_f32_16x16x32_bf16 v[96:99], v[60:63], a[100:103], v[96:99]
    ds_read_b128 v[60:63], v8 offset:16960
    v_exp_f32 v88, v88
    v_mfma_f32_16x16x32_bf16 v[96:99], v[64:67], a[104:107], v[96:99]
    ds_read_b128 v[64:67], v8 offset:17024
    v_exp_f32 v89, v89
    v_mfma_f32_16x16x32_bf16 v[96:99], v[68:71], a[108:111], v[96:99]
    ds_read_b128 v[68:71], v8 offset:17088
    v_exp_f32 v90, v90
    v_mfma_f32_16x16x32_bf16 v[100:103], v[84:87], a[108:111], v[52:55]
    ds_read_b128 v[84:87], v8 offset:17600
    v_exp_f32 v91, v91
    v_mfma_f32_16x16x32_bf16 v[100:103], v[80:83], a[104:107], v[100:103]
    ds_read_b128 v[80:83], v8 offset:17536
    v_add_f32 v22, v22, v88
    v_add_f32 v23, v23, v89
    v_mfma_f32_16x16x32_bf16 v[100:103], v[76:79], a[100:103], v[100:103]
    ds_read_b128 v[76:79], v8 offset:17472
    v_cvt_pk_bf16_f32 v104, v88, v89
    v_mfma_f32_16x16x32_bf16 v[100:103], v[72:75], a[96:99], v[100:103]
    ds_read_b128 v[72:75], v8 offset:17408
    v_exp_f32 v92, v92
    v_mfma_f32_16x16x32_bf16 v[160:163], v[112:115], v[108:111], v[160:163]
    v_exp_f32 v93, v93
    v_mfma_f32_16x16x32_bf16 v[188:191], v[116:119], v[108:111], v[188:191]
    v_add_f32 v22, v22, v90
    v_add_f32 v23, v23, v91
    v_mfma_f32_16x16x32_bf16 v[216:219], v[120:123], v[108:111], v[216:219]
    v_cvt_pk_bf16_f32 v105, v90, v91
    v_mfma_f32_16x16x32_bf16 v[244:247], v[124:127], v[108:111], v[244:247]
    v_exp_f32 v94, v94
    v_mfma_f32_16x16x32_bf16 a[128:131], v[128:131], v[108:111], a[128:131]
    v_exp_f32 v95, v95
    v_mfma_f32_16x16x32_bf16 a[156:159], v[132:135], v[108:111], a[156:159]
    v_add_f32 v22, v22, v92
    v_add_f32 v23, v23, v93
    v_mfma_f32_16x16x32_bf16 a[184:187], v[136:139], v[108:111], a[184:187]
    v_cvt_pk_bf16_f32 v106, v92, v93
    v_add_f32 v22, v22, v94
    v_mfma_f32_16x16x32_bf16 a[212:215], v[140:143], v[108:111], a[212:215]
    v_add_f32 v23, v23, v95
    v_cvt_pk_bf16_f32 v107, v94, v95
    s_waitcnt lgkmcnt(0)
    v_mfma_f32_16x16x32_bf16 v[88:91], v[56:59], a[0:3], v[28:31]
    v_mfma_f32_16x16x32_bf16 v[88:91], v[60:63], a[4:7], v[88:91]
    v_exp_f32 v96, v96
    v_mfma_f32_16x16x32_bf16 v[88:91], v[64:67], a[8:11], v[88:91]
    v_exp_f32 v97, v97
    v_mfma_f32_16x16x32_bf16 v[88:91], v[68:71], a[12:15], v[88:91]
    v_exp_f32 v98, v98
    v_mfma_f32_16x16x32_bf16 v[92:95], v[84:87], a[12:15], v[28:31]
    v_exp_f32 v99, v99
    v_mfma_f32_16x16x32_bf16 v[92:95], v[80:83], a[8:11], v[92:95]
    v_add_f32 v24, v24, v96
    v_add_f32 v25, v25, v97
    v_mfma_f32_16x16x32_bf16 v[92:95], v[76:79], a[4:7], v[92:95]
    v_cvt_pk_bf16_f32 v108, v96, v97
    v_mfma_f32_16x16x32_bf16 v[92:95], v[72:75], a[0:3], v[92:95]
    v_exp_f32 v100, v100
    v_mfma_f32_16x16x32_bf16 v[164:167], v[112:115], v[104:107], v[164:167]
    v_exp_f32 v101, v101
    v_mfma_f32_16x16x32_bf16 v[192:195], v[116:119], v[104:107], v[192:195]
    v_add_f32 v24, v24, v98
    v_add_f32 v25, v25, v99
    v_mfma_f32_16x16x32_bf16 v[220:223], v[120:123], v[104:107], v[220:223]
    v_cvt_pk_bf16_f32 v109, v98, v99
    v_mfma_f32_16x16x32_bf16 v[248:251], v[124:127], v[104:107], v[248:251]
    v_exp_f32 v102, v102
    v_mfma_f32_16x16x32_bf16 a[132:135], v[128:131], v[104:107], a[132:135]
    v_exp_f32 v103, v103
    v_mfma_f32_16x16x32_bf16 a[160:163], v[132:135], v[104:107], a[160:163]
    v_add_f32 v24, v24, v100
    v_add_f32 v25, v25, v101
    v_mfma_f32_16x16x32_bf16 a[188:191], v[136:139], v[104:107], a[188:191]
    v_cvt_pk_bf16_f32 v110, v100, v101
    v_add_f32 v24, v24, v102
    v_mfma_f32_16x16x32_bf16 a[216:219], v[140:143], v[104:107], a[216:219]
    v_add_f32 v25, v25, v103
    v_cvt_pk_bf16_f32 v111, v102, v103
    v_mfma_f32_16x16x32_bf16 v[96:99], v[56:59], a[16:19], v[32:35]
    v_mfma_f32_16x16x32_bf16 v[96:99], v[60:63], a[20:23], v[96:99]
    v_exp_f32 v88, v88
    v_mfma_f32_16x16x32_bf16 v[96:99], v[64:67], a[24:27], v[96:99]
    v_exp_f32 v89, v89
    v_mfma_f32_16x16x32_bf16 v[96:99], v[68:71], a[28:31], v[96:99]
    v_exp_f32 v90, v90
    v_mfma_f32_16x16x32_bf16 v[100:103], v[84:87], a[28:31], v[32:35]
    v_exp_f32 v91, v91
    v_mfma_f32_16x16x32_bf16 v[100:103], v[80:83], a[24:27], v[100:103]
    v_add_f32 v12, v12, v88
    v_add_f32 v13, v13, v89
    v_mfma_f32_16x16x32_bf16 v[100:103], v[76:79], a[20:23], v[100:103]
    v_cvt_pk_bf16_f32 v104, v88, v89
    v_mfma_f32_16x16x32_bf16 v[100:103], v[72:75], a[16:19], v[100:103]
    v_exp_f32 v92, v92
    v_mfma_f32_16x16x32_bf16 v[168:171], v[112:115], v[108:111], v[168:171]
    ds_read_b64_tr_b16 v[112:113], v9 offset:16896
    ds_read_b64_tr_b16 v[114:115], v9 offset:17408
    v_exp_f32 v93, v93
    v_mfma_f32_16x16x32_bf16 v[196:199], v[116:119], v[108:111], v[196:199]
    ds_read_b64_tr_b16 v[116:117], v9 offset:16928
    ds_read_b64_tr_b16 v[118:119], v9 offset:17440
    v_add_f32 v12, v12, v90
    v_add_f32 v13, v13, v91
    v_mfma_f32_16x16x32_bf16 v[224:227], v[120:123], v[108:111], v[224:227]
    ds_read_b64_tr_b16 v[120:121], v9 offset:16960
    ds_read_b64_tr_b16 v[122:123], v9 offset:17472
    v_cvt_pk_bf16_f32 v105, v90, v91
    v_mfma_f32_16x16x32_bf16 v[252:255], v[124:127], v[108:111], v[252:255]
    ds_read_b64_tr_b16 v[124:125], v9 offset:16992
    ds_read_b64_tr_b16 v[126:127], v9 offset:17504
    v_exp_f32 v94, v94
    v_mfma_f32_16x16x32_bf16 a[136:139], v[128:131], v[108:111], a[136:139]
    ds_read_b64_tr_b16 v[128:129], v9 offset:17024
    ds_read_b64_tr_b16 v[130:131], v9 offset:17536
    v_exp_f32 v95, v95
    v_mfma_f32_16x16x32_bf16 a[164:167], v[132:135], v[108:111], a[164:167]
    ds_read_b64_tr_b16 v[132:133], v9 offset:17056
    ds_read_b64_tr_b16 v[134:135], v9 offset:17568
    v_add_f32 v12, v12, v92
    v_add_f32 v13, v13, v93
    v_mfma_f32_16x16x32_bf16 a[192:195], v[136:139], v[108:111], a[192:195]
    ds_read_b64_tr_b16 v[136:137], v9 offset:17088
    ds_read_b64_tr_b16 v[138:139], v9 offset:17600
    v_cvt_pk_bf16_f32 v106, v92, v93
    v_add_f32 v12, v12, v94
    v_mfma_f32_16x16x32_bf16 a[220:223], v[140:143], v[108:111], a[220:223]
    ds_read_b64_tr_b16 v[140:141], v9 offset:17120
    ds_read_b64_tr_b16 v[142:143], v9 offset:17632
    v_add_f32 v13, v13, v95
    v_cvt_pk_bf16_f32 v107, v94, v95
    v_mfma_f32_16x16x32_bf16 v[88:91], v[56:59], a[32:35], v[36:39]
    v_mfma_f32_16x16x32_bf16 v[88:91], v[60:63], a[36:39], v[88:91]
    s_add_u32 m0, s33, 8448
    v_exp_f32 v96, v96
    v_mfma_f32_16x16x32_bf16 v[88:91], v[64:67], a[40:43], v[88:91]
    v_exp_f32 v97, v97
    v_mfma_f32_16x16x32_bf16 v[88:91], v[68:71], a[44:47], v[88:91]
    s_add_u32 s49, s50, s46
    v_exp_f32 v98, v98
    v_mfma_f32_16x16x32_bf16 v[92:95], v[84:87], a[44:47], v[36:39]
    v_exp_f32 v99, v99
    v_mfma_f32_16x16x32_bf16 v[92:95], v[80:83], a[40:43], v[92:95]
    s_lshl1_add_u32 s50, s51, s50
    v_add_f32 v14, v14, v96
    v_add_f32 v15, v15, v97
    v_mfma_f32_16x16x32_bf16 v[92:95], v[76:79], a[36:39], v[92:95]
    v_cvt_pk_bf16_f32 v108, v96, v97
    v_mfma_f32_16x16x32_bf16 v[92:95], v[72:75], a[32:35], v[92:95]
    s_add_u32 s82, s82, 2
    v_exp_f32 v100, v100
    s_waitcnt lgkmcnt(0)
    v_mfma_f32_16x16x32_bf16 v[144:147], v[112:115], v[104:107], v[144:147]
    v_exp_f32 v101, v101
    v_mfma_f32_16x16x32_bf16 v[172:175], v[116:119], v[104:107], v[172:175]
    s_cmp_eq_u32 s82, 20
    v_add_f32 v14, v14, v98
    v_add_f32 v15, v15, v99
    v_mfma_f32_16x16x32_bf16 v[200:203], v[120:123], v[104:107], v[200:203]
    v_cvt_pk_bf16_f32 v109, v98, v99
    v_mfma_f32_16x16x32_bf16 v[228:231], v[124:127], v[104:107], v[228:231]
    s_cselect_b32 s29, s83, 0
    v_exp_f32 v102, v102
    v_mfma_f32_16x16x32_bf16 a[112:115], v[128:131], v[104:107], a[112:115]
    v_exp_f32 v103, v103
    v_mfma_f32_16x16x32_bf16 a[140:143], v[132:135], v[104:107], a[140:143]
    s_sub_u32 s50, s50, s29
    v_add_f32 v14, v14, v100
    v_add_f32 v15, v15, v101
    v_mfma_f32_16x16x32_bf16 a[168:171], v[136:139], v[104:107], a[168:171]
    v_cvt_pk_bf16_f32 v110, v100, v101
    v_add_f32 v14, v14, v102
    v_mfma_f32_16x16x32_bf16 a[196:199], v[140:143], v[104:107], a[196:199]
    s_add_u32 s28, s49, s88
    v_add_f32 v15, v15, v103
    v_cvt_pk_bf16_f32 v111, v102, v103
    v_mfma_f32_16x16x32_bf16 v[96:99], v[56:59], a[48:51], v[40:43]
    v_mfma_f32_16x16x32_bf16 v[96:99], v[60:63], a[52:55], v[96:99]
    buffer_load_dwordx4 v26, s[16:19], s28 offen lds
    v_exp_f32 v88, v88
    v_mfma_f32_16x16x32_bf16 v[96:99], v[64:67], a[56:59], v[96:99]
    v_exp_f32 v89, v89
    v_mfma_f32_16x16x32_bf16 v[96:99], v[68:71], a[60:63], v[96:99]
    s_add_u32 m0, m0, s53
    v_exp_f32 v90, v90
    v_mfma_f32_16x16x32_bf16 v[100:103], v[84:87], a[60:63], v[40:43]
    v_exp_f32 v91, v91
    v_mfma_f32_16x16x32_bf16 v[100:103], v[80:83], a[56:59], v[100:103]
    s_add_u32 s28, s49, s89
    v_add_f32 v16, v16, v88
    v_add_f32 v17, v17, v89
    v_mfma_f32_16x16x32_bf16 v[100:103], v[76:79], a[52:55], v[100:103]
    v_cvt_pk_bf16_f32 v104, v88, v89
    v_mfma_f32_16x16x32_bf16 v[100:103], v[72:75], a[48:51], v[100:103]
    buffer_load_dwordx4 v26, s[16:19], s28 offen lds
    v_exp_f32 v92, v92
    v_mfma_f32_16x16x32_bf16 v[148:151], v[112:115], v[108:111], v[148:151]
    v_exp_f32 v93, v93
    v_mfma_f32_16x16x32_bf16 v[176:179], v[116:119], v[108:111], v[176:179]
    s_add_u32 m0, m0, s53
    v_add_f32 v16, v16, v90
    v_add_f32 v17, v17, v91
    v_mfma_f32_16x16x32_bf16 v[204:207], v[120:123], v[108:111], v[204:207]
    v_cvt_pk_bf16_f32 v105, v90, v91
    v_mfma_f32_16x16x32_bf16 v[232:235], v[124:127], v[108:111], v[232:235]
    s_add_u32 s28, s49, s90
    v_exp_f32 v94, v94
    v_mfma_f32_16x16x32_bf16 a[116:119], v[128:131], v[108:111], a[116:119]
    v_exp_f32 v95, v95
    v_mfma_f32_16x16x32_bf16 a[144:147], v[132:135], v[108:111], a[144:147]
    buffer_load_dwordx4 v26, s[16:19], s28 offen lds
    v_add_f32 v16, v16, v92
    v_add_f32 v17, v17, v93
    v_mfma_f32_16x16x32_bf16 a[172:175], v[136:139], v[108:111], a[172:175]
    v_cvt_pk_bf16_f32 v106, v92, v93
    v_add_f32 v16, v16, v94
    v_mfma_f32_16x16x32_bf16 a[200:203], v[140:143], v[108:111], a[200:203]
    s_add_u32 m0, m0, s53
    v_add_f32 v17, v17, v95
    v_cvt_pk_bf16_f32 v107, v94, v95
    v_mfma_f32_16x16x32_bf16 v[88:91], v[56:59], a[64:67], v[44:47]
    v_mfma_f32_16x16x32_bf16 v[88:91], v[60:63], a[68:71], v[88:91]
    s_add_u32 s28, s49, s91
    v_exp_f32 v96, v96
    v_mfma_f32_16x16x32_bf16 v[88:91], v[64:67], a[72:75], v[88:91]
    v_exp_f32 v97, v97
    v_mfma_f32_16x16x32_bf16 v[88:91], v[68:71], a[76:79], v[88:91]
    buffer_load_dwordx4 v26, s[16:19], s28 offen lds
    v_exp_f32 v98, v98
    v_mfma_f32_16x16x32_bf16 v[92:95], v[84:87], a[76:79], v[44:47]
    v_exp_f32 v99, v99
    v_mfma_f32_16x16x32_bf16 v[92:95], v[80:83], a[72:75], v[92:95]
    s_add_u32 m0, m0, s53
    v_add_f32 v18, v18, v96
    v_add_f32 v19, v19, v97
    v_mfma_f32_16x16x32_bf16 v[92:95], v[76:79], a[68:71], v[92:95]
    v_cvt_pk_bf16_f32 v108, v96, v97
    v_mfma_f32_16x16x32_bf16 v[92:95], v[72:75], a[64:67], v[92:95]
    s_add_u32 s28, s49, s92
    v_exp_f32 v100, v100
    v_mfma_f32_16x16x32_bf16 v[152:155], v[112:115], v[104:107], v[152:155]
    v_exp_f32 v101, v101
    v_mfma_f32_16x16x32_bf16 v[180:183], v[116:119], v[104:107], v[180:183]
    buffer_load_dwordx4 v26, s[16:19], s28 offen lds
    v_add_f32 v18, v18, v98
    v_add_f32 v19, v19, v99
    v_mfma_f32_16x16x32_bf16 v[208:211], v[120:123], v[104:107], v[208:211]
    v_cvt_pk_bf16_f32 v109, v98, v99
    v_mfma_f32_16x16x32_bf16 v[236:239], v[124:127], v[104:107], v[236:239]
    s_add_u32 m0, m0, s53
    v_exp_f32 v102, v102
    v_mfma_f32_16x16x32_bf16 a[120:123], v[128:131], v[104:107], a[120:123]
    v_exp_f32 v103, v103
    v_mfma_f32_16x16x32_bf16 a[148:151], v[132:135], v[104:107], a[148:151]
    s_add_u32 s28, s49, s93
    v_add_f32 v18, v18, v100
    v_add_f32 v19, v19, v101
    v_mfma_f32_16x16x32_bf16 a[176:179], v[136:139], v[104:107], a[176:179]
    v_cvt_pk_bf16_f32 v110, v100, v101
    v_add_f32 v18, v18, v102
    v_mfma_f32_16x16x32_bf16 a[204:207], v[140:143], v[104:107], a[204:207]
    buffer_load_dwordx4 v26, s[16:19], s28 offen lds
    v_add_f32 v19, v19, v103
    v_cvt_pk_bf16_f32 v111, v102, v103
    v_mfma_f32_16x16x32_bf16 v[96:99], v[56:59], a[80:83], v[48:51]
    v_mfma_f32_16x16x32_bf16 v[96:99], v[60:63], a[84:87], v[96:99]
    s_add_u32 m0, m0, s53
    v_exp_f32 v88, v88
    v_mfma_f32_16x16x32_bf16 v[96:99], v[64:67], a[88:91], v[96:99]
    v_exp_f32 v89, v89
    v_mfma_f32_16x16x32_bf16 v[96:99], v[68:71], a[92:95], v[96:99]
    s_add_u32 s28, s49, s47
    v_exp_f32 v90, v90
    v_mfma_f32_16x16x32_bf16 v[100:103], v[84:87], a[92:95], v[48:51]
    v_exp_f32 v91, v91
    v_mfma_f32_16x16x32_bf16 v[100:103], v[80:83], a[88:91], v[100:103]
    buffer_load_dwordx4 v26, s[16:19], s28 offen lds
    v_add_f32 v20, v20, v88
    v_add_f32 v21, v21, v89
    v_mfma_f32_16x16x32_bf16 v[100:103], v[76:79], a[84:87], v[100:103]
    v_cvt_pk_bf16_f32 v104, v88, v89
    v_mfma_f32_16x16x32_bf16 v[100:103], v[72:75], a[80:83], v[100:103]
    s_add_u32 m0, m0, s53
    v_exp_f32 v92, v92
    v_mfma_f32_16x16x32_bf16 v[156:159], v[112:115], v[108:111], v[156:159]
    v_exp_f32 v93, v93
    v_mfma_f32_16x16x32_bf16 v[184:187], v[116:119], v[108:111], v[184:187]
    s_add_u32 s28, s49, s98
    v_add_f32 v20, v20, v90
    v_add_f32 v21, v21, v91
    v_mfma_f32_16x16x32_bf16 v[212:215], v[120:123], v[108:111], v[212:215]
    v_cvt_pk_bf16_f32 v105, v90, v91
    v_mfma_f32_16x16x32_bf16 v[240:243], v[124:127], v[108:111], v[240:243]
    buffer_load_dwordx4 v26, s[16:19], s28 offen lds
    v_exp_f32 v94, v94
    v_mfma_f32_16x16x32_bf16 a[124:127], v[128:131], v[108:111], a[124:127]
    v_exp_f32 v95, v95
    v_mfma_f32_16x16x32_bf16 a[152:155], v[132:135], v[108:111], a[152:155]
    v_add_f32 v20, v20, v92
    v_add_f32 v21, v21, v93
    v_mfma_f32_16x16x32_bf16 a[180:183], v[136:139], v[108:111], a[180:183]
    v_cvt_pk_bf16_f32 v106, v92, v93
    v_add_f32 v20, v20, v94
    v_mfma_f32_16x16x32_bf16 a[208:211], v[140:143], v[108:111], a[208:211]
    v_add_f32 v21, v21, v95
    v_cvt_pk_bf16_f32 v107, v94, v95
    s_waitcnt vmcnt(16) lgkmcnt(0)
    s_barrier
    v_mfma_f32_16x16x32_bf16 v[88:91], v[56:59], a[96:99], v[52:55]
    ds_read_b128 v[56:59], v8 offset:25344
    v_mfma_f32_16x16x32_bf16 v[88:91], v[60:63], a[100:103], v[88:91]
    ds_read_b128 v[60:63], v8 offset:25408
    v_exp_f32 v96, v96
    v_mfma_f32_16x16x32_bf16 v[88:91], v[64:67], a[104:107], v[88:91]
    ds_read_b128 v[64:67], v8 offset:25472
    v_exp_f32 v97, v97
    v_mfma_f32_16x16x32_bf16 v[88:91], v[68:71], a[108:111], v[88:91]
    ds_read_b128 v[68:71], v8 offset:25536
    v_exp_f32 v98, v98
    v_mfma_f32_16x16x32_bf16 v[92:95], v[84:87], a[108:111], v[52:55]
    ds_read_b128 v[84:87], v8 offset:26048
    v_exp_f32 v99, v99
    v_mfma_f32_16x16x32_bf16 v[92:95], v[80:83], a[104:107], v[92:95]
    ds_read_b128 v[80:83], v8 offset:25984
    v_add_f32 v22, v22, v96
    v_add_f32 v23, v23, v97
    v_mfma_f32_16x16x32_bf16 v[92:95], v[76:79], a[100:103], v[92:95]
    ds_read_b128 v[76:79], v8 offset:25920
    v_cvt_pk_bf16_f32 v108, v96, v97
    v_mfma_f32_16x16x32_bf16 v[92:95], v[72:75], a[96:99], v[92:95]
    ds_read_b128 v[72:75], v8 offset:25856
    v_exp_f32 v100, v100
    v_mfma_f32_16x16x32_bf16 v[160:163], v[112:115], v[104:107], v[160:163]
    v_exp_f32 v101, v101
    v_mfma_f32_16x16x32_bf16 v[188:191], v[116:119], v[104:107], v[188:191]
    v_add_f32 v22, v22, v98
    v_add_f32 v23, v23, v99
    v_mfma_f32_16x16x32_bf16 v[216:219], v[120:123], v[104:107], v[216:219]
    v_cvt_pk_bf16_f32 v109, v98, v99
    v_mfma_f32_16x16x32_bf16 v[244:247], v[124:127], v[104:107], v[244:247]
    v_exp_f32 v102, v102
    v_mfma_f32_16x16x32_bf16 a[128:131], v[128:131], v[104:107], a[128:131]
    v_exp_f32 v103, v103
    v_mfma_f32_16x16x32_bf16 a[156:159], v[132:135], v[104:107], a[156:159]
    v_add_f32 v22, v22, v100
    v_add_f32 v23, v23, v101
    v_mfma_f32_16x16x32_bf16 a[184:187], v[136:139], v[104:107], a[184:187]
    v_cvt_pk_bf16_f32 v110, v100, v101
    v_add_f32 v22, v22, v102
    v_mfma_f32_16x16x32_bf16 a[212:215], v[140:143], v[104:107], a[212:215]
    v_add_f32 v23, v23, v103
    v_cvt_pk_bf16_f32 v111, v102, v103
    s_waitcnt lgkmcnt(0)
    v_mfma_f32_16x16x32_bf16 v[96:99], v[56:59], a[0:3], v[28:31]
    v_mfma_f32_16x16x32_bf16 v[96:99], v[60:63], a[4:7], v[96:99]
    v_exp_f32 v88, v88
    v_mfma_f32_16x16x32_bf16 v[96:99], v[64:67], a[8:11], v[96:99]
    v_exp_f32 v89, v89
    v_mfma_f32_16x16x32_bf16 v[96:99], v[68:71], a[12:15], v[96:99]
    v_exp_f32 v90, v90
    v_mfma_f32_16x16x32_bf16 v[100:103], v[84:87], a[12:15], v[28:31]
    v_exp_f32 v91, v91
    v_mfma_f32_16x16x32_bf16 v[100:103], v[80:83], a[8:11], v[100:103]
    v_add_f32 v24, v24, v88
    v_add_f32 v25, v25, v89
    v_mfma_f32_16x16x32_bf16 v[100:103], v[76:79], a[4:7], v[100:103]
    v_cvt_pk_bf16_f32 v104, v88, v89
    v_mfma_f32_16x16x32_bf16 v[100:103], v[72:75], a[0:3], v[100:103]
    v_exp_f32 v92, v92
    v_mfma_f32_16x16x32_bf16 v[164:167], v[112:115], v[108:111], v[164:167]
    v_exp_f32 v93, v93
    v_mfma_f32_16x16x32_bf16 v[192:195], v[116:119], v[108:111], v[192:195]
    v_add_f32 v24, v24, v90
    v_add_f32 v25, v25, v91
    v_mfma_f32_16x16x32_bf16 v[220:223], v[120:123], v[108:111], v[220:223]
    v_cvt_pk_bf16_f32 v105, v90, v91
    v_mfma_f32_16x16x32_bf16 v[248:251], v[124:127], v[108:111], v[248:251]
    v_exp_f32 v94, v94
    v_mfma_f32_16x16x32_bf16 a[132:135], v[128:131], v[108:111], a[132:135]
    v_exp_f32 v95, v95
    v_mfma_f32_16x16x32_bf16 a[160:163], v[132:135], v[108:111], a[160:163]
    v_add_f32 v24, v24, v92
    v_add_f32 v25, v25, v93
    v_mfma_f32_16x16x32_bf16 a[188:191], v[136:139], v[108:111], a[188:191]
    v_cvt_pk_bf16_f32 v106, v92, v93
    v_add_f32 v24, v24, v94
    v_mfma_f32_16x16x32_bf16 a[216:219], v[140:143], v[108:111], a[216:219]
    v_add_f32 v25, v25, v95
    v_cvt_pk_bf16_f32 v107, v94, v95
    v_mfma_f32_16x16x32_bf16 v[88:91], v[56:59], a[16:19], v[32:35]
    v_mfma_f32_16x16x32_bf16 v[88:91], v[60:63], a[20:23], v[88:91]
    v_exp_f32 v96, v96
    v_mfma_f32_16x16x32_bf16 v[88:91], v[64:67], a[24:27], v[88:91]
    v_exp_f32 v97, v97
    v_mfma_f32_16x16x32_bf16 v[88:91], v[68:71], a[28:31], v[88:91]
    v_exp_f32 v98, v98
    v_mfma_f32_16x16x32_bf16 v[92:95], v[84:87], a[28:31], v[32:35]
    v_exp_f32 v99, v99
    v_mfma_f32_16x16x32_bf16 v[92:95], v[80:83], a[24:27], v[92:95]
    v_add_f32 v12, v12, v96
    v_add_f32 v13, v13, v97
    v_mfma_f32_16x16x32_bf16 v[92:95], v[76:79], a[20:23], v[92:95]
    v_cvt_pk_bf16_f32 v108, v96, v97
    v_mfma_f32_16x16x32_bf16 v[92:95], v[72:75], a[16:19], v[92:95]
    v_exp_f32 v100, v100
    v_mfma_f32_16x16x32_bf16 v[168:171], v[112:115], v[104:107], v[168:171]
    ds_read_b64_tr_b16 v[112:113], v9 offset:25344
    ds_read_b64_tr_b16 v[114:115], v9 offset:25856
    v_exp_f32 v101, v101
    v_mfma_f32_16x16x32_bf16 v[196:199], v[116:119], v[104:107], v[196:199]
    ds_read_b64_tr_b16 v[116:117], v9 offset:25376
    ds_read_b64_tr_b16 v[118:119], v9 offset:25888
    v_add_f32 v12, v12, v98
    v_add_f32 v13, v13, v99
    v_mfma_f32_16x16x32_bf16 v[224:227], v[120:123], v[104:107], v[224:227]
    ds_read_b64_tr_b16 v[120:121], v9 offset:25408
    ds_read_b64_tr_b16 v[122:123], v9 offset:25920
    v_cvt_pk_bf16_f32 v109, v98, v99
    v_mfma_f32_16x16x32_bf16 v[252:255], v[124:127], v[104:107], v[252:255]
    ds_read_b64_tr_b16 v[124:125], v9 offset:25440
    ds_read_b64_tr_b16 v[126:127], v9 offset:25952
    v_exp_f32 v102, v102
    v_mfma_f32_16x16x32_bf16 a[136:139], v[128:131], v[104:107], a[136:139]
    ds_read_b64_tr_b16 v[128:129], v9 offset:25472
    ds_read_b64_tr_b16 v[130:131], v9 offset:25984
    v_exp_f32 v103, v103
    v_mfma_f32_16x16x32_bf16 a[164:167], v[132:135], v[104:107], a[164:167]
    ds_read_b64_tr_b16 v[132:133], v9 offset:25504
    ds_read_b64_tr_b16 v[134:135], v9 offset:26016
    v_add_f32 v12, v12, v100
    v_add_f32 v13, v13, v101
    v_mfma_f32_16x16x32_bf16 a[192:195], v[136:139], v[104:107], a[192:195]
    ds_read_b64_tr_b16 v[136:137], v9 offset:25536
    ds_read_b64_tr_b16 v[138:139], v9 offset:26048
    v_cvt_pk_bf16_f32 v110, v100, v101
    v_add_f32 v12, v12, v102
    v_mfma_f32_16x16x32_bf16 a[220:223], v[140:143], v[104:107], a[220:223]
    ds_read_b64_tr_b16 v[140:141], v9 offset:25568
    ds_read_b64_tr_b16 v[142:143], v9 offset:26080
    v_add_f32 v13, v13, v103
    v_cvt_pk_bf16_f32 v111, v102, v103
    v_mfma_f32_16x16x32_bf16 v[96:99], v[56:59], a[32:35], v[36:39]
    v_mfma_f32_16x16x32_bf16 v[96:99], v[60:63], a[36:39], v[96:99]
    s_add_u32 m0, s33, 16896
    v_exp_f32 v88, v88
    v_mfma_f32_16x16x32_bf16 v[96:99], v[64:67], a[40:43], v[96:99]
    v_exp_f32 v89, v89
    v_mfma_f32_16x16x32_bf16 v[96:99], v[68:71], a[44:47], v[96:99]
    s_mov_b32 s49, s50
    v_exp_f32 v90, v90
    v_mfma_f32_16x16x32_bf16 v[100:103], v[84:87], a[44:47], v[36:39]
    v_exp_f32 v91, v91
    v_mfma_f32_16x16x32_bf16 v[100:103], v[80:83], a[40:43], v[100:103]
    s_add_u32 s28, s49, s88
    v_add_f32 v14, v14, v88
    v_add_f32 v15, v15, v89
    v_mfma_f32_16x16x32_bf16 v[100:103], v[76:79], a[36:39], v[100:103]
    v_cvt_pk_bf16_f32 v104, v88, v89
    v_mfma_f32_16x16x32_bf16 v[100:103], v[72:75], a[32:35], v[100:103]
    v_exp_f32 v92, v92
    s_waitcnt lgkmcnt(0)
    v_mfma_f32_16x16x32_bf16 v[144:147], v[112:115], v[108:111], v[144:147]
    buffer_load_dwordx4 v26, s[16:19], s28 offen lds
    v_exp_f32 v93, v93
    v_mfma_f32_16x16x32_bf16 v[172:175], v[116:119], v[108:111], v[172:175]
    v_add_f32 v14, v14, v90
    v_add_f32 v15, v15, v91
    v_mfma_f32_16x16x32_bf16 v[200:203], v[120:123], v[108:111], v[200:203]
    s_add_u32 m0, m0, s53
    v_cvt_pk_bf16_f32 v105, v90, v91
    v_mfma_f32_16x16x32_bf16 v[228:231], v[124:127], v[108:111], v[228:231]
    v_exp_f32 v94, v94
    v_mfma_f32_16x16x32_bf16 a[112:115], v[128:131], v[108:111], a[112:115]
    s_add_u32 s28, s49, s89
    v_exp_f32 v95, v95
    v_mfma_f32_16x16x32_bf16 a[140:143], v[132:135], v[108:111], a[140:143]
    v_add_f32 v14, v14, v92
    v_add_f32 v15, v15, v93
    v_mfma_f32_16x16x32_bf16 a[168:171], v[136:139], v[108:111], a[168:171]
    buffer_load_dwordx4 v26, s[16:19], s28 offen lds
    v_cvt_pk_bf16_f32 v106, v92, v93
    v_add_f32 v14, v14, v94
    v_mfma_f32_16x16x32_bf16 a[196:199], v[140:143], v[108:111], a[196:199]
    v_add_f32 v15, v15, v95
    v_cvt_pk_bf16_f32 v107, v94, v95
    v_mfma_f32_16x16x32_bf16 v[88:91], v[56:59], a[48:51], v[40:43]
    v_mfma_f32_16x16x32_bf16 v[88:91], v[60:63], a[52:55], v[88:91]
    s_add_u32 m0, m0, s53
    v_exp_f32 v96, v96
    v_mfma_f32_16x16x32_bf16 v[88:91], v[64:67], a[56:59], v[88:91]
    v_exp_f32 v97, v97
    v_mfma_f32_16x16x32_bf16 v[88:91], v[68:71], a[60:63], v[88:91]
    s_add_u32 s28, s49, s90
    v_exp_f32 v98, v98
    v_mfma_f32_16x16x32_bf16 v[92:95], v[84:87], a[60:63], v[40:43]
    v_exp_f32 v99, v99
    v_mfma_f32_16x16x32_bf16 v[92:95], v[80:83], a[56:59], v[92:95]
    buffer_load_dwordx4 v26, s[16:19], s28 offen lds
    v_add_f32 v16, v16, v96
    v_add_f32 v17, v17, v97
    v_mfma_f32_16x16x32_bf16 v[92:95], v[76:79], a[52:55], v[92:95]
    v_cvt_pk_bf16_f32 v108, v96, v97
    v_mfma_f32_16x16x32_bf16 v[92:95], v[72:75], a[48:51], v[92:95]
    v_exp_f32 v100, v100
    v_mfma_f32_16x16x32_bf16 v[148:151], v[112:115], v[104:107], v[148:151]
    s_add_u32 m0, m0, s53
    v_exp_f32 v101, v101
    v_mfma_f32_16x16x32_bf16 v[176:179], v[116:119], v[104:107], v[176:179]
    v_add_f32 v16, v16, v98
    v_add_f32 v17, v17, v99
    v_mfma_f32_16x16x32_bf16 v[204:207], v[120:123], v[104:107], v[204:207]
    s_add_u32 s28, s49, s91
    v_cvt_pk_bf16_f32 v109, v98, v99
    v_mfma_f32_16x16x32_bf16 v[232:235], v[124:127], v[104:107], v[232:235]
    v_exp_f32 v102, v102
    v_mfma_f32_16x16x32_bf16 a[116:119], v[128:131], v[104:107], a[116:119]
    buffer_load_dwordx4 v26, s[16:19], s28 offen lds
    v_exp_f32 v103, v103
    v_mfma_f32_16x16x32_bf16 a[144:147], v[132:135], v[104:107], a[144:147]
    v_add_f32 v16, v16, v100
    v_add_f32 v17, v17, v101
    v_mfma_f32_16x16x32_bf16 a[172:175], v[136:139], v[104:107], a[172:175]
    s_add_u32 m0, m0, s53
    v_cvt_pk_bf16_f32 v110, v100, v101
    v_add_f32 v16, v16, v102
    v_mfma_f32_16x16x32_bf16 a[200:203], v[140:143], v[104:107], a[200:203]
    v_add_f32 v17, v17, v103
    v_cvt_pk_bf16_f32 v111, v102, v103
    v_mfma_f32_16x16x32_bf16 v[96:99], v[56:59], a[64:67], v[44:47]
    v_mfma_f32_16x16x32_bf16 v[96:99], v[60:63], a[68:71], v[96:99]
    s_add_u32 s28, s49, s92
    v_exp_f32 v88, v88
    v_mfma_f32_16x16x32_bf16 v[96:99], v[64:67], a[72:75], v[96:99]
    v_exp_f32 v89, v89
    v_mfma_f32_16x16x32_bf16 v[96:99], v[68:71], a[76:79], v[96:99]
    buffer_load_dwordx4 v26, s[16:19], s28 offen lds
    v_exp_f32 v90, v90
    v_mfma_f32_16x16x32_bf16 v[100:103], v[84:87], a[76:79], v[44:47]
    v_exp_f32 v91, v91
    v_mfma_f32_16x16x32_bf16 v[100:103], v[80:83], a[72:75], v[100:103]
    s_add_u32 m0, m0, s53
    v_add_f32 v18, v18, v88
    v_add_f32 v19, v19, v89
    v_mfma_f32_16x16x32_bf16 v[100:103], v[76:79], a[68:71], v[100:103]
    v_cvt_pk_bf16_f32 v104, v88, v89
    v_mfma_f32_16x16x32_bf16 v[100:103], v[72:75], a[64:67], v[100:103]
    v_exp_f32 v92, v92
    v_mfma_f32_16x16x32_bf16 v[152:155], v[112:115], v[108:111], v[152:155]
    s_add_u32 s28, s49, s93
    v_exp_f32 v93, v93
    v_mfma_f32_16x16x32_bf16 v[180:183], v[116:119], v[108:111], v[180:183]
    v_add_f32 v18, v18, v90
    v_add_f32 v19, v19, v91
    v_mfma_f32_16x16x32_bf16 v[208:211], v[120:123], v[108:111], v[208:211]
    buffer_load_dwordx4 v26, s[16:19], s28 offen lds
    v_cvt_pk_bf16_f32 v105, v90, v91
    v_mfma_f32_16x16x32_bf16 v[236:239], v[124:127], v[108:111], v[236:239]
    v_exp_f32 v94, v94
    v_mfma_f32_16x16x32_bf16 a[120:123], v[128:131], v[108:111], a[120:123]
    s_add_u32 m0, m0, s53
    v_exp_f32 v95, v95
    v_mfma_f32_16x16x32_bf16 a[148:151], v[132:135], v[108:111], a[148:151]
    v_add_f32 v18, v18, v92
    v_add_f32 v19, v19, v93
    v_mfma_f32_16x16x32_bf16 a[176:179], v[136:139], v[108:111], a[176:179]
    s_add_u32 s28, s49, s94
    v_cvt_pk_bf16_f32 v106, v92, v93
    v_add_f32 v18, v18, v94
    v_mfma_f32_16x16x32_bf16 a[204:207], v[140:143], v[108:111], a[204:207]
    v_add_f32 v19, v19, v95
    v_cvt_pk_bf16_f32 v107, v94, v95
    v_mfma_f32_16x16x32_bf16 v[88:91], v[56:59], a[80:83], v[48:51]
    v_mfma_f32_16x16x32_bf16 v[88:91], v[60:63], a[84:87], v[88:91]
    buffer_load_dwordx4 v26, s[16:19], s28 offen lds
    v_exp_f32 v96, v96
    v_mfma_f32_16x16x32_bf16 v[88:91], v[64:67], a[88:91], v[88:91]
    v_exp_f32 v97, v97
    v_mfma_f32_16x16x32_bf16 v[88:91], v[68:71], a[92:95], v[88:91]
    s_add_u32 m0, m0, s53
    v_exp_f32 v98, v98
    v_mfma_f32_16x16x32_bf16 v[92:95], v[84:87], a[92:95], v[48:51]
    v_exp_f32 v99, v99
    v_mfma_f32_16x16x32_bf16 v[92:95], v[80:83], a[88:91], v[92:95]
    s_add_u32 s28, s49, s95
    v_add_f32 v20, v20, v96
    v_add_f32 v21, v21, v97
    v_mfma_f32_16x16x32_bf16 v[92:95], v[76:79], a[84:87], v[92:95]
    v_cvt_pk_bf16_f32 v108, v96, v97
    v_mfma_f32_16x16x32_bf16 v[92:95], v[72:75], a[80:83], v[92:95]
    v_exp_f32 v100, v100
    v_mfma_f32_16x16x32_bf16 v[156:159], v[112:115], v[104:107], v[156:159]
    buffer_load_dwordx4 v26, s[16:19], s28 offen lds
    v_exp_f32 v101, v101
    v_mfma_f32_16x16x32_bf16 v[184:187], v[116:119], v[104:107], v[184:187]
    v_add_f32 v20, v20, v98
    v_add_f32 v21, v21, v99
    v_mfma_f32_16x16x32_bf16 v[212:215], v[120:123], v[104:107], v[212:215]
    v_cvt_pk_bf16_f32 v109, v98, v99
    v_mfma_f32_16x16x32_bf16 v[240:243], v[124:127], v[104:107], v[240:243]
    v_exp_f32 v102, v102
    v_mfma_f32_16x16x32_bf16 a[124:127], v[128:131], v[104:107], a[124:127]
    v_exp_f32 v103, v103
    v_mfma_f32_16x16x32_bf16 a[152:155], v[132:135], v[104:107], a[152:155]
    v_add_f32 v20, v20, v100
    v_add_f32 v21, v21, v101
    v_mfma_f32_16x16x32_bf16 a[180:183], v[136:139], v[104:107], a[180:183]
    v_cvt_pk_bf16_f32 v110, v100, v101
    v_add_f32 v20, v20, v102
    v_mfma_f32_16x16x32_bf16 a[208:211], v[140:143], v[104:107], a[208:211]
    v_add_f32 v21, v21, v103
    v_cvt_pk_bf16_f32 v111, v102, v103
    s_waitcnt vmcnt(8) lgkmcnt(0)
    s_barrier
    v_mfma_f32_16x16x32_bf16 v[96:99], v[56:59], a[96:99], v[52:55]
    s_add_u32 m0, s33, 25344
    v_mfma_f32_16x16x32_bf16 v[96:99], v[60:63], a[100:103], v[96:99]
    s_add_u32 s49, s50, s46
    v_exp_f32 v88, v88
    v_mfma_f32_16x16x32_bf16 v[96:99], v[64:67], a[104:107], v[96:99]
    s_lshl1_add_u32 s50, s51, s50
    v_exp_f32 v89, v89
    v_mfma_f32_16x16x32_bf16 v[96:99], v[68:71], a[108:111], v[96:99]
    s_add_u32 s82, s82, 2
    v_exp_f32 v90, v90
    v_mfma_f32_16x16x32_bf16 v[100:103], v[84:87], a[108:111], v[52:55]
    s_cmp_eq_u32 s82, 20
    v_exp_f32 v91, v91
    v_mfma_f32_16x16x32_bf16 v[100:103], v[80:83], a[104:107], v[100:103]
    s_cselect_b32 s29, s83, 0
    v_add_f32 v22, v22, v88
    v_add_f32 v23, v23, v89
    v_mfma_f32_16x16x32_bf16 v[100:103], v[76:79], a[100:103], v[100:103]
    s_sub_u32 s50, s50, s29
    v_cvt_pk_bf16_f32 v104, v88, v89
    v_mfma_f32_16x16x32_bf16 v[100:103], v[72:75], a[96:99], v[100:103]
    v_exp_f32 v92, v92
    v_mfma_f32_16x16x32_bf16 v[160:163], v[112:115], v[108:111], v[160:163]
    s_add_u32 s28, s49, s88
    v_exp_f32 v93, v93
    v_mfma_f32_16x16x32_bf16 v[188:191], v[116:119], v[108:111], v[188:191]
    buffer_load_dwordx4 v26, s[16:19], s28 offen lds
    v_add_f32 v22, v22, v90
    v_add_f32 v23, v23, v91
    v_mfma_f32_16x16x32_bf16 v[216:219], v[120:123], v[108:111], v[216:219]
    s_add_u32 m0, m0, s53
    v_cvt_pk_bf16_f32 v105, v90, v91
    v_mfma_f32_16x16x32_bf16 v[244:247], v[124:127], v[108:111], v[244:247]
    s_add_u32 s28, s49, s89
    v_exp_f32 v94, v94
    v_mfma_f32_16x16x32_bf16 a[128:131], v[128:131], v[108:111], a[128:131]
    buffer_load_dwordx4 v26, s[16:19], s28 offen lds
    v_exp_f32 v95, v95
    v_mfma_f32_16x16x32_bf16 a[156:159], v[132:135], v[108:111], a[156:159]
    s_add_u32 m0, m0, s53
    v_add_f32 v22, v22, v92
    v_add_f32 v23, v23, v93
    v_mfma_f32_16x16x32_bf16 a[184:187], v[136:139], v[108:111], a[184:187]
    s_add_u32 s28, s49, s90
    v_cvt_pk_bf16_f32 v106, v92, v93
    v_add_f32 v22, v22, v94
    v_mfma_f32_16x16x32_bf16 a[212:215], v[140:143], v[108:111], a[212:215]
    buffer_load_dwordx4 v26, s[16:19], s28 offen lds
    v_add_f32 v23, v23, v95
    v_cvt_pk_bf16_f32 v107, v94, v95
    s_nop 1
    v_mfma_f32_16x16x32_bf16 v[164:167], v[112:115], v[104:107], v[164:167]
    s_add_u32 m0, m0, s53
    s_add_u32 s28, s49, s91
    v_exp_f32 v96, v96
    v_mfma_f32_16x16x32_bf16 v[192:195], v[116:119], v[104:107], v[192:195]
    buffer_load_dwordx4 v26, s[16:19], s28 offen lds
    s_add_u32 m0, m0, s53
    v_exp_f32 v97, v97
    v_exp_f32 v98, v98
    v_mfma_f32_16x16x32_bf16 v[220:223], v[120:123], v[104:107], v[220:223]
    s_add_u32 s28, s49, s92
    buffer_load_dwordx4 v26, s[16:19], s28 offen lds
    v_exp_f32 v99, v99
    v_add_f32 v24, v24, v96
    v_add_f32 v25, v25, v97
    v_mfma_f32_16x16x32_bf16 v[248:251], v[124:127], v[104:107], v[248:251]
    s_add_u32 m0, m0, s53
    v_cvt_pk_bf16_f32 v108, v96, v97
    v_exp_f32 v100, v100
    v_mfma_f32_16x16x32_bf16 a[132:135], v[128:131], v[104:107], a[132:135]
    s_add_u32 s28, s49, s93
    buffer_load_dwordx4 v26, s[16:19], s28 offen lds
    v_exp_f32 v101, v101
    v_add_f32 v24, v24, v98
    v_add_f32 v25, v25, v99
    v_mfma_f32_16x16x32_bf16 a[160:163], v[132:135], v[104:107], a[160:163]
    s_add_u32 m0, m0, s53
    s_add_u32 s28, s49, s47
    v_cvt_pk_bf16_f32 v109, v98, v99
    v_exp_f32 v102, v102
    v_mfma_f32_16x16x32_bf16 a[188:191], v[136:139], v[104:107], a[188:191]
    buffer_load_dwordx4 v26, s[16:19], s28 offen lds
    s_add_u32 m0, m0, s53
    v_exp_f32 v103, v103
    v_add_f32 v24, v24, v100
    v_add_f32 v25, v25, v101
    v_mfma_f32_16x16x32_bf16 a[216:219], v[140:143], v[104:107], a[216:219]
    s_add_u32 s28, s49, s98
    buffer_load_dwordx4 v26, s[16:19], s28 offen lds
    v_cvt_pk_bf16_f32 v110, v100, v101
    v_add_f32 v24, v24, v102
    v_add_f32 v25, v25, v103
    v_cvt_pk_bf16_f32 v111, v102, v103
    s_branch L_at_aepi
L_at_atailB:
    v_mfma_f32_16x16x32_bf16 v[88:91], v[56:59], a[16:19], v[32:35]
    v_mfma_f32_16x16x32_bf16 v[88:91], v[60:63], a[20:23], v[88:91]
    v_exp_f32 v96, v96
    v_mfma_f32_16x16x32_bf16 v[88:91], v[64:67], a[24:27], v[88:91]
    v_exp_f32 v97, v97
    v_mfma_f32_16x16x32_bf16 v[88:91], v[68:71], a[28:31], v[88:91]
    v_exp_f32 v98, v98
    v_mfma_f32_16x16x32_bf16 v[92:95], v[84:87], a[28:31], v[32:35]
    v_exp_f32 v99, v99
    v_mfma_f32_16x16x32_bf16 v[92:95], v[80:83], a[24:27], v[92:95]
    v_add_f32 v12, v12, v96
    v_add_f32 v13, v13, v97
    v_mfma_f32_16x16x32_bf16 v[92:95], v[76:79], a[20:23], v[92:95]
    v_cvt_pk_bf16_f32 v108, v96, v97
    v_mfma_f32_16x16x32_bf16 v[92:95], v[72:75], a[16:19], v[92:95]
    v_exp_f32 v100, v100
    v_mfma_f32_16x16x32_bf16 v[168:171], v[112:115], v[104:107], v[168:171]
    ds_read_b64_tr_b16 v[112:113], v9 offset:8448
    ds_read_b64_tr_b16 v[114:115], v9 offset:8960
    v_exp_f32 v101, v101
    v_mfma_f32_16x16x32_bf16 v[196:199], v[116:119], v[104:107], v[196:199]
    ds_read_b64_tr_b16 v[116:117], v9 offset:8480
    ds_read_b64_tr_b16 v[118:119], v9 offset:8992
    v_add_f32 v12, v12, v98
    v_add_f32 v13, v13, v99
    v_mfma_f32_16x16x32_bf16 v[224:227], v[120:123], v[104:107], v[224:227]
    ds_read_b64_tr_b16 v[120:121], v9 offset:8512
    ds_read_b64_tr_b16 v[122:123], v9 offset:9024
    v_cvt_pk_bf16_f32 v109, v98, v99
    v_mfma_f32_16x16x32_bf16 v[252:255], v[124:127], v[104:107], v[252:255]
    ds_read_b64_tr_b16 v[124:125], v9 offset:8544
    ds_read_b64_tr_b16 v[126:127], v9 offset:9056
    v_exp_f32 v102, v102
    v_mfma_f32_16x16x32_bf16 a[136:139], v[128:131], v[104:107], a[136:139]
    ds_read_b64_tr_b16 v[128:129], v9 offset:8576
    ds_read_b64_tr_b16 v[130:131], v9 offset:9088
    v_exp_f32 v103, v103
    v_mfma_f32_16x16x32_bf16 a[164:167], v[132:135], v[104:107], a[164:167]
    ds_read_b64_tr_b16 v[132:133], v9 offset:8608
    ds_read_b64_tr_b16 v[134:135], v9 offset:9120
    v_add_f32 v12, v12, v100
    v_add_f32 v13, v13, v101
    v_mfma_f32_16x16x32_bf16 a[192:195], v[136:139], v[104:107], a[192:195]
    ds_read_b64_tr_b16 v[136:137], v9 offset:8640
    ds_read_b64_tr_b16 v[138:139], v9 offset:9152
    v_cvt_pk_bf16_f32 v110, v100, v101
    v_add_f32 v12, v12, v102
    v_mfma_f32_16x16x32_bf16 a[220:223], v[140:143], v[104:107], a[220:223]
    ds_read_b64_tr_b16 v[140:141], v9 offset:8672
    ds_read_b64_tr_b16 v[142:143], v9 offset:9184
    v_add_f32 v13, v13, v103
    v_cvt_pk_bf16_f32 v111, v102, v103
    v_mfma_f32_16x16x32_bf16 v[96:99], v[56:59], a[32:35], v[36:39]
    v_mfma_f32_16x16x32_bf16 v[96:99], v[60:63], a[36:39], v[96:99]
    s_add_u32 s29, s34, s100
    v_exp_f32 v88, v88
    v_mfma_f32_16x16x32_bf16 v[96:99], v[64:67], a[40:43], v[96:99]
    v_exp_f32 v89, v89
    v_mfma_f32_16x16x32_bf16 v[96:99], v[68:71], a[44:47], v[96:99]
    s_bfe_u32 s28, s29, 0x20003
    v_exp_f32 v90, v90
    v_mfma_f32_16x16x32_bf16 v[100:103], v[84:87], a[44:47], v[36:39]
    v_exp_f32 v91, v91
    v_mfma_f32_16x16x32_bf16 v[100:103], v[80:83], a[40:43], v[100:103]
    s_lshl_b32 s28, s28, 16
    v_add_f32 v14, v14, v88
    v_add_f32 v15, v15, v89
    v_mfma_f32_16x16x32_bf16 v[100:103], v[76:79], a[36:39], v[100:103]
    v_cvt_pk_bf16_f32 v104, v88, v89
    v_mfma_f32_16x16x32_bf16 v[100:103], v[72:75], a[32:35], v[100:103]
    v_exp_f32 v92, v92
    s_waitcnt lgkmcnt(0)
    v_mfma_f32_16x16x32_bf16 v[144:147], v[112:115], v[108:111], v[144:147]
    s_and_b32 s29, s29, 7
    v_exp_f32 v93, v93
    v_mfma_f32_16x16x32_bf16 v[172:175], v[116:119], v[108:111], v[172:175]
    v_add_f32 v14, v14, v90
    v_add_f32 v15, v15, v91
    v_mfma_f32_16x16x32_bf16 v[200:203], v[120:123], v[108:111], v[200:203]
    s_lshl_b32 s29, s29, 11
    v_cvt_pk_bf16_f32 v105, v90, v91
    v_mfma_f32_16x16x32_bf16 v[228:231], v[124:127], v[108:111], v[228:231]
    v_exp_f32 v94, v94
    v_mfma_f32_16x16x32_bf16 a[112:115], v[128:131], v[108:111], a[112:115]
    s_add_u32 s29, s28, s29
    v_exp_f32 v95, v95
    v_mfma_f32_16x16x32_bf16 a[140:143], v[132:135], v[108:111], a[140:143]
    v_add_f32 v14, v14, v92
    v_add_f32 v15, v15, v93
    v_mfma_f32_16x16x32_bf16 a[168:171], v[136:139], v[108:111], a[168:171]
    s_lshr_b32 s28, s34, 5
    v_cvt_pk_bf16_f32 v106, v92, v93
    v_add_f32 v14, v14, v94
    v_mfma_f32_16x16x32_bf16 a[196:199], v[140:143], v[108:111], a[196:199]
    v_add_f32 v15, v15, v95
    v_cvt_pk_bf16_f32 v107, v94, v95
    v_mfma_f32_16x16x32_bf16 v[88:91], v[56:59], a[48:51], v[40:43]
    v_mfma_f32_16x16x32_bf16 v[88:91], v[60:63], a[52:55], v[88:91]
    s_lshl_b32 s28, s28, 19
    v_exp_f32 v96, v96
    v_mfma_f32_16x16x32_bf16 v[88:91], v[64:67], a[56:59], v[88:91]
    v_exp_f32 v97, v97
    v_mfma_f32_16x16x32_bf16 v[88:91], v[68:71], a[60:63], v[88:91]
    s_add_u32 s49, s28, s29
    v_exp_f32 v98, v98
    v_mfma_f32_16x16x32_bf16 v[92:95], v[84:87], a[60:63], v[40:43]
    v_exp_f32 v99, v99
    v_mfma_f32_16x16x32_bf16 v[92:95], v[80:83], a[56:59], v[92:95]
    s_add_u32 m0, s33, 0
    v_add_f32 v16, v16, v96
    v_add_f32 v17, v17, v97
    v_mfma_f32_16x16x32_bf16 v[92:95], v[76:79], a[52:55], v[92:95]
    v_cvt_pk_bf16_f32 v108, v96, v97
    v_mfma_f32_16x16x32_bf16 v[92:95], v[72:75], a[48:51], v[92:95]
    v_exp_f32 v100, v100
    v_mfma_f32_16x16x32_bf16 v[148:151], v[112:115], v[104:107], v[148:151]
    s_add_u32 s34, s34, 1
    v_exp_f32 v101, v101
    v_mfma_f32_16x16x32_bf16 v[176:179], v[116:119], v[104:107], v[176:179]
    v_add_f32 v16, v16, v98
    v_add_f32 v17, v17, v99
    v_mfma_f32_16x16x32_bf16 v[204:207], v[120:123], v[104:107], v[204:207]
    buffer_load_dwordx4 v7, s[4:7], s49 offen offset:0 nt lds
    v_cvt_pk_bf16_f32 v109, v98, v99
    v_mfma_f32_16x16x32_bf16 v[232:235], v[124:127], v[104:107], v[232:235]
    v_exp_f32 v102, v102
    v_mfma_f32_16x16x32_bf16 a[116:119], v[128:131], v[104:107], a[116:119]
    s_add_u32 m0, m0, s96
    v_exp_f32 v103, v103
    v_mfma_f32_16x16x32_bf16 a[144:147], v[132:135], v[104:107], a[144:147]
    v_add_f32 v16, v16, v100
    v_add_f32 v17, v17, v101
    v_mfma_f32_16x16x32_bf16 a[172:175], v[136:139], v[104:107], a[172:175]
    buffer_load_dwordx4 v7, s[4:7], s49 offen offset:256 nt lds
    v_cvt_pk_bf16_f32 v110, v100, v101
    v_add_f32 v16, v16, v102
    v_mfma_f32_16x16x32_bf16 a[200:203], v[140:143], v[104:107], a[200:203]
    v_add_f32 v17, v17, v103
    v_cvt_pk_bf16_f32 v111, v102, v103
    v_mfma_f32_16x16x32_bf16 v[96:99], v[56:59], a[64:67], v[44:47]
    v_mfma_f32_16x16x32_bf16 v[96:99], v[60:63], a[68:71], v[96:99]
    s_add_u32 m0, m0, s97
    v_exp_f32 v88, v88
    v_mfma_f32_16x16x32_bf16 v[96:99], v[64:67], a[72:75], v[96:99]
    v_exp_f32 v89, v89
    v_mfma_f32_16x16x32_bf16 v[96:99], v[68:71], a[76:79], v[96:99]
    buffer_load_dwordx4 v7, s[4:7], s49 offen offset:512 nt lds
    v_exp_f32 v90, v90
    v_mfma_f32_16x16x32_bf16 v[100:103], v[84:87], a[76:79], v[44:47]
    v_exp_f32 v91, v91
    v_mfma_f32_16x16x32_bf16 v[100:103], v[80:83], a[72:75], v[100:103]
    s_add_u32 m0, m0, s96
    v_add_f32 v18, v18, v88
    v_add_f32 v19, v19, v89
    v_mfma_f32_16x16x32_bf16 v[100:103], v[76:79], a[68:71], v[100:103]
    v_cvt_pk_bf16_f32 v104, v88, v89
    v_mfma_f32_16x16x32_bf16 v[100:103], v[72:75], a[64:67], v[100:103]
    v_exp_f32 v92, v92
    v_mfma_f32_16x16x32_bf16 v[152:155], v[112:115], v[108:111], v[152:155]
    buffer_load_dwordx4 v7, s[4:7], s49 offen offset:768 nt lds
    v_exp_f32 v93, v93
    v_mfma_f32_16x16x32_bf16 v[180:183], v[116:119], v[108:111], v[180:183]
    v_add_f32 v18, v18, v90
    v_add_f32 v19, v19, v91
    v_mfma_f32_16x16x32_bf16 v[208:211], v[120:123], v[108:111], v[208:211]
    s_add_u32 m0, m0, s97
    v_cvt_pk_bf16_f32 v105, v90, v91
    v_mfma_f32_16x16x32_bf16 v[236:239], v[124:127], v[108:111], v[236:239]
    v_exp_f32 v94, v94
    v_mfma_f32_16x16x32_bf16 a[120:123], v[128:131], v[108:111], a[120:123]
    buffer_load_dwordx4 v7, s[4:7], s49 offen offset:1024 nt lds
    v_exp_f32 v95, v95
    v_mfma_f32_16x16x32_bf16 a[148:151], v[132:135], v[108:111], a[148:151]
    v_add_f32 v18, v18, v92
    v_add_f32 v19, v19, v93
    v_mfma_f32_16x16x32_bf16 a[176:179], v[136:139], v[108:111], a[176:179]
    s_add_u32 m0, m0, s96
    v_cvt_pk_bf16_f32 v106, v92, v93
    v_add_f32 v18, v18, v94
    v_mfma_f32_16x16x32_bf16 a[204:207], v[140:143], v[108:111], a[204:207]
    v_add_f32 v19, v19, v95
    v_cvt_pk_bf16_f32 v107, v94, v95
    v_mfma_f32_16x16x32_bf16 v[88:91], v[56:59], a[80:83], v[48:51]
    v_mfma_f32_16x16x32_bf16 v[88:91], v[60:63], a[84:87], v[88:91]
    buffer_load_dwordx4 v7, s[4:7], s49 offen offset:1280 nt lds
    v_exp_f32 v96, v96
    v_mfma_f32_16x16x32_bf16 v[88:91], v[64:67], a[88:91], v[88:91]
    v_exp_f32 v97, v97
    v_mfma_f32_16x16x32_bf16 v[88:91], v[68:71], a[92:95], v[88:91]
    s_add_u32 m0, m0, s97
    v_exp_f32 v98, v98
    v_mfma_f32_16x16x32_bf16 v[92:95], v[84:87], a[92:95], v[48:51]
    v_exp_f32 v99, v99
    v_mfma_f32_16x16x32_bf16 v[92:95], v[80:83], a[88:91], v[92:95]
    buffer_load_dwordx4 v7, s[4:7], s49 offen offset:1536 nt lds
    v_add_f32 v20, v20, v96
    v_add_f32 v21, v21, v97
    v_mfma_f32_16x16x32_bf16 v[92:95], v[76:79], a[84:87], v[92:95]
    v_cvt_pk_bf16_f32 v108, v96, v97
    v_mfma_f32_16x16x32_bf16 v[92:95], v[72:75], a[80:83], v[92:95]
    v_exp_f32 v100, v100
    v_mfma_f32_16x16x32_bf16 v[156:159], v[112:115], v[104:107], v[156:159]
    s_add_u32 m0, m0, s96
    v_exp_f32 v101, v101
    v_mfma_f32_16x16x32_bf16 v[184:187], v[116:119], v[104:107], v[184:187]
    v_add_f32 v20, v20, v98
    v_add_f32 v21, v21, v99
    v_mfma_f32_16x16x32_bf16 v[212:215], v[120:123], v[104:107], v[212:215]
    buffer_load_dwordx4 v7, s[4:7], s49 offen offset:1792 nt lds
    v_cvt_pk_bf16_f32 v109, v98, v99
    v_mfma_f32_16x16x32_bf16 v[240:243], v[124:127], v[104:107], v[240:243]
    v_exp_f32 v102, v102
    v_mfma_f32_16x16x32_bf16 a[124:127], v[128:131], v[104:107], a[124:127]
    v_exp_f32 v103, v103
    v_mfma_f32_16x16x32_bf16 a[152:155], v[132:135], v[104:107], a[152:155]
    v_add_f32 v20, v20, v100
    v_add_f32 v21, v21, v101
    v_mfma_f32_16x16x32_bf16 a[180:183], v[136:139], v[104:107], a[180:183]
    v_cvt_pk_bf16_f32 v110, v100, v101
    v_add_f32 v20, v20, v102
    v_mfma_f32_16x16x32_bf16 a[208:211], v[140:143], v[104:107], a[208:211]
    v_add_f32 v21, v21, v103
    v_cvt_pk_bf16_f32 v111, v102, v103
    s_waitcnt vmcnt(16) lgkmcnt(0)
    s_barrier
    v_mfma_f32_16x16x32_bf16 v[96:99], v[56:59], a[96:99], v[52:55]
    ds_read_b128 v[56:59], v8 offset:16896
    v_mfma_f32_16x16x32_bf16 v[96:99], v[60:63], a[100:103], v[96:99]
    ds_read_b128 v[60:63], v8 offset:16960
    v_exp_f32 v88, v88
    v_mfma_f32_16x16x32_bf16 v[96:99], v[64:67], a[104:107], v[96:99]
    ds_read_b128 v[64:67], v8 offset:17024
    v_exp_f32 v89, v89
    v_mfma_f32_16x16x32_bf16 v[96:99], v[68:71], a[108:111], v[96:99]
    ds_read_b128 v[68:71], v8 offset:17088
    v_exp_f32 v90, v90
    v_mfma_f32_16x16x32_bf16 v[100:103], v[84:87], a[108:111], v[52:55]
    ds_read_b128 v[84:87], v8 offset:17600
    v_exp_f32 v91, v91
    v_mfma_f32_16x16x32_bf16 v[100:103], v[80:83], a[104:107], v[100:103]
    ds_read_b128 v[80:83], v8 offset:17536
    v_add_f32 v22, v22, v88
    v_add_f32 v23, v23, v89
    v_mfma_f32_16x16x32_bf16 v[100:103], v[76:79], a[100:103], v[100:103]
    ds_read_b128 v[76:79], v8 offset:17472
    v_cvt_pk_bf16_f32 v104, v88, v89
    v_mfma_f32_16x16x32_bf16 v[100:103], v[72:75], a[96:99], v[100:103]
    ds_read_b128 v[72:75], v8 offset:17408
    v_exp_f32 v92, v92
    v_mfma_f32_16x16x32_bf16 v[160:163], v[112:115], v[108:111], v[160:163]
    v_exp_f32 v93, v93
    v_mfma_f32_16x16x32_bf16 v[188:191], v[116:119], v[108:111], v[188:191]
    v_add_f32 v22, v22, v90
    v_add_f32 v23, v23, v91
    v_mfma_f32_16x16x32_bf16 v[216:219], v[120:123], v[108:111], v[216:219]
    v_cvt_pk_bf16_f32 v105, v90, v91
    v_mfma_f32_16x16x32_bf16 v[244:247], v[124:127], v[108:111], v[244:247]
    v_exp_f32 v94, v94
    v_mfma_f32_16x16x32_bf16 a[128:131], v[128:131], v[108:111], a[128:131]
    v_exp_f32 v95, v95
    v_mfma_f32_16x16x32_bf16 a[156:159], v[132:135], v[108:111], a[156:159]
    v_add_f32 v22, v22, v92
    v_add_f32 v23, v23, v93
    v_mfma_f32_16x16x32_bf16 a[184:187], v[136:139], v[108:111], a[184:187]
    v_cvt_pk_bf16_f32 v106, v92, v93
    v_add_f32 v22, v22, v94
    v_mfma_f32_16x16x32_bf16 a[212:215], v[140:143], v[108:111], a[212:215]
    v_add_f32 v23, v23, v95
    v_cvt_pk_bf16_f32 v107, v94, v95
    s_waitcnt lgkmcnt(0)
    v_mfma_f32_16x16x32_bf16 v[88:91], v[56:59], a[0:3], v[28:31]
    v_mfma_f32_16x16x32_bf16 v[88:91], v[60:63], a[4:7], v[88:91]
    v_exp_f32 v96, v96
    v_mfma_f32_16x16x32_bf16 v[88:91], v[64:67], a[8:11], v[88:91]
    v_exp_f32 v97, v97
    v_mfma_f32_16x16x32_bf16 v[88:91], v[68:71], a[12:15], v[88:91]
    v_exp_f32 v98, v98
    v_mfma_f32_16x16x32_bf16 v[92:95], v[84:87], a[12:15], v[28:31]
    v_exp_f32 v99, v99
    v_mfma_f32_16x16x32_bf16 v[92:95], v[80:83], a[8:11], v[92:95]
    v_add_f32 v24, v24, v96
    v_add_f32 v25, v25, v97
    v_mfma_f32_16x16x32_bf16 v[92:95], v[76:79], a[4:7], v[92:95]
    v_cvt_pk_bf16_f32 v108, v96, v97
    v_mfma_f32_16x16x32_bf16 v[92:95], v[72:75], a[0:3], v[92:95]
    v_exp_f32 v100, v100
    v_mfma_f32_16x16x32_bf16 v[164:167], v[112:115], v[104:107], v[164:167]
    v_exp_f32 v101, v101
    v_mfma_f32_16x16x32_bf16 v[192:195], v[116:119], v[104:107], v[192:195]
    v_add_f32 v24, v24, v98
    v_add_f32 v25, v25, v99
    v_mfma_f32_16x16x32_bf16 v[220:223], v[120:123], v[104:107], v[220:223]
    v_cvt_pk_bf16_f32 v109, v98, v99
    v_mfma_f32_16x16x32_bf16 v[248:251], v[124:127], v[104:107], v[248:251]
    v_exp_f32 v102, v102
    v_mfma_f32_16x16x32_bf16 a[132:135], v[128:131], v[104:107], a[132:135]
    v_exp_f32 v103, v103
    v_mfma_f32_16x16x32_bf16 a[160:163], v[132:135], v[104:107], a[160:163]
    v_add_f32 v24, v24, v100
    v_add_f32 v25, v25, v101
    v_mfma_f32_16x16x32_bf16 a[188:191], v[136:139], v[104:107], a[188:191]
    v_cvt_pk_bf16_f32 v110, v100, v101
    v_add_f32 v24, v24, v102
    v_mfma_f32_16x16x32_bf16 a[216:219], v[140:143], v[104:107], a[216:219]
    v_add_f32 v25, v25, v103
    v_cvt_pk_bf16_f32 v111, v102, v103
    v_mfma_f32_16x16x32_bf16 v[96:99], v[56:59], a[16:19], v[32:35]
    v_mfma_f32_16x16x32_bf16 v[96:99], v[60:63], a[20:23], v[96:99]
    v_exp_f32 v88, v88
    v_mfma_f32_16x16x32_bf16 v[96:99], v[64:67], a[24:27], v[96:99]
    v_exp_f32 v89, v89
    v_mfma_f32_16x16x32_bf16 v[96:99], v[68:71], a[28:31], v[96:99]
    v_exp_f32 v90, v90
    v_mfma_f32_16x16x32_bf16 v[100:103], v[84:87], a[28:31], v[32:35]
    v_exp_f32 v91, v91
    v_mfma_f32_16x16x32_bf16 v[100:103], v[80:83], a[24:27], v[100:103]
    v_add_f32 v12, v12, v88
    v_add_f32 v13, v13, v89
    v_mfma_f32_16x16x32_bf16 v[100:103], v[76:79], a[20:23], v[100:103]
    v_cvt_pk_bf16_f32 v104, v88, v89
    v_mfma_f32_16x16x32_bf16 v[100:103], v[72:75], a[16:19], v[100:103]
    v_exp_f32 v92, v92
    v_mfma_f32_16x16x32_bf16 v[168:171], v[112:115], v[108:111], v[168:171]
    ds_read_b64_tr_b16 v[112:113], v9 offset:16896
    ds_read_b64_tr_b16 v[114:115], v9 offset:17408
    v_exp_f32 v93, v93
    v_mfma_f32_16x16x32_bf16 v[196:199], v[116:119], v[108:111], v[196:199]
    ds_read_b64_tr_b16 v[116:117], v9 offset:16928
    ds_read_b64_tr_b16 v[118:119], v9 offset:17440
    v_add_f32 v12, v12, v90
    v_add_f32 v13, v13, v91
    v_mfma_f32_16x16x32_bf16 v[224:227], v[120:123], v[108:111], v[224:227]
    ds_read_b64_tr_b16 v[120:121], v9 offset:16960
    ds_read_b64_tr_b16 v[122:123], v9 offset:17472
    v_cvt_pk_bf16_f32 v105, v90, v91
    v_mfma_f32_16x16x32_bf16 v[252:255], v[124:127], v[108:111], v[252:255]
    ds_read_b64_tr_b16 v[124:125], v9 offset:16992
    ds_read_b64_tr_b16 v[126:127], v9 offset:17504
    v_exp_f32 v94, v94
    v_mfma_f32_16x16x32_bf16 a[136:139], v[128:131], v[108:111], a[136:139]
    ds_read_b64_tr_b16 v[128:129], v9 offset:17024
    ds_read_b64_tr_b16 v[130:131], v9 offset:17536
    v_exp_f32 v95, v95
    v_mfma_f32_16x16x32_bf16 a[164:167], v[132:135], v[108:111], a[164:167]
    ds_read_b64_tr_b16 v[132:133], v9 offset:17056
    ds_read_b64_tr_b16 v[134:135], v9 offset:17568
    v_add_f32 v12, v12, v92
    v_add_f32 v13, v13, v93
    v_mfma_f32_16x16x32_bf16 a[192:195], v[136:139], v[108:111], a[192:195]
    ds_read_b64_tr_b16 v[136:137], v9 offset:17088
    ds_read_b64_tr_b16 v[138:139], v9 offset:17600
    v_cvt_pk_bf16_f32 v106, v92, v93
    v_add_f32 v12, v12, v94
    v_mfma_f32_16x16x32_bf16 a[220:223], v[140:143], v[108:111], a[220:223]
    ds_read_b64_tr_b16 v[140:141], v9 offset:17120
    ds_read_b64_tr_b16 v[142:143], v9 offset:17632
    v_add_f32 v13, v13, v95
    v_cvt_pk_bf16_f32 v107, v94, v95
    v_mfma_f32_16x16x32_bf16 v[88:91], v[56:59], a[32:35], v[36:39]
    v_mfma_f32_16x16x32_bf16 v[88:91], v[60:63], a[36:39], v[88:91]
    s_add_u32 s29, s34, s100
    v_exp_f32 v96, v96
    v_mfma_f32_16x16x32_bf16 v[88:91], v[64:67], a[40:43], v[88:91]
    v_exp_f32 v97, v97
    v_mfma_f32_16x16x32_bf16 v[88:91], v[68:71], a[44:47], v[88:91]
    s_bfe_u32 s28, s29, 0x20003
    v_exp_f32 v98, v98
    v_mfma_f32_16x16x32_bf16 v[92:95], v[84:87], a[44:47], v[36:39]
    v_exp_f32 v99, v99
    v_mfma_f32_16x16x32_bf16 v[92:95], v[80:83], a[40:43], v[92:95]
    s_lshl_b32 s28, s28, 16
    v_add_f32 v14, v14, v96
    v_add_f32 v15, v15, v97
    v_mfma_f32_16x16x32_bf16 v[92:95], v[76:79], a[36:39], v[92:95]
    v_cvt_pk_bf16_f32 v108, v96, v97
    v_mfma_f32_16x16x32_bf16 v[92:95], v[72:75], a[32:35], v[92:95]
    v_exp_f32 v100, v100
    s_waitcnt lgkmcnt(0)
    v_mfma_f32_16x16x32_bf16 v[144:147], v[112:115], v[104:107], v[144:147]
    s_and_b32 s29, s29, 7
    v_exp_f32 v101, v101
    v_mfma_f32_16x16x32_bf16 v[172:175], v[116:119], v[104:107], v[172:175]
    v_add_f32 v14, v14, v98
    v_add_f32 v15, v15, v99
    v_mfma_f32_16x16x32_bf16 v[200:203], v[120:123], v[104:107], v[200:203]
    s_lshl_b32 s29, s29, 11
    v_cvt_pk_bf16_f32 v109, v98, v99
    v_mfma_f32_16x16x32_bf16 v[228:231], v[124:127], v[104:107], v[228:231]
    v_exp_f32 v102, v102
    v_mfma_f32_16x16x32_bf16 a[112:115], v[128:131], v[104:107], a[112:115]
    s_add_u32 s29, s28, s29
    v_exp_f32 v103, v103
    v_mfma_f32_16x16x32_bf16 a[140:143], v[132:135], v[104:107], a[140:143]
    v_add_f32 v14, v14, v100
    v_add_f32 v15, v15, v101
    v_mfma_f32_16x16x32_bf16 a[168:171], v[136:139], v[104:107], a[168:171]
    s_lshr_b32 s28, s34, 5
    v_cvt_pk_bf16_f32 v110, v100, v101
    v_add_f32 v14, v14, v102
    v_mfma_f32_16x16x32_bf16 a[196:199], v[140:143], v[104:107], a[196:199]
    v_add_f32 v15, v15, v103
    v_cvt_pk_bf16_f32 v111, v102, v103
    v_mfma_f32_16x16x32_bf16 v[96:99], v[56:59], a[48:51], v[40:43]
    v_mfma_f32_16x16x32_bf16 v[96:99], v[60:63], a[52:55], v[96:99]
    s_lshl_b32 s28, s28, 19
    v_exp_f32 v88, v88
    v_mfma_f32_16x16x32_bf16 v[96:99], v[64:67], a[56:59], v[96:99]
    v_exp_f32 v89, v89
    v_mfma_f32_16x16x32_bf16 v[96:99], v[68:71], a[60:63], v[96:99]
    s_add_u32 s49, s28, s29
    v_exp_f32 v90, v90
    v_mfma_f32_16x16x32_bf16 v[100:103], v[84:87], a[60:63], v[40:43]
    v_exp_f32 v91, v91
    v_mfma_f32_16x16x32_bf16 v[100:103], v[80:83], a[56:59], v[100:103]
    s_add_u32 m0, s33, 8448
    v_add_f32 v16, v16, v88
    v_add_f32 v17, v17, v89
    v_mfma_f32_16x16x32_bf16 v[100:103], v[76:79], a[52:55], v[100:103]
    v_cvt_pk_bf16_f32 v104, v88, v89
    v_mfma_f32_16x16x32_bf16 v[100:103], v[72:75], a[48:51], v[100:103]
    v_exp_f32 v92, v92
    v_mfma_f32_16x16x32_bf16 v[148:151], v[112:115], v[108:111], v[148:151]
    s_add_u32 s34, s34, 1
    v_exp_f32 v93, v93
    v_mfma_f32_16x16x32_bf16 v[176:179], v[116:119], v[108:111], v[176:179]
    v_add_f32 v16, v16, v90
    v_add_f32 v17, v17, v91
    v_mfma_f32_16x16x32_bf16 v[204:207], v[120:123], v[108:111], v[204:207]
    buffer_load_dwordx4 v7, s[4:7], s49 offen offset:0 nt lds
    v_cvt_pk_bf16_f32 v105, v90, v91
    v_mfma_f32_16x16x32_bf16 v[232:235], v[124:127], v[108:111], v[232:235]
    v_exp_f32 v94, v94
    v_mfma_f32_16x16x32_bf16 a[116:119], v[128:131], v[108:111], a[116:119]
    s_add_u32 m0, m0, s96
    v_exp_f32 v95, v95
    v_mfma_f32_16x16x32_bf16 a[144:147], v[132:135], v[108:111], a[144:147]
    v_add_f32 v16, v16, v92
    v_add_f32 v17, v17, v93
    v_mfma_f32_16x16x32_bf16 a[172:175], v[136:139], v[108:111], a[172:175]
    buffer_load_dwordx4 v7, s[4:7], s49 offen offset:256 nt lds
    v_cvt_pk_bf16_f32 v106, v92, v93
    v_add_f32 v16, v16, v94
    v_mfma_f32_16x16x32_bf16 a[200:203], v[140:143], v[108:111], a[200:203]
    v_add_f32 v17, v17, v95
    v_cvt_pk_bf16_f32 v107, v94, v95
    v_mfma_f32_16x16x32_bf16 v[88:91], v[56:59], a[64:67], v[44:47]
    v_mfma_f32_16x16x32_bf16 v[88:91], v[60:63], a[68:71], v[88:91]
    s_add_u32 m0, m0, s97
    v_exp_f32 v96, v96
    v_mfma_f32_16x16x32_bf16 v[88:91], v[64:67], a[72:75], v[88:91]
    v_exp_f32 v97, v97
    v_mfma_f32_16x16x32_bf16 v[88:91], v[68:71], a[76:79], v[88:91]
    buffer_load_dwordx4 v7, s[4:7], s49 offen offset:512 nt lds
    v_exp_f32 v98, v98
    v_mfma_f32_16x16x32_bf16 v[92:95], v[84:87], a[76:79], v[44:47]
    v_exp_f32 v99, v99
    v_mfma_f32_16x16x32_bf16 v[92:95], v[80:83], a[72:75], v[92:95]
    s_add_u32 m0, m0, s96
    v_add_f32 v18, v18, v96
    v_add_f32 v19, v19, v97
    v_mfma_f32_16x16x32_bf16 v[92:95], v[76:79], a[68:71], v[92:95]
    v_cvt_pk_bf16_f32 v108, v96, v97
    v_mfma_f32_16x16x32_bf16 v[92:95], v[72:75], a[64:67], v[92:95]
    v_exp_f32 v100, v100
    v_mfma_f32_16x16x32_bf16 v[152:155], v[112:115], v[104:107], v[152:155]
    buffer_load_dwordx4 v7, s[4:7], s49 offen offset:768 nt lds
    v_exp_f32 v101, v101
    v_mfma_f32_16x16x32_bf16 v[180:183], v[116:119], v[104:107], v[180:183]
    v_add_f32 v18, v18, v98
    v_add_f32 v19, v19, v99
    v_mfma_f32_16x16x32_bf16 v[208:211], v[120:123], v[104:107], v[208:211]
    s_add_u32 m0, m0, s97
    v_cvt_pk_bf16_f32 v109, v98, v99
    v_mfma_f32_16x16x32_bf16 v[236:239], v[124:127], v[104:107], v[236:239]
    v_exp_f32 v102, v102
    v_mfma_f32_16x16x32_bf16 a[120:123], v[128:131], v[104:107], a[120:123]
    buffer_load_dwordx4 v7, s[4:7], s49 offen offset:1024 nt lds
    v_exp_f32 v103, v103
    v_mfma_f32_16x16x32_bf16 a[148:151], v[132:135], v[104:107], a[148:151]
    v_add_f32 v18, v18, v100
    v_add_f32 v19, v19, v101
    v_mfma_f32_16x16x32_bf16 a[176:179], v[136:139], v[104:107], a[176:179]
    s_add_u32 m0, m0, s96
    v_cvt_pk_bf16_f32 v110, v100, v101
    v_add_f32 v18, v18, v102
    v_mfma_f32_16x16x32_bf16 a[204:207], v[140:143], v[104:107], a[204:207]
    v_add_f32 v19, v19, v103
    v_cvt_pk_bf16_f32 v111, v102, v103
    v_mfma_f32_16x16x32_bf16 v[96:99], v[56:59], a[80:83], v[48:51]
    v_mfma_f32_16x16x32_bf16 v[96:99], v[60:63], a[84:87], v[96:99]
    buffer_load_dwordx4 v7, s[4:7], s49 offen offset:1280 nt lds
    v_exp_f32 v88, v88
    v_mfma_f32_16x16x32_bf16 v[96:99], v[64:67], a[88:91], v[96:99]
    v_exp_f32 v89, v89
    v_mfma_f32_16x16x32_bf16 v[96:99], v[68:71], a[92:95], v[96:99]
    s_add_u32 m0, m0, s97
    v_exp_f32 v90, v90
    v_mfma_f32_16x16x32_bf16 v[100:103], v[84:87], a[92:95], v[48:51]
    v_exp_f32 v91, v91
    v_mfma_f32_16x16x32_bf16 v[100:103], v[80:83], a[88:91], v[100:103]
    buffer_load_dwordx4 v7, s[4:7], s49 offen offset:1536 nt lds
    v_add_f32 v20, v20, v88
    v_add_f32 v21, v21, v89
    v_mfma_f32_16x16x32_bf16 v[100:103], v[76:79], a[84:87], v[100:103]
    v_cvt_pk_bf16_f32 v104, v88, v89
    v_mfma_f32_16x16x32_bf16 v[100:103], v[72:75], a[80:83], v[100:103]
    v_exp_f32 v92, v92
    v_mfma_f32_16x16x32_bf16 v[156:159], v[112:115], v[108:111], v[156:159]
    s_add_u32 m0, m0, s96
    v_exp_f32 v93, v93
    v_mfma_f32_16x16x32_bf16 v[184:187], v[116:119], v[108:111], v[184:187]
    v_add_f32 v20, v20, v90
    v_add_f32 v21, v21, v91
    v_mfma_f32_16x16x32_bf16 v[212:215], v[120:123], v[108:111], v[212:215]
    buffer_load_dwordx4 v7, s[4:7], s49 offen offset:1792 nt lds
    v_cvt_pk_bf16_f32 v105, v90, v91
    v_mfma_f32_16x16x32_bf16 v[240:243], v[124:127], v[108:111], v[240:243]
    v_exp_f32 v94, v94
    v_mfma_f32_16x16x32_bf16 a[124:127], v[128:131], v[108:111], a[124:127]
    v_exp_f32 v95, v95
    v_mfma_f32_16x16x32_bf16 a[152:155], v[132:135], v[108:111], a[152:155]
    v_add_f32 v20, v20, v92
    v_add_f32 v21, v21, v93
    v_mfma_f32_16x16x32_bf16 a[180:183], v[136:139], v[108:111], a[180:183]
    v_cvt_pk_bf16_f32 v106, v92, v93
    v_add_f32 v20, v20, v94
    v_mfma_f32_16x16x32_bf16 a[208:211], v[140:143], v[108:111], a[208:211]
    v_add_f32 v21, v21, v95
    v_cvt_pk_bf16_f32 v107, v94, v95
    s_waitcnt vmcnt(16) lgkmcnt(0)
    s_barrier
    v_mfma_f32_16x16x32_bf16 v[88:91], v[56:59], a[96:99], v[52:55]
    ds_read_b128 v[56:59], v8 offset:25344
    v_mfma_f32_16x16x32_bf16 v[88:91], v[60:63], a[100:103], v[88:91]
    ds_read_b128 v[60:63], v8 offset:25408
    v_exp_f32 v96, v96
    v_mfma_f32_16x16x32_bf16 v[88:91], v[64:67], a[104:107], v[88:91]
    ds_read_b128 v[64:67], v8 offset:25472
    v_exp_f32 v97, v97
    v_mfma_f32_16x16x32_bf16 v[88:91], v[68:71], a[108:111], v[88:91]
    ds_read_b128 v[68:71], v8 offset:25536
    v_exp_f32 v98, v98
    v_mfma_f32_16x16x32_bf16 v[92:95], v[84:87], a[108:111], v[52:55]
    ds_read_b128 v[84:87], v8 offset:26048
    v_exp_f32 v99, v99
    v_mfma_f32_16x16x32_bf16 v[92:95], v[80:83], a[104:107], v[92:95]
    ds_read_b128 v[80:83], v8 offset:25984
    v_add_f32 v22, v22, v96
    v_add_f32 v23, v23, v97
    v_mfma_f32_16x16x32_bf16 v[92:95], v[76:79], a[100:103], v[92:95]
    ds_read_b128 v[76:79], v8 offset:25920
    v_cvt_pk_bf16_f32 v108, v96, v97
    v_mfma_f32_16x16x32_bf16 v[92:95], v[72:75], a[96:99], v[92:95]
    ds_read_b128 v[72:75], v8 offset:25856
    v_exp_f32 v100, v100
    v_mfma_f32_16x16x32_bf16 v[160:163], v[112:115], v[104:107], v[160:163]
    v_exp_f32 v101, v101
    v_mfma_f32_16x16x32_bf16 v[188:191], v[116:119], v[104:107], v[188:191]
    v_add_f32 v22, v22, v98
    v_add_f32 v23, v23, v99
    v_mfma_f32_16x16x32_bf16 v[216:219], v[120:123], v[104:107], v[216:219]
    v_cvt_pk_bf16_f32 v109, v98, v99
    v_mfma_f32_16x16x32_bf16 v[244:247], v[124:127], v[104:107], v[244:247]
    v_exp_f32 v102, v102
    v_mfma_f32_16x16x32_bf16 a[128:131], v[128:131], v[104:107], a[128:131]
    v_exp_f32 v103, v103
    v_mfma_f32_16x16x32_bf16 a[156:159], v[132:135], v[104:107], a[156:159]
    v_add_f32 v22, v22, v100
    v_add_f32 v23, v23, v101
    v_mfma_f32_16x16x32_bf16 a[184:187], v[136:139], v[104:107], a[184:187]
    v_cvt_pk_bf16_f32 v110, v100, v101
    v_add_f32 v22, v22, v102
    v_mfma_f32_16x16x32_bf16 a[212:215], v[140:143], v[104:107], a[212:215]
    v_add_f32 v23, v23, v103
    v_cvt_pk_bf16_f32 v111, v102, v103
    s_waitcnt lgkmcnt(0)
    v_mfma_f32_16x16x32_bf16 v[96:99], v[56:59], a[0:3], v[28:31]
    v_mfma_f32_16x16x32_bf16 v[96:99], v[60:63], a[4:7], v[96:99]
    v_exp_f32 v88, v88
    v_mfma_f32_16x16x32_bf16 v[96:99], v[64:67], a[8:11], v[96:99]
    v_exp_f32 v89, v89
    v_mfma_f32_16x16x32_bf16 v[96:99], v[68:71], a[12:15], v[96:99]
    v_exp_f32 v90, v90
    v_mfma_f32_16x16x32_bf16 v[100:103], v[84:87], a[12:15], v[28:31]
    v_exp_f32 v91, v91
    v_mfma_f32_16x16x32_bf16 v[100:103], v[80:83], a[8:11], v[100:103]
    v_add_f32 v24, v24, v88
    v_add_f32 v25, v25, v89
    v_mfma_f32_16x16x32_bf16 v[100:103], v[76:79], a[4:7], v[100:103]
    v_cvt_pk_bf16_f32 v104, v88, v89
    v_mfma_f32_16x16x32_bf16 v[100:103], v[72:75], a[0:3], v[100:103]
    v_exp_f32 v92, v92
    v_mfma_f32_16x16x32_bf16 v[164:167], v[112:115], v[108:111], v[164:167]
    v_exp_f32 v93, v93
    v_mfma_f32_16x16x32_bf16 v[192:195], v[116:119], v[108:111], v[192:195]
    v_add_f32 v24, v24, v90
    v_add_f32 v25, v25, v91
    v_mfma_f32_16x16x32_bf16 v[220:223], v[120:123], v[108:111], v[220:223]
    v_cvt_pk_bf16_f32 v105, v90, v91
    v_mfma_f32_16x16x32_bf16 v[248:251], v[124:127], v[108:111], v[248:251]
    v_exp_f32 v94, v94
    v_mfma_f32_16x16x32_bf16 a[132:135], v[128:131], v[108:111], a[132:135]
    v_exp_f32 v95, v95
    v_mfma_f32_16x16x32_bf16 a[160:163], v[132:135], v[108:111], a[160:163]
    v_add_f32 v24, v24, v92
    v_add_f32 v25, v25, v93
    v_mfma_f32_16x16x32_bf16 a[188:191], v[136:139], v[108:111], a[188:191]
    v_cvt_pk_bf16_f32 v106, v92, v93
    v_add_f32 v24, v24, v94
    v_mfma_f32_16x16x32_bf16 a[216:219], v[140:143], v[108:111], a[216:219]
    v_add_f32 v25, v25, v95
    v_cvt_pk_bf16_f32 v107, v94, v95
    v_mfma_f32_16x16x32_bf16 v[88:91], v[56:59], a[16:19], v[32:35]
    v_mfma_f32_16x16x32_bf16 v[88:91], v[60:63], a[20:23], v[88:91]
    v_exp_f32 v96, v96
    v_mfma_f32_16x16x32_bf16 v[88:91], v[64:67], a[24:27], v[88:91]
    v_exp_f32 v97, v97
    v_mfma_f32_16x16x32_bf16 v[88:91], v[68:71], a[28:31], v[88:91]
    v_exp_f32 v98, v98
    v_mfma_f32_16x16x32_bf16 v[92:95], v[84:87], a[28:31], v[32:35]
    v_exp_f32 v99, v99
    v_mfma_f32_16x16x32_bf16 v[92:95], v[80:83], a[24:27], v[92:95]
    v_add_f32 v12, v12, v96
    v_add_f32 v13, v13, v97
    v_mfma_f32_16x16x32_bf16 v[92:95], v[76:79], a[20:23], v[92:95]
    v_cvt_pk_bf16_f32 v108, v96, v97
    v_mfma_f32_16x16x32_bf16 v[92:95], v[72:75], a[16:19], v[92:95]
    v_exp_f32 v100, v100
    v_mfma_f32_16x16x32_bf16 v[168:171], v[112:115], v[104:107], v[168:171]
    ds_read_b64_tr_b16 v[112:113], v9 offset:25344
    ds_read_b64_tr_b16 v[114:115], v9 offset:25856
    v_exp_f32 v101, v101
    v_mfma_f32_16x16x32_bf16 v[196:199], v[116:119], v[104:107], v[196:199]
    ds_read_b64_tr_b16 v[116:117], v9 offset:25376
    ds_read_b64_tr_b16 v[118:119], v9 offset:25888
    v_add_f32 v12, v12, v98
    v_add_f32 v13, v13, v99
    v_mfma_f32_16x16x32_bf16 v[224:227], v[120:123], v[104:107], v[224:227]
    ds_read_b64_tr_b16 v[120:121], v9 offset:25408
    ds_read_b64_tr_b16 v[122:123], v9 offset:25920
    v_cvt_pk_bf16_f32 v109, v98, v99
    v_mfma_f32_16x16x32_bf16 v[252:255], v[124:127], v[104:107], v[252:255]
    ds_read_b64_tr_b16 v[124:125], v9 offset:25440
    ds_read_b64_tr_b16 v[126:127], v9 offset:25952
    v_exp_f32 v102, v102
    v_mfma_f32_16x16x32_bf16 a[136:139], v[128:131], v[104:107], a[136:139]
    ds_read_b64_tr_b16 v[128:129], v9 offset:25472
    ds_read_b64_tr_b16 v[130:131], v9 offset:25984
    v_exp_f32 v103, v103
    v_mfma_f32_16x16x32_bf16 a[164:167], v[132:135], v[104:107], a[164:167]
    ds_read_b64_tr_b16 v[132:133], v9 offset:25504
    ds_read_b64_tr_b16 v[134:135], v9 offset:26016
    v_add_f32 v12, v12, v100
    v_add_f32 v13, v13, v101
    v_mfma_f32_16x16x32_bf16 a[192:195], v[136:139], v[104:107], a[192:195]
    ds_read_b64_tr_b16 v[136:137], v9 offset:25536
    ds_read_b64_tr_b16 v[138:139], v9 offset:26048
    v_cvt_pk_bf16_f32 v110, v100, v101
    v_add_f32 v12, v12, v102
    v_mfma_f32_16x16x32_bf16 a[220:223], v[140:143], v[104:107], a[220:223]
    ds_read_b64_tr_b16 v[140:141], v9 offset:25568
    ds_read_b64_tr_b16 v[142:143], v9 offset:26080
    v_add_f32 v13, v13, v103
    v_cvt_pk_bf16_f32 v111, v102, v103
    v_mfma_f32_16x16x32_bf16 v[96:99], v[56:59], a[32:35], v[36:39]
    v_mfma_f32_16x16x32_bf16 v[96:99], v[60:63], a[36:39], v[96:99]
    s_add_u32 s29, s34, s100
    v_exp_f32 v88, v88
    v_mfma_f32_16x16x32_bf16 v[96:99], v[64:67], a[40:43], v[96:99]
    v_exp_f32 v89, v89
    v_mfma_f32_16x16x32_bf16 v[96:99], v[68:71], a[44:47], v[96:99]
    s_bfe_u32 s28, s29, 0x20003
    v_exp_f32 v90, v90
    v_mfma_f32_16x16x32_bf16 v[100:103], v[84:87], a[44:47], v[36:39]
    v_exp_f32 v91, v91
    v_mfma_f32_16x16x32_bf16 v[100:103], v[80:83], a[40:43], v[100:103]
    s_lshl_b32 s28, s28, 16
    v_add_f32 v14, v14, v88
    v_add_f32 v15, v15, v89
    v_mfma_f32_16x16x32_bf16 v[100:103], v[76:79], a[36:39], v[100:103]
    v_cvt_pk_bf16_f32 v104, v88, v89
    v_mfma_f32_16x16x32_bf16 v[100:103], v[72:75], a[32:35], v[100:103]
    v_exp_f32 v92, v92
    s_waitcnt lgkmcnt(0)
    v_mfma_f32_16x16x32_bf16 v[144:147], v[112:115], v[108:111], v[144:147]
    s_and_b32 s29, s29, 7
    v_exp_f32 v93, v93
    v_mfma_f32_16x16x32_bf16 v[172:175], v[116:119], v[108:111], v[172:175]
    v_add_f32 v14, v14, v90
    v_add_f32 v15, v15, v91
    v_mfma_f32_16x16x32_bf16 v[200:203], v[120:123], v[108:111], v[200:203]
    s_lshl_b32 s29, s29, 11
    v_cvt_pk_bf16_f32 v105, v90, v91
    v_mfma_f32_16x16x32_bf16 v[228:231], v[124:127], v[108:111], v[228:231]
    v_exp_f32 v94, v94
    v_mfma_f32_16x16x32_bf16 a[112:115], v[128:131], v[108:111], a[112:115]
    s_add_u32 s29, s28, s29
    v_exp_f32 v95, v95
    v_mfma_f32_16x16x32_bf16 a[140:143], v[132:135], v[108:111], a[140:143]
    v_add_f32 v14, v14, v92
    v_add_f32 v15, v15, v93
    v_mfma_f32_16x16x32_bf16 a[168:171], v[136:139], v[108:111], a[168:171]
    s_lshr_b32 s28, s34, 5
    v_cvt_pk_bf16_f32 v106, v92, v93
    v_add_f32 v14, v14, v94
    v_mfma_f32_16x16x32_bf16 a[196:199], v[140:143], v[108:111], a[196:199]
    v_add_f32 v15, v15, v95
    v_cvt_pk_bf16_f32 v107, v94, v95
    v_mfma_f32_16x16x32_bf16 v[88:91], v[56:59], a[48:51], v[40:43]
    v_mfma_f32_16x16x32_bf16 v[88:91], v[60:63], a[52:55], v[88:91]
    s_lshl_b32 s28, s28, 19
    v_exp_f32 v96, v96
    v_mfma_f32_16x16x32_bf16 v[88:91], v[64:67], a[56:59], v[88:91]
    v_exp_f32 v97, v97
    v_mfma_f32_16x16x32_bf16 v[88:91], v[68:71], a[60:63], v[88:91]
    s_add_u32 s49, s28, s29
    v_exp_f32 v98, v98
    v_mfma_f32_16x16x32_bf16 v[92:95], v[84:87], a[60:63], v[40:43]
    v_exp_f32 v99, v99
    v_mfma_f32_16x16x32_bf16 v[92:95], v[80:83], a[56:59], v[92:95]
    s_add_u32 m0, s33, 16896
    v_add_f32 v16, v16, v96
    v_add_f32 v17, v17, v97
    v_mfma_f32_16x16x32_bf16 v[92:95], v[76:79], a[52:55], v[92:95]
    v_cvt_pk_bf16_f32 v108, v96, v97
    v_mfma_f32_16x16x32_bf16 v[92:95], v[72:75], a[48:51], v[92:95]
    v_exp_f32 v100, v100
    v_mfma_f32_16x16x32_bf16 v[148:151], v[112:115], v[104:107], v[148:151]
    s_add_u32 s34, s34, 1
    v_exp_f32 v101, v101
    v_mfma_f32_16x16x32_bf16 v[176:179], v[116:119], v[104:107], v[176:179]
    v_add_f32 v16, v16, v98
    v_add_f32 v17, v17, v99
    v_mfma_f32_16x16x32_bf16 v[204:207], v[120:123], v[104:107], v[204:207]
    buffer_load_dwordx4 v7, s[4:7], s49 offen offset:0 nt lds
    v_cvt_pk_bf16_f32 v109, v98, v99
    v_mfma_f32_16x16x32_bf16 v[232:235], v[124:127], v[104:107], v[232:235]
    v_exp_f32 v102, v102
    v_mfma_f32_16x16x32_bf16 a[116:119], v[128:131], v[104:107], a[116:119]
    s_add_u32 m0, m0, s96
    v_exp_f32 v103, v103
    v_mfma_f32_16x16x32_bf16 a[144:147], v[132:135], v[104:107], a[144:147]
    v_add_f32 v16, v16, v100
    v_add_f32 v17, v17, v101
    v_mfma_f32_16x16x32_bf16 a[172:175], v[136:139], v[104:107], a[172:175]
    buffer_load_dwordx4 v7, s[4:7], s49 offen offset:256 nt lds
    v_cvt_pk_bf16_f32 v110, v100, v101
    v_add_f32 v16, v16, v102
    v_mfma_f32_16x16x32_bf16 a[200:203], v[140:143], v[104:107], a[200:203]
    v_add_f32 v17, v17, v103
    v_cvt_pk_bf16_f32 v111, v102, v103
    v_mfma_f32_16x16x32_bf16 v[96:99], v[56:59], a[64:67], v[44:47]
    v_mfma_f32_16x16x32_bf16 v[96:99], v[60:63], a[68:71], v[96:99]
    s_add_u32 m0, m0, s97
    v_exp_f32 v88, v88
    v_mfma_f32_16x16x32_bf16 v[96:99], v[64:67], a[72:75], v[96:99]
    v_exp_f32 v89, v89
    v_mfma_f32_16x16x32_bf16 v[96:99], v[68:71], a[76:79], v[96:99]
    buffer_load_dwordx4 v7, s[4:7], s49 offen offset:512 nt lds
    v_exp_f32 v90, v90
    v_mfma_f32_16x16x32_bf16 v[100:103], v[84:87], a[76:79], v[44:47]
    v_exp_f32 v91, v91
    v_mfma_f32_16x16x32_bf16 v[100:103], v[80:83], a[72:75], v[100:103]
    s_add_u32 m0, m0, s96
    v_add_f32 v18, v18, v88
    v_add_f32 v19, v19, v89
    v_mfma_f32_16x16x32_bf16 v[100:103], v[76:79], a[68:71], v[100:103]
    v_cvt_pk_bf16_f32 v104, v88, v89
    v_mfma_f32_16x16x32_bf16 v[100:103], v[72:75], a[64:67], v[100:103]
    v_exp_f32 v92, v92
    v_mfma_f32_16x16x32_bf16 v[152:155], v[112:115], v[108:111], v[152:155]
    buffer_load_dwordx4 v7, s[4:7], s49 offen offset:768 nt lds
    v_exp_f32 v93, v93
    v_mfma_f32_16x16x32_bf16 v[180:183], v[116:119], v[108:111], v[180:183]
    v_add_f32 v18, v18, v90
    v_add_f32 v19, v19, v91
    v_mfma_f32_16x16x32_bf16 v[208:211], v[120:123], v[108:111], v[208:211]
    s_add_u32 m0, m0, s97
    v_cvt_pk_bf16_f32 v105, v90, v91
    v_mfma_f32_16x16x32_bf16 v[236:239], v[124:127], v[108:111], v[236:239]
    v_exp_f32 v94, v94
    v_mfma_f32_16x16x32_bf16 a[120:123], v[128:131], v[108:111], a[120:123]
    buffer_load_dwordx4 v7, s[4:7], s49 offen offset:1024 nt lds
    v_exp_f32 v95, v95
    v_mfma_f32_16x16x32_bf16 a[148:151], v[132:135], v[108:111], a[148:151]
    v_add_f32 v18, v18, v92
    v_add_f32 v19, v19, v93
    v_mfma_f32_16x16x32_bf16 a[176:179], v[136:139], v[108:111], a[176:179]
    s_add_u32 m0, m0, s96
    v_cvt_pk_bf16_f32 v106, v92, v93
    v_add_f32 v18, v18, v94
    v_mfma_f32_16x16x32_bf16 a[204:207], v[140:143], v[108:111], a[204:207]
    v_add_f32 v19, v19, v95
    v_cvt_pk_bf16_f32 v107, v94, v95
    v_mfma_f32_16x16x32_bf16 v[88:91], v[56:59], a[80:83], v[48:51]
    v_mfma_f32_16x16x32_bf16 v[88:91], v[60:63], a[84:87], v[88:91]
    buffer_load_dwordx4 v7, s[4:7], s49 offen offset:1280 nt lds
    v_exp_f32 v96, v96
    v_mfma_f32_16x16x32_bf16 v[88:91], v[64:67], a[88:91], v[88:91]
    v_exp_f32 v97, v97
    v_mfma_f32_16x16x32_bf16 v[88:91], v[68:71], a[92:95], v[88:91]
    s_add_u32 m0, m0, s97
    v_exp_f32 v98, v98
    v_mfma_f32_16x16x32_bf16 v[92:95], v[84:87], a[92:95], v[48:51]
    v_exp_f32 v99, v99
    v_mfma_f32_16x16x32_bf16 v[92:95], v[80:83], a[88:91], v[92:95]
    buffer_load_dwordx4 v7, s[4:7], s49 offen offset:1536 nt lds
    v_add_f32 v20, v20, v96
    v_add_f32 v21, v21, v97
    v_mfma_f32_16x16x32_bf16 v[92:95], v[76:79], a[84:87], v[92:95]
    v_cvt_pk_bf16_f32 v108, v96, v97
    v_mfma_f32_16x16x32_bf16 v[92:95], v[72:75], a[80:83], v[92:95]
    v_exp_f32 v100, v100
    v_mfma_f32_16x16x32_bf16 v[156:159], v[112:115], v[104:107], v[156:159]
    s_add_u32 m0, m0, s96
    v_exp_f32 v101, v101
    v_mfma_f32_16x16x32_bf16 v[184:187], v[116:119], v[104:107], v[184:187]
    v_add_f32 v20, v20, v98
    v_add_f32 v21, v21, v99
    v_mfma_f32_16x16x32_bf16 v[212:215], v[120:123], v[104:107], v[212:215]
    buffer_load_dwordx4 v7, s[4:7], s49 offen offset:1792 nt lds
    v_cvt_pk_bf16_f32 v109, v98, v99
    v_mfma_f32_16x16x32_bf16 v[240:243], v[124:127], v[104:107], v[240:243]
    v_exp_f32 v102, v102
    v_mfma_f32_16x16x32_bf16 a[124:127], v[128:131], v[104:107], a[124:127]
    v_exp_f32 v103, v103
    v_mfma_f32_16x16x32_bf16 a[152:155], v[132:135], v[104:107], a[152:155]
    v_add_f32 v20, v20, v100
    v_add_f32 v21, v21, v101
    v_mfma_f32_16x16x32_bf16 a[180:183], v[136:139], v[104:107], a[180:183]
    v_cvt_pk_bf16_f32 v110, v100, v101
    v_add_f32 v20, v20, v102
    v_mfma_f32_16x16x32_bf16 a[208:211], v[140:143], v[104:107], a[208:211]
    v_add_f32 v21, v21, v103
    v_cvt_pk_bf16_f32 v111, v102, v103
    s_waitcnt vmcnt(16) lgkmcnt(0)
    s_barrier
    v_mfma_f32_16x16x32_bf16 v[96:99], v[56:59], a[96:99], v[52:55]
    ds_read_b128 v[56:59], v8 offset:0
    s_add_u32 s29, s34, s100
    v_mfma_f32_16x16x32_bf16 v[96:99], v[60:63], a[100:103], v[96:99]
    ds_read_b128 v[60:63], v8 offset:64
    s_bfe_u32 s28, s29, 0x20003
    v_exp_f32 v88, v88
    v_mfma_f32_16x16x32_bf16 v[96:99], v[64:67], a[104:107], v[96:99]
    ds_read_b128 v[64:67], v8 offset:128
    s_lshl_b32 s28, s28, 16
    v_exp_f32 v89, v89
    v_mfma_f32_16x16x32_bf16 v[96:99], v[68:71], a[108:111], v[96:99]
    ds_read_b128 v[68:71], v8 offset:192
    s_and_b32 s29, s29, 7
    v_exp_f32 v90, v90
    v_mfma_f32_16x16x32_bf16 v[100:103], v[84:87], a[108:111], v[52:55]
    ds_read_b128 v[84:87], v8 offset:704
    s_lshl_b32 s29, s29, 11
    v_exp_f32 v91, v91
    v_mfma_f32_16x16x32_bf16 v[100:103], v[80:83], a[104:107], v[100:103]
    ds_read_b128 v[80:83], v8 offset:640
    s_add_u32 s29, s28, s29
    v_add_f32 v22, v22, v88
    v_add_f32 v23, v23, v89
    v_mfma_f32_16x16x32_bf16 v[100:103], v[76:79], a[100:103], v[100:103]
    ds_read_b128 v[76:79], v8 offset:576
    s_lshr_b32 s28, s34, 5
    v_cvt_pk_bf16_f32 v104, v88, v89
    v_mfma_f32_16x16x32_bf16 v[100:103], v[72:75], a[96:99], v[100:103]
    ds_read_b128 v[72:75], v8 offset:512
    s_lshl_b32 s28, s28, 19
    v_exp_f32 v92, v92
    v_mfma_f32_16x16x32_bf16 v[160:163], v[112:115], v[108:111], v[160:163]
    s_add_u32 s49, s28, s29
    s_add_u32 m0, s33, 25344
    v_exp_f32 v93, v93
    v_mfma_f32_16x16x32_bf16 v[188:191], v[116:119], v[108:111], v[188:191]
    s_add_u32 s34, s34, 1
    v_add_f32 v22, v22, v90
    v_add_f32 v23, v23, v91
    v_mfma_f32_16x16x32_bf16 v[216:219], v[120:123], v[108:111], v[216:219]
    s_nop 0
    v_cvt_pk_bf16_f32 v105, v90, v91
    v_mfma_f32_16x16x32_bf16 v[244:247], v[124:127], v[108:111], v[244:247]
    buffer_load_dwordx4 v7, s[4:7], s49 offen offset:0 nt lds
    v_exp_f32 v94, v94
    v_mfma_f32_16x16x32_bf16 a[128:131], v[128:131], v[108:111], a[128:131]
    s_add_u32 m0, m0, s96
    v_exp_f32 v95, v95
    v_mfma_f32_16x16x32_bf16 a[156:159], v[132:135], v[108:111], a[156:159]
    s_nop 0
    v_add_f32 v22, v22, v92
    v_add_f32 v23, v23, v93
    v_mfma_f32_16x16x32_bf16 a[184:187], v[136:139], v[108:111], a[184:187]
    buffer_load_dwordx4 v7, s[4:7], s49 offen offset:256 nt lds
    v_cvt_pk_bf16_f32 v106, v92, v93
    v_add_f32 v22, v22, v94
    v_mfma_f32_16x16x32_bf16 a[212:215], v[140:143], v[108:111], a[212:215]
    s_add_u32 m0, m0, s97
    v_add_f32 v23, v23, v95
    v_cvt_pk_bf16_f32 v107, v94, v95
    s_lshl_b32 s30, s2, 2
    s_add_u32 s30, s30, s20
    s_mul_i32 s30, s30, 28672
    v_lshlrev_b32 v4, 4, v1
    buffer_load_dwordx4 a[0:3], v4, s[12:15], s30 offen offset:0
    buffer_load_dwordx4 a[4:7], v4, s[12:15], s30 offen offset:1024
    buffer_load_dwordx4 a[8:11], v4, s[12:15], s30 offen offset:2048
    buffer_load_dwordx4 a[12:15], v4, s[12:15], s30 offen offset:3072
    s_add_u32 s30, s30, 4096
    buffer_load_dwordx4 a[16:19], v4, s[12:15], s30 offen offset:0
    buffer_load_dwordx4 a[20:23], v4, s[12:15], s30 offen offset:1024
    buffer_load_dwordx4 a[24:27], v4, s[12:15], s30 offen offset:2048
    buffer_load_dwordx4 a[28:31], v4, s[12:15], s30 offen offset:3072
    s_add_u32 s30, s30, 4096
    buffer_load_dwordx4 a[32:35], v4, s[12:15], s30 offen offset:0
    buffer_load_dwordx4 a[36:39], v4, s[12:15], s30 offen offset:1024
    buffer_load_dwordx4 a[40:43], v4, s[12:15], s30 offen offset:2048
    buffer_load_dwordx4 a[44:47], v4, s[12:15], s30 offen offset:3072
    s_add_u32 s30, s30, 4096
    buffer_load_dwordx4 a[48:51], v4, s[12:15], s30 offen offset:0
    buffer_load_dwordx4 a[52:55], v4, s[12:15], s30 offen offset:1024
    buffer_load_dwordx4 a[56:59], v4, s[12:15], s30 offen offset:2048
    buffer_load_dwordx4 a[60:63], v4, s[12:15], s30 offen offset:3072
    s_add_u32 s30, s30, 4096
    buffer_load_dwordx4 a[64:67], v4, s[12:15], s30 offen offset:0
    buffer_load_dwordx4 a[68:71], v4, s[12:15], s30 offen offset:1024
    buffer_load_dwordx4 a[72:75], v4, s[12:15], s30 offen offset:2048
    buffer_load_dwordx4 a[76:79], v4, s[12:15], s30 offen offset:3072
    s_add_u32 s30, s30, 4096
    buffer_load_dwordx4 a[80:83], v4, s[12:15], s30 offen offset:0
    buffer_load_dwordx4 a[84:87], v4, s[12:15], s30 offen offset:1024
    buffer_load_dwordx4 a[88:91], v4, s[12:15], s30 offen offset:2048
    buffer_load_dwordx4 a[92:95], v4, s[12:15], s30 offen offset:3072
    s_add_u32 s30, s30, 4096
    buffer_load_dwordx4 a[96:99], v4, s[12:15], s30 offen offset:0
    buffer_load_dwordx4 a[100:103], v4, s[12:15], s30 offen offset:1024
    buffer_load_dwordx4 a[104:107], v4, s[12:15], s30 offen offset:2048
    buffer_load_dwordx4 a[108:111], v4, s[12:15], s30 offen offset:3072
    s_nop 1
    v_mfma_f32_16x16x32_bf16 v[164:167], v[112:115], v[104:107], v[164:167]
    s_nop 0
    buffer_load_dwordx4 v7, s[4:7], s49 offen offset:512 nt lds
    v_exp_f32 v96, v96
    v_mfma_f32_16x16x32_bf16 v[192:195], v[116:119], v[104:107], v[192:195]
    s_add_u32 m0, m0, s96
    s_nop 0
    v_exp_f32 v97, v97
    v_exp_f32 v98, v98
    v_mfma_f32_16x16x32_bf16 v[220:223], v[120:123], v[104:107], v[220:223]
    buffer_load_dwordx4 v7, s[4:7], s49 offen offset:768 nt lds
    s_add_u32 m0, m0, s97
    v_exp_f32 v99, v99
    v_add_f32 v24, v24, v96
    v_add_f32 v25, v25, v97
    v_mfma_f32_16x16x32_bf16 v[248:251], v[124:127], v[104:107], v[248:251]
    s_nop 0
    buffer_load_dwordx4 v7, s[4:7], s49 offen offset:1024 nt lds
    v_cvt_pk_bf16_f32 v108, v96, v97
    v_exp_f32 v100, v100
    v_mfma_f32_16x16x32_bf16 a[132:135], v[128:131], v[104:107], a[132:135]
    s_add_u32 m0, m0, s96
    s_nop 0
    buffer_load_dwordx4 v7, s[4:7], s49 offen offset:1280 nt lds
    v_exp_f32 v101, v101
    v_add_f32 v24, v24, v98
    v_add_f32 v25, v25, v99
    v_mfma_f32_16x16x32_bf16 a[160:163], v[132:135], v[104:107], a[160:163]
    s_add_u32 m0, m0, s97
    s_nop 0
    v_cvt_pk_bf16_f32 v109, v98, v99
    v_exp_f32 v102, v102
    v_mfma_f32_16x16x32_bf16 a[188:191], v[136:139], v[104:107], a[188:191]
    buffer_load_dwordx4 v7, s[4:7], s49 offen offset:1536 nt lds
    s_add_u32 m0, m0, s96
    v_exp_f32 v103, v103
    v_add_f32 v24, v24, v100
    v_add_f32 v25, v25, v101
    v_mfma_f32_16x16x32_bf16 a[216:219], v[140:143], v[104:107], a[216:219]
    s_nop 0
    buffer_load_dwordx4 v7, s[4:7], s49 offen offset:1792 nt lds
    v_cvt_pk_bf16_f32 v110, v100, v101
    v_add_f32 v24, v24, v102
    v_add_f32 v25, v25, v103
    v_cvt_pk_bf16_f32 v111, v102, v103
L_at_aepi:
    s_nop 1
    s_waitcnt lgkmcnt(0)
    v_mfma_f32_16x16x32_bf16 v[168:171], v[112:115], v[108:111], v[168:171]
    v_add_f32 v12, v12, v13
    v_add_f32 v14, v14, v15
    v_add_f32 v16, v16, v17
    v_add_f32 v18, v18, v19
    v_add_f32 v20, v20, v21
    v_add_f32 v22, v22, v23
    v_mfma_f32_16x16x32_bf16 v[196:199], v[116:119], v[108:111], v[196:199]
    v_add_f32 v24, v24, v25
    v_mov_b32 v88, v12
    v_mov_b32 v89, v14
    v_mov_b32 v90, v16
    v_mov_b32 v91, v18
    v_mov_b32 v92, v20
    v_mfma_f32_16x16x32_bf16 v[224:227], v[120:123], v[108:111], v[224:227]
    v_mov_b32 v93, v22
    v_mov_b32 v94, v24
    v_permlane16_swap_b32 v12, v88
    v_permlane16_swap_b32 v14, v89
    v_permlane16_swap_b32 v16, v90
    v_permlane16_swap_b32 v18, v91
    v_mfma_f32_16x16x32_bf16 v[252:255], v[124:127], v[108:111], v[252:255]
    v_permlane16_swap_b32 v20, v92
    v_permlane16_swap_b32 v22, v93
    v_permlane16_swap_b32 v24, v94
    v_add_f32 v12, v12, v88
    v_add_f32 v14, v14, v89
    v_add_f32 v16, v16, v90
    v_mfma_f32_16x16x32_bf16 a[136:139], v[128:131], v[108:111], a[136:139]
    v_add_f32 v18, v18, v91
    v_add_f32 v20, v20, v92
    v_add_f32 v22, v22, v93
    v_add_f32 v24, v24, v94
    v_mov_b32 v88, v12
    v_mov_b32 v89, v14
    v_mfma_f32_16x16x32_bf16 a[164:167], v[132:135], v[108:111], a[164:167]
    v_mov_b32 v90, v16
    v_mov_b32 v91, v18
    v_mov_b32 v92, v20
    v_mov_b32 v93, v22
    v_mov_b32 v94, v24
    v_permlane32_swap_b32 v12, v88
    v_mfma_f32_16x16x32_bf16 a[192:195], v[136:139], v[108:111], a[192:195]
    v_permlane32_swap_b32 v14, v89
    v_permlane32_swap_b32 v16, v90
    v_permlane32_swap_b32 v18, v91
    v_permlane32_swap_b32 v20, v92
    v_permlane32_swap_b32 v22, v93
    v_permlane32_swap_b32 v24, v94
    v_mfma_f32_16x16x32_bf16 a[220:223], v[140:143], v[108:111], a[220:223]
    v_add_f32 v12, v12, v88
    v_add_f32 v14, v14, v89
    v_add_f32 v16, v16, v90
    v_add_f32 v18, v18, v91
    v_add_f32 v20, v20, v92
    v_add_f32 v22, v22, v93
    v_add_f32 v24, v24, v94
    v_rcp_f32 v28, v12
    v_rcp_f32 v32, v14
    v_rcp_f32 v36, v16
    v_rcp_f32 v40, v18
    v_rcp_f32 v44, v20
    v_rcp_f32 v48, v22
    v_rcp_f32 v52, v24
    v_add_f32 v90, v12, v14
    v_add_f32 v91, v16, v18
    v_add_f32 v92, v20, v22
    v_add_f32 v90, v90, v24
    v_add_f32 v91, v91, v92
    v_add_f32 v90, v90, v91
    v_cmp_nge_f32 vcc, s32, v90
    v_mov_b32 v12, 0xff800000
    v_mov_b32 v14, 0xff800000
    v_mov_b32 v16, 0xff800000
    v_mov_b32 v18, 0xff800000
    v_mov_b32 v20, 0xff800000
    v_mov_b32 v22, 0xff800000
    v_mov_b32 v24, 0xff800000
    s_cmp_eq_u64 vcc, 0
    s_cbranch_scc1 L_at_noflag
    s_lshl_b32 s29, s21, 2
    s_add_u32 s29, s29, 75996
    v_mov_b32 v90, s29
    v_mov_b32 v91, 1
    ds_write_b32 v90, v91
L_at_noflag:
    s_mul_i32 s31, s21, 114688
    s_add_u32 s31, s31, s24
    s_sub_u32 s31, s31, 114688
    v_pk_mul_f32 v[144:145], v[144:145], v[28:29] op_sel_hi:[1,0]
    v_pk_mul_f32 v[146:147], v[146:147], v[28:29] op_sel_hi:[1,0]
    v_pk_mul_f32 v[148:149], v[148:149], v[32:33] op_sel_hi:[1,0]
    v_pk_mul_f32 v[150:151], v[150:151], v[32:33] op_sel_hi:[1,0]
    v_pk_mul_f32 v[152:153], v[152:153], v[36:37] op_sel_hi:[1,0]
    v_pk_mul_f32 v[154:155], v[154:155], v[36:37] op_sel_hi:[1,0]
    v_pk_mul_f32 v[156:157], v[156:157], v[40:41] op_sel_hi:[1,0]
    v_pk_mul_f32 v[158:159], v[158:159], v[40:41] op_sel_hi:[1,0]
    v_pk_mul_f32 v[160:161], v[160:161], v[44:45] op_sel_hi:[1,0]
    v_pk_mul_f32 v[162:163], v[162:163], v[44:45] op_sel_hi:[1,0]
    v_pk_mul_f32 v[164:165], v[164:165], v[48:49] op_sel_hi:[1,0]
    v_pk_mul_f32 v[166:167], v[166:167], v[48:49] op_sel_hi:[1,0]
    v_pk_mul_f32 v[168:169], v[168:169], v[52:53] op_sel_hi:[1,0]
    v_pk_mul_f32 v[170:171], v[170:171], v[52:53] op_sel_hi:[1,0]
    v_pk_mul_f32 v[172:173], v[172:173], v[28:29] op_sel_hi:[1,0]
    v_pk_mul_f32 v[174:175], v[174:175], v[28:29] op_sel_hi:[1,0]
    v_pk_mul_f32 v[176:177], v[176:177], v[32:33] op_sel_hi:[1,0]
    v_pk_mul_f32 v[178:179], v[178:179], v[32:33] op_sel_hi:[1,0]
    v_pk_mul_f32 v[180:181], v[180:181], v[36:37] op_sel_hi:[1,0]
    v_pk_mul_f32 v[182:183], v[182:183], v[36:37] op_sel_hi:[1,0]
    v_pk_mul_f32 v[184:185], v[184:185], v[40:41] op_sel_hi:[1,0]
    v_pk_mul_f32 v[186:187], v[186:187], v[40:41] op_sel_hi:[1,0]
    v_pk_mul_f32 v[188:189], v[188:189], v[44:45] op_sel_hi:[1,0]
    v_pk_mul_f32 v[190:191], v[190:191], v[44:45] op_sel_hi:[1,0]
    v_pk_mul_f32 v[192:193], v[192:193], v[48:49] op_sel_hi:[1,0]
    v_pk_mul_f32 v[194:195], v[194:195], v[48:49] op_sel_hi:[1,0]
    v_pk_mul_f32 v[196:197], v[196:197], v[52:53] op_sel_hi:[1,0]
    v_pk_mul_f32 v[198:199], v[198:199], v[52:53] op_sel_hi:[1,0]
    v_cvt_pk_bf16_f32 v88, v144, v145
    v_cvt_pk_bf16_f32 v89, v146, v147
    v_cvt_pk_bf16_f32 v90, v172, v173
    v_cvt_pk_bf16_f32 v91, v174, v175
    v_cvt_pk_bf16_f32 v92, v148, v149
    v_cvt_pk_bf16_f32 v93, v150, v151
    v_cvt_pk_bf16_f32 v94, v176, v177
    v_cvt_pk_bf16_f32 v95, v178, v179
    v_cvt_pk_bf16_f32 v96, v152, v153
    v_cvt_pk_bf16_f32 v97, v154, v155
    v_cvt_pk_bf16_f32 v98, v180, v181
    v_cvt_pk_bf16_f32 v99, v182, v183
    v_cvt_pk_bf16_f32 v100, v156, v157
    v_cvt_pk_bf16_f32 v101, v158, v159
    v_cvt_pk_bf16_f32 v102, v184, v185
    v_cvt_pk_bf16_f32 v103, v186, v187
    v_cvt_pk_bf16_f32 v104, v160, v161
    v_cvt_pk_bf16_f32 v105, v162, v163
    v_cvt_pk_bf16_f32 v106, v188, v189
    v_cvt_pk_bf16_f32 v107, v190, v191
    v_cvt_pk_bf16_f32 v108, v164, v165
    v_cvt_pk_bf16_f32 v109, v166, v167
    v_cvt_pk_bf16_f32 v110, v192, v193
    v_cvt_pk_bf16_f32 v111, v194, v195
    v_cvt_pk_bf16_f32 v112, v168, v169
    v_cvt_pk_bf16_f32 v113, v170, v171
    v_cvt_pk_bf16_f32 v114, v196, v197
    v_cvt_pk_bf16_f32 v115, v198, v199
    s_mov_b32 s28, s31
    buffer_store_dwordx4 v[88:91], v10, s[12:15], s28 offen offset:0 sc0 sc1
    s_add_u32 s28, s28, 4096
    buffer_store_dwordx4 v[92:95], v10, s[12:15], s28 offen offset:0 sc0 sc1
    s_add_u32 s28, s28, 4096
    buffer_store_dwordx4 v[96:99], v10, s[12:15], s28 offen offset:0 sc0 sc1
    s_add_u32 s28, s28, 4096
    buffer_store_dwordx4 v[100:103], v10, s[12:15], s28 offen offset:0 sc0 sc1
    s_add_u32 s28, s28, 4096
    buffer_store_dwordx4 v[104:107], v10, s[12:15], s28 offen offset:0 sc0 sc1
    s_add_u32 s28, s28, 4096
    buffer_store_dwordx4 v[108:111], v10, s[12:15], s28 offen offset:0 sc0 sc1
    s_add_u32 s28, s28, 4096
    buffer_store_dwordx4 v[112:115], v10, s[12:15], s28 offen offset:0 sc0 sc1
    v_pk_mul_f32 v[200:201], v[200:201], v[28:29] op_sel_hi:[1,0]
    v_pk_mul_f32 v[202:203], v[202:203], v[28:29] op_sel_hi:[1,0]
    v_pk_mul_f32 v[204:205], v[204:205], v[32:33] op_sel_hi:[1,0]
    v_pk_mul_f32 v[206:207], v[206:207], v[32:33] op_sel_hi:[1,0]
    v_pk_mul_f32 v[208:209], v[208:209], v[36:37] op_sel_hi:[1,0]
    v_pk_mul_f32 v[210:211], v[210:211], v[36:37] op_sel_hi:[1,0]
    v_pk_mul_f32 v[212:213], v[212:213], v[40:41] op_sel_hi:[1,0]
    v_pk_mul_f32 v[214:215], v[214:215], v[40:41] op_sel_hi:[1,0]
    v_pk_mul_f32 v[216:217], v[216:217], v[44:45] op_sel_hi:[1,0]
    v_pk_mul_f32 v[218:219], v[218:219], v[44:45] op_sel_hi:[1,0]
    v_pk_mul_f32 v[220:221], v[220:221], v[48:49] op_sel_hi:[1,0]
    v_pk_mul_f32 v[222:223], v[222:223], v[48:49] op_sel_hi:[1,0]
    v_pk_mul_f32 v[224:225], v[224:225], v[52:53] op_sel_hi:[1,0]
    v_pk_mul_f32 v[226:227], v[226:227], v[52:53] op_sel_hi:[1,0]
    v_pk_mul_f32 v[228:229], v[228:229], v[28:29] op_sel_hi:[1,0]
    v_pk_mul_f32 v[230:231], v[230:231], v[28:29] op_sel_hi:[1,0]
    v_pk_mul_f32 v[232:233], v[232:233], v[32:33] op_sel_hi:[1,0]
    v_pk_mul_f32 v[234:235], v[234:235], v[32:33] op_sel_hi:[1,0]
    v_pk_mul_f32 v[236:237], v[236:237], v[36:37] op_sel_hi:[1,0]
    v_pk_mul_f32 v[238:239], v[238:239], v[36:37] op_sel_hi:[1,0]
    v_pk_mul_f32 v[240:241], v[240:241], v[40:41] op_sel_hi:[1,0]
    v_pk_mul_f32 v[242:243], v[242:243], v[40:41] op_sel_hi:[1,0]
    v_pk_mul_f32 v[244:245], v[244:245], v[44:45] op_sel_hi:[1,0]
    v_pk_mul_f32 v[246:247], v[246:247], v[44:45] op_sel_hi:[1,0]
    v_pk_mul_f32 v[248:249], v[248:249], v[48:49] op_sel_hi:[1,0]
    v_pk_mul_f32 v[250:251], v[250:251], v[48:49] op_sel_hi:[1,0]
    v_pk_mul_f32 v[252:253], v[252:253], v[52:53] op_sel_hi:[1,0]
    v_pk_mul_f32 v[254:255], v[254:255], v[52:53] op_sel_hi:[1,0]
    v_cvt_pk_bf16_f32 v116, v200, v201
    v_cvt_pk_bf16_f32 v117, v202, v203
    v_cvt_pk_bf16_f32 v118, v228, v229
    v_cvt_pk_bf16_f32 v119, v230, v231
    v_cvt_pk_bf16_f32 v120, v204, v205
    v_cvt_pk_bf16_f32 v121, v206, v207
    v_cvt_pk_bf16_f32 v122, v232, v233
    v_cvt_pk_bf16_f32 v123, v234, v235
    v_cvt_pk_bf16_f32 v124, v208, v209
    v_cvt_pk_bf16_f32 v125, v210, v211
    v_cvt_pk_bf16_f32 v126, v236, v237
    v_cvt_pk_bf16_f32 v127, v238, v239
    v_cvt_pk_bf16_f32 v128, v212, v213
    v_cvt_pk_bf16_f32 v129, v214, v215
    v_cvt_pk_bf16_f32 v130, v240, v241
    v_cvt_pk_bf16_f32 v131, v242, v243
    v_cvt_pk_bf16_f32 v132, v216, v217
    v_cvt_pk_bf16_f32 v133, v218, v219
    v_cvt_pk_bf16_f32 v134, v244, v245
    v_cvt_pk_bf16_f32 v135, v246, v247
    v_cvt_pk_bf16_f32 v136, v220, v221
    v_cvt_pk_bf16_f32 v137, v222, v223
    v_cvt_pk_bf16_f32 v138, v248, v249
    v_cvt_pk_bf16_f32 v139, v250, v251
    v_cvt_pk_bf16_f32 v140, v224, v225
    v_cvt_pk_bf16_f32 v141, v226, v227
    v_cvt_pk_bf16_f32 v142, v252, v253
    v_cvt_pk_bf16_f32 v143, v254, v255
    s_mov_b32 s28, s31
    buffer_store_dwordx4 v[116:119], v10, s[12:15], s28 offen offset:1024 sc0 sc1
    s_add_u32 s28, s28, 4096
    buffer_store_dwordx4 v[120:123], v10, s[12:15], s28 offen offset:1024 sc0 sc1
    s_add_u32 s28, s28, 4096
    buffer_store_dwordx4 v[124:127], v10, s[12:15], s28 offen offset:1024 sc0 sc1
    s_add_u32 s28, s28, 4096
    buffer_store_dwordx4 v[128:131], v10, s[12:15], s28 offen offset:1024 sc0 sc1
    s_add_u32 s28, s28, 4096
    buffer_store_dwordx4 v[132:135], v10, s[12:15], s28 offen offset:1024 sc0 sc1
    s_add_u32 s28, s28, 4096
    buffer_store_dwordx4 v[136:139], v10, s[12:15], s28 offen offset:1024 sc0 sc1
    s_add_u32 s28, s28, 4096
    buffer_store_dwordx4 v[140:143], v10, s[12:15], s28 offen offset:1024 sc0 sc1
    v_accvgpr_read_b32 v144, a112
    v_accvgpr_read_b32 v145, a113
    v_accvgpr_read_b32 v146, a114
    v_accvgpr_read_b32 v147, a115
    v_accvgpr_read_b32 v148, a116
    v_accvgpr_read_b32 v149, a117
    v_accvgpr_read_b32 v150, a118
    v_accvgpr_read_b32 v151, a119
    v_accvgpr_read_b32 v152, a120
    v_accvgpr_read_b32 v153, a121
    v_accvgpr_read_b32 v154, a122
    v_accvgpr_read_b32 v155, a123
    v_accvgpr_read_b32 v156, a124
    v_accvgpr_read_b32 v157, a125
    v_accvgpr_read_b32 v158, a126
    v_accvgpr_read_b32 v159, a127
    v_accvgpr_read_b32 v160, a128
    v_accvgpr_read_b32 v161, a129
    v_accvgpr_read_b32 v162, a130
    v_accvgpr_read_b32 v163, a131
    v_accvgpr_read_b32 v164, a132
    v_accvgpr_read_b32 v165, a133
    v_accvgpr_read_b32 v166, a134
    v_accvgpr_read_b32 v167, a135
    v_accvgpr_read_b32 v168, a136
    v_accvgpr_read_b32 v169, a137
    v_accvgpr_read_b32 v170, a138
    v_accvgpr_read_b32 v171, a139
    v_accvgpr_read_b32 v172, a140
    v_accvgpr_read_b32 v173, a141
    v_accvgpr_read_b32 v174, a142
    v_accvgpr_read_b32 v175, a143
    v_accvgpr_read_b32 v176, a144
    v_accvgpr_read_b32 v177, a145
    v_accvgpr_read_b32 v178, a146
    v_accvgpr_read_b32 v179, a147
    v_accvgpr_read_b32 v180, a148
    v_accvgpr_read_b32 v181, a149
    v_accvgpr_read_b32 v182, a150
    v_accvgpr_read_b32 v183, a151
    v_accvgpr_read_b32 v184, a152
    v_accvgpr_read_b32 v185, a153
    v_accvgpr_read_b32 v186, a154
    v_accvgpr_read_b32 v187, a155
    v_accvgpr_read_b32 v188, a156
    v_accvgpr_read_b32 v189, a157
    v_accvgpr_read_b32 v190, a158
    v_accvgpr_read_b32 v191, a159
    v_accvgpr_read_b32 v192, a160
    v_accvgpr_read_b32 v193, a161
    v_accvgpr_read_b32 v194, a162
    v_accvgpr_read_b32 v195, a163
    v_accvgpr_read_b32 v196, a164
    v_accvgpr_read_b32 v197, a165
    v_accvgpr_read_b32 v198, a166
    v_accvgpr_read_b32 v199, a167
    v_pk_mul_f32 v[144:145], v[144:145], v[28:29] op_sel_hi:[1,0]
    v_pk_mul_f32 v[146:147], v[146:147], v[28:29] op_sel_hi:[1,0]
    v_pk_mul_f32 v[148:149], v[148:149], v[32:33] op_sel_hi:[1,0]
    v_pk_mul_f32 v[150:151], v[150:151], v[32:33] op_sel_hi:[1,0]
    v_pk_mul_f32 v[152:153], v[152:153], v[36:37] op_sel_hi:[1,0]
    v_pk_mul_f32 v[154:155], v[154:155], v[36:37] op_sel_hi:[1,0]
    v_pk_mul_f32 v[156:157], v[156:157], v[40:41] op_sel_hi:[1,0]
    v_pk_mul_f32 v[158:159], v[158:159], v[40:41] op_sel_hi:[1,0]
    v_pk_mul_f32 v[160:161], v[160:161], v[44:45] op_sel_hi:[1,0]
    v_pk_mul_f32 v[162:163], v[162:163], v[44:45] op_sel_hi:[1,0]
    v_pk_mul_f32 v[164:165], v[164:165], v[48:49] op_sel_hi:[1,0]
    v_pk_mul_f32 v[166:167], v[166:167], v[48:49] op_sel_hi:[1,0]
    v_pk_mul_f32 v[168:169], v[168:169], v[52:53] op_sel_hi:[1,0]
    v_pk_mul_f32 v[170:171], v[170:171], v[52:53] op_sel_hi:[1,0]
    v_pk_mul_f32 v[172:173], v[172:173], v[28:29] op_sel_hi:[1,0]
    v_pk_mul_f32 v[174:175], v[174:175], v[28:29] op_sel_hi:[1,0]
    v_pk_mul_f32 v[176:177], v[176:177], v[32:33] op_sel_hi:[1,0]
    v_pk_mul_f32 v[178:179], v[178:179], v[32:33] op_sel_hi:[1,0]
    v_pk_mul_f32 v[180:181], v[180:181], v[36:37] op_sel_hi:[1,0]
    v_pk_mul_f32 v[182:183], v[182:183], v[36:37] op_sel_hi:[1,0]
    v_pk_mul_f32 v[184:185], v[184:185], v[40:41] op_sel_hi:[1,0]
    v_pk_mul_f32 v[186:187], v[186:187], v[40:41] op_sel_hi:[1,0]
    v_pk_mul_f32 v[188:189], v[188:189], v[44:45] op_sel_hi:[1,0]
    v_pk_mul_f32 v[190:191], v[190:191], v[44:45] op_sel_hi:[1,0]
    v_pk_mul_f32 v[192:193], v[192:193], v[48:49] op_sel_hi:[1,0]
    v_pk_mul_f32 v[194:195], v[194:195], v[48:49] op_sel_hi:[1,0]
    v_pk_mul_f32 v[196:197], v[196:197], v[52:53] op_sel_hi:[1,0]
    v_pk_mul_f32 v[198:199], v[198:199], v[52:53] op_sel_hi:[1,0]
    v_cvt_pk_bf16_f32 v88, v144, v145
    v_cvt_pk_bf16_f32 v89, v146, v147
    v_cvt_pk_bf16_f32 v90, v172, v173
    v_cvt_pk_bf16_f32 v91, v174, v175
    v_cvt_pk_bf16_f32 v92, v148, v149
    v_cvt_pk_bf16_f32 v93, v150, v151
    v_cvt_pk_bf16_f32 v94, v176, v177
    v_cvt_pk_bf16_f32 v95, v178, v179
    v_cvt_pk_bf16_f32 v96, v152, v153
    v_cvt_pk_bf16_f32 v97, v154, v155
    v_cvt_pk_bf16_f32 v98, v180, v181
    v_cvt_pk_bf16_f32 v99, v182, v183
    v_cvt_pk_bf16_f32 v100, v156, v157
    v_cvt_pk_bf16_f32 v101, v158, v159
    v_cvt_pk_bf16_f32 v102, v184, v185
    v_cvt_pk_bf16_f32 v103, v186, v187
    v_cvt_pk_bf16_f32 v104, v160, v161
    v_cvt_pk_bf16_f32 v105, v162, v163
    v_cvt_pk_bf16_f32 v106, v188, v189
    v_cvt_pk_bf16_f32 v107, v190, v191
    v_cvt_pk_bf16_f32 v108, v164, v165
    v_cvt_pk_bf16_f32 v109, v166, v167
    v_cvt_pk_bf16_f32 v110, v192, v193
    v_cvt_pk_bf16_f32 v111, v194, v195
    v_cvt_pk_bf16_f32 v112, v168, v169
    v_cvt_pk_bf16_f32 v113, v170, v171
    v_cvt_pk_bf16_f32 v114, v196, v197
    v_cvt_pk_bf16_f32 v115, v198, v199
    s_mov_b32 s28, s31
    buffer_store_dwordx4 v[88:91], v10, s[12:15], s28 offen offset:2048 sc0 sc1
    s_add_u32 s28, s28, 4096
    buffer_store_dwordx4 v[92:95], v10, s[12:15], s28 offen offset:2048 sc0 sc1
    s_add_u32 s28, s28, 4096
    buffer_store_dwordx4 v[96:99], v10, s[12:15], s28 offen offset:2048 sc0 sc1
    s_add_u32 s28, s28, 4096
    buffer_store_dwordx4 v[100:103], v10, s[12:15], s28 offen offset:2048 sc0 sc1
    s_add_u32 s28, s28, 4096
    buffer_store_dwordx4 v[104:107], v10, s[12:15], s28 offen offset:2048 sc0 sc1
    s_add_u32 s28, s28, 4096
    buffer_store_dwordx4 v[108:111], v10, s[12:15], s28 offen offset:2048 sc0 sc1
    s_add_u32 s28, s28, 4096
    buffer_store_dwordx4 v[112:115], v10, s[12:15], s28 offen offset:2048 sc0 sc1
    v_accvgpr_read_b32 v200, a168
    v_accvgpr_read_b32 v201, a169
    v_accvgpr_read_b32 v202, a170
    v_accvgpr_read_b32 v203, a171
    v_accvgpr_read_b32 v204, a172
    v_accvgpr_read_b32 v205, a173
    v_accvgpr_read_b32 v206, a174
    v_accvgpr_read_b32 v207, a175
    v_accvgpr_read_b32 v208, a176
    v_accvgpr_read_b32 v209, a177
    v_accvgpr_read_b32 v210, a178
    v_accvgpr_read_b32 v211, a179
    v_accvgpr_read_b32 v212, a180
    v_accvgpr_read_b32 v213, a181
    v_accvgpr_read_b32 v214, a182
    v_accvgpr_read_b32 v215, a183
    v_accvgpr_read_b32 v216, a184
    v_accvgpr_read_b32 v217, a185
    v_accvgpr_read_b32 v218, a186
    v_accvgpr_read_b32 v219, a187
    v_accvgpr_read_b32 v220, a188
    v_accvgpr_read_b32 v221, a189
    v_accvgpr_read_b32 v222, a190
    v_accvgpr_read_b32 v223, a191
    v_accvgpr_read_b32 v224, a192
    v_accvgpr_read_b32 v225, a193
    v_accvgpr_read_b32 v226, a194
    v_accvgpr_read_b32 v227, a195
    v_accvgpr_read_b32 v228, a196
    v_accvgpr_read_b32 v229, a197
    v_accvgpr_read_b32 v230, a198
    v_accvgpr_read_b32 v231, a199
    v_accvgpr_read_b32 v232, a200
    v_accvgpr_read_b32 v233, a201
    v_accvgpr_read_b32 v234, a202
    v_accvgpr_read_b32 v235, a203
    v_accvgpr_read_b32 v236, a204
    v_accvgpr_read_b32 v237, a205
    v_accvgpr_read_b32 v238, a206
    v_accvgpr_read_b32 v239, a207
    v_accvgpr_read_b32 v240, a208
    v_accvgpr_read_b32 v241, a209
    v_accvgpr_read_b32 v242, a210
    v_accvgpr_read_b32 v243, a211
    v_accvgpr_read_b32 v244, a212
    v_accvgpr_read_b32 v245, a213
    v_accvgpr_read_b32 v246, a214
    v_accvgpr_read_b32 v247, a215
    v_accvgpr_read_b32 v248, a216
    v_accvgpr_read_b32 v249, a217
    v_accvgpr_read_b32 v250, a218
    v_accvgpr_read_b32 v251, a219
    v_accvgpr_read_b32 v252, a220
    v_accvgpr_read_b32 v253, a221
    v_accvgpr_read_b32 v254, a222
    v_accvgpr_read_b32 v255, a223
    v_pk_mul_f32 v[200:201], v[200:201], v[28:29] op_sel_hi:[1,0]
    v_pk_mul_f32 v[202:203], v[202:203], v[28:29] op_sel_hi:[1,0]
    v_pk_mul_f32 v[204:205], v[204:205], v[32:33] op_sel_hi:[1,0]
    v_pk_mul_f32 v[206:207], v[206:207], v[32:33] op_sel_hi:[1,0]
    v_pk_mul_f32 v[208:209], v[208:209], v[36:37] op_sel_hi:[1,0]
    v_pk_mul_f32 v[210:211], v[210:211], v[36:37] op_sel_hi:[1,0]
    v_pk_mul_f32 v[212:213], v[212:213], v[40:41] op_sel_hi:[1,0]
    v_pk_mul_f32 v[214:215], v[214:215], v[40:41] op_sel_hi:[1,0]
    v_pk_mul_f32 v[216:217], v[216:217], v[44:45] op_sel_hi:[1,0]
    v_pk_mul_f32 v[218:219], v[218:219], v[44:45] op_sel_hi:[1,0]
    v_pk_mul_f32 v[220:221], v[220:221], v[48:49] op_sel_hi:[1,0]
    v_pk_mul_f32 v[222:223], v[222:223], v[48:49] op_sel_hi:[1,0]
    v_pk_mul_f32 v[224:225], v[224:225], v[52:53] op_sel_hi:[1,0]
    v_pk_mul_f32 v[226:227], v[226:227], v[52:53] op_sel_hi:[1,0]
    v_pk_mul_f32 v[228:229], v[228:229], v[28:29] op_sel_hi:[1,0]
    v_pk_mul_f32 v[230:231], v[230:231], v[28:29] op_sel_hi:[1,0]
    v_pk_mul_f32 v[232:233], v[232:233], v[32:33] op_sel_hi:[1,0]
    v_pk_mul_f32 v[234:235], v[234:235], v[32:33] op_sel_hi:[1,0]
    v_pk_mul_f32 v[236:237], v[236:237], v[36:37] op_sel_hi:[1,0]
    v_pk_mul_f32 v[238:239], v[238:239], v[36:37] op_sel_hi:[1,0]
    v_pk_mul_f32 v[240:241], v[240:241], v[40:41] op_sel_hi:[1,0]
    v_pk_mul_f32 v[242:243], v[242:243], v[40:41] op_sel_hi:[1,0]
    v_pk_mul_f32 v[244:245], v[244:245], v[44:45] op_sel_hi:[1,0]
    v_pk_mul_f32 v[246:247], v[246:247], v[44:45] op_sel_hi:[1,0]
    v_pk_mul_f32 v[248:249], v[248:249], v[48:49] op_sel_hi:[1,0]
    v_pk_mul_f32 v[250:251], v[250:251], v[48:49] op_sel_hi:[1,0]
    v_pk_mul_f32 v[252:253], v[252:253], v[52:53] op_sel_hi:[1,0]
    v_pk_mul_f32 v[254:255], v[254:255], v[52:53] op_sel_hi:[1,0]
    v_cvt_pk_bf16_f32 v116, v200, v201
    v_cvt_pk_bf16_f32 v117, v202, v203
    v_cvt_pk_bf16_f32 v118, v228, v229
    v_cvt_pk_bf16_f32 v119, v230, v231
    v_cvt_pk_bf16_f32 v120, v204, v205
    v_cvt_pk_bf16_f32 v121, v206, v207
    v_cvt_pk_bf16_f32 v122, v232, v233
    v_cvt_pk_bf16_f32 v123, v234, v235
    v_cvt_pk_bf16_f32 v124, v208, v209
    v_cvt_pk_bf16_f32 v125, v210, v211
    v_cvt_pk_bf16_f32 v126, v236, v237
    v_cvt_pk_bf16_f32 v127, v238, v239
    v_cvt_pk_bf16_f32 v128, v212, v213
    v_cvt_pk_bf16_f32 v129, v214, v215
    v_cvt_pk_bf16_f32 v130, v240, v241
    v_cvt_pk_bf16_f32 v131, v242, v243
    v_cvt_pk_bf16_f32 v132, v216, v217
    v_cvt_pk_bf16_f32 v133, v218, v219
    v_cvt_pk_bf16_f32 v134, v244, v245
    v_cvt_pk_bf16_f32 v135, v246, v247
    v_cvt_pk_bf16_f32 v136, v220, v221
    v_cvt_pk_bf16_f32 v137, v222, v223
    v_cvt_pk_bf16_f32 v138, v248, v249
    v_cvt_pk_bf16_f32 v139, v250, v251
    v_cvt_pk_bf16_f32 v140, v224, v225
    v_cvt_pk_bf16_f32 v141, v226, v227
    v_cvt_pk_bf16_f32 v142, v252, v253
    v_cvt_pk_bf16_f32 v143, v254, v255
    s_mov_b32 s28, s31
    buffer_store_dwordx4 v[116:119], v10, s[12:15], s28 offen offset:3072 sc0 sc1
    s_add_u32 s28, s28, 4096
    buffer_store_dwordx4 v[120:123], v10, s[12:15], s28 offen offset:3072 sc0 sc1
    s_add_u32 s28, s28, 4096
    buffer_store_dwordx4 v[124:127], v10, s[12:15], s28 offen offset:3072 sc0 sc1
    s_add_u32 s28, s28, 4096
    buffer_store_dwordx4 v[128:131], v10, s[12:15], s28 offen offset:3072 sc0 sc1
    s_add_u32 s28, s28, 4096
    buffer_store_dwordx4 v[132:135], v10, s[12:15], s28 offen offset:3072 sc0 sc1
    s_add_u32 s28, s28, 4096
    buffer_store_dwordx4 v[136:139], v10, s[12:15], s28 offen offset:3072 sc0 sc1
    s_add_u32 s28, s28, 4096
    buffer_store_dwordx4 v[140:143], v10, s[12:15], s28 offen offset:3072 sc0 sc1
    s_nop 1
L_at_nowo2:
    s_mov_b32 s68, 3
    s_cmp_ge_u32 s21, 2
    s_cbranch_scc1 L_at_fin
    s_cmp_eq_u32 s69, 0
    s_cbranch_scc1 L_at_round
    s_waitcnt vmcnt(28)
    s_branch L_at_pre
L_at_fin:
    s_waitcnt lgkmcnt(0)
    s_barrier
    s_cmp_le_u32 s21, s27
    s_cbranch_scc1 L_at_nofb_6926
    s_sub_u32 s28, s21, 1
    s_cmp_eq_u32 s28, s23
    s_cbranch_scc1 L_at_nofb_6926
    s_lshl_b32 s29, s28, 2
    s_add_u32 s29, s29, 76000
    v_mov_b32 v4, s29
    ds_read_b32 v4, v4
    s_waitcnt lgkmcnt(0)
    v_readfirstlane_b32 s29, v4
    s_nop 3
    s_cmp_lg_u32 s29, 0
    s_cbranch_scc1 L_at_fallback
L_at_nofb_6926:
    s_branch L_at_end
L_bw1_449:
    s_sub_u32 s68, s68, 1
    s_waitcnt vmcnt(44) lgkmcnt(0)
    s_branch L_bw2_449
L_bw1_572:
    s_sub_u32 s68, s68, 1
    s_waitcnt vmcnt(36) lgkmcnt(0)
    s_branch L_bw2_572
L_bw1_689:
    s_sub_u32 s68, s68, 1
    s_waitcnt vmcnt(44) lgkmcnt(0)
    s_branch L_bw2_689
L_bw1_3105:
    s_sub_u32 s68, s68, 1
    s_waitcnt vmcnt(44) lgkmcnt(0)
    s_branch L_bw2_3105
L_bw1_3487:
    s_sub_u32 s68, s68, 1
    s_waitcnt vmcnt(44) lgkmcnt(0)
    s_branch L_bw2_3487
L_bw1_3796:
    s_sub_u32 s68, s68, 1
    s_waitcnt vmcnt(44) lgkmcnt(0)
    s_branch L_bw2_3796
L_at_wt0:
    s_and_b32 s28, s2, 127
    s_mul_i32 s28, s28, 40960
    s_mul_i32 s29, s20, 10240
    s_add_u32 s28, s28, s29
    v_lshlrev_b32 v4, 7, v1
    v_and_b32 v5, 15, v1
    v_lshlrev_b32 v5, 7, v5
    buffer_load_dword a250, v4, s[84:87], s28 offen
    s_add_u32 s28, s28, 8192
    buffer_load_dword a251, v5, s[84:87], s28 offen
    s_lshl_b32 s28, s20, 13
    v_lshlrev_b32 v4, 7, v1
    v_add_u32 v4, s28, v4
    v_add_u32 v4, op_kernel - L_pc0, v4
    v_min_u32 v4, L_code_end - L_pc0 - 4, v4
    v_mov_b32 v5, s73
    v_add_co_u32 v4, vcc, s72, v4
    v_addc_co_u32 v5, vcc, 0, v5, vcc
    global_load_dword a250, v[4:5], off
    s_branch L_at_wt0r
L_at_fallback:
    s_sub_u32 s27, s21, 1
    s_mov_b32 s23, s27
    s_mov_b32 s25, 1
    s_mov_b32 s69, 0
    s_mov_b32 s70, 0
    s_mov_b32 s68, 0
    v_mov_b32 v12, 0xff800000
    v_mov_b32 v14, 0xff800000
    v_mov_b32 v16, 0xff800000
    v_mov_b32 v18, 0xff800000
    v_mov_b32 v20, 0xff800000
    v_mov_b32 v22, 0xff800000
    v_mov_b32 v24, 0xff800000
    s_waitcnt vmcnt(0) lgkmcnt(0)
    s_barrier
    s_branch L_at_start
L_at_maxpass:
    s_mov_b32 s25, 0
    s_waitcnt lgkmcnt(0)
    v_and_b32 v2, 15, v1
    v_lshlrev_b32 v2, 8, v2
    v_bfe_u32 v3, v1, 4, 1
    v_lshl_add_u32 v2, v3, 5, v2
    v_bfe_u32 v3, v1, 5, 1
    v_lshl_add_u32 v4, v3, 4, v2
    v_add_u32 v5, 4096, v4
    s_lshl_b32 s29, s21, 19
    s_mov_b32 s22, 0
L_at_mp:
    buffer_load_dwordx4 v[112:115], v4, s[8:11], s29 offen offset:0
    buffer_load_dwordx4 v[116:119], v4, s[8:11], s29 offen offset:64
    buffer_load_dwordx4 v[120:123], v4, s[8:11], s29 offen offset:128
    buffer_load_dwordx4 v[124:127], v4, s[8:11], s29 offen offset:192
    buffer_load_dwordx4 v[128:131], v5, s[8:11], s29 offen offset:0
    buffer_load_dwordx4 v[132:135], v5, s[8:11], s29 offen offset:64
    buffer_load_dwordx4 v[136:139], v5, s[8:11], s29 offen offset:128
    buffer_load_dwordx4 v[140:143], v5, s[8:11], s29 offen offset:192
    s_waitcnt vmcnt(0)
    v_mfma_f32_16x16x32_bf16 v[88:91], v[112:115], a[0:3], 0
    v_mfma_f32_16x16x32_bf16 v[88:91], v[116:119], a[4:7], v[88:91]
    v_mfma_f32_16x16x32_bf16 v[88:91], v[120:123], a[8:11], v[88:91]
    v_mfma_f32_16x16x32_bf16 v[88:91], v[124:127], a[12:15], v[88:91]
    v_mfma_f32_16x16x32_bf16 v[92:95], v[128:131], a[0:3], 0
    v_mfma_f32_16x16x32_bf16 v[92:95], v[132:135], a[4:7], v[92:95]
    v_mfma_f32_16x16x32_bf16 v[92:95], v[136:139], a[8:11], v[92:95]
    v_mfma_f32_16x16x32_bf16 v[92:95], v[140:143], a[12:15], v[92:95]
    s_nop 9
    v_max3_f32 v12, v88, v89, v12
    v_max3_f32 v12, v90, v91, v12
    v_max3_f32 v12, v92, v93, v12
    v_max3_f32 v12, v94, v95, v12
    s_nop 3
    v_mfma_f32_16x16x32_bf16 v[88:91], v[112:115], a[16:19], 0
    v_mfma_f32_16x16x32_bf16 v[88:91], v[116:119], a[20:23], v[88:91]
    v_mfma_f32_16x16x32_bf16 v[88:91], v[120:123], a[24:27], v[88:91]
    v_mfma_f32_16x16x32_bf16 v[88:91], v[124:127], a[28:31], v[88:91]
    v_mfma_f32_16x16x32_bf16 v[92:95], v[128:131], a[16:19], 0
    v_mfma_f32_16x16x32_bf16 v[92:95], v[132:135], a[20:23], v[92:95]
    v_mfma_f32_16x16x32_bf16 v[92:95], v[136:139], a[24:27], v[92:95]
    v_mfma_f32_16x16x32_bf16 v[92:95], v[140:143], a[28:31], v[92:95]
    s_nop 9
    v_max3_f32 v14, v88, v89, v14
    v_max3_f32 v14, v90, v91, v14
    v_max3_f32 v14, v92, v93, v14
    v_max3_f32 v14, v94, v95, v14
    s_nop 3
    v_mfma_f32_16x16x32_bf16 v[88:91], v[112:115], a[32:35], 0
    v_mfma_f32_16x16x32_bf16 v[88:91], v[116:119], a[36:39], v[88:91]
    v_mfma_f32_16x16x32_bf16 v[88:91], v[120:123], a[40:43], v[88:91]
    v_mfma_f32_16x16x32_bf16 v[88:91], v[124:127], a[44:47], v[88:91]
    v_mfma_f32_16x16x32_bf16 v[92:95], v[128:131], a[32:35], 0
    v_mfma_f32_16x16x32_bf16 v[92:95], v[132:135], a[36:39], v[92:95]
    v_mfma_f32_16x16x32_bf16 v[92:95], v[136:139], a[40:43], v[92:95]
    v_mfma_f32_16x16x32_bf16 v[92:95], v[140:143], a[44:47], v[92:95]
    s_nop 9
    v_max3_f32 v16, v88, v89, v16
    v_max3_f32 v16, v90, v91, v16
    v_max3_f32 v16, v92, v93, v16
    v_max3_f32 v16, v94, v95, v16
    s_nop 3
    v_mfma_f32_16x16x32_bf16 v[88:91], v[112:115], a[48:51], 0
    v_mfma_f32_16x16x32_bf16 v[88:91], v[116:119], a[52:55], v[88:91]
    v_mfma_f32_16x16x32_bf16 v[88:91], v[120:123], a[56:59], v[88:91]
    v_mfma_f32_16x16x32_bf16 v[88:91], v[124:127], a[60:63], v[88:91]
    v_mfma_f32_16x16x32_bf16 v[92:95], v[128:131], a[48:51], 0
    v_mfma_f32_16x16x32_bf16 v[92:95], v[132:135], a[52:55], v[92:95]
    v_mfma_f32_16x16x32_bf16 v[92:95], v[136:139], a[56:59], v[92:95]
    v_mfma_f32_16x16x32_bf16 v[92:95], v[140:143], a[60:63], v[92:95]
    s_nop 9
    v_max3_f32 v18, v88, v89, v18
    v_max3_f32 v18, v90, v91, v18
    v_max3_f32 v18, v92, v93, v18
    v_max3_f32 v18, v94, v95, v18
    s_nop 3
    v_mfma_f32_16x16x32_bf16 v[88:91], v[112:115], a[64:67], 0
    v_mfma_f32_16x16x32_bf16 v[88:91], v[116:119], a[68:71], v[88:91]
    v_mfma_f32_16x16x32_bf16 v[88:91], v[120:123], a[72:75], v[88:91]
    v_mfma_f32_16x16x32_bf16 v[88:91], v[124:127], a[76:79], v[88:91]
    v_mfma_f32_16x16x32_bf16 v[92:95], v[128:131], a[64:67], 0
    v_mfma_f32_16x16x32_bf16 v[92:95], v[132:135], a[68:71], v[92:95]
    v_mfma_f32_16x16x32_bf16 v[92:95], v[136:139], a[72:75], v[92:95]
    v_mfma_f32_16x16x32_bf16 v[92:95], v[140:143], a[76:79], v[92:95]
    s_nop 9
    v_max3_f32 v20, v88, v89, v20
    v_max3_f32 v20, v90, v91, v20
    v_max3_f32 v20, v92, v93, v20
    v_max3_f32 v20, v94, v95, v20
    s_nop 3
    v_mfma_f32_16x16x32_bf16 v[88:91], v[112:115], a[80:83], 0
    v_mfma_f32_16x16x32_bf16 v[88:91], v[116:119], a[84:87], v[88:91]
    v_mfma_f32_16x16x32_bf16 v[88:91], v[120:123], a[88:91], v[88:91]
    v_mfma_f32_16x16x32_bf16 v[88:91], v[124:127], a[92:95], v[88:91]
    v_mfma_f32_16x16x32_bf16 v[92:95], v[128:131], a[80:83], 0
    v_mfma_f32_16x16x32_bf16 v[92:95], v[132:135], a[84:87], v[92:95]
    v_mfma_f32_16x16x32_bf16 v[92:95], v[136:139], a[88:91], v[92:95]
    v_mfma_f32_16x16x32_bf16 v[92:95], v[140:143], a[92:95], v[92:95]
    s_nop 9
    v_max3_f32 v22, v88, v89, v22
    v_max3_f32 v22, v90, v91, v22
    v_max3_f32 v22, v92, v93, v22
    v_max3_f32 v22, v94, v95, v22
    s_nop 3
    v_mfma_f32_16x16x32_bf16 v[88:91], v[112:115], a[96:99], 0
    v_mfma_f32_16x16x32_bf16 v[88:91], v[116:119], a[100:103], v[88:91]
    v_mfma_f32_16x16x32_bf16 v[88:91], v[120:123], a[104:107], v[88:91]
    v_mfma_f32_16x16x32_bf16 v[88:91], v[124:127], a[108:111], v[88:91]
    v_mfma_f32_16x16x32_bf16 v[92:95], v[128:131], a[96:99], 0
    v_mfma_f32_16x16x32_bf16 v[92:95], v[132:135], a[100:103], v[92:95]
    v_mfma_f32_16x16x32_bf16 v[92:95], v[136:139], a[104:107], v[92:95]
    v_mfma_f32_16x16x32_bf16 v[92:95], v[140:143], a[108:111], v[92:95]
    s_nop 9
    v_max3_f32 v24, v88, v89, v24
    v_max3_f32 v24, v90, v91, v24
    v_max3_f32 v24, v92, v93, v24
    v_max3_f32 v24, v94, v95, v24
    s_nop 3
    s_add_u32 s29, s29, 8192
    s_add_u32 s22, s22, 1
    s_cmp_lt_u32 s22, 32
    s_cbranch_scc1 L_at_mp
    s_branch L_at_pre
L_at_end:
    s_endpgm
.globl op_kernel
.p2align 8
.type op_kernel,@function
op_kernel:
    s_cmp_ge_u32 s2, 256
    s_cbranch_scc1 L_op_end
    s_and_b32 s3, s2, 7
    s_lshl_b32 s3, s3, 5
    s_lshr_b32 s30, s2, 3
    s_add_u32 s3, s3, s30
    s_cmp_ge_u32 s3, 250
    s_cbranch_scc1 L_op_end
    s_load_dwordx2 s[36:37], s[0:1], 32
    s_load_dwordx2 s[38:39], s[0:1], 72
    s_load_dwordx2 s[40:41], s[0:1], 80
    s_load_dwordx2 s[44:45], s[0:1], 96
    v_and_b32 v1, 63, v0
    v_lshrrev_b32 v2, 6, v0
    s_nop 0
    v_readfirstlane_b32 s20, v2
    s_mul_i32 s28, s3, 13108
    s_lshr_b32 s28, s28, 16
    s_mul_i32 s22, s28, 5
    s_sub_u32 s29, s3, s22
    s_mov_b32 s61, s28
    s_cmp_ge_u32 s28, 25
    s_cselect_b32 s30, 1, 0
    s_cselect_b32 s22, 25, 0
    s_sub_u32 s28, s28, s22
    s_mul_i32 s31, s28, 9
    s_lshl_b32 s24, s20, 10
    s_add_u32 s24, s24, 58720256
    s_mul_i32 s23, s30, 29360128
    s_add_u32 s24, s24, s23
    s_cmp_lt_u32 s20, 2
    s_cselect_b32 s58, 5, 0
    s_add_u32 s22, s31, 0
    s_add_u32 s22, s22, s58
    s_mul_i32 s23, s22, 4682
    s_lshr_b32 s23, s23, 16
    s_mul_i32 s62, s23, 1777664
    s_lshl_b32 s48, s22, 12
    s_add_u32 s48, s48, s62
    s_add_u32 s48, s48, s24
    s_add_u32 s22, s31, 1
    s_add_u32 s22, s22, s58
    s_mul_i32 s23, s22, 4682
    s_lshr_b32 s23, s23, 16
    s_mul_i32 s62, s23, 1777664
    s_lshl_b32 s49, s22, 12
    s_add_u32 s49, s49, s62
    s_add_u32 s49, s49, s24
    s_add_u32 s22, s31, 2
    s_add_u32 s22, s22, s58
    s_mul_i32 s23, s22, 4682
    s_lshr_b32 s23, s23, 16
    s_mul_i32 s62, s23, 1777664
    s_lshl_b32 s50, s22, 12
    s_add_u32 s50, s50, s62
    s_add_u32 s50, s50, s24
    s_add_u32 s22, s31, 3
    s_add_u32 s22, s22, s58
    s_mul_i32 s23, s22, 4682
    s_lshr_b32 s23, s23, 16
    s_mul_i32 s62, s23, 1777664
    s_lshl_b32 s51, s22, 12
    s_add_u32 s51, s51, s62
    s_add_u32 s51, s51, s24
    s_cmp_ge_u32 s22, 224
    s_cselect_b32 s62, 0x40000000, 0
    s_add_u32 s51, s51, s62
    s_add_u32 s22, s31, 4
    s_mul_i32 s23, s22, 4682
    s_lshr_b32 s23, s23, 16
    s_mul_i32 s62, s23, 1777664
    s_lshl_b32 s52, s22, 12
    s_add_u32 s52, s52, s62
    s_add_u32 s52, s52, s24
    s_add_u32 s22, s31, 5
    s_sub_u32 s22, s22, s58
    s_mul_i32 s23, s22, 4682
    s_lshr_b32 s23, s23, 16
    s_mul_i32 s62, s23, 1777664
    s_lshl_b32 s53, s22, 12
    s_add_u32 s53, s53, s62
    s_add_u32 s53, s53, s24
    s_add_u32 s22, s31, 6
    s_sub_u32 s22, s22, s58
    s_mul_i32 s23, s22, 4682
    s_lshr_b32 s23, s23, 16
    s_mul_i32 s62, s23, 1777664
    s_lshl_b32 s54, s22, 12
    s_add_u32 s54, s54, s62
    s_add_u32 s54, s54, s24
    s_add_u32 s22, s31, 7
    s_sub_u32 s22, s22, s58
    s_mul_i32 s23, s22, 4682
    s_lshr_b32 s23, s23, 16
    s_mul_i32 s62, s23, 1777664
    s_lshl_b32 s55, s22, 12
    s_add_u32 s55, s55, s62
    s_add_u32 s55, s55, s24
    s_add_u32 s22, s31, 8
    s_sub_u32 s22, s22, s58
    s_mul_i32 s23, s22, 4682
    s_lshr_b32 s23, s23, 16
    s_mul_i32 s62, s23, 1777664
    s_lshl_b32 s56, s22, 12
    s_add_u32 s56, s56, s62
    s_add_u32 s56, s56, s24
    s_cmp_ge_u32 s22, 224
    s_cselect_b32 s62, 0x40000000, 0
    s_add_u32 s56, s56, s62
    v_lshlrev_b32 v6, 4, v1
    v_lshrrev_b32 v2, 4, v1
    v_and_b32 v3, 15, v1
    v_lshlrev_b32 v4, 1, v2
    v_xor_b32 v3, v3, v4
    v_lshlrev_b32 v3, 4, v3
    v_mul_u32_u24 v4, 1280, v2
    v_add_u32 v5, v4, v3
    v_xor_b32 v3, 128, v3
    v_add_u32 v4, v4, v3
    v_add_u32 v10, 0, v5
    v_add_u32 v11, 4096, v4
    v_add_u32 v12, 8192, v5
    v_add_u32 v13, 12288, v4
    v_add_u32 v14, 20480, v5
    v_add_u32 v15, 24576, v4
    v_add_u32 v16, 28672, v5
    v_add_u32 v17, 32768, v4
    s_mul_i32 s27, s20, 40960
    s_waitcnt lgkmcnt(0)
    s_cmp_lg_u32 s30, 0
    s_cselect_b32 s8, s38, s36
    s_cselect_b32 s9, s39, s37
    s_mov_b32 s10, 5242880
    s_mov_b32 s11, 0x20000
    s_mov_b32 s4, s44
    s_mov_b32 s5, s45
    s_mov_b32 s6, 127926272
    s_mov_b32 s7, 0x20000
    s_mov_b32 s12, s40
    s_mov_b32 s13, s41
    s_mov_b32 s14, 9175040
    s_mov_b32 s15, 0x20000
    s_mul_i32 s22, s20, 40960
    s_lshl_b32 s23, s29, 8
    s_add_u32 s26, s22, s23
    s_mov_b32 s25, 0
    v_add_u32 v7, s25, v6
    s_add_u32 m0, s27, 0
    s_nop 0
    buffer_load_dwordx4 v10, s[8:11], s26 offen offset:0 lds
    buffer_load_dwordx4 v11, s[8:11], s26 offen offset:1024 lds
    buffer_load_dwordx4 v12, s[8:11], s26 offen offset:2048 lds
    buffer_load_dwordx4 v13, s[8:11], s26 offen offset:3072 lds
    s_add_u32 m0, s27, 4096
    s_nop 0
    buffer_load_dwordx4 v14, s[8:11], s26 offen offset:0 lds
    buffer_load_dwordx4 v15, s[8:11], s26 offen offset:1024 lds
    buffer_load_dwordx4 v16, s[8:11], s26 offen offset:2048 lds
    buffer_load_dwordx4 v17, s[8:11], s26 offen offset:3072 lds
    s_add_u32 s26, s26, 163840
    buffer_load_dwordx4 v[92:95], v7, s[4:7], s48 offen
    buffer_load_dwordx4 v[96:99], v7, s[4:7], s49 offen
    buffer_load_dwordx4 v[100:103], v7, s[4:7], s50 offen
    buffer_load_dwordx4 v[104:107], v7, s[4:7], s51 offen
    buffer_load_dwordx4 v[108:111], v7, s[4:7], s52 offen
    buffer_load_dwordx4 v[112:115], v7, s[4:7], s53 offen
    buffer_load_dwordx4 v[116:119], v7, s[4:7], s54 offen
    buffer_load_dwordx4 v[120:123], v7, s[4:7], s55 offen
    buffer_load_dwordx4 v[124:127], v7, s[4:7], s56 offen
    v_add_u32 v7, 57344, v7
    s_add_u32 m0, s27, 8192
    s_nop 0
    buffer_load_dwordx4 v10, s[8:11], s26 offen offset:0 lds
    buffer_load_dwordx4 v11, s[8:11], s26 offen offset:1024 lds
    buffer_load_dwordx4 v12, s[8:11], s26 offen offset:2048 lds
    buffer_load_dwordx4 v13, s[8:11], s26 offen offset:3072 lds
    s_add_u32 m0, s27, 12288
    s_nop 0
    buffer_load_dwordx4 v14, s[8:11], s26 offen offset:0 lds
    buffer_load_dwordx4 v15, s[8:11], s26 offen offset:1024 lds
    buffer_load_dwordx4 v16, s[8:11], s26 offen offset:2048 lds
    buffer_load_dwordx4 v17, s[8:11], s26 offen offset:3072 lds
    s_add_u32 s26, s26, 163840
    v_lshrrev_b32 v2, 4, v1
    v_bfe_u32 v3, v1, 2, 2
    v_lshl_add_u32 v4, v2, 2, v3
    v_lshlrev_b32 v4, 8, v4
    v_and_b32 v2, 1, v2
    v_lshl_add_u32 v3, v2, 2, v3
    v_lshl_add_u32 v4, v3, 5, v4
    v_and_b32 v3, 3, v1
    v_lshl_add_u32 v4, v3, 3, v4
    v_add_u32 v4, s27, v4
    s_and_b32 s62, s20, 1
    s_lshl_b32 s62, s62, 1
    s_lshr_b32 s59, s20, 1
    s_add_u32 s59, s59, s62
    s_lshl_b32 s59, s59, 6
    s_xor_b32 s62, s59, 192
    v_xor_b32 v18, s62, v4
    s_xor_b32 s62, s59, 224
    v_xor_b32 v19, s62, v4
    s_xor_b32 s62, s59, 128
    v_xor_b32 v20, s62, v4
    s_xor_b32 s62, s59, 160
    v_xor_b32 v21, s62, v4
    s_xor_b32 s62, s59, 64
    v_xor_b32 v22, s62, v4
    s_xor_b32 s62, s59, 96
    v_xor_b32 v23, s62, v4
    s_xor_b32 s62, s59, 0
    v_xor_b32 v24, s62, v4
    s_xor_b32 s62, s59, 32
    v_xor_b32 v25, s62, v4
    v_add_u32 v8, s27, v6
    v_bfe_u32 v4, v1, 4, 1
    v_lshlrev_b32 v4, 5, v4
    v_and_b32 v2, 15, v1
    v_mul_u32_u24 v2, 2560, v2
    v_add_u32 v2, v2, v4
    v_bfe_u32 v4, v1, 5, 1
    v_lshl_add_u32 v9, v4, 4, v2
    s_xor_b32 s22, s20, 3
    s_mul_i32 s22, s22, 40960
    v_add_u32 v2, s22, v6
    s_xor_b32 s22, s20, 1
    s_mul_i32 s22, s22, 40960
    v_add_u32 v3, s22, v6
    s_xor_b32 s22, s20, 2
    s_mul_i32 s22, s22, 40960
    v_add_u32 v4, s22, v6
    v_and_b32 v26, 7, v1
    v_mul_u32_u24 v26, 2560, v26
    v_bfe_u32 v27, v1, 3, 1
    s_lshr_b32 s22, s20, 1
    s_xor_b32 s22, s22, 1
    v_xor_b32 v27, s22, v27
    v_lshl_add_u32 v26, v27, 6, v26
    v_bfe_u32 v27, v1, 4, 1
    v_lshl_add_u32 v26, v27, 5, v26
    v_bfe_u32 v27, v1, 5, 1
    v_lshl_add_u32 v26, v27, 4, v26
    v_xor_b32 v27, 64, v26
    v_add_u32 v27, 20480, v27
    s_mov_b32 s64, 0x00ff00ff
    s_mov_b32 s65, 0x00ff00ff
    s_mov_b32 s66, 0xff00ff00
    s_mov_b32 s67, 0xff00ff00
    s_mul_i32 s22, s28, 368640
    s_mul_i32 s23, s30, 1280
    s_add_u32 s22, s22, s23
    s_lshl_b32 s23, s29, 8
    s_add_u32 s24, s22, s23
    s_waitcnt vmcnt(17)
    ds_read_b64_tr_b16 v[60:61], v18 offset:0
    ds_read_b64_tr_b16 v[62:63], v18 offset:4096
    ds_read_b64_tr_b16 v[64:65], v19 offset:0
    ds_read_b64_tr_b16 v[66:67], v19 offset:4096
    ds_read_b64_tr_b16 v[68:69], v20 offset:0
    ds_read_b64_tr_b16 v[70:71], v20 offset:4096
    ds_read_b64_tr_b16 v[72:73], v21 offset:0
    ds_read_b64_tr_b16 v[74:75], v21 offset:4096
    ds_read_b64_tr_b16 v[76:77], v22 offset:0
    ds_read_b64_tr_b16 v[78:79], v22 offset:4096
    ds_read_b64_tr_b16 v[80:81], v23 offset:0
    ds_read_b64_tr_b16 v[82:83], v23 offset:4096
    ds_read_b64_tr_b16 v[84:85], v24 offset:0
    ds_read_b64_tr_b16 v[86:87], v24 offset:4096
    ds_read_b64_tr_b16 v[88:89], v25 offset:0
    ds_read_b64_tr_b16 v[90:91], v25 offset:4096
    s_waitcnt vmcnt(0) lgkmcnt(12)
    v_mfma_f32_16x16x32_bf16 a[0:3], v[60:63], v[92:95], 0
    buffer_load_dwordx4 v[128:131], v7, s[4:7], s48 offen
    v_mfma_f32_16x16x32_bf16 a[4:7], v[60:63], v[96:99], 0
    buffer_load_dwordx4 v[132:135], v7, s[4:7], s49 offen
    v_mfma_f32_16x16x32_bf16 a[8:11], v[60:63], v[100:103], 0
    buffer_load_dwordx4 v[136:139], v7, s[4:7], s50 offen
    v_mfma_f32_16x16x32_bf16 a[12:15], v[60:63], v[104:107], 0
    buffer_load_dwordx4 v[140:143], v7, s[4:7], s51 offen
    v_mfma_f32_16x16x32_bf16 a[16:19], v[60:63], v[108:111], 0
    buffer_load_dwordx4 v[144:147], v7, s[4:7], s52 offen
    v_mfma_f32_16x16x32_bf16 a[20:23], v[60:63], v[112:115], 0
    buffer_load_dwordx4 v[148:151], v7, s[4:7], s53 offen
    v_mfma_f32_16x16x32_bf16 a[24:27], v[60:63], v[116:119], 0
    buffer_load_dwordx4 v[152:155], v7, s[4:7], s54 offen
    v_mfma_f32_16x16x32_bf16 a[28:31], v[60:63], v[120:123], 0
    buffer_load_dwordx4 v[156:159], v7, s[4:7], s55 offen
    v_mfma_f32_16x16x32_bf16 a[32:35], v[60:63], v[124:127], 0
    ds_read_b64_tr_b16 v[60:61], v18 offset:8192
    ds_read_b64_tr_b16 v[62:63], v18 offset:12288
    v_mfma_f32_16x16x32_bf16 a[36:39], v[64:67], v[92:95], 0
    buffer_load_dwordx4 v[160:163], v7, s[4:7], s56 offen
    v_mfma_f32_16x16x32_bf16 a[40:43], v[64:67], v[96:99], 0
    v_add_u32 v7, 57344, v7
    v_mfma_f32_16x16x32_bf16 a[44:47], v[64:67], v[100:103], 0
    s_add_u32 m0, s27, 16384
    v_mfma_f32_16x16x32_bf16 a[48:51], v[64:67], v[104:107], 0
    s_nop 0
    v_mfma_f32_16x16x32_bf16 a[52:55], v[64:67], v[108:111], 0
    buffer_load_dwordx4 v10, s[8:11], s26 offen offset:0 lds
    v_mfma_f32_16x16x32_bf16 a[56:59], v[64:67], v[112:115], 0
    buffer_load_dwordx4 v11, s[8:11], s26 offen offset:1024 lds
    v_mfma_f32_16x16x32_bf16 a[60:63], v[64:67], v[116:119], 0
    buffer_load_dwordx4 v12, s[8:11], s26 offen offset:2048 lds
    v_mfma_f32_16x16x32_bf16 a[64:67], v[64:67], v[120:123], 0
    buffer_load_dwordx4 v13, s[8:11], s26 offen offset:3072 lds
    v_mfma_f32_16x16x32_bf16 a[68:71], v[64:67], v[124:127], 0
    ds_read_b64_tr_b16 v[64:65], v19 offset:8192
    ds_read_b64_tr_b16 v[66:67], v19 offset:12288
    s_waitcnt lgkmcnt(4)
    v_mfma_f32_16x16x32_bf16 a[72:75], v[68:71], v[92:95], 0
    s_add_u32 m0, s27, 20480
    v_mfma_f32_16x16x32_bf16 a[76:79], v[68:71], v[96:99], 0
    s_nop 0
    v_mfma_f32_16x16x32_bf16 a[80:83], v[68:71], v[100:103], 0
    buffer_load_dwordx4 v14, s[8:11], s26 offen offset:0 lds
    v_mfma_f32_16x16x32_bf16 a[84:87], v[68:71], v[104:107], 0
    buffer_load_dwordx4 v15, s[8:11], s26 offen offset:1024 lds
    v_mfma_f32_16x16x32_bf16 a[88:91], v[68:71], v[108:111], 0
    buffer_load_dwordx4 v16, s[8:11], s26 offen offset:2048 lds
    v_mfma_f32_16x16x32_bf16 a[92:95], v[68:71], v[112:115], 0
    buffer_load_dwordx4 v17, s[8:11], s26 offen offset:3072 lds
    v_mfma_f32_16x16x32_bf16 a[96:99], v[68:71], v[116:119], 0
    s_add_u32 s26, s26, 163840
    v_mfma_f32_16x16x32_bf16 a[100:103], v[68:71], v[120:123], 0
    s_add_u32 m0, s27, 24576
    v_mfma_f32_16x16x32_bf16 a[104:107], v[68:71], v[124:127], 0
    ds_read_b64_tr_b16 v[68:69], v20 offset:8192
    ds_read_b64_tr_b16 v[70:71], v20 offset:12288
    v_mfma_f32_16x16x32_bf16 a[108:111], v[72:75], v[92:95], 0
    s_nop 0
    v_mfma_f32_16x16x32_bf16 a[112:115], v[72:75], v[96:99], 0
    buffer_load_dwordx4 v10, s[8:11], s26 offen offset:0 lds
    v_mfma_f32_16x16x32_bf16 a[116:119], v[72:75], v[100:103], 0
    buffer_load_dwordx4 v11, s[8:11], s26 offen offset:1024 lds
    v_mfma_f32_16x16x32_bf16 a[120:123], v[72:75], v[104:107], 0
    buffer_load_dwordx4 v12, s[8:11], s26 offen offset:2048 lds
    v_mfma_f32_16x16x32_bf16 a[124:127], v[72:75], v[108:111], 0
    buffer_load_dwordx4 v13, s[8:11], s26 offen offset:3072 lds
    v_mfma_f32_16x16x32_bf16 a[128:131], v[72:75], v[112:115], 0
    s_add_u32 m0, s27, 28672
    v_mfma_f32_16x16x32_bf16 a[132:135], v[72:75], v[116:119], 0
    s_nop 0
    v_mfma_f32_16x16x32_bf16 a[136:139], v[72:75], v[120:123], 0
    buffer_load_dwordx4 v14, s[8:11], s26 offen offset:0 lds
    v_mfma_f32_16x16x32_bf16 a[140:143], v[72:75], v[124:127], 0
    ds_read_b64_tr_b16 v[72:73], v21 offset:8192
    ds_read_b64_tr_b16 v[74:75], v21 offset:12288
    v_mfma_f32_16x16x32_bf16 a[144:147], v[76:79], v[92:95], 0
    buffer_load_dwordx4 v15, s[8:11], s26 offen offset:1024 lds
    v_mfma_f32_16x16x32_bf16 a[148:151], v[76:79], v[96:99], 0
    buffer_load_dwordx4 v16, s[8:11], s26 offen offset:2048 lds
    v_mfma_f32_16x16x32_bf16 a[152:155], v[76:79], v[100:103], 0
    buffer_load_dwordx4 v17, s[8:11], s26 offen offset:3072 lds
    v_mfma_f32_16x16x32_bf16 a[156:159], v[76:79], v[104:107], 0
    s_add_u32 s26, s26, 163840
    v_mfma_f32_16x16x32_bf16 a[160:163], v[76:79], v[108:111], 0
    buffer_load_dwordx4 v[164:167], v7, s[4:7], s48 offen
    v_mfma_f32_16x16x32_bf16 a[164:167], v[76:79], v[112:115], 0
    buffer_load_dwordx4 v[168:171], v7, s[4:7], s49 offen
    v_mfma_f32_16x16x32_bf16 a[168:171], v[76:79], v[116:119], 0
    buffer_load_dwordx4 v[172:175], v7, s[4:7], s50 offen
    v_mfma_f32_16x16x32_bf16 v[36:39], v[76:79], v[120:123], 0
    buffer_load_dwordx4 v[176:179], v7, s[4:7], s51 offen
    v_mfma_f32_16x16x32_bf16 v[52:55], v[76:79], v[124:127], 0
    ds_read_b64_tr_b16 v[76:77], v22 offset:8192
    ds_read_b64_tr_b16 v[78:79], v22 offset:12288
    v_mfma_f32_16x16x32_bf16 a[172:175], v[80:83], v[92:95], 0
    buffer_load_dwordx4 v[180:183], v7, s[4:7], s52 offen
    v_mfma_f32_16x16x32_bf16 a[176:179], v[80:83], v[96:99], 0
    buffer_load_dwordx4 v[184:187], v7, s[4:7], s53 offen
    v_mfma_f32_16x16x32_bf16 a[180:183], v[80:83], v[100:103], 0
    buffer_load_dwordx4 v[188:191], v7, s[4:7], s54 offen
    v_mfma_f32_16x16x32_bf16 a[184:187], v[80:83], v[104:107], 0
    buffer_load_dwordx4 v[192:195], v7, s[4:7], s55 offen
    v_mfma_f32_16x16x32_bf16 a[188:191], v[80:83], v[108:111], 0
    buffer_load_dwordx4 v[196:199], v7, s[4:7], s56 offen
    v_mfma_f32_16x16x32_bf16 a[192:195], v[80:83], v[112:115], 0
    v_add_u32 v7, 57344, v7
    v_mfma_f32_16x16x32_bf16 a[196:199], v[80:83], v[116:119], 0
    buffer_load_dwordx4 v[200:203], v7, s[4:7], s48 offen
    v_mfma_f32_16x16x32_bf16 v[40:43], v[80:83], v[120:123], 0
    buffer_load_dwordx4 v[204:207], v7, s[4:7], s49 offen
    v_mfma_f32_16x16x32_bf16 v[56:59], v[80:83], v[124:127], 0
    ds_read_b64_tr_b16 v[80:81], v23 offset:8192
    ds_read_b64_tr_b16 v[82:83], v23 offset:12288
    v_mfma_f32_16x16x32_bf16 a[200:203], v[84:87], v[92:95], 0
    buffer_load_dwordx4 v[208:211], v7, s[4:7], s50 offen
    v_mfma_f32_16x16x32_bf16 a[204:207], v[84:87], v[96:99], 0
    buffer_load_dwordx4 v[212:215], v7, s[4:7], s51 offen
    v_mfma_f32_16x16x32_bf16 a[208:211], v[84:87], v[100:103], 0
    buffer_load_dwordx4 v[216:219], v7, s[4:7], s52 offen
    v_mfma_f32_16x16x32_bf16 a[212:215], v[84:87], v[104:107], 0
    buffer_load_dwordx4 v[220:223], v7, s[4:7], s53 offen
    v_mfma_f32_16x16x32_bf16 v[244:247], v[84:87], v[108:111], 0
    buffer_load_dwordx4 v[224:227], v7, s[4:7], s54 offen
    v_mfma_f32_16x16x32_bf16 a[216:219], v[84:87], v[112:115], 0
    buffer_load_dwordx4 v[228:231], v7, s[4:7], s55 offen
    v_mfma_f32_16x16x32_bf16 v[28:31], v[84:87], v[116:119], 0
    buffer_load_dwordx4 v[232:235], v7, s[4:7], s56 offen
    v_mfma_f32_16x16x32_bf16 v[44:47], v[84:87], v[120:123], 0
    v_add_u32 v7, 57344, v7
    v_mfma_f32_16x16x32_bf16 v[236:239], v[84:87], v[124:127], 0
    ds_read_b64_tr_b16 v[84:85], v24 offset:8192
    ds_read_b64_tr_b16 v[86:87], v24 offset:12288
    v_mfma_f32_16x16x32_bf16 a[220:223], v[88:91], v[92:95], 0
    v_mfma_f32_16x16x32_bf16 a[224:227], v[88:91], v[96:99], 0
    v_mfma_f32_16x16x32_bf16 a[228:231], v[88:91], v[100:103], 0
    v_mfma_f32_16x16x32_bf16 a[232:235], v[88:91], v[104:107], 0
    v_mfma_f32_16x16x32_bf16 v[248:251], v[88:91], v[108:111], 0
    v_mfma_f32_16x16x32_bf16 a[236:239], v[88:91], v[112:115], 0
    v_mfma_f32_16x16x32_bf16 v[32:35], v[88:91], v[116:119], 0
    v_mfma_f32_16x16x32_bf16 v[48:51], v[88:91], v[120:123], 0
    v_mfma_f32_16x16x32_bf16 v[240:243], v[88:91], v[124:127], 0
    ds_read_b64_tr_b16 v[88:89], v25 offset:8192
    ds_read_b64_tr_b16 v[90:91], v25 offset:12288
    s_waitcnt vmcnt(34) lgkmcnt(12)
    v_mfma_f32_16x16x32_bf16 a[0:3], v[60:63], v[128:131], a[0:3]
    v_mfma_f32_16x16x32_bf16 a[4:7], v[60:63], v[132:135], a[4:7]
    v_mfma_f32_16x16x32_bf16 a[8:11], v[60:63], v[136:139], a[8:11]
    v_mfma_f32_16x16x32_bf16 a[12:15], v[60:63], v[140:143], a[12:15]
    v_mfma_f32_16x16x32_bf16 a[16:19], v[60:63], v[144:147], a[16:19]
    v_mfma_f32_16x16x32_bf16 a[20:23], v[60:63], v[148:151], a[20:23]
    v_mfma_f32_16x16x32_bf16 a[24:27], v[60:63], v[152:155], a[24:27]
    v_mfma_f32_16x16x32_bf16 a[28:31], v[60:63], v[156:159], a[28:31]
    v_mfma_f32_16x16x32_bf16 a[32:35], v[60:63], v[160:163], a[32:35]
    v_mfma_f32_16x16x32_bf16 a[36:39], v[64:67], v[128:131], a[36:39]
    v_mfma_f32_16x16x32_bf16 a[40:43], v[64:67], v[132:135], a[40:43]
    v_mfma_f32_16x16x32_bf16 a[44:47], v[64:67], v[136:139], a[44:47]
    v_mfma_f32_16x16x32_bf16 a[48:51], v[64:67], v[140:143], a[48:51]
    v_mfma_f32_16x16x32_bf16 a[52:55], v[64:67], v[144:147], a[52:55]
    v_mfma_f32_16x16x32_bf16 a[56:59], v[64:67], v[148:151], a[56:59]
    v_mfma_f32_16x16x32_bf16 a[60:63], v[64:67], v[152:155], a[60:63]
    v_mfma_f32_16x16x32_bf16 a[64:67], v[64:67], v[156:159], a[64:67]
    v_mfma_f32_16x16x32_bf16 a[68:71], v[64:67], v[160:163], a[68:71]
    s_waitcnt vmcnt(18)
    ds_read_b64_tr_b16 v[60:61], v18 offset:16384
    ds_read_b64_tr_b16 v[62:63], v18 offset:20480
    ds_read_b64_tr_b16 v[64:65], v18 offset:24576
    ds_read_b64_tr_b16 v[66:67], v18 offset:28672
    s_waitcnt lgkmcnt(4)
    v_mfma_f32_16x16x32_bf16 a[72:75], v[68:71], v[128:131], a[72:75]
    s_add_u32 m0, s27, 0
    v_mfma_f32_16x16x32_bf16 a[76:79], v[68:71], v[132:135], a[76:79]
    s_nop 0
    v_mfma_f32_16x16x32_bf16 a[80:83], v[68:71], v[136:139], a[80:83]
    buffer_load_dwordx4 v10, s[8:11], s26 offen offset:0 lds
    v_mfma_f32_16x16x32_bf16 a[84:87], v[68:71], v[140:143], a[84:87]
    buffer_load_dwordx4 v11, s[8:11], s26 offen offset:1024 lds
    v_mfma_f32_16x16x32_bf16 a[88:91], v[68:71], v[144:147], a[88:91]
    buffer_load_dwordx4 v12, s[8:11], s26 offen offset:2048 lds
    v_mfma_f32_16x16x32_bf16 a[92:95], v[68:71], v[148:151], a[92:95]
    buffer_load_dwordx4 v13, s[8:11], s26 offen offset:3072 lds
    v_mfma_f32_16x16x32_bf16 a[96:99], v[68:71], v[152:155], a[96:99]
    s_add_u32 m0, s27, 4096
    v_mfma_f32_16x16x32_bf16 a[100:103], v[68:71], v[156:159], a[100:103]
    s_nop 0
    v_mfma_f32_16x16x32_bf16 a[104:107], v[68:71], v[160:163], a[104:107]
    buffer_load_dwordx4 v14, s[8:11], s26 offen offset:0 lds
    v_mfma_f32_16x16x32_bf16 a[108:111], v[72:75], v[128:131], a[108:111]
    buffer_load_dwordx4 v15, s[8:11], s26 offen offset:1024 lds
    v_mfma_f32_16x16x32_bf16 a[112:115], v[72:75], v[132:135], a[112:115]
    buffer_load_dwordx4 v16, s[8:11], s26 offen offset:2048 lds
    v_mfma_f32_16x16x32_bf16 a[116:119], v[72:75], v[136:139], a[116:119]
    buffer_load_dwordx4 v17, s[8:11], s26 offen offset:3072 lds
    v_mfma_f32_16x16x32_bf16 a[120:123], v[72:75], v[140:143], a[120:123]
    s_add_u32 s26, s26, 163840
    v_mfma_f32_16x16x32_bf16 a[124:127], v[72:75], v[144:147], a[124:127]
    s_add_u32 m0, s27, 8192
    v_mfma_f32_16x16x32_bf16 a[128:131], v[72:75], v[148:151], a[128:131]
    s_nop 0
    v_mfma_f32_16x16x32_bf16 a[132:135], v[72:75], v[152:155], a[132:135]
    buffer_load_dwordx4 v10, s[8:11], s26 offen offset:0 lds
    v_mfma_f32_16x16x32_bf16 a[136:139], v[72:75], v[156:159], a[136:139]
    buffer_load_dwordx4 v11, s[8:11], s26 offen offset:1024 lds
    v_mfma_f32_16x16x32_bf16 a[140:143], v[72:75], v[160:163], a[140:143]
    ds_read_b64_tr_b16 v[68:69], v19 offset:16384
    ds_read_b64_tr_b16 v[70:71], v19 offset:20480
    ds_read_b64_tr_b16 v[72:73], v19 offset:24576
    ds_read_b64_tr_b16 v[74:75], v19 offset:28672
    v_mfma_f32_16x16x32_bf16 a[144:147], v[76:79], v[128:131], a[144:147]
    buffer_load_dwordx4 v12, s[8:11], s26 offen offset:2048 lds
    v_mfma_f32_16x16x32_bf16 a[148:151], v[76:79], v[132:135], a[148:151]
    buffer_load_dwordx4 v13, s[8:11], s26 offen offset:3072 lds
    v_mfma_f32_16x16x32_bf16 a[152:155], v[76:79], v[136:139], a[152:155]
    s_add_u32 m0, s27, 12288
    v_mfma_f32_16x16x32_bf16 a[156:159], v[76:79], v[140:143], a[156:159]
    s_nop 0
    v_mfma_f32_16x16x32_bf16 a[160:163], v[76:79], v[144:147], a[160:163]
    buffer_load_dwordx4 v14, s[8:11], s26 offen offset:0 lds
    v_mfma_f32_16x16x32_bf16 a[164:167], v[76:79], v[148:151], a[164:167]
    buffer_load_dwordx4 v15, s[8:11], s26 offen offset:1024 lds
    v_mfma_f32_16x16x32_bf16 a[168:171], v[76:79], v[152:155], a[168:171]
    buffer_load_dwordx4 v16, s[8:11], s26 offen offset:2048 lds
    v_mfma_f32_16x16x32_bf16 v[36:39], v[76:79], v[156:159], v[36:39]
    buffer_load_dwordx4 v17, s[8:11], s26 offen offset:3072 lds
    v_mfma_f32_16x16x32_bf16 v[52:55], v[76:79], v[160:163], v[52:55]
    s_add_u32 s26, s26, 163840
    v_mfma_f32_16x16x32_bf16 a[172:175], v[80:83], v[128:131], a[172:175]
    v_mfma_f32_16x16x32_bf16 a[176:179], v[80:83], v[132:135], a[176:179]
    v_mfma_f32_16x16x32_bf16 a[180:183], v[80:83], v[136:139], a[180:183]
    v_mfma_f32_16x16x32_bf16 a[184:187], v[80:83], v[140:143], a[184:187]
    v_mfma_f32_16x16x32_bf16 a[188:191], v[80:83], v[144:147], a[188:191]
    v_mfma_f32_16x16x32_bf16 a[192:195], v[80:83], v[148:151], a[192:195]
    v_mfma_f32_16x16x32_bf16 a[196:199], v[80:83], v[152:155], a[196:199]
    v_mfma_f32_16x16x32_bf16 v[40:43], v[80:83], v[156:159], v[40:43]
    v_mfma_f32_16x16x32_bf16 v[56:59], v[80:83], v[160:163], v[56:59]
    ds_read_b64_tr_b16 v[76:77], v20 offset:16384
    ds_read_b64_tr_b16 v[78:79], v20 offset:20480
    ds_read_b64_tr_b16 v[80:81], v20 offset:24576
    ds_read_b64_tr_b16 v[82:83], v20 offset:28672
    v_mfma_f32_16x16x32_bf16 a[200:203], v[84:87], v[128:131], a[200:203]
    v_mfma_f32_16x16x32_bf16 a[204:207], v[84:87], v[132:135], a[204:207]
    v_mfma_f32_16x16x32_bf16 a[208:211], v[84:87], v[136:139], a[208:211]
    v_mfma_f32_16x16x32_bf16 a[212:215], v[84:87], v[140:143], a[212:215]
    v_mfma_f32_16x16x32_bf16 v[244:247], v[84:87], v[144:147], v[244:247]
    v_mfma_f32_16x16x32_bf16 a[216:219], v[84:87], v[148:151], a[216:219]
    v_mfma_f32_16x16x32_bf16 v[28:31], v[84:87], v[152:155], v[28:31]
    v_mfma_f32_16x16x32_bf16 v[44:47], v[84:87], v[156:159], v[44:47]
    v_mfma_f32_16x16x32_bf16 v[236:239], v[84:87], v[160:163], v[236:239]
    v_mfma_f32_16x16x32_bf16 a[220:223], v[88:91], v[128:131], a[220:223]
    v_mfma_f32_16x16x32_bf16 a[224:227], v[88:91], v[132:135], a[224:227]
    v_mfma_f32_16x16x32_bf16 a[228:231], v[88:91], v[136:139], a[228:231]
    v_mfma_f32_16x16x32_bf16 a[232:235], v[88:91], v[140:143], a[232:235]
    v_mfma_f32_16x16x32_bf16 v[248:251], v[88:91], v[144:147], v[248:251]
    v_mfma_f32_16x16x32_bf16 a[236:239], v[88:91], v[148:151], a[236:239]
    v_mfma_f32_16x16x32_bf16 v[32:35], v[88:91], v[152:155], v[32:35]
    v_mfma_f32_16x16x32_bf16 v[48:51], v[88:91], v[156:159], v[48:51]
    v_mfma_f32_16x16x32_bf16 v[240:243], v[88:91], v[160:163], v[240:243]
    ds_read_b64_tr_b16 v[84:85], v21 offset:16384
    ds_read_b64_tr_b16 v[86:87], v21 offset:20480
    ds_read_b64_tr_b16 v[88:89], v21 offset:24576
    ds_read_b64_tr_b16 v[90:91], v21 offset:28672
    s_waitcnt vmcnt(16) lgkmcnt(12)
    v_mfma_f32_16x16x32_bf16 a[0:3], v[60:63], v[164:167], a[0:3]
    buffer_load_dwordx4 v[92:95], v7, s[4:7], s48 offen
    v_mfma_f32_16x16x32_bf16 a[0:3], v[64:67], v[200:203], a[0:3]
    buffer_load_dwordx4 v[96:99], v7, s[4:7], s49 offen
    v_mfma_f32_16x16x32_bf16 a[4:7], v[60:63], v[168:171], a[4:7]
    buffer_load_dwordx4 v[100:103], v7, s[4:7], s50 offen
    v_mfma_f32_16x16x32_bf16 a[4:7], v[64:67], v[204:207], a[4:7]
    buffer_load_dwordx4 v[104:107], v7, s[4:7], s51 offen
    v_mfma_f32_16x16x32_bf16 a[8:11], v[60:63], v[172:175], a[8:11]
    buffer_load_dwordx4 v[108:111], v7, s[4:7], s52 offen
    v_mfma_f32_16x16x32_bf16 a[8:11], v[64:67], v[208:211], a[8:11]
    buffer_load_dwordx4 v[112:115], v7, s[4:7], s53 offen
    v_mfma_f32_16x16x32_bf16 a[12:15], v[60:63], v[176:179], a[12:15]
    buffer_load_dwordx4 v[116:119], v7, s[4:7], s54 offen
    v_mfma_f32_16x16x32_bf16 a[12:15], v[64:67], v[212:215], a[12:15]
    buffer_load_dwordx4 v[120:123], v7, s[4:7], s55 offen
    v_mfma_f32_16x16x32_bf16 a[16:19], v[60:63], v[180:183], a[16:19]
    buffer_load_dwordx4 v[124:127], v7, s[4:7], s56 offen
    v_mfma_f32_16x16x32_bf16 a[16:19], v[64:67], v[216:219], a[16:19]
    v_add_u32 v7, 57344, v7
    v_mfma_f32_16x16x32_bf16 a[20:23], v[60:63], v[184:187], a[20:23]
    buffer_load_dwordx4 v[128:131], v7, s[4:7], s48 offen
    v_mfma_f32_16x16x32_bf16 a[20:23], v[64:67], v[220:223], a[20:23]
    buffer_load_dwordx4 v[132:135], v7, s[4:7], s49 offen
    v_mfma_f32_16x16x32_bf16 a[24:27], v[60:63], v[188:191], a[24:27]
    buffer_load_dwordx4 v[136:139], v7, s[4:7], s50 offen
    v_mfma_f32_16x16x32_bf16 a[24:27], v[64:67], v[224:227], a[24:27]
    buffer_load_dwordx4 v[140:143], v7, s[4:7], s51 offen
    v_mfma_f32_16x16x32_bf16 a[28:31], v[60:63], v[192:195], a[28:31]
    buffer_load_dwordx4 v[144:147], v7, s[4:7], s52 offen
    v_mfma_f32_16x16x32_bf16 a[28:31], v[64:67], v[228:231], a[28:31]
    buffer_load_dwordx4 v[148:151], v7, s[4:7], s53 offen
    v_mfma_f32_16x16x32_bf16 a[32:35], v[60:63], v[196:199], a[32:35]
    buffer_load_dwordx4 v[152:155], v7, s[4:7], s54 offen
    v_mfma_f32_16x16x32_bf16 a[32:35], v[64:67], v[232:235], a[32:35]
    ds_read_b64_tr_b16 v[60:61], v22 offset:16384
    ds_read_b64_tr_b16 v[62:63], v22 offset:20480
    ds_read_b64_tr_b16 v[64:65], v22 offset:24576
    ds_read_b64_tr_b16 v[66:67], v22 offset:28672
    s_waitcnt lgkmcnt(12)
    v_mfma_f32_16x16x32_bf16 a[36:39], v[68:71], v[164:167], a[36:39]
    buffer_load_dwordx4 v[156:159], v7, s[4:7], s55 offen
    v_mfma_f32_16x16x32_bf16 a[36:39], v[72:75], v[200:203], a[36:39]
    buffer_load_dwordx4 v[160:163], v7, s[4:7], s56 offen
    v_mfma_f32_16x16x32_bf16 a[40:43], v[68:71], v[168:171], a[40:43]
    v_add_u32 v7, 57344, v7
    v_mfma_f32_16x16x32_bf16 a[40:43], v[72:75], v[204:207], a[40:43]
    v_mfma_f32_16x16x32_bf16 a[44:47], v[68:71], v[172:175], a[44:47]
    v_mfma_f32_16x16x32_bf16 a[44:47], v[72:75], v[208:211], a[44:47]
    v_mfma_f32_16x16x32_bf16 a[48:51], v[68:71], v[176:179], a[48:51]
    v_mfma_f32_16x16x32_bf16 a[48:51], v[72:75], v[212:215], a[48:51]
    v_mfma_f32_16x16x32_bf16 a[52:55], v[68:71], v[180:183], a[52:55]
    v_mfma_f32_16x16x32_bf16 a[52:55], v[72:75], v[216:219], a[52:55]
    v_mfma_f32_16x16x32_bf16 a[56:59], v[68:71], v[184:187], a[56:59]
    v_mfma_f32_16x16x32_bf16 a[56:59], v[72:75], v[220:223], a[56:59]
    v_mfma_f32_16x16x32_bf16 a[60:63], v[68:71], v[188:191], a[60:63]
    v_mfma_f32_16x16x32_bf16 a[60:63], v[72:75], v[224:227], a[60:63]
    v_mfma_f32_16x16x32_bf16 a[64:67], v[68:71], v[192:195], a[64:67]
    v_mfma_f32_16x16x32_bf16 a[64:67], v[72:75], v[228:231], a[64:67]
    v_mfma_f32_16x16x32_bf16 a[68:71], v[68:71], v[196:199], a[68:71]
    v_mfma_f32_16x16x32_bf16 a[68:71], v[72:75], v[232:235], a[68:71]
    ds_read_b64_tr_b16 v[68:69], v23 offset:16384
    ds_read_b64_tr_b16 v[70:71], v23 offset:20480
    ds_read_b64_tr_b16 v[72:73], v23 offset:24576
    ds_read_b64_tr_b16 v[74:75], v23 offset:28672
    s_waitcnt lgkmcnt(12)
    v_mfma_f32_16x16x32_bf16 a[72:75], v[76:79], v[164:167], a[72:75]
    v_mfma_f32_16x16x32_bf16 a[72:75], v[80:83], v[200:203], a[72:75]
    v_mfma_f32_16x16x32_bf16 a[76:79], v[76:79], v[168:171], a[76:79]
    v_mfma_f32_16x16x32_bf16 a[76:79], v[80:83], v[204:207], a[76:79]
    v_mfma_f32_16x16x32_bf16 a[80:83], v[76:79], v[172:175], a[80:83]
    v_mfma_f32_16x16x32_bf16 a[80:83], v[80:83], v[208:211], a[80:83]
    v_mfma_f32_16x16x32_bf16 a[84:87], v[76:79], v[176:179], a[84:87]
    v_mfma_f32_16x16x32_bf16 a[84:87], v[80:83], v[212:215], a[84:87]
    v_mfma_f32_16x16x32_bf16 a[88:91], v[76:79], v[180:183], a[88:91]
    v_mfma_f32_16x16x32_bf16 a[88:91], v[80:83], v[216:219], a[88:91]
    v_mfma_f32_16x16x32_bf16 a[92:95], v[76:79], v[184:187], a[92:95]
    v_mfma_f32_16x16x32_bf16 a[92:95], v[80:83], v[220:223], a[92:95]
    v_mfma_f32_16x16x32_bf16 a[96:99], v[76:79], v[188:191], a[96:99]
    v_mfma_f32_16x16x32_bf16 a[96:99], v[80:83], v[224:227], a[96:99]
    v_mfma_f32_16x16x32_bf16 a[100:103], v[76:79], v[192:195], a[100:103]
    v_mfma_f32_16x16x32_bf16 a[100:103], v[80:83], v[228:231], a[100:103]
    v_mfma_f32_16x16x32_bf16 a[104:107], v[76:79], v[196:199], a[104:107]
    v_mfma_f32_16x16x32_bf16 a[104:107], v[80:83], v[232:235], a[104:107]
    ds_read_b64_tr_b16 v[76:77], v24 offset:16384
    ds_read_b64_tr_b16 v[78:79], v24 offset:20480
    ds_read_b64_tr_b16 v[80:81], v24 offset:24576
    ds_read_b64_tr_b16 v[82:83], v24 offset:28672
    s_waitcnt lgkmcnt(12)
    v_mfma_f32_16x16x32_bf16 a[108:111], v[84:87], v[164:167], a[108:111]
    v_mfma_f32_16x16x32_bf16 a[108:111], v[88:91], v[200:203], a[108:111]
    v_mfma_f32_16x16x32_bf16 a[112:115], v[84:87], v[168:171], a[112:115]
    v_mfma_f32_16x16x32_bf16 a[112:115], v[88:91], v[204:207], a[112:115]
    v_mfma_f32_16x16x32_bf16 a[116:119], v[84:87], v[172:175], a[116:119]
    v_mfma_f32_16x16x32_bf16 a[116:119], v[88:91], v[208:211], a[116:119]
    v_mfma_f32_16x16x32_bf16 a[120:123], v[84:87], v[176:179], a[120:123]
    v_mfma_f32_16x16x32_bf16 a[120:123], v[88:91], v[212:215], a[120:123]
    v_mfma_f32_16x16x32_bf16 a[124:127], v[84:87], v[180:183], a[124:127]
    v_mfma_f32_16x16x32_bf16 a[124:127], v[88:91], v[216:219], a[124:127]
    v_mfma_f32_16x16x32_bf16 a[128:131], v[84:87], v[184:187], a[128:131]
    v_mfma_f32_16x16x32_bf16 a[128:131], v[88:91], v[220:223], a[128:131]
    v_mfma_f32_16x16x32_bf16 a[132:135], v[84:87], v[188:191], a[132:135]
    v_mfma_f32_16x16x32_bf16 a[132:135], v[88:91], v[224:227], a[132:135]
    v_mfma_f32_16x16x32_bf16 a[136:139], v[84:87], v[192:195], a[136:139]
    v_mfma_f32_16x16x32_bf16 a[136:139], v[88:91], v[228:231], a[136:139]
    v_mfma_f32_16x16x32_bf16 a[140:143], v[84:87], v[196:199], a[140:143]
    v_mfma_f32_16x16x32_bf16 a[140:143], v[88:91], v[232:235], a[140:143]
    ds_read_b64_tr_b16 v[84:85], v25 offset:16384
    ds_read_b64_tr_b16 v[86:87], v25 offset:20480
    ds_read_b64_tr_b16 v[88:89], v25 offset:24576
    ds_read_b64_tr_b16 v[90:91], v25 offset:28672
    s_waitcnt lgkmcnt(12)
    v_mfma_f32_16x16x32_bf16 a[144:147], v[60:63], v[164:167], a[144:147]
    v_mfma_f32_16x16x32_bf16 a[144:147], v[64:67], v[200:203], a[144:147]
    v_mfma_f32_16x16x32_bf16 a[148:151], v[60:63], v[168:171], a[148:151]
    v_mfma_f32_16x16x32_bf16 a[148:151], v[64:67], v[204:207], a[148:151]
    v_mfma_f32_16x16x32_bf16 a[152:155], v[60:63], v[172:175], a[152:155]
    v_mfma_f32_16x16x32_bf16 a[152:155], v[64:67], v[208:211], a[152:155]
    v_mfma_f32_16x16x32_bf16 a[156:159], v[60:63], v[176:179], a[156:159]
    v_mfma_f32_16x16x32_bf16 a[156:159], v[64:67], v[212:215], a[156:159]
    v_mfma_f32_16x16x32_bf16 a[160:163], v[60:63], v[180:183], a[160:163]
    v_mfma_f32_16x16x32_bf16 a[160:163], v[64:67], v[216:219], a[160:163]
    v_mfma_f32_16x16x32_bf16 a[164:167], v[60:63], v[184:187], a[164:167]
    v_mfma_f32_16x16x32_bf16 a[164:167], v[64:67], v[220:223], a[164:167]
    v_mfma_f32_16x16x32_bf16 a[168:171], v[60:63], v[188:191], a[168:171]
    v_mfma_f32_16x16x32_bf16 a[168:171], v[64:67], v[224:227], a[168:171]
    v_mfma_f32_16x16x32_bf16 v[36:39], v[60:63], v[192:195], v[36:39]
    v_mfma_f32_16x16x32_bf16 v[36:39], v[64:67], v[228:231], v[36:39]
    v_mfma_f32_16x16x32_bf16 v[52:55], v[60:63], v[196:199], v[52:55]
    v_mfma_f32_16x16x32_bf16 v[52:55], v[64:67], v[232:235], v[52:55]
    s_waitcnt vmcnt(18)
    ds_read_b64_tr_b16 v[60:61], v18 offset:0
    ds_read_b64_tr_b16 v[62:63], v18 offset:4096
    ds_read_b64_tr_b16 v[64:65], v18 offset:8192
    ds_read_b64_tr_b16 v[66:67], v18 offset:12288
    s_waitcnt lgkmcnt(4)
    v_mfma_f32_16x16x32_bf16 a[172:175], v[68:71], v[164:167], a[172:175]
    s_add_u32 m0, s27, 16384
    v_mfma_f32_16x16x32_bf16 a[172:175], v[72:75], v[200:203], a[172:175]
    s_nop 0
    v_mfma_f32_16x16x32_bf16 a[176:179], v[68:71], v[168:171], a[176:179]
    buffer_load_dwordx4 v10, s[8:11], s26 offen offset:0 lds
    v_mfma_f32_16x16x32_bf16 a[176:179], v[72:75], v[204:207], a[176:179]
    buffer_load_dwordx4 v11, s[8:11], s26 offen offset:1024 lds
    v_mfma_f32_16x16x32_bf16 a[180:183], v[68:71], v[172:175], a[180:183]
    buffer_load_dwordx4 v12, s[8:11], s26 offen offset:2048 lds
    v_mfma_f32_16x16x32_bf16 a[180:183], v[72:75], v[208:211], a[180:183]
    buffer_load_dwordx4 v13, s[8:11], s26 offen offset:3072 lds
    v_mfma_f32_16x16x32_bf16 a[184:187], v[68:71], v[176:179], a[184:187]
    s_add_u32 m0, s27, 20480
    v_mfma_f32_16x16x32_bf16 a[184:187], v[72:75], v[212:215], a[184:187]
    s_nop 0
    v_mfma_f32_16x16x32_bf16 a[188:191], v[68:71], v[180:183], a[188:191]
    buffer_load_dwordx4 v14, s[8:11], s26 offen offset:0 lds
    v_mfma_f32_16x16x32_bf16 a[188:191], v[72:75], v[216:219], a[188:191]
    buffer_load_dwordx4 v15, s[8:11], s26 offen offset:1024 lds
    v_mfma_f32_16x16x32_bf16 a[192:195], v[68:71], v[184:187], a[192:195]
    buffer_load_dwordx4 v16, s[8:11], s26 offen offset:2048 lds
    v_mfma_f32_16x16x32_bf16 a[192:195], v[72:75], v[220:223], a[192:195]
    buffer_load_dwordx4 v17, s[8:11], s26 offen offset:3072 lds
    v_mfma_f32_16x16x32_bf16 a[196:199], v[68:71], v[188:191], a[196:199]
    s_add_u32 s26, s26, 163840
    v_mfma_f32_16x16x32_bf16 a[196:199], v[72:75], v[224:227], a[196:199]
    s_add_u32 m0, s27, 24576
    v_mfma_f32_16x16x32_bf16 v[40:43], v[68:71], v[192:195], v[40:43]
    s_nop 0
    v_mfma_f32_16x16x32_bf16 v[40:43], v[72:75], v[228:231], v[40:43]
    buffer_load_dwordx4 v10, s[8:11], s26 offen offset:0 lds
    v_mfma_f32_16x16x32_bf16 v[56:59], v[68:71], v[196:199], v[56:59]
    buffer_load_dwordx4 v11, s[8:11], s26 offen offset:1024 lds
    v_mfma_f32_16x16x32_bf16 v[56:59], v[72:75], v[232:235], v[56:59]
    ds_read_b64_tr_b16 v[68:69], v19 offset:0
    ds_read_b64_tr_b16 v[70:71], v19 offset:4096
    ds_read_b64_tr_b16 v[72:73], v19 offset:8192
    ds_read_b64_tr_b16 v[74:75], v19 offset:12288
    s_waitcnt lgkmcnt(12)
    v_mfma_f32_16x16x32_bf16 a[200:203], v[76:79], v[164:167], a[200:203]
    buffer_load_dwordx4 v12, s[8:11], s26 offen offset:2048 lds
    v_mfma_f32_16x16x32_bf16 a[200:203], v[80:83], v[200:203], a[200:203]
    buffer_load_dwordx4 v13, s[8:11], s26 offen offset:3072 lds
    v_mfma_f32_16x16x32_bf16 a[204:207], v[76:79], v[168:171], a[204:207]
    s_add_u32 m0, s27, 28672
    v_mfma_f32_16x16x32_bf16 a[204:207], v[80:83], v[204:207], a[204:207]
    s_nop 0
    v_mfma_f32_16x16x32_bf16 a[208:211], v[76:79], v[172:175], a[208:211]
    buffer_load_dwordx4 v14, s[8:11], s26 offen offset:0 lds
    v_mfma_f32_16x16x32_bf16 a[208:211], v[80:83], v[208:211], a[208:211]
    buffer_load_dwordx4 v15, s[8:11], s26 offen offset:1024 lds
    v_mfma_f32_16x16x32_bf16 a[212:215], v[76:79], v[176:179], a[212:215]
    buffer_load_dwordx4 v16, s[8:11], s26 offen offset:2048 lds
    v_mfma_f32_16x16x32_bf16 a[212:215], v[80:83], v[212:215], a[212:215]
    buffer_load_dwordx4 v17, s[8:11], s26 offen offset:3072 lds
    v_mfma_f32_16x16x32_bf16 v[244:247], v[76:79], v[180:183], v[244:247]
    s_add_u32 s26, s26, 163840
    v_mfma_f32_16x16x32_bf16 v[244:247], v[80:83], v[216:219], v[244:247]
    v_mfma_f32_16x16x32_bf16 a[216:219], v[76:79], v[184:187], a[216:219]
    v_mfma_f32_16x16x32_bf16 a[216:219], v[80:83], v[220:223], a[216:219]
    v_mfma_f32_16x16x32_bf16 v[28:31], v[76:79], v[188:191], v[28:31]
    v_mfma_f32_16x16x32_bf16 v[28:31], v[80:83], v[224:227], v[28:31]
    v_mfma_f32_16x16x32_bf16 v[44:47], v[76:79], v[192:195], v[44:47]
    v_mfma_f32_16x16x32_bf16 v[44:47], v[80:83], v[228:231], v[44:47]
    v_mfma_f32_16x16x32_bf16 v[236:239], v[76:79], v[196:199], v[236:239]
    v_mfma_f32_16x16x32_bf16 v[236:239], v[80:83], v[232:235], v[236:239]
    ds_read_b64_tr_b16 v[76:77], v20 offset:0
    ds_read_b64_tr_b16 v[78:79], v20 offset:4096
    ds_read_b64_tr_b16 v[80:81], v20 offset:8192
    ds_read_b64_tr_b16 v[82:83], v20 offset:12288
    s_waitcnt lgkmcnt(12)
    v_mfma_f32_16x16x32_bf16 a[220:223], v[84:87], v[164:167], a[220:223]
    v_mfma_f32_16x16x32_bf16 a[220:223], v[88:91], v[200:203], a[220:223]
    v_mfma_f32_16x16x32_bf16 a[224:227], v[84:87], v[168:171], a[224:227]
    v_mfma_f32_16x16x32_bf16 a[224:227], v[88:91], v[204:207], a[224:227]
    v_mfma_f32_16x16x32_bf16 a[228:231], v[84:87], v[172:175], a[228:231]
    v_mfma_f32_16x16x32_bf16 a[228:231], v[88:91], v[208:211], a[228:231]
    v_mfma_f32_16x16x32_bf16 a[232:235], v[84:87], v[176:179], a[232:235]
    v_mfma_f32_16x16x32_bf16 a[232:235], v[88:91], v[212:215], a[232:235]
    v_mfma_f32_16x16x32_bf16 v[248:251], v[84:87], v[180:183], v[248:251]
    v_mfma_f32_16x16x32_bf16 v[248:251], v[88:91], v[216:219], v[248:251]
    v_mfma_f32_16x16x32_bf16 a[236:239], v[84:87], v[184:187], a[236:239]
    v_mfma_f32_16x16x32_bf16 a[236:239], v[88:91], v[220:223], a[236:239]
    v_mfma_f32_16x16x32_bf16 v[32:35], v[84:87], v[188:191], v[32:35]
    v_mfma_f32_16x16x32_bf16 v[32:35], v[88:91], v[224:227], v[32:35]
    v_mfma_f32_16x16x32_bf16 v[48:51], v[84:87], v[192:195], v[48:51]
    v_mfma_f32_16x16x32_bf16 v[48:51], v[88:91], v[228:231], v[48:51]
    v_mfma_f32_16x16x32_bf16 v[240:243], v[84:87], v[196:199], v[240:243]
    v_mfma_f32_16x16x32_bf16 v[240:243], v[88:91], v[232:235], v[240:243]
    ds_read_b64_tr_b16 v[84:85], v21 offset:0
    ds_read_b64_tr_b16 v[86:87], v21 offset:4096
    ds_read_b64_tr_b16 v[88:89], v21 offset:8192
    ds_read_b64_tr_b16 v[90:91], v21 offset:12288
    s_mov_b32 s21, 0
L_op_loop:
    s_waitcnt vmcnt(16) lgkmcnt(12)
    v_mfma_f32_16x16x32_bf16 a[0:3], v[60:63], v[92:95], a[0:3]
    buffer_load_dwordx4 v[164:167], v7, s[4:7], s48 offen
    v_mfma_f32_16x16x32_bf16 a[0:3], v[64:67], v[128:131], a[0:3]
    buffer_load_dwordx4 v[168:171], v7, s[4:7], s49 offen
    v_mfma_f32_16x16x32_bf16 a[4:7], v[60:63], v[96:99], a[4:7]
    buffer_load_dwordx4 v[172:175], v7, s[4:7], s50 offen
    v_mfma_f32_16x16x32_bf16 a[4:7], v[64:67], v[132:135], a[4:7]
    buffer_load_dwordx4 v[176:179], v7, s[4:7], s51 offen
    v_mfma_f32_16x16x32_bf16 a[8:11], v[60:63], v[100:103], a[8:11]
    buffer_load_dwordx4 v[180:183], v7, s[4:7], s52 offen
    v_mfma_f32_16x16x32_bf16 a[8:11], v[64:67], v[136:139], a[8:11]
    buffer_load_dwordx4 v[184:187], v7, s[4:7], s53 offen
    v_mfma_f32_16x16x32_bf16 a[12:15], v[60:63], v[104:107], a[12:15]
    buffer_load_dwordx4 v[188:191], v7, s[4:7], s54 offen
    v_mfma_f32_16x16x32_bf16 a[12:15], v[64:67], v[140:143], a[12:15]
    buffer_load_dwordx4 v[192:195], v7, s[4:7], s55 offen
    v_mfma_f32_16x16x32_bf16 a[16:19], v[60:63], v[108:111], a[16:19]
    buffer_load_dwordx4 v[196:199], v7, s[4:7], s56 offen
    v_mfma_f32_16x16x32_bf16 a[16:19], v[64:67], v[144:147], a[16:19]
    v_add_u32 v7, 57344, v7
    v_mfma_f32_16x16x32_bf16 a[20:23], v[60:63], v[112:115], a[20:23]
    buffer_load_dwordx4 v[200:203], v7, s[4:7], s48 offen
    v_mfma_f32_16x16x32_bf16 a[20:23], v[64:67], v[148:151], a[20:23]
    buffer_load_dwordx4 v[204:207], v7, s[4:7], s49 offen
    v_mfma_f32_16x16x32_bf16 a[24:27], v[60:63], v[116:119], a[24:27]
    buffer_load_dwordx4 v[208:211], v7, s[4:7], s50 offen
    v_mfma_f32_16x16x32_bf16 a[24:27], v[64:67], v[152:155], a[24:27]
    buffer_load_dwordx4 v[212:215], v7, s[4:7], s51 offen
    v_mfma_f32_16x16x32_bf16 a[28:31], v[60:63], v[120:123], a[28:31]
    buffer_load_dwordx4 v[216:219], v7, s[4:7], s52 offen
    v_mfma_f32_16x16x32_bf16 a[28:31], v[64:67], v[156:159], a[28:31]
    buffer_load_dwordx4 v[220:223], v7, s[4:7], s53 offen
    v_mfma_f32_16x16x32_bf16 a[32:35], v[60:63], v[124:127], a[32:35]
    buffer_load_dwordx4 v[224:227], v7, s[4:7], s54 offen
    v_mfma_f32_16x16x32_bf16 a[32:35], v[64:67], v[160:163], a[32:35]
    ds_read_b64_tr_b16 v[60:61], v22 offset:0
    ds_read_b64_tr_b16 v[62:63], v22 offset:4096
    ds_read_b64_tr_b16 v[64:65], v22 offset:8192
    ds_read_b64_tr_b16 v[66:67], v22 offset:12288
    s_waitcnt lgkmcnt(12)
    v_mfma_f32_16x16x32_bf16 a[36:39], v[68:71], v[92:95], a[36:39]
    buffer_load_dwordx4 v[228:231], v7, s[4:7], s55 offen
    v_mfma_f32_16x16x32_bf16 a[36:39], v[72:75], v[128:131], a[36:39]
    buffer_load_dwordx4 v[232:235], v7, s[4:7], s56 offen
    v_mfma_f32_16x16x32_bf16 a[40:43], v[68:71], v[96:99], a[40:43]
    v_add_u32 v7, 57344, v7
    v_mfma_f32_16x16x32_bf16 a[40:43], v[72:75], v[132:135], a[40:43]
    v_mfma_f32_16x16x32_bf16 a[44:47], v[68:71], v[100:103], a[44:47]
    v_mfma_f32_16x16x32_bf16 a[44:47], v[72:75], v[136:139], a[44:47]
    v_mfma_f32_16x16x32_bf16 a[48:51], v[68:71], v[104:107], a[48:51]
    v_mfma_f32_16x16x32_bf16 a[48:51], v[72:75], v[140:143], a[48:51]
    v_mfma_f32_16x16x32_bf16 a[52:55], v[68:71], v[108:111], a[52:55]
    v_mfma_f32_16x16x32_bf16 a[52:55], v[72:75], v[144:147], a[52:55]
    v_mfma_f32_16x16x32_bf16 a[56:59], v[68:71], v[112:115], a[56:59]
    v_mfma_f32_16x16x32_bf16 a[56:59], v[72:75], v[148:151], a[56:59]
    v_mfma_f32_16x16x32_bf16 a[60:63], v[68:71], v[116:119], a[60:63]
    v_mfma_f32_16x16x32_bf16 a[60:63], v[72:75], v[152:155], a[60:63]
    v_mfma_f32_16x16x32_bf16 a[64:67], v[68:71], v[120:123], a[64:67]
    v_mfma_f32_16x16x32_bf16 a[64:67], v[72:75], v[156:159], a[64:67]
    v_mfma_f32_16x16x32_bf16 a[68:71], v[68:71], v[124:127], a[68:71]
    v_mfma_f32_16x16x32_bf16 a[68:71], v[72:75], v[160:163], a[68:71]
    ds_read_b64_tr_b16 v[68:69], v23 offset:0
    ds_read_b64_tr_b16 v[70:71], v23 offset:4096
    ds_read_b64_tr_b16 v[72:73], v23 offset:8192
    ds_read_b64_tr_b16 v[74:75], v23 offset:12288
    s_waitcnt lgkmcnt(12)
    v_mfma_f32_16x16x32_bf16 a[72:75], v[76:79], v[92:95], a[72:75]
    v_mfma_f32_16x16x32_bf16 a[72:75], v[80:83], v[128:131], a[72:75]
    v_mfma_f32_16x16x32_bf16 a[76:79], v[76:79], v[96:99], a[76:79]
    v_mfma_f32_16x16x32_bf16 a[76:79], v[80:83], v[132:135], a[76:79]
    v_mfma_f32_16x16x32_bf16 a[80:83], v[76:79], v[100:103], a[80:83]
    v_mfma_f32_16x16x32_bf16 a[80:83], v[80:83], v[136:139], a[80:83]
    v_mfma_f32_16x16x32_bf16 a[84:87], v[76:79], v[104:107], a[84:87]
    v_mfma_f32_16x16x32_bf16 a[84:87], v[80:83], v[140:143], a[84:87]
    v_mfma_f32_16x16x32_bf16 a[88:91], v[76:79], v[108:111], a[88:91]
    v_mfma_f32_16x16x32_bf16 a[88:91], v[80:83], v[144:147], a[88:91]
    v_mfma_f32_16x16x32_bf16 a[92:95], v[76:79], v[112:115], a[92:95]
    v_mfma_f32_16x16x32_bf16 a[92:95], v[80:83], v[148:151], a[92:95]
    v_mfma_f32_16x16x32_bf16 a[96:99], v[76:79], v[116:119], a[96:99]
    v_mfma_f32_16x16x32_bf16 a[96:99], v[80:83], v[152:155], a[96:99]
    v_mfma_f32_16x16x32_bf16 a[100:103], v[76:79], v[120:123], a[100:103]
    v_mfma_f32_16x16x32_bf16 a[100:103], v[80:83], v[156:159], a[100:103]
    v_mfma_f32_16x16x32_bf16 a[104:107], v[76:79], v[124:127], a[104:107]
    v_mfma_f32_16x16x32_bf16 a[104:107], v[80:83], v[160:163], a[104:107]
    ds_read_b64_tr_b16 v[76:77], v24 offset:0
    ds_read_b64_tr_b16 v[78:79], v24 offset:4096
    ds_read_b64_tr_b16 v[80:81], v24 offset:8192
    ds_read_b64_tr_b16 v[82:83], v24 offset:12288
    s_waitcnt lgkmcnt(12)
    v_mfma_f32_16x16x32_bf16 a[108:111], v[84:87], v[92:95], a[108:111]
    v_mfma_f32_16x16x32_bf16 a[108:111], v[88:91], v[128:131], a[108:111]
    v_mfma_f32_16x16x32_bf16 a[112:115], v[84:87], v[96:99], a[112:115]
    v_mfma_f32_16x16x32_bf16 a[112:115], v[88:91], v[132:135], a[112:115]
    v_mfma_f32_16x16x32_bf16 a[116:119], v[84:87], v[100:103], a[116:119]
    v_mfma_f32_16x16x32_bf16 a[116:119], v[88:91], v[136:139], a[116:119]
    v_mfma_f32_16x16x32_bf16 a[120:123], v[84:87], v[104:107], a[120:123]
    v_mfma_f32_16x16x32_bf16 a[120:123], v[88:91], v[140:143], a[120:123]
    v_mfma_f32_16x16x32_bf16 a[124:127], v[84:87], v[108:111], a[124:127]
    v_mfma_f32_16x16x32_bf16 a[124:127], v[88:91], v[144:147], a[124:127]
    v_mfma_f32_16x16x32_bf16 a[128:131], v[84:87], v[112:115], a[128:131]
    v_mfma_f32_16x16x32_bf16 a[128:131], v[88:91], v[148:151], a[128:131]
    v_mfma_f32_16x16x32_bf16 a[132:135], v[84:87], v[116:119], a[132:135]
    v_mfma_f32_16x16x32_bf16 a[132:135], v[88:91], v[152:155], a[132:135]
    v_mfma_f32_16x16x32_bf16 a[136:139], v[84:87], v[120:123], a[136:139]
    v_mfma_f32_16x16x32_bf16 a[136:139], v[88:91], v[156:159], a[136:139]
    v_mfma_f32_16x16x32_bf16 a[140:143], v[84:87], v[124:127], a[140:143]
    v_mfma_f32_16x16x32_bf16 a[140:143], v[88:91], v[160:163], a[140:143]
    ds_read_b64_tr_b16 v[84:85], v25 offset:0
    ds_read_b64_tr_b16 v[86:87], v25 offset:4096
    ds_read_b64_tr_b16 v[88:89], v25 offset:8192
    ds_read_b64_tr_b16 v[90:91], v25 offset:12288
    s_waitcnt lgkmcnt(12)
    v_mfma_f32_16x16x32_bf16 a[144:147], v[60:63], v[92:95], a[144:147]
    v_mfma_f32_16x16x32_bf16 a[144:147], v[64:67], v[128:131], a[144:147]
    v_mfma_f32_16x16x32_bf16 a[148:151], v[60:63], v[96:99], a[148:151]
    v_mfma_f32_16x16x32_bf16 a[148:151], v[64:67], v[132:135], a[148:151]
    v_mfma_f32_16x16x32_bf16 a[152:155], v[60:63], v[100:103], a[152:155]
    v_mfma_f32_16x16x32_bf16 a[152:155], v[64:67], v[136:139], a[152:155]
    v_mfma_f32_16x16x32_bf16 a[156:159], v[60:63], v[104:107], a[156:159]
    v_mfma_f32_16x16x32_bf16 a[156:159], v[64:67], v[140:143], a[156:159]
    v_mfma_f32_16x16x32_bf16 a[160:163], v[60:63], v[108:111], a[160:163]
    v_mfma_f32_16x16x32_bf16 a[160:163], v[64:67], v[144:147], a[160:163]
    v_mfma_f32_16x16x32_bf16 a[164:167], v[60:63], v[112:115], a[164:167]
    v_mfma_f32_16x16x32_bf16 a[164:167], v[64:67], v[148:151], a[164:167]
    v_mfma_f32_16x16x32_bf16 a[168:171], v[60:63], v[116:119], a[168:171]
    v_mfma_f32_16x16x32_bf16 a[168:171], v[64:67], v[152:155], a[168:171]
    v_mfma_f32_16x16x32_bf16 v[36:39], v[60:63], v[120:123], v[36:39]
    v_mfma_f32_16x16x32_bf16 v[36:39], v[64:67], v[156:159], v[36:39]
    v_mfma_f32_16x16x32_bf16 v[52:55], v[60:63], v[124:127], v[52:55]
    v_mfma_f32_16x16x32_bf16 v[52:55], v[64:67], v[160:163], v[52:55]
    s_waitcnt vmcnt(18)
    ds_read_b64_tr_b16 v[60:61], v18 offset:16384
    ds_read_b64_tr_b16 v[62:63], v18 offset:20480
    ds_read_b64_tr_b16 v[64:65], v18 offset:24576
    ds_read_b64_tr_b16 v[66:67], v18 offset:28672
    s_waitcnt lgkmcnt(4)
    v_mfma_f32_16x16x32_bf16 a[172:175], v[68:71], v[92:95], a[172:175]
    s_add_u32 m0, s27, 0
    v_mfma_f32_16x16x32_bf16 a[172:175], v[72:75], v[128:131], a[172:175]
    s_nop 0
    v_mfma_f32_16x16x32_bf16 a[176:179], v[68:71], v[96:99], a[176:179]
    buffer_load_dwordx4 v10, s[8:11], s26 offen offset:0 lds
    v_mfma_f32_16x16x32_bf16 a[176:179], v[72:75], v[132:135], a[176:179]
    buffer_load_dwordx4 v11, s[8:11], s26 offen offset:1024 lds
    v_mfma_f32_16x16x32_bf16 a[180:183], v[68:71], v[100:103], a[180:183]
    buffer_load_dwordx4 v12, s[8:11], s26 offen offset:2048 lds
    v_mfma_f32_16x16x32_bf16 a[180:183], v[72:75], v[136:139], a[180:183]
    buffer_load_dwordx4 v13, s[8:11], s26 offen offset:3072 lds
    v_mfma_f32_16x16x32_bf16 a[184:187], v[68:71], v[104:107], a[184:187]
    s_add_u32 m0, s27, 4096
    v_mfma_f32_16x16x32_bf16 a[184:187], v[72:75], v[140:143], a[184:187]
    s_nop 0
    v_mfma_f32_16x16x32_bf16 a[188:191], v[68:71], v[108:111], a[188:191]
    buffer_load_dwordx4 v14, s[8:11], s26 offen offset:0 lds
    v_mfma_f32_16x16x32_bf16 a[188:191], v[72:75], v[144:147], a[188:191]
    buffer_load_dwordx4 v15, s[8:11], s26 offen offset:1024 lds
    v_mfma_f32_16x16x32_bf16 a[192:195], v[68:71], v[112:115], a[192:195]
    buffer_load_dwordx4 v16, s[8:11], s26 offen offset:2048 lds
    v_mfma_f32_16x16x32_bf16 a[192:195], v[72:75], v[148:151], a[192:195]
    buffer_load_dwordx4 v17, s[8:11], s26 offen offset:3072 lds
    v_mfma_f32_16x16x32_bf16 a[196:199], v[68:71], v[116:119], a[196:199]
    s_add_u32 s26, s26, 163840
    v_mfma_f32_16x16x32_bf16 a[196:199], v[72:75], v[152:155], a[196:199]
    s_add_u32 m0, s27, 8192
    v_mfma_f32_16x16x32_bf16 v[40:43], v[68:71], v[120:123], v[40:43]
    s_nop 0
    v_mfma_f32_16x16x32_bf16 v[40:43], v[72:75], v[156:159], v[40:43]
    buffer_load_dwordx4 v10, s[8:11], s26 offen offset:0 lds
    v_mfma_f32_16x16x32_bf16 v[56:59], v[68:71], v[124:127], v[56:59]
    buffer_load_dwordx4 v11, s[8:11], s26 offen offset:1024 lds
    v_mfma_f32_16x16x32_bf16 v[56:59], v[72:75], v[160:163], v[56:59]
    ds_read_b64_tr_b16 v[68:69], v19 offset:16384
    ds_read_b64_tr_b16 v[70:71], v19 offset:20480
    ds_read_b64_tr_b16 v[72:73], v19 offset:24576
    ds_read_b64_tr_b16 v[74:75], v19 offset:28672
    s_waitcnt lgkmcnt(12)
    v_mfma_f32_16x16x32_bf16 a[200:203], v[76:79], v[92:95], a[200:203]
    buffer_load_dwordx4 v12, s[8:11], s26 offen offset:2048 lds
    v_mfma_f32_16x16x32_bf16 a[200:203], v[80:83], v[128:131], a[200:203]
    buffer_load_dwordx4 v13, s[8:11], s26 offen offset:3072 lds
    v_mfma_f32_16x16x32_bf16 a[204:207], v[76:79], v[96:99], a[204:207]
    s_add_u32 m0, s27, 12288
    v_mfma_f32_16x16x32_bf16 a[204:207], v[80:83], v[132:135], a[204:207]
    s_nop 0
    v_mfma_f32_16x16x32_bf16 a[208:211], v[76:79], v[100:103], a[208:211]
    buffer_load_dwordx4 v14, s[8:11], s26 offen offset:0 lds
    v_mfma_f32_16x16x32_bf16 a[208:211], v[80:83], v[136:139], a[208:211]
    buffer_load_dwordx4 v15, s[8:11], s26 offen offset:1024 lds
    v_mfma_f32_16x16x32_bf16 a[212:215], v[76:79], v[104:107], a[212:215]
    buffer_load_dwordx4 v16, s[8:11], s26 offen offset:2048 lds
    v_mfma_f32_16x16x32_bf16 a[212:215], v[80:83], v[140:143], a[212:215]
    buffer_load_dwordx4 v17, s[8:11], s26 offen offset:3072 lds
    v_mfma_f32_16x16x32_bf16 v[244:247], v[76:79], v[108:111], v[244:247]
    s_add_u32 s26, s26, 163840
    v_mfma_f32_16x16x32_bf16 v[244:247], v[80:83], v[144:147], v[244:247]
    v_mfma_f32_16x16x32_bf16 a[216:219], v[76:79], v[112:115], a[216:219]
    v_mfma_f32_16x16x32_bf16 a[216:219], v[80:83], v[148:151], a[216:219]
    v_mfma_f32_16x16x32_bf16 v[28:31], v[76:79], v[116:119], v[28:31]
    v_mfma_f32_16x16x32_bf16 v[28:31], v[80:83], v[152:155], v[28:31]
    v_mfma_f32_16x16x32_bf16 v[44:47], v[76:79], v[120:123], v[44:47]
    v_mfma_f32_16x16x32_bf16 v[44:47], v[80:83], v[156:159], v[44:47]
    v_mfma_f32_16x16x32_bf16 v[236:239], v[76:79], v[124:127], v[236:239]
    v_mfma_f32_16x16x32_bf16 v[236:239], v[80:83], v[160:163], v[236:239]
    ds_read_b64_tr_b16 v[76:77], v20 offset:16384
    ds_read_b64_tr_b16 v[78:79], v20 offset:20480
    ds_read_b64_tr_b16 v[80:81], v20 offset:24576
    ds_read_b64_tr_b16 v[82:83], v20 offset:28672
    s_waitcnt lgkmcnt(12)
    v_mfma_f32_16x16x32_bf16 a[220:223], v[84:87], v[92:95], a[220:223]
    v_mfma_f32_16x16x32_bf16 a[220:223], v[88:91], v[128:131], a[220:223]
    v_mfma_f32_16x16x32_bf16 a[224:227], v[84:87], v[96:99], a[224:227]
    v_mfma_f32_16x16x32_bf16 a[224:227], v[88:91], v[132:135], a[224:227]
    v_mfma_f32_16x16x32_bf16 a[228:231], v[84:87], v[100:103], a[228:231]
    v_mfma_f32_16x16x32_bf16 a[228:231], v[88:91], v[136:139], a[228:231]
    v_mfma_f32_16x16x32_bf16 a[232:235], v[84:87], v[104:107], a[232:235]
    v_mfma_f32_16x16x32_bf16 a[232:235], v[88:91], v[140:143], a[232:235]
    v_mfma_f32_16x16x32_bf16 v[248:251], v[84:87], v[108:111], v[248:251]
    v_mfma_f32_16x16x32_bf16 v[248:251], v[88:91], v[144:147], v[248:251]
    v_mfma_f32_16x16x32_bf16 a[236:239], v[84:87], v[112:115], a[236:239]
    v_mfma_f32_16x16x32_bf16 a[236:239], v[88:91], v[148:151], a[236:239]
    v_mfma_f32_16x16x32_bf16 v[32:35], v[84:87], v[116:119], v[32:35]
    v_mfma_f32_16x16x32_bf16 v[32:35], v[88:91], v[152:155], v[32:35]
    v_mfma_f32_16x16x32_bf16 v[48:51], v[84:87], v[120:123], v[48:51]
    v_mfma_f32_16x16x32_bf16 v[48:51], v[88:91], v[156:159], v[48:51]
    v_mfma_f32_16x16x32_bf16 v[240:243], v[84:87], v[124:127], v[240:243]
    v_mfma_f32_16x16x32_bf16 v[240:243], v[88:91], v[160:163], v[240:243]
    ds_read_b64_tr_b16 v[84:85], v21 offset:16384
    ds_read_b64_tr_b16 v[86:87], v21 offset:20480
    ds_read_b64_tr_b16 v[88:89], v21 offset:24576
    ds_read_b64_tr_b16 v[90:91], v21 offset:28672
    s_waitcnt vmcnt(16) lgkmcnt(12)
    v_mfma_f32_16x16x32_bf16 a[0:3], v[60:63], v[164:167], a[0:3]
    buffer_load_dwordx4 v[92:95], v7, s[4:7], s48 offen
    v_mfma_f32_16x16x32_bf16 a[0:3], v[64:67], v[200:203], a[0:3]
    buffer_load_dwordx4 v[96:99], v7, s[4:7], s49 offen
    v_mfma_f32_16x16x32_bf16 a[4:7], v[60:63], v[168:171], a[4:7]
    buffer_load_dwordx4 v[100:103], v7, s[4:7], s50 offen
    v_mfma_f32_16x16x32_bf16 a[4:7], v[64:67], v[204:207], a[4:7]
    buffer_load_dwordx4 v[104:107], v7, s[4:7], s51 offen
    v_mfma_f32_16x16x32_bf16 a[8:11], v[60:63], v[172:175], a[8:11]
    buffer_load_dwordx4 v[108:111], v7, s[4:7], s52 offen
    v_mfma_f32_16x16x32_bf16 a[8:11], v[64:67], v[208:211], a[8:11]
    buffer_load_dwordx4 v[112:115], v7, s[4:7], s53 offen
    v_mfma_f32_16x16x32_bf16 a[12:15], v[60:63], v[176:179], a[12:15]
    buffer_load_dwordx4 v[116:119], v7, s[4:7], s54 offen
    v_mfma_f32_16x16x32_bf16 a[12:15], v[64:67], v[212:215], a[12:15]
    buffer_load_dwordx4 v[120:123], v7, s[4:7], s55 offen
    v_mfma_f32_16x16x32_bf16 a[16:19], v[60:63], v[180:183], a[16:19]
    buffer_load_dwordx4 v[124:127], v7, s[4:7], s56 offen
    v_mfma_f32_16x16x32_bf16 a[16:19], v[64:67], v[216:219], a[16:19]
    v_add_u32 v7, 57344, v7
    v_mfma_f32_16x16x32_bf16 a[20:23], v[60:63], v[184:187], a[20:23]
    buffer_load_dwordx4 v[128:131], v7, s[4:7], s48 offen
    v_mfma_f32_16x16x32_bf16 a[20:23], v[64:67], v[220:223], a[20:23]
    buffer_load_dwordx4 v[132:135], v7, s[4:7], s49 offen
    v_mfma_f32_16x16x32_bf16 a[24:27], v[60:63], v[188:191], a[24:27]
    buffer_load_dwordx4 v[136:139], v7, s[4:7], s50 offen
    v_mfma_f32_16x16x32_bf16 a[24:27], v[64:67], v[224:227], a[24:27]
    buffer_load_dwordx4 v[140:143], v7, s[4:7], s51 offen
    v_mfma_f32_16x16x32_bf16 a[28:31], v[60:63], v[192:195], a[28:31]
    buffer_load_dwordx4 v[144:147], v7, s[4:7], s52 offen
    v_mfma_f32_16x16x32_bf16 a[28:31], v[64:67], v[228:231], a[28:31]
    buffer_load_dwordx4 v[148:151], v7, s[4:7], s53 offen
    v_mfma_f32_16x16x32_bf16 a[32:35], v[60:63], v[196:199], a[32:35]
    buffer_load_dwordx4 v[152:155], v7, s[4:7], s54 offen
    v_mfma_f32_16x16x32_bf16 a[32:35], v[64:67], v[232:235], a[32:35]
    ds_read_b64_tr_b16 v[60:61], v22 offset:16384
    ds_read_b64_tr_b16 v[62:63], v22 offset:20480
    ds_read_b64_tr_b16 v[64:65], v22 offset:24576
    ds_read_b64_tr_b16 v[66:67], v22 offset:28672
    s_waitcnt lgkmcnt(12)
    v_mfma_f32_16x16x32_bf16 a[36:39], v[68:71], v[164:167], a[36:39]
    buffer_load_dwordx4 v[156:159], v7, s[4:7], s55 offen
    v_mfma_f32_16x16x32_bf16 a[36:39], v[72:75], v[200:203], a[36:39]
    buffer_load_dwordx4 v[160:163], v7, s[4:7], s56 offen
    v_mfma_f32_16x16x32_bf16 a[40:43], v[68:71], v[168:171], a[40:43]
    v_add_u32 v7, 57344, v7
    v_mfma_f32_16x16x32_bf16 a[40:43], v[72:75], v[204:207], a[40:43]
    v_mfma_f32_16x16x32_bf16 a[44:47], v[68:71], v[172:175], a[44:47]
    v_mfma_f32_16x16x32_bf16 a[44:47], v[72:75], v[208:211], a[44:47]
    v_mfma_f32_16x16x32_bf16 a[48:51], v[68:71], v[176:179], a[48:51]
    v_mfma_f32_16x16x32_bf16 a[48:51], v[72:75], v[212:215], a[48:51]
    v_mfma_f32_16x16x32_bf16 a[52:55], v[68:71], v[180:183], a[52:55]
    v_mfma_f32_16x16x32_bf16 a[52:55], v[72:75], v[216:219], a[52:55]
    v_mfma_f32_16x16x32_bf16 a[56:59], v[68:71], v[184:187], a[56:59]
    v_mfma_f32_16x16x32_bf16 a[56:59], v[72:75], v[220:223], a[56:59]
    v_mfma_f32_16x16x32_bf16 a[60:63], v[68:71], v[188:191], a[60:63]
    v_mfma_f32_16x16x32_bf16 a[60:63], v[72:75], v[224:227], a[60:63]
    v_mfma_f32_16x16x32_bf16 a[64:67], v[68:71], v[192:195], a[64:67]
    v_mfma_f32_16x16x32_bf16 a[64:67], v[72:75], v[228:231], a[64:67]
    v_mfma_f32_16x16x32_bf16 a[68:71], v[68:71], v[196:199], a[68:71]
    v_mfma_f32_16x16x32_bf16 a[68:71], v[72:75], v[232:235], a[68:71]
    ds_read_b64_tr_b16 v[68:69], v23 offset:16384
    ds_read_b64_tr_b16 v[70:71], v23 offset:20480
    ds_read_b64_tr_b16 v[72:73], v23 offset:24576
    ds_read_b64_tr_b16 v[74:75], v23 offset:28672
    s_waitcnt lgkmcnt(12)
    v_mfma_f32_16x16x32_bf16 a[72:75], v[76:79], v[164:167], a[72:75]
    v_mfma_f32_16x16x32_bf16 a[72:75], v[80:83], v[200:203], a[72:75]
    v_mfma_f32_16x16x32_bf16 a[76:79], v[76:79], v[168:171], a[76:79]
    v_mfma_f32_16x16x32_bf16 a[76:79], v[80:83], v[204:207], a[76:79]
    v_mfma_f32_16x16x32_bf16 a[80:83], v[76:79], v[172:175], a[80:83]
    v_mfma_f32_16x16x32_bf16 a[80:83], v[80:83], v[208:211], a[80:83]
    v_mfma_f32_16x16x32_bf16 a[84:87], v[76:79], v[176:179], a[84:87]
    v_mfma_f32_16x16x32_bf16 a[84:87], v[80:83], v[212:215], a[84:87]
    v_mfma_f32_16x16x32_bf16 a[88:91], v[76:79], v[180:183], a[88:91]
    v_mfma_f32_16x16x32_bf16 a[88:91], v[80:83], v[216:219], a[88:91]
    v_mfma_f32_16x16x32_bf16 a[92:95], v[76:79], v[184:187], a[92:95]
    v_mfma_f32_16x16x32_bf16 a[92:95], v[80:83], v[220:223], a[92:95]
    v_mfma_f32_16x16x32_bf16 a[96:99], v[76:79], v[188:191], a[96:99]
    v_mfma_f32_16x16x32_bf16 a[96:99], v[80:83], v[224:227], a[96:99]
    v_mfma_f32_16x16x32_bf16 a[100:103], v[76:79], v[192:195], a[100:103]
    v_mfma_f32_16x16x32_bf16 a[100:103], v[80:83], v[228:231], a[100:103]
    v_mfma_f32_16x16x32_bf16 a[104:107], v[76:79], v[196:199], a[104:107]
    v_mfma_f32_16x16x32_bf16 a[104:107], v[80:83], v[232:235], a[104:107]
    ds_read_b64_tr_b16 v[76:77], v24 offset:16384
    ds_read_b64_tr_b16 v[78:79], v24 offset:20480
    ds_read_b64_tr_b16 v[80:81], v24 offset:24576
    ds_read_b64_tr_b16 v[82:83], v24 offset:28672
    s_waitcnt lgkmcnt(12)
    v_mfma_f32_16x16x32_bf16 a[108:111], v[84:87], v[164:167], a[108:111]
    v_mfma_f32_16x16x32_bf16 a[108:111], v[88:91], v[200:203], a[108:111]
    v_mfma_f32_16x16x32_bf16 a[112:115], v[84:87], v[168:171], a[112:115]
    v_mfma_f32_16x16x32_bf16 a[112:115], v[88:91], v[204:207], a[112:115]
    v_mfma_f32_16x16x32_bf16 a[116:119], v[84:87], v[172:175], a[116:119]
    v_mfma_f32_16x16x32_bf16 a[116:119], v[88:91], v[208:211], a[116:119]
    v_mfma_f32_16x16x32_bf16 a[120:123], v[84:87], v[176:179], a[120:123]
    v_mfma_f32_16x16x32_bf16 a[120:123], v[88:91], v[212:215], a[120:123]
    v_mfma_f32_16x16x32_bf16 a[124:127], v[84:87], v[180:183], a[124:127]
    v_mfma_f32_16x16x32_bf16 a[124:127], v[88:91], v[216:219], a[124:127]
    v_mfma_f32_16x16x32_bf16 a[128:131], v[84:87], v[184:187], a[128:131]
    v_mfma_f32_16x16x32_bf16 a[128:131], v[88:91], v[220:223], a[128:131]
    v_mfma_f32_16x16x32_bf16 a[132:135], v[84:87], v[188:191], a[132:135]
    v_mfma_f32_16x16x32_bf16 a[132:135], v[88:91], v[224:227], a[132:135]
    v_mfma_f32_16x16x32_bf16 a[136:139], v[84:87], v[192:195], a[136:139]
    v_mfma_f32_16x16x32_bf16 a[136:139], v[88:91], v[228:231], a[136:139]
    v_mfma_f32_16x16x32_bf16 a[140:143], v[84:87], v[196:199], a[140:143]
    v_mfma_f32_16x16x32_bf16 a[140:143], v[88:91], v[232:235], a[140:143]
    ds_read_b64_tr_b16 v[84:85], v25 offset:16384
    ds_read_b64_tr_b16 v[86:87], v25 offset:20480
    ds_read_b64_tr_b16 v[88:89], v25 offset:24576
    ds_read_b64_tr_b16 v[90:91], v25 offset:28672
    s_waitcnt lgkmcnt(12)
    v_mfma_f32_16x16x32_bf16 a[144:147], v[60:63], v[164:167], a[144:147]
    v_mfma_f32_16x16x32_bf16 a[144:147], v[64:67], v[200:203], a[144:147]
    v_mfma_f32_16x16x32_bf16 a[148:151], v[60:63], v[168:171], a[148:151]
    v_mfma_f32_16x16x32_bf16 a[148:151], v[64:67], v[204:207], a[148:151]
    v_mfma_f32_16x16x32_bf16 a[152:155], v[60:63], v[172:175], a[152:155]
    v_mfma_f32_16x16x32_bf16 a[152:155], v[64:67], v[208:211], a[152:155]
    v_mfma_f32_16x16x32_bf16 a[156:159], v[60:63], v[176:179], a[156:159]
    v_mfma_f32_16x16x32_bf16 a[156:159], v[64:67], v[212:215], a[156:159]
    v_mfma_f32_16x16x32_bf16 a[160:163], v[60:63], v[180:183], a[160:163]
    v_mfma_f32_16x16x32_bf16 a[160:163], v[64:67], v[216:219], a[160:163]
    v_mfma_f32_16x16x32_bf16 a[164:167], v[60:63], v[184:187], a[164:167]
    v_mfma_f32_16x16x32_bf16 a[164:167], v[64:67], v[220:223], a[164:167]
    v_mfma_f32_16x16x32_bf16 a[168:171], v[60:63], v[188:191], a[168:171]
    v_mfma_f32_16x16x32_bf16 a[168:171], v[64:67], v[224:227], a[168:171]
    v_mfma_f32_16x16x32_bf16 v[36:39], v[60:63], v[192:195], v[36:39]
    v_mfma_f32_16x16x32_bf16 v[36:39], v[64:67], v[228:231], v[36:39]
    v_mfma_f32_16x16x32_bf16 v[52:55], v[60:63], v[196:199], v[52:55]
    v_mfma_f32_16x16x32_bf16 v[52:55], v[64:67], v[232:235], v[52:55]
    s_waitcnt vmcnt(18)
    ds_read_b64_tr_b16 v[60:61], v18 offset:0
    ds_read_b64_tr_b16 v[62:63], v18 offset:4096
    ds_read_b64_tr_b16 v[64:65], v18 offset:8192
    ds_read_b64_tr_b16 v[66:67], v18 offset:12288
    s_waitcnt lgkmcnt(4)
    v_mfma_f32_16x16x32_bf16 a[172:175], v[68:71], v[164:167], a[172:175]
    s_add_u32 m0, s27, 16384
    v_mfma_f32_16x16x32_bf16 a[172:175], v[72:75], v[200:203], a[172:175]
    s_nop 0
    v_mfma_f32_16x16x32_bf16 a[176:179], v[68:71], v[168:171], a[176:179]
    buffer_load_dwordx4 v10, s[8:11], s26 offen offset:0 lds
    v_mfma_f32_16x16x32_bf16 a[176:179], v[72:75], v[204:207], a[176:179]
    buffer_load_dwordx4 v11, s[8:11], s26 offen offset:1024 lds
    v_mfma_f32_16x16x32_bf16 a[180:183], v[68:71], v[172:175], a[180:183]
    buffer_load_dwordx4 v12, s[8:11], s26 offen offset:2048 lds
    v_mfma_f32_16x16x32_bf16 a[180:183], v[72:75], v[208:211], a[180:183]
    buffer_load_dwordx4 v13, s[8:11], s26 offen offset:3072 lds
    v_mfma_f32_16x16x32_bf16 a[184:187], v[68:71], v[176:179], a[184:187]
    s_add_u32 m0, s27, 20480
    v_mfma_f32_16x16x32_bf16 a[184:187], v[72:75], v[212:215], a[184:187]
    s_nop 0
    v_mfma_f32_16x16x32_bf16 a[188:191], v[68:71], v[180:183], a[188:191]
    buffer_load_dwordx4 v14, s[8:11], s26 offen offset:0 lds
    v_mfma_f32_16x16x32_bf16 a[188:191], v[72:75], v[216:219], a[188:191]
    buffer_load_dwordx4 v15, s[8:11], s26 offen offset:1024 lds
    v_mfma_f32_16x16x32_bf16 a[192:195], v[68:71], v[184:187], a[192:195]
    buffer_load_dwordx4 v16, s[8:11], s26 offen offset:2048 lds
    v_mfma_f32_16x16x32_bf16 a[192:195], v[72:75], v[220:223], a[192:195]
    buffer_load_dwordx4 v17, s[8:11], s26 offen offset:3072 lds
    v_mfma_f32_16x16x32_bf16 a[196:199], v[68:71], v[188:191], a[196:199]
    s_add_u32 s26, s26, 163840
    v_mfma_f32_16x16x32_bf16 a[196:199], v[72:75], v[224:227], a[196:199]
    s_add_u32 m0, s27, 24576
    v_mfma_f32_16x16x32_bf16 v[40:43], v[68:71], v[192:195], v[40:43]
    s_nop 0
    v_mfma_f32_16x16x32_bf16 v[40:43], v[72:75], v[228:231], v[40:43]
    buffer_load_dwordx4 v10, s[8:11], s26 offen offset:0 lds
    v_mfma_f32_16x16x32_bf16 v[56:59], v[68:71], v[196:199], v[56:59]
    buffer_load_dwordx4 v11, s[8:11], s26 offen offset:1024 lds
    v_mfma_f32_16x16x32_bf16 v[56:59], v[72:75], v[232:235], v[56:59]
    ds_read_b64_tr_b16 v[68:69], v19 offset:0
    ds_read_b64_tr_b16 v[70:71], v19 offset:4096
    ds_read_b64_tr_b16 v[72:73], v19 offset:8192
    ds_read_b64_tr_b16 v[74:75], v19 offset:12288
    s_waitcnt lgkmcnt(12)
    v_mfma_f32_16x16x32_bf16 a[200:203], v[76:79], v[164:167], a[200:203]
    buffer_load_dwordx4 v12, s[8:11], s26 offen offset:2048 lds
    v_mfma_f32_16x16x32_bf16 a[200:203], v[80:83], v[200:203], a[200:203]
    buffer_load_dwordx4 v13, s[8:11], s26 offen offset:3072 lds
    v_mfma_f32_16x16x32_bf16 a[204:207], v[76:79], v[168:171], a[204:207]
    s_add_u32 m0, s27, 28672
    v_mfma_f32_16x16x32_bf16 a[204:207], v[80:83], v[204:207], a[204:207]
    s_nop 0
    v_mfma_f32_16x16x32_bf16 a[208:211], v[76:79], v[172:175], a[208:211]
    buffer_load_dwordx4 v14, s[8:11], s26 offen offset:0 lds
    v_mfma_f32_16x16x32_bf16 a[208:211], v[80:83], v[208:211], a[208:211]
    buffer_load_dwordx4 v15, s[8:11], s26 offen offset:1024 lds
    v_mfma_f32_16x16x32_bf16 a[212:215], v[76:79], v[176:179], a[212:215]
    buffer_load_dwordx4 v16, s[8:11], s26 offen offset:2048 lds
    v_mfma_f32_16x16x32_bf16 a[212:215], v[80:83], v[212:215], a[212:215]
    buffer_load_dwordx4 v17, s[8:11], s26 offen offset:3072 lds
    v_mfma_f32_16x16x32_bf16 v[244:247], v[76:79], v[180:183], v[244:247]
    s_add_u32 s26, s26, 163840
    v_mfma_f32_16x16x32_bf16 v[244:247], v[80:83], v[216:219], v[244:247]
    v_mfma_f32_16x16x32_bf16 a[216:219], v[76:79], v[184:187], a[216:219]
    v_mfma_f32_16x16x32_bf16 a[216:219], v[80:83], v[220:223], a[216:219]
    v_mfma_f32_16x16x32_bf16 v[28:31], v[76:79], v[188:191], v[28:31]
    v_mfma_f32_16x16x32_bf16 v[28:31], v[80:83], v[224:227], v[28:31]
    v_mfma_f32_16x16x32_bf16 v[44:47], v[76:79], v[192:195], v[44:47]
    v_mfma_f32_16x16x32_bf16 v[44:47], v[80:83], v[228:231], v[44:47]
    v_mfma_f32_16x16x32_bf16 v[236:239], v[76:79], v[196:199], v[236:239]
    v_mfma_f32_16x16x32_bf16 v[236:239], v[80:83], v[232:235], v[236:239]
    ds_read_b64_tr_b16 v[76:77], v20 offset:0
    ds_read_b64_tr_b16 v[78:79], v20 offset:4096
    ds_read_b64_tr_b16 v[80:81], v20 offset:8192
    ds_read_b64_tr_b16 v[82:83], v20 offset:12288
    s_waitcnt lgkmcnt(12)
    v_mfma_f32_16x16x32_bf16 a[220:223], v[84:87], v[164:167], a[220:223]
    v_mfma_f32_16x16x32_bf16 a[220:223], v[88:91], v[200:203], a[220:223]
    v_mfma_f32_16x16x32_bf16 a[224:227], v[84:87], v[168:171], a[224:227]
    v_mfma_f32_16x16x32_bf16 a[224:227], v[88:91], v[204:207], a[224:227]
    v_mfma_f32_16x16x32_bf16 a[228:231], v[84:87], v[172:175], a[228:231]
    v_mfma_f32_16x16x32_bf16 a[228:231], v[88:91], v[208:211], a[228:231]
    v_mfma_f32_16x16x32_bf16 a[232:235], v[84:87], v[176:179], a[232:235]
    v_mfma_f32_16x16x32_bf16 a[232:235], v[88:91], v[212:215], a[232:235]
    v_mfma_f32_16x16x32_bf16 v[248:251], v[84:87], v[180:183], v[248:251]
    v_mfma_f32_16x16x32_bf16 v[248:251], v[88:91], v[216:219], v[248:251]
    v_mfma_f32_16x16x32_bf16 a[236:239], v[84:87], v[184:187], a[236:239]
    v_mfma_f32_16x16x32_bf16 a[236:239], v[88:91], v[220:223], a[236:239]
    v_mfma_f32_16x16x32_bf16 v[32:35], v[84:87], v[188:191], v[32:35]
    v_mfma_f32_16x16x32_bf16 v[32:35], v[88:91], v[224:227], v[32:35]
    v_mfma_f32_16x16x32_bf16 v[48:51], v[84:87], v[192:195], v[48:51]
    v_mfma_f32_16x16x32_bf16 v[48:51], v[88:91], v[228:231], v[48:51]
    v_mfma_f32_16x16x32_bf16 v[240:243], v[84:87], v[196:199], v[240:243]
    v_mfma_f32_16x16x32_bf16 v[240:243], v[88:91], v[232:235], v[240:243]
    ds_read_b64_tr_b16 v[84:85], v21 offset:0
    ds_read_b64_tr_b16 v[86:87], v21 offset:4096
    ds_read_b64_tr_b16 v[88:89], v21 offset:8192
    ds_read_b64_tr_b16 v[90:91], v21 offset:12288
    s_add_u32 s21, s21, 1
    s_cmp_lt_u32 s21, 6
    s_cbranch_scc1 L_op_loop
    s_waitcnt vmcnt(16) lgkmcnt(12)
    v_mfma_f32_16x16x32_bf16 a[0:3], v[60:63], v[92:95], a[0:3]
    buffer_load_dwordx4 v[164:167], v7, s[4:7], s48 offen
    v_mfma_f32_16x16x32_bf16 a[0:3], v[64:67], v[128:131], a[0:3]
    buffer_load_dwordx4 v[168:171], v7, s[4:7], s49 offen
    v_mfma_f32_16x16x32_bf16 a[4:7], v[60:63], v[96:99], a[4:7]
    buffer_load_dwordx4 v[172:175], v7, s[4:7], s50 offen
    v_mfma_f32_16x16x32_bf16 a[4:7], v[64:67], v[132:135], a[4:7]
    buffer_load_dwordx4 v[176:179], v7, s[4:7], s51 offen
    v_mfma_f32_16x16x32_bf16 a[8:11], v[60:63], v[100:103], a[8:11]
    buffer_load_dwordx4 v[180:183], v7, s[4:7], s52 offen
    v_mfma_f32_16x16x32_bf16 a[8:11], v[64:67], v[136:139], a[8:11]
    buffer_load_dwordx4 v[184:187], v7, s[4:7], s53 offen
    v_mfma_f32_16x16x32_bf16 a[12:15], v[60:63], v[104:107], a[12:15]
    buffer_load_dwordx4 v[188:191], v7, s[4:7], s54 offen
    v_mfma_f32_16x16x32_bf16 a[12:15], v[64:67], v[140:143], a[12:15]
    buffer_load_dwordx4 v[192:195], v7, s[4:7], s55 offen
    v_mfma_f32_16x16x32_bf16 a[16:19], v[60:63], v[108:111], a[16:19]
    buffer_load_dwordx4 v[196:199], v7, s[4:7], s56 offen
    v_mfma_f32_16x16x32_bf16 a[16:19], v[64:67], v[144:147], a[16:19]
    v_add_u32 v7, 57344, v7
    v_mfma_f32_16x16x32_bf16 a[20:23], v[60:63], v[112:115], a[20:23]
    buffer_load_dwordx4 v[200:203], v7, s[4:7], s48 offen
    v_mfma_f32_16x16x32_bf16 a[20:23], v[64:67], v[148:151], a[20:23]
    buffer_load_dwordx4 v[204:207], v7, s[4:7], s49 offen
    v_mfma_f32_16x16x32_bf16 a[24:27], v[60:63], v[116:119], a[24:27]
    buffer_load_dwordx4 v[208:211], v7, s[4:7], s50 offen
    v_mfma_f32_16x16x32_bf16 a[24:27], v[64:67], v[152:155], a[24:27]
    buffer_load_dwordx4 v[212:215], v7, s[4:7], s51 offen
    v_mfma_f32_16x16x32_bf16 a[28:31], v[60:63], v[120:123], a[28:31]
    buffer_load_dwordx4 v[216:219], v7, s[4:7], s52 offen
    v_mfma_f32_16x16x32_bf16 a[28:31], v[64:67], v[156:159], a[28:31]
    buffer_load_dwordx4 v[220:223], v7, s[4:7], s53 offen
    v_mfma_f32_16x16x32_bf16 a[32:35], v[60:63], v[124:127], a[32:35]
    buffer_load_dwordx4 v[224:227], v7, s[4:7], s54 offen
    v_mfma_f32_16x16x32_bf16 a[32:35], v[64:67], v[160:163], a[32:35]
    ds_read_b64_tr_b16 v[60:61], v22 offset:0
    ds_read_b64_tr_b16 v[62:63], v22 offset:4096
    ds_read_b64_tr_b16 v[64:65], v22 offset:8192
    ds_read_b64_tr_b16 v[66:67], v22 offset:12288
    s_waitcnt lgkmcnt(12)
    v_mfma_f32_16x16x32_bf16 a[36:39], v[68:71], v[92:95], a[36:39]
    buffer_load_dwordx4 v[228:231], v7, s[4:7], s55 offen
    v_mfma_f32_16x16x32_bf16 a[36:39], v[72:75], v[128:131], a[36:39]
    buffer_load_dwordx4 v[232:235], v7, s[4:7], s56 offen
    v_mfma_f32_16x16x32_bf16 a[40:43], v[68:71], v[96:99], a[40:43]
    v_add_u32 v7, 57344, v7
    v_mfma_f32_16x16x32_bf16 a[40:43], v[72:75], v[132:135], a[40:43]
    v_mfma_f32_16x16x32_bf16 a[44:47], v[68:71], v[100:103], a[44:47]
    v_mfma_f32_16x16x32_bf16 a[44:47], v[72:75], v[136:139], a[44:47]
    v_mfma_f32_16x16x32_bf16 a[48:51], v[68:71], v[104:107], a[48:51]
    v_mfma_f32_16x16x32_bf16 a[48:51], v[72:75], v[140:143], a[48:51]
    v_mfma_f32_16x16x32_bf16 a[52:55], v[68:71], v[108:111], a[52:55]
    v_mfma_f32_16x16x32_bf16 a[52:55], v[72:75], v[144:147], a[52:55]
    v_mfma_f32_16x16x32_bf16 a[56:59], v[68:71], v[112:115], a[56:59]
    v_mfma_f32_16x16x32_bf16 a[56:59], v[72:75], v[148:151], a[56:59]
    v_mfma_f32_16x16x32_bf16 a[60:63], v[68:71], v[116:119], a[60:63]
    v_mfma_f32_16x16x32_bf16 a[60:63], v[72:75], v[152:155], a[60:63]
    v_mfma_f32_16x16x32_bf16 a[64:67], v[68:71], v[120:123], a[64:67]
    v_mfma_f32_16x16x32_bf16 a[64:67], v[72:75], v[156:159], a[64:67]
    v_mfma_f32_16x16x32_bf16 a[68:71], v[68:71], v[124:127], a[68:71]
    v_mfma_f32_16x16x32_bf16 a[68:71], v[72:75], v[160:163], a[68:71]
    ds_read_b64_tr_b16 v[68:69], v23 offset:0
    ds_read_b64_tr_b16 v[70:71], v23 offset:4096
    ds_read_b64_tr_b16 v[72:73], v23 offset:8192
    ds_read_b64_tr_b16 v[74:75], v23 offset:12288
    s_waitcnt lgkmcnt(12)
    v_mfma_f32_16x16x32_bf16 a[72:75], v[76:79], v[92:95], a[72:75]
    v_mfma_f32_16x16x32_bf16 a[72:75], v[80:83], v[128:131], a[72:75]
    v_mfma_f32_16x16x32_bf16 a[76:79], v[76:79], v[96:99], a[76:79]
    v_mfma_f32_16x16x32_bf16 a[76:79], v[80:83], v[132:135], a[76:79]
    v_mfma_f32_16x16x32_bf16 a[80:83], v[76:79], v[100:103], a[80:83]
    v_mfma_f32_16x16x32_bf16 a[80:83], v[80:83], v[136:139], a[80:83]
    v_mfma_f32_16x16x32_bf16 a[84:87], v[76:79], v[104:107], a[84:87]
    v_mfma_f32_16x16x32_bf16 a[84:87], v[80:83], v[140:143], a[84:87]
    v_mfma_f32_16x16x32_bf16 a[88:91], v[76:79], v[108:111], a[88:91]
    v_mfma_f32_16x16x32_bf16 a[88:91], v[80:83], v[144:147], a[88:91]
    v_mfma_f32_16x16x32_bf16 a[92:95], v[76:79], v[112:115], a[92:95]
    v_mfma_f32_16x16x32_bf16 a[92:95], v[80:83], v[148:151], a[92:95]
    v_mfma_f32_16x16x32_bf16 a[96:99], v[76:79], v[116:119], a[96:99]
    v_mfma_f32_16x16x32_bf16 a[96:99], v[80:83], v[152:155], a[96:99]
    v_mfma_f32_16x16x32_bf16 a[100:103], v[76:79], v[120:123], a[100:103]
    v_mfma_f32_16x16x32_bf16 a[100:103], v[80:83], v[156:159], a[100:103]
    v_mfma_f32_16x16x32_bf16 a[104:107], v[76:79], v[124:127], a[104:107]
    v_mfma_f32_16x16x32_bf16 a[104:107], v[80:83], v[160:163], a[104:107]
    ds_read_b64_tr_b16 v[76:77], v24 offset:0
    ds_read_b64_tr_b16 v[78:79], v24 offset:4096
    ds_read_b64_tr_b16 v[80:81], v24 offset:8192
    ds_read_b64_tr_b16 v[82:83], v24 offset:12288
    s_waitcnt lgkmcnt(12)
    v_mfma_f32_16x16x32_bf16 a[108:111], v[84:87], v[92:95], a[108:111]
    v_mfma_f32_16x16x32_bf16 a[108:111], v[88:91], v[128:131], a[108:111]
    v_mfma_f32_16x16x32_bf16 a[112:115], v[84:87], v[96:99], a[112:115]
    v_mfma_f32_16x16x32_bf16 a[112:115], v[88:91], v[132:135], a[112:115]
    v_mfma_f32_16x16x32_bf16 a[116:119], v[84:87], v[100:103], a[116:119]
    v_mfma_f32_16x16x32_bf16 a[116:119], v[88:91], v[136:139], a[116:119]
    v_mfma_f32_16x16x32_bf16 a[120:123], v[84:87], v[104:107], a[120:123]
    v_mfma_f32_16x16x32_bf16 a[120:123], v[88:91], v[140:143], a[120:123]
    v_mfma_f32_16x16x32_bf16 a[124:127], v[84:87], v[108:111], a[124:127]
    v_mfma_f32_16x16x32_bf16 a[124:127], v[88:91], v[144:147], a[124:127]
    v_mfma_f32_16x16x32_bf16 a[128:131], v[84:87], v[112:115], a[128:131]
    v_mfma_f32_16x16x32_bf16 a[128:131], v[88:91], v[148:151], a[128:131]
    v_mfma_f32_16x16x32_bf16 a[132:135], v[84:87], v[116:119], a[132:135]
    v_mfma_f32_16x16x32_bf16 a[132:135], v[88:91], v[152:155], a[132:135]
    v_mfma_f32_16x16x32_bf16 a[136:139], v[84:87], v[120:123], a[136:139]
    v_mfma_f32_16x16x32_bf16 a[136:139], v[88:91], v[156:159], a[136:139]
    v_mfma_f32_16x16x32_bf16 a[140:143], v[84:87], v[124:127], a[140:143]
    v_mfma_f32_16x16x32_bf16 a[140:143], v[88:91], v[160:163], a[140:143]
    ds_read_b64_tr_b16 v[84:85], v25 offset:0
    ds_read_b64_tr_b16 v[86:87], v25 offset:4096
    ds_read_b64_tr_b16 v[88:89], v25 offset:8192
    ds_read_b64_tr_b16 v[90:91], v25 offset:12288
    s_waitcnt lgkmcnt(12)
    v_mfma_f32_16x16x32_bf16 a[144:147], v[60:63], v[92:95], a[144:147]
    v_mfma_f32_16x16x32_bf16 a[144:147], v[64:67], v[128:131], a[144:147]
    v_mfma_f32_16x16x32_bf16 a[148:151], v[60:63], v[96:99], a[148:151]
    v_mfma_f32_16x16x32_bf16 a[148:151], v[64:67], v[132:135], a[148:151]
    v_mfma_f32_16x16x32_bf16 a[152:155], v[60:63], v[100:103], a[152:155]
    v_mfma_f32_16x16x32_bf16 a[152:155], v[64:67], v[136:139], a[152:155]
    v_mfma_f32_16x16x32_bf16 a[156:159], v[60:63], v[104:107], a[156:159]
    v_mfma_f32_16x16x32_bf16 a[156:159], v[64:67], v[140:143], a[156:159]
    v_mfma_f32_16x16x32_bf16 a[160:163], v[60:63], v[108:111], a[160:163]
    v_mfma_f32_16x16x32_bf16 a[160:163], v[64:67], v[144:147], a[160:163]
    v_mfma_f32_16x16x32_bf16 a[164:167], v[60:63], v[112:115], a[164:167]
    v_mfma_f32_16x16x32_bf16 a[164:167], v[64:67], v[148:151], a[164:167]
    v_mfma_f32_16x16x32_bf16 a[168:171], v[60:63], v[116:119], a[168:171]
    v_mfma_f32_16x16x32_bf16 a[168:171], v[64:67], v[152:155], a[168:171]
    v_mfma_f32_16x16x32_bf16 v[36:39], v[60:63], v[120:123], v[36:39]
    v_mfma_f32_16x16x32_bf16 v[36:39], v[64:67], v[156:159], v[36:39]
    v_mfma_f32_16x16x32_bf16 v[52:55], v[60:63], v[124:127], v[52:55]
    v_mfma_f32_16x16x32_bf16 v[52:55], v[64:67], v[160:163], v[52:55]
    s_waitcnt vmcnt(18)
    ds_read_b64_tr_b16 v[60:61], v18 offset:16384
    ds_read_b64_tr_b16 v[62:63], v18 offset:20480
    ds_read_b64_tr_b16 v[64:65], v18 offset:24576
    ds_read_b64_tr_b16 v[66:67], v18 offset:28672
    s_waitcnt lgkmcnt(12)
    v_mfma_f32_16x16x32_bf16 a[172:175], v[68:71], v[92:95], a[172:175]
    v_mfma_f32_16x16x32_bf16 a[172:175], v[72:75], v[128:131], a[172:175]
    v_mfma_f32_16x16x32_bf16 a[176:179], v[68:71], v[96:99], a[176:179]
    v_mfma_f32_16x16x32_bf16 a[176:179], v[72:75], v[132:135], a[176:179]
    v_mfma_f32_16x16x32_bf16 a[180:183], v[68:71], v[100:103], a[180:183]
    v_mfma_f32_16x16x32_bf16 a[180:183], v[72:75], v[136:139], a[180:183]
    v_mfma_f32_16x16x32_bf16 a[184:187], v[68:71], v[104:107], a[184:187]
    v_mfma_f32_16x16x32_bf16 a[184:187], v[72:75], v[140:143], a[184:187]
    v_mfma_f32_16x16x32_bf16 a[188:191], v[68:71], v[108:111], a[188:191]
    v_mfma_f32_16x16x32_bf16 a[188:191], v[72:75], v[144:147], a[188:191]
    v_mfma_f32_16x16x32_bf16 a[192:195], v[68:71], v[112:115], a[192:195]
    v_mfma_f32_16x16x32_bf16 a[192:195], v[72:75], v[148:151], a[192:195]
    v_mfma_f32_16x16x32_bf16 a[196:199], v[68:71], v[116:119], a[196:199]
    v_mfma_f32_16x16x32_bf16 a[196:199], v[72:75], v[152:155], a[196:199]
    v_mfma_f32_16x16x32_bf16 v[40:43], v[68:71], v[120:123], v[40:43]
    v_mfma_f32_16x16x32_bf16 v[40:43], v[72:75], v[156:159], v[40:43]
    v_mfma_f32_16x16x32_bf16 v[56:59], v[68:71], v[124:127], v[56:59]
    v_mfma_f32_16x16x32_bf16 v[56:59], v[72:75], v[160:163], v[56:59]
    ds_read_b64_tr_b16 v[68:69], v19 offset:16384
    ds_read_b64_tr_b16 v[70:71], v19 offset:20480
    ds_read_b64_tr_b16 v[72:73], v19 offset:24576
    ds_read_b64_tr_b16 v[74:75], v19 offset:28672
    s_waitcnt lgkmcnt(12)
    v_mfma_f32_16x16x32_bf16 a[200:203], v[76:79], v[92:95], a[200:203]
    v_mfma_f32_16x16x32_bf16 a[200:203], v[80:83], v[128:131], a[200:203]
    v_mfma_f32_16x16x32_bf16 a[204:207], v[76:79], v[96:99], a[204:207]
    v_mfma_f32_16x16x32_bf16 a[204:207], v[80:83], v[132:135], a[204:207]
    v_mfma_f32_16x16x32_bf16 a[208:211], v[76:79], v[100:103], a[208:211]
    v_mfma_f32_16x16x32_bf16 a[208:211], v[80:83], v[136:139], a[208:211]
    v_mfma_f32_16x16x32_bf16 a[212:215], v[76:79], v[104:107], a[212:215]
    v_mfma_f32_16x16x32_bf16 a[212:215], v[80:83], v[140:143], a[212:215]
    v_mfma_f32_16x16x32_bf16 v[244:247], v[76:79], v[108:111], v[244:247]
    v_mfma_f32_16x16x32_bf16 v[244:247], v[80:83], v[144:147], v[244:247]
    v_mfma_f32_16x16x32_bf16 a[216:219], v[76:79], v[112:115], a[216:219]
    v_mfma_f32_16x16x32_bf16 a[216:219], v[80:83], v[148:151], a[216:219]
    v_mfma_f32_16x16x32_bf16 v[28:31], v[76:79], v[116:119], v[28:31]
    v_mfma_f32_16x16x32_bf16 v[28:31], v[80:83], v[152:155], v[28:31]
    v_mfma_f32_16x16x32_bf16 v[44:47], v[76:79], v[120:123], v[44:47]
    v_mfma_f32_16x16x32_bf16 v[44:47], v[80:83], v[156:159], v[44:47]
    v_mfma_f32_16x16x32_bf16 v[236:239], v[76:79], v[124:127], v[236:239]
    v_mfma_f32_16x16x32_bf16 v[236:239], v[80:83], v[160:163], v[236:239]
    ds_read_b64_tr_b16 v[76:77], v20 offset:16384
    ds_read_b64_tr_b16 v[78:79], v20 offset:20480
    ds_read_b64_tr_b16 v[80:81], v20 offset:24576
    ds_read_b64_tr_b16 v[82:83], v20 offset:28672
    s_waitcnt lgkmcnt(12)
    v_mfma_f32_16x16x32_bf16 a[220:223], v[84:87], v[92:95], a[220:223]
    v_mfma_f32_16x16x32_bf16 a[220:223], v[88:91], v[128:131], a[220:223]
    v_mfma_f32_16x16x32_bf16 a[224:227], v[84:87], v[96:99], a[224:227]
    v_mfma_f32_16x16x32_bf16 a[224:227], v[88:91], v[132:135], a[224:227]
    v_mfma_f32_16x16x32_bf16 a[228:231], v[84:87], v[100:103], a[228:231]
    v_mfma_f32_16x16x32_bf16 a[228:231], v[88:91], v[136:139], a[228:231]
    v_mfma_f32_16x16x32_bf16 a[232:235], v[84:87], v[104:107], a[232:235]
    v_mfma_f32_16x16x32_bf16 a[232:235], v[88:91], v[140:143], a[232:235]
    v_mfma_f32_16x16x32_bf16 v[248:251], v[84:87], v[108:111], v[248:251]
    v_mfma_f32_16x16x32_bf16 v[248:251], v[88:91], v[144:147], v[248:251]
    v_mfma_f32_16x16x32_bf16 a[236:239], v[84:87], v[112:115], a[236:239]
    v_mfma_f32_16x16x32_bf16 a[236:239], v[88:91], v[148:151], a[236:239]
    v_mfma_f32_16x16x32_bf16 v[32:35], v[84:87], v[116:119], v[32:35]
    v_mfma_f32_16x16x32_bf16 v[32:35], v[88:91], v[152:155], v[32:35]
    v_mfma_f32_16x16x32_bf16 v[48:51], v[84:87], v[120:123], v[48:51]
    v_mfma_f32_16x16x32_bf16 v[48:51], v[88:91], v[156:159], v[48:51]
    v_mfma_f32_16x16x32_bf16 v[240:243], v[84:87], v[124:127], v[240:243]
    v_mfma_f32_16x16x32_bf16 v[240:243], v[88:91], v[160:163], v[240:243]
    ds_read_b64_tr_b16 v[84:85], v21 offset:16384
    ds_read_b64_tr_b16 v[86:87], v21 offset:20480
    ds_read_b64_tr_b16 v[88:89], v21 offset:24576
    ds_read_b64_tr_b16 v[90:91], v21 offset:28672
    s_waitcnt vmcnt(0) lgkmcnt(12)
    v_mfma_f32_16x16x32_bf16 a[0:3], v[60:63], v[164:167], a[0:3]
    ds_read_b64_tr_b16 v[92:93], v22 offset:16384
    ds_read_b64_tr_b16 v[94:95], v22 offset:20480
    v_mfma_f32_16x16x32_bf16 a[0:3], v[64:67], v[200:203], a[0:3]
    ds_read_b64_tr_b16 v[96:97], v22 offset:24576
    ds_read_b64_tr_b16 v[98:99], v22 offset:28672
    v_mfma_f32_16x16x32_bf16 a[4:7], v[60:63], v[168:171], a[4:7]
    ds_read_b64_tr_b16 v[100:101], v23 offset:16384
    ds_read_b64_tr_b16 v[102:103], v23 offset:20480
    v_mfma_f32_16x16x32_bf16 a[4:7], v[64:67], v[204:207], a[4:7]
    ds_read_b64_tr_b16 v[104:105], v23 offset:24576
    ds_read_b64_tr_b16 v[106:107], v23 offset:28672
    v_mfma_f32_16x16x32_bf16 a[8:11], v[60:63], v[172:175], a[8:11]
    ds_read_b64_tr_b16 v[108:109], v24 offset:16384
    ds_read_b64_tr_b16 v[110:111], v24 offset:20480
    v_mfma_f32_16x16x32_bf16 a[8:11], v[64:67], v[208:211], a[8:11]
    ds_read_b64_tr_b16 v[112:113], v24 offset:24576
    ds_read_b64_tr_b16 v[114:115], v24 offset:28672
    v_mfma_f32_16x16x32_bf16 a[20:23], v[60:63], v[184:187], a[20:23]
    ds_read_b64_tr_b16 v[116:117], v25 offset:16384
    ds_read_b64_tr_b16 v[118:119], v25 offset:20480
    v_mfma_f32_16x16x32_bf16 a[20:23], v[64:67], v[220:223], a[20:23]
    ds_read_b64_tr_b16 v[120:121], v25 offset:24576
    ds_read_b64_tr_b16 v[122:123], v25 offset:28672
    v_mfma_f32_16x16x32_bf16 a[24:27], v[60:63], v[188:191], a[24:27]
    ds_write_b128 v8, a[0:3] offset:2048
    v_mfma_f32_16x16x32_bf16 a[24:27], v[64:67], v[224:227], a[24:27]
    v_mfma_f32_16x16x32_bf16 a[28:31], v[60:63], v[192:195], a[28:31]
    v_mfma_f32_16x16x32_bf16 a[28:31], v[64:67], v[228:231], a[28:31]
    ds_write_b128 v8, a[4:7] offset:6144
    v_mfma_f32_16x16x32_bf16 a[32:35], v[60:63], v[196:199], a[32:35]
    v_mfma_f32_16x16x32_bf16 a[32:35], v[64:67], v[232:235], a[32:35]
    s_waitcnt lgkmcnt(15)
    v_mfma_f32_16x16x32_bf16 a[36:39], v[68:71], v[164:167], a[36:39]
    ds_write_b128 v8, a[8:11] offset:10240
    v_mfma_f32_16x16x32_bf16 a[36:39], v[72:75], v[200:203], a[36:39]
    v_mfma_f32_16x16x32_bf16 a[40:43], v[68:71], v[168:171], a[40:43]
    v_mfma_f32_16x16x32_bf16 a[40:43], v[72:75], v[204:207], a[40:43]
    ds_write_b128 v8, a[20:23] offset:14336
    v_mfma_f32_16x16x32_bf16 a[44:47], v[68:71], v[172:175], a[44:47]
    v_mfma_f32_16x16x32_bf16 a[44:47], v[72:75], v[208:211], a[44:47]
    v_mfma_f32_16x16x32_bf16 a[56:59], v[68:71], v[184:187], a[56:59]
    ds_write_b128 v8, a[24:27] offset:18432
    v_mfma_f32_16x16x32_bf16 a[56:59], v[72:75], v[220:223], a[56:59]
    v_mfma_f32_16x16x32_bf16 a[60:63], v[68:71], v[188:191], a[60:63]
    v_mfma_f32_16x16x32_bf16 a[60:63], v[72:75], v[224:227], a[60:63]
    ds_write_b128 v8, a[28:31] offset:22528
    v_mfma_f32_16x16x32_bf16 a[64:67], v[68:71], v[192:195], a[64:67]
    v_mfma_f32_16x16x32_bf16 a[64:67], v[72:75], v[228:231], a[64:67]
    v_mfma_f32_16x16x32_bf16 a[72:75], v[76:79], v[164:167], a[72:75]
    ds_write_b128 v8, a[32:35] offset:26624
    v_mfma_f32_16x16x32_bf16 a[72:75], v[80:83], v[200:203], a[72:75]
    v_mfma_f32_16x16x32_bf16 a[76:79], v[76:79], v[168:171], a[76:79]
    v_mfma_f32_16x16x32_bf16 a[76:79], v[80:83], v[204:207], a[76:79]
    ds_write_b128 v8, a[36:39] offset:3072
    v_mfma_f32_16x16x32_bf16 a[80:83], v[76:79], v[172:175], a[80:83]
    v_mfma_f32_16x16x32_bf16 a[80:83], v[80:83], v[208:211], a[80:83]
    v_mfma_f32_16x16x32_bf16 a[84:87], v[76:79], v[176:179], a[84:87]
    ds_write_b128 v8, a[40:43] offset:7168
    v_mfma_f32_16x16x32_bf16 a[84:87], v[80:83], v[212:215], a[84:87]
    v_mfma_f32_16x16x32_bf16 a[92:95], v[76:79], v[184:187], a[92:95]
    v_mfma_f32_16x16x32_bf16 a[92:95], v[80:83], v[220:223], a[92:95]
    ds_write_b128 v8, a[44:47] offset:11264
    v_mfma_f32_16x16x32_bf16 a[96:99], v[76:79], v[188:191], a[96:99]
    v_mfma_f32_16x16x32_bf16 a[96:99], v[80:83], v[224:227], a[96:99]
    v_mfma_f32_16x16x32_bf16 a[100:103], v[76:79], v[192:195], a[100:103]
    ds_write_b128 v8, a[56:59] offset:15360
    v_mfma_f32_16x16x32_bf16 a[100:103], v[80:83], v[228:231], a[100:103]
    v_mfma_f32_16x16x32_bf16 a[108:111], v[84:87], v[164:167], a[108:111]
    v_mfma_f32_16x16x32_bf16 a[108:111], v[88:91], v[200:203], a[108:111]
    ds_write_b128 v8, a[60:63] offset:19456
    v_mfma_f32_16x16x32_bf16 a[112:115], v[84:87], v[168:171], a[112:115]
    v_mfma_f32_16x16x32_bf16 a[112:115], v[88:91], v[204:207], a[112:115]
    v_mfma_f32_16x16x32_bf16 a[116:119], v[84:87], v[172:175], a[116:119]
    ds_write_b128 v8, a[64:67] offset:23552
    v_mfma_f32_16x16x32_bf16 a[116:119], v[88:91], v[208:211], a[116:119]
    v_mfma_f32_16x16x32_bf16 a[120:123], v[84:87], v[176:179], a[120:123]
    v_mfma_f32_16x16x32_bf16 a[120:123], v[88:91], v[212:215], a[120:123]
    ds_write_b128 v8, a[72:75] offset:0
    v_mfma_f32_16x16x32_bf16 a[128:131], v[84:87], v[184:187], a[128:131]
    v_mfma_f32_16x16x32_bf16 a[128:131], v[88:91], v[220:223], a[128:131]
    v_mfma_f32_16x16x32_bf16 a[132:135], v[84:87], v[188:191], a[132:135]
    ds_write_b128 v8, a[76:79] offset:4096
    v_mfma_f32_16x16x32_bf16 a[132:135], v[88:91], v[224:227], a[132:135]
    v_mfma_f32_16x16x32_bf16 a[136:139], v[84:87], v[192:195], a[136:139]
    v_mfma_f32_16x16x32_bf16 a[136:139], v[88:91], v[228:231], a[136:139]
    ds_write_b128 v8, a[80:83] offset:8192
    s_waitcnt lgkmcnt(15)
    v_mfma_f32_16x16x32_bf16 a[200:203], v[108:111], v[164:167], a[200:203]
    v_mfma_f32_16x16x32_bf16 a[200:203], v[112:115], v[200:203], a[200:203]
    v_mfma_f32_16x16x32_bf16 a[220:223], v[116:119], v[164:167], a[220:223]
    ds_write_b128 v8, a[84:87] offset:12288
    v_mfma_f32_16x16x32_bf16 a[220:223], v[120:123], v[200:203], a[220:223]
    v_mfma_f32_16x16x32_bf16 a[144:147], v[92:95], v[164:167], a[144:147]
    v_mfma_f32_16x16x32_bf16 a[144:147], v[96:99], v[200:203], a[144:147]
    ds_write_b128 v8, a[92:95] offset:16384
    v_mfma_f32_16x16x32_bf16 a[172:175], v[100:103], v[164:167], a[172:175]
    v_mfma_f32_16x16x32_bf16 a[172:175], v[104:107], v[200:203], a[172:175]
    v_mfma_f32_16x16x32_bf16 a[204:207], v[108:111], v[168:171], a[204:207]
    ds_write_b128 v8, a[96:99] offset:20480
    v_mfma_f32_16x16x32_bf16 a[204:207], v[112:115], v[204:207], a[204:207]
    v_mfma_f32_16x16x32_bf16 a[224:227], v[116:119], v[168:171], a[224:227]
    v_mfma_f32_16x16x32_bf16 a[224:227], v[120:123], v[204:207], a[224:227]
    ds_write_b128 v8, a[100:103] offset:24576
    v_mfma_f32_16x16x32_bf16 a[148:151], v[92:95], v[168:171], a[148:151]
    v_mfma_f32_16x16x32_bf16 a[148:151], v[96:99], v[204:207], a[148:151]
    v_mfma_f32_16x16x32_bf16 a[176:179], v[100:103], v[168:171], a[176:179]
    ds_write_b128 v8, a[108:111] offset:1024
    v_mfma_f32_16x16x32_bf16 a[176:179], v[104:107], v[204:207], a[176:179]
    v_mfma_f32_16x16x32_bf16 a[208:211], v[108:111], v[172:175], a[208:211]
    v_mfma_f32_16x16x32_bf16 a[208:211], v[112:115], v[208:211], a[208:211]
    ds_write_b128 v8, a[112:115] offset:5120
    v_mfma_f32_16x16x32_bf16 a[228:231], v[116:119], v[172:175], a[228:231]
    v_mfma_f32_16x16x32_bf16 a[228:231], v[120:123], v[208:211], a[228:231]
    v_mfma_f32_16x16x32_bf16 a[152:155], v[92:95], v[172:175], a[152:155]
    ds_write_b128 v8, a[116:119] offset:9216
    v_mfma_f32_16x16x32_bf16 a[152:155], v[96:99], v[208:211], a[152:155]
    v_mfma_f32_16x16x32_bf16 a[180:183], v[100:103], v[172:175], a[180:183]
    v_mfma_f32_16x16x32_bf16 a[180:183], v[104:107], v[208:211], a[180:183]
    ds_write_b128 v8, a[120:123] offset:13312
    v_mfma_f32_16x16x32_bf16 a[212:215], v[108:111], v[176:179], a[212:215]
    v_mfma_f32_16x16x32_bf16 a[212:215], v[112:115], v[212:215], a[212:215]
    v_mfma_f32_16x16x32_bf16 a[12:15], v[60:63], v[176:179], a[12:15]
    ds_write_b128 v8, a[128:131] offset:17408
    v_mfma_f32_16x16x32_bf16 a[12:15], v[64:67], v[212:215], a[12:15]
    v_mfma_f32_16x16x32_bf16 a[48:51], v[68:71], v[176:179], a[48:51]
    v_mfma_f32_16x16x32_bf16 a[48:51], v[72:75], v[212:215], a[48:51]
    ds_write_b128 v8, a[132:135] offset:21504
    v_mfma_f32_16x16x32_bf16 a[16:19], v[60:63], v[180:183], a[16:19]
    v_mfma_f32_16x16x32_bf16 a[16:19], v[64:67], v[216:219], a[16:19]
    v_mfma_f32_16x16x32_bf16 a[52:55], v[68:71], v[180:183], a[52:55]
    ds_write_b128 v8, a[136:139] offset:25600
    v_mfma_f32_16x16x32_bf16 a[52:55], v[72:75], v[216:219], a[52:55]
    v_mfma_f32_16x16x32_bf16 a[68:71], v[68:71], v[196:199], a[68:71]
    v_mfma_f32_16x16x32_bf16 a[68:71], v[72:75], v[232:235], a[68:71]
    ds_write_b128 v8, a[200:203] offset:27648
    v_mfma_f32_16x16x32_bf16 a[104:107], v[76:79], v[196:199], a[104:107]
    v_mfma_f32_16x16x32_bf16 a[104:107], v[80:83], v[232:235], a[104:107]
    v_mfma_f32_16x16x32_bf16 a[140:143], v[84:87], v[196:199], a[140:143]
    ds_write_b128 v8, a[220:223] offset:28672
    v_mfma_f32_16x16x32_bf16 a[140:143], v[88:91], v[232:235], a[140:143]
    v_mfma_f32_16x16x32_bf16 a[88:91], v[76:79], v[180:183], a[88:91]
    v_mfma_f32_16x16x32_bf16 a[88:91], v[80:83], v[216:219], a[88:91]
    ds_write_b128 v8, a[144:147] offset:29696
    v_mfma_f32_16x16x32_bf16 a[124:127], v[84:87], v[180:183], a[124:127]
    v_mfma_f32_16x16x32_bf16 a[124:127], v[88:91], v[216:219], a[124:127]
    v_mfma_f32_16x16x32_bf16 a[232:235], v[116:119], v[176:179], a[232:235]
    ds_write_b128 v8, a[172:175] offset:30720
    v_mfma_f32_16x16x32_bf16 a[232:235], v[120:123], v[212:215], a[232:235]
    v_mfma_f32_16x16x32_bf16 a[156:159], v[92:95], v[176:179], a[156:159]
    v_mfma_f32_16x16x32_bf16 a[156:159], v[96:99], v[212:215], a[156:159]
    ds_write_b128 v8, a[204:207] offset:31744
    v_mfma_f32_16x16x32_bf16 a[184:187], v[100:103], v[176:179], a[184:187]
    v_mfma_f32_16x16x32_bf16 a[184:187], v[104:107], v[212:215], a[184:187]
    v_mfma_f32_16x16x32_bf16 a[160:163], v[92:95], v[180:183], a[160:163]
    ds_write_b128 v8, a[224:227] offset:32768
    v_mfma_f32_16x16x32_bf16 a[160:163], v[96:99], v[216:219], a[160:163]
    v_mfma_f32_16x16x32_bf16 a[188:191], v[100:103], v[180:183], a[188:191]
    v_mfma_f32_16x16x32_bf16 a[188:191], v[104:107], v[216:219], a[188:191]
    ds_write_b128 v8, a[148:151] offset:33792
    v_mfma_f32_16x16x32_bf16 a[164:167], v[92:95], v[184:187], a[164:167]
    v_mfma_f32_16x16x32_bf16 a[164:167], v[96:99], v[220:223], a[164:167]
    v_mfma_f32_16x16x32_bf16 a[192:195], v[100:103], v[184:187], a[192:195]
    ds_write_b128 v8, a[176:179] offset:34816
    v_mfma_f32_16x16x32_bf16 a[192:195], v[104:107], v[220:223], a[192:195]
    v_mfma_f32_16x16x32_bf16 a[216:219], v[108:111], v[184:187], a[216:219]
    v_mfma_f32_16x16x32_bf16 a[216:219], v[112:115], v[220:223], a[216:219]
    ds_write_b128 v8, a[208:211] offset:35840
    v_mfma_f32_16x16x32_bf16 a[236:239], v[116:119], v[184:187], a[236:239]
    v_mfma_f32_16x16x32_bf16 a[236:239], v[120:123], v[220:223], a[236:239]
    v_mfma_f32_16x16x32_bf16 a[168:171], v[92:95], v[188:191], a[168:171]
    ds_write_b128 v8, a[228:231] offset:36864
    v_mfma_f32_16x16x32_bf16 a[168:171], v[96:99], v[224:227], a[168:171]
    v_mfma_f32_16x16x32_bf16 a[196:199], v[100:103], v[188:191], a[196:199]
    v_mfma_f32_16x16x32_bf16 a[196:199], v[104:107], v[224:227], a[196:199]
    ds_write_b128 v8, a[152:155] offset:37888
    v_mfma_f32_16x16x32_bf16 v[28:31], v[108:111], v[188:191], v[28:31]
    v_mfma_f32_16x16x32_bf16 v[28:31], v[112:115], v[224:227], v[28:31]
    v_mfma_f32_16x16x32_bf16 v[32:35], v[116:119], v[188:191], v[32:35]
    ds_write_b128 v8, a[180:183] offset:38912
    v_mfma_f32_16x16x32_bf16 v[32:35], v[120:123], v[224:227], v[32:35]
    v_mfma_f32_16x16x32_bf16 v[36:39], v[92:95], v[192:195], v[36:39]
    v_mfma_f32_16x16x32_bf16 v[36:39], v[96:99], v[228:231], v[36:39]
    ds_write_b128 v8, a[212:215] offset:39936
    v_mfma_f32_16x16x32_bf16 v[40:43], v[100:103], v[192:195], v[40:43]
    v_mfma_f32_16x16x32_bf16 v[40:43], v[104:107], v[228:231], v[40:43]
    v_mfma_f32_16x16x32_bf16 v[44:47], v[108:111], v[192:195], v[44:47]
    v_mfma_f32_16x16x32_bf16 v[44:47], v[112:115], v[228:231], v[44:47]
    v_mfma_f32_16x16x32_bf16 v[48:51], v[116:119], v[192:195], v[48:51]
    v_mfma_f32_16x16x32_bf16 v[48:51], v[120:123], v[228:231], v[48:51]
    v_mfma_f32_16x16x32_bf16 v[52:55], v[92:95], v[196:199], v[52:55]
    v_mfma_f32_16x16x32_bf16 v[52:55], v[96:99], v[232:235], v[52:55]
    v_mfma_f32_16x16x32_bf16 v[56:59], v[100:103], v[196:199], v[56:59]
    v_mfma_f32_16x16x32_bf16 v[56:59], v[104:107], v[232:235], v[56:59]
    v_mfma_f32_16x16x32_bf16 v[236:239], v[108:111], v[196:199], v[236:239]
    v_mfma_f32_16x16x32_bf16 v[236:239], v[112:115], v[232:235], v[236:239]
    v_mfma_f32_16x16x32_bf16 v[240:243], v[116:119], v[196:199], v[240:243]
    v_mfma_f32_16x16x32_bf16 v[240:243], v[120:123], v[232:235], v[240:243]
    v_mfma_f32_16x16x32_bf16 v[244:247], v[108:111], v[180:183], v[244:247]
    v_mfma_f32_16x16x32_bf16 v[244:247], v[112:115], v[216:219], v[244:247]
    v_mfma_f32_16x16x32_bf16 v[248:251], v[116:119], v[180:183], v[248:251]
    v_mfma_f32_16x16x32_bf16 v[248:251], v[120:123], v[216:219], v[248:251]
    s_and_b32 s62, s20, 1
    s_lshl_b32 s62, s62, 7
    s_add_u32 s23, s24, s62
    s_lshr_b32 s62, s20, 1
    s_lshl_b32 s59, s62, 6
    s_add_u32 s59, s59, s23
    s_add_u32 s59, s59, 163840
    s_mul_i32 s62, s62, 5
    s_mul_i32 s22, s62, 40960
    s_add_u32 s23, s23, s22
    s_add_u32 s62, s62, s31
    s_add_u32 s62, s62, 3
    s_cmp_ge_u32 s62, 224
    s_cselect_b32 s22, 0x40000000, 0
    s_add_u32 s22, s22, 122880
    s_add_u32 s22, s22, s23
    s_waitcnt lgkmcnt(0)
    s_barrier
    ds_read_b128 v[60:63], v2 offset:0
    ds_read_b128 v[64:67], v2 offset:1024
    ds_read_b128 v[68:71], v2 offset:2048
    ds_read_b128 v[72:75], v2 offset:3072
    ds_read_b128 v[76:79], v3 offset:14336
    ds_read_b128 v[80:83], v3 offset:15360
    ds_read_b128 v[84:87], v3 offset:16384
    ds_read_b128 v[88:91], v3 offset:17408
    ds_read_b128 v[92:95], v4 offset:27648
    ds_read_b128 v[96:99], v4 offset:28672
    ds_read_b128 v[100:103], v4 offset:29696
    ds_read_b128 v[104:107], v4 offset:30720
    v_accvgpr_read_b32 v220, a164
    v_accvgpr_read_b32 v221, a165
    v_accvgpr_read_b32 v222, a166
    v_accvgpr_read_b32 v223, a167
    v_accvgpr_read_b32 v224, a192
    v_accvgpr_read_b32 v225, a193
    v_accvgpr_read_b32 v226, a194
    v_accvgpr_read_b32 v227, a195
    v_accvgpr_read_b32 v228, a216
    v_accvgpr_read_b32 v229, a217
    v_accvgpr_read_b32 v230, a218
    v_accvgpr_read_b32 v231, a219
    v_accvgpr_read_b32 v232, a236
    v_accvgpr_read_b32 v233, a237
    v_accvgpr_read_b32 v234, a238
    v_accvgpr_read_b32 v235, a239
    v_accvgpr_read_b32 v10, a168
    v_accvgpr_read_b32 v11, a169
    v_accvgpr_read_b32 v12, a170
    v_accvgpr_read_b32 v13, a171
    v_accvgpr_read_b32 v14, a196
    v_accvgpr_read_b32 v15, a197
    v_accvgpr_read_b32 v16, a198
    v_accvgpr_read_b32 v17, a199
    ds_read_b128 v[108:111], v2 offset:4096
    ds_read_b128 v[112:115], v2 offset:5120
    ds_read_b128 v[116:119], v2 offset:6144
    ds_read_b128 v[120:123], v2 offset:7168
    ds_read_b128 v[124:127], v3 offset:18432
    ds_read_b128 v[128:131], v3 offset:19456
    ds_read_b128 v[132:135], v3 offset:20480
    ds_read_b128 v[136:139], v3 offset:21504
    ds_read_b128 v[140:143], v4 offset:31744
    ds_read_b128 v[144:147], v4 offset:32768
    ds_read_b128 v[148:151], v4 offset:33792
    ds_read_b128 v[152:155], v4 offset:34816
    s_waitcnt lgkmcnt(12)
    v_pk_add_f32 v[76:77], v[76:77], v[92:93]
    v_pk_add_f32 v[78:79], v[78:79], v[94:95]
    ds_read_b128 v[156:159], v2 offset:8192
    v_pk_add_f32 v[80:81], v[80:81], v[96:97]
    v_pk_add_f32 v[82:83], v[82:83], v[98:99]
    ds_read_b128 v[160:163], v2 offset:9216
    v_pk_add_f32 v[84:85], v[84:85], v[100:101]
    v_pk_add_f32 v[86:87], v[86:87], v[102:103]
    ds_read_b128 v[164:167], v2 offset:10240
    v_pk_add_f32 v[88:89], v[88:89], v[104:105]
    v_pk_add_f32 v[90:91], v[90:91], v[106:107]
    ds_read_b128 v[168:171], v2 offset:11264
    v_pk_add_f32 v[220:221], v[220:221], v[60:61]
    v_pk_add_f32 v[222:223], v[222:223], v[62:63]
    ds_read_b128 v[172:175], v3 offset:22528
    v_pk_add_f32 v[224:225], v[224:225], v[64:65]
    v_pk_add_f32 v[226:227], v[226:227], v[66:67]
    ds_read_b128 v[176:179], v3 offset:23552
    v_pk_add_f32 v[228:229], v[228:229], v[68:69]
    v_pk_add_f32 v[230:231], v[230:231], v[70:71]
    ds_read_b128 v[180:183], v3 offset:24576
    v_pk_add_f32 v[232:233], v[232:233], v[72:73]
    v_pk_add_f32 v[234:235], v[234:235], v[74:75]
    ds_read_b128 v[184:187], v3 offset:25600
    v_pk_add_f32 v[220:221], v[220:221], v[76:77]
    v_pk_add_f32 v[222:223], v[222:223], v[78:79]
    ds_read_b128 v[188:191], v4 offset:35840
    v_pk_add_f32 v[224:225], v[224:225], v[80:81]
    v_pk_add_f32 v[226:227], v[226:227], v[82:83]
    ds_read_b128 v[192:195], v4 offset:36864
    v_pk_add_f32 v[228:229], v[228:229], v[84:85]
    v_pk_add_f32 v[230:231], v[230:231], v[86:87]
    ds_read_b128 v[196:199], v4 offset:37888
    v_pk_add_f32 v[232:233], v[232:233], v[88:89]
    v_pk_add_f32 v[234:235], v[234:235], v[90:91]
    ds_read_b128 v[200:203], v4 offset:38912
    v_cvt_pk_bf16_f32 v60, v220, v221
    v_cvt_pk_bf16_f32 v61, v222, v223
    v_cvt_pk_bf16_f32 v62, v224, v225
    ds_read_b128 v[204:207], v2 offset:12288
    v_cvt_pk_bf16_f32 v63, v226, v227
    v_cvt_pk_bf16_f32 v64, v228, v229
    v_cvt_pk_bf16_f32 v65, v230, v231
    ds_read_b128 v[208:211], v3 offset:26624
    v_cvt_pk_bf16_f32 v66, v232, v233
    v_cvt_pk_bf16_f32 v67, v234, v235
    s_add_u32 s62, s23, 0
    ds_read_b128 v[212:215], v4 offset:39936
    v_permlane16_swap_b32 v60, v62
    v_permlane16_swap_b32 v61, v63
    v_permlane16_swap_b32 v64, v66
    ds_read_b128 v[216:219], v2 offset:13312
    v_permlane16_swap_b32 v65, v67
    s_mov_b64 vcc, s[64:65]
    s_nop 0
    v_cndmask_b32_dpp v68, v64, v60, vcc row_ror:8 row_mask:0xf bank_mask:0xf
    v_cndmask_b32_dpp v69, v65, v61, vcc row_ror:8 row_mask:0xf bank_mask:0xf
    v_cndmask_b32_dpp v70, v66, v62, vcc row_ror:8 row_mask:0xf bank_mask:0xf
    v_cndmask_b32_dpp v71, v67, v63, vcc row_ror:8 row_mask:0xf bank_mask:0xf
    s_mov_b64 vcc, s[66:67]
    buffer_store_dwordx4 v[68:71], v26, s[12:15], s62 offen sc0 sc1
    v_cndmask_b32_dpp v72, v64, v60, vcc row_ror:8 row_mask:0xf bank_mask:0xf
    v_cndmask_b32_dpp v73, v65, v61, vcc row_ror:8 row_mask:0xf bank_mask:0xf
    v_cndmask_b32_dpp v74, v66, v62, vcc row_ror:8 row_mask:0xf bank_mask:0xf
    v_cndmask_b32_dpp v75, v67, v63, vcc row_ror:8 row_mask:0xf bank_mask:0xf
    buffer_store_dwordx4 v[72:75], v27, s[12:15], s62 offen sc0 sc1
    s_waitcnt lgkmcnt(15)
    v_pk_add_f32 v[124:125], v[124:125], v[140:141]
    v_pk_add_f32 v[126:127], v[126:127], v[142:143]
    v_pk_add_f32 v[128:129], v[128:129], v[144:145]
    ds_write_b128 v2, a[12:15] offset:0
    v_pk_add_f32 v[130:131], v[130:131], v[146:147]
    v_pk_add_f32 v[132:133], v[132:133], v[148:149]
    v_pk_add_f32 v[134:135], v[134:135], v[150:151]
    ds_write_b128 v2, a[48:51] offset:1024
    v_pk_add_f32 v[136:137], v[136:137], v[152:153]
    v_pk_add_f32 v[138:139], v[138:139], v[154:155]
    v_pk_add_f32 v[10:11], v[10:11], v[108:109]
    ds_write_b128 v2, a[16:19] offset:2048
    v_pk_add_f32 v[12:13], v[12:13], v[110:111]
    v_pk_add_f32 v[14:15], v[14:15], v[112:113]
    v_pk_add_f32 v[16:17], v[16:17], v[114:115]
    ds_write_b128 v2, a[52:55] offset:3072
    v_pk_add_f32 v[28:29], v[28:29], v[116:117]
    v_pk_add_f32 v[30:31], v[30:31], v[118:119]
    v_pk_add_f32 v[32:33], v[32:33], v[120:121]
    ds_write_b128 v2, a[68:71] offset:4096
    v_pk_add_f32 v[34:35], v[34:35], v[122:123]
    v_pk_add_f32 v[10:11], v[10:11], v[124:125]
    v_pk_add_f32 v[12:13], v[12:13], v[126:127]
    ds_write_b128 v2, a[104:107] offset:5120
    v_pk_add_f32 v[14:15], v[14:15], v[128:129]
    v_pk_add_f32 v[16:17], v[16:17], v[130:131]
    v_pk_add_f32 v[28:29], v[28:29], v[132:133]
    ds_write_b128 v2, a[140:143] offset:6144
    v_pk_add_f32 v[30:31], v[30:31], v[134:135]
    v_pk_add_f32 v[32:33], v[32:33], v[136:137]
    v_pk_add_f32 v[34:35], v[34:35], v[138:139]
    ds_write_b128 v2, a[88:91] offset:7168
    v_cvt_pk_bf16_f32 v108, v10, v11
    v_cvt_pk_bf16_f32 v109, v12, v13
    v_cvt_pk_bf16_f32 v110, v14, v15
    ds_write_b128 v2, a[124:127] offset:8192
    v_cvt_pk_bf16_f32 v111, v16, v17
    v_cvt_pk_bf16_f32 v112, v28, v29
    v_cvt_pk_bf16_f32 v113, v30, v31
    ds_write_b128 v2, a[232:235] offset:9216
    v_cvt_pk_bf16_f32 v114, v32, v33
    v_cvt_pk_bf16_f32 v115, v34, v35
    s_add_u32 s62, s23, 40960
    ds_write_b128 v2, a[156:159] offset:10240
    v_permlane16_swap_b32 v108, v110
    v_permlane16_swap_b32 v109, v111
    v_permlane16_swap_b32 v112, v114
    ds_write_b128 v2, a[184:187] offset:11264
    v_permlane16_swap_b32 v113, v115
    s_mov_b64 vcc, s[64:65]
    s_nop 0
    ds_write_b128 v2, a[160:163] offset:12288
    v_cndmask_b32_dpp v116, v112, v108, vcc row_ror:8 row_mask:0xf bank_mask:0xf
    v_cndmask_b32_dpp v117, v113, v109, vcc row_ror:8 row_mask:0xf bank_mask:0xf
    v_cndmask_b32_dpp v118, v114, v110, vcc row_ror:8 row_mask:0xf bank_mask:0xf
    ds_write_b128 v2, a[188:191] offset:13312
    v_cndmask_b32_dpp v119, v115, v111, vcc row_ror:8 row_mask:0xf bank_mask:0xf
    s_mov_b64 vcc, s[66:67]
    buffer_store_dwordx4 v[116:119], v26, s[12:15], s62 offen sc0 sc1
    v_cndmask_b32_dpp v120, v112, v108, vcc row_ror:8 row_mask:0xf bank_mask:0xf
    v_cndmask_b32_dpp v121, v113, v109, vcc row_ror:8 row_mask:0xf bank_mask:0xf
    v_cndmask_b32_dpp v122, v114, v110, vcc row_ror:8 row_mask:0xf bank_mask:0xf
    v_cndmask_b32_dpp v123, v115, v111, vcc row_ror:8 row_mask:0xf bank_mask:0xf
    buffer_store_dwordx4 v[120:123], v27, s[12:15], s62 offen sc0 sc1
    s_waitcnt lgkmcnt(15)
    v_pk_add_f32 v[172:173], v[172:173], v[188:189]
    v_pk_add_f32 v[174:175], v[174:175], v[190:191]
    v_pk_add_f32 v[176:177], v[176:177], v[192:193]
    v_pk_add_f32 v[178:179], v[178:179], v[194:195]
    v_pk_add_f32 v[180:181], v[180:181], v[196:197]
    v_pk_add_f32 v[182:183], v[182:183], v[198:199]
    v_pk_add_f32 v[184:185], v[184:185], v[200:201]
    v_pk_add_f32 v[186:187], v[186:187], v[202:203]
    v_pk_add_f32 v[36:37], v[36:37], v[156:157]
    v_pk_add_f32 v[38:39], v[38:39], v[158:159]
    v_pk_add_f32 v[40:41], v[40:41], v[160:161]
    v_pk_add_f32 v[42:43], v[42:43], v[162:163]
    v_pk_add_f32 v[44:45], v[44:45], v[164:165]
    v_pk_add_f32 v[46:47], v[46:47], v[166:167]
    v_pk_add_f32 v[48:49], v[48:49], v[168:169]
    v_pk_add_f32 v[50:51], v[50:51], v[170:171]
    v_pk_add_f32 v[36:37], v[36:37], v[172:173]
    v_pk_add_f32 v[38:39], v[38:39], v[174:175]
    v_pk_add_f32 v[40:41], v[40:41], v[176:177]
    v_pk_add_f32 v[42:43], v[42:43], v[178:179]
    v_pk_add_f32 v[44:45], v[44:45], v[180:181]
    v_pk_add_f32 v[46:47], v[46:47], v[182:183]
    v_pk_add_f32 v[48:49], v[48:49], v[184:185]
    v_pk_add_f32 v[50:51], v[50:51], v[186:187]
    v_cvt_pk_bf16_f32 v156, v36, v37
    v_cvt_pk_bf16_f32 v157, v38, v39
    v_cvt_pk_bf16_f32 v158, v40, v41
    v_cvt_pk_bf16_f32 v159, v42, v43
    v_cvt_pk_bf16_f32 v160, v44, v45
    v_cvt_pk_bf16_f32 v161, v46, v47
    v_cvt_pk_bf16_f32 v162, v48, v49
    v_cvt_pk_bf16_f32 v163, v50, v51
    s_add_u32 s62, s23, 81920
    v_permlane16_swap_b32 v156, v158
    v_permlane16_swap_b32 v157, v159
    v_permlane16_swap_b32 v160, v162
    v_permlane16_swap_b32 v161, v163
    s_mov_b64 vcc, s[64:65]
    s_nop 0
    v_cndmask_b32_dpp v164, v160, v156, vcc row_ror:8 row_mask:0xf bank_mask:0xf
    v_cndmask_b32_dpp v165, v161, v157, vcc row_ror:8 row_mask:0xf bank_mask:0xf
    v_cndmask_b32_dpp v166, v162, v158, vcc row_ror:8 row_mask:0xf bank_mask:0xf
    v_cndmask_b32_dpp v167, v163, v159, vcc row_ror:8 row_mask:0xf bank_mask:0xf
    s_mov_b64 vcc, s[66:67]
    buffer_store_dwordx4 v[164:167], v26, s[12:15], s62 offen sc0 sc1
    v_cndmask_b32_dpp v168, v160, v156, vcc row_ror:8 row_mask:0xf bank_mask:0xf
    v_cndmask_b32_dpp v169, v161, v157, vcc row_ror:8 row_mask:0xf bank_mask:0xf
    v_cndmask_b32_dpp v170, v162, v158, vcc row_ror:8 row_mask:0xf bank_mask:0xf
    v_cndmask_b32_dpp v171, v163, v159, vcc row_ror:8 row_mask:0xf bank_mask:0xf
    buffer_store_dwordx4 v[168:171], v27, s[12:15], s62 offen sc0 sc1
    s_waitcnt lgkmcnt(14)
    v_pk_add_f32 v[208:209], v[208:209], v[212:213]
    v_pk_add_f32 v[210:211], v[210:211], v[214:215]
    v_pk_add_f32 v[52:53], v[52:53], v[204:205]
    v_pk_add_f32 v[54:55], v[54:55], v[206:207]
    v_pk_add_f32 v[52:53], v[52:53], v[208:209]
    v_pk_add_f32 v[54:55], v[54:55], v[210:211]
    v_pk_add_f32 v[56:57], v[56:57], v[216:217]
    v_pk_add_f32 v[58:59], v[58:59], v[218:219]
    s_waitcnt lgkmcnt(0)
    s_barrier
    ds_read_b128 v[76:79], v4 offset:4096
    ds_read_b128 v[80:83], v3 offset:9216
    ds_read_b128 v[84:87], v8 offset:0
    ds_read_b128 v[88:91], v4 offset:5120
    ds_read_b128 v[92:95], v3 offset:10240
    ds_read_b128 v[96:99], v8 offset:1024
    ds_read_b128 v[100:103], v4 offset:6144
    ds_read_b128 v[104:107], v3 offset:11264
    ds_read_b128 v[124:127], v8 offset:2048
    ds_read_b128 v[128:131], v4 offset:7168
    ds_read_b128 v[132:135], v3 offset:12288
    ds_read_b128 v[136:139], v8 offset:3072
    ds_read_b128 v[140:143], v4 offset:8192
    ds_read_b128 v[144:147], v3 offset:13312
    s_waitcnt lgkmcnt(6)
    v_pk_add_f32 v[76:77], v[76:77], v[80:81]
    v_pk_add_f32 v[78:79], v[78:79], v[82:83]
    v_pk_add_f32 v[56:57], v[56:57], v[76:77]
    v_pk_add_f32 v[58:59], v[58:59], v[78:79]
    v_pk_add_f32 v[88:89], v[88:89], v[92:93]
    v_pk_add_f32 v[90:91], v[90:91], v[94:95]
    v_pk_add_f32 v[100:101], v[100:101], v[104:105]
    v_pk_add_f32 v[102:103], v[102:103], v[106:107]
    v_pk_add_f32 v[236:237], v[236:237], v[84:85]
    v_pk_add_f32 v[238:239], v[238:239], v[86:87]
    v_pk_add_f32 v[240:241], v[240:241], v[96:97]
    v_pk_add_f32 v[242:243], v[242:243], v[98:99]
    v_pk_add_f32 v[236:237], v[236:237], v[88:89]
    v_pk_add_f32 v[238:239], v[238:239], v[90:91]
    v_pk_add_f32 v[240:241], v[240:241], v[100:101]
    v_pk_add_f32 v[242:243], v[242:243], v[102:103]
    v_cvt_pk_bf16_f32 v204, v52, v53
    v_cvt_pk_bf16_f32 v205, v54, v55
    v_cvt_pk_bf16_f32 v206, v56, v57
    v_cvt_pk_bf16_f32 v207, v58, v59
    v_cvt_pk_bf16_f32 v208, v236, v237
    v_cvt_pk_bf16_f32 v209, v238, v239
    v_cvt_pk_bf16_f32 v210, v240, v241
    v_cvt_pk_bf16_f32 v211, v242, v243
    s_mov_b32 s62, s22
    v_permlane16_swap_b32 v204, v206
    v_permlane16_swap_b32 v205, v207
    v_permlane16_swap_b32 v208, v210
    v_permlane16_swap_b32 v209, v211
    s_mov_b64 vcc, s[64:65]
    s_nop 0
    v_cndmask_b32_dpp v212, v208, v204, vcc row_ror:8 row_mask:0xf bank_mask:0xf
    v_cndmask_b32_dpp v213, v209, v205, vcc row_ror:8 row_mask:0xf bank_mask:0xf
    v_cndmask_b32_dpp v214, v210, v206, vcc row_ror:8 row_mask:0xf bank_mask:0xf
    v_cndmask_b32_dpp v215, v211, v207, vcc row_ror:8 row_mask:0xf bank_mask:0xf
    s_mov_b64 vcc, s[66:67]
    buffer_store_dwordx4 v[212:215], v26, s[12:15], s62 offen sc0 sc1
    v_cndmask_b32_dpp v216, v208, v204, vcc row_ror:8 row_mask:0xf bank_mask:0xf
    v_cndmask_b32_dpp v217, v209, v205, vcc row_ror:8 row_mask:0xf bank_mask:0xf
    v_cndmask_b32_dpp v218, v210, v206, vcc row_ror:8 row_mask:0xf bank_mask:0xf
    v_cndmask_b32_dpp v219, v211, v207, vcc row_ror:8 row_mask:0xf bank_mask:0xf
    buffer_store_dwordx4 v[216:219], v27, s[12:15], s62 offen sc0 sc1
    s_waitcnt lgkmcnt(0)
    v_pk_add_f32 v[128:129], v[128:129], v[132:133]
    v_pk_add_f32 v[130:131], v[130:131], v[134:135]
    v_pk_add_f32 v[140:141], v[140:141], v[144:145]
    v_pk_add_f32 v[142:143], v[142:143], v[146:147]
    v_pk_add_f32 v[244:245], v[244:245], v[124:125]
    v_pk_add_f32 v[246:247], v[246:247], v[126:127]
    v_pk_add_f32 v[248:249], v[248:249], v[136:137]
    v_pk_add_f32 v[250:251], v[250:251], v[138:139]
    v_pk_add_f32 v[244:245], v[244:245], v[128:129]
    v_pk_add_f32 v[246:247], v[246:247], v[130:131]
    v_pk_add_f32 v[248:249], v[248:249], v[140:141]
    v_pk_add_f32 v[250:251], v[250:251], v[142:143]
    v_cvt_pk_bf16_f32 v60, v244, v245
    v_cvt_pk_bf16_f32 v61, v246, v247
    v_cvt_pk_bf16_f32 v62, v248, v249
    v_cvt_pk_bf16_f32 v63, v250, v251
    s_nop 1
    v_permlane16_swap_b32 v60, v62
    v_permlane16_swap_b32 v61, v63
    buffer_store_dwordx4 v[60:63], v9, s[12:15], s59 offen sc0 sc1
L_op_end:
    s_endpgm
L_code_end:
.section .rodata,"a"
.p2align 6
.amdhsa_kernel fused_kernel
  .amdhsa_next_free_vgpr 512
  .amdhsa_next_free_sgpr 102
  .amdhsa_accum_offset 256
  .amdhsa_group_segment_fixed_size 0
  .amdhsa_kernarg_size 104
  .amdhsa_user_sgpr_count 2
  .amdhsa_user_sgpr_kernarg_segment_ptr 1
  .amdhsa_system_sgpr_workgroup_id_x 1
.end_amdhsa_kernel
.p2align 6
.amdhsa_kernel op_kernel
  .amdhsa_next_free_vgpr 512
  .amdhsa_next_free_sgpr 102
  .amdhsa_accum_offset 256
  .amdhsa_group_segment_fixed_size 0
  .amdhsa_kernarg_size 104
  .amdhsa_user_sgpr_count 2
  .amdhsa_user_sgpr_kernarg_segment_ptr 1
  .amdhsa_system_sgpr_workgroup_id_x 1
.end_amdhsa_kernel
```

```asm
; @launch kernel=fused_kernel grid=(256,1,1) block=(256,1,1) lds=163840
; @launch kernel=op_kernel grid=(256,1,1) block=(256,1,1) lds=163840
.amdgcn_target "amdgcn-amd-amdhsa--gfx950"
.text
.globl fused_kernel
.p2align 8
.type fused_kernel,@function
fused_kernel:
    s_cmp_ge_u32 s2, 256
    s_cbranch_scc1 L_at_end
    s_and_b32 s3, s2, 7
    s_lshl_b32 s3, s3, 5
    s_lshr_b32 s36, s2, 6
    s_lshl_b32 s36, s36, 3
    s_or_b32 s3, s3, s36
    s_bfe_u32 s36, s2, 0x30003
    s_or_b32 s2, s3, s36
    s_load_dwordx8 s[36:43], s[0:1], 0
    s_load_dwordx8 s[56:63], s[0:1], 40
    s_load_dwordx2 s[44:45], s[0:1], 96
    s_load_dwordx2 s[84:85], s[0:1], 32
    s_load_dwordx2 s[86:87], s[0:1], 72
    s_getpc_b64 s[72:73]
L_pc0:
    v_lshlrev_b32 v105, 7, v0
    v_add_u32 v104, 0, v105
    v_min_u32 v104, L_code_end - L_pc0 - 4, v104
    v_mov_b32 v107, s73
    v_add_co_u32 v106, vcc, s72, v104
    v_addc_co_u32 v107, vcc, 0, v107, vcc
    global_load_dword v108, v[106:107], off
    v_add_u32 v104, 32768, v105
    v_min_u32 v104, L_code_end - L_pc0 - 4, v104
    v_mov_b32 v107, s73
    v_add_co_u32 v106, vcc, s72, v104
    v_addc_co_u32 v107, vcc, 0, v107, vcc
    global_load_dword v108, v[106:107], off
    v_add_u32 v104, 65536, v105
    v_min_u32 v104, L_code_end - L_pc0 - 4, v104
    v_mov_b32 v107, s73
    v_add_co_u32 v106, vcc, s72, v104
    v_addc_co_u32 v107, vcc, 0, v107, vcc
    global_load_dword v108, v[106:107], off
    v_and_b32 v1, 63, v0
    v_lshrrev_b32 v2, 6, v0
    s_nop 0
    v_readfirstlane_b32 s20, v2
    s_waitcnt lgkmcnt(0)
    s_and_b32 s48, s20, 1
    s_lshr_b32 s35, s20, 1
    s_cmp_ge_u32 s2, 128
    s_cselect_b32 s36, s56, s36
    s_cselect_b32 s37, s57, s37
    s_cselect_b32 s38, s58, s38
    s_cselect_b32 s39, s59, s39
    s_cselect_b32 s40, s60, s40
    s_cselect_b32 s41, s61, s41
    s_cselect_b32 s42, s62, s42
    s_cselect_b32 s43, s63, s43
    s_cselect_b32 s84, s86, s84
    s_cselect_b32 s85, s87, s85
    s_mov_b32 s86, 5242880
    s_mov_b32 s87, 0x20000
    s_and_b32 s28, s2, 127
    s_lshl_b32 s29, s28, 20
    s_lshl_b32 s30, s35, 18
    s_add_u32 s29, s29, s30
    s_add_u32 s38, s38, s29
    s_addc_u32 s39, s39, 0
    s_add_u32 s40, s40, s29
    s_addc_u32 s41, s41, 0
    s_sub_u32 s30, 0x100000, s30
    s_mov_b32 s8, s38
    s_mov_b32 s9, s39
    s_mov_b32 s10, s30
    s_mov_b32 s11, 0x20000
    s_cmp_eq_u32 s48, 0
    s_cselect_b32 s4, s38, s40
    s_cselect_b32 s5, s39, s41
    s_mov_b32 s6, s30
    s_mov_b32 s7, 0x20000
    s_cselect_b32 s16, s42, s36
    s_cselect_b32 s17, s43, s37
    s_mov_b32 s28, 5242880
    s_mov_b32 s29, 4587520
    s_cselect_b32 s18, s28, s29
    s_mov_b32 s19, 0x20000
    s_mov_b32 s28, 262144
    s_mov_b32 s29, 64
    s_cselect_b32 s51, s28, s29
    s_cselect_b32 s52, 512, 0
    s_mov_b32 s28, 81920
    s_cselect_b32 s46, 128, s28
    s_mov_b32 s28, 81920
    s_cselect_b32 s47, s28, 0x40000000
    s_mov_b32 s28, 90112
    s_cselect_b32 s98, s28, 0x40000000
    s_mov_b32 s28, 1056
    s_mov_b32 s29, 1024
    s_cselect_b32 s53, s28, s29
    s_mov_b32 s28, 0
    s_mov_b32 s29, 0
    s_cselect_b32 s88, s28, s29
    s_mov_b32 s28, 8192
    s_mov_b32 s29, 10240
    s_cselect_b32 s89, s28, s29
    s_mov_b32 s28, 16384
    s_mov_b32 s29, 20480
    s_cselect_b32 s90, s28, s29
    s_mov_b32 s28, 24576
    s_mov_b32 s29, 30720
    s_cselect_b32 s91, s28, s29
    s_mov_b32 s28, 65536
    s_mov_b32 s29, 40960
    s_cselect_b32 s92, s28, s29
    s_mov_b32 s28, 73728
    s_mov_b32 s29, 51200
    s_cselect_b32 s93, s28, s29
    s_mov_b32 s28, 81920
    s_mov_b32 s29, 61440
    s_cselect_b32 s94, s28, s29
    s_mov_b32 s28, 90112
    s_mov_b32 s29, 71680
    s_cselect_b32 s95, s28, s29
    s_and_b32 s28, s2, 7
    s_lshl_b32 s28, s28, 2
    s_add_u32 s28, s28, s35
    s_lshl_b32 s28, s28, 8
    s_bfe_u32 s29, s2, 262147
    s_lshl_b32 s29, s29, 1
    s_add_u32 s29, s29, s35
    s_mul_i32 s29, s29, 143360
    s_cmp_eq_u32 s48, 0
    s_cselect_b32 s55, s28, s29
    s_add_u32 s12, s44, 0
    s_addc_u32 s13, s45, 0
    s_mov_b32 s14, 127926272
    s_mov_b32 s15, 0x20000
    s_lshl_b32 s28, s2, 2
    s_add_u32 s28, s28, s35
    s_mul_i32 s24, s28, 57344
    s_mul_i32 s28, s48, 28672
    s_add_u32 s24, s24, s28
    s_add_u32 s24, s24, 58720256
    s_mov_b32 s23, -1
    s_mov_b32 s60, s42
    s_mov_b32 s61, s43
    s_mov_b32 s62, 5242880
    s_mov_b32 s63, 0x20000
    s_mov_b32 s27, 0
    s_mov_b32 s25, 0
    s_mov_b32 s68, 0
    s_mov_b32 s71, 0
    s_lshr_b32 s26, s2, 3
    s_lshr_b32 s28, s2, 1
    s_add_u32 s26, s26, s28
    s_and_b32 s26, s26, 3
    s_mul_i32 s26, s26, 5
    s_and_b32 s26, s26, 30
    s_mul_i32 s83, s51, 20
    s_and_b32 s69, s2, 1
    s_min_u32 s69, s69, 1
    s_bfe_u32 s3, s2, 0x10005
    s_xor_b32 s3, s3, 1
    s_and_b32 s69, s2, s3
    s_nop 0
    s_mov_b32 s70, s69
    s_mov_b32 s32, 0x4e800000
    s_mov_b32 s54, 0x3e0293ee
    s_lshl_b32 s28, s48, 1
    s_add_u32 s28, s28, s35
    s_mul_i32 s33, s28, 33792
    v_lshlrev_b32 v6, 4, v1
    v_lshrrev_b32 v2, 4, v1
    v_and_b32 v3, 15, v1
    v_lshlrev_b32 v4, 4, v3
    v_lshl_add_u32 v7, v2, 14, v4
    v_and_b32 v26, 7, v1
    v_lshlrev_b32 v26, 4, v26
    v_bfe_u32 v5, v1, 3, 1
    v_lshl_add_u32 v26, v5, 15, v26
    v_bfe_u32 v5, v1, 4, 1
    v_lshl_add_u32 v26, v5, 17, v26
    v_bfe_u32 v5, v1, 5, 1
    v_lshl_add_u32 v26, v5, 18, v26
    v_mul_u32_u24 v27, 1280, v3
    v_lshl_add_u32 v27, v2, 4, v27
    v_lshrrev_b32 v5, 3, v1
    v_and_b32 v27, 6, v5
    v_xor_b32 v27, v27, v1
    v_and_b32 v27, 7, v27
    v_lshlrev_b32 v27, 4, v27
    v_mul_u32_u24 v5, 1280, v5
    v_add_u32 v27, v27, v5
    s_cmp_eq_u32 s48, 0
    s_cselect_b64 vcc, -1, 0
    s_nop 1
    v_cndmask_b32 v26, v27, v26, vcc
    s_add_u32 s28, s48, 2
    s_mul_i32 s28, s28, 33792
    v_and_b32 v27, 6, v3
    v_xor_b32 v27, v27, v2
    v_lshlrev_b32 v27, 4, v27
    v_and_b32 v5, 7, v3
    v_lshl_add_u32 v27, v5, 7, v27
    v_lshrrev_b32 v5, 3, v3
    v_lshl_add_u32 v27, v5, 10, v27
    v_add_u32 v27, s28, v27
    v_lshl_add_u32 v10, v2, 8, v4
    v_and_b32 v4, 7, v3
    v_lshlrev_b32 v8, 10, v4
    v_and_b32 v5, 1, v3
    v_lshl_add_u32 v8, v5, 4, v8
    v_bfe_u32 v5, v3, 1, 2
    v_lshl_add_u32 v8, v5, 6, v8
    v_lshrrev_b32 v5, 3, v3
    v_lshl_add_u32 v8, v5, 8, v8
    v_bfe_u32 v5, v1, 4, 1
    v_lshl_add_u32 v8, v5, 5, v8
    v_bfe_u32 v5, v1, 5, 1
    v_lshl_add_u32 v8, v5, 4, v8
    s_mul_i32 s28, s35, 33792
    v_add_u32 v8, s28, v8
    v_bfe_u32 v3, v1, 2, 2
    v_bfe_u32 v5, v1, 4, 1
    v_lshl_add_u32 v4, v5, 2, v3
    v_mul_u32_u24 v4, 1056, v4
    v_bfe_u32 v5, v1, 5, 1
    v_lshl_add_u32 v4, v5, 8, v4
    v_and_b32 v5, 3, v1
    v_lshl_add_u32 v4, v5, 3, v4
    v_add_u32 v11, s28, v4
    v_lshl_add_u32 v3, v2, 2, v3
    v_and_b32 v4, 7, v3
    v_mul_u32_u24 v4, 1056, v4
    v_lshrrev_b32 v5, 3, v3
    v_lshl_add_u32 v4, v5, 8, v4
    v_and_b32 v5, 3, v1
    v_lshl_add_u32 v4, v5, 3, v4
    s_add_u32 s28, s28, 67584
    v_add_u32 v9, s28, v4
    v_mov_b32 v12, 0xff800000
    v_mov_b32 v14, 0xff800000
    v_mov_b32 v16, 0xff800000
    v_mov_b32 v18, 0xff800000
    v_mov_b32 v20, 0xff800000
    v_mov_b32 v22, 0xff800000
    v_mov_b32 v24, 0xff800000
    v_mov_b32 v2, 0x3f803f80
    v_accvgpr_write_b32 a252, v2
    v_accvgpr_write_b32 a253, v2
    v_accvgpr_write_b32 a254, v2
    v_accvgpr_write_b32 a255, v2
    v_and_b32 v2, 3, v1
    v_lshlrev_b32 v2, 2, v2
    v_add_u32 v2, 76000, v2
    v_mov_b32 v3, 0
    ds_write_b32 v2, v3
    s_cmp_eq_u32 s48, 0
    s_mov_b32 s28, 784
    s_mov_b32 s29, 800
    s_cselect_b32 s96, s28, s29
    s_mov_b32 s28, 816
    s_cselect_b32 s97, s28, s29
    v_lshrrev_b32 v2, 1, v1
    v_lshlrev_b32 v2, 13, v2
    v_and_b32 v3, 1, v1
    v_lshl_add_u32 v2, v3, 7, v2
    v_lshlrev_b32 v3, 7, v1
    s_bfe_u32 s28, s2, 0x20003
    s_lshl_b32 s28, s28, 18
    s_and_b32 s29, s2, 7
    s_mul_i32 s29, s29, 17920
    s_cmp_eq_u32 s48, 0
    s_cselect_b64 vcc, -1, 0
    s_cselect_b32 s100, s28, s29
    s_add_u32 s100, s100, s55
    s_cmp_eq_u32 s48, 0
    s_mov_b32 s28, 1048576
    s_mov_b32 s29, 8192
    s_cselect_b32 s99, s28, s29
    v_cndmask_b32 v6, v3, v2, vcc
    v_xor_b32 v6, 64, v27
    s_mul_i32 s100, s2, 11
    s_lshr_b32 s28, s2, 5
    s_mul_i32 s28, s28, 7
    s_add_u32 s100, s100, s28
    s_lshl_b32 s28, s35, 4
    s_add_u32 s100, s100, s28
    s_and_b32 s100, s100, 31
L_at_start:
    s_mov_b32 s21, s27
    s_lshl_b32 s34, s27, 5
    s_add_u32 s31, s21, s70
    s_mul_i32 s50, s31, s52
    s_mov_b32 s101, s31
    s_add_u32 s50, s50, s55
    s_cmp_ge_u32 s31, 2
    s_cselect_b32 s28, 0x40000000, 0
    s_add_u32 s50, s50, s28
    s_mov_b32 s82, s26
    s_mul_i32 s28, s26, s51
    s_add_u32 s50, s50, s28
    s_add_u32 m0, s33, 0
    s_mov_b32 s49, s50
    s_add_u32 s28, s49, s88
    buffer_load_dwordx4 v26, s[16:19], s28 offen lds
    s_add_u32 m0, m0, s53
    s_add_u32 s28, s49, s89
    buffer_load_dwordx4 v26, s[16:19], s28 offen lds
    s_add_u32 m0, m0, s53
    s_add_u32 s28, s49, s90
    buffer_load_dwordx4 v26, s[16:19], s28 offen lds
    s_add_u32 m0, m0, s53
    s_add_u32 s28, s49, s91
    buffer_load_dwordx4 v26, s[16:19], s28 offen lds
    s_add_u32 m0, m0, s53
    s_add_u32 s28, s49, s92
    buffer_load_dwordx4 v26, s[16:19], s28 offen lds
    s_add_u32 m0, m0, s53
    s_add_u32 s28, s49, s93
    buffer_load_dwordx4 v26, s[16:19], s28 offen lds
    s_add_u32 m0, m0, s53
    s_add_u32 s28, s49, s94
    buffer_load_dwordx4 v26, s[16:19], s28 offen lds
    s_add_u32 m0, m0, s53
    s_add_u32 s28, s49, s95
    buffer_load_dwordx4 v26, s[16:19], s28 offen lds
    s_add_u32 m0, s33, 8448
    s_add_u32 s49, s50, s46
    s_lshl1_add_u32 s50, s51, s50
    s_add_u32 s82, s82, 2
    s_cmp_eq_u32 s82, 20
    s_cselect_b32 s29, s83, 0
    s_sub_u32 s50, s50, s29
    s_add_u32 s28, s49, s88
    buffer_load_dwordx4 v26, s[16:19], s28 offen lds
    s_add_u32 m0, m0, s53
    s_add_u32 s28, s49, s89
    buffer_load_dwordx4 v26, s[16:19], s28 offen lds
    s_add_u32 m0, m0, s53
    s_add_u32 s28, s49, s90
    buffer_load_dwordx4 v26, s[16:19], s28 offen lds
    s_add_u32 m0, m0, s53
    s_add_u32 s28, s49, s91
    buffer_load_dwordx4 v26, s[16:19], s28 offen lds
    s_add_u32 m0, m0, s53
    s_add_u32 s28, s49, s92
    buffer_load_dwordx4 v26, s[16:19], s28 offen lds
    s_add_u32 m0, m0, s53
    s_add_u32 s28, s49, s93
    buffer_load_dwordx4 v26, s[16:19], s28 offen lds
    s_add_u32 m0, m0, s53
    s_add_u32 s28, s49, s47
    buffer_load_dwordx4 v26, s[16:19], s28 offen lds
    s_add_u32 m0, m0, s53
    s_add_u32 s28, s49, s98
    buffer_load_dwordx4 v26, s[16:19], s28 offen lds
    s_add_u32 m0, s33, 16896
    s_mov_b32 s49, s50
    s_add_u32 s28, s49, s88
    buffer_load_dwordx4 v26, s[16:19], s28 offen lds
    s_add_u32 m0, m0, s53
    s_add_u32 s28, s49, s89
    buffer_load_dwordx4 v26, s[16:19], s28 offen lds
    s_add_u32 m0, m0, s53
    s_add_u32 s28, s49, s90
    buffer_load_dwordx4 v26, s[16:19], s28 offen lds
    s_add_u32 m0, m0, s53
    s_add_u32 s28, s49, s91
    buffer_load_dwordx4 v26, s[16:19], s28 offen lds
    s_add_u32 m0, m0, s53
    s_add_u32 s28, s49, s92
    buffer_load_dwordx4 v26, s[16:19], s28 offen lds
    s_add_u32 m0, m0, s53
    s_add_u32 s28, s49, s93
    buffer_load_dwordx4 v26, s[16:19], s28 offen lds
    s_add_u32 m0, m0, s53
    s_add_u32 s28, s49, s94
    buffer_load_dwordx4 v26, s[16:19], s28 offen lds
    s_add_u32 m0, m0, s53
    s_add_u32 s28, s49, s95
    buffer_load_dwordx4 v26, s[16:19], s28 offen lds
    s_add_u32 m0, s33, 25344
    s_add_u32 s49, s50, s46
    s_lshl1_add_u32 s50, s51, s50
    s_add_u32 s82, s82, 2
    s_cmp_eq_u32 s82, 20
    s_cselect_b32 s29, s83, 0
    s_sub_u32 s50, s50, s29
    s_add_u32 s28, s49, s88
    buffer_load_dwordx4 v26, s[16:19], s28 offen lds
    s_add_u32 m0, m0, s53
    s_add_u32 s28, s49, s89
    buffer_load_dwordx4 v26, s[16:19], s28 offen lds
    s_add_u32 m0, m0, s53
    s_add_u32 s28, s49, s90
    buffer_load_dwordx4 v26, s[16:19], s28 offen lds
    s_add_u32 m0, m0, s53
    s_add_u32 s28, s49, s91
    buffer_load_dwordx4 v26, s[16:19], s28 offen lds
    s_add_u32 m0, m0, s53
    s_add_u32 s28, s49, s92
    buffer_load_dwordx4 v26, s[16:19], s28 offen lds
    s_add_u32 m0, m0, s53
    s_add_u32 s28, s49, s93
    buffer_load_dwordx4 v26, s[16:19], s28 offen lds
    s_add_u32 m0, m0, s53
    s_add_u32 s28, s49, s47
    buffer_load_dwordx4 v26, s[16:19], s28 offen lds
    s_add_u32 m0, m0, s53
    s_add_u32 s28, s49, s98
    buffer_load_dwordx4 v26, s[16:19], s28 offen lds
    s_waitcnt vmcnt(16) lgkmcnt(0)
    s_barrier
L_at_round:
    ds_read_b64_tr_b16 v[112:113], v11 offset:0
    ds_read_b64_tr_b16 v[114:115], v11 offset:128
    ds_read_b64_tr_b16 v[116:117], v11 offset:512
    ds_read_b64_tr_b16 v[118:119], v11 offset:640
    ds_read_b64_tr_b16 v[120:121], v11 offset:32
    ds_read_b64_tr_b16 v[122:123], v11 offset:160
    ds_read_b64_tr_b16 v[124:125], v11 offset:544
    ds_read_b64_tr_b16 v[126:127], v11 offset:672
    ds_read_b64_tr_b16 v[128:129], v11 offset:64
    ds_read_b64_tr_b16 v[130:131], v11 offset:192
    ds_read_b64_tr_b16 v[132:133], v11 offset:576
    ds_read_b64_tr_b16 v[134:135], v11 offset:704
    ds_read_b64_tr_b16 v[136:137], v11 offset:96
    ds_read_b64_tr_b16 v[138:139], v11 offset:224
    ds_read_b64_tr_b16 v[140:141], v11 offset:608
    ds_read_b64_tr_b16 v[142:143], v11 offset:736
    ds_read_b128 v[28:31], v27 offset:0
    ds_read_b128 v[32:35], v27 offset:2048
    ds_read_b128 v[36:39], v27 offset:4096
    ds_read_b128 v[40:43], v27 offset:6144
    ds_read_b128 v[44:47], v27 offset:8448
    ds_read_b128 v[48:51], v27 offset:10496
    ds_read_b128 v[52:55], v27 offset:12544
    ds_read_b128 v[56:59], v6 offset:0
    ds_read_b128 v[60:63], v6 offset:2048
    ds_read_b128 v[64:67], v6 offset:4096
    ds_read_b128 v[68:71], v6 offset:6144
    ds_read_b128 v[72:75], v6 offset:8448
    ds_read_b128 v[76:79], v6 offset:10496
    ds_read_b128 v[80:83], v6 offset:12544
    v_add_u32 v88, s88, v26
    v_add_u32 v89, s89, v26
    v_add_u32 v90, s90, v26
    v_add_u32 v91, s91, v26
    v_add_u32 v92, s92, v26
    v_add_u32 v93, s93, v26
    v_add_u32 v94, s94, v26
    v_add_u32 v95, s95, v26
    s_waitcnt lgkmcnt(0)
    v_mfma_f32_16x16x32_bf16 v[144:147], v[112:115], v[28:31], 0
    s_add_u32 m0, s33, 0
    v_mfma_f32_16x16x32_bf16 v[144:147], v[116:119], v[56:59], v[144:147]
    s_mov_b32 s49, s50
    v_mfma_f32_16x16x32_bf16 v[148:151], v[112:115], v[32:35], 0
    s_add_u32 s64, s16, s49
    v_mfma_f32_16x16x32_bf16 v[148:151], v[116:119], v[60:63], v[148:151]
    s_addc_u32 s65, s17, 0
    v_mfma_f32_16x16x32_bf16 v[152:155], v[112:115], v[36:39], 0
    v_mfma_f32_16x16x32_bf16 v[152:155], v[116:119], v[64:67], v[152:155]
    v_mfma_f32_16x16x32_bf16 v[156:159], v[112:115], v[40:43], 0
    s_cmp_eq_u32 s68, 0
    s_cbranch_scc0 L_bw1_458
    s_waitcnt vmcnt(16) lgkmcnt(0)
L_bw2_458:
    s_barrier
    s_cmp_le_u32 s21, s27
    s_cbranch_scc1 L_at_nofb_463
    s_sub_u32 s28, s21, 1
    s_cmp_eq_u32 s28, s23
    s_cbranch_scc1 L_at_nofb_463
    s_lshl_b32 s29, s28, 2
    s_add_u32 s29, s29, 76000
    v_mov_b32 v4, s29
    ds_read_b32 v4, v4
    s_waitcnt lgkmcnt(0)
    v_readfirstlane_b32 s29, v4
    s_nop 3
    s_cmp_lg_u32 s29, 0
    s_cbranch_scc1 L_at_fallback
L_at_nofb_463:
    v_mfma_f32_16x16x32_bf16 v[156:159], v[116:119], v[68:71], v[156:159]
    v_mfma_f32_16x16x32_bf16 v[160:163], v[112:115], v[44:47], 0
    v_mfma_f32_16x16x32_bf16 v[160:163], v[116:119], v[72:75], v[160:163]
    global_load_lds_dwordx4 v88, s[64:65]
    v_mfma_f32_16x16x32_bf16 v[164:167], v[112:115], v[48:51], 0
    s_add_u32 m0, m0, s53
    v_mfma_f32_16x16x32_bf16 v[164:167], v[116:119], v[76:79], v[164:167]
    v_mfma_f32_16x16x32_bf16 v[168:171], v[112:115], v[52:55], 0
    v_mfma_f32_16x16x32_bf16 v[168:171], v[116:119], v[80:83], v[168:171]
    ds_read_b64_tr_b16 v[112:113], v11 offset:8448
    v_mfma_f32_16x16x32_bf16 v[172:175], v[120:123], v[28:31], 0
    ds_read_b64_tr_b16 v[114:115], v11 offset:8576
    v_mfma_f32_16x16x32_bf16 v[172:175], v[124:127], v[56:59], v[172:175]
    global_load_lds_dwordx4 v89, s[64:65]
    v_mfma_f32_16x16x32_bf16 v[176:179], v[120:123], v[32:35], 0
    s_add_u32 m0, m0, s53
    ds_read_b64_tr_b16 v[116:117], v11 offset:8960
    v_mfma_f32_16x16x32_bf16 v[176:179], v[124:127], v[60:63], v[176:179]
    ds_read_b64_tr_b16 v[118:119], v11 offset:9088
    v_mfma_f32_16x16x32_bf16 v[180:183], v[120:123], v[36:39], 0
    v_mfma_f32_16x16x32_bf16 v[180:183], v[124:127], v[64:67], v[180:183]
    v_mfma_f32_16x16x32_bf16 v[184:187], v[120:123], v[40:43], 0
    v_mfma_f32_16x16x32_bf16 v[184:187], v[124:127], v[68:71], v[184:187]
    global_load_lds_dwordx4 v90, s[64:65]
    v_mfma_f32_16x16x32_bf16 v[188:191], v[120:123], v[44:47], 0
    s_add_u32 m0, m0, s53
    v_mfma_f32_16x16x32_bf16 v[188:191], v[124:127], v[72:75], v[188:191]
    v_mfma_f32_16x16x32_bf16 v[192:195], v[120:123], v[48:51], 0
    v_mfma_f32_16x16x32_bf16 v[192:195], v[124:127], v[76:79], v[192:195]
    v_mfma_f32_16x16x32_bf16 v[196:199], v[120:123], v[52:55], 0
    v_mfma_f32_16x16x32_bf16 v[196:199], v[124:127], v[80:83], v[196:199]
    global_load_lds_dwordx4 v91, s[64:65]
    v_mfma_f32_16x16x32_bf16 v[200:203], v[128:131], v[28:31], 0
    s_add_u32 m0, m0, s53
    ds_read_b64_tr_b16 v[120:121], v11 offset:8480
    v_mfma_f32_16x16x32_bf16 v[200:203], v[132:135], v[56:59], v[200:203]
    ds_read_b64_tr_b16 v[122:123], v11 offset:8608
    v_mfma_f32_16x16x32_bf16 v[204:207], v[128:131], v[32:35], 0
    ds_read_b64_tr_b16 v[124:125], v11 offset:8992
    v_mfma_f32_16x16x32_bf16 v[204:207], v[132:135], v[60:63], v[204:207]
    ds_read_b64_tr_b16 v[126:127], v11 offset:9120
    v_mfma_f32_16x16x32_bf16 v[208:211], v[128:131], v[36:39], 0
    v_mfma_f32_16x16x32_bf16 v[208:211], v[132:135], v[64:67], v[208:211]
    global_load_lds_dwordx4 v92, s[64:65]
    v_mfma_f32_16x16x32_bf16 v[212:215], v[128:131], v[40:43], 0
    s_add_u32 m0, m0, s53
    v_mfma_f32_16x16x32_bf16 v[212:215], v[132:135], v[68:71], v[212:215]
    v_mfma_f32_16x16x32_bf16 v[216:219], v[128:131], v[44:47], 0
    v_mfma_f32_16x16x32_bf16 v[216:219], v[132:135], v[72:75], v[216:219]
    v_mfma_f32_16x16x32_bf16 v[220:223], v[128:131], v[48:51], 0
    v_mfma_f32_16x16x32_bf16 v[220:223], v[132:135], v[76:79], v[220:223]
    global_load_lds_dwordx4 v93, s[64:65]
    v_mfma_f32_16x16x32_bf16 v[224:227], v[128:131], v[52:55], 0
    s_add_u32 m0, m0, s53
    v_mfma_f32_16x16x32_bf16 v[224:227], v[132:135], v[80:83], v[224:227]
    ds_read_b64_tr_b16 v[128:129], v11 offset:8512
    v_mfma_f32_16x16x32_bf16 v[228:231], v[136:139], v[28:31], 0
    ds_read_b64_tr_b16 v[130:131], v11 offset:8640
    v_mfma_f32_16x16x32_bf16 v[228:231], v[140:143], v[56:59], v[228:231]
    ds_read_b64_tr_b16 v[132:133], v11 offset:9024
    v_mfma_f32_16x16x32_bf16 v[232:235], v[136:139], v[32:35], 0
    ds_read_b64_tr_b16 v[134:135], v11 offset:9152
    v_mfma_f32_16x16x32_bf16 v[232:235], v[140:143], v[60:63], v[232:235]
    global_load_lds_dwordx4 v94, s[64:65]
    v_mfma_f32_16x16x32_bf16 v[236:239], v[136:139], v[36:39], 0
    s_add_u32 m0, m0, s53
    v_mfma_f32_16x16x32_bf16 v[236:239], v[140:143], v[64:67], v[236:239]
    v_mfma_f32_16x16x32_bf16 v[240:243], v[136:139], v[40:43], 0
    v_mfma_f32_16x16x32_bf16 v[240:243], v[140:143], v[68:71], v[240:243]
    v_mfma_f32_16x16x32_bf16 v[244:247], v[136:139], v[44:47], 0
    v_mfma_f32_16x16x32_bf16 v[244:247], v[140:143], v[72:75], v[244:247]
    global_load_lds_dwordx4 v95, s[64:65]
    v_mfma_f32_16x16x32_bf16 v[248:251], v[136:139], v[48:51], 0
    s_waitcnt lgkmcnt(4)
    v_mfma_f32_16x16x32_bf16 v[248:251], v[140:143], v[76:79], v[248:251]
    v_mfma_f32_16x16x32_bf16 v[252:255], v[136:139], v[52:55], 0
    ds_read_b64_tr_b16 v[136:137], v11 offset:8544
    ds_read_b64_tr_b16 v[138:139], v11 offset:8672
    v_mfma_f32_16x16x32_bf16 v[252:255], v[140:143], v[80:83], v[252:255]
    ds_read_b64_tr_b16 v[140:141], v11 offset:9056
    ds_read_b64_tr_b16 v[142:143], v11 offset:9184
    v_mfma_f32_16x16x32_bf16 a[112:115], v[112:115], v[28:31], 0
    s_add_u32 m0, s33, 8448
    v_mfma_f32_16x16x32_bf16 a[112:115], v[116:119], v[56:59], a[112:115]
    s_add_u32 s49, s50, s46
    v_mfma_f32_16x16x32_bf16 a[116:119], v[112:115], v[32:35], 0
    s_lshl1_add_u32 s50, s51, s50
    v_add_u32 v104, s49, v26
    v_mfma_f32_16x16x32_bf16 a[116:119], v[116:119], v[60:63], a[116:119]
    s_add_u32 s82, s82, 2
    v_mfma_f32_16x16x32_bf16 a[120:123], v[112:115], v[36:39], 0
    s_cmp_eq_u32 s82, 20
    v_mfma_f32_16x16x32_bf16 a[120:123], v[116:119], v[64:67], a[120:123]
    s_cselect_b32 s29, s83, 0
    v_mfma_f32_16x16x32_bf16 a[124:127], v[112:115], v[40:43], 0
    s_sub_u32 s50, s50, s29
    s_cmp_eq_u32 s68, 0
    s_cbranch_scc0 L_bw1_574
    s_waitcnt vmcnt(8) lgkmcnt(0)
L_bw2_574:
    s_barrier
    ds_read_b128 a[0:3], v27 offset:16896
    v_mfma_f32_16x16x32_bf16 a[124:127], v[116:119], v[68:71], a[124:127]
    s_add_u32 s64, s16, s49
    ds_read_b128 a[4:7], v27 offset:18944
    v_mfma_f32_16x16x32_bf16 a[128:131], v[112:115], v[44:47], 0
    s_addc_u32 s65, s17, 0
    ds_read_b128 a[8:11], v27 offset:20992
    v_mfma_f32_16x16x32_bf16 a[128:131], v[116:119], v[72:75], a[128:131]
    global_load_lds_dwordx4 v88, s[64:65]
    v_mfma_f32_16x16x32_bf16 a[132:135], v[112:115], v[48:51], 0
    s_add_u32 m0, m0, s53
    ds_read_b128 a[12:15], v27 offset:23040
    v_mfma_f32_16x16x32_bf16 a[132:135], v[116:119], v[76:79], a[132:135]
    ds_read_b128 a[16:19], v27 offset:25344
    v_mfma_f32_16x16x32_bf16 a[136:139], v[112:115], v[52:55], 0
    ds_read_b128 a[20:23], v27 offset:27392
    v_mfma_f32_16x16x32_bf16 a[136:139], v[116:119], v[80:83], a[136:139]
    ds_read_b128 a[24:27], v27 offset:29440
    v_mfma_f32_16x16x32_bf16 a[140:143], v[120:123], v[28:31], 0
    ds_read_b128 a[28:31], v6 offset:16896
    v_mfma_f32_16x16x32_bf16 a[140:143], v[124:127], v[56:59], a[140:143]
    global_load_lds_dwordx4 v89, s[64:65]
    v_mfma_f32_16x16x32_bf16 a[144:147], v[120:123], v[32:35], 0
    s_add_u32 m0, m0, s53
    ds_read_b128 a[32:35], v6 offset:18944
    v_mfma_f32_16x16x32_bf16 a[144:147], v[124:127], v[60:63], a[144:147]
    ds_read_b128 a[36:39], v6 offset:20992
    v_mfma_f32_16x16x32_bf16 a[148:151], v[120:123], v[36:39], 0
    ds_read_b128 a[40:43], v6 offset:23040
    v_mfma_f32_16x16x32_bf16 a[148:151], v[124:127], v[64:67], a[148:151]
    ds_read_b128 a[44:47], v6 offset:25344
    v_mfma_f32_16x16x32_bf16 a[152:155], v[120:123], v[40:43], 0
    ds_read_b128 a[48:51], v6 offset:27392
    v_mfma_f32_16x16x32_bf16 a[152:155], v[124:127], v[68:71], a[152:155]
    global_load_lds_dwordx4 v90, s[64:65]
    v_mfma_f32_16x16x32_bf16 a[156:159], v[120:123], v[44:47], 0
    s_add_u32 m0, m0, s53
    ds_read_b128 a[52:55], v6 offset:29440
    v_mfma_f32_16x16x32_bf16 a[156:159], v[124:127], v[72:75], a[156:159]
    ds_read_b64_tr_b16 v[112:113], v11 offset:16896
    v_mfma_f32_16x16x32_bf16 a[160:163], v[120:123], v[48:51], 0
    ds_read_b64_tr_b16 v[114:115], v11 offset:17024
    v_mfma_f32_16x16x32_bf16 a[160:163], v[124:127], v[76:79], a[160:163]
    ds_read_b64_tr_b16 v[116:117], v11 offset:17408
    v_mfma_f32_16x16x32_bf16 a[164:167], v[120:123], v[52:55], 0
    ds_read_b64_tr_b16 v[118:119], v11 offset:17536
    v_mfma_f32_16x16x32_bf16 a[164:167], v[124:127], v[80:83], a[164:167]
    global_load_lds_dwordx4 v91, s[64:65]
    v_mfma_f32_16x16x32_bf16 a[168:171], v[128:131], v[28:31], 0
    s_add_u32 m0, m0, s53
    ds_read_b64_tr_b16 v[120:121], v11 offset:16928
    v_mfma_f32_16x16x32_bf16 a[168:171], v[132:135], v[56:59], a[168:171]
    ds_read_b64_tr_b16 v[122:123], v11 offset:17056
    v_mfma_f32_16x16x32_bf16 a[172:175], v[128:131], v[32:35], 0
    ds_read_b64_tr_b16 v[124:125], v11 offset:17440
    v_mfma_f32_16x16x32_bf16 a[172:175], v[132:135], v[60:63], a[172:175]
    ds_read_b64_tr_b16 v[126:127], v11 offset:17568
    v_mfma_f32_16x16x32_bf16 a[176:179], v[128:131], v[36:39], 0
    v_mfma_f32_16x16x32_bf16 a[176:179], v[132:135], v[64:67], a[176:179]
    global_load_lds_dwordx4 v92, s[64:65]
    v_mfma_f32_16x16x32_bf16 a[180:183], v[128:131], v[40:43], 0
    s_add_u32 m0, m0, s53
    v_mfma_f32_16x16x32_bf16 a[180:183], v[132:135], v[68:71], a[180:183]
    v_mfma_f32_16x16x32_bf16 a[184:187], v[128:131], v[44:47], 0
    v_mfma_f32_16x16x32_bf16 a[184:187], v[132:135], v[72:75], a[184:187]
    v_mfma_f32_16x16x32_bf16 a[188:191], v[128:131], v[48:51], 0
    v_mfma_f32_16x16x32_bf16 a[188:191], v[132:135], v[76:79], a[188:191]
    global_load_lds_dwordx4 v93, s[64:65]
    v_mfma_f32_16x16x32_bf16 a[192:195], v[128:131], v[52:55], 0
    s_add_u32 m0, m0, s53
    v_mfma_f32_16x16x32_bf16 a[192:195], v[132:135], v[80:83], a[192:195]
    ds_read_b64_tr_b16 v[128:129], v11 offset:16960
    v_mfma_f32_16x16x32_bf16 a[196:199], v[136:139], v[28:31], 0
    ds_read_b64_tr_b16 v[130:131], v11 offset:17088
    v_mfma_f32_16x16x32_bf16 a[196:199], v[140:143], v[56:59], a[196:199]
    ds_read_b64_tr_b16 v[132:133], v11 offset:17472
    v_mfma_f32_16x16x32_bf16 a[200:203], v[136:139], v[32:35], 0
    ds_read_b64_tr_b16 v[134:135], v11 offset:17600
    v_mfma_f32_16x16x32_bf16 a[200:203], v[140:143], v[60:63], a[200:203]
    buffer_load_dwordx4 v104, s[16:19], s47 offen lds
    v_mfma_f32_16x16x32_bf16 a[204:207], v[136:139], v[36:39], 0
    s_add_u32 m0, m0, s53
    v_mfma_f32_16x16x32_bf16 a[204:207], v[140:143], v[64:67], a[204:207]
    v_mfma_f32_16x16x32_bf16 a[208:211], v[136:139], v[40:43], 0
    v_mfma_f32_16x16x32_bf16 a[208:211], v[140:143], v[68:71], a[208:211]
    v_mfma_f32_16x16x32_bf16 a[212:215], v[136:139], v[44:47], 0
    v_mfma_f32_16x16x32_bf16 a[212:215], v[140:143], v[72:75], a[212:215]
    buffer_load_dwordx4 v104, s[16:19], s98 offen lds
    v_mfma_f32_16x16x32_bf16 a[216:219], v[136:139], v[48:51], 0
    s_waitcnt lgkmcnt(4)
    v_mfma_f32_16x16x32_bf16 a[216:219], v[140:143], v[76:79], a[216:219]
    v_mfma_f32_16x16x32_bf16 a[220:223], v[136:139], v[52:55], 0
    ds_read_b64_tr_b16 v[136:137], v11 offset:16992
    ds_read_b64_tr_b16 v[138:139], v11 offset:17120
    v_mfma_f32_16x16x32_bf16 a[220:223], v[140:143], v[80:83], a[220:223]
    ds_read_b64_tr_b16 v[140:141], v11 offset:17504
    ds_read_b64_tr_b16 v[142:143], v11 offset:17632
    v_mfma_f32_16x16x32_bf16 v[144:147], v[112:115], a[0:3], v[144:147]
    s_add_u32 m0, s33, 16896
    v_mfma_f32_16x16x32_bf16 v[144:147], v[116:119], a[28:31], v[144:147]
    s_mov_b32 s49, s50
    v_mfma_f32_16x16x32_bf16 v[148:151], v[112:115], a[4:7], v[148:151]
    s_add_u32 s64, s16, s49
    v_mfma_f32_16x16x32_bf16 v[148:151], v[116:119], a[32:35], v[148:151]
    s_addc_u32 s65, s17, 0
    v_mfma_f32_16x16x32_bf16 v[152:155], v[112:115], a[8:11], v[152:155]
    v_mfma_f32_16x16x32_bf16 v[152:155], v[116:119], a[36:39], v[152:155]
    v_mfma_f32_16x16x32_bf16 v[156:159], v[112:115], a[12:15], v[156:159]
    s_cmp_eq_u32 s68, 0
    s_cbranch_scc0 L_bw1_687
    s_waitcnt vmcnt(16) lgkmcnt(0)
L_bw2_687:
    s_barrier
    v_mfma_f32_16x16x32_bf16 v[156:159], v[116:119], a[40:43], v[156:159]
    v_mfma_f32_16x16x32_bf16 v[160:163], v[112:115], a[16:19], v[160:163]
    v_mfma_f32_16x16x32_bf16 v[160:163], v[116:119], a[44:47], v[160:163]
    global_load_lds_dwordx4 v88, s[64:65]
    v_mfma_f32_16x16x32_bf16 v[164:167], v[112:115], a[20:23], v[164:167]
    s_add_u32 m0, m0, s53
    v_mfma_f32_16x16x32_bf16 v[164:167], v[116:119], a[48:51], v[164:167]
    v_mfma_f32_16x16x32_bf16 v[168:171], v[112:115], a[24:27], v[168:171]
    v_mfma_f32_16x16x32_bf16 v[168:171], v[116:119], a[52:55], v[168:171]
    ds_read_b64_tr_b16 v[112:113], v11 offset:25344
    v_mfma_f32_16x16x32_bf16 v[172:175], v[120:123], a[0:3], v[172:175]
    ds_read_b64_tr_b16 v[114:115], v11 offset:25472
    v_mfma_f32_16x16x32_bf16 v[172:175], v[124:127], a[28:31], v[172:175]
    global_load_lds_dwordx4 v89, s[64:65]
    v_mfma_f32_16x16x32_bf16 v[176:179], v[120:123], a[4:7], v[176:179]
    s_add_u32 m0, m0, s53
    ds_read_b64_tr_b16 v[116:117], v11 offset:25856
    v_mfma_f32_16x16x32_bf16 v[176:179], v[124:127], a[32:35], v[176:179]
    ds_read_b64_tr_b16 v[118:119], v11 offset:25984
    v_mfma_f32_16x16x32_bf16 v[180:183], v[120:123], a[8:11], v[180:183]
    v_mfma_f32_16x16x32_bf16 v[180:183], v[124:127], a[36:39], v[180:183]
    v_mfma_f32_16x16x32_bf16 v[184:187], v[120:123], a[12:15], v[184:187]
    v_mfma_f32_16x16x32_bf16 v[184:187], v[124:127], a[40:43], v[184:187]
    global_load_lds_dwordx4 v90, s[64:65]
    v_mfma_f32_16x16x32_bf16 v[188:191], v[120:123], a[16:19], v[188:191]
    s_add_u32 m0, m0, s53
    v_mfma_f32_16x16x32_bf16 v[188:191], v[124:127], a[44:47], v[188:191]
    v_mfma_f32_16x16x32_bf16 v[192:195], v[120:123], a[20:23], v[192:195]
    v_mfma_f32_16x16x32_bf16 v[192:195], v[124:127], a[48:51], v[192:195]
    v_mfma_f32_16x16x32_bf16 v[196:199], v[120:123], a[24:27], v[196:199]
    v_mfma_f32_16x16x32_bf16 v[196:199], v[124:127], a[52:55], v[196:199]
    global_load_lds_dwordx4 v91, s[64:65]
    v_mfma_f32_16x16x32_bf16 v[200:203], v[128:131], a[0:3], v[200:203]
    s_add_u32 m0, m0, s53
    ds_read_b64_tr_b16 v[120:121], v11 offset:25376
    v_mfma_f32_16x16x32_bf16 v[200:203], v[132:135], a[28:31], v[200:203]
    ds_read_b64_tr_b16 v[122:123], v11 offset:25504
    v_mfma_f32_16x16x32_bf16 v[204:207], v[128:131], a[4:7], v[204:207]
    ds_read_b64_tr_b16 v[124:125], v11 offset:25888
    v_mfma_f32_16x16x32_bf16 v[204:207], v[132:135], a[32:35], v[204:207]
    ds_read_b64_tr_b16 v[126:127], v11 offset:26016
    v_mfma_f32_16x16x32_bf16 v[208:211], v[128:131], a[8:11], v[208:211]
    v_mfma_f32_16x16x32_bf16 v[208:211], v[132:135], a[36:39], v[208:211]
    global_load_lds_dwordx4 v92, s[64:65]
    v_mfma_f32_16x16x32_bf16 v[212:215], v[128:131], a[12:15], v[212:215]
    s_add_u32 m0, m0, s53
    v_mfma_f32_16x16x32_bf16 v[212:215], v[132:135], a[40:43], v[212:215]
    v_mfma_f32_16x16x32_bf16 v[216:219], v[128:131], a[16:19], v[216:219]
    v_mfma_f32_16x16x32_bf16 v[216:219], v[132:135], a[44:47], v[216:219]
    v_mfma_f32_16x16x32_bf16 v[220:223], v[128:131], a[20:23], v[220:223]
    v_mfma_f32_16x16x32_bf16 v[220:223], v[132:135], a[48:51], v[220:223]
    global_load_lds_dwordx4 v93, s[64:65]
    v_mfma_f32_16x16x32_bf16 v[224:227], v[128:131], a[24:27], v[224:227]
    s_add_u32 m0, m0, s53
    v_mfma_f32_16x16x32_bf16 v[224:227], v[132:135], a[52:55], v[224:227]
    ds_read_b64_tr_b16 v[128:129], v11 offset:25408
    v_mfma_f32_16x16x32_bf16 v[228:231], v[136:139], a[0:3], v[228:231]
    ds_read_b64_tr_b16 v[130:131], v11 offset:25536
    v_mfma_f32_16x16x32_bf16 v[228:231], v[140:143], a[28:31], v[228:231]
    ds_read_b64_tr_b16 v[132:133], v11 offset:25920
    v_mfma_f32_16x16x32_bf16 v[232:235], v[136:139], a[4:7], v[232:235]
    ds_read_b64_tr_b16 v[134:135], v11 offset:26048
    v_mfma_f32_16x16x32_bf16 v[232:235], v[140:143], a[32:35], v[232:235]
    global_load_lds_dwordx4 v94, s[64:65]
    v_mfma_f32_16x16x32_bf16 v[236:239], v[136:139], a[8:11], v[236:239]
    s_add_u32 m0, m0, s53
    v_mfma_f32_16x16x32_bf16 v[236:239], v[140:143], a[36:39], v[236:239]
    v_mfma_f32_16x16x32_bf16 v[240:243], v[136:139], a[12:15], v[240:243]
    v_mfma_f32_16x16x32_bf16 v[240:243], v[140:143], a[40:43], v[240:243]
    v_mfma_f32_16x16x32_bf16 v[244:247], v[136:139], a[16:19], v[244:247]
    v_mfma_f32_16x16x32_bf16 v[244:247], v[140:143], a[44:47], v[244:247]
    global_load_lds_dwordx4 v95, s[64:65]
    v_mfma_f32_16x16x32_bf16 v[248:251], v[136:139], a[20:23], v[248:251]
    s_waitcnt lgkmcnt(4)
    v_mfma_f32_16x16x32_bf16 v[248:251], v[140:143], a[48:51], v[248:251]
    v_mfma_f32_16x16x32_bf16 v[252:255], v[136:139], a[24:27], v[252:255]
    ds_read_b64_tr_b16 v[136:137], v11 offset:25440
    ds_read_b64_tr_b16 v[138:139], v11 offset:25568
    v_mfma_f32_16x16x32_bf16 v[252:255], v[140:143], a[52:55], v[252:255]
    ds_read_b64_tr_b16 v[140:141], v11 offset:25952
    ds_read_b64_tr_b16 v[142:143], v11 offset:26080
    v_mfma_f32_16x16x32_bf16 a[112:115], v[112:115], a[0:3], a[112:115]
    s_add_u32 m0, s33, 25344
    v_mfma_f32_16x16x32_bf16 a[112:115], v[116:119], a[28:31], a[112:115]
    s_add_u32 s49, s50, s46
    v_mfma_f32_16x16x32_bf16 a[116:119], v[112:115], a[4:7], a[116:119]
    s_lshl1_add_u32 s50, s51, s50
    v_add_u32 v104, s49, v26
    v_mfma_f32_16x16x32_bf16 a[116:119], v[116:119], a[32:35], a[116:119]
    s_add_u32 s82, s82, 2
    v_mfma_f32_16x16x32_bf16 a[120:123], v[112:115], a[8:11], a[120:123]
    s_cmp_eq_u32 s82, 20
    v_mfma_f32_16x16x32_bf16 a[120:123], v[116:119], a[36:39], a[120:123]
    s_cselect_b32 s29, s83, 0
    v_mfma_f32_16x16x32_bf16 a[124:127], v[112:115], a[12:15], a[124:127]
    s_sub_u32 s50, s50, s29
    s_waitcnt vmcnt(8) lgkmcnt(0)
    s_barrier
    ds_read_b128 v[28:31], v27 offset:0
    v_mfma_f32_16x16x32_bf16 a[124:127], v[116:119], a[40:43], a[124:127]
    s_add_u32 s64, s16, s49
    ds_read_b128 v[32:35], v27 offset:2048
    v_mfma_f32_16x16x32_bf16 a[128:131], v[112:115], a[16:19], a[128:131]
    s_addc_u32 s65, s17, 0
    ds_read_b128 v[36:39], v27 offset:4096
    v_mfma_f32_16x16x32_bf16 a[128:131], v[116:119], a[44:47], a[128:131]
    global_load_lds_dwordx4 v88, s[64:65]
    v_mfma_f32_16x16x32_bf16 a[132:135], v[112:115], a[20:23], a[132:135]
    s_add_u32 m0, m0, s53
    ds_read_b128 v[40:43], v27 offset:6144
    v_mfma_f32_16x16x32_bf16 a[132:135], v[116:119], a[48:51], a[132:135]
    ds_read_b128 v[44:47], v27 offset:8448
    v_mfma_f32_16x16x32_bf16 a[136:139], v[112:115], a[24:27], a[136:139]
    ds_read_b128 v[48:51], v27 offset:10496
    v_mfma_f32_16x16x32_bf16 a[136:139], v[116:119], a[52:55], a[136:139]
    ds_read_b128 v[52:55], v27 offset:12544
    v_mfma_f32_16x16x32_bf16 a[140:143], v[120:123], a[0:3], a[140:143]
    ds_read_b128 v[56:59], v6 offset:0
    v_mfma_f32_16x16x32_bf16 a[140:143], v[124:127], a[28:31], a[140:143]
    global_load_lds_dwordx4 v89, s[64:65]
    v_mfma_f32_16x16x32_bf16 a[144:147], v[120:123], a[4:7], a[144:147]
    s_add_u32 m0, m0, s53
    ds_read_b128 v[60:63], v6 offset:2048
    v_mfma_f32_16x16x32_bf16 a[144:147], v[124:127], a[32:35], a[144:147]
    ds_read_b128 v[64:67], v6 offset:4096
    v_mfma_f32_16x16x32_bf16 a[148:151], v[120:123], a[8:11], a[148:151]
    ds_read_b128 v[68:71], v6 offset:6144
    v_mfma_f32_16x16x32_bf16 a[148:151], v[124:127], a[36:39], a[148:151]
    ds_read_b128 v[72:75], v6 offset:8448
    v_mfma_f32_16x16x32_bf16 a[152:155], v[120:123], a[12:15], a[152:155]
    ds_read_b128 v[76:79], v6 offset:10496
    v_mfma_f32_16x16x32_bf16 a[152:155], v[124:127], a[40:43], a[152:155]
    global_load_lds_dwordx4 v90, s[64:65]
    v_mfma_f32_16x16x32_bf16 a[156:159], v[120:123], a[16:19], a[156:159]
    s_add_u32 m0, m0, s53
    ds_read_b128 v[80:83], v6 offset:12544
    v_mfma_f32_16x16x32_bf16 a[156:159], v[124:127], a[44:47], a[156:159]
    ds_read_b64_tr_b16 v[112:113], v11 offset:0
    v_mfma_f32_16x16x32_bf16 a[160:163], v[120:123], a[20:23], a[160:163]
    ds_read_b64_tr_b16 v[114:115], v11 offset:128
    v_mfma_f32_16x16x32_bf16 a[160:163], v[124:127], a[48:51], a[160:163]
    ds_read_b64_tr_b16 v[116:117], v11 offset:512
    v_mfma_f32_16x16x32_bf16 a[164:167], v[120:123], a[24:27], a[164:167]
    ds_read_b64_tr_b16 v[118:119], v11 offset:640
    v_mfma_f32_16x16x32_bf16 a[164:167], v[124:127], a[52:55], a[164:167]
    global_load_lds_dwordx4 v91, s[64:65]
    v_mfma_f32_16x16x32_bf16 a[168:171], v[128:131], a[0:3], a[168:171]
    s_add_u32 m0, m0, s53
    ds_read_b64_tr_b16 v[120:121], v11 offset:32
    v_mfma_f32_16x16x32_bf16 a[168:171], v[132:135], a[28:31], a[168:171]
    ds_read_b64_tr_b16 v[122:123], v11 offset:160
    v_mfma_f32_16x16x32_bf16 a[172:175], v[128:131], a[4:7], a[172:175]
    ds_read_b64_tr_b16 v[124:125], v11 offset:544
    v_mfma_f32_16x16x32_bf16 a[172:175], v[132:135], a[32:35], a[172:175]
    ds_read_b64_tr_b16 v[126:127], v11 offset:672
    v_mfma_f32_16x16x32_bf16 a[176:179], v[128:131], a[8:11], a[176:179]
    v_mfma_f32_16x16x32_bf16 a[176:179], v[132:135], a[36:39], a[176:179]
    global_load_lds_dwordx4 v92, s[64:65]
    v_mfma_f32_16x16x32_bf16 a[180:183], v[128:131], a[12:15], a[180:183]
    s_add_u32 m0, m0, s53
    v_mfma_f32_16x16x32_bf16 a[180:183], v[132:135], a[40:43], a[180:183]
    v_mfma_f32_16x16x32_bf16 a[184:187], v[128:131], a[16:19], a[184:187]
    v_mfma_f32_16x16x32_bf16 a[184:187], v[132:135], a[44:47], a[184:187]
    v_mfma_f32_16x16x32_bf16 a[188:191], v[128:131], a[20:23], a[188:191]
    v_mfma_f32_16x16x32_bf16 a[188:191], v[132:135], a[48:51], a[188:191]
    global_load_lds_dwordx4 v93, s[64:65]
    v_mfma_f32_16x16x32_bf16 a[192:195], v[128:131], a[24:27], a[192:195]
    s_add_u32 m0, m0, s53
    v_mfma_f32_16x16x32_bf16 a[192:195], v[132:135], a[52:55], a[192:195]
    ds_read_b64_tr_b16 v[128:129], v11 offset:64
    v_mfma_f32_16x16x32_bf16 a[196:199], v[136:139], a[0:3], a[196:199]
    ds_read_b64_tr_b16 v[130:131], v11 offset:192
    v_mfma_f32_16x16x32_bf16 a[196:199], v[140:143], a[28:31], a[196:199]
    ds_read_b64_tr_b16 v[132:133], v11 offset:576
    v_mfma_f32_16x16x32_bf16 a[200:203], v[136:139], a[4:7], a[200:203]
    ds_read_b64_tr_b16 v[134:135], v11 offset:704
    v_mfma_f32_16x16x32_bf16 a[200:203], v[140:143], a[32:35], a[200:203]
    buffer_load_dwordx4 v104, s[16:19], s47 offen lds
    v_mfma_f32_16x16x32_bf16 a[204:207], v[136:139], a[8:11], a[204:207]
    s_add_u32 m0, m0, s53
    v_mfma_f32_16x16x32_bf16 a[204:207], v[140:143], a[36:39], a[204:207]
    v_mfma_f32_16x16x32_bf16 a[208:211], v[136:139], a[12:15], a[208:211]
    v_mfma_f32_16x16x32_bf16 a[208:211], v[140:143], a[40:43], a[208:211]
    v_mfma_f32_16x16x32_bf16 a[212:215], v[136:139], a[16:19], a[212:215]
    v_mfma_f32_16x16x32_bf16 a[212:215], v[140:143], a[44:47], a[212:215]
    buffer_load_dwordx4 v104, s[16:19], s98 offen lds
    v_mfma_f32_16x16x32_bf16 a[216:219], v[136:139], a[20:23], a[216:219]
    s_waitcnt lgkmcnt(4)
    v_mfma_f32_16x16x32_bf16 a[216:219], v[140:143], a[48:51], a[216:219]
    v_mfma_f32_16x16x32_bf16 a[220:223], v[136:139], a[24:27], a[220:223]
    ds_read_b64_tr_b16 v[136:137], v11 offset:96
    ds_read_b64_tr_b16 v[138:139], v11 offset:224
    v_mfma_f32_16x16x32_bf16 a[220:223], v[140:143], a[52:55], a[220:223]
    ds_read_b64_tr_b16 v[140:141], v11 offset:608
    ds_read_b64_tr_b16 v[142:143], v11 offset:736
    s_mov_b32 s22, 0
L_at_qploop:
    v_mfma_f32_16x16x32_bf16 v[144:147], v[112:115], v[28:31], v[144:147]
    s_add_u32 m0, s33, 0
    v_mfma_f32_16x16x32_bf16 v[144:147], v[116:119], v[56:59], v[144:147]
    s_mov_b32 s49, s50
    v_mfma_f32_16x16x32_bf16 v[148:151], v[112:115], v[32:35], v[148:151]
    s_add_u32 s64, s16, s49
    v_mfma_f32_16x16x32_bf16 v[148:151], v[116:119], v[60:63], v[148:151]
    s_addc_u32 s65, s17, 0
    v_mfma_f32_16x16x32_bf16 v[152:155], v[112:115], v[36:39], v[152:155]
    v_mfma_f32_16x16x32_bf16 v[152:155], v[116:119], v[64:67], v[152:155]
    v_mfma_f32_16x16x32_bf16 v[156:159], v[112:115], v[40:43], v[156:159]
    s_waitcnt vmcnt(16) lgkmcnt(0)
    s_barrier
    v_mfma_f32_16x16x32_bf16 v[156:159], v[116:119], v[68:71], v[156:159]
    v_mfma_f32_16x16x32_bf16 v[160:163], v[112:115], v[44:47], v[160:163]
    v_mfma_f32_16x16x32_bf16 v[160:163], v[116:119], v[72:75], v[160:163]
    global_load_lds_dwordx4 v88, s[64:65]
    v_mfma_f32_16x16x32_bf16 v[164:167], v[112:115], v[48:51], v[164:167]
    s_add_u32 m0, m0, s53
    v_mfma_f32_16x16x32_bf16 v[164:167], v[116:119], v[76:79], v[164:167]
    v_mfma_f32_16x16x32_bf16 v[168:171], v[112:115], v[52:55], v[168:171]
    v_mfma_f32_16x16x32_bf16 v[168:171], v[116:119], v[80:83], v[168:171]
    ds_read_b64_tr_b16 v[112:113], v11 offset:8448
    v_mfma_f32_16x16x32_bf16 v[172:175], v[120:123], v[28:31], v[172:175]
    ds_read_b64_tr_b16 v[114:115], v11 offset:8576
    v_mfma_f32_16x16x32_bf16 v[172:175], v[124:127], v[56:59], v[172:175]
    global_load_lds_dwordx4 v89, s[64:65]
    v_mfma_f32_16x16x32_bf16 v[176:179], v[120:123], v[32:35], v[176:179]
    s_add_u32 m0, m0, s53
    ds_read_b64_tr_b16 v[116:117], v11 offset:8960
    v_mfma_f32_16x16x32_bf16 v[176:179], v[124:127], v[60:63], v[176:179]
    ds_read_b64_tr_b16 v[118:119], v11 offset:9088
    v_mfma_f32_16x16x32_bf16 v[180:183], v[120:123], v[36:39], v[180:183]
    v_mfma_f32_16x16x32_bf16 v[180:183], v[124:127], v[64:67], v[180:183]
    v_mfma_f32_16x16x32_bf16 v[184:187], v[120:123], v[40:43], v[184:187]
    v_mfma_f32_16x16x32_bf16 v[184:187], v[124:127], v[68:71], v[184:187]
    global_load_lds_dwordx4 v90, s[64:65]
    v_mfma_f32_16x16x32_bf16 v[188:191], v[120:123], v[44:47], v[188:191]
    s_add_u32 m0, m0, s53
    v_mfma_f32_16x16x32_bf16 v[188:191], v[124:127], v[72:75], v[188:191]
    v_mfma_f32_16x16x32_bf16 v[192:195], v[120:123], v[48:51], v[192:195]
    v_mfma_f32_16x16x32_bf16 v[192:195], v[124:127], v[76:79], v[192:195]
    v_mfma_f32_16x16x32_bf16 v[196:199], v[120:123], v[52:55], v[196:199]
    v_mfma_f32_16x16x32_bf16 v[196:199], v[124:127], v[80:83], v[196:199]
    global_load_lds_dwordx4 v91, s[64:65]
    v_mfma_f32_16x16x32_bf16 v[200:203], v[128:131], v[28:31], v[200:203]
    s_add_u32 m0, m0, s53
    ds_read_b64_tr_b16 v[120:121], v11 offset:8480
    v_mfma_f32_16x16x32_bf16 v[200:203], v[132:135], v[56:59], v[200:203]
    ds_read_b64_tr_b16 v[122:123], v11 offset:8608
    v_mfma_f32_16x16x32_bf16 v[204:207], v[128:131], v[32:35], v[204:207]
    ds_read_b64_tr_b16 v[124:125], v11 offset:8992
    v_mfma_f32_16x16x32_bf16 v[204:207], v[132:135], v[60:63], v[204:207]
    ds_read_b64_tr_b16 v[126:127], v11 offset:9120
    v_mfma_f32_16x16x32_bf16 v[208:211], v[128:131], v[36:39], v[208:211]
    v_mfma_f32_16x16x32_bf16 v[208:211], v[132:135], v[64:67], v[208:211]
    global_load_lds_dwordx4 v92, s[64:65]
    v_mfma_f32_16x16x32_bf16 v[212:215], v[128:131], v[40:43], v[212:215]
    s_add_u32 m0, m0, s53
    v_mfma_f32_16x16x32_bf16 v[212:215], v[132:135], v[68:71], v[212:215]
    v_mfma_f32_16x16x32_bf16 v[216:219], v[128:131], v[44:47], v[216:219]
    v_mfma_f32_16x16x32_bf16 v[216:219], v[132:135], v[72:75], v[216:219]
    v_mfma_f32_16x16x32_bf16 v[220:223], v[128:131], v[48:51], v[220:223]
    v_mfma_f32_16x16x32_bf16 v[220:223], v[132:135], v[76:79], v[220:223]
    global_load_lds_dwordx4 v93, s[64:65]
    v_mfma_f32_16x16x32_bf16 v[224:227], v[128:131], v[52:55], v[224:227]
    s_add_u32 m0, m0, s53
    v_mfma_f32_16x16x32_bf16 v[224:227], v[132:135], v[80:83], v[224:227]
    ds_read_b64_tr_b16 v[128:129], v11 offset:8512
    v_mfma_f32_16x16x32_bf16 v[228:231], v[136:139], v[28:31], v[228:231]
    ds_read_b64_tr_b16 v[130:131], v11 offset:8640
    v_mfma_f32_16x16x32_bf16 v[228:231], v[140:143], v[56:59], v[228:231]
    ds_read_b64_tr_b16 v[132:133], v11 offset:9024
    v_mfma_f32_16x16x32_bf16 v[232:235], v[136:139], v[32:35], v[232:235]
    ds_read_b64_tr_b16 v[134:135], v11 offset:9152
    v_mfma_f32_16x16x32_bf16 v[232:235], v[140:143], v[60:63], v[232:235]
    global_load_lds_dwordx4 v94, s[64:65]
    v_mfma_f32_16x16x32_bf16 v[236:239], v[136:139], v[36:39], v[236:239]
    s_add_u32 m0, m0, s53
    v_mfma_f32_16x16x32_bf16 v[236:239], v[140:143], v[64:67], v[236:239]
    v_mfma_f32_16x16x32_bf16 v[240:243], v[136:139], v[40:43], v[240:243]
    v_mfma_f32_16x16x32_bf16 v[240:243], v[140:143], v[68:71], v[240:243]
    v_mfma_f32_16x16x32_bf16 v[244:247], v[136:139], v[44:47], v[244:247]
    v_mfma_f32_16x16x32_bf16 v[244:247], v[140:143], v[72:75], v[244:247]
    global_load_lds_dwordx4 v95, s[64:65]
    v_mfma_f32_16x16x32_bf16 v[248:251], v[136:139], v[48:51], v[248:251]
    s_waitcnt lgkmcnt(4)
    v_mfma_f32_16x16x32_bf16 v[248:251], v[140:143], v[76:79], v[248:251]
    v_mfma_f32_16x16x32_bf16 v[252:255], v[136:139], v[52:55], v[252:255]
    ds_read_b64_tr_b16 v[136:137], v11 offset:8544
    ds_read_b64_tr_b16 v[138:139], v11 offset:8672
    v_mfma_f32_16x16x32_bf16 v[252:255], v[140:143], v[80:83], v[252:255]
    ds_read_b64_tr_b16 v[140:141], v11 offset:9056
    ds_read_b64_tr_b16 v[142:143], v11 offset:9184
    v_mfma_f32_16x16x32_bf16 a[112:115], v[112:115], v[28:31], a[112:115]
    s_add_u32 m0, s33, 8448
    v_mfma_f32_16x16x32_bf16 a[112:115], v[116:119], v[56:59], a[112:115]
    s_add_u32 s49, s50, s46
    v_mfma_f32_16x16x32_bf16 a[116:119], v[112:115], v[32:35], a[116:119]
    s_lshl1_add_u32 s50, s51, s50
    v_add_u32 v104, s49, v26
    v_mfma_f32_16x16x32_bf16 a[116:119], v[116:119], v[60:63], a[116:119]
    s_add_u32 s82, s82, 2
    v_mfma_f32_16x16x32_bf16 a[120:123], v[112:115], v[36:39], a[120:123]
    s_cmp_eq_u32 s82, 20
    v_mfma_f32_16x16x32_bf16 a[120:123], v[116:119], v[64:67], a[120:123]
    s_cselect_b32 s29, s83, 0
    v_mfma_f32_16x16x32_bf16 a[124:127], v[112:115], v[40:43], a[124:127]
    s_sub_u32 s50, s50, s29
    s_waitcnt vmcnt(8) lgkmcnt(0)
    s_barrier
    ds_read_b128 a[0:3], v27 offset:16896
    v_mfma_f32_16x16x32_bf16 a[124:127], v[116:119], v[68:71], a[124:127]
    s_add_u32 s64, s16, s49
    ds_read_b128 a[4:7], v27 offset:18944
    v_mfma_f32_16x16x32_bf16 a[128:131], v[112:115], v[44:47], a[128:131]
    s_addc_u32 s65, s17, 0
    ds_read_b128 a[8:11], v27 offset:20992
    v_mfma_f32_16x16x32_bf16 a[128:131], v[116:119], v[72:75], a[128:131]
    global_load_lds_dwordx4 v88, s[64:65]
    v_mfma_f32_16x16x32_bf16 a[132:135], v[112:115], v[48:51], a[132:135]
    s_add_u32 m0, m0, s53
    ds_read_b128 a[12:15], v27 offset:23040
    v_mfma_f32_16x16x32_bf16 a[132:135], v[116:119], v[76:79], a[132:135]
    ds_read_b128 a[16:19], v27 offset:25344
    v_mfma_f32_16x16x32_bf16 a[136:139], v[112:115], v[52:55], a[136:139]
    ds_read_b128 a[20:23], v27 offset:27392
    v_mfma_f32_16x16x32_bf16 a[136:139], v[116:119], v[80:83], a[136:139]
    ds_read_b128 a[24:27], v27 offset:29440
    v_mfma_f32_16x16x32_bf16 a[140:143], v[120:123], v[28:31], a[140:143]
    ds_read_b128 a[28:31], v6 offset:16896
    v_mfma_f32_16x16x32_bf16 a[140:143], v[124:127], v[56:59], a[140:143]
    global_load_lds_dwordx4 v89, s[64:65]
    v_mfma_f32_16x16x32_bf16 a[144:147], v[120:123], v[32:35], a[144:147]
    s_add_u32 m0, m0, s53
    ds_read_b128 a[32:35], v6 offset:18944
    v_mfma_f32_16x16x32_bf16 a[144:147], v[124:127], v[60:63], a[144:147]
    ds_read_b128 a[36:39], v6 offset:20992
    v_mfma_f32_16x16x32_bf16 a[148:151], v[120:123], v[36:39], a[148:151]
    ds_read_b128 a[40:43], v6 offset:23040
    v_mfma_f32_16x16x32_bf16 a[148:151], v[124:127], v[64:67], a[148:151]
    ds_read_b128 a[44:47], v6 offset:25344
    v_mfma_f32_16x16x32_bf16 a[152:155], v[120:123], v[40:43], a[152:155]
    ds_read_b128 a[48:51], v6 offset:27392
    v_mfma_f32_16x16x32_bf16 a[152:155], v[124:127], v[68:71], a[152:155]
    global_load_lds_dwordx4 v90, s[64:65]
    v_mfma_f32_16x16x32_bf16 a[156:159], v[120:123], v[44:47], a[156:159]
    s_add_u32 m0, m0, s53
    ds_read_b128 a[52:55], v6 offset:29440
    v_mfma_f32_16x16x32_bf16 a[156:159], v[124:127], v[72:75], a[156:159]
    ds_read_b64_tr_b16 v[112:113], v11 offset:16896
    v_mfma_f32_16x16x32_bf16 a[160:163], v[120:123], v[48:51], a[160:163]
    ds_read_b64_tr_b16 v[114:115], v11 offset:17024
    v_mfma_f32_16x16x32_bf16 a[160:163], v[124:127], v[76:79], a[160:163]
    ds_read_b64_tr_b16 v[116:117], v11 offset:17408
    v_mfma_f32_16x16x32_bf16 a[164:167], v[120:123], v[52:55], a[164:167]
    ds_read_b64_tr_b16 v[118:119], v11 offset:17536
    v_mfma_f32_16x16x32_bf16 a[164:167], v[124:127], v[80:83], a[164:167]
    global_load_lds_dwordx4 v91, s[64:65]
    v_mfma_f32_16x16x32_bf16 a[168:171], v[128:131], v[28:31], a[168:171]
    s_add_u32 m0, m0, s53
    ds_read_b64_tr_b16 v[120:121], v11 offset:16928
    v_mfma_f32_16x16x32_bf16 a[168:171], v[132:135], v[56:59], a[168:171]
    ds_read_b64_tr_b16 v[122:123], v11 offset:17056
    v_mfma_f32_16x16x32_bf16 a[172:175], v[128:131], v[32:35], a[172:175]
    ds_read_b64_tr_b16 v[124:125], v11 offset:17440
    v_mfma_f32_16x16x32_bf16 a[172:175], v[132:135], v[60:63], a[172:175]
    ds_read_b64_tr_b16 v[126:127], v11 offset:17568
    v_mfma_f32_16x16x32_bf16 a[176:179], v[128:131], v[36:39], a[176:179]
    v_mfma_f32_16x16x32_bf16 a[176:179], v[132:135], v[64:67], a[176:179]
    global_load_lds_dwordx4 v92, s[64:65]
    v_mfma_f32_16x16x32_bf16 a[180:183], v[128:131], v[40:43], a[180:183]
    s_add_u32 m0, m0, s53
    v_mfma_f32_16x16x32_bf16 a[180:183], v[132:135], v[68:71], a[180:183]
    v_mfma_f32_16x16x32_bf16 a[184:187], v[128:131], v[44:47], a[184:187]
    v_mfma_f32_16x16x32_bf16 a[184:187], v[132:135], v[72:75], a[184:187]
    v_mfma_f32_16x16x32_bf16 a[188:191], v[128:131], v[48:51], a[188:191]
    v_mfma_f32_16x16x32_bf16 a[188:191], v[132:135], v[76:79], a[188:191]
    global_load_lds_dwordx4 v93, s[64:65]
    v_mfma_f32_16x16x32_bf16 a[192:195], v[128:131], v[52:55], a[192:195]
    s_add_u32 m0, m0, s53
    v_mfma_f32_16x16x32_bf16 a[192:195], v[132:135], v[80:83], a[192:195]
    ds_read_b64_tr_b16 v[128:129], v11 offset:16960
    v_mfma_f32_16x16x32_bf16 a[196:199], v[136:139], v[28:31], a[196:199]
    ds_read_b64_tr_b16 v[130:131], v11 offset:17088
    v_mfma_f32_16x16x32_bf16 a[196:199], v[140:143], v[56:59], a[196:199]
    ds_read_b64_tr_b16 v[132:133], v11 offset:17472
    v_mfma_f32_16x16x32_bf16 a[200:203], v[136:139], v[32:35], a[200:203]
    ds_read_b64_tr_b16 v[134:135], v11 offset:17600
    v_mfma_f32_16x16x32_bf16 a[200:203], v[140:143], v[60:63], a[200:203]
    buffer_load_dwordx4 v104, s[16:19], s47 offen lds
    v_mfma_f32_16x16x32_bf16 a[204:207], v[136:139], v[36:39], a[204:207]
    s_add_u32 m0, m0, s53
    v_mfma_f32_16x16x32_bf16 a[204:207], v[140:143], v[64:67], a[204:207]
    v_mfma_f32_16x16x32_bf16 a[208:211], v[136:139], v[40:43], a[208:211]
    v_mfma_f32_16x16x32_bf16 a[208:211], v[140:143], v[68:71], a[208:211]
    v_mfma_f32_16x16x32_bf16 a[212:215], v[136:139], v[44:47], a[212:215]
    v_mfma_f32_16x16x32_bf16 a[212:215], v[140:143], v[72:75], a[212:215]
    buffer_load_dwordx4 v104, s[16:19], s98 offen lds
    v_mfma_f32_16x16x32_bf16 a[216:219], v[136:139], v[48:51], a[216:219]
    s_waitcnt lgkmcnt(4)
    v_mfma_f32_16x16x32_bf16 a[216:219], v[140:143], v[76:79], a[216:219]
    v_mfma_f32_16x16x32_bf16 a[220:223], v[136:139], v[52:55], a[220:223]
    ds_read_b64_tr_b16 v[136:137], v11 offset:16992
    ds_read_b64_tr_b16 v[138:139], v11 offset:17120
    v_mfma_f32_16x16x32_bf16 a[220:223], v[140:143], v[80:83], a[220:223]
    ds_read_b64_tr_b16 v[140:141], v11 offset:17504
    ds_read_b64_tr_b16 v[142:143], v11 offset:17632
    v_mfma_f32_16x16x32_bf16 v[144:147], v[112:115], a[0:3], v[144:147]
    s_add_u32 m0, s33, 16896
    v_mfma_f32_16x16x32_bf16 v[144:147], v[116:119], a[28:31], v[144:147]
    s_mov_b32 s49, s50
    v_mfma_f32_16x16x32_bf16 v[148:151], v[112:115], a[4:7], v[148:151]
    s_add_u32 s64, s16, s49
    v_mfma_f32_16x16x32_bf16 v[148:151], v[116:119], a[32:35], v[148:151]
    s_addc_u32 s65, s17, 0
    v_mfma_f32_16x16x32_bf16 v[152:155], v[112:115], a[8:11], v[152:155]
    v_mfma_f32_16x16x32_bf16 v[152:155], v[116:119], a[36:39], v[152:155]
    v_mfma_f32_16x16x32_bf16 v[156:159], v[112:115], a[12:15], v[156:159]
    s_waitcnt vmcnt(16) lgkmcnt(0)
    s_barrier
    v_mfma_f32_16x16x32_bf16 v[156:159], v[116:119], a[40:43], v[156:159]
    v_mfma_f32_16x16x32_bf16 v[160:163], v[112:115], a[16:19], v[160:163]
    v_mfma_f32_16x16x32_bf16 v[160:163], v[116:119], a[44:47], v[160:163]
    global_load_lds_dwordx4 v88, s[64:65]
    v_mfma_f32_16x16x32_bf16 v[164:167], v[112:115], a[20:23], v[164:167]
    s_add_u32 m0, m0, s53
    v_mfma_f32_16x16x32_bf16 v[164:167], v[116:119], a[48:51], v[164:167]
    v_mfma_f32_16x16x32_bf16 v[168:171], v[112:115], a[24:27], v[168:171]
    v_mfma_f32_16x16x32_bf16 v[168:171], v[116:119], a[52:55], v[168:171]
    ds_read_b64_tr_b16 v[112:113], v11 offset:25344
    v_mfma_f32_16x16x32_bf16 v[172:175], v[120:123], a[0:3], v[172:175]
    ds_read_b64_tr_b16 v[114:115], v11 offset:25472
    v_mfma_f32_16x16x32_bf16 v[172:175], v[124:127], a[28:31], v[172:175]
    global_load_lds_dwordx4 v89, s[64:65]
    v_mfma_f32_16x16x32_bf16 v[176:179], v[120:123], a[4:7], v[176:179]
    s_add_u32 m0, m0, s53
    ds_read_b64_tr_b16 v[116:117], v11 offset:25856
    v_mfma_f32_16x16x32_bf16 v[176:179], v[124:127], a[32:35], v[176:179]
    ds_read_b64_tr_b16 v[118:119], v11 offset:25984
    v_mfma_f32_16x16x32_bf16 v[180:183], v[120:123], a[8:11], v[180:183]
    v_mfma_f32_16x16x32_bf16 v[180:183], v[124:127], a[36:39], v[180:183]
    v_mfma_f32_16x16x32_bf16 v[184:187], v[120:123], a[12:15], v[184:187]
    v_mfma_f32_16x16x32_bf16 v[184:187], v[124:127], a[40:43], v[184:187]
    global_load_lds_dwordx4 v90, s[64:65]
    v_mfma_f32_16x16x32_bf16 v[188:191], v[120:123], a[16:19], v[188:191]
    s_add_u32 m0, m0, s53
    v_mfma_f32_16x16x32_bf16 v[188:191], v[124:127], a[44:47], v[188:191]
    v_mfma_f32_16x16x32_bf16 v[192:195], v[120:123], a[20:23], v[192:195]
    v_mfma_f32_16x16x32_bf16 v[192:195], v[124:127], a[48:51], v[192:195]
    v_mfma_f32_16x16x32_bf16 v[196:199], v[120:123], a[24:27], v[196:199]
    v_mfma_f32_16x16x32_bf16 v[196:199], v[124:127], a[52:55], v[196:199]
    global_load_lds_dwordx4 v91, s[64:65]
    v_mfma_f32_16x16x32_bf16 v[200:203], v[128:131], a[0:3], v[200:203]
    s_add_u32 m0, m0, s53
    ds_read_b64_tr_b16 v[120:121], v11 offset:25376
    v_mfma_f32_16x16x32_bf16 v[200:203], v[132:135], a[28:31], v[200:203]
    ds_read_b64_tr_b16 v[122:123], v11 offset:25504
    v_mfma_f32_16x16x32_bf16 v[204:207], v[128:131], a[4:7], v[204:207]
    ds_read_b64_tr_b16 v[124:125], v11 offset:25888
    v_mfma_f32_16x16x32_bf16 v[204:207], v[132:135], a[32:35], v[204:207]
    ds_read_b64_tr_b16 v[126:127], v11 offset:26016
    v_mfma_f32_16x16x32_bf16 v[208:211], v[128:131], a[8:11], v[208:211]
    v_mfma_f32_16x16x32_bf16 v[208:211], v[132:135], a[36:39], v[208:211]
    global_load_lds_dwordx4 v92, s[64:65]
    v_mfma_f32_16x16x32_bf16 v[212:215], v[128:131], a[12:15], v[212:215]
    s_add_u32 m0, m0, s53
    v_mfma_f32_16x16x32_bf16 v[212:215], v[132:135], a[40:43], v[212:215]
    v_mfma_f32_16x16x32_bf16 v[216:219], v[128:131], a[16:19], v[216:219]
    v_mfma_f32_16x16x32_bf16 v[216:219], v[132:135], a[44:47], v[216:219]
    v_mfma_f32_16x16x32_bf16 v[220:223], v[128:131], a[20:23], v[220:223]
    v_mfma_f32_16x16x32_bf16 v[220:223], v[132:135], a[48:51], v[220:223]
    global_load_lds_dwordx4 v93, s[64:65]
    v_mfma_f32_16x16x32_bf16 v[224:227], v[128:131], a[24:27], v[224:227]
    s_add_u32 m0, m0, s53
    v_mfma_f32_16x16x32_bf16 v[224:227], v[132:135], a[52:55], v[224:227]
    ds_read_b64_tr_b16 v[128:129], v11 offset:25408
    v_mfma_f32_16x16x32_bf16 v[228:231], v[136:139], a[0:3], v[228:231]
    ds_read_b64_tr_b16 v[130:131], v11 offset:25536
    v_mfma_f32_16x16x32_bf16 v[228:231], v[140:143], a[28:31], v[228:231]
    ds_read_b64_tr_b16 v[132:133], v11 offset:25920
    v_mfma_f32_16x16x32_bf16 v[232:235], v[136:139], a[4:7], v[232:235]
    ds_read_b64_tr_b16 v[134:135], v11 offset:26048
    v_mfma_f32_16x16x32_bf16 v[232:235], v[140:143], a[32:35], v[232:235]
    global_load_lds_dwordx4 v94, s[64:65]
    v_mfma_f32_16x16x32_bf16 v[236:239], v[136:139], a[8:11], v[236:239]
    s_add_u32 m0, m0, s53
    v_mfma_f32_16x16x32_bf16 v[236:239], v[140:143], a[36:39], v[236:239]
    v_mfma_f32_16x16x32_bf16 v[240:243], v[136:139], a[12:15], v[240:243]
    v_mfma_f32_16x16x32_bf16 v[240:243], v[140:143], a[40:43], v[240:243]
    v_mfma_f32_16x16x32_bf16 v[244:247], v[136:139], a[16:19], v[244:247]
    v_mfma_f32_16x16x32_bf16 v[244:247], v[140:143], a[44:47], v[244:247]
    global_load_lds_dwordx4 v95, s[64:65]
    v_mfma_f32_16x16x32_bf16 v[248:251], v[136:139], a[20:23], v[248:251]
    s_waitcnt lgkmcnt(4)
    v_mfma_f32_16x16x32_bf16 v[248:251], v[140:143], a[48:51], v[248:251]
    v_mfma_f32_16x16x32_bf16 v[252:255], v[136:139], a[24:27], v[252:255]
    ds_read_b64_tr_b16 v[136:137], v11 offset:25440
    ds_read_b64_tr_b16 v[138:139], v11 offset:25568
    v_mfma_f32_16x16x32_bf16 v[252:255], v[140:143], a[52:55], v[252:255]
    ds_read_b64_tr_b16 v[140:141], v11 offset:25952
    ds_read_b64_tr_b16 v[142:143], v11 offset:26080
    v_mfma_f32_16x16x32_bf16 a[112:115], v[112:115], a[0:3], a[112:115]
    s_add_u32 m0, s33, 25344
    v_mfma_f32_16x16x32_bf16 a[112:115], v[116:119], a[28:31], a[112:115]
    s_add_u32 s49, s50, s46
    v_mfma_f32_16x16x32_bf16 a[116:119], v[112:115], a[4:7], a[116:119]
    s_lshl1_add_u32 s50, s51, s50
    v_add_u32 v104, s49, v26
    v_mfma_f32_16x16x32_bf16 a[116:119], v[116:119], a[32:35], a[116:119]
    s_add_u32 s82, s82, 2
    v_mfma_f32_16x16x32_bf16 a[120:123], v[112:115], a[8:11], a[120:123]
    s_cmp_eq_u32 s82, 20
    v_mfma_f32_16x16x32_bf16 a[120:123], v[116:119], a[36:39], a[120:123]
    s_cselect_b32 s29, s83, 0
    v_mfma_f32_16x16x32_bf16 a[124:127], v[112:115], a[12:15], a[124:127]
    s_sub_u32 s50, s50, s29
    s_waitcnt vmcnt(8) lgkmcnt(0)
    s_barrier
    ds_read_b128 v[28:31], v27 offset:0
    v_mfma_f32_16x16x32_bf16 a[124:127], v[116:119], a[40:43], a[124:127]
    s_add_u32 s64, s16, s49
    ds_read_b128 v[32:35], v27 offset:2048
    v_mfma_f32_16x16x32_bf16 a[128:131], v[112:115], a[16:19], a[128:131]
    s_addc_u32 s65, s17, 0
    ds_read_b128 v[36:39], v27 offset:4096
    v_mfma_f32_16x16x32_bf16 a[128:131], v[116:119], a[44:47], a[128:131]
    global_load_lds_dwordx4 v88, s[64:65]
    v_mfma_f32_16x16x32_bf16 a[132:135], v[112:115], a[20:23], a[132:135]
    s_add_u32 m0, m0, s53
    ds_read_b128 v[40:43], v27 offset:6144
    v_mfma_f32_16x16x32_bf16 a[132:135], v[116:119], a[48:51], a[132:135]
    ds_read_b128 v[44:47], v27 offset:8448
    v_mfma_f32_16x16x32_bf16 a[136:139], v[112:115], a[24:27], a[136:139]
    ds_read_b128 v[48:51], v27 offset:10496
    v_mfma_f32_16x16x32_bf16 a[136:139], v[116:119], a[52:55], a[136:139]
    ds_read_b128 v[52:55], v27 offset:12544
    v_mfma_f32_16x16x32_bf16 a[140:143], v[120:123], a[0:3], a[140:143]
    ds_read_b128 v[56:59], v6 offset:0
    v_mfma_f32_16x16x32_bf16 a[140:143], v[124:127], a[28:31], a[140:143]
    global_load_lds_dwordx4 v89, s[64:65]
    v_mfma_f32_16x16x32_bf16 a[144:147], v[120:123], a[4:7], a[144:147]
    s_add_u32 m0, m0, s53
    ds_read_b128 v[60:63], v6 offset:2048
    v_mfma_f32_16x16x32_bf16 a[144:147], v[124:127], a[32:35], a[144:147]
    ds_read_b128 v[64:67], v6 offset:4096
    v_mfma_f32_16x16x32_bf16 a[148:151], v[120:123], a[8:11], a[148:151]
    ds_read_b128 v[68:71], v6 offset:6144
    v_mfma_f32_16x16x32_bf16 a[148:151], v[124:127], a[36:39], a[148:151]
    ds_read_b128 v[72:75], v6 offset:8448
    v_mfma_f32_16x16x32_bf16 a[152:155], v[120:123], a[12:15], a[152:155]
    ds_read_b128 v[76:79], v6 offset:10496
    v_mfma_f32_16x16x32_bf16 a[152:155], v[124:127], a[40:43], a[152:155]
    global_load_lds_dwordx4 v90, s[64:65]
    v_mfma_f32_16x16x32_bf16 a[156:159], v[120:123], a[16:19], a[156:159]
    s_add_u32 m0, m0, s53
    ds_read_b128 v[80:83], v6 offset:12544
    v_mfma_f32_16x16x32_bf16 a[156:159], v[124:127], a[44:47], a[156:159]
    ds_read_b64_tr_b16 v[112:113], v11 offset:0
    v_mfma_f32_16x16x32_bf16 a[160:163], v[120:123], a[20:23], a[160:163]
    ds_read_b64_tr_b16 v[114:115], v11 offset:128
    v_mfma_f32_16x16x32_bf16 a[160:163], v[124:127], a[48:51], a[160:163]
    ds_read_b64_tr_b16 v[116:117], v11 offset:512
    v_mfma_f32_16x16x32_bf16 a[164:167], v[120:123], a[24:27], a[164:167]
    ds_read_b64_tr_b16 v[118:119], v11 offset:640
    v_mfma_f32_16x16x32_bf16 a[164:167], v[124:127], a[52:55], a[164:167]
    global_load_lds_dwordx4 v91, s[64:65]
    v_mfma_f32_16x16x32_bf16 a[168:171], v[128:131], a[0:3], a[168:171]
    s_add_u32 m0, m0, s53
    ds_read_b64_tr_b16 v[120:121], v11 offset:32
    v_mfma_f32_16x16x32_bf16 a[168:171], v[132:135], a[28:31], a[168:171]
    ds_read_b64_tr_b16 v[122:123], v11 offset:160
    v_mfma_f32_16x16x32_bf16 a[172:175], v[128:131], a[4:7], a[172:175]
    ds_read_b64_tr_b16 v[124:125], v11 offset:544
    v_mfma_f32_16x16x32_bf16 a[172:175], v[132:135], a[32:35], a[172:175]
    ds_read_b64_tr_b16 v[126:127], v11 offset:672
    v_mfma_f32_16x16x32_bf16 a[176:179], v[128:131], a[8:11], a[176:179]
    v_mfma_f32_16x16x32_bf16 a[176:179], v[132:135], a[36:39], a[176:179]
    global_load_lds_dwordx4 v92, s[64:65]
    v_mfma_f32_16x16x32_bf16 a[180:183], v[128:131], a[12:15], a[180:183]
    s_add_u32 m0, m0, s53
    v_mfma_f32_16x16x32_bf16 a[180:183], v[132:135], a[40:43], a[180:183]
    v_mfma_f32_16x16x32_bf16 a[184:187], v[128:131], a[16:19], a[184:187]
    v_mfma_f32_16x16x32_bf16 a[184:187], v[132:135], a[44:47], a[184:187]
    v_mfma_f32_16x16x32_bf16 a[188:191], v[128:131], a[20:23], a[188:191]
    v_mfma_f32_16x16x32_bf16 a[188:191], v[132:135], a[48:51], a[188:191]
    global_load_lds_dwordx4 v93, s[64:65]
    v_mfma_f32_16x16x32_bf16 a[192:195], v[128:131], a[24:27], a[192:195]
    s_add_u32 m0, m0, s53
    v_mfma_f32_16x16x32_bf16 a[192:195], v[132:135], a[52:55], a[192:195]
    ds_read_b64_tr_b16 v[128:129], v11 offset:64
    v_mfma_f32_16x16x32_bf16 a[196:199], v[136:139], a[0:3], a[196:199]
    ds_read_b64_tr_b16 v[130:131], v11 offset:192
    v_mfma_f32_16x16x32_bf16 a[196:199], v[140:143], a[28:31], a[196:199]
    ds_read_b64_tr_b16 v[132:133], v11 offset:576
    v_mfma_f32_16x16x32_bf16 a[200:203], v[136:139], a[4:7], a[200:203]
    ds_read_b64_tr_b16 v[134:135], v11 offset:704
    v_mfma_f32_16x16x32_bf16 a[200:203], v[140:143], a[32:35], a[200:203]
    buffer_load_dwordx4 v104, s[16:19], s47 offen lds
    v_mfma_f32_16x16x32_bf16 a[204:207], v[136:139], a[8:11], a[204:207]
    s_add_u32 m0, m0, s53
    v_mfma_f32_16x16x32_bf16 a[204:207], v[140:143], a[36:39], a[204:207]
    v_mfma_f32_16x16x32_bf16 a[208:211], v[136:139], a[12:15], a[208:211]
    v_mfma_f32_16x16x32_bf16 a[208:211], v[140:143], a[40:43], a[208:211]
    v_mfma_f32_16x16x32_bf16 a[212:215], v[136:139], a[16:19], a[212:215]
    v_mfma_f32_16x16x32_bf16 a[212:215], v[140:143], a[44:47], a[212:215]
    buffer_load_dwordx4 v104, s[16:19], s98 offen lds
    v_mfma_f32_16x16x32_bf16 a[216:219], v[136:139], a[20:23], a[216:219]
    s_waitcnt lgkmcnt(4)
    v_mfma_f32_16x16x32_bf16 a[216:219], v[140:143], a[48:51], a[216:219]
    v_mfma_f32_16x16x32_bf16 a[220:223], v[136:139], a[24:27], a[220:223]
    ds_read_b64_tr_b16 v[136:137], v11 offset:96
    ds_read_b64_tr_b16 v[138:139], v11 offset:224
    v_mfma_f32_16x16x32_bf16 a[220:223], v[140:143], a[52:55], a[220:223]
    ds_read_b64_tr_b16 v[140:141], v11 offset:608
    ds_read_b64_tr_b16 v[142:143], v11 offset:736
    s_add_u32 s22, s22, 1
    s_cmp_lt_u32 s22, 3
    s_cbranch_scc1 L_at_qploop
    s_cmp_lg_u32 s70, 0
    s_cbranch_scc1 L_at_qptailB
    v_mfma_f32_16x16x32_bf16 v[144:147], v[112:115], v[28:31], v[144:147]
    s_add_u32 s29, s34, s100
    v_mfma_f32_16x16x32_bf16 v[144:147], v[116:119], v[56:59], v[144:147]
    s_bfe_u32 s28, s29, 0x20003
    v_mfma_f32_16x16x32_bf16 v[148:151], v[112:115], v[32:35], v[148:151]
    s_lshl_b32 s28, s28, 16
    v_mfma_f32_16x16x32_bf16 v[148:151], v[116:119], v[60:63], v[148:151]
    s_and_b32 s29, s29, 7
    v_mfma_f32_16x16x32_bf16 v[152:155], v[112:115], v[36:39], v[152:155]
    s_lshl_b32 s29, s29, 11
    v_mfma_f32_16x16x32_bf16 v[152:155], v[116:119], v[64:67], v[152:155]
    s_add_u32 s29, s28, s29
    v_mfma_f32_16x16x32_bf16 v[156:159], v[112:115], v[40:43], v[156:159]
    s_lshr_b32 s28, s34, 5
    s_waitcnt vmcnt(16) lgkmcnt(0)
    s_barrier
    v_mfma_f32_16x16x32_bf16 v[156:159], v[116:119], v[68:71], v[156:159]
    s_lshl_b32 s28, s28, 19
    v_mfma_f32_16x16x32_bf16 v[160:163], v[112:115], v[44:47], v[160:163]
    s_add_u32 s49, s28, s29
    v_mfma_f32_16x16x32_bf16 v[160:163], v[116:119], v[72:75], v[160:163]
    s_add_u32 m0, s33, 0
    v_mfma_f32_16x16x32_bf16 v[164:167], v[112:115], v[48:51], v[164:167]
    s_add_u32 s34, s34, 1
    v_mfma_f32_16x16x32_bf16 v[164:167], v[116:119], v[76:79], v[164:167]
    buffer_load_dwordx4 v7, s[4:7], s49 offen offset:0 nt lds
    v_mfma_f32_16x16x32_bf16 v[168:171], v[112:115], v[52:55], v[168:171]
    s_add_u32 m0, m0, s96
    v_mfma_f32_16x16x32_bf16 v[168:171], v[116:119], v[80:83], v[168:171]
    ds_read_b64_tr_b16 v[112:113], v11 offset:8448
    v_mfma_f32_16x16x32_bf16 v[172:175], v[120:123], v[28:31], v[172:175]
    ds_read_b64_tr_b16 v[114:115], v11 offset:8576
    v_mfma_f32_16x16x32_bf16 v[172:175], v[124:127], v[56:59], v[172:175]
    buffer_load_dwordx4 v7, s[4:7], s49 offen offset:256 nt lds
    v_mfma_f32_16x16x32_bf16 v[176:179], v[120:123], v[32:35], v[176:179]
    s_add_u32 m0, m0, s97
    ds_read_b64_tr_b16 v[116:117], v11 offset:8960
    v_mfma_f32_16x16x32_bf16 v[176:179], v[124:127], v[60:63], v[176:179]
    ds_read_b64_tr_b16 v[118:119], v11 offset:9088
    v_mfma_f32_16x16x32_bf16 v[180:183], v[120:123], v[36:39], v[180:183]
    v_mfma_f32_16x16x32_bf16 v[180:183], v[124:127], v[64:67], v[180:183]
    v_mfma_f32_16x16x32_bf16 v[184:187], v[120:123], v[40:43], v[184:187]
    v_mfma_f32_16x16x32_bf16 v[184:187], v[124:127], v[68:71], v[184:187]
    buffer_load_dwordx4 v7, s[4:7], s49 offen offset:512 nt lds
    v_mfma_f32_16x16x32_bf16 v[188:191], v[120:123], v[44:47], v[188:191]
    s_add_u32 m0, m0, s96
    v_mfma_f32_16x16x32_bf16 v[188:191], v[124:127], v[72:75], v[188:191]
    v_mfma_f32_16x16x32_bf16 v[192:195], v[120:123], v[48:51], v[192:195]
    v_mfma_f32_16x16x32_bf16 v[192:195], v[124:127], v[76:79], v[192:195]
    v_mfma_f32_16x16x32_bf16 v[196:199], v[120:123], v[52:55], v[196:199]
    v_mfma_f32_16x16x32_bf16 v[196:199], v[124:127], v[80:83], v[196:199]
    buffer_load_dwordx4 v7, s[4:7], s49 offen offset:768 nt lds
    v_mfma_f32_16x16x32_bf16 v[200:203], v[128:131], v[28:31], v[200:203]
    s_add_u32 m0, m0, s97
    ds_read_b64_tr_b16 v[120:121], v11 offset:8480
    v_mfma_f32_16x16x32_bf16 v[200:203], v[132:135], v[56:59], v[200:203]
    ds_read_b64_tr_b16 v[122:123], v11 offset:8608
    v_mfma_f32_16x16x32_bf16 v[204:207], v[128:131], v[32:35], v[204:207]
    ds_read_b64_tr_b16 v[124:125], v11 offset:8992
    v_mfma_f32_16x16x32_bf16 v[204:207], v[132:135], v[60:63], v[204:207]
    ds_read_b64_tr_b16 v[126:127], v11 offset:9120
    v_mfma_f32_16x16x32_bf16 v[208:211], v[128:131], v[36:39], v[208:211]
    v_mfma_f32_16x16x32_bf16 v[208:211], v[132:135], v[64:67], v[208:211]
    buffer_load_dwordx4 v7, s[4:7], s49 offen offset:1024 nt lds
    v_mfma_f32_16x16x32_bf16 v[212:215], v[128:131], v[40:43], v[212:215]
    s_add_u32 m0, m0, s96
    v_mfma_f32_16x16x32_bf16 v[212:215], v[132:135], v[68:71], v[212:215]
    v_mfma_f32_16x16x32_bf16 v[216:219], v[128:131], v[44:47], v[216:219]
    v_mfma_f32_16x16x32_bf16 v[216:219], v[132:135], v[72:75], v[216:219]
    v_mfma_f32_16x16x32_bf16 v[220:223], v[128:131], v[48:51], v[220:223]
    v_mfma_f32_16x16x32_bf16 v[220:223], v[132:135], v[76:79], v[220:223]
    buffer_load_dwordx4 v7, s[4:7], s49 offen offset:1280 nt lds
    v_mfma_f32_16x16x32_bf16 v[224:227], v[128:131], v[52:55], v[224:227]
    s_add_u32 m0, m0, s97
    v_mfma_f32_16x16x32_bf16 v[224:227], v[132:135], v[80:83], v[224:227]
    ds_read_b64_tr_b16 v[128:129], v11 offset:8512
    v_mfma_f32_16x16x32_bf16 v[228:231], v[136:139], v[28:31], v[228:231]
    ds_read_b64_tr_b16 v[130:131], v11 offset:8640
    v_mfma_f32_16x16x32_bf16 v[228:231], v[140:143], v[56:59], v[228:231]
    ds_read_b64_tr_b16 v[132:133], v11 offset:9024
    v_mfma_f32_16x16x32_bf16 v[232:235], v[136:139], v[32:35], v[232:235]
    ds_read_b64_tr_b16 v[134:135], v11 offset:9152
    v_mfma_f32_16x16x32_bf16 v[232:235], v[140:143], v[60:63], v[232:235]
    buffer_load_dwordx4 v7, s[4:7], s49 offen offset:1536 nt lds
    v_mfma_f32_16x16x32_bf16 v[236:239], v[136:139], v[36:39], v[236:239]
    s_add_u32 m0, m0, s96
    v_mfma_f32_16x16x32_bf16 v[236:239], v[140:143], v[64:67], v[236:239]
    v_mfma_f32_16x16x32_bf16 v[240:243], v[136:139], v[40:43], v[240:243]
    v_mfma_f32_16x16x32_bf16 v[240:243], v[140:143], v[68:71], v[240:243]
    v_mfma_f32_16x16x32_bf16 v[244:247], v[136:139], v[44:47], v[244:247]
    v_mfma_f32_16x16x32_bf16 v[244:247], v[140:143], v[72:75], v[244:247]
    buffer_load_dwordx4 v7, s[4:7], s49 offen offset:1792 nt lds
    v_mfma_f32_16x16x32_bf16 v[248:251], v[136:139], v[48:51], v[248:251]
    s_waitcnt lgkmcnt(4)
    v_mfma_f32_16x16x32_bf16 v[248:251], v[140:143], v[76:79], v[248:251]
    v_mfma_f32_16x16x32_bf16 v[252:255], v[136:139], v[52:55], v[252:255]
    ds_read_b64_tr_b16 v[136:137], v11 offset:8544
    ds_read_b64_tr_b16 v[138:139], v11 offset:8672
    v_mfma_f32_16x16x32_bf16 v[252:255], v[140:143], v[80:83], v[252:255]
    ds_read_b64_tr_b16 v[140:141], v11 offset:9056
    ds_read_b64_tr_b16 v[142:143], v11 offset:9184
    v_mfma_f32_16x16x32_bf16 a[112:115], v[112:115], v[28:31], a[112:115]
    s_add_u32 s29, s34, s100
    v_mfma_f32_16x16x32_bf16 a[112:115], v[116:119], v[56:59], a[112:115]
    s_bfe_u32 s28, s29, 0x20003
    v_mfma_f32_16x16x32_bf16 a[116:119], v[112:115], v[32:35], a[116:119]
    s_lshl_b32 s28, s28, 16
    v_mfma_f32_16x16x32_bf16 a[116:119], v[116:119], v[60:63], a[116:119]
    s_and_b32 s29, s29, 7
    v_mfma_f32_16x16x32_bf16 a[120:123], v[112:115], v[36:39], a[120:123]
    s_lshl_b32 s29, s29, 11
    v_mfma_f32_16x16x32_bf16 a[120:123], v[116:119], v[64:67], a[120:123]
    s_add_u32 s29, s28, s29
    v_mfma_f32_16x16x32_bf16 a[124:127], v[112:115], v[40:43], a[124:127]
    s_lshr_b32 s28, s34, 5
    s_waitcnt vmcnt(8) lgkmcnt(0)
    s_barrier
    ds_read_b128 a[0:3], v27 offset:16896
    v_mfma_f32_16x16x32_bf16 a[124:127], v[116:119], v[68:71], a[124:127]
    s_lshl_b32 s28, s28, 19
    ds_read_b128 a[4:7], v27 offset:18944
    v_mfma_f32_16x16x32_bf16 a[128:131], v[112:115], v[44:47], a[128:131]
    s_add_u32 s49, s28, s29
    ds_read_b128 a[8:11], v27 offset:20992
    v_mfma_f32_16x16x32_bf16 a[128:131], v[116:119], v[72:75], a[128:131]
    s_add_u32 m0, s33, 8448
    ds_read_b128 a[12:15], v27 offset:23040
    v_mfma_f32_16x16x32_bf16 a[132:135], v[112:115], v[48:51], a[132:135]
    s_add_u32 s34, s34, 1
    ds_read_b128 a[16:19], v27 offset:25344
    v_mfma_f32_16x16x32_bf16 a[132:135], v[116:119], v[76:79], a[132:135]
    buffer_load_dwordx4 v7, s[4:7], s49 offen offset:0 nt lds
    v_mfma_f32_16x16x32_bf16 a[136:139], v[112:115], v[52:55], a[136:139]
    s_add_u32 m0, m0, s96
    ds_read_b128 a[20:23], v27 offset:27392
    v_mfma_f32_16x16x32_bf16 a[136:139], v[116:119], v[80:83], a[136:139]
    ds_read_b128 a[24:27], v27 offset:29440
    v_mfma_f32_16x16x32_bf16 a[140:143], v[120:123], v[28:31], a[140:143]
    ds_read_b128 a[28:31], v6 offset:16896
    v_mfma_f32_16x16x32_bf16 a[140:143], v[124:127], v[56:59], a[140:143]
    buffer_load_dwordx4 v7, s[4:7], s49 offen offset:256 nt lds
    v_mfma_f32_16x16x32_bf16 a[144:147], v[120:123], v[32:35], a[144:147]
    s_add_u32 m0, m0, s97
    ds_read_b128 a[32:35], v6 offset:18944
    v_mfma_f32_16x16x32_bf16 a[144:147], v[124:127], v[60:63], a[144:147]
    ds_read_b128 a[36:39], v6 offset:20992
    v_mfma_f32_16x16x32_bf16 a[148:151], v[120:123], v[36:39], a[148:151]
    ds_read_b128 a[40:43], v6 offset:23040
    v_mfma_f32_16x16x32_bf16 a[148:151], v[124:127], v[64:67], a[148:151]
    ds_read_b128 a[44:47], v6 offset:25344
    v_mfma_f32_16x16x32_bf16 a[152:155], v[120:123], v[40:43], a[152:155]
    ds_read_b128 a[48:51], v6 offset:27392
    v_mfma_f32_16x16x32_bf16 a[152:155], v[124:127], v[68:71], a[152:155]
    buffer_load_dwordx4 v7, s[4:7], s49 offen offset:512 nt lds
    v_mfma_f32_16x16x32_bf16 a[156:159], v[120:123], v[44:47], a[156:159]
    s_add_u32 m0, m0, s96
    ds_read_b128 a[52:55], v6 offset:29440
    v_mfma_f32_16x16x32_bf16 a[156:159], v[124:127], v[72:75], a[156:159]
    ds_read_b64_tr_b16 v[112:113], v11 offset:16896
    v_mfma_f32_16x16x32_bf16 a[160:163], v[120:123], v[48:51], a[160:163]
    ds_read_b64_tr_b16 v[114:115], v11 offset:17024
    v_mfma_f32_16x16x32_bf16 a[160:163], v[124:127], v[76:79], a[160:163]
    ds_read_b64_tr_b16 v[116:117], v11 offset:17408
    v_mfma_f32_16x16x32_bf16 a[164:167], v[120:123], v[52:55], a[164:167]
    ds_read_b64_tr_b16 v[118:119], v11 offset:17536
    v_mfma_f32_16x16x32_bf16 a[164:167], v[124:127], v[80:83], a[164:167]
    buffer_load_dwordx4 v7, s[4:7], s49 offen offset:768 nt lds
    v_mfma_f32_16x16x32_bf16 a[168:171], v[128:131], v[28:31], a[168:171]
    s_add_u32 m0, m0, s97
    ds_read_b64_tr_b16 v[120:121], v11 offset:16928
    v_mfma_f32_16x16x32_bf16 a[168:171], v[132:135], v[56:59], a[168:171]
    ds_read_b64_tr_b16 v[122:123], v11 offset:17056
    v_mfma_f32_16x16x32_bf16 a[172:175], v[128:131], v[32:35], a[172:175]
    ds_read_b64_tr_b16 v[124:125], v11 offset:17440
    v_mfma_f32_16x16x32_bf16 a[172:175], v[132:135], v[60:63], a[172:175]
    ds_read_b64_tr_b16 v[126:127], v11 offset:17568
    v_mfma_f32_16x16x32_bf16 a[176:179], v[128:131], v[36:39], a[176:179]
    v_mfma_f32_16x16x32_bf16 a[176:179], v[132:135], v[64:67], a[176:179]
    buffer_load_dwordx4 v7, s[4:7], s49 offen offset:1024 nt lds
    v_mfma_f32_16x16x32_bf16 a[180:183], v[128:131], v[40:43], a[180:183]
    s_add_u32 m0, m0, s96
    v_mfma_f32_16x16x32_bf16 a[180:183], v[132:135], v[68:71], a[180:183]
    v_mfma_f32_16x16x32_bf16 a[184:187], v[128:131], v[44:47], a[184:187]
    v_mfma_f32_16x16x32_bf16 a[184:187], v[132:135], v[72:75], a[184:187]
    v_mfma_f32_16x16x32_bf16 a[188:191], v[128:131], v[48:51], a[188:191]
    v_mfma_f32_16x16x32_bf16 a[188:191], v[132:135], v[76:79], a[188:191]
    buffer_load_dwordx4 v7, s[4:7], s49 offen offset:1280 nt lds
    v_mfma_f32_16x16x32_bf16 a[192:195], v[128:131], v[52:55], a[192:195]
    s_add_u32 m0, m0, s97
    v_mfma_f32_16x16x32_bf16 a[192:195], v[132:135], v[80:83], a[192:195]
    ds_read_b64_tr_b16 v[128:129], v11 offset:16960
    v_mfma_f32_16x16x32_bf16 a[196:199], v[136:139], v[28:31], a[196:199]
    ds_read_b64_tr_b16 v[130:131], v11 offset:17088
    v_mfma_f32_16x16x32_bf16 a[196:199], v[140:143], v[56:59], a[196:199]
    ds_read_b64_tr_b16 v[132:133], v11 offset:17472
    v_mfma_f32_16x16x32_bf16 a[200:203], v[136:139], v[32:35], a[200:203]
    ds_read_b64_tr_b16 v[134:135], v11 offset:17600
    v_mfma_f32_16x16x32_bf16 a[200:203], v[140:143], v[60:63], a[200:203]
    buffer_load_dwordx4 v7, s[4:7], s49 offen offset:1536 nt lds
    v_mfma_f32_16x16x32_bf16 a[204:207], v[136:139], v[36:39], a[204:207]
    s_add_u32 m0, m0, s96
    v_mfma_f32_16x16x32_bf16 a[204:207], v[140:143], v[64:67], a[204:207]
    v_mfma_f32_16x16x32_bf16 a[208:211], v[136:139], v[40:43], a[208:211]
    v_mfma_f32_16x16x32_bf16 a[208:211], v[140:143], v[68:71], a[208:211]
    v_mfma_f32_16x16x32_bf16 a[212:215], v[136:139], v[44:47], a[212:215]
    v_mfma_f32_16x16x32_bf16 a[212:215], v[140:143], v[72:75], a[212:215]
    buffer_load_dwordx4 v7, s[4:7], s49 offen offset:1792 nt lds
    v_mfma_f32_16x16x32_bf16 a[216:219], v[136:139], v[48:51], a[216:219]
    s_waitcnt lgkmcnt(4)
    v_mfma_f32_16x16x32_bf16 a[216:219], v[140:143], v[76:79], a[216:219]
    v_mfma_f32_16x16x32_bf16 a[220:223], v[136:139], v[52:55], a[220:223]
    ds_read_b64_tr_b16 v[136:137], v11 offset:16992
    ds_read_b64_tr_b16 v[138:139], v11 offset:17120
    v_mfma_f32_16x16x32_bf16 a[220:223], v[140:143], v[80:83], a[220:223]
    ds_read_b64_tr_b16 v[140:141], v11 offset:17504
    ds_read_b64_tr_b16 v[142:143], v11 offset:17632
    v_mfma_f32_16x16x32_bf16 v[144:147], v[112:115], a[0:3], v[144:147]
    s_add_u32 s29, s34, s100
    v_mfma_f32_16x16x32_bf16 v[144:147], v[116:119], a[28:31], v[144:147]
    s_bfe_u32 s28, s29, 0x20003
    v_mfma_f32_16x16x32_bf16 v[148:151], v[112:115], a[4:7], v[148:151]
    s_lshl_b32 s28, s28, 16
    v_mfma_f32_16x16x32_bf16 v[148:151], v[116:119], a[32:35], v[148:151]
    s_and_b32 s29, s29, 7
    v_mfma_f32_16x16x32_bf16 v[152:155], v[112:115], a[8:11], v[152:155]
    s_lshl_b32 s29, s29, 11
    v_mfma_f32_16x16x32_bf16 v[152:155], v[116:119], a[36:39], v[152:155]
    s_add_u32 s29, s28, s29
    v_mfma_f32_16x16x32_bf16 v[156:159], v[112:115], a[12:15], v[156:159]
    s_lshr_b32 s28, s34, 5
    s_waitcnt vmcnt(16) lgkmcnt(0)
    s_barrier
    v_mfma_f32_16x16x32_bf16 v[156:159], v[116:119], a[40:43], v[156:159]
    s_lshl_b32 s28, s28, 19
    v_mfma_f32_16x16x32_bf16 v[160:163], v[112:115], a[16:19], v[160:163]
    s_add_u32 s49, s28, s29
    v_mfma_f32_16x16x32_bf16 v[160:163], v[116:119], a[44:47], v[160:163]
    s_add_u32 m0, s33, 16896
    v_mfma_f32_16x16x32_bf16 v[164:167], v[112:115], a[20:23], v[164:167]
    s_add_u32 s34, s34, 1
    v_mfma_f32_16x16x32_bf16 v[164:167], v[116:119], a[48:51], v[164:167]
    buffer_load_dwordx4 v7, s[4:7], s49 offen offset:0 nt lds
    v_mfma_f32_16x16x32_bf16 v[168:171], v[112:115], a[24:27], v[168:171]
    s_add_u32 m0, m0, s96
    v_mfma_f32_16x16x32_bf16 v[168:171], v[116:119], a[52:55], v[168:171]
    ds_read_b64_tr_b16 v[112:113], v11 offset:25344
    v_mfma_f32_16x16x32_bf16 v[172:175], v[120:123], a[0:3], v[172:175]
    ds_read_b64_tr_b16 v[114:115], v11 offset:25472
    v_mfma_f32_16x16x32_bf16 v[172:175], v[124:127], a[28:31], v[172:175]
    buffer_load_dwordx4 v7, s[4:7], s49 offen offset:256 nt lds
    v_mfma_f32_16x16x32_bf16 v[176:179], v[120:123], a[4:7], v[176:179]
    s_add_u32 m0, m0, s97
    ds_read_b64_tr_b16 v[116:117], v11 offset:25856
    v_mfma_f32_16x16x32_bf16 v[176:179], v[124:127], a[32:35], v[176:179]
    ds_read_b64_tr_b16 v[118:119], v11 offset:25984
    v_mfma_f32_16x16x32_bf16 v[180:183], v[120:123], a[8:11], v[180:183]
    v_mfma_f32_16x16x32_bf16 v[180:183], v[124:127], a[36:39], v[180:183]
    v_mfma_f32_16x16x32_bf16 v[184:187], v[120:123], a[12:15], v[184:187]
    v_mfma_f32_16x16x32_bf16 v[184:187], v[124:127], a[40:43], v[184:187]
    buffer_load_dwordx4 v7, s[4:7], s49 offen offset:512 nt lds
    v_mfma_f32_16x16x32_bf16 v[188:191], v[120:123], a[16:19], v[188:191]
    s_add_u32 m0, m0, s96
    v_mfma_f32_16x16x32_bf16 v[188:191], v[124:127], a[44:47], v[188:191]
    v_mfma_f32_16x16x32_bf16 v[192:195], v[120:123], a[20:23], v[192:195]
    v_mfma_f32_16x16x32_bf16 v[192:195], v[124:127], a[48:51], v[192:195]
    v_mfma_f32_16x16x32_bf16 v[196:199], v[120:123], a[24:27], v[196:199]
    v_mfma_f32_16x16x32_bf16 v[196:199], v[124:127], a[52:55], v[196:199]
    buffer_load_dwordx4 v7, s[4:7], s49 offen offset:768 nt lds
    v_mfma_f32_16x16x32_bf16 v[200:203], v[128:131], a[0:3], v[200:203]
    s_add_u32 m0, m0, s97
    ds_read_b64_tr_b16 v[120:121], v11 offset:25376
    v_mfma_f32_16x16x32_bf16 v[200:203], v[132:135], a[28:31], v[200:203]
    ds_read_b64_tr_b16 v[122:123], v11 offset:25504
    v_mfma_f32_16x16x32_bf16 v[204:207], v[128:131], a[4:7], v[204:207]
    ds_read_b64_tr_b16 v[124:125], v11 offset:25888
    v_mfma_f32_16x16x32_bf16 v[204:207], v[132:135], a[32:35], v[204:207]
    ds_read_b64_tr_b16 v[126:127], v11 offset:26016
    v_mfma_f32_16x16x32_bf16 v[208:211], v[128:131], a[8:11], v[208:211]
    v_mfma_f32_16x16x32_bf16 v[208:211], v[132:135], a[36:39], v[208:211]
    buffer_load_dwordx4 v7, s[4:7], s49 offen offset:1024 nt lds
    v_mfma_f32_16x16x32_bf16 v[212:215], v[128:131], a[12:15], v[212:215]
    s_add_u32 m0, m0, s96
    v_mfma_f32_16x16x32_bf16 v[212:215], v[132:135], a[40:43], v[212:215]
    v_mfma_f32_16x16x32_bf16 v[216:219], v[128:131], a[16:19], v[216:219]
    v_mfma_f32_16x16x32_bf16 v[216:219], v[132:135], a[44:47], v[216:219]
    v_mfma_f32_16x16x32_bf16 v[220:223], v[128:131], a[20:23], v[220:223]
    v_mfma_f32_16x16x32_bf16 v[220:223], v[132:135], a[48:51], v[220:223]
    buffer_load_dwordx4 v7, s[4:7], s49 offen offset:1280 nt lds
    v_mfma_f32_16x16x32_bf16 v[224:227], v[128:131], a[24:27], v[224:227]
    s_add_u32 m0, m0, s97
    v_mfma_f32_16x16x32_bf16 v[224:227], v[132:135], a[52:55], v[224:227]
    ds_read_b64_tr_b16 v[128:129], v11 offset:25408
    v_mfma_f32_16x16x32_bf16 v[228:231], v[136:139], a[0:3], v[228:231]
    ds_read_b64_tr_b16 v[130:131], v11 offset:25536
    v_mfma_f32_16x16x32_bf16 v[228:231], v[140:143], a[28:31], v[228:231]
    ds_read_b64_tr_b16 v[132:133], v11 offset:25920
    v_mfma_f32_16x16x32_bf16 v[232:235], v[136:139], a[4:7], v[232:235]
    ds_read_b64_tr_b16 v[134:135], v11 offset:26048
    v_mfma_f32_16x16x32_bf16 v[232:235], v[140:143], a[32:35], v[232:235]
    buffer_load_dwordx4 v7, s[4:7], s49 offen offset:1536 nt lds
    v_mfma_f32_16x16x32_bf16 v[236:239], v[136:139], a[8:11], v[236:239]
    s_add_u32 m0, m0, s96
    v_mfma_f32_16x16x32_bf16 v[236:239], v[140:143], a[36:39], v[236:239]
    v_mfma_f32_16x16x32_bf16 v[240:243], v[136:139], a[12:15], v[240:243]
    v_mfma_f32_16x16x32_bf16 v[240:243], v[140:143], a[40:43], v[240:243]
    v_mfma_f32_16x16x32_bf16 v[244:247], v[136:139], a[16:19], v[244:247]
    v_mfma_f32_16x16x32_bf16 v[244:247], v[140:143], a[44:47], v[244:247]
    buffer_load_dwordx4 v7, s[4:7], s49 offen offset:1792 nt lds
    v_mfma_f32_16x16x32_bf16 v[248:251], v[136:139], a[20:23], v[248:251]
    s_waitcnt lgkmcnt(4)
    v_mfma_f32_16x16x32_bf16 v[248:251], v[140:143], a[48:51], v[248:251]
    v_mfma_f32_16x16x32_bf16 v[252:255], v[136:139], a[24:27], v[252:255]
    ds_read_b64_tr_b16 v[136:137], v11 offset:25440
    ds_read_b64_tr_b16 v[138:139], v11 offset:25568
    v_mfma_f32_16x16x32_bf16 v[252:255], v[140:143], a[52:55], v[252:255]
    ds_read_b64_tr_b16 v[140:141], v11 offset:25952
    ds_read_b64_tr_b16 v[142:143], v11 offset:26080
    v_mfma_f32_16x16x32_bf16 a[112:115], v[112:115], a[0:3], a[112:115]
    s_add_u32 s29, s34, s100
    v_mfma_f32_16x16x32_bf16 a[112:115], v[116:119], a[28:31], a[112:115]
    s_bfe_u32 s28, s29, 0x20003
    v_mfma_f32_16x16x32_bf16 a[116:119], v[112:115], a[4:7], a[116:119]
    s_lshl_b32 s28, s28, 16
    v_mfma_f32_16x16x32_bf16 a[116:119], v[116:119], a[32:35], a[116:119]
    s_and_b32 s29, s29, 7
    v_mfma_f32_16x16x32_bf16 a[120:123], v[112:115], a[8:11], a[120:123]
    s_lshl_b32 s29, s29, 11
    v_mfma_f32_16x16x32_bf16 a[120:123], v[116:119], a[36:39], a[120:123]
    s_add_u32 s29, s28, s29
    v_mfma_f32_16x16x32_bf16 a[124:127], v[112:115], a[12:15], a[124:127]
    s_lshr_b32 s28, s34, 5
    s_waitcnt vmcnt(16) lgkmcnt(0)
    s_barrier
    ds_read_b128 v[56:59], v8 offset:0
    v_mfma_f32_16x16x32_bf16 a[124:127], v[116:119], a[40:43], a[124:127]
    s_lshl_b32 s28, s28, 19
    ds_read_b128 v[60:63], v8 offset:64
    v_mfma_f32_16x16x32_bf16 a[128:131], v[112:115], a[16:19], a[128:131]
    s_add_u32 s49, s28, s29
    ds_read_b128 v[64:67], v8 offset:128
    v_mfma_f32_16x16x32_bf16 a[128:131], v[116:119], a[44:47], a[128:131]
    s_add_u32 m0, s33, 25344
    ds_read_b128 v[68:71], v8 offset:192
    v_mfma_f32_16x16x32_bf16 a[132:135], v[112:115], a[20:23], a[132:135]
    s_add_u32 s34, s34, 1
    ds_read_b128 v[72:75], v8 offset:512
    v_mfma_f32_16x16x32_bf16 a[132:135], v[116:119], a[48:51], a[132:135]
    buffer_load_dwordx4 v7, s[4:7], s49 offen offset:0 nt lds
    v_mfma_f32_16x16x32_bf16 a[136:139], v[112:115], a[24:27], a[136:139]
    s_add_u32 m0, m0, s96
    ds_read_b128 v[76:79], v8 offset:576
    v_mfma_f32_16x16x32_bf16 a[136:139], v[116:119], a[52:55], a[136:139]
    ds_read_b128 v[80:83], v8 offset:640
    v_mfma_f32_16x16x32_bf16 a[140:143], v[120:123], a[0:3], a[140:143]
    ds_read_b128 v[84:87], v8 offset:704
    v_mfma_f32_16x16x32_bf16 a[140:143], v[124:127], a[28:31], a[140:143]
    buffer_load_dwordx4 v7, s[4:7], s49 offen offset:256 nt lds
    v_mfma_f32_16x16x32_bf16 a[144:147], v[120:123], a[4:7], a[144:147]
    s_add_u32 m0, m0, s97
    v_mfma_f32_16x16x32_bf16 a[144:147], v[124:127], a[32:35], a[144:147]
    v_mfma_f32_16x16x32_bf16 a[148:151], v[120:123], a[8:11], a[148:151]
    v_mfma_f32_16x16x32_bf16 a[148:151], v[124:127], a[36:39], a[148:151]
    v_mfma_f32_16x16x32_bf16 a[152:155], v[120:123], a[12:15], a[152:155]
    v_mfma_f32_16x16x32_bf16 a[152:155], v[124:127], a[40:43], a[152:155]
    buffer_load_dwordx4 v7, s[4:7], s49 offen offset:512 nt lds
    v_mfma_f32_16x16x32_bf16 a[156:159], v[120:123], a[16:19], a[156:159]
    s_add_u32 m0, m0, s96
    v_mfma_f32_16x16x32_bf16 a[156:159], v[124:127], a[44:47], a[156:159]
    v_mfma_f32_16x16x32_bf16 a[160:163], v[120:123], a[20:23], a[160:163]
    v_mfma_f32_16x16x32_bf16 a[160:163], v[124:127], a[48:51], a[160:163]
    v_mfma_f32_16x16x32_bf16 a[164:167], v[120:123], a[24:27], a[164:167]
    v_mfma_f32_16x16x32_bf16 a[164:167], v[124:127], a[52:55], a[164:167]
    buffer_load_dwordx4 v7, s[4:7], s49 offen offset:768 nt lds
    v_mfma_f32_16x16x32_bf16 a[168:171], v[128:131], a[0:3], a[168:171]
    s_add_u32 m0, m0, s97
    v_mfma_f32_16x16x32_bf16 a[168:171], v[132:135], a[28:31], a[168:171]
    v_mfma_f32_16x16x32_bf16 a[172:175], v[128:131], a[4:7], a[172:175]
    v_mfma_f32_16x16x32_bf16 a[172:175], v[132:135], a[32:35], a[172:175]
    v_mfma_f32_16x16x32_bf16 a[176:179], v[128:131], a[8:11], a[176:179]
    v_mfma_f32_16x16x32_bf16 a[176:179], v[132:135], a[36:39], a[176:179]
    buffer_load_dwordx4 v7, s[4:7], s49 offen offset:1024 nt lds
    v_mfma_f32_16x16x32_bf16 a[180:183], v[128:131], a[12:15], a[180:183]
    s_add_u32 m0, m0, s96
    v_mfma_f32_16x16x32_bf16 a[180:183], v[132:135], a[40:43], a[180:183]
    v_mfma_f32_16x16x32_bf16 a[184:187], v[128:131], a[16:19], a[184:187]
    v_mfma_f32_16x16x32_bf16 a[184:187], v[132:135], a[44:47], a[184:187]
    v_mfma_f32_16x16x32_bf16 a[188:191], v[128:131], a[20:23], a[188:191]
    v_mfma_f32_16x16x32_bf16 a[188:191], v[132:135], a[48:51], a[188:191]
    buffer_load_dwordx4 v7, s[4:7], s49 offen offset:1280 nt lds
    v_mfma_f32_16x16x32_bf16 a[192:195], v[128:131], a[24:27], a[192:195]
    s_add_u32 m0, m0, s97
    v_mfma_f32_16x16x32_bf16 a[192:195], v[132:135], a[52:55], a[192:195]
    v_mfma_f32_16x16x32_bf16 a[196:199], v[136:139], a[0:3], a[196:199]
    v_mfma_f32_16x16x32_bf16 a[196:199], v[140:143], a[28:31], a[196:199]
    v_mfma_f32_16x16x32_bf16 a[200:203], v[136:139], a[4:7], a[200:203]
    v_mfma_f32_16x16x32_bf16 a[200:203], v[140:143], a[32:35], a[200:203]
    buffer_load_dwordx4 v7, s[4:7], s49 offen offset:1536 nt lds
    v_mfma_f32_16x16x32_bf16 a[204:207], v[136:139], a[8:11], a[204:207]
    s_add_u32 m0, m0, s96
    v_mfma_f32_16x16x32_bf16 a[204:207], v[140:143], a[36:39], a[204:207]
    v_mfma_f32_16x16x32_bf16 a[208:211], v[136:139], a[12:15], a[208:211]
    v_mfma_f32_16x16x32_bf16 a[208:211], v[140:143], a[40:43], a[208:211]
    v_mfma_f32_16x16x32_bf16 a[212:215], v[136:139], a[16:19], a[212:215]
    v_mfma_f32_16x16x32_bf16 a[212:215], v[140:143], a[44:47], a[212:215]
    buffer_load_dwordx4 v7, s[4:7], s49 offen offset:1792 nt lds
    v_mfma_f32_16x16x32_bf16 a[216:219], v[136:139], a[20:23], a[216:219]
    v_mfma_f32_16x16x32_bf16 a[216:219], v[140:143], a[48:51], a[216:219]
    v_mfma_f32_16x16x32_bf16 a[220:223], v[136:139], a[24:27], a[220:223]
    v_mfma_f32_16x16x32_bf16 a[220:223], v[140:143], a[52:55], a[220:223]
    s_branch L_at_qpepi
L_at_qptailB:
    s_mul_i32 s50, s21, s52
    s_mov_b32 s101, s21
    s_add_u32 s50, s50, s55
    s_cmp_ge_u32 s21, 2
    s_cselect_b32 s28, 0x40000000, 0
    s_add_u32 s50, s50, s28
    s_mov_b32 s82, s26
    s_mul_i32 s28, s26, s51
    s_add_u32 s50, s50, s28
    v_mfma_f32_16x16x32_bf16 v[144:147], v[112:115], v[28:31], v[144:147]
    s_add_u32 m0, s33, 0
    v_mfma_f32_16x16x32_bf16 v[144:147], v[116:119], v[56:59], v[144:147]
    s_mov_b32 s49, s50
    v_mfma_f32_16x16x32_bf16 v[148:151], v[112:115], v[32:35], v[148:151]
    s_add_u32 s64, s16, s49
    v_mfma_f32_16x16x32_bf16 v[148:151], v[116:119], v[60:63], v[148:151]
    s_addc_u32 s65, s17, 0
    v_mfma_f32_16x16x32_bf16 v[152:155], v[112:115], v[36:39], v[152:155]
    v_mfma_f32_16x16x32_bf16 v[152:155], v[116:119], v[64:67], v[152:155]
    v_mfma_f32_16x16x32_bf16 v[156:159], v[112:115], v[40:43], v[156:159]
    s_waitcnt vmcnt(16) lgkmcnt(0)
    s_barrier
    v_mfma_f32_16x16x32_bf16 v[156:159], v[116:119], v[68:71], v[156:159]
    v_mfma_f32_16x16x32_bf16 v[160:163], v[112:115], v[44:47], v[160:163]
    v_mfma_f32_16x16x32_bf16 v[160:163], v[116:119], v[72:75], v[160:163]
    global_load_lds_dwordx4 v88, s[64:65]
    v_mfma_f32_16x16x32_bf16 v[164:167], v[112:115], v[48:51], v[164:167]
    s_add_u32 m0, m0, s53
    v_mfma_f32_16x16x32_bf16 v[164:167], v[116:119], v[76:79], v[164:167]
    v_mfma_f32_16x16x32_bf16 v[168:171], v[112:115], v[52:55], v[168:171]
    v_mfma_f32_16x16x32_bf16 v[168:171], v[116:119], v[80:83], v[168:171]
    ds_read_b64_tr_b16 v[112:113], v11 offset:8448
    v_mfma_f32_16x16x32_bf16 v[172:175], v[120:123], v[28:31], v[172:175]
    ds_read_b64_tr_b16 v[114:115], v11 offset:8576
    v_mfma_f32_16x16x32_bf16 v[172:175], v[124:127], v[56:59], v[172:175]
    global_load_lds_dwordx4 v89, s[64:65]
    v_mfma_f32_16x16x32_bf16 v[176:179], v[120:123], v[32:35], v[176:179]
    s_add_u32 m0, m0, s53
    ds_read_b64_tr_b16 v[116:117], v11 offset:8960
    v_mfma_f32_16x16x32_bf16 v[176:179], v[124:127], v[60:63], v[176:179]
    ds_read_b64_tr_b16 v[118:119], v11 offset:9088
    v_mfma_f32_16x16x32_bf16 v[180:183], v[120:123], v[36:39], v[180:183]
    v_mfma_f32_16x16x32_bf16 v[180:183], v[124:127], v[64:67], v[180:183]
    v_mfma_f32_16x16x32_bf16 v[184:187], v[120:123], v[40:43], v[184:187]
    v_mfma_f32_16x16x32_bf16 v[184:187], v[124:127], v[68:71], v[184:187]
    global_load_lds_dwordx4 v90, s[64:65]
    v_mfma_f32_16x16x32_bf16 v[188:191], v[120:123], v[44:47], v[188:191]
    s_add_u32 m0, m0, s53
    v_mfma_f32_16x16x32_bf16 v[188:191], v[124:127], v[72:75], v[188:191]
    v_mfma_f32_16x16x32_bf16 v[192:195], v[120:123], v[48:51], v[192:195]
    v_mfma_f32_16x16x32_bf16 v[192:195], v[124:127], v[76:79], v[192:195]
    v_mfma_f32_16x16x32_bf16 v[196:199], v[120:123], v[52:55], v[196:199]
    v_mfma_f32_16x16x32_bf16 v[196:199], v[124:127], v[80:83], v[196:199]
    global_load_lds_dwordx4 v91, s[64:65]
    v_mfma_f32_16x16x32_bf16 v[200:203], v[128:131], v[28:31], v[200:203]
    s_add_u32 m0, m0, s53
    ds_read_b64_tr_b16 v[120:121], v11 offset:8480
    v_mfma_f32_16x16x32_bf16 v[200:203], v[132:135], v[56:59], v[200:203]
    ds_read_b64_tr_b16 v[122:123], v11 offset:8608
    v_mfma_f32_16x16x32_bf16 v[204:207], v[128:131], v[32:35], v[204:207]
    ds_read_b64_tr_b16 v[124:125], v11 offset:8992
    v_mfma_f32_16x16x32_bf16 v[204:207], v[132:135], v[60:63], v[204:207]
    ds_read_b64_tr_b16 v[126:127], v11 offset:9120
    v_mfma_f32_16x16x32_bf16 v[208:211], v[128:131], v[36:39], v[208:211]
    v_mfma_f32_16x16x32_bf16 v[208:211], v[132:135], v[64:67], v[208:211]
    global_load_lds_dwordx4 v92, s[64:65]
    v_mfma_f32_16x16x32_bf16 v[212:215], v[128:131], v[40:43], v[212:215]
    s_add_u32 m0, m0, s53
    v_mfma_f32_16x16x32_bf16 v[212:215], v[132:135], v[68:71], v[212:215]
    v_mfma_f32_16x16x32_bf16 v[216:219], v[128:131], v[44:47], v[216:219]
    v_mfma_f32_16x16x32_bf16 v[216:219], v[132:135], v[72:75], v[216:219]
    v_mfma_f32_16x16x32_bf16 v[220:223], v[128:131], v[48:51], v[220:223]
    v_mfma_f32_16x16x32_bf16 v[220:223], v[132:135], v[76:79], v[220:223]
    global_load_lds_dwordx4 v93, s[64:65]
    v_mfma_f32_16x16x32_bf16 v[224:227], v[128:131], v[52:55], v[224:227]
    s_add_u32 m0, m0, s53
    v_mfma_f32_16x16x32_bf16 v[224:227], v[132:135], v[80:83], v[224:227]
    ds_read_b64_tr_b16 v[128:129], v11 offset:8512
    v_mfma_f32_16x16x32_bf16 v[228:231], v[136:139], v[28:31], v[228:231]
    ds_read_b64_tr_b16 v[130:131], v11 offset:8640
    v_mfma_f32_16x16x32_bf16 v[228:231], v[140:143], v[56:59], v[228:231]
    ds_read_b64_tr_b16 v[132:133], v11 offset:9024
    v_mfma_f32_16x16x32_bf16 v[232:235], v[136:139], v[32:35], v[232:235]
    ds_read_b64_tr_b16 v[134:135], v11 offset:9152
    v_mfma_f32_16x16x32_bf16 v[232:235], v[140:143], v[60:63], v[232:235]
    global_load_lds_dwordx4 v94, s[64:65]
    v_mfma_f32_16x16x32_bf16 v[236:239], v[136:139], v[36:39], v[236:239]
    s_add_u32 m0, m0, s53
    v_mfma_f32_16x16x32_bf16 v[236:239], v[140:143], v[64:67], v[236:239]
    v_mfma_f32_16x16x32_bf16 v[240:243], v[136:139], v[40:43], v[240:243]
    v_mfma_f32_16x16x32_bf16 v[240:243], v[140:143], v[68:71], v[240:243]
    v_mfma_f32_16x16x32_bf16 v[244:247], v[136:139], v[44:47], v[244:247]
    v_mfma_f32_16x16x32_bf16 v[244:247], v[140:143], v[72:75], v[244:247]
    global_load_lds_dwordx4 v95, s[64:65]
    v_mfma_f32_16x16x32_bf16 v[248:251], v[136:139], v[48:51], v[248:251]
    s_waitcnt lgkmcnt(4)
    v_mfma_f32_16x16x32_bf16 v[248:251], v[140:143], v[76:79], v[248:251]
    v_mfma_f32_16x16x32_bf16 v[252:255], v[136:139], v[52:55], v[252:255]
    ds_read_b64_tr_b16 v[136:137], v11 offset:8544
    ds_read_b64_tr_b16 v[138:139], v11 offset:8672
    v_mfma_f32_16x16x32_bf16 v[252:255], v[140:143], v[80:83], v[252:255]
    ds_read_b64_tr_b16 v[140:141], v11 offset:9056
    ds_read_b64_tr_b16 v[142:143], v11 offset:9184
    v_mfma_f32_16x16x32_bf16 a[112:115], v[112:115], v[28:31], a[112:115]
    s_add_u32 m0, s33, 8448
    v_mfma_f32_16x16x32_bf16 a[112:115], v[116:119], v[56:59], a[112:115]
    s_add_u32 s49, s50, s46
    v_mfma_f32_16x16x32_bf16 a[116:119], v[112:115], v[32:35], a[116:119]
    s_lshl1_add_u32 s50, s51, s50
    v_add_u32 v104, s49, v26
    v_mfma_f32_16x16x32_bf16 a[116:119], v[116:119], v[60:63], a[116:119]
    s_add_u32 s82, s82, 2
    v_mfma_f32_16x16x32_bf16 a[120:123], v[112:115], v[36:39], a[120:123]
    s_cmp_eq_u32 s82, 20
    v_mfma_f32_16x16x32_bf16 a[120:123], v[116:119], v[64:67], a[120:123]
    s_cselect_b32 s29, s83, 0
    v_mfma_f32_16x16x32_bf16 a[124:127], v[112:115], v[40:43], a[124:127]
    s_sub_u32 s50, s50, s29
    s_waitcnt vmcnt(8) lgkmcnt(0)
    s_barrier
    ds_read_b128 a[0:3], v27 offset:16896
    v_mfma_f32_16x16x32_bf16 a[124:127], v[116:119], v[68:71], a[124:127]
    s_add_u32 s64, s16, s49
    ds_read_b128 a[4:7], v27 offset:18944
    v_mfma_f32_16x16x32_bf16 a[128:131], v[112:115], v[44:47], a[128:131]
    s_addc_u32 s65, s17, 0
    ds_read_b128 a[8:11], v27 offset:20992
    v_mfma_f32_16x16x32_bf16 a[128:131], v[116:119], v[72:75], a[128:131]
    global_load_lds_dwordx4 v88, s[64:65]
    v_mfma_f32_16x16x32_bf16 a[132:135], v[112:115], v[48:51], a[132:135]
    s_add_u32 m0, m0, s53
    ds_read_b128 a[12:15], v27 offset:23040
    v_mfma_f32_16x16x32_bf16 a[132:135], v[116:119], v[76:79], a[132:135]
    ds_read_b128 a[16:19], v27 offset:25344
    v_mfma_f32_16x16x32_bf16 a[136:139], v[112:115], v[52:55], a[136:139]
    ds_read_b128 a[20:23], v27 offset:27392
    v_mfma_f32_16x16x32_bf16 a[136:139], v[116:119], v[80:83], a[136:139]
    ds_read_b128 a[24:27], v27 offset:29440
    v_mfma_f32_16x16x32_bf16 a[140:143], v[120:123], v[28:31], a[140:143]
    ds_read_b128 a[28:31], v6 offset:16896
    v_mfma_f32_16x16x32_bf16 a[140:143], v[124:127], v[56:59], a[140:143]
    global_load_lds_dwordx4 v89, s[64:65]
    v_mfma_f32_16x16x32_bf16 a[144:147], v[120:123], v[32:35], a[144:147]
    s_add_u32 m0, m0, s53
    ds_read_b128 a[32:35], v6 offset:18944
    v_mfma_f32_16x16x32_bf16 a[144:147], v[124:127], v[60:63], a[144:147]
    ds_read_b128 a[36:39], v6 offset:20992
    v_mfma_f32_16x16x32_bf16 a[148:151], v[120:123], v[36:39], a[148:151]
    ds_read_b128 a[40:43], v6 offset:23040
    v_mfma_f32_16x16x32_bf16 a[148:151], v[124:127], v[64:67], a[148:151]
    ds_read_b128 a[44:47], v6 offset:25344
    v_mfma_f32_16x16x32_bf16 a[152:155], v[120:123], v[40:43], a[152:155]
    ds_read_b128 a[48:51], v6 offset:27392
    v_mfma_f32_16x16x32_bf16 a[152:155], v[124:127], v[68:71], a[152:155]
    global_load_lds_dwordx4 v90, s[64:65]
    v_mfma_f32_16x16x32_bf16 a[156:159], v[120:123], v[44:47], a[156:159]
    s_add_u32 m0, m0, s53
    ds_read_b128 a[52:55], v6 offset:29440
    v_mfma_f32_16x16x32_bf16 a[156:159], v[124:127], v[72:75], a[156:159]
    ds_read_b64_tr_b16 v[112:113], v11 offset:16896
    v_mfma_f32_16x16x32_bf16 a[160:163], v[120:123], v[48:51], a[160:163]
    ds_read_b64_tr_b16 v[114:115], v11 offset:17024
    v_mfma_f32_16x16x32_bf16 a[160:163], v[124:127], v[76:79], a[160:163]
    ds_read_b64_tr_b16 v[116:117], v11 offset:17408
    v_mfma_f32_16x16x32_bf16 a[164:167], v[120:123], v[52:55], a[164:167]
    ds_read_b64_tr_b16 v[118:119], v11 offset:17536
    v_mfma_f32_16x16x32_bf16 a[164:167], v[124:127], v[80:83], a[164:167]
    global_load_lds_dwordx4 v91, s[64:65]
    v_mfma_f32_16x16x32_bf16 a[168:171], v[128:131], v[28:31], a[168:171]
    s_add_u32 m0, m0, s53
    ds_read_b64_tr_b16 v[120:121], v11 offset:16928
    v_mfma_f32_16x16x32_bf16 a[168:171], v[132:135], v[56:59], a[168:171]
    ds_read_b64_tr_b16 v[122:123], v11 offset:17056
    v_mfma_f32_16x16x32_bf16 a[172:175], v[128:131], v[32:35], a[172:175]
    ds_read_b64_tr_b16 v[124:125], v11 offset:17440
    v_mfma_f32_16x16x32_bf16 a[172:175], v[132:135], v[60:63], a[172:175]
    ds_read_b64_tr_b16 v[126:127], v11 offset:17568
    v_mfma_f32_16x16x32_bf16 a[176:179], v[128:131], v[36:39], a[176:179]
    v_mfma_f32_16x16x32_bf16 a[176:179], v[132:135], v[64:67], a[176:179]
    global_load_lds_dwordx4 v92, s[64:65]
    v_mfma_f32_16x16x32_bf16 a[180:183], v[128:131], v[40:43], a[180:183]
    s_add_u32 m0, m0, s53
    v_mfma_f32_16x16x32_bf16 a[180:183], v[132:135], v[68:71], a[180:183]
    v_mfma_f32_16x16x32_bf16 a[184:187], v[128:131], v[44:47], a[184:187]
    v_mfma_f32_16x16x32_bf16 a[184:187], v[132:135], v[72:75], a[184:187]
    v_mfma_f32_16x16x32_bf16 a[188:191], v[128:131], v[48:51], a[188:191]
    v_mfma_f32_16x16x32_bf16 a[188:191], v[132:135], v[76:79], a[188:191]
    global_load_lds_dwordx4 v93, s[64:65]
    v_mfma_f32_16x16x32_bf16 a[192:195], v[128:131], v[52:55], a[192:195]
    s_add_u32 m0, m0, s53
    v_mfma_f32_16x16x32_bf16 a[192:195], v[132:135], v[80:83], a[192:195]
    ds_read_b64_tr_b16 v[128:129], v11 offset:16960
    v_mfma_f32_16x16x32_bf16 a[196:199], v[136:139], v[28:31], a[196:199]
    ds_read_b64_tr_b16 v[130:131], v11 offset:17088
    v_mfma_f32_16x16x32_bf16 a[196:199], v[140:143], v[56:59], a[196:199]
    ds_read_b64_tr_b16 v[132:133], v11 offset:17472
    v_mfma_f32_16x16x32_bf16 a[200:203], v[136:139], v[32:35], a[200:203]
    ds_read_b64_tr_b16 v[134:135], v11 offset:17600
    v_mfma_f32_16x16x32_bf16 a[200:203], v[140:143], v[60:63], a[200:203]
    buffer_load_dwordx4 v104, s[16:19], s47 offen lds
    v_mfma_f32_16x16x32_bf16 a[204:207], v[136:139], v[36:39], a[204:207]
    s_add_u32 m0, m0, s53
    v_mfma_f32_16x16x32_bf16 a[204:207], v[140:143], v[64:67], a[204:207]
    v_mfma_f32_16x16x32_bf16 a[208:211], v[136:139], v[40:43], a[208:211]
    v_mfma_f32_16x16x32_bf16 a[208:211], v[140:143], v[68:71], a[208:211]
    v_mfma_f32_16x16x32_bf16 a[212:215], v[136:139], v[44:47], a[212:215]
    v_mfma_f32_16x16x32_bf16 a[212:215], v[140:143], v[72:75], a[212:215]
    buffer_load_dwordx4 v104, s[16:19], s98 offen lds
    v_mfma_f32_16x16x32_bf16 a[216:219], v[136:139], v[48:51], a[216:219]
    s_waitcnt lgkmcnt(4)
    v_mfma_f32_16x16x32_bf16 a[216:219], v[140:143], v[76:79], a[216:219]
    v_mfma_f32_16x16x32_bf16 a[220:223], v[136:139], v[52:55], a[220:223]
    ds_read_b64_tr_b16 v[136:137], v11 offset:16992
    ds_read_b64_tr_b16 v[138:139], v11 offset:17120
    v_mfma_f32_16x16x32_bf16 a[220:223], v[140:143], v[80:83], a[220:223]
    ds_read_b64_tr_b16 v[140:141], v11 offset:17504
    ds_read_b64_tr_b16 v[142:143], v11 offset:17632
    v_mfma_f32_16x16x32_bf16 v[144:147], v[112:115], a[0:3], v[144:147]
    s_add_u32 m0, s33, 16896
    v_mfma_f32_16x16x32_bf16 v[144:147], v[116:119], a[28:31], v[144:147]
    s_mov_b32 s49, s50
    v_mfma_f32_16x16x32_bf16 v[148:151], v[112:115], a[4:7], v[148:151]
    s_add_u32 s64, s16, s49
    v_mfma_f32_16x16x32_bf16 v[148:151], v[116:119], a[32:35], v[148:151]
    s_addc_u32 s65, s17, 0
    v_mfma_f32_16x16x32_bf16 v[152:155], v[112:115], a[8:11], v[152:155]
    v_mfma_f32_16x16x32_bf16 v[152:155], v[116:119], a[36:39], v[152:155]
    v_mfma_f32_16x16x32_bf16 v[156:159], v[112:115], a[12:15], v[156:159]
    s_waitcnt vmcnt(16) lgkmcnt(0)
    s_barrier
    v_mfma_f32_16x16x32_bf16 v[156:159], v[116:119], a[40:43], v[156:159]
    v_mfma_f32_16x16x32_bf16 v[160:163], v[112:115], a[16:19], v[160:163]
    v_mfma_f32_16x16x32_bf16 v[160:163], v[116:119], a[44:47], v[160:163]
    global_load_lds_dwordx4 v88, s[64:65]
    v_mfma_f32_16x16x32_bf16 v[164:167], v[112:115], a[20:23], v[164:167]
    s_add_u32 m0, m0, s53
    v_mfma_f32_16x16x32_bf16 v[164:167], v[116:119], a[48:51], v[164:167]
    v_mfma_f32_16x16x32_bf16 v[168:171], v[112:115], a[24:27], v[168:171]
    v_mfma_f32_16x16x32_bf16 v[168:171], v[116:119], a[52:55], v[168:171]
    ds_read_b64_tr_b16 v[112:113], v11 offset:25344
    v_mfma_f32_16x16x32_bf16 v[172:175], v[120:123], a[0:3], v[172:175]
    ds_read_b64_tr_b16 v[114:115], v11 offset:25472
    v_mfma_f32_16x16x32_bf16 v[172:175], v[124:127], a[28:31], v[172:175]
    global_load_lds_dwordx4 v89, s[64:65]
    v_mfma_f32_16x16x32_bf16 v[176:179], v[120:123], a[4:7], v[176:179]
    s_add_u32 m0, m0, s53
    ds_read_b64_tr_b16 v[116:117], v11 offset:25856
    v_mfma_f32_16x16x32_bf16 v[176:179], v[124:127], a[32:35], v[176:179]
    ds_read_b64_tr_b16 v[118:119], v11 offset:25984
    v_mfma_f32_16x16x32_bf16 v[180:183], v[120:123], a[8:11], v[180:183]
    v_mfma_f32_16x16x32_bf16 v[180:183], v[124:127], a[36:39], v[180:183]
    v_mfma_f32_16x16x32_bf16 v[184:187], v[120:123], a[12:15], v[184:187]
    v_mfma_f32_16x16x32_bf16 v[184:187], v[124:127], a[40:43], v[184:187]
    global_load_lds_dwordx4 v90, s[64:65]
    v_mfma_f32_16x16x32_bf16 v[188:191], v[120:123], a[16:19], v[188:191]
    s_add_u32 m0, m0, s53
    v_mfma_f32_16x16x32_bf16 v[188:191], v[124:127], a[44:47], v[188:191]
    v_mfma_f32_16x16x32_bf16 v[192:195], v[120:123], a[20:23], v[192:195]
    v_mfma_f32_16x16x32_bf16 v[192:195], v[124:127], a[48:51], v[192:195]
    v_mfma_f32_16x16x32_bf16 v[196:199], v[120:123], a[24:27], v[196:199]
    v_mfma_f32_16x16x32_bf16 v[196:199], v[124:127], a[52:55], v[196:199]
    global_load_lds_dwordx4 v91, s[64:65]
    v_mfma_f32_16x16x32_bf16 v[200:203], v[128:131], a[0:3], v[200:203]
    s_add_u32 m0, m0, s53
    ds_read_b64_tr_b16 v[120:121], v11 offset:25376
    v_mfma_f32_16x16x32_bf16 v[200:203], v[132:135], a[28:31], v[200:203]
    ds_read_b64_tr_b16 v[122:123], v11 offset:25504
    v_mfma_f32_16x16x32_bf16 v[204:207], v[128:131], a[4:7], v[204:207]
    ds_read_b64_tr_b16 v[124:125], v11 offset:25888
    v_mfma_f32_16x16x32_bf16 v[204:207], v[132:135], a[32:35], v[204:207]
    ds_read_b64_tr_b16 v[126:127], v11 offset:26016
    v_mfma_f32_16x16x32_bf16 v[208:211], v[128:131], a[8:11], v[208:211]
    v_mfma_f32_16x16x32_bf16 v[208:211], v[132:135], a[36:39], v[208:211]
    global_load_lds_dwordx4 v92, s[64:65]
    v_mfma_f32_16x16x32_bf16 v[212:215], v[128:131], a[12:15], v[212:215]
    s_add_u32 m0, m0, s53
    v_mfma_f32_16x16x32_bf16 v[212:215], v[132:135], a[40:43], v[212:215]
    v_mfma_f32_16x16x32_bf16 v[216:219], v[128:131], a[16:19], v[216:219]
    v_mfma_f32_16x16x32_bf16 v[216:219], v[132:135], a[44:47], v[216:219]
    v_mfma_f32_16x16x32_bf16 v[220:223], v[128:131], a[20:23], v[220:223]
    v_mfma_f32_16x16x32_bf16 v[220:223], v[132:135], a[48:51], v[220:223]
    global_load_lds_dwordx4 v93, s[64:65]
    v_mfma_f32_16x16x32_bf16 v[224:227], v[128:131], a[24:27], v[224:227]
    s_add_u32 m0, m0, s53
    v_mfma_f32_16x16x32_bf16 v[224:227], v[132:135], a[52:55], v[224:227]
    ds_read_b64_tr_b16 v[128:129], v11 offset:25408
    v_mfma_f32_16x16x32_bf16 v[228:231], v[136:139], a[0:3], v[228:231]
    ds_read_b64_tr_b16 v[130:131], v11 offset:25536
    v_mfma_f32_16x16x32_bf16 v[228:231], v[140:143], a[28:31], v[228:231]
    ds_read_b64_tr_b16 v[132:133], v11 offset:25920
    v_mfma_f32_16x16x32_bf16 v[232:235], v[136:139], a[4:7], v[232:235]
    ds_read_b64_tr_b16 v[134:135], v11 offset:26048
    v_mfma_f32_16x16x32_bf16 v[232:235], v[140:143], a[32:35], v[232:235]
    global_load_lds_dwordx4 v94, s[64:65]
    v_mfma_f32_16x16x32_bf16 v[236:239], v[136:139], a[8:11], v[236:239]
    s_add_u32 m0, m0, s53
    v_mfma_f32_16x16x32_bf16 v[236:239], v[140:143], a[36:39], v[236:239]
    v_mfma_f32_16x16x32_bf16 v[240:243], v[136:139], a[12:15], v[240:243]
    v_mfma_f32_16x16x32_bf16 v[240:243], v[140:143], a[40:43], v[240:243]
    v_mfma_f32_16x16x32_bf16 v[244:247], v[136:139], a[16:19], v[244:247]
    v_mfma_f32_16x16x32_bf16 v[244:247], v[140:143], a[44:47], v[244:247]
    global_load_lds_dwordx4 v95, s[64:65]
    v_mfma_f32_16x16x32_bf16 v[248:251], v[136:139], a[20:23], v[248:251]
    s_waitcnt lgkmcnt(4)
    v_mfma_f32_16x16x32_bf16 v[248:251], v[140:143], a[48:51], v[248:251]
    v_mfma_f32_16x16x32_bf16 v[252:255], v[136:139], a[24:27], v[252:255]
    ds_read_b64_tr_b16 v[136:137], v11 offset:25440
    ds_read_b64_tr_b16 v[138:139], v11 offset:25568
    v_mfma_f32_16x16x32_bf16 v[252:255], v[140:143], a[52:55], v[252:255]
    ds_read_b64_tr_b16 v[140:141], v11 offset:25952
    ds_read_b64_tr_b16 v[142:143], v11 offset:26080
    v_mfma_f32_16x16x32_bf16 a[112:115], v[112:115], a[0:3], a[112:115]
    s_add_u32 m0, s33, 25344
    v_mfma_f32_16x16x32_bf16 a[112:115], v[116:119], a[28:31], a[112:115]
    s_add_u32 s49, s50, s46
    v_mfma_f32_16x16x32_bf16 a[116:119], v[112:115], a[4:7], a[116:119]
    s_lshl1_add_u32 s50, s51, s50
    v_add_u32 v104, s49, v26
    v_mfma_f32_16x16x32_bf16 a[116:119], v[116:119], a[32:35], a[116:119]
    s_add_u32 s82, s82, 2
    v_mfma_f32_16x16x32_bf16 a[120:123], v[112:115], a[8:11], a[120:123]
    s_cmp_eq_u32 s82, 20
    v_mfma_f32_16x16x32_bf16 a[120:123], v[116:119], a[36:39], a[120:123]
    s_cselect_b32 s29, s83, 0
    v_mfma_f32_16x16x32_bf16 a[124:127], v[112:115], a[12:15], a[124:127]
    s_sub_u32 s50, s50, s29
    s_waitcnt vmcnt(8) lgkmcnt(0)
    s_barrier
    v_mfma_f32_16x16x32_bf16 a[124:127], v[116:119], a[40:43], a[124:127]
    s_add_u32 s64, s16, s49
    v_mfma_f32_16x16x32_bf16 a[128:131], v[112:115], a[16:19], a[128:131]
    s_addc_u32 s65, s17, 0
    v_mfma_f32_16x16x32_bf16 a[128:131], v[116:119], a[44:47], a[128:131]
    global_load_lds_dwordx4 v88, s[64:65]
    v_mfma_f32_16x16x32_bf16 a[132:135], v[112:115], a[20:23], a[132:135]
    s_add_u32 m0, m0, s53
    v_mfma_f32_16x16x32_bf16 a[132:135], v[116:119], a[48:51], a[132:135]
    v_mfma_f32_16x16x32_bf16 a[136:139], v[112:115], a[24:27], a[136:139]
    v_mfma_f32_16x16x32_bf16 a[136:139], v[116:119], a[52:55], a[136:139]
    v_mfma_f32_16x16x32_bf16 a[140:143], v[120:123], a[0:3], a[140:143]
    v_mfma_f32_16x16x32_bf16 a[140:143], v[124:127], a[28:31], a[140:143]
    global_load_lds_dwordx4 v89, s[64:65]
    v_mfma_f32_16x16x32_bf16 a[144:147], v[120:123], a[4:7], a[144:147]
    s_add_u32 m0, m0, s53
    v_mfma_f32_16x16x32_bf16 a[144:147], v[124:127], a[32:35], a[144:147]
    v_mfma_f32_16x16x32_bf16 a[148:151], v[120:123], a[8:11], a[148:151]
    v_mfma_f32_16x16x32_bf16 a[148:151], v[124:127], a[36:39], a[148:151]
    v_mfma_f32_16x16x32_bf16 a[152:155], v[120:123], a[12:15], a[152:155]
    v_mfma_f32_16x16x32_bf16 a[152:155], v[124:127], a[40:43], a[152:155]
    global_load_lds_dwordx4 v90, s[64:65]
    v_mfma_f32_16x16x32_bf16 a[156:159], v[120:123], a[16:19], a[156:159]
    s_add_u32 m0, m0, s53
    v_mfma_f32_16x16x32_bf16 a[156:159], v[124:127], a[44:47], a[156:159]
    v_mfma_f32_16x16x32_bf16 a[160:163], v[120:123], a[20:23], a[160:163]
    v_mfma_f32_16x16x32_bf16 a[160:163], v[124:127], a[48:51], a[160:163]
    v_mfma_f32_16x16x32_bf16 a[164:167], v[120:123], a[24:27], a[164:167]
    v_mfma_f32_16x16x32_bf16 a[164:167], v[124:127], a[52:55], a[164:167]
    global_load_lds_dwordx4 v91, s[64:65]
    v_mfma_f32_16x16x32_bf16 a[168:171], v[128:131], a[0:3], a[168:171]
    s_add_u32 m0, m0, s53
    v_mfma_f32_16x16x32_bf16 a[168:171], v[132:135], a[28:31], a[168:171]
    v_mfma_f32_16x16x32_bf16 a[172:175], v[128:131], a[4:7], a[172:175]
    v_mfma_f32_16x16x32_bf16 a[172:175], v[132:135], a[32:35], a[172:175]
    v_mfma_f32_16x16x32_bf16 a[176:179], v[128:131], a[8:11], a[176:179]
    v_mfma_f32_16x16x32_bf16 a[176:179], v[132:135], a[36:39], a[176:179]
    global_load_lds_dwordx4 v92, s[64:65]
    v_mfma_f32_16x16x32_bf16 a[180:183], v[128:131], a[12:15], a[180:183]
    s_add_u32 m0, m0, s53
    v_mfma_f32_16x16x32_bf16 a[180:183], v[132:135], a[40:43], a[180:183]
    v_mfma_f32_16x16x32_bf16 a[184:187], v[128:131], a[16:19], a[184:187]
    v_mfma_f32_16x16x32_bf16 a[184:187], v[132:135], a[44:47], a[184:187]
    v_mfma_f32_16x16x32_bf16 a[188:191], v[128:131], a[20:23], a[188:191]
    v_mfma_f32_16x16x32_bf16 a[188:191], v[132:135], a[48:51], a[188:191]
    global_load_lds_dwordx4 v93, s[64:65]
    v_mfma_f32_16x16x32_bf16 a[192:195], v[128:131], a[24:27], a[192:195]
    s_add_u32 m0, m0, s53
    v_mfma_f32_16x16x32_bf16 a[192:195], v[132:135], a[52:55], a[192:195]
    v_mfma_f32_16x16x32_bf16 a[196:199], v[136:139], a[0:3], a[196:199]
    v_mfma_f32_16x16x32_bf16 a[196:199], v[140:143], a[28:31], a[196:199]
    v_mfma_f32_16x16x32_bf16 a[200:203], v[136:139], a[4:7], a[200:203]
    v_mfma_f32_16x16x32_bf16 a[200:203], v[140:143], a[32:35], a[200:203]
    buffer_load_dwordx4 v104, s[16:19], s47 offen lds
    v_mfma_f32_16x16x32_bf16 a[204:207], v[136:139], a[8:11], a[204:207]
    s_add_u32 m0, m0, s53
    v_mfma_f32_16x16x32_bf16 a[204:207], v[140:143], a[36:39], a[204:207]
    v_mfma_f32_16x16x32_bf16 a[208:211], v[136:139], a[12:15], a[208:211]
    v_mfma_f32_16x16x32_bf16 a[208:211], v[140:143], a[40:43], a[208:211]
    v_mfma_f32_16x16x32_bf16 a[212:215], v[136:139], a[16:19], a[212:215]
    v_mfma_f32_16x16x32_bf16 a[212:215], v[140:143], a[44:47], a[212:215]
    buffer_load_dwordx4 v104, s[16:19], s98 offen lds
    v_mfma_f32_16x16x32_bf16 a[216:219], v[136:139], a[20:23], a[216:219]
    v_mfma_f32_16x16x32_bf16 a[216:219], v[140:143], a[48:51], a[216:219]
    v_mfma_f32_16x16x32_bf16 a[220:223], v[136:139], a[24:27], a[220:223]
    v_mfma_f32_16x16x32_bf16 a[220:223], v[140:143], a[52:55], a[220:223]
L_at_qpepi:
    v_mov_b32 v4, s54
    v_mov_b32 v5, s54
    s_nop 6
    v_pk_mul_f32 v[144:145], v[144:145], v[4:5]
    v_pk_mul_f32 v[146:147], v[146:147], v[4:5]
    v_pk_mul_f32 v[148:149], v[148:149], v[4:5]
    v_pk_mul_f32 v[150:151], v[150:151], v[4:5]
    v_pk_mul_f32 v[152:153], v[152:153], v[4:5]
    v_pk_mul_f32 v[154:155], v[154:155], v[4:5]
    v_pk_mul_f32 v[156:157], v[156:157], v[4:5]
    v_pk_mul_f32 v[158:159], v[158:159], v[4:5]
    v_pk_mul_f32 v[160:161], v[160:161], v[4:5]
    v_pk_mul_f32 v[162:163], v[162:163], v[4:5]
    v_pk_mul_f32 v[164:165], v[164:165], v[4:5]
    v_pk_mul_f32 v[166:167], v[166:167], v[4:5]
    v_pk_mul_f32 v[168:169], v[168:169], v[4:5]
    v_pk_mul_f32 v[170:171], v[170:171], v[4:5]
    v_pk_mul_f32 v[172:173], v[172:173], v[4:5]
    v_pk_mul_f32 v[174:175], v[174:175], v[4:5]
    v_pk_mul_f32 v[176:177], v[176:177], v[4:5]
    v_pk_mul_f32 v[178:179], v[178:179], v[4:5]
    v_pk_mul_f32 v[180:181], v[180:181], v[4:5]
    v_pk_mul_f32 v[182:183], v[182:183], v[4:5]
    v_pk_mul_f32 v[184:185], v[184:185], v[4:5]
    v_pk_mul_f32 v[186:187], v[186:187], v[4:5]
    v_pk_mul_f32 v[188:189], v[188:189], v[4:5]
    v_pk_mul_f32 v[190:191], v[190:191], v[4:5]
    v_pk_mul_f32 v[192:193], v[192:193], v[4:5]
    v_pk_mul_f32 v[194:195], v[194:195], v[4:5]
    v_pk_mul_f32 v[196:197], v[196:197], v[4:5]
    v_pk_mul_f32 v[198:199], v[198:199], v[4:5]
    v_cvt_pk_bf16_f32 v88, v144, v145
    v_cvt_pk_bf16_f32 v89, v146, v147
    v_cvt_pk_bf16_f32 v90, v172, v173
    v_cvt_pk_bf16_f32 v91, v174, v175
    v_cvt_pk_bf16_f32 v92, v148, v149
    v_cvt_pk_bf16_f32 v93, v150, v151
    v_cvt_pk_bf16_f32 v94, v176, v177
    v_cvt_pk_bf16_f32 v95, v178, v179
    v_cvt_pk_bf16_f32 v96, v152, v153
    v_cvt_pk_bf16_f32 v97, v154, v155
    v_cvt_pk_bf16_f32 v98, v180, v181
    v_cvt_pk_bf16_f32 v99, v182, v183
    v_cvt_pk_bf16_f32 v100, v156, v157
    v_cvt_pk_bf16_f32 v101, v158, v159
    v_cvt_pk_bf16_f32 v102, v184, v185
    v_cvt_pk_bf16_f32 v103, v186, v187
    v_cvt_pk_bf16_f32 v104, v160, v161
    v_cvt_pk_bf16_f32 v105, v162, v163
    v_cvt_pk_bf16_f32 v106, v188, v189
    v_cvt_pk_bf16_f32 v107, v190, v191
    v_cvt_pk_bf16_f32 v108, v164, v165
    v_cvt_pk_bf16_f32 v109, v166, v167
    v_cvt_pk_bf16_f32 v110, v192, v193
    v_cvt_pk_bf16_f32 v111, v194, v195
    v_cvt_pk_bf16_f32 v112, v168, v169
    v_cvt_pk_bf16_f32 v113, v170, v171
    v_cvt_pk_bf16_f32 v114, v196, v197
    v_cvt_pk_bf16_f32 v115, v198, v199
    s_nop 1
    v_permlane16_swap_b32 v88, v90
    v_permlane16_swap_b32 v89, v91
    v_permlane16_swap_b32 v92, v94
    v_permlane16_swap_b32 v93, v95
    v_permlane16_swap_b32 v96, v98
    v_permlane16_swap_b32 v97, v99
    v_permlane16_swap_b32 v100, v102
    v_permlane16_swap_b32 v101, v103
    v_permlane16_swap_b32 v104, v106
    v_permlane16_swap_b32 v105, v107
    v_permlane16_swap_b32 v108, v110
    v_permlane16_swap_b32 v109, v111
    v_permlane16_swap_b32 v112, v114
    v_permlane16_swap_b32 v113, v115
    v_accvgpr_write_b32 a0, v88
    v_accvgpr_write_b32 a1, v89
    v_accvgpr_write_b32 a2, v90
    v_accvgpr_write_b32 a3, v91
    v_accvgpr_write_b32 a16, v92
    v_accvgpr_write_b32 a17, v93
    v_accvgpr_write_b32 a18, v94
    v_accvgpr_write_b32 a19, v95
    v_accvgpr_write_b32 a32, v96
    v_accvgpr_write_b32 a33, v97
    v_accvgpr_write_b32 a34, v98
    v_accvgpr_write_b32 a35, v99
    v_accvgpr_write_b32 a48, v100
    v_accvgpr_write_b32 a49, v101
    v_accvgpr_write_b32 a50, v102
    v_accvgpr_write_b32 a51, v103
    v_accvgpr_write_b32 a64, v104
    v_accvgpr_write_b32 a65, v105
    v_accvgpr_write_b32 a66, v106
    v_accvgpr_write_b32 a67, v107
    v_accvgpr_write_b32 a80, v108
    v_accvgpr_write_b32 a81, v109
    v_accvgpr_write_b32 a82, v110
    v_accvgpr_write_b32 a83, v111
    v_accvgpr_write_b32 a96, v112
    v_accvgpr_write_b32 a97, v113
    v_accvgpr_write_b32 a98, v114
    v_accvgpr_write_b32 a99, v115
    v_pk_mul_f32 v[200:201], v[200:201], v[4:5]
    v_pk_mul_f32 v[202:203], v[202:203], v[4:5]
    v_pk_mul_f32 v[204:205], v[204:205], v[4:5]
    v_pk_mul_f32 v[206:207], v[206:207], v[4:5]
    v_pk_mul_f32 v[208:209], v[208:209], v[4:5]
    v_pk_mul_f32 v[210:211], v[210:211], v[4:5]
    v_pk_mul_f32 v[212:213], v[212:213], v[4:5]
    v_pk_mul_f32 v[214:215], v[214:215], v[4:5]
    v_pk_mul_f32 v[216:217], v[216:217], v[4:5]
    v_pk_mul_f32 v[218:219], v[218:219], v[4:5]
    v_pk_mul_f32 v[220:221], v[220:221], v[4:5]
    v_pk_mul_f32 v[222:223], v[222:223], v[4:5]
    v_pk_mul_f32 v[224:225], v[224:225], v[4:5]
    v_pk_mul_f32 v[226:227], v[226:227], v[4:5]
    v_pk_mul_f32 v[228:229], v[228:229], v[4:5]
    v_pk_mul_f32 v[230:231], v[230:231], v[4:5]
    v_pk_mul_f32 v[232:233], v[232:233], v[4:5]
    v_pk_mul_f32 v[234:235], v[234:235], v[4:5]
    v_pk_mul_f32 v[236:237], v[236:237], v[4:5]
    v_pk_mul_f32 v[238:239], v[238:239], v[4:5]
    v_pk_mul_f32 v[240:241], v[240:241], v[4:5]
    v_pk_mul_f32 v[242:243], v[242:243], v[4:5]
    v_pk_mul_f32 v[244:245], v[244:245], v[4:5]
    v_pk_mul_f32 v[246:247], v[246:247], v[4:5]
    v_pk_mul_f32 v[248:249], v[248:249], v[4:5]
    v_pk_mul_f32 v[250:251], v[250:251], v[4:5]
    v_pk_mul_f32 v[252:253], v[252:253], v[4:5]
    v_pk_mul_f32 v[254:255], v[254:255], v[4:5]
    v_cvt_pk_bf16_f32 v116, v200, v201
    v_cvt_pk_bf16_f32 v117, v202, v203
    v_cvt_pk_bf16_f32 v118, v228, v229
    v_cvt_pk_bf16_f32 v119, v230, v231
    v_cvt_pk_bf16_f32 v120, v204, v205
    v_cvt_pk_bf16_f32 v121, v206, v207
    v_cvt_pk_bf16_f32 v122, v232, v233
    v_cvt_pk_bf16_f32 v123, v234, v235
    v_cvt_pk_bf16_f32 v124, v208, v209
    v_cvt_pk_bf16_f32 v125, v210, v211
    v_cvt_pk_bf16_f32 v126, v236, v237
    v_cvt_pk_bf16_f32 v127, v238, v239
    v_cvt_pk_bf16_f32 v128, v212, v213
    v_cvt_pk_bf16_f32 v129, v214, v215
    v_cvt_pk_bf16_f32 v130, v240, v241
    v_cvt_pk_bf16_f32 v131, v242, v243
    v_cvt_pk_bf16_f32 v132, v216, v217
    v_cvt_pk_bf16_f32 v133, v218, v219
    v_cvt_pk_bf16_f32 v134, v244, v245
    v_cvt_pk_bf16_f32 v135, v246, v247
    v_cvt_pk_bf16_f32 v136, v220, v221
    v_cvt_pk_bf16_f32 v137, v222, v223
    v_cvt_pk_bf16_f32 v138, v248, v249
    v_cvt_pk_bf16_f32 v139, v250, v251
    v_cvt_pk_bf16_f32 v140, v224, v225
    v_cvt_pk_bf16_f32 v141, v226, v227
    v_cvt_pk_bf16_f32 v142, v252, v253
    v_cvt_pk_bf16_f32 v143, v254, v255
    s_nop 1
    v_permlane16_swap_b32 v116, v118
    v_permlane16_swap_b32 v117, v119
    v_permlane16_swap_b32 v120, v122
    v_permlane16_swap_b32 v121, v123
    v_permlane16_swap_b32 v124, v126
    v_permlane16_swap_b32 v125, v127
    v_permlane16_swap_b32 v128, v130
    v_permlane16_swap_b32 v129, v131
    v_permlane16_swap_b32 v132, v134
    v_permlane16_swap_b32 v133, v135
    v_permlane16_swap_b32 v136, v138
    v_permlane16_swap_b32 v137, v139
    v_permlane16_swap_b32 v140, v142
    v_permlane16_swap_b32 v141, v143
    v_accvgpr_write_b32 a4, v116
    v_accvgpr_write_b32 a5, v117
    v_accvgpr_write_b32 a6, v118
    v_accvgpr_write_b32 a7, v119
    v_accvgpr_write_b32 a20, v120
    v_accvgpr_write_b32 a21, v121
    v_accvgpr_write_b32 a22, v122
    v_accvgpr_write_b32 a23, v123
    v_accvgpr_write_b32 a36, v124
    v_accvgpr_write_b32 a37, v125
    v_accvgpr_write_b32 a38, v126
    v_accvgpr_write_b32 a39, v127
    v_accvgpr_write_b32 a52, v128
    v_accvgpr_write_b32 a53, v129
    v_accvgpr_write_b32 a54, v130
    v_accvgpr_write_b32 a55, v131
    v_accvgpr_write_b32 a68, v132
    v_accvgpr_write_b32 a69, v133
    v_accvgpr_write_b32 a70, v134
    v_accvgpr_write_b32 a71, v135
    v_accvgpr_write_b32 a84, v136
    v_accvgpr_write_b32 a85, v137
    v_accvgpr_write_b32 a86, v138
    v_accvgpr_write_b32 a87, v139
    v_accvgpr_write_b32 a100, v140
    v_accvgpr_write_b32 a101, v141
    v_accvgpr_write_b32 a102, v142
    v_accvgpr_write_b32 a103, v143
    v_accvgpr_read_b32 v144, a112
    v_accvgpr_read_b32 v145, a113
    v_accvgpr_read_b32 v146, a114
    v_accvgpr_read_b32 v147, a115
    v_accvgpr_read_b32 v148, a116
    v_accvgpr_read_b32 v149, a117
    v_accvgpr_read_b32 v150, a118
    v_accvgpr_read_b32 v151, a119
    v_accvgpr_read_b32 v152, a120
    v_accvgpr_read_b32 v153, a121
    v_accvgpr_read_b32 v154, a122
    v_accvgpr_read_b32 v155, a123
    v_accvgpr_read_b32 v156, a124
    v_accvgpr_read_b32 v157, a125
    v_accvgpr_read_b32 v158, a126
    v_accvgpr_read_b32 v159, a127
    v_accvgpr_read_b32 v160, a128
    v_accvgpr_read_b32 v161, a129
    v_accvgpr_read_b32 v162, a130
    v_accvgpr_read_b32 v163, a131
    v_accvgpr_read_b32 v164, a132
    v_accvgpr_read_b32 v165, a133
    v_accvgpr_read_b32 v166, a134
    v_accvgpr_read_b32 v167, a135
    v_accvgpr_read_b32 v168, a136
    v_accvgpr_read_b32 v169, a137
    v_accvgpr_read_b32 v170, a138
    v_accvgpr_read_b32 v171, a139
    v_accvgpr_read_b32 v172, a140
    v_accvgpr_read_b32 v173, a141
    v_accvgpr_read_b32 v174, a142
    v_accvgpr_read_b32 v175, a143
    v_accvgpr_read_b32 v176, a144
    v_accvgpr_read_b32 v177, a145
    v_accvgpr_read_b32 v178, a146
    v_accvgpr_read_b32 v179, a147
    v_accvgpr_read_b32 v180, a148
    v_accvgpr_read_b32 v181, a149
    v_accvgpr_read_b32 v182, a150
    v_accvgpr_read_b32 v183, a151
    v_accvgpr_read_b32 v184, a152
    v_accvgpr_read_b32 v185, a153
    v_accvgpr_read_b32 v186, a154
    v_accvgpr_read_b32 v187, a155
    v_accvgpr_read_b32 v188, a156
    v_accvgpr_read_b32 v189, a157
    v_accvgpr_read_b32 v190, a158
    v_accvgpr_read_b32 v191, a159
    v_accvgpr_read_b32 v192, a160
    v_accvgpr_read_b32 v193, a161
    v_accvgpr_read_b32 v194, a162
    v_accvgpr_read_b32 v195, a163
    v_accvgpr_read_b32 v196, a164
    v_accvgpr_read_b32 v197, a165
    v_accvgpr_read_b32 v198, a166
    v_accvgpr_read_b32 v199, a167
    v_pk_mul_f32 v[144:145], v[144:145], v[4:5]
    v_pk_mul_f32 v[146:147], v[146:147], v[4:5]
    v_pk_mul_f32 v[148:149], v[148:149], v[4:5]
    v_pk_mul_f32 v[150:151], v[150:151], v[4:5]
    v_pk_mul_f32 v[152:153], v[152:153], v[4:5]
    v_pk_mul_f32 v[154:155], v[154:155], v[4:5]
    v_pk_mul_f32 v[156:157], v[156:157], v[4:5]
    v_pk_mul_f32 v[158:159], v[158:159], v[4:5]
    v_pk_mul_f32 v[160:161], v[160:161], v[4:5]
    v_pk_mul_f32 v[162:163], v[162:163], v[4:5]
    v_pk_mul_f32 v[164:165], v[164:165], v[4:5]
    v_pk_mul_f32 v[166:167], v[166:167], v[4:5]
    v_pk_mul_f32 v[168:169], v[168:169], v[4:5]
    v_pk_mul_f32 v[170:171], v[170:171], v[4:5]
    v_pk_mul_f32 v[172:173], v[172:173], v[4:5]
    v_pk_mul_f32 v[174:175], v[174:175], v[4:5]
    v_pk_mul_f32 v[176:177], v[176:177], v[4:5]
    v_pk_mul_f32 v[178:179], v[178:179], v[4:5]
    v_pk_mul_f32 v[180:181], v[180:181], v[4:5]
    v_pk_mul_f32 v[182:183], v[182:183], v[4:5]
    v_pk_mul_f32 v[184:185], v[184:185], v[4:5]
    v_pk_mul_f32 v[186:187], v[186:187], v[4:5]
    v_pk_mul_f32 v[188:189], v[188:189], v[4:5]
    v_pk_mul_f32 v[190:191], v[190:191], v[4:5]
    v_pk_mul_f32 v[192:193], v[192:193], v[4:5]
    v_pk_mul_f32 v[194:195], v[194:195], v[4:5]
    v_pk_mul_f32 v[196:197], v[196:197], v[4:5]
    v_pk_mul_f32 v[198:199], v[198:199], v[4:5]
    v_cvt_pk_bf16_f32 v88, v144, v145
    v_cvt_pk_bf16_f32 v89, v146, v147
    v_cvt_pk_bf16_f32 v90, v172, v173
    v_cvt_pk_bf16_f32 v91, v174, v175
    v_cvt_pk_bf16_f32 v92, v148, v149
    v_cvt_pk_bf16_f32 v93, v150, v151
    v_cvt_pk_bf16_f32 v94, v176, v177
    v_cvt_pk_bf16_f32 v95, v178, v179
    v_cvt_pk_bf16_f32 v96, v152, v153
    v_cvt_pk_bf16_f32 v97, v154, v155
    v_cvt_pk_bf16_f32 v98, v180, v181
    v_cvt_pk_bf16_f32 v99, v182, v183
    v_cvt_pk_bf16_f32 v100, v156, v157
    v_cvt_pk_bf16_f32 v101, v158, v159
    v_cvt_pk_bf16_f32 v102, v184, v185
    v_cvt_pk_bf16_f32 v103, v186, v187
    v_cvt_pk_bf16_f32 v104, v160, v161
    v_cvt_pk_bf16_f32 v105, v162, v163
    v_cvt_pk_bf16_f32 v106, v188, v189
    v_cvt_pk_bf16_f32 v107, v190, v191
    v_cvt_pk_bf16_f32 v108, v164, v165
    v_cvt_pk_bf16_f32 v109, v166, v167
    v_cvt_pk_bf16_f32 v110, v192, v193
    v_cvt_pk_bf16_f32 v111, v194, v195
    v_cvt_pk_bf16_f32 v112, v168, v169
    v_cvt_pk_bf16_f32 v113, v170, v171
    v_cvt_pk_bf16_f32 v114, v196, v197
    v_cvt_pk_bf16_f32 v115, v198, v199
    s_nop 1
    v_permlane16_swap_b32 v88, v90
    v_permlane16_swap_b32 v89, v91
    v_permlane16_swap_b32 v92, v94
    v_permlane16_swap_b32 v93, v95
    v_permlane16_swap_b32 v96, v98
    v_permlane16_swap_b32 v97, v99
    v_permlane16_swap_b32 v100, v102
    v_permlane16_swap_b32 v101, v103
    v_permlane16_swap_b32 v104, v106
    v_permlane16_swap_b32 v105, v107
    v_permlane16_swap_b32 v108, v110
    v_permlane16_swap_b32 v109, v111
    v_permlane16_swap_b32 v112, v114
    v_permlane16_swap_b32 v113, v115
    v_accvgpr_write_b32 a8, v88
    v_accvgpr_write_b32 a9, v89
    v_accvgpr_write_b32 a10, v90
    v_accvgpr_write_b32 a11, v91
    v_accvgpr_write_b32 a24, v92
    v_accvgpr_write_b32 a25, v93
    v_accvgpr_write_b32 a26, v94
    v_accvgpr_write_b32 a27, v95
    v_accvgpr_write_b32 a40, v96
    v_accvgpr_write_b32 a41, v97
    v_accvgpr_write_b32 a42, v98
    v_accvgpr_write_b32 a43, v99
    v_accvgpr_write_b32 a56, v100
    v_accvgpr_write_b32 a57, v101
    v_accvgpr_write_b32 a58, v102
    v_accvgpr_write_b32 a59, v103
    v_accvgpr_write_b32 a72, v104
    v_accvgpr_write_b32 a73, v105
    v_accvgpr_write_b32 a74, v106
    v_accvgpr_write_b32 a75, v107
    v_accvgpr_write_b32 a88, v108
    v_accvgpr_write_b32 a89, v109
    v_accvgpr_write_b32 a90, v110
    v_accvgpr_write_b32 a91, v111
    v_accvgpr_write_b32 a104, v112
    v_accvgpr_write_b32 a105, v113
    v_accvgpr_write_b32 a106, v114
    v_accvgpr_write_b32 a107, v115
    v_accvgpr_read_b32 v200, a168
    v_accvgpr_read_b32 v201, a169
    v_accvgpr_read_b32 v202, a170
    v_accvgpr_read_b32 v203, a171
    v_accvgpr_read_b32 v204, a172
    v_accvgpr_read_b32 v205, a173
    v_accvgpr_read_b32 v206, a174
    v_accvgpr_read_b32 v207, a175
    v_accvgpr_read_b32 v208, a176
    v_accvgpr_read_b32 v209, a177
    v_accvgpr_read_b32 v210, a178
    v_accvgpr_read_b32 v211, a179
    v_accvgpr_read_b32 v212, a180
    v_accvgpr_read_b32 v213, a181
    v_accvgpr_read_b32 v214, a182
    v_accvgpr_read_b32 v215, a183
    v_accvgpr_read_b32 v216, a184
    v_accvgpr_read_b32 v217, a185
    v_accvgpr_read_b32 v218, a186
    v_accvgpr_read_b32 v219, a187
    v_accvgpr_read_b32 v220, a188
    v_accvgpr_read_b32 v221, a189
    v_accvgpr_read_b32 v222, a190
    v_accvgpr_read_b32 v223, a191
    v_accvgpr_read_b32 v224, a192
    v_accvgpr_read_b32 v225, a193
    v_accvgpr_read_b32 v226, a194
    v_accvgpr_read_b32 v227, a195
    v_accvgpr_read_b32 v228, a196
    v_accvgpr_read_b32 v229, a197
    v_accvgpr_read_b32 v230, a198
    v_accvgpr_read_b32 v231, a199
    v_accvgpr_read_b32 v232, a200
    v_accvgpr_read_b32 v233, a201
    v_accvgpr_read_b32 v234, a202
    v_accvgpr_read_b32 v235, a203
    v_accvgpr_read_b32 v236, a204
    v_accvgpr_read_b32 v237, a205
    v_accvgpr_read_b32 v238, a206
    v_accvgpr_read_b32 v239, a207
    v_accvgpr_read_b32 v240, a208
    v_accvgpr_read_b32 v241, a209
    v_accvgpr_read_b32 v242, a210
    v_accvgpr_read_b32 v243, a211
    v_accvgpr_read_b32 v244, a212
    v_accvgpr_read_b32 v245, a213
    v_accvgpr_read_b32 v246, a214
    v_accvgpr_read_b32 v247, a215
    v_accvgpr_read_b32 v248, a216
    v_accvgpr_read_b32 v249, a217
    v_accvgpr_read_b32 v250, a218
    v_accvgpr_read_b32 v251, a219
    v_accvgpr_read_b32 v252, a220
    v_accvgpr_read_b32 v253, a221
    v_accvgpr_read_b32 v254, a222
    v_accvgpr_read_b32 v255, a223
    v_pk_mul_f32 v[200:201], v[200:201], v[4:5]
    v_pk_mul_f32 v[202:203], v[202:203], v[4:5]
    v_pk_mul_f32 v[204:205], v[204:205], v[4:5]
    v_pk_mul_f32 v[206:207], v[206:207], v[4:5]
    v_pk_mul_f32 v[208:209], v[208:209], v[4:5]
    v_pk_mul_f32 v[210:211], v[210:211], v[4:5]
    v_pk_mul_f32 v[212:213], v[212:213], v[4:5]
    v_pk_mul_f32 v[214:215], v[214:215], v[4:5]
    v_pk_mul_f32 v[216:217], v[216:217], v[4:5]
    v_pk_mul_f32 v[218:219], v[218:219], v[4:5]
    v_pk_mul_f32 v[220:221], v[220:221], v[4:5]
    v_pk_mul_f32 v[222:223], v[222:223], v[4:5]
    v_pk_mul_f32 v[224:225], v[224:225], v[4:5]
    v_pk_mul_f32 v[226:227], v[226:227], v[4:5]
    v_pk_mul_f32 v[228:229], v[228:229], v[4:5]
    v_pk_mul_f32 v[230:231], v[230:231], v[4:5]
    v_pk_mul_f32 v[232:233], v[232:233], v[4:5]
    v_pk_mul_f32 v[234:235], v[234:235], v[4:5]
    v_pk_mul_f32 v[236:237], v[236:237], v[4:5]
    v_pk_mul_f32 v[238:239], v[238:239], v[4:5]
    v_pk_mul_f32 v[240:241], v[240:241], v[4:5]
    v_pk_mul_f32 v[242:243], v[242:243], v[4:5]
    v_pk_mul_f32 v[244:245], v[244:245], v[4:5]
    v_pk_mul_f32 v[246:247], v[246:247], v[4:5]
    v_pk_mul_f32 v[248:249], v[248:249], v[4:5]
    v_pk_mul_f32 v[250:251], v[250:251], v[4:5]
    v_pk_mul_f32 v[252:253], v[252:253], v[4:5]
    v_pk_mul_f32 v[254:255], v[254:255], v[4:5]
    v_cvt_pk_bf16_f32 v116, v200, v201
    v_cvt_pk_bf16_f32 v117, v202, v203
    v_cvt_pk_bf16_f32 v118, v228, v229
    v_cvt_pk_bf16_f32 v119, v230, v231
    v_cvt_pk_bf16_f32 v120, v204, v205
    v_cvt_pk_bf16_f32 v121, v206, v207
    v_cvt_pk_bf16_f32 v122, v232, v233
    v_cvt_pk_bf16_f32 v123, v234, v235
    v_cvt_pk_bf16_f32 v124, v208, v209
    v_cvt_pk_bf16_f32 v125, v210, v211
    v_cvt_pk_bf16_f32 v126, v236, v237
    v_cvt_pk_bf16_f32 v127, v238, v239
    v_cvt_pk_bf16_f32 v128, v212, v213
    v_cvt_pk_bf16_f32 v129, v214, v215
    v_cvt_pk_bf16_f32 v130, v240, v241
    v_cvt_pk_bf16_f32 v131, v242, v243
    v_cvt_pk_bf16_f32 v132, v216, v217
    v_cvt_pk_bf16_f32 v133, v218, v219
    v_cvt_pk_bf16_f32 v134, v244, v245
    v_cvt_pk_bf16_f32 v135, v246, v247
    v_cvt_pk_bf16_f32 v136, v220, v221
    v_cvt_pk_bf16_f32 v137, v222, v223
    v_cvt_pk_bf16_f32 v138, v248, v249
    v_cvt_pk_bf16_f32 v139, v250, v251
    v_cvt_pk_bf16_f32 v140, v224, v225
    v_cvt_pk_bf16_f32 v141, v226, v227
    v_cvt_pk_bf16_f32 v142, v252, v253
    v_cvt_pk_bf16_f32 v143, v254, v255
    s_nop 1
    v_permlane16_swap_b32 v116, v118
    v_permlane16_swap_b32 v117, v119
    v_permlane16_swap_b32 v120, v122
    v_permlane16_swap_b32 v121, v123
    v_permlane16_swap_b32 v124, v126
    v_permlane16_swap_b32 v125, v127
    v_permlane16_swap_b32 v128, v130
    v_permlane16_swap_b32 v129, v131
    v_permlane16_swap_b32 v132, v134
    v_permlane16_swap_b32 v133, v135
    v_permlane16_swap_b32 v136, v138
    v_permlane16_swap_b32 v137, v139
    v_permlane16_swap_b32 v140, v142
    v_permlane16_swap_b32 v141, v143
    v_accvgpr_write_b32 a12, v116
    v_accvgpr_write_b32 a13, v117
    v_accvgpr_write_b32 a14, v118
    v_accvgpr_write_b32 a15, v119
    v_accvgpr_write_b32 a28, v120
    v_accvgpr_write_b32 a29, v121
    v_accvgpr_write_b32 a30, v122
    v_accvgpr_write_b32 a31, v123
    v_accvgpr_write_b32 a44, v124
    v_accvgpr_write_b32 a45, v125
    v_accvgpr_write_b32 a46, v126
    v_accvgpr_write_b32 a47, v127
    v_accvgpr_write_b32 a60, v128
    v_accvgpr_write_b32 a61, v129
    v_accvgpr_write_b32 a62, v130
    v_accvgpr_write_b32 a63, v131
    v_accvgpr_write_b32 a76, v132
    v_accvgpr_write_b32 a77, v133
    v_accvgpr_write_b32 a78, v134
    v_accvgpr_write_b32 a79, v135
    v_accvgpr_write_b32 a92, v136
    v_accvgpr_write_b32 a93, v137
    v_accvgpr_write_b32 a94, v138
    v_accvgpr_write_b32 a95, v139
    v_accvgpr_write_b32 a108, v140
    v_accvgpr_write_b32 a109, v141
    v_accvgpr_write_b32 a110, v142
    v_accvgpr_write_b32 a111, v143
    s_cmp_eq_u32 s70, 0
    s_cbranch_scc1 L_at_nostash
    s_mov_b32 s70, 0
    s_lshl_b32 s30, s2, 2
    s_add_u32 s30, s30, s20
    s_mul_i32 s30, s30, 28672
    v_lshlrev_b32 v4, 4, v1
    buffer_store_dwordx4 a[0:3], v4, s[12:15], s30 offen offset:0
    buffer_store_dwordx4 a[4:7], v4, s[12:15], s30 offen offset:1024
    buffer_store_dwordx4 a[8:11], v4, s[12:15], s30 offen offset:2048
    buffer_store_dwordx4 a[12:15], v4, s[12:15], s30 offen offset:3072
    s_add_u32 s30, s30, 4096
    buffer_store_dwordx4 a[16:19], v4, s[12:15], s30 offen offset:0
    buffer_store_dwordx4 a[20:23], v4, s[12:15], s30 offen offset:1024
    buffer_store_dwordx4 a[24:27], v4, s[12:15], s30 offen offset:2048
    buffer_store_dwordx4 a[28:31], v4, s[12:15], s30 offen offset:3072
    s_add_u32 s30, s30, 4096
    buffer_store_dwordx4 a[32:35], v4, s[12:15], s30 offen offset:0
    buffer_store_dwordx4 a[36:39], v4, s[12:15], s30 offen offset:1024
    buffer_store_dwordx4 a[40:43], v4, s[12:15], s30 offen offset:2048
    buffer_store_dwordx4 a[44:47], v4, s[12:15], s30 offen offset:3072
    s_add_u32 s30, s30, 4096
    buffer_store_dwordx4 a[48:51], v4, s[12:15], s30 offen offset:0
    buffer_store_dwordx4 a[52:55], v4, s[12:15], s30 offen offset:1024
    buffer_store_dwordx4 a[56:59], v4, s[12:15], s30 offen offset:2048
    buffer_store_dwordx4 a[60:63], v4, s[12:15], s30 offen offset:3072
    s_add_u32 s30, s30, 4096
    buffer_store_dwordx4 a[64:67], v4, s[12:15], s30 offen offset:0
    buffer_store_dwordx4 a[68:71], v4, s[12:15], s30 offen offset:1024
    buffer_store_dwordx4 a[72:75], v4, s[12:15], s30 offen offset:2048
    buffer_store_dwordx4 a[76:79], v4, s[12:15], s30 offen offset:3072
    s_add_u32 s30, s30, 4096
    buffer_store_dwordx4 a[80:83], v4, s[12:15], s30 offen offset:0
    buffer_store_dwordx4 a[84:87], v4, s[12:15], s30 offen offset:1024
    buffer_store_dwordx4 a[88:91], v4, s[12:15], s30 offen offset:2048
    buffer_store_dwordx4 a[92:95], v4, s[12:15], s30 offen offset:3072
    s_add_u32 s30, s30, 4096
    buffer_store_dwordx4 a[96:99], v4, s[12:15], s30 offen offset:0
    buffer_store_dwordx4 a[100:103], v4, s[12:15], s30 offen offset:1024
    buffer_store_dwordx4 a[104:107], v4, s[12:15], s30 offen offset:2048
    buffer_store_dwordx4 a[108:111], v4, s[12:15], s30 offen offset:3072
    s_mov_b32 s68, 3
    s_branch L_at_round
L_at_nostash:
    s_cmp_lg_u32 s25, 0
    s_cbranch_scc1 L_at_maxpass
L_at_pre:
L_at_nowo1:
    s_waitcnt lgkmcnt(0)
    v_mfma_f32_16x16x32_bf16 v[88:91], v[56:59], a[0:3], 0
    v_mov_b32 v168, 0
    v_mov_b32 v169, 0
    v_mfma_f32_16x16x32_bf16 v[88:91], v[60:63], a[4:7], v[88:91]
    v_mov_b32 v170, 0
    v_mov_b32 v171, 0
    v_mfma_f32_16x16x32_bf16 v[88:91], v[64:67], a[8:11], v[88:91]
    v_mov_b32 v196, 0
    v_mov_b32 v197, 0
    v_mfma_f32_16x16x32_bf16 v[88:91], v[68:71], a[12:15], v[88:91]
    v_mov_b32 v198, 0
    v_mov_b32 v199, 0
    v_mfma_f32_16x16x32_bf16 v[92:95], v[84:87], a[12:15], 0
    v_mov_b32 v224, 0
    v_mov_b32 v225, 0
    v_mfma_f32_16x16x32_bf16 v[92:95], v[80:83], a[8:11], v[92:95]
    v_mov_b32 v226, 0
    v_mov_b32 v227, 0
    v_mfma_f32_16x16x32_bf16 v[92:95], v[76:79], a[4:7], v[92:95]
    v_mov_b32 v252, 0
    v_mov_b32 v253, 0
    v_mfma_f32_16x16x32_bf16 v[92:95], v[72:75], a[0:3], v[92:95]
    v_mov_b32 v254, 0
    v_mov_b32 v255, 0
    v_accvgpr_write_b32 a136, 0
    v_accvgpr_write_b32 a137, 0
    v_accvgpr_write_b32 a138, 0
    v_accvgpr_write_b32 a139, 0
    v_accvgpr_write_b32 a164, 0
    v_accvgpr_write_b32 a165, 0
    v_accvgpr_write_b32 a166, 0
    v_accvgpr_write_b32 a167, 0
    v_accvgpr_write_b32 a192, 0
    v_accvgpr_write_b32 a193, 0
    v_accvgpr_write_b32 a194, 0
    v_accvgpr_write_b32 a195, 0
    v_accvgpr_write_b32 a220, 0
    v_accvgpr_write_b32 a221, 0
    v_accvgpr_write_b32 a222, 0
    v_accvgpr_write_b32 a223, 0
    v_mfma_f32_16x16x32_bf16 v[96:99], v[56:59], a[16:19], 0
    v_max3_f32 v2, v88, v89, v12
    v_max3_f32 v3, v90, v91, v92
    v_max3_f32 v2, v93, v94, v2
    v_mfma_f32_16x16x32_bf16 v[96:99], v[60:63], a[20:23], v[96:99]
    v_max3_f32 v2, v95, v2, v3
    v_mov_b32 v3, v2
    s_nop 1
    v_permlane16_swap_b32 v2, v3
    v_mfma_f32_16x16x32_bf16 v[96:99], v[64:67], a[24:27], v[96:99]
    s_nop 1
    v_max_f32 v2, v2, v3
    v_mov_b32 v3, v2
    v_mfma_f32_16x16x32_bf16 v[96:99], v[68:71], a[28:31], v[96:99]
    s_nop 1
    v_permlane32_swap_b32 v2, v3
    s_nop 1
    v_max_f32 v2, v2, v3
    v_mfma_f32_16x16x32_bf16 v[100:103], v[84:87], a[28:31], 0
    v_mov_b32 v12, 0
    v_mov_b32 v13, 0
    v_sub_f32 v88, v88, v2
    v_mfma_f32_16x16x32_bf16 v[100:103], v[80:83], a[24:27], v[100:103]
    v_sub_f32 v89, v89, v2
    v_sub_f32 v90, v90, v2
    v_sub_f32 v91, v91, v2
    v_sub_f32 v92, v92, v2
    v_mfma_f32_16x16x32_bf16 v[100:103], v[76:79], a[20:23], v[100:103]
    v_sub_f32 v93, v93, v2
    v_sub_f32 v94, v94, v2
    v_sub_f32 v95, v95, v2
    v_mfma_f32_16x16x32_bf16 v[100:103], v[72:75], a[16:19], v[100:103]
    v_sub_f32 v28, 0, v2
    v_sub_f32 v29, 0, v2
    v_sub_f32 v30, 0, v2
    v_sub_f32 v31, 0, v2
    ds_read_b64_tr_b16 v[112:113], v9 offset:0
    ds_read_b64_tr_b16 v[114:115], v9 offset:512
    v_exp_f32 v88, v88
    ds_read_b64_tr_b16 v[116:117], v9 offset:32
    ds_read_b64_tr_b16 v[118:119], v9 offset:544
    v_exp_f32 v89, v89
    v_exp_f32 v90, v90
    ds_read_b64_tr_b16 v[120:121], v9 offset:64
    ds_read_b64_tr_b16 v[122:123], v9 offset:576
    v_exp_f32 v91, v91
    v_add_f32 v12, v12, v88
    v_add_f32 v13, v13, v89
    ds_read_b64_tr_b16 v[124:125], v9 offset:96
    ds_read_b64_tr_b16 v[126:127], v9 offset:608
    v_cvt_pk_bf16_f32 v104, v88, v89
    v_exp_f32 v92, v92
    ds_read_b64_tr_b16 v[128:129], v9 offset:128
    ds_read_b64_tr_b16 v[130:131], v9 offset:640
    v_exp_f32 v93, v93
    v_add_f32 v12, v12, v90
    v_add_f32 v13, v13, v91
    ds_read_b64_tr_b16 v[132:133], v9 offset:160
    ds_read_b64_tr_b16 v[134:135], v9 offset:672
    v_cvt_pk_bf16_f32 v105, v90, v91
    v_exp_f32 v94, v94
    ds_read_b64_tr_b16 v[136:137], v9 offset:192
    ds_read_b64_tr_b16 v[138:139], v9 offset:704
    v_exp_f32 v95, v95
    v_add_f32 v12, v12, v92
    v_add_f32 v13, v13, v93
    ds_read_b64_tr_b16 v[140:141], v9 offset:224
    ds_read_b64_tr_b16 v[142:143], v9 offset:736
    v_cvt_pk_bf16_f32 v106, v92, v93
    v_add_f32 v12, v12, v94
    v_add_f32 v13, v13, v95
    v_cvt_pk_bf16_f32 v107, v94, v95
    v_mfma_f32_16x16x32_bf16 v[88:91], v[56:59], a[32:35], 0
    v_max3_f32 v2, v96, v97, v14
    v_max3_f32 v3, v98, v99, v100
    v_max3_f32 v2, v101, v102, v2
    v_mfma_f32_16x16x32_bf16 v[88:91], v[60:63], a[36:39], v[88:91]
    v_max3_f32 v2, v103, v2, v3
    v_mov_b32 v3, v2
    s_nop 1
    v_permlane16_swap_b32 v2, v3
    v_mfma_f32_16x16x32_bf16 v[88:91], v[64:67], a[40:43], v[88:91]
    s_nop 1
    v_max_f32 v2, v2, v3
    v_mov_b32 v3, v2
    v_mfma_f32_16x16x32_bf16 v[88:91], v[68:71], a[44:47], v[88:91]
    s_nop 1
    v_permlane32_swap_b32 v2, v3
    s_nop 1
    v_max_f32 v2, v2, v3
    v_mfma_f32_16x16x32_bf16 v[92:95], v[84:87], a[44:47], 0
    v_mov_b32 v14, 0
    v_mov_b32 v15, 0
    v_sub_f32 v96, v96, v2
    v_mfma_f32_16x16x32_bf16 v[92:95], v[80:83], a[40:43], v[92:95]
    v_sub_f32 v97, v97, v2
    v_sub_f32 v98, v98, v2
    v_sub_f32 v99, v99, v2
    v_sub_f32 v100, v100, v2
    v_mfma_f32_16x16x32_bf16 v[92:95], v[76:79], a[36:39], v[92:95]
    v_sub_f32 v101, v101, v2
    v_sub_f32 v102, v102, v2
    v_sub_f32 v103, v103, v2
    v_mfma_f32_16x16x32_bf16 v[92:95], v[72:75], a[32:35], v[92:95]
    v_sub_f32 v32, 0, v2
    v_sub_f32 v33, 0, v2
    v_sub_f32 v34, 0, v2
    v_sub_f32 v35, 0, v2
    s_waitcnt lgkmcnt(0)
    v_mfma_f32_16x16x32_bf16 v[144:147], v[112:115], v[104:107], 0
    v_exp_f32 v96, v96
    v_mfma_f32_16x16x32_bf16 v[172:175], v[116:119], v[104:107], 0
    v_exp_f32 v97, v97
    v_exp_f32 v98, v98
    v_mfma_f32_16x16x32_bf16 v[200:203], v[120:123], v[104:107], 0
    v_exp_f32 v99, v99
    v_add_f32 v14, v14, v96
    v_add_f32 v15, v15, v97
    v_mfma_f32_16x16x32_bf16 v[228:231], v[124:127], v[104:107], 0
    v_cvt_pk_bf16_f32 v108, v96, v97
    v_exp_f32 v100, v100
    v_mfma_f32_16x16x32_bf16 a[112:115], v[128:131], v[104:107], 0
    v_exp_f32 v101, v101
    v_add_f32 v14, v14, v98
    v_add_f32 v15, v15, v99
    v_mfma_f32_16x16x32_bf16 a[140:143], v[132:135], v[104:107], 0
    v_cvt_pk_bf16_f32 v109, v98, v99
    v_exp_f32 v102, v102
    v_mfma_f32_16x16x32_bf16 a[168:171], v[136:139], v[104:107], 0
    v_exp_f32 v103, v103
    v_add_f32 v14, v14, v100
    v_add_f32 v15, v15, v101
    v_mfma_f32_16x16x32_bf16 a[196:199], v[140:143], v[104:107], 0
    v_cvt_pk_bf16_f32 v110, v100, v101
    v_add_f32 v14, v14, v102
    v_add_f32 v15, v15, v103
    v_cvt_pk_bf16_f32 v111, v102, v103
    v_mfma_f32_16x16x32_bf16 v[96:99], v[56:59], a[48:51], 0
    v_max3_f32 v2, v88, v89, v16
    v_max3_f32 v3, v90, v91, v92
    v_max3_f32 v2, v93, v94, v2
    v_mfma_f32_16x16x32_bf16 v[96:99], v[60:63], a[52:55], v[96:99]
    v_max3_f32 v2, v95, v2, v3
    v_mov_b32 v3, v2
    s_nop 1
    v_permlane16_swap_b32 v2, v3
    v_mfma_f32_16x16x32_bf16 v[96:99], v[64:67], a[56:59], v[96:99]
    s_nop 1
    v_max_f32 v2, v2, v3
    v_mov_b32 v3, v2
    v_mfma_f32_16x16x32_bf16 v[96:99], v[68:71], a[60:63], v[96:99]
    s_nop 1
    v_permlane32_swap_b32 v2, v3
    s_nop 1
    v_max_f32 v2, v2, v3
    v_mfma_f32_16x16x32_bf16 v[100:103], v[84:87], a[60:63], 0
    v_mov_b32 v16, 0
    v_mov_b32 v17, 0
    v_sub_f32 v88, v88, v2
    v_mfma_f32_16x16x32_bf16 v[100:103], v[80:83], a[56:59], v[100:103]
    v_sub_f32 v89, v89, v2
    v_sub_f32 v90, v90, v2
    v_sub_f32 v91, v91, v2
    v_sub_f32 v92, v92, v2
    v_mfma_f32_16x16x32_bf16 v[100:103], v[76:79], a[52:55], v[100:103]
    v_sub_f32 v93, v93, v2
    v_sub_f32 v94, v94, v2
    v_sub_f32 v95, v95, v2
    v_mfma_f32_16x16x32_bf16 v[100:103], v[72:75], a[48:51], v[100:103]
    v_sub_f32 v36, 0, v2
    v_sub_f32 v37, 0, v2
    v_sub_f32 v38, 0, v2
    v_sub_f32 v39, 0, v2
    v_mfma_f32_16x16x32_bf16 v[148:151], v[112:115], v[108:111], 0
    v_exp_f32 v88, v88
    v_mfma_f32_16x16x32_bf16 v[176:179], v[116:119], v[108:111], 0
    v_exp_f32 v89, v89
    v_exp_f32 v90, v90
    v_mfma_f32_16x16x32_bf16 v[204:207], v[120:123], v[108:111], 0
    v_exp_f32 v91, v91
    v_add_f32 v16, v16, v88
    v_add_f32 v17, v17, v89
    v_mfma_f32_16x16x32_bf16 v[232:235], v[124:127], v[108:111], 0
    v_cvt_pk_bf16_f32 v104, v88, v89
    v_exp_f32 v92, v92
    v_mfma_f32_16x16x32_bf16 a[116:119], v[128:131], v[108:111], 0
    v_exp_f32 v93, v93
    v_add_f32 v16, v16, v90
    v_add_f32 v17, v17, v91
    v_mfma_f32_16x16x32_bf16 a[144:147], v[132:135], v[108:111], 0
    v_cvt_pk_bf16_f32 v105, v90, v91
    v_exp_f32 v94, v94
    v_mfma_f32_16x16x32_bf16 a[172:175], v[136:139], v[108:111], 0
    v_exp_f32 v95, v95
    v_add_f32 v16, v16, v92
    v_add_f32 v17, v17, v93
    v_mfma_f32_16x16x32_bf16 a[200:203], v[140:143], v[108:111], 0
    v_cvt_pk_bf16_f32 v106, v92, v93
    v_add_f32 v16, v16, v94
    v_add_f32 v17, v17, v95
    v_cvt_pk_bf16_f32 v107, v94, v95
    v_mfma_f32_16x16x32_bf16 v[88:91], v[56:59], a[64:67], 0
    v_max3_f32 v2, v96, v97, v18
    v_max3_f32 v3, v98, v99, v100
    v_max3_f32 v2, v101, v102, v2
    v_mfma_f32_16x16x32_bf16 v[88:91], v[60:63], a[68:71], v[88:91]
    v_max3_f32 v2, v103, v2, v3
    v_mov_b32 v3, v2
    s_nop 1
    v_permlane16_swap_b32 v2, v3
    v_mfma_f32_16x16x32_bf16 v[88:91], v[64:67], a[72:75], v[88:91]
    s_nop 1
    v_max_f32 v2, v2, v3
    v_mov_b32 v3, v2
    v_mfma_f32_16x16x32_bf16 v[88:91], v[68:71], a[76:79], v[88:91]
    s_nop 1
    v_permlane32_swap_b32 v2, v3
    s_nop 1
    v_max_f32 v2, v2, v3
    v_mfma_f32_16x16x32_bf16 v[92:95], v[84:87], a[76:79], 0
    v_mov_b32 v18, 0
    v_mov_b32 v19, 0
    v_sub_f32 v96, v96, v2
    v_mfma_f32_16x16x32_bf16 v[92:95], v[80:83], a[72:75], v[92:95]
    v_sub_f32 v97, v97, v2
    v_sub_f32 v98, v98, v2
    v_sub_f32 v99, v99, v2
    v_sub_f32 v100, v100, v2
    v_mfma_f32_16x16x32_bf16 v[92:95], v[76:79], a[68:71], v[92:95]
    v_sub_f32 v101, v101, v2
    v_sub_f32 v102, v102, v2
    v_sub_f32 v103, v103, v2
    v_mfma_f32_16x16x32_bf16 v[92:95], v[72:75], a[64:67], v[92:95]
    v_sub_f32 v40, 0, v2
    v_sub_f32 v41, 0, v2
    v_sub_f32 v42, 0, v2
    v_sub_f32 v43, 0, v2
    v_mfma_f32_16x16x32_bf16 v[152:155], v[112:115], v[104:107], 0
    v_exp_f32 v96, v96
    v_mfma_f32_16x16x32_bf16 v[180:183], v[116:119], v[104:107], 0
    v_exp_f32 v97, v97
    v_exp_f32 v98, v98
    v_mfma_f32_16x16x32_bf16 v[208:211], v[120:123], v[104:107], 0
    v_exp_f32 v99, v99
    v_add_f32 v18, v18, v96
    v_add_f32 v19, v19, v97
    v_mfma_f32_16x16x32_bf16 v[236:239], v[124:127], v[104:107], 0
    v_cvt_pk_bf16_f32 v108, v96, v97
    v_exp_f32 v100, v100
    v_mfma_f32_16x16x32_bf16 a[120:123], v[128:131], v[104:107], 0
    v_exp_f32 v101, v101
    v_add_f32 v18, v18, v98
    v_add_f32 v19, v19, v99
    v_mfma_f32_16x16x32_bf16 a[148:151], v[132:135], v[104:107], 0
    v_cvt_pk_bf16_f32 v109, v98, v99
    v_exp_f32 v102, v102
    v_mfma_f32_16x16x32_bf16 a[176:179], v[136:139], v[104:107], 0
    v_exp_f32 v103, v103
    v_add_f32 v18, v18, v100
    v_add_f32 v19, v19, v101
    v_mfma_f32_16x16x32_bf16 a[204:207], v[140:143], v[104:107], 0
    v_cvt_pk_bf16_f32 v110, v100, v101
    v_add_f32 v18, v18, v102
    v_add_f32 v19, v19, v103
    v_cvt_pk_bf16_f32 v111, v102, v103
    v_mfma_f32_16x16x32_bf16 v[96:99], v[56:59], a[80:83], 0
    v_max3_f32 v2, v88, v89, v20
    v_max3_f32 v3, v90, v91, v92
    v_max3_f32 v2, v93, v94, v2
    v_mfma_f32_16x16x32_bf16 v[96:99], v[60:63], a[84:87], v[96:99]
    v_max3_f32 v2, v95, v2, v3
    v_mov_b32 v3, v2
    s_nop 1
    v_permlane16_swap_b32 v2, v3
    v_mfma_f32_16x16x32_bf16 v[96:99], v[64:67], a[88:91], v[96:99]
    s_nop 1
    v_max_f32 v2, v2, v3
    v_mov_b32 v3, v2
    v_mfma_f32_16x16x32_bf16 v[96:99], v[68:71], a[92:95], v[96:99]
    s_nop 1
    v_permlane32_swap_b32 v2, v3
    s_nop 1
    v_max_f32 v2, v2, v3
    v_mfma_f32_16x16x32_bf16 v[100:103], v[84:87], a[92:95], 0
    v_mov_b32 v20, 0
    v_mov_b32 v21, 0
    v_sub_f32 v88, v88, v2
    v_mfma_f32_16x16x32_bf16 v[100:103], v[80:83], a[88:91], v[100:103]
    v_sub_f32 v89, v89, v2
    v_sub_f32 v90, v90, v2
    v_sub_f32 v91, v91, v2
    v_sub_f32 v92, v92, v2
    v_mfma_f32_16x16x32_bf16 v[100:103], v[76:79], a[84:87], v[100:103]
    v_sub_f32 v93, v93, v2
    v_sub_f32 v94, v94, v2
    v_sub_f32 v95, v95, v2
    v_mfma_f32_16x16x32_bf16 v[100:103], v[72:75], a[80:83], v[100:103]
    v_sub_f32 v44, 0, v2
    v_sub_f32 v45, 0, v2
    v_sub_f32 v46, 0, v2
    v_sub_f32 v47, 0, v2
    v_mfma_f32_16x16x32_bf16 v[156:159], v[112:115], v[108:111], 0
    v_exp_f32 v88, v88
    v_mfma_f32_16x16x32_bf16 v[184:187], v[116:119], v[108:111], 0
    v_exp_f32 v89, v89
    v_exp_f32 v90, v90
    v_mfma_f32_16x16x32_bf16 v[212:215], v[120:123], v[108:111], 0
    v_exp_f32 v91, v91
    v_add_f32 v20, v20, v88
    v_add_f32 v21, v21, v89
    v_mfma_f32_16x16x32_bf16 v[240:243], v[124:127], v[108:111], 0
    v_cvt_pk_bf16_f32 v104, v88, v89
    v_exp_f32 v92, v92
    v_mfma_f32_16x16x32_bf16 a[124:127], v[128:131], v[108:111], 0
    v_exp_f32 v93, v93
    v_add_f32 v20, v20, v90
    v_add_f32 v21, v21, v91
    v_mfma_f32_16x16x32_bf16 a[152:155], v[132:135], v[108:111], 0
    v_cvt_pk_bf16_f32 v105, v90, v91
    v_exp_f32 v94, v94
    v_mfma_f32_16x16x32_bf16 a[180:183], v[136:139], v[108:111], 0
    v_exp_f32 v95, v95
    v_add_f32 v20, v20, v92
    v_add_f32 v21, v21, v93
    v_mfma_f32_16x16x32_bf16 a[208:211], v[140:143], v[108:111], 0
    v_cvt_pk_bf16_f32 v106, v92, v93
    v_add_f32 v20, v20, v94
    v_add_f32 v21, v21, v95
    v_cvt_pk_bf16_f32 v107, v94, v95
    s_cmp_eq_u32 s68, 0
    s_cbranch_scc0 L_bw1_3045
    s_waitcnt vmcnt(16) lgkmcnt(0)
L_bw2_3045:
    s_barrier
    s_cmp_le_u32 s21, s27
    s_cbranch_scc1 L_at_nofb_3050
    s_sub_u32 s28, s21, 1
    s_cmp_eq_u32 s28, s23
    s_cbranch_scc1 L_at_nofb_3050
    s_lshl_b32 s29, s28, 2
    s_add_u32 s29, s29, 76000
    v_mov_b32 v4, s29
    ds_read_b32 v4, v4
    s_waitcnt lgkmcnt(0)
    v_readfirstlane_b32 s29, v4
    s_nop 3
    s_cmp_lg_u32 s29, 0
    s_cbranch_scc1 L_at_fallback
L_at_nofb_3050:
    v_mfma_f32_16x16x32_bf16 v[88:91], v[56:59], a[96:99], 0
    ds_read_b128 v[56:59], v8 offset:8448
    v_max3_f32 v2, v96, v97, v22
    v_max3_f32 v3, v98, v99, v100
    v_max3_f32 v2, v101, v102, v2
    v_mfma_f32_16x16x32_bf16 v[88:91], v[60:63], a[100:103], v[88:91]
    ds_read_b128 v[60:63], v8 offset:8512
    v_max3_f32 v2, v103, v2, v3
    v_mov_b32 v3, v2
    s_nop 1
    v_permlane16_swap_b32 v2, v3
    v_mfma_f32_16x16x32_bf16 v[88:91], v[64:67], a[104:107], v[88:91]
    ds_read_b128 v[64:67], v8 offset:8576
    s_nop 1
    v_max_f32 v2, v2, v3
    v_mov_b32 v3, v2
    v_mfma_f32_16x16x32_bf16 v[88:91], v[68:71], a[108:111], v[88:91]
    ds_read_b128 v[68:71], v8 offset:8640
    s_nop 1
    v_permlane32_swap_b32 v2, v3
    s_nop 1
    v_max_f32 v2, v2, v3
    v_mfma_f32_16x16x32_bf16 v[92:95], v[84:87], a[108:111], 0
    ds_read_b128 v[84:87], v8 offset:9152
    v_mov_b32 v22, 0
    v_mov_b32 v23, 0
    v_sub_f32 v96, v96, v2
    v_mfma_f32_16x16x32_bf16 v[92:95], v[80:83], a[104:107], v[92:95]
    ds_read_b128 v[80:83], v8 offset:9088
    v_sub_f32 v97, v97, v2
    v_sub_f32 v98, v98, v2
    v_sub_f32 v99, v99, v2
    v_sub_f32 v100, v100, v2
    v_mfma_f32_16x16x32_bf16 v[92:95], v[76:79], a[100:103], v[92:95]
    ds_read_b128 v[76:79], v8 offset:9024
    v_sub_f32 v101, v101, v2
    v_sub_f32 v102, v102, v2
    v_sub_f32 v103, v103, v2
    v_mfma_f32_16x16x32_bf16 v[92:95], v[72:75], a[96:99], v[92:95]
    ds_read_b128 v[72:75], v8 offset:8960
    v_sub_f32 v48, 0, v2
    v_sub_f32 v49, 0, v2
    v_sub_f32 v50, 0, v2
    v_sub_f32 v51, 0, v2
    v_mfma_f32_16x16x32_bf16 v[160:163], v[112:115], v[104:107], 0
    v_exp_f32 v96, v96
    v_mfma_f32_16x16x32_bf16 v[188:191], v[116:119], v[104:107], 0
    v_exp_f32 v97, v97
    v_exp_f32 v98, v98
    v_mfma_f32_16x16x32_bf16 v[216:219], v[120:123], v[104:107], 0
    v_exp_f32 v99, v99
    v_add_f32 v22, v22, v96
    v_add_f32 v23, v23, v97
    v_mfma_f32_16x16x32_bf16 v[244:247], v[124:127], v[104:107], 0
    v_cvt_pk_bf16_f32 v108, v96, v97
    v_exp_f32 v100, v100
    v_mfma_f32_16x16x32_bf16 a[128:131], v[128:131], v[104:107], 0
    v_exp_f32 v101, v101
    v_add_f32 v22, v22, v98
    v_add_f32 v23, v23, v99
    v_mfma_f32_16x16x32_bf16 a[156:159], v[132:135], v[104:107], 0
    v_cvt_pk_bf16_f32 v109, v98, v99
    v_exp_f32 v102, v102
    v_mfma_f32_16x16x32_bf16 a[184:187], v[136:139], v[104:107], 0
    v_exp_f32 v103, v103
    v_add_f32 v22, v22, v100
    v_add_f32 v23, v23, v101
    v_mfma_f32_16x16x32_bf16 a[212:215], v[140:143], v[104:107], 0
    v_cvt_pk_bf16_f32 v110, v100, v101
    v_add_f32 v22, v22, v102
    v_add_f32 v23, v23, v103
    v_cvt_pk_bf16_f32 v111, v102, v103
    s_waitcnt lgkmcnt(0)
    v_mfma_f32_16x16x32_bf16 v[96:99], v[56:59], a[0:3], v[28:31]
    v_max3_f32 v2, v88, v89, v24
    v_max3_f32 v3, v90, v91, v92
    v_max3_f32 v2, v93, v94, v2
    v_mfma_f32_16x16x32_bf16 v[96:99], v[60:63], a[4:7], v[96:99]
    v_max3_f32 v2, v95, v2, v3
    v_mov_b32 v3, v2
    s_nop 1
    v_permlane16_swap_b32 v2, v3
    v_mfma_f32_16x16x32_bf16 v[96:99], v[64:67], a[8:11], v[96:99]
    s_nop 1
    v_max_f32 v2, v2, v3
    v_mov_b32 v3, v2
    v_mfma_f32_16x16x32_bf16 v[96:99], v[68:71], a[12:15], v[96:99]
    s_nop 1
    v_permlane32_swap_b32 v2, v3
    s_nop 1
    v_max_f32 v2, v2, v3
    v_mfma_f32_16x16x32_bf16 v[100:103], v[84:87], a[12:15], v[28:31]
    v_mov_b32 v24, 0
    v_mov_b32 v25, 0
    v_sub_f32 v88, v88, v2
    v_mfma_f32_16x16x32_bf16 v[100:103], v[80:83], a[8:11], v[100:103]
    v_sub_f32 v89, v89, v2
    v_sub_f32 v90, v90, v2
    v_sub_f32 v91, v91, v2
    v_sub_f32 v92, v92, v2
    v_mfma_f32_16x16x32_bf16 v[100:103], v[76:79], a[4:7], v[100:103]
    v_sub_f32 v93, v93, v2
    v_sub_f32 v94, v94, v2
    v_sub_f32 v95, v95, v2
    v_mfma_f32_16x16x32_bf16 v[100:103], v[72:75], a[0:3], v[100:103]
    v_sub_f32 v52, 0, v2
    v_sub_f32 v53, 0, v2
    v_sub_f32 v54, 0, v2
    v_sub_f32 v55, 0, v2
    v_mfma_f32_16x16x32_bf16 v[164:167], v[112:115], v[108:111], 0
    v_exp_f32 v88, v88
    v_mfma_f32_16x16x32_bf16 v[192:195], v[116:119], v[108:111], 0
    v_exp_f32 v89, v89
    v_exp_f32 v90, v90
    v_mfma_f32_16x16x32_bf16 v[220:223], v[120:123], v[108:111], 0
    v_exp_f32 v91, v91
    v_add_f32 v24, v24, v88
    v_add_f32 v25, v25, v89
    v_mfma_f32_16x16x32_bf16 v[248:251], v[124:127], v[108:111], 0
    v_cvt_pk_bf16_f32 v104, v88, v89
    v_exp_f32 v92, v92
    v_mfma_f32_16x16x32_bf16 a[132:135], v[128:131], v[108:111], 0
    v_exp_f32 v93, v93
    v_add_f32 v24, v24, v90
    v_add_f32 v25, v25, v91
    v_mfma_f32_16x16x32_bf16 a[160:163], v[132:135], v[108:111], 0
    v_cvt_pk_bf16_f32 v105, v90, v91
    v_exp_f32 v94, v94
    v_mfma_f32_16x16x32_bf16 a[188:191], v[136:139], v[108:111], 0
    v_exp_f32 v95, v95
    v_add_f32 v24, v24, v92
    v_add_f32 v25, v25, v93
    v_mfma_f32_16x16x32_bf16 a[216:219], v[140:143], v[108:111], 0
    v_cvt_pk_bf16_f32 v106, v92, v93
    v_add_f32 v24, v24, v94
    v_add_f32 v25, v25, v95
    v_cvt_pk_bf16_f32 v107, v94, v95
    s_mov_b32 s22, 0
L_at_loop:
    v_mfma_f32_16x16x32_bf16 v[88:91], v[56:59], a[16:19], v[32:35]
    v_mfma_f32_16x16x32_bf16 v[88:91], v[60:63], a[20:23], v[88:91]
    v_exp_f32 v96, v96
    v_mfma_f32_16x16x32_bf16 v[88:91], v[64:67], a[24:27], v[88:91]
    v_exp_f32 v97, v97
    v_mfma_f32_16x16x32_bf16 v[88:91], v[68:71], a[28:31], v[88:91]
    v_exp_f32 v98, v98
    v_mfma_f32_16x16x32_bf16 v[92:95], v[84:87], a[28:31], v[32:35]
    v_exp_f32 v99, v99
    v_mfma_f32_16x16x32_bf16 v[92:95], v[80:83], a[24:27], v[92:95]
    v_add_f32 v12, v12, v96
    v_add_f32 v13, v13, v97
    v_mfma_f32_16x16x32_bf16 v[92:95], v[76:79], a[20:23], v[92:95]
    v_cvt_pk_bf16_f32 v108, v96, v97
    v_mfma_f32_16x16x32_bf16 v[92:95], v[72:75], a[16:19], v[92:95]
    v_exp_f32 v100, v100
    v_mfma_f32_16x16x32_bf16 v[168:171], v[112:115], v[104:107], v[168:171]
    ds_read_b64_tr_b16 v[112:113], v9 offset:8448
    ds_read_b64_tr_b16 v[114:115], v9 offset:8960
    v_exp_f32 v101, v101
    v_mfma_f32_16x16x32_bf16 v[196:199], v[116:119], v[104:107], v[196:199]
    ds_read_b64_tr_b16 v[116:117], v9 offset:8480
    ds_read_b64_tr_b16 v[118:119], v9 offset:8992
    v_add_f32 v12, v12, v98
    v_add_f32 v13, v13, v99
    v_mfma_f32_16x16x32_bf16 v[224:227], v[120:123], v[104:107], v[224:227]
    ds_read_b64_tr_b16 v[120:121], v9 offset:8512
    ds_read_b64_tr_b16 v[122:123], v9 offset:9024
    v_cvt_pk_bf16_f32 v109, v98, v99
    v_mfma_f32_16x16x32_bf16 v[252:255], v[124:127], v[104:107], v[252:255]
    ds_read_b64_tr_b16 v[124:125], v9 offset:8544
    ds_read_b64_tr_b16 v[126:127], v9 offset:9056
    v_exp_f32 v102, v102
    v_mfma_f32_16x16x32_bf16 a[136:139], v[128:131], v[104:107], a[136:139]
    ds_read_b64_tr_b16 v[128:129], v9 offset:8576
    ds_read_b64_tr_b16 v[130:131], v9 offset:9088
    v_exp_f32 v103, v103
    v_mfma_f32_16x16x32_bf16 a[164:167], v[132:135], v[104:107], a[164:167]
    ds_read_b64_tr_b16 v[132:133], v9 offset:8608
    ds_read_b64_tr_b16 v[134:135], v9 offset:9120
    v_add_f32 v12, v12, v100
    v_add_f32 v13, v13, v101
    v_mfma_f32_16x16x32_bf16 a[192:195], v[136:139], v[104:107], a[192:195]
    ds_read_b64_tr_b16 v[136:137], v9 offset:8640
    ds_read_b64_tr_b16 v[138:139], v9 offset:9152
    v_cvt_pk_bf16_f32 v110, v100, v101
    v_add_f32 v12, v12, v102
    v_mfma_f32_16x16x32_bf16 a[220:223], v[140:143], v[104:107], a[220:223]
    ds_read_b64_tr_b16 v[140:141], v9 offset:8672
    ds_read_b64_tr_b16 v[142:143], v9 offset:9184
    v_add_f32 v13, v13, v103
    v_cvt_pk_bf16_f32 v111, v102, v103
    v_mfma_f32_16x16x32_bf16 v[96:99], v[56:59], a[32:35], v[36:39]
    v_mfma_f32_16x16x32_bf16 v[96:99], v[60:63], a[36:39], v[96:99]
    s_add_u32 s29, s34, s100
    v_exp_f32 v88, v88
    v_mfma_f32_16x16x32_bf16 v[96:99], v[64:67], a[40:43], v[96:99]
    v_exp_f32 v89, v89
    v_mfma_f32_16x16x32_bf16 v[96:99], v[68:71], a[44:47], v[96:99]
    s_bfe_u32 s28, s29, 0x20003
    v_exp_f32 v90, v90
    v_mfma_f32_16x16x32_bf16 v[100:103], v[84:87], a[44:47], v[36:39]
    v_exp_f32 v91, v91
    v_mfma_f32_16x16x32_bf16 v[100:103], v[80:83], a[40:43], v[100:103]
    s_lshl_b32 s28, s28, 16
    v_add_f32 v14, v14, v88
    v_add_f32 v15, v15, v89
    v_mfma_f32_16x16x32_bf16 v[100:103], v[76:79], a[36:39], v[100:103]
    v_cvt_pk_bf16_f32 v104, v88, v89
    v_mfma_f32_16x16x32_bf16 v[100:103], v[72:75], a[32:35], v[100:103]
    v_exp_f32 v92, v92
    s_waitcnt lgkmcnt(0)
    v_mfma_f32_16x16x32_bf16 v[144:147], v[112:115], v[108:111], v[144:147]
    s_and_b32 s29, s29, 7
    v_exp_f32 v93, v93
    v_mfma_f32_16x16x32_bf16 v[172:175], v[116:119], v[108:111], v[172:175]
    v_add_f32 v14, v14, v90
    v_add_f32 v15, v15, v91
    v_mfma_f32_16x16x32_bf16 v[200:203], v[120:123], v[108:111], v[200:203]
    s_lshl_b32 s29, s29, 11
    v_cvt_pk_bf16_f32 v105, v90, v91
    v_mfma_f32_16x16x32_bf16 v[228:231], v[124:127], v[108:111], v[228:231]
    v_exp_f32 v94, v94
    v_mfma_f32_16x16x32_bf16 a[112:115], v[128:131], v[108:111], a[112:115]
    s_add_u32 s29, s28, s29
    v_exp_f32 v95, v95
    v_mfma_f32_16x16x32_bf16 a[140:143], v[132:135], v[108:111], a[140:143]
    v_add_f32 v14, v14, v92
    v_add_f32 v15, v15, v93
    v_mfma_f32_16x16x32_bf16 a[168:171], v[136:139], v[108:111], a[168:171]
    s_lshr_b32 s28, s34, 5
    v_cvt_pk_bf16_f32 v106, v92, v93
    v_add_f32 v14, v14, v94
    v_mfma_f32_16x16x32_bf16 a[196:199], v[140:143], v[108:111], a[196:199]
    v_add_f32 v15, v15, v95
    v_cvt_pk_bf16_f32 v107, v94, v95
    v_mfma_f32_16x16x32_bf16 v[88:91], v[56:59], a[48:51], v[40:43]
    v_mfma_f32_16x16x32_bf16 v[88:91], v[60:63], a[52:55], v[88:91]
    s_lshl_b32 s28, s28, 19
    v_exp_f32 v96, v96
    v_mfma_f32_16x16x32_bf16 v[88:91], v[64:67], a[56:59], v[88:91]
    v_exp_f32 v97, v97
    v_mfma_f32_16x16x32_bf16 v[88:91], v[68:71], a[60:63], v[88:91]
    s_add_u32 s49, s28, s29
    v_exp_f32 v98, v98
    v_mfma_f32_16x16x32_bf16 v[92:95], v[84:87], a[60:63], v[40:43]
    v_exp_f32 v99, v99
    v_mfma_f32_16x16x32_bf16 v[92:95], v[80:83], a[56:59], v[92:95]
    s_add_u32 m0, s33, 0
    v_add_f32 v16, v16, v96
    v_add_f32 v17, v17, v97
    v_mfma_f32_16x16x32_bf16 v[92:95], v[76:79], a[52:55], v[92:95]
    v_cvt_pk_bf16_f32 v108, v96, v97
    v_mfma_f32_16x16x32_bf16 v[92:95], v[72:75], a[48:51], v[92:95]
    v_exp_f32 v100, v100
    v_mfma_f32_16x16x32_bf16 v[148:151], v[112:115], v[104:107], v[148:151]
    s_add_u32 s34, s34, 1
    v_exp_f32 v101, v101
    v_mfma_f32_16x16x32_bf16 v[176:179], v[116:119], v[104:107], v[176:179]
    v_add_f32 v16, v16, v98
    v_add_f32 v17, v17, v99
    v_mfma_f32_16x16x32_bf16 v[204:207], v[120:123], v[104:107], v[204:207]
    buffer_load_dwordx4 v7, s[4:7], s49 offen offset:0 nt lds
    v_cvt_pk_bf16_f32 v109, v98, v99
    v_mfma_f32_16x16x32_bf16 v[232:235], v[124:127], v[104:107], v[232:235]
    v_exp_f32 v102, v102
    v_mfma_f32_16x16x32_bf16 a[116:119], v[128:131], v[104:107], a[116:119]
    s_add_u32 m0, m0, s96
    v_exp_f32 v103, v103
    v_mfma_f32_16x16x32_bf16 a[144:147], v[132:135], v[104:107], a[144:147]
    v_add_f32 v16, v16, v100
    v_add_f32 v17, v17, v101
    v_mfma_f32_16x16x32_bf16 a[172:175], v[136:139], v[104:107], a[172:175]
    buffer_load_dwordx4 v7, s[4:7], s49 offen offset:256 nt lds
    v_cvt_pk_bf16_f32 v110, v100, v101
    v_add_f32 v16, v16, v102
    v_mfma_f32_16x16x32_bf16 a[200:203], v[140:143], v[104:107], a[200:203]
    v_add_f32 v17, v17, v103
    v_cvt_pk_bf16_f32 v111, v102, v103
    v_mfma_f32_16x16x32_bf16 v[96:99], v[56:59], a[64:67], v[44:47]
    v_mfma_f32_16x16x32_bf16 v[96:99], v[60:63], a[68:71], v[96:99]
    s_add_u32 m0, m0, s97
    v_exp_f32 v88, v88
    v_mfma_f32_16x16x32_bf16 v[96:99], v[64:67], a[72:75], v[96:99]
    v_exp_f32 v89, v89
    v_mfma_f32_16x16x32_bf16 v[96:99], v[68:71], a[76:79], v[96:99]
    buffer_load_dwordx4 v7, s[4:7], s49 offen offset:512 nt lds
    v_exp_f32 v90, v90
    v_mfma_f32_16x16x32_bf16 v[100:103], v[84:87], a[76:79], v[44:47]
    v_exp_f32 v91, v91
    v_mfma_f32_16x16x32_bf16 v[100:103], v[80:83], a[72:75], v[100:103]
    s_add_u32 m0, m0, s96
    v_add_f32 v18, v18, v88
    v_add_f32 v19, v19, v89
    v_mfma_f32_16x16x32_bf16 v[100:103], v[76:79], a[68:71], v[100:103]
    v_cvt_pk_bf16_f32 v104, v88, v89
    v_mfma_f32_16x16x32_bf16 v[100:103], v[72:75], a[64:67], v[100:103]
    v_exp_f32 v92, v92
    v_mfma_f32_16x16x32_bf16 v[152:155], v[112:115], v[108:111], v[152:155]
    buffer_load_dwordx4 v7, s[4:7], s49 offen offset:768 nt lds
    v_exp_f32 v93, v93
    v_mfma_f32_16x16x32_bf16 v[180:183], v[116:119], v[108:111], v[180:183]
    v_add_f32 v18, v18, v90
    v_add_f32 v19, v19, v91
    v_mfma_f32_16x16x32_bf16 v[208:211], v[120:123], v[108:111], v[208:211]
    s_add_u32 m0, m0, s97
    v_cvt_pk_bf16_f32 v105, v90, v91
    v_mfma_f32_16x16x32_bf16 v[236:239], v[124:127], v[108:111], v[236:239]
    v_exp_f32 v94, v94
    v_mfma_f32_16x16x32_bf16 a[120:123], v[128:131], v[108:111], a[120:123]
    buffer_load_dwordx4 v7, s[4:7], s49 offen offset:1024 nt lds
    v_exp_f32 v95, v95
    v_mfma_f32_16x16x32_bf16 a[148:151], v[132:135], v[108:111], a[148:151]
    v_add_f32 v18, v18, v92
    v_add_f32 v19, v19, v93
    v_mfma_f32_16x16x32_bf16 a[176:179], v[136:139], v[108:111], a[176:179]
    s_add_u32 m0, m0, s96
    v_cvt_pk_bf16_f32 v106, v92, v93
    v_add_f32 v18, v18, v94
    v_mfma_f32_16x16x32_bf16 a[204:207], v[140:143], v[108:111], a[204:207]
    v_add_f32 v19, v19, v95
    v_cvt_pk_bf16_f32 v107, v94, v95
    v_mfma_f32_16x16x32_bf16 v[88:91], v[56:59], a[80:83], v[48:51]
    v_mfma_f32_16x16x32_bf16 v[88:91], v[60:63], a[84:87], v[88:91]
    buffer_load_dwordx4 v7, s[4:7], s49 offen offset:1280 nt lds
    v_exp_f32 v96, v96
    v_mfma_f32_16x16x32_bf16 v[88:91], v[64:67], a[88:91], v[88:91]
    v_exp_f32 v97, v97
    v_mfma_f32_16x16x32_bf16 v[88:91], v[68:71], a[92:95], v[88:91]
    s_add_u32 m0, m0, s97
    v_exp_f32 v98, v98
    v_mfma_f32_16x16x32_bf16 v[92:95], v[84:87], a[92:95], v[48:51]
    v_exp_f32 v99, v99
    v_mfma_f32_16x16x32_bf16 v[92:95], v[80:83], a[88:91], v[92:95]
    buffer_load_dwordx4 v7, s[4:7], s49 offen offset:1536 nt lds
    v_add_f32 v20, v20, v96
    v_add_f32 v21, v21, v97
    v_mfma_f32_16x16x32_bf16 v[92:95], v[76:79], a[84:87], v[92:95]
    v_cvt_pk_bf16_f32 v108, v96, v97
    v_mfma_f32_16x16x32_bf16 v[92:95], v[72:75], a[80:83], v[92:95]
    v_exp_f32 v100, v100
    v_mfma_f32_16x16x32_bf16 v[156:159], v[112:115], v[104:107], v[156:159]
    s_add_u32 m0, m0, s96
    v_exp_f32 v101, v101
    v_mfma_f32_16x16x32_bf16 v[184:187], v[116:119], v[104:107], v[184:187]
    v_add_f32 v20, v20, v98
    v_add_f32 v21, v21, v99
    v_mfma_f32_16x16x32_bf16 v[212:215], v[120:123], v[104:107], v[212:215]
    buffer_load_dwordx4 v7, s[4:7], s49 offen offset:1792 nt lds
    v_cvt_pk_bf16_f32 v109, v98, v99
    v_mfma_f32_16x16x32_bf16 v[240:243], v[124:127], v[104:107], v[240:243]
    v_exp_f32 v102, v102
    v_mfma_f32_16x16x32_bf16 a[124:127], v[128:131], v[104:107], a[124:127]
    v_exp_f32 v103, v103
    v_mfma_f32_16x16x32_bf16 a[152:155], v[132:135], v[104:107], a[152:155]
    v_add_f32 v20, v20, v100
    v_add_f32 v21, v21, v101
    v_mfma_f32_16x16x32_bf16 a[180:183], v[136:139], v[104:107], a[180:183]
    v_cvt_pk_bf16_f32 v110, v100, v101
    v_add_f32 v20, v20, v102
    v_mfma_f32_16x16x32_bf16 a[208:211], v[140:143], v[104:107], a[208:211]
    v_add_f32 v21, v21, v103
    v_cvt_pk_bf16_f32 v111, v102, v103
    s_cmp_eq_u32 s68, 0
    s_cbranch_scc0 L_bw1_3427
    s_waitcnt vmcnt(16) lgkmcnt(0)
L_bw2_3427:
    s_barrier
    v_mfma_f32_16x16x32_bf16 v[96:99], v[56:59], a[96:99], v[52:55]
    ds_read_b128 v[56:59], v8 offset:16896
    v_mfma_f32_16x16x32_bf16 v[96:99], v[60:63], a[100:103], v[96:99]
    ds_read_b128 v[60:63], v8 offset:16960
    v_exp_f32 v88, v88
    v_mfma_f32_16x16x32_bf16 v[96:99], v[64:67], a[104:107], v[96:99]
    ds_read_b128 v[64:67], v8 offset:17024
    v_exp_f32 v89, v89
    v_mfma_f32_16x16x32_bf16 v[96:99], v[68:71], a[108:111], v[96:99]
    ds_read_b128 v[68:71], v8 offset:17088
    v_exp_f32 v90, v90
    v_mfma_f32_16x16x32_bf16 v[100:103], v[84:87], a[108:111], v[52:55]
    ds_read_b128 v[84:87], v8 offset:17600
    v_exp_f32 v91, v91
    v_mfma_f32_16x16x32_bf16 v[100:103], v[80:83], a[104:107], v[100:103]
    ds_read_b128 v[80:83], v8 offset:17536
    v_add_f32 v22, v22, v88
    v_add_f32 v23, v23, v89
    v_mfma_f32_16x16x32_bf16 v[100:103], v[76:79], a[100:103], v[100:103]
    ds_read_b128 v[76:79], v8 offset:17472
    v_cvt_pk_bf16_f32 v104, v88, v89
    v_mfma_f32_16x16x32_bf16 v[100:103], v[72:75], a[96:99], v[100:103]
    ds_read_b128 v[72:75], v8 offset:17408
    v_exp_f32 v92, v92
    v_mfma_f32_16x16x32_bf16 v[160:163], v[112:115], v[108:111], v[160:163]
    v_exp_f32 v93, v93
    v_mfma_f32_16x16x32_bf16 v[188:191], v[116:119], v[108:111], v[188:191]
    v_add_f32 v22, v22, v90
    v_add_f32 v23, v23, v91
    v_mfma_f32_16x16x32_bf16 v[216:219], v[120:123], v[108:111], v[216:219]
    v_cvt_pk_bf16_f32 v105, v90, v91
    v_mfma_f32_16x16x32_bf16 v[244:247], v[124:127], v[108:111], v[244:247]
    v_exp_f32 v94, v94
    v_mfma_f32_16x16x32_bf16 a[128:131], v[128:131], v[108:111], a[128:131]
    v_exp_f32 v95, v95
    v_mfma_f32_16x16x32_bf16 a[156:159], v[132:135], v[108:111], a[156:159]
    v_add_f32 v22, v22, v92
    v_add_f32 v23, v23, v93
    v_mfma_f32_16x16x32_bf16 a[184:187], v[136:139], v[108:111], a[184:187]
    v_cvt_pk_bf16_f32 v106, v92, v93
    v_add_f32 v22, v22, v94
    v_mfma_f32_16x16x32_bf16 a[212:215], v[140:143], v[108:111], a[212:215]
    v_add_f32 v23, v23, v95
    v_cvt_pk_bf16_f32 v107, v94, v95
    s_waitcnt lgkmcnt(0)
    v_mfma_f32_16x16x32_bf16 v[88:91], v[56:59], a[0:3], v[28:31]
    v_mfma_f32_16x16x32_bf16 v[88:91], v[60:63], a[4:7], v[88:91]
    v_exp_f32 v96, v96
    v_mfma_f32_16x16x32_bf16 v[88:91], v[64:67], a[8:11], v[88:91]
    v_exp_f32 v97, v97
    v_mfma_f32_16x16x32_bf16 v[88:91], v[68:71], a[12:15], v[88:91]
    v_exp_f32 v98, v98
    v_mfma_f32_16x16x32_bf16 v[92:95], v[84:87], a[12:15], v[28:31]
    v_exp_f32 v99, v99
    v_mfma_f32_16x16x32_bf16 v[92:95], v[80:83], a[8:11], v[92:95]
    v_add_f32 v24, v24, v96
    v_add_f32 v25, v25, v97
    v_mfma_f32_16x16x32_bf16 v[92:95], v[76:79], a[4:7], v[92:95]
    v_cvt_pk_bf16_f32 v108, v96, v97
    v_mfma_f32_16x16x32_bf16 v[92:95], v[72:75], a[0:3], v[92:95]
    v_exp_f32 v100, v100
    v_mfma_f32_16x16x32_bf16 v[164:167], v[112:115], v[104:107], v[164:167]
    v_exp_f32 v101, v101
    v_mfma_f32_16x16x32_bf16 v[192:195], v[116:119], v[104:107], v[192:195]
    v_add_f32 v24, v24, v98
    v_add_f32 v25, v25, v99
    v_mfma_f32_16x16x32_bf16 v[220:223], v[120:123], v[104:107], v[220:223]
    v_cvt_pk_bf16_f32 v109, v98, v99
    v_mfma_f32_16x16x32_bf16 v[248:251], v[124:127], v[104:107], v[248:251]
    v_exp_f32 v102, v102
    v_mfma_f32_16x16x32_bf16 a[132:135], v[128:131], v[104:107], a[132:135]
    v_exp_f32 v103, v103
    v_mfma_f32_16x16x32_bf16 a[160:163], v[132:135], v[104:107], a[160:163]
    v_add_f32 v24, v24, v100
    v_add_f32 v25, v25, v101
    v_mfma_f32_16x16x32_bf16 a[188:191], v[136:139], v[104:107], a[188:191]
    v_cvt_pk_bf16_f32 v110, v100, v101
    v_add_f32 v24, v24, v102
    v_mfma_f32_16x16x32_bf16 a[216:219], v[140:143], v[104:107], a[216:219]
    v_add_f32 v25, v25, v103
    v_cvt_pk_bf16_f32 v111, v102, v103
    v_mfma_f32_16x16x32_bf16 v[96:99], v[56:59], a[16:19], v[32:35]
    v_mfma_f32_16x16x32_bf16 v[96:99], v[60:63], a[20:23], v[96:99]
    v_exp_f32 v88, v88
    v_mfma_f32_16x16x32_bf16 v[96:99], v[64:67], a[24:27], v[96:99]
    v_exp_f32 v89, v89
    v_mfma_f32_16x16x32_bf16 v[96:99], v[68:71], a[28:31], v[96:99]
    v_exp_f32 v90, v90
    v_mfma_f32_16x16x32_bf16 v[100:103], v[84:87], a[28:31], v[32:35]
    v_exp_f32 v91, v91
    v_mfma_f32_16x16x32_bf16 v[100:103], v[80:83], a[24:27], v[100:103]
    v_add_f32 v12, v12, v88
    v_add_f32 v13, v13, v89
    v_mfma_f32_16x16x32_bf16 v[100:103], v[76:79], a[20:23], v[100:103]
    v_cvt_pk_bf16_f32 v104, v88, v89
    v_mfma_f32_16x16x32_bf16 v[100:103], v[72:75], a[16:19], v[100:103]
    v_exp_f32 v92, v92
    v_mfma_f32_16x16x32_bf16 v[168:171], v[112:115], v[108:111], v[168:171]
    ds_read_b64_tr_b16 v[112:113], v9 offset:16896
    ds_read_b64_tr_b16 v[114:115], v9 offset:17408
    v_exp_f32 v93, v93
    v_mfma_f32_16x16x32_bf16 v[196:199], v[116:119], v[108:111], v[196:199]
    ds_read_b64_tr_b16 v[116:117], v9 offset:16928
    ds_read_b64_tr_b16 v[118:119], v9 offset:17440
    v_add_f32 v12, v12, v90
    v_add_f32 v13, v13, v91
    v_mfma_f32_16x16x32_bf16 v[224:227], v[120:123], v[108:111], v[224:227]
    ds_read_b64_tr_b16 v[120:121], v9 offset:16960
    ds_read_b64_tr_b16 v[122:123], v9 offset:17472
    v_cvt_pk_bf16_f32 v105, v90, v91
    v_mfma_f32_16x16x32_bf16 v[252:255], v[124:127], v[108:111], v[252:255]
    ds_read_b64_tr_b16 v[124:125], v9 offset:16992
    ds_read_b64_tr_b16 v[126:127], v9 offset:17504
    v_exp_f32 v94, v94
    v_mfma_f32_16x16x32_bf16 a[136:139], v[128:131], v[108:111], a[136:139]
    ds_read_b64_tr_b16 v[128:129], v9 offset:17024
    ds_read_b64_tr_b16 v[130:131], v9 offset:17536
    v_exp_f32 v95, v95
    v_mfma_f32_16x16x32_bf16 a[164:167], v[132:135], v[108:111], a[164:167]
    ds_read_b64_tr_b16 v[132:133], v9 offset:17056
    ds_read_b64_tr_b16 v[134:135], v9 offset:17568
    v_add_f32 v12, v12, v92
    v_add_f32 v13, v13, v93
    v_mfma_f32_16x16x32_bf16 a[192:195], v[136:139], v[108:111], a[192:195]
    ds_read_b64_tr_b16 v[136:137], v9 offset:17088
    ds_read_b64_tr_b16 v[138:139], v9 offset:17600
    v_cvt_pk_bf16_f32 v106, v92, v93
    v_add_f32 v12, v12, v94
    v_mfma_f32_16x16x32_bf16 a[220:223], v[140:143], v[108:111], a[220:223]
    ds_read_b64_tr_b16 v[140:141], v9 offset:17120
    ds_read_b64_tr_b16 v[142:143], v9 offset:17632
    v_add_f32 v13, v13, v95
    v_cvt_pk_bf16_f32 v107, v94, v95
    v_mfma_f32_16x16x32_bf16 v[88:91], v[56:59], a[32:35], v[36:39]
    v_mfma_f32_16x16x32_bf16 v[88:91], v[60:63], a[36:39], v[88:91]
    s_add_u32 s29, s34, s100
    v_exp_f32 v96, v96
    v_mfma_f32_16x16x32_bf16 v[88:91], v[64:67], a[40:43], v[88:91]
    v_exp_f32 v97, v97
    v_mfma_f32_16x16x32_bf16 v[88:91], v[68:71], a[44:47], v[88:91]
    s_bfe_u32 s28, s29, 0x20003
    v_exp_f32 v98, v98
    v_mfma_f32_16x16x32_bf16 v[92:95], v[84:87], a[44:47], v[36:39]
    v_exp_f32 v99, v99
    v_mfma_f32_16x16x32_bf16 v[92:95], v[80:83], a[40:43], v[92:95]
    s_lshl_b32 s28, s28, 16
    v_add_f32 v14, v14, v96
    v_add_f32 v15, v15, v97
    v_mfma_f32_16x16x32_bf16 v[92:95], v[76:79], a[36:39], v[92:95]
    v_cvt_pk_bf16_f32 v108, v96, v97
    v_mfma_f32_16x16x32_bf16 v[92:95], v[72:75], a[32:35], v[92:95]
    v_exp_f32 v100, v100
    s_waitcnt lgkmcnt(0)
    v_mfma_f32_16x16x32_bf16 v[144:147], v[112:115], v[104:107], v[144:147]
    s_and_b32 s29, s29, 7
    v_exp_f32 v101, v101
    v_mfma_f32_16x16x32_bf16 v[172:175], v[116:119], v[104:107], v[172:175]
    v_add_f32 v14, v14, v98
    v_add_f32 v15, v15, v99
    v_mfma_f32_16x16x32_bf16 v[200:203], v[120:123], v[104:107], v[200:203]
    s_lshl_b32 s29, s29, 11
    v_cvt_pk_bf16_f32 v109, v98, v99
    v_mfma_f32_16x16x32_bf16 v[228:231], v[124:127], v[104:107], v[228:231]
    v_exp_f32 v102, v102
    v_mfma_f32_16x16x32_bf16 a[112:115], v[128:131], v[104:107], a[112:115]
    s_add_u32 s29, s28, s29
    v_exp_f32 v103, v103
    v_mfma_f32_16x16x32_bf16 a[140:143], v[132:135], v[104:107], a[140:143]
    v_add_f32 v14, v14, v100
    v_add_f32 v15, v15, v101
    v_mfma_f32_16x16x32_bf16 a[168:171], v[136:139], v[104:107], a[168:171]
    s_lshr_b32 s28, s34, 5
    v_cvt_pk_bf16_f32 v110, v100, v101
    v_add_f32 v14, v14, v102
    v_mfma_f32_16x16x32_bf16 a[196:199], v[140:143], v[104:107], a[196:199]
    v_add_f32 v15, v15, v103
    v_cvt_pk_bf16_f32 v111, v102, v103
    v_mfma_f32_16x16x32_bf16 v[96:99], v[56:59], a[48:51], v[40:43]
    v_mfma_f32_16x16x32_bf16 v[96:99], v[60:63], a[52:55], v[96:99]
    s_lshl_b32 s28, s28, 19
    v_exp_f32 v88, v88
    v_mfma_f32_16x16x32_bf16 v[96:99], v[64:67], a[56:59], v[96:99]
    v_exp_f32 v89, v89
    v_mfma_f32_16x16x32_bf16 v[96:99], v[68:71], a[60:63], v[96:99]
    s_add_u32 s49, s28, s29
    v_exp_f32 v90, v90
    v_mfma_f32_16x16x32_bf16 v[100:103], v[84:87], a[60:63], v[40:43]
    v_exp_f32 v91, v91
    v_mfma_f32_16x16x32_bf16 v[100:103], v[80:83], a[56:59], v[100:103]
    s_add_u32 m0, s33, 8448
    v_add_f32 v16, v16, v88
    v_add_f32 v17, v17, v89
    v_mfma_f32_16x16x32_bf16 v[100:103], v[76:79], a[52:55], v[100:103]
    v_cvt_pk_bf16_f32 v104, v88, v89
    v_mfma_f32_16x16x32_bf16 v[100:103], v[72:75], a[48:51], v[100:103]
    v_exp_f32 v92, v92
    v_mfma_f32_16x16x32_bf16 v[148:151], v[112:115], v[108:111], v[148:151]
    s_add_u32 s34, s34, 1
    v_exp_f32 v93, v93
    v_mfma_f32_16x16x32_bf16 v[176:179], v[116:119], v[108:111], v[176:179]
    v_add_f32 v16, v16, v90
    v_add_f32 v17, v17, v91
    v_mfma_f32_16x16x32_bf16 v[204:207], v[120:123], v[108:111], v[204:207]
    buffer_load_dwordx4 v7, s[4:7], s49 offen offset:0 nt lds
    v_cvt_pk_bf16_f32 v105, v90, v91
    v_mfma_f32_16x16x32_bf16 v[232:235], v[124:127], v[108:111], v[232:235]
    v_exp_f32 v94, v94
    v_mfma_f32_16x16x32_bf16 a[116:119], v[128:131], v[108:111], a[116:119]
    s_add_u32 m0, m0, s96
    v_exp_f32 v95, v95
    v_mfma_f32_16x16x32_bf16 a[144:147], v[132:135], v[108:111], a[144:147]
    v_add_f32 v16, v16, v92
    v_add_f32 v17, v17, v93
    v_mfma_f32_16x16x32_bf16 a[172:175], v[136:139], v[108:111], a[172:175]
    buffer_load_dwordx4 v7, s[4:7], s49 offen offset:256 nt lds
    v_cvt_pk_bf16_f32 v106, v92, v93
    v_add_f32 v16, v16, v94
    v_mfma_f32_16x16x32_bf16 a[200:203], v[140:143], v[108:111], a[200:203]
    v_add_f32 v17, v17, v95
    v_cvt_pk_bf16_f32 v107, v94, v95
    v_mfma_f32_16x16x32_bf16 v[88:91], v[56:59], a[64:67], v[44:47]
    v_mfma_f32_16x16x32_bf16 v[88:91], v[60:63], a[68:71], v[88:91]
    s_add_u32 m0, m0, s97
    v_exp_f32 v96, v96
    v_mfma_f32_16x16x32_bf16 v[88:91], v[64:67], a[72:75], v[88:91]
    v_exp_f32 v97, v97
    v_mfma_f32_16x16x32_bf16 v[88:91], v[68:71], a[76:79], v[88:91]
    buffer_load_dwordx4 v7, s[4:7], s49 offen offset:512 nt lds
    v_exp_f32 v98, v98
    v_mfma_f32_16x16x32_bf16 v[92:95], v[84:87], a[76:79], v[44:47]
    v_exp_f32 v99, v99
    v_mfma_f32_16x16x32_bf16 v[92:95], v[80:83], a[72:75], v[92:95]
    s_add_u32 m0, m0, s96
    v_add_f32 v18, v18, v96
    v_add_f32 v19, v19, v97
    v_mfma_f32_16x16x32_bf16 v[92:95], v[76:79], a[68:71], v[92:95]
    v_cvt_pk_bf16_f32 v108, v96, v97
    v_mfma_f32_16x16x32_bf16 v[92:95], v[72:75], a[64:67], v[92:95]
    v_exp_f32 v100, v100
    v_mfma_f32_16x16x32_bf16 v[152:155], v[112:115], v[104:107], v[152:155]
    buffer_load_dwordx4 v7, s[4:7], s49 offen offset:768 nt lds
    v_exp_f32 v101, v101
    v_mfma_f32_16x16x32_bf16 v[180:183], v[116:119], v[104:107], v[180:183]
    v_add_f32 v18, v18, v98
    v_add_f32 v19, v19, v99
    v_mfma_f32_16x16x32_bf16 v[208:211], v[120:123], v[104:107], v[208:211]
    s_add_u32 m0, m0, s97
    v_cvt_pk_bf16_f32 v109, v98, v99
    v_mfma_f32_16x16x32_bf16 v[236:239], v[124:127], v[104:107], v[236:239]
    v_exp_f32 v102, v102
    v_mfma_f32_16x16x32_bf16 a[120:123], v[128:131], v[104:107], a[120:123]
    buffer_load_dwordx4 v7, s[4:7], s49 offen offset:1024 nt lds
    v_exp_f32 v103, v103
    v_mfma_f32_16x16x32_bf16 a[148:151], v[132:135], v[104:107], a[148:151]
    v_add_f32 v18, v18, v100
    v_add_f32 v19, v19, v101
    v_mfma_f32_16x16x32_bf16 a[176:179], v[136:139], v[104:107], a[176:179]
    s_add_u32 m0, m0, s96
    v_cvt_pk_bf16_f32 v110, v100, v101
    v_add_f32 v18, v18, v102
    v_mfma_f32_16x16x32_bf16 a[204:207], v[140:143], v[104:107], a[204:207]
    v_add_f32 v19, v19, v103
    v_cvt_pk_bf16_f32 v111, v102, v103
    v_mfma_f32_16x16x32_bf16 v[96:99], v[56:59], a[80:83], v[48:51]
    v_mfma_f32_16x16x32_bf16 v[96:99], v[60:63], a[84:87], v[96:99]
    buffer_load_dwordx4 v7, s[4:7], s49 offen offset:1280 nt lds
    v_exp_f32 v88, v88
    v_mfma_f32_16x16x32_bf16 v[96:99], v[64:67], a[88:91], v[96:99]
    v_exp_f32 v89, v89
    v_mfma_f32_16x16x32_bf16 v[96:99], v[68:71], a[92:95], v[96:99]
    s_add_u32 m0, m0, s97
    v_exp_f32 v90, v90
    v_mfma_f32_16x16x32_bf16 v[100:103], v[84:87], a[92:95], v[48:51]
    v_exp_f32 v91, v91
    v_mfma_f32_16x16x32_bf16 v[100:103], v[80:83], a[88:91], v[100:103]
    buffer_load_dwordx4 v7, s[4:7], s49 offen offset:1536 nt lds
    v_add_f32 v20, v20, v88
    v_add_f32 v21, v21, v89
    v_mfma_f32_16x16x32_bf16 v[100:103], v[76:79], a[84:87], v[100:103]
    v_cvt_pk_bf16_f32 v104, v88, v89
    v_mfma_f32_16x16x32_bf16 v[100:103], v[72:75], a[80:83], v[100:103]
    v_exp_f32 v92, v92
    v_mfma_f32_16x16x32_bf16 v[156:159], v[112:115], v[108:111], v[156:159]
    s_add_u32 m0, m0, s96
    v_exp_f32 v93, v93
    v_mfma_f32_16x16x32_bf16 v[184:187], v[116:119], v[108:111], v[184:187]
    v_add_f32 v20, v20, v90
    v_add_f32 v21, v21, v91
    v_mfma_f32_16x16x32_bf16 v[212:215], v[120:123], v[108:111], v[212:215]
    buffer_load_dwordx4 v7, s[4:7], s49 offen offset:1792 nt lds
    v_cvt_pk_bf16_f32 v105, v90, v91
    v_mfma_f32_16x16x32_bf16 v[240:243], v[124:127], v[108:111], v[240:243]
    v_exp_f32 v94, v94
    v_mfma_f32_16x16x32_bf16 a[124:127], v[128:131], v[108:111], a[124:127]
    v_exp_f32 v95, v95
    v_mfma_f32_16x16x32_bf16 a[152:155], v[132:135], v[108:111], a[152:155]
    v_add_f32 v20, v20, v92
    v_add_f32 v21, v21, v93
    v_mfma_f32_16x16x32_bf16 a[180:183], v[136:139], v[108:111], a[180:183]
    v_cvt_pk_bf16_f32 v106, v92, v93
    v_add_f32 v20, v20, v94
    v_mfma_f32_16x16x32_bf16 a[208:211], v[140:143], v[108:111], a[208:211]
    v_add_f32 v21, v21, v95
    v_cvt_pk_bf16_f32 v107, v94, v95
    s_cmp_eq_u32 s68, 0
    s_cbranch_scc0 L_bw1_3736
    s_waitcnt vmcnt(16) lgkmcnt(0)
L_bw2_3736:
    s_barrier
    v_mfma_f32_16x16x32_bf16 v[88:91], v[56:59], a[96:99], v[52:55]
    ds_read_b128 v[56:59], v8 offset:25344
    v_mfma_f32_16x16x32_bf16 v[88:91], v[60:63], a[100:103], v[88:91]
    ds_read_b128 v[60:63], v8 offset:25408
    v_exp_f32 v96, v96
    v_mfma_f32_16x16x32_bf16 v[88:91], v[64:67], a[104:107], v[88:91]
    ds_read_b128 v[64:67], v8 offset:25472
    v_exp_f32 v97, v97
    v_mfma_f32_16x16x32_bf16 v[88:91], v[68:71], a[108:111], v[88:91]
    ds_read_b128 v[68:71], v8 offset:25536
    v_exp_f32 v98, v98
    v_mfma_f32_16x16x32_bf16 v[92:95], v[84:87], a[108:111], v[52:55]
    ds_read_b128 v[84:87], v8 offset:26048
    v_exp_f32 v99, v99
    v_mfma_f32_16x16x32_bf16 v[92:95], v[80:83], a[104:107], v[92:95]
    ds_read_b128 v[80:83], v8 offset:25984
    v_add_f32 v22, v22, v96
    v_add_f32 v23, v23, v97
    v_mfma_f32_16x16x32_bf16 v[92:95], v[76:79], a[100:103], v[92:95]
    ds_read_b128 v[76:79], v8 offset:25920
    v_cvt_pk_bf16_f32 v108, v96, v97
    v_mfma_f32_16x16x32_bf16 v[92:95], v[72:75], a[96:99], v[92:95]
    ds_read_b128 v[72:75], v8 offset:25856
    v_exp_f32 v100, v100
    v_mfma_f32_16x16x32_bf16 v[160:163], v[112:115], v[104:107], v[160:163]
    v_exp_f32 v101, v101
    v_mfma_f32_16x16x32_bf16 v[188:191], v[116:119], v[104:107], v[188:191]
    v_add_f32 v22, v22, v98
    v_add_f32 v23, v23, v99
    v_mfma_f32_16x16x32_bf16 v[216:219], v[120:123], v[104:107], v[216:219]
    v_cvt_pk_bf16_f32 v109, v98, v99
    v_mfma_f32_16x16x32_bf16 v[244:247], v[124:127], v[104:107], v[244:247]
    v_exp_f32 v102, v102
    v_mfma_f32_16x16x32_bf16 a[128:131], v[128:131], v[104:107], a[128:131]
    v_exp_f32 v103, v103
    v_mfma_f32_16x16x32_bf16 a[156:159], v[132:135], v[104:107], a[156:159]
    v_add_f32 v22, v22, v100
    v_add_f32 v23, v23, v101
    v_mfma_f32_16x16x32_bf16 a[184:187], v[136:139], v[104:107], a[184:187]
    v_cvt_pk_bf16_f32 v110, v100, v101
    v_add_f32 v22, v22, v102
    v_mfma_f32_16x16x32_bf16 a[212:215], v[140:143], v[104:107], a[212:215]
    v_add_f32 v23, v23, v103
    v_cvt_pk_bf16_f32 v111, v102, v103
    s_waitcnt lgkmcnt(0)
    v_mfma_f32_16x16x32_bf16 v[96:99], v[56:59], a[0:3], v[28:31]
    v_mfma_f32_16x16x32_bf16 v[96:99], v[60:63], a[4:7], v[96:99]
    v_exp_f32 v88, v88
    v_mfma_f32_16x16x32_bf16 v[96:99], v[64:67], a[8:11], v[96:99]
    v_exp_f32 v89, v89
    v_mfma_f32_16x16x32_bf16 v[96:99], v[68:71], a[12:15], v[96:99]
    v_exp_f32 v90, v90
    v_mfma_f32_16x16x32_bf16 v[100:103], v[84:87], a[12:15], v[28:31]
    v_exp_f32 v91, v91
    v_mfma_f32_16x16x32_bf16 v[100:103], v[80:83], a[8:11], v[100:103]
    v_add_f32 v24, v24, v88
    v_add_f32 v25, v25, v89
    v_mfma_f32_16x16x32_bf16 v[100:103], v[76:79], a[4:7], v[100:103]
    v_cvt_pk_bf16_f32 v104, v88, v89
    v_mfma_f32_16x16x32_bf16 v[100:103], v[72:75], a[0:3], v[100:103]
    v_exp_f32 v92, v92
    v_mfma_f32_16x16x32_bf16 v[164:167], v[112:115], v[108:111], v[164:167]
    v_exp_f32 v93, v93
    v_mfma_f32_16x16x32_bf16 v[192:195], v[116:119], v[108:111], v[192:195]
    v_add_f32 v24, v24, v90
    v_add_f32 v25, v25, v91
    v_mfma_f32_16x16x32_bf16 v[220:223], v[120:123], v[108:111], v[220:223]
    v_cvt_pk_bf16_f32 v105, v90, v91
    v_mfma_f32_16x16x32_bf16 v[248:251], v[124:127], v[108:111], v[248:251]
    v_exp_f32 v94, v94
    v_mfma_f32_16x16x32_bf16 a[132:135], v[128:131], v[108:111], a[132:135]
    v_exp_f32 v95, v95
    v_mfma_f32_16x16x32_bf16 a[160:163], v[132:135], v[108:111], a[160:163]
    v_add_f32 v24, v24, v92
    v_add_f32 v25, v25, v93
    v_mfma_f32_16x16x32_bf16 a[188:191], v[136:139], v[108:111], a[188:191]
    v_cvt_pk_bf16_f32 v106, v92, v93
    v_add_f32 v24, v24, v94
    v_mfma_f32_16x16x32_bf16 a[216:219], v[140:143], v[108:111], a[216:219]
    v_add_f32 v25, v25, v95
    v_cvt_pk_bf16_f32 v107, v94, v95
    v_mfma_f32_16x16x32_bf16 v[88:91], v[56:59], a[16:19], v[32:35]
    v_mfma_f32_16x16x32_bf16 v[88:91], v[60:63], a[20:23], v[88:91]
    v_exp_f32 v96, v96
    v_mfma_f32_16x16x32_bf16 v[88:91], v[64:67], a[24:27], v[88:91]
    v_exp_f32 v97, v97
    v_mfma_f32_16x16x32_bf16 v[88:91], v[68:71], a[28:31], v[88:91]
    v_exp_f32 v98, v98
    v_mfma_f32_16x16x32_bf16 v[92:95], v[84:87], a[28:31], v[32:35]
    v_exp_f32 v99, v99
    v_mfma_f32_16x16x32_bf16 v[92:95], v[80:83], a[24:27], v[92:95]
    v_add_f32 v12, v12, v96
    v_add_f32 v13, v13, v97
    v_mfma_f32_16x16x32_bf16 v[92:95], v[76:79], a[20:23], v[92:95]
    v_cvt_pk_bf16_f32 v108, v96, v97
    v_mfma_f32_16x16x32_bf16 v[92:95], v[72:75], a[16:19], v[92:95]
    v_exp_f32 v100, v100
    v_mfma_f32_16x16x32_bf16 v[168:171], v[112:115], v[104:107], v[168:171]
    ds_read_b64_tr_b16 v[112:113], v9 offset:25344
    ds_read_b64_tr_b16 v[114:115], v9 offset:25856
    v_exp_f32 v101, v101
    v_mfma_f32_16x16x32_bf16 v[196:199], v[116:119], v[104:107], v[196:199]
    ds_read_b64_tr_b16 v[116:117], v9 offset:25376
    ds_read_b64_tr_b16 v[118:119], v9 offset:25888
    v_add_f32 v12, v12, v98
    v_add_f32 v13, v13, v99
    v_mfma_f32_16x16x32_bf16 v[224:227], v[120:123], v[104:107], v[224:227]
    ds_read_b64_tr_b16 v[120:121], v9 offset:25408
    ds_read_b64_tr_b16 v[122:123], v9 offset:25920
    v_cvt_pk_bf16_f32 v109, v98, v99
    v_mfma_f32_16x16x32_bf16 v[252:255], v[124:127], v[104:107], v[252:255]
    ds_read_b64_tr_b16 v[124:125], v9 offset:25440
    ds_read_b64_tr_b16 v[126:127], v9 offset:25952
    v_exp_f32 v102, v102
    v_mfma_f32_16x16x32_bf16 a[136:139], v[128:131], v[104:107], a[136:139]
    ds_read_b64_tr_b16 v[128:129], v9 offset:25472
    ds_read_b64_tr_b16 v[130:131], v9 offset:25984
    v_exp_f32 v103, v103
    v_mfma_f32_16x16x32_bf16 a[164:167], v[132:135], v[104:107], a[164:167]
    ds_read_b64_tr_b16 v[132:133], v9 offset:25504
    ds_read_b64_tr_b16 v[134:135], v9 offset:26016
    v_add_f32 v12, v12, v100
    v_add_f32 v13, v13, v101
    v_mfma_f32_16x16x32_bf16 a[192:195], v[136:139], v[104:107], a[192:195]
    ds_read_b64_tr_b16 v[136:137], v9 offset:25536
    ds_read_b64_tr_b16 v[138:139], v9 offset:26048
    v_cvt_pk_bf16_f32 v110, v100, v101
    v_add_f32 v12, v12, v102
    v_mfma_f32_16x16x32_bf16 a[220:223], v[140:143], v[104:107], a[220:223]
    ds_read_b64_tr_b16 v[140:141], v9 offset:25568
    ds_read_b64_tr_b16 v[142:143], v9 offset:26080
    v_add_f32 v13, v13, v103
    v_cvt_pk_bf16_f32 v111, v102, v103
    v_mfma_f32_16x16x32_bf16 v[96:99], v[56:59], a[32:35], v[36:39]
    v_mfma_f32_16x16x32_bf16 v[96:99], v[60:63], a[36:39], v[96:99]
    s_add_u32 s29, s34, s100
    v_exp_f32 v88, v88
    v_mfma_f32_16x16x32_bf16 v[96:99], v[64:67], a[40:43], v[96:99]
    v_exp_f32 v89, v89
    v_mfma_f32_16x16x32_bf16 v[96:99], v[68:71], a[44:47], v[96:99]
    s_bfe_u32 s28, s29, 0x20003
    v_exp_f32 v90, v90
    v_mfma_f32_16x16x32_bf16 v[100:103], v[84:87], a[44:47], v[36:39]
    v_exp_f32 v91, v91
    v_mfma_f32_16x16x32_bf16 v[100:103], v[80:83], a[40:43], v[100:103]
    s_lshl_b32 s28, s28, 16
    v_add_f32 v14, v14, v88
    v_add_f32 v15, v15, v89
    v_mfma_f32_16x16x32_bf16 v[100:103], v[76:79], a[36:39], v[100:103]
    v_cvt_pk_bf16_f32 v104, v88, v89
    v_mfma_f32_16x16x32_bf16 v[100:103], v[72:75], a[32:35], v[100:103]
    v_exp_f32 v92, v92
    s_waitcnt lgkmcnt(0)
    v_mfma_f32_16x16x32_bf16 v[144:147], v[112:115], v[108:111], v[144:147]
    s_and_b32 s29, s29, 7
    v_exp_f32 v93, v93
    v_mfma_f32_16x16x32_bf16 v[172:175], v[116:119], v[108:111], v[172:175]
    v_add_f32 v14, v14, v90
    v_add_f32 v15, v15, v91
    v_mfma_f32_16x16x32_bf16 v[200:203], v[120:123], v[108:111], v[200:203]
    s_lshl_b32 s29, s29, 11
    v_cvt_pk_bf16_f32 v105, v90, v91
    v_mfma_f32_16x16x32_bf16 v[228:231], v[124:127], v[108:111], v[228:231]
    v_exp_f32 v94, v94
    v_mfma_f32_16x16x32_bf16 a[112:115], v[128:131], v[108:111], a[112:115]
    s_add_u32 s29, s28, s29
    v_exp_f32 v95, v95
    v_mfma_f32_16x16x32_bf16 a[140:143], v[132:135], v[108:111], a[140:143]
    v_add_f32 v14, v14, v92
    v_add_f32 v15, v15, v93
    v_mfma_f32_16x16x32_bf16 a[168:171], v[136:139], v[108:111], a[168:171]
    s_lshr_b32 s28, s34, 5
    v_cvt_pk_bf16_f32 v106, v92, v93
    v_add_f32 v14, v14, v94
    v_mfma_f32_16x16x32_bf16 a[196:199], v[140:143], v[108:111], a[196:199]
    v_add_f32 v15, v15, v95
    v_cvt_pk_bf16_f32 v107, v94, v95
    v_mfma_f32_16x16x32_bf16 v[88:91], v[56:59], a[48:51], v[40:43]
    v_mfma_f32_16x16x32_bf16 v[88:91], v[60:63], a[52:55], v[88:91]
    s_lshl_b32 s28, s28, 19
    v_exp_f32 v96, v96
    v_mfma_f32_16x16x32_bf16 v[88:91], v[64:67], a[56:59], v[88:91]
    v_exp_f32 v97, v97
    v_mfma_f32_16x16x32_bf16 v[88:91], v[68:71], a[60:63], v[88:91]
    s_add_u32 s49, s28, s29
    v_exp_f32 v98, v98
    v_mfma_f32_16x16x32_bf16 v[92:95], v[84:87], a[60:63], v[40:43]
    v_exp_f32 v99, v99
    v_mfma_f32_16x16x32_bf16 v[92:95], v[80:83], a[56:59], v[92:95]
    s_add_u32 m0, s33, 16896
    v_add_f32 v16, v16, v96
    v_add_f32 v17, v17, v97
    v_mfma_f32_16x16x32_bf16 v[92:95], v[76:79], a[52:55], v[92:95]
    v_cvt_pk_bf16_f32 v108, v96, v97
    v_mfma_f32_16x16x32_bf16 v[92:95], v[72:75], a[48:51], v[92:95]
    v_exp_f32 v100, v100
    v_mfma_f32_16x16x32_bf16 v[148:151], v[112:115], v[104:107], v[148:151]
    s_add_u32 s34, s34, 1
    v_exp_f32 v101, v101
    v_mfma_f32_16x16x32_bf16 v[176:179], v[116:119], v[104:107], v[176:179]
    v_add_f32 v16, v16, v98
    v_add_f32 v17, v17, v99
    v_mfma_f32_16x16x32_bf16 v[204:207], v[120:123], v[104:107], v[204:207]
    buffer_load_dwordx4 v7, s[4:7], s49 offen offset:0 nt lds
    v_cvt_pk_bf16_f32 v109, v98, v99
    v_mfma_f32_16x16x32_bf16 v[232:235], v[124:127], v[104:107], v[232:235]
    v_exp_f32 v102, v102
    v_mfma_f32_16x16x32_bf16 a[116:119], v[128:131], v[104:107], a[116:119]
    s_add_u32 m0, m0, s96
    v_exp_f32 v103, v103
    v_mfma_f32_16x16x32_bf16 a[144:147], v[132:135], v[104:107], a[144:147]
    v_add_f32 v16, v16, v100
    v_add_f32 v17, v17, v101
    v_mfma_f32_16x16x32_bf16 a[172:175], v[136:139], v[104:107], a[172:175]
    buffer_load_dwordx4 v7, s[4:7], s49 offen offset:256 nt lds
    v_cvt_pk_bf16_f32 v110, v100, v101
    v_add_f32 v16, v16, v102
    v_mfma_f32_16x16x32_bf16 a[200:203], v[140:143], v[104:107], a[200:203]
    v_add_f32 v17, v17, v103
    v_cvt_pk_bf16_f32 v111, v102, v103
    v_mfma_f32_16x16x32_bf16 v[96:99], v[56:59], a[64:67], v[44:47]
    v_mfma_f32_16x16x32_bf16 v[96:99], v[60:63], a[68:71], v[96:99]
    s_add_u32 m0, m0, s97
    v_exp_f32 v88, v88
    v_mfma_f32_16x16x32_bf16 v[96:99], v[64:67], a[72:75], v[96:99]
    v_exp_f32 v89, v89
    v_mfma_f32_16x16x32_bf16 v[96:99], v[68:71], a[76:79], v[96:99]
    buffer_load_dwordx4 v7, s[4:7], s49 offen offset:512 nt lds
    v_exp_f32 v90, v90
    v_mfma_f32_16x16x32_bf16 v[100:103], v[84:87], a[76:79], v[44:47]
    v_exp_f32 v91, v91
    v_mfma_f32_16x16x32_bf16 v[100:103], v[80:83], a[72:75], v[100:103]
    s_add_u32 m0, m0, s96
    v_add_f32 v18, v18, v88
    v_add_f32 v19, v19, v89
    v_mfma_f32_16x16x32_bf16 v[100:103], v[76:79], a[68:71], v[100:103]
    v_cvt_pk_bf16_f32 v104, v88, v89
    v_mfma_f32_16x16x32_bf16 v[100:103], v[72:75], a[64:67], v[100:103]
    v_exp_f32 v92, v92
    v_mfma_f32_16x16x32_bf16 v[152:155], v[112:115], v[108:111], v[152:155]
    buffer_load_dwordx4 v7, s[4:7], s49 offen offset:768 nt lds
    v_exp_f32 v93, v93
    v_mfma_f32_16x16x32_bf16 v[180:183], v[116:119], v[108:111], v[180:183]
    v_add_f32 v18, v18, v90
    v_add_f32 v19, v19, v91
    v_mfma_f32_16x16x32_bf16 v[208:211], v[120:123], v[108:111], v[208:211]
    s_add_u32 m0, m0, s97
    v_cvt_pk_bf16_f32 v105, v90, v91
    v_mfma_f32_16x16x32_bf16 v[236:239], v[124:127], v[108:111], v[236:239]
    v_exp_f32 v94, v94
    v_mfma_f32_16x16x32_bf16 a[120:123], v[128:131], v[108:111], a[120:123]
    buffer_load_dwordx4 v7, s[4:7], s49 offen offset:1024 nt lds
    v_exp_f32 v95, v95
    v_mfma_f32_16x16x32_bf16 a[148:151], v[132:135], v[108:111], a[148:151]
    v_add_f32 v18, v18, v92
    v_add_f32 v19, v19, v93
    v_mfma_f32_16x16x32_bf16 a[176:179], v[136:139], v[108:111], a[176:179]
    s_add_u32 m0, m0, s96
    v_cvt_pk_bf16_f32 v106, v92, v93
    v_add_f32 v18, v18, v94
    v_mfma_f32_16x16x32_bf16 a[204:207], v[140:143], v[108:111], a[204:207]
    v_add_f32 v19, v19, v95
    v_cvt_pk_bf16_f32 v107, v94, v95
    v_mfma_f32_16x16x32_bf16 v[88:91], v[56:59], a[80:83], v[48:51]
    v_mfma_f32_16x16x32_bf16 v[88:91], v[60:63], a[84:87], v[88:91]
    buffer_load_dwordx4 v7, s[4:7], s49 offen offset:1280 nt lds
    v_exp_f32 v96, v96
    v_mfma_f32_16x16x32_bf16 v[88:91], v[64:67], a[88:91], v[88:91]
    v_exp_f32 v97, v97
    v_mfma_f32_16x16x32_bf16 v[88:91], v[68:71], a[92:95], v[88:91]
    s_add_u32 m0, m0, s97
    v_exp_f32 v98, v98
    v_mfma_f32_16x16x32_bf16 v[92:95], v[84:87], a[92:95], v[48:51]
    v_exp_f32 v99, v99
    v_mfma_f32_16x16x32_bf16 v[92:95], v[80:83], a[88:91], v[92:95]
    buffer_load_dwordx4 v7, s[4:7], s49 offen offset:1536 nt lds
    v_add_f32 v20, v20, v96
    v_add_f32 v21, v21, v97
    v_mfma_f32_16x16x32_bf16 v[92:95], v[76:79], a[84:87], v[92:95]
    v_cvt_pk_bf16_f32 v108, v96, v97
    v_mfma_f32_16x16x32_bf16 v[92:95], v[72:75], a[80:83], v[92:95]
    v_exp_f32 v100, v100
    v_mfma_f32_16x16x32_bf16 v[156:159], v[112:115], v[104:107], v[156:159]
    s_add_u32 m0, m0, s96
    v_exp_f32 v101, v101
    v_mfma_f32_16x16x32_bf16 v[184:187], v[116:119], v[104:107], v[184:187]
    v_add_f32 v20, v20, v98
    v_add_f32 v21, v21, v99
    v_mfma_f32_16x16x32_bf16 v[212:215], v[120:123], v[104:107], v[212:215]
    buffer_load_dwordx4 v7, s[4:7], s49 offen offset:1792 nt lds
    v_cvt_pk_bf16_f32 v109, v98, v99
    v_mfma_f32_16x16x32_bf16 v[240:243], v[124:127], v[104:107], v[240:243]
    v_exp_f32 v102, v102
    v_mfma_f32_16x16x32_bf16 a[124:127], v[128:131], v[104:107], a[124:127]
    v_exp_f32 v103, v103
    v_mfma_f32_16x16x32_bf16 a[152:155], v[132:135], v[104:107], a[152:155]
    v_add_f32 v20, v20, v100
    v_add_f32 v21, v21, v101
    v_mfma_f32_16x16x32_bf16 a[180:183], v[136:139], v[104:107], a[180:183]
    v_cvt_pk_bf16_f32 v110, v100, v101
    v_add_f32 v20, v20, v102
    v_mfma_f32_16x16x32_bf16 a[208:211], v[140:143], v[104:107], a[208:211]
    v_add_f32 v21, v21, v103
    v_cvt_pk_bf16_f32 v111, v102, v103
    s_waitcnt vmcnt(16) lgkmcnt(0)
    s_barrier
    v_mfma_f32_16x16x32_bf16 v[96:99], v[56:59], a[96:99], v[52:55]
    ds_read_b128 v[56:59], v8 offset:0
    v_mfma_f32_16x16x32_bf16 v[96:99], v[60:63], a[100:103], v[96:99]
    ds_read_b128 v[60:63], v8 offset:64
    v_exp_f32 v88, v88
    v_mfma_f32_16x16x32_bf16 v[96:99], v[64:67], a[104:107], v[96:99]
    ds_read_b128 v[64:67], v8 offset:128
    v_exp_f32 v89, v89
    v_mfma_f32_16x16x32_bf16 v[96:99], v[68:71], a[108:111], v[96:99]
    ds_read_b128 v[68:71], v8 offset:192
    v_exp_f32 v90, v90
    v_mfma_f32_16x16x32_bf16 v[100:103], v[84:87], a[108:111], v[52:55]
    ds_read_b128 v[84:87], v8 offset:704
    v_exp_f32 v91, v91
    v_mfma_f32_16x16x32_bf16 v[100:103], v[80:83], a[104:107], v[100:103]
    ds_read_b128 v[80:83], v8 offset:640
    v_add_f32 v22, v22, v88
    v_add_f32 v23, v23, v89
    v_mfma_f32_16x16x32_bf16 v[100:103], v[76:79], a[100:103], v[100:103]
    ds_read_b128 v[76:79], v8 offset:576
    v_cvt_pk_bf16_f32 v104, v88, v89
    v_mfma_f32_16x16x32_bf16 v[100:103], v[72:75], a[96:99], v[100:103]
    ds_read_b128 v[72:75], v8 offset:512
    v_exp_f32 v92, v92
    v_mfma_f32_16x16x32_bf16 v[160:163], v[112:115], v[108:111], v[160:163]
    v_exp_f32 v93, v93
    v_mfma_f32_16x16x32_bf16 v[188:191], v[116:119], v[108:111], v[188:191]
    v_add_f32 v22, v22, v90
    v_add_f32 v23, v23, v91
    v_mfma_f32_16x16x32_bf16 v[216:219], v[120:123], v[108:111], v[216:219]
    v_cvt_pk_bf16_f32 v105, v90, v91
    v_mfma_f32_16x16x32_bf16 v[244:247], v[124:127], v[108:111], v[244:247]
    v_exp_f32 v94, v94
    v_mfma_f32_16x16x32_bf16 a[128:131], v[128:131], v[108:111], a[128:131]
    v_exp_f32 v95, v95
    v_mfma_f32_16x16x32_bf16 a[156:159], v[132:135], v[108:111], a[156:159]
    v_add_f32 v22, v22, v92
    v_add_f32 v23, v23, v93
    v_mfma_f32_16x16x32_bf16 a[184:187], v[136:139], v[108:111], a[184:187]
    v_cvt_pk_bf16_f32 v106, v92, v93
    v_add_f32 v22, v22, v94
    v_mfma_f32_16x16x32_bf16 a[212:215], v[140:143], v[108:111], a[212:215]
    v_add_f32 v23, v23, v95
    v_cvt_pk_bf16_f32 v107, v94, v95
    s_waitcnt lgkmcnt(0)
    v_mfma_f32_16x16x32_bf16 v[88:91], v[56:59], a[0:3], v[28:31]
    v_mfma_f32_16x16x32_bf16 v[88:91], v[60:63], a[4:7], v[88:91]
    v_exp_f32 v96, v96
    v_mfma_f32_16x16x32_bf16 v[88:91], v[64:67], a[8:11], v[88:91]
    v_exp_f32 v97, v97
    v_mfma_f32_16x16x32_bf16 v[88:91], v[68:71], a[12:15], v[88:91]
    v_exp_f32 v98, v98
    v_mfma_f32_16x16x32_bf16 v[92:95], v[84:87], a[12:15], v[28:31]
    v_exp_f32 v99, v99
    v_mfma_f32_16x16x32_bf16 v[92:95], v[80:83], a[8:11], v[92:95]
    v_add_f32 v24, v24, v96
    v_add_f32 v25, v25, v97
    v_mfma_f32_16x16x32_bf16 v[92:95], v[76:79], a[4:7], v[92:95]
    v_cvt_pk_bf16_f32 v108, v96, v97
    v_mfma_f32_16x16x32_bf16 v[92:95], v[72:75], a[0:3], v[92:95]
    v_exp_f32 v100, v100
    v_mfma_f32_16x16x32_bf16 v[164:167], v[112:115], v[104:107], v[164:167]
    v_exp_f32 v101, v101
    v_mfma_f32_16x16x32_bf16 v[192:195], v[116:119], v[104:107], v[192:195]
    v_add_f32 v24, v24, v98
    v_add_f32 v25, v25, v99
    v_mfma_f32_16x16x32_bf16 v[220:223], v[120:123], v[104:107], v[220:223]
    v_cvt_pk_bf16_f32 v109, v98, v99
    v_mfma_f32_16x16x32_bf16 v[248:251], v[124:127], v[104:107], v[248:251]
    v_exp_f32 v102, v102
    v_mfma_f32_16x16x32_bf16 a[132:135], v[128:131], v[104:107], a[132:135]
    v_exp_f32 v103, v103
    v_mfma_f32_16x16x32_bf16 a[160:163], v[132:135], v[104:107], a[160:163]
    v_add_f32 v24, v24, v100
    v_add_f32 v25, v25, v101
    v_mfma_f32_16x16x32_bf16 a[188:191], v[136:139], v[104:107], a[188:191]
    v_cvt_pk_bf16_f32 v110, v100, v101
    v_add_f32 v24, v24, v102
    v_mfma_f32_16x16x32_bf16 a[216:219], v[140:143], v[104:107], a[216:219]
    v_add_f32 v25, v25, v103
    v_cvt_pk_bf16_f32 v111, v102, v103
    v_mfma_f32_16x16x32_bf16 v[96:99], v[56:59], a[16:19], v[32:35]
    v_mfma_f32_16x16x32_bf16 v[96:99], v[60:63], a[20:23], v[96:99]
    v_exp_f32 v88, v88
    v_mfma_f32_16x16x32_bf16 v[96:99], v[64:67], a[24:27], v[96:99]
    v_exp_f32 v89, v89
    v_mfma_f32_16x16x32_bf16 v[96:99], v[68:71], a[28:31], v[96:99]
    v_exp_f32 v90, v90
    v_mfma_f32_16x16x32_bf16 v[100:103], v[84:87], a[28:31], v[32:35]
    v_exp_f32 v91, v91
    v_mfma_f32_16x16x32_bf16 v[100:103], v[80:83], a[24:27], v[100:103]
    v_add_f32 v12, v12, v88
    v_add_f32 v13, v13, v89
    v_mfma_f32_16x16x32_bf16 v[100:103], v[76:79], a[20:23], v[100:103]
    v_cvt_pk_bf16_f32 v104, v88, v89
    v_mfma_f32_16x16x32_bf16 v[100:103], v[72:75], a[16:19], v[100:103]
    v_exp_f32 v92, v92
    v_mfma_f32_16x16x32_bf16 v[168:171], v[112:115], v[108:111], v[168:171]
    ds_read_b64_tr_b16 v[112:113], v9 offset:0
    ds_read_b64_tr_b16 v[114:115], v9 offset:512
    v_exp_f32 v93, v93
    v_mfma_f32_16x16x32_bf16 v[196:199], v[116:119], v[108:111], v[196:199]
    ds_read_b64_tr_b16 v[116:117], v9 offset:32
    ds_read_b64_tr_b16 v[118:119], v9 offset:544
    v_add_f32 v12, v12, v90
    v_add_f32 v13, v13, v91
    v_mfma_f32_16x16x32_bf16 v[224:227], v[120:123], v[108:111], v[224:227]
    ds_read_b64_tr_b16 v[120:121], v9 offset:64
    ds_read_b64_tr_b16 v[122:123], v9 offset:576
    v_cvt_pk_bf16_f32 v105, v90, v91
    v_mfma_f32_16x16x32_bf16 v[252:255], v[124:127], v[108:111], v[252:255]
    ds_read_b64_tr_b16 v[124:125], v9 offset:96
    ds_read_b64_tr_b16 v[126:127], v9 offset:608
    v_exp_f32 v94, v94
    v_mfma_f32_16x16x32_bf16 a[136:139], v[128:131], v[108:111], a[136:139]
    ds_read_b64_tr_b16 v[128:129], v9 offset:128
    ds_read_b64_tr_b16 v[130:131], v9 offset:640
    v_exp_f32 v95, v95
    v_mfma_f32_16x16x32_bf16 a[164:167], v[132:135], v[108:111], a[164:167]
    ds_read_b64_tr_b16 v[132:133], v9 offset:160
    ds_read_b64_tr_b16 v[134:135], v9 offset:672
    v_add_f32 v12, v12, v92
    v_add_f32 v13, v13, v93
    v_mfma_f32_16x16x32_bf16 a[192:195], v[136:139], v[108:111], a[192:195]
    ds_read_b64_tr_b16 v[136:137], v9 offset:192
    ds_read_b64_tr_b16 v[138:139], v9 offset:704
    v_cvt_pk_bf16_f32 v106, v92, v93
    v_add_f32 v12, v12, v94
    v_mfma_f32_16x16x32_bf16 a[220:223], v[140:143], v[108:111], a[220:223]
    ds_read_b64_tr_b16 v[140:141], v9 offset:224
    ds_read_b64_tr_b16 v[142:143], v9 offset:736
    v_add_f32 v13, v13, v95
    v_cvt_pk_bf16_f32 v107, v94, v95
    v_mfma_f32_16x16x32_bf16 v[88:91], v[56:59], a[32:35], v[36:39]
    v_mfma_f32_16x16x32_bf16 v[88:91], v[60:63], a[36:39], v[88:91]
    s_add_u32 s29, s34, s100
    v_exp_f32 v96, v96
    v_mfma_f32_16x16x32_bf16 v[88:91], v[64:67], a[40:43], v[88:91]
    v_exp_f32 v97, v97
    v_mfma_f32_16x16x32_bf16 v[88:91], v[68:71], a[44:47], v[88:91]
    s_bfe_u32 s28, s29, 0x20003
    v_exp_f32 v98, v98
    v_mfma_f32_16x16x32_bf16 v[92:95], v[84:87], a[44:47], v[36:39]
    v_exp_f32 v99, v99
    v_mfma_f32_16x16x32_bf16 v[92:95], v[80:83], a[40:43], v[92:95]
    s_lshl_b32 s28, s28, 16
    v_add_f32 v14, v14, v96
    v_add_f32 v15, v15, v97
    v_mfma_f32_16x16x32_bf16 v[92:95], v[76:79], a[36:39], v[92:95]
    v_cvt_pk_bf16_f32 v108, v96, v97
    v_mfma_f32_16x16x32_bf16 v[92:95], v[72:75], a[32:35], v[92:95]
    v_exp_f32 v100, v100
    s_waitcnt lgkmcnt(0)
    v_mfma_f32_16x16x32_bf16 v[144:147], v[112:115], v[104:107], v[144:147]
    s_and_b32 s29, s29, 7
    v_exp_f32 v101, v101
    v_mfma_f32_16x16x32_bf16 v[172:175], v[116:119], v[104:107], v[172:175]
    v_add_f32 v14, v14, v98
    v_add_f32 v15, v15, v99
    v_mfma_f32_16x16x32_bf16 v[200:203], v[120:123], v[104:107], v[200:203]
    s_lshl_b32 s29, s29, 11
    v_cvt_pk_bf16_f32 v109, v98, v99
    v_mfma_f32_16x16x32_bf16 v[228:231], v[124:127], v[104:107], v[228:231]
    v_exp_f32 v102, v102
    v_mfma_f32_16x16x32_bf16 a[112:115], v[128:131], v[104:107], a[112:115]
    s_add_u32 s29, s28, s29
    v_exp_f32 v103, v103
    v_mfma_f32_16x16x32_bf16 a[140:143], v[132:135], v[104:107], a[140:143]
    v_add_f32 v14, v14, v100
    v_add_f32 v15, v15, v101
    v_mfma_f32_16x16x32_bf16 a[168:171], v[136:139], v[104:107], a[168:171]
    s_lshr_b32 s28, s34, 5
    v_cvt_pk_bf16_f32 v110, v100, v101
    v_add_f32 v14, v14, v102
    v_mfma_f32_16x16x32_bf16 a[196:199], v[140:143], v[104:107], a[196:199]
    v_add_f32 v15, v15, v103
    v_cvt_pk_bf16_f32 v111, v102, v103
    v_mfma_f32_16x16x32_bf16 v[96:99], v[56:59], a[48:51], v[40:43]
    v_mfma_f32_16x16x32_bf16 v[96:99], v[60:63], a[52:55], v[96:99]
    s_lshl_b32 s28, s28, 19
    v_exp_f32 v88, v88
    v_mfma_f32_16x16x32_bf16 v[96:99], v[64:67], a[56:59], v[96:99]
    v_exp_f32 v89, v89
    v_mfma_f32_16x16x32_bf16 v[96:99], v[68:71], a[60:63], v[96:99]
    s_add_u32 s49, s28, s29
    v_exp_f32 v90, v90
    v_mfma_f32_16x16x32_bf16 v[100:103], v[84:87], a[60:63], v[40:43]
    v_exp_f32 v91, v91
    v_mfma_f32_16x16x32_bf16 v[100:103], v[80:83], a[56:59], v[100:103]
    s_add_u32 m0, s33, 25344
    v_add_f32 v16, v16, v88
    v_add_f32 v17, v17, v89
    v_mfma_f32_16x16x32_bf16 v[100:103], v[76:79], a[52:55], v[100:103]
    v_cvt_pk_bf16_f32 v104, v88, v89
    v_mfma_f32_16x16x32_bf16 v[100:103], v[72:75], a[48:51], v[100:103]
    v_exp_f32 v92, v92
    v_mfma_f32_16x16x32_bf16 v[148:151], v[112:115], v[108:111], v[148:151]
    s_add_u32 s34, s34, 1
    v_exp_f32 v93, v93
    v_mfma_f32_16x16x32_bf16 v[176:179], v[116:119], v[108:111], v[176:179]
    v_add_f32 v16, v16, v90
    v_add_f32 v17, v17, v91
    v_mfma_f32_16x16x32_bf16 v[204:207], v[120:123], v[108:111], v[204:207]
    buffer_load_dwordx4 v7, s[4:7], s49 offen offset:0 nt lds
    v_cvt_pk_bf16_f32 v105, v90, v91
    v_mfma_f32_16x16x32_bf16 v[232:235], v[124:127], v[108:111], v[232:235]
    v_exp_f32 v94, v94
    v_mfma_f32_16x16x32_bf16 a[116:119], v[128:131], v[108:111], a[116:119]
    s_add_u32 m0, m0, s96
    v_exp_f32 v95, v95
    v_mfma_f32_16x16x32_bf16 a[144:147], v[132:135], v[108:111], a[144:147]
    v_add_f32 v16, v16, v92
    v_add_f32 v17, v17, v93
    v_mfma_f32_16x16x32_bf16 a[172:175], v[136:139], v[108:111], a[172:175]
    buffer_load_dwordx4 v7, s[4:7], s49 offen offset:256 nt lds
    v_cvt_pk_bf16_f32 v106, v92, v93
    v_add_f32 v16, v16, v94
    v_mfma_f32_16x16x32_bf16 a[200:203], v[140:143], v[108:111], a[200:203]
    v_add_f32 v17, v17, v95
    v_cvt_pk_bf16_f32 v107, v94, v95
    v_mfma_f32_16x16x32_bf16 v[88:91], v[56:59], a[64:67], v[44:47]
    v_mfma_f32_16x16x32_bf16 v[88:91], v[60:63], a[68:71], v[88:91]
    s_add_u32 m0, m0, s97
    v_exp_f32 v96, v96
    v_mfma_f32_16x16x32_bf16 v[88:91], v[64:67], a[72:75], v[88:91]
    v_exp_f32 v97, v97
    v_mfma_f32_16x16x32_bf16 v[88:91], v[68:71], a[76:79], v[88:91]
    buffer_load_dwordx4 v7, s[4:7], s49 offen offset:512 nt lds
    v_exp_f32 v98, v98
    v_mfma_f32_16x16x32_bf16 v[92:95], v[84:87], a[76:79], v[44:47]
    v_exp_f32 v99, v99
    v_mfma_f32_16x16x32_bf16 v[92:95], v[80:83], a[72:75], v[92:95]
    s_add_u32 m0, m0, s96
    v_add_f32 v18, v18, v96
    v_add_f32 v19, v19, v97
    v_mfma_f32_16x16x32_bf16 v[92:95], v[76:79], a[68:71], v[92:95]
    v_cvt_pk_bf16_f32 v108, v96, v97
    v_mfma_f32_16x16x32_bf16 v[92:95], v[72:75], a[64:67], v[92:95]
    v_exp_f32 v100, v100
    v_mfma_f32_16x16x32_bf16 v[152:155], v[112:115], v[104:107], v[152:155]
    buffer_load_dwordx4 v7, s[4:7], s49 offen offset:768 nt lds
    v_exp_f32 v101, v101
    v_mfma_f32_16x16x32_bf16 v[180:183], v[116:119], v[104:107], v[180:183]
    v_add_f32 v18, v18, v98
    v_add_f32 v19, v19, v99
    v_mfma_f32_16x16x32_bf16 v[208:211], v[120:123], v[104:107], v[208:211]
    s_add_u32 m0, m0, s97
    v_cvt_pk_bf16_f32 v109, v98, v99
    v_mfma_f32_16x16x32_bf16 v[236:239], v[124:127], v[104:107], v[236:239]
    v_exp_f32 v102, v102
    v_mfma_f32_16x16x32_bf16 a[120:123], v[128:131], v[104:107], a[120:123]
    buffer_load_dwordx4 v7, s[4:7], s49 offen offset:1024 nt lds
    v_exp_f32 v103, v103
    v_mfma_f32_16x16x32_bf16 a[148:151], v[132:135], v[104:107], a[148:151]
    v_add_f32 v18, v18, v100
    v_add_f32 v19, v19, v101
    v_mfma_f32_16x16x32_bf16 a[176:179], v[136:139], v[104:107], a[176:179]
    s_add_u32 m0, m0, s96
    v_cvt_pk_bf16_f32 v110, v100, v101
    v_add_f32 v18, v18, v102
    v_mfma_f32_16x16x32_bf16 a[204:207], v[140:143], v[104:107], a[204:207]
    v_add_f32 v19, v19, v103
    v_cvt_pk_bf16_f32 v111, v102, v103
    v_mfma_f32_16x16x32_bf16 v[96:99], v[56:59], a[80:83], v[48:51]
    v_mfma_f32_16x16x32_bf16 v[96:99], v[60:63], a[84:87], v[96:99]
    buffer_load_dwordx4 v7, s[4:7], s49 offen offset:1280 nt lds
    v_exp_f32 v88, v88
    v_mfma_f32_16x16x32_bf16 v[96:99], v[64:67], a[88:91], v[96:99]
    v_exp_f32 v89, v89
    v_mfma_f32_16x16x32_bf16 v[96:99], v[68:71], a[92:95], v[96:99]
    s_add_u32 m0, m0, s97
    v_exp_f32 v90, v90
    v_mfma_f32_16x16x32_bf16 v[100:103], v[84:87], a[92:95], v[48:51]
    v_exp_f32 v91, v91
    v_mfma_f32_16x16x32_bf16 v[100:103], v[80:83], a[88:91], v[100:103]
    buffer_load_dwordx4 v7, s[4:7], s49 offen offset:1536 nt lds
    v_add_f32 v20, v20, v88
    v_add_f32 v21, v21, v89
    v_mfma_f32_16x16x32_bf16 v[100:103], v[76:79], a[84:87], v[100:103]
    v_cvt_pk_bf16_f32 v104, v88, v89
    v_mfma_f32_16x16x32_bf16 v[100:103], v[72:75], a[80:83], v[100:103]
    v_exp_f32 v92, v92
    v_mfma_f32_16x16x32_bf16 v[156:159], v[112:115], v[108:111], v[156:159]
    s_add_u32 m0, m0, s96
    v_exp_f32 v93, v93
    v_mfma_f32_16x16x32_bf16 v[184:187], v[116:119], v[108:111], v[184:187]
    v_add_f32 v20, v20, v90
    v_add_f32 v21, v21, v91
    v_mfma_f32_16x16x32_bf16 v[212:215], v[120:123], v[108:111], v[212:215]
    buffer_load_dwordx4 v7, s[4:7], s49 offen offset:1792 nt lds
    v_cvt_pk_bf16_f32 v105, v90, v91
    v_mfma_f32_16x16x32_bf16 v[240:243], v[124:127], v[108:111], v[240:243]
    v_exp_f32 v94, v94
    v_mfma_f32_16x16x32_bf16 a[124:127], v[128:131], v[108:111], a[124:127]
    v_exp_f32 v95, v95
    v_mfma_f32_16x16x32_bf16 a[152:155], v[132:135], v[108:111], a[152:155]
    v_add_f32 v20, v20, v92
    v_add_f32 v21, v21, v93
    v_mfma_f32_16x16x32_bf16 a[180:183], v[136:139], v[108:111], a[180:183]
    v_cvt_pk_bf16_f32 v106, v92, v93
    v_add_f32 v20, v20, v94
    v_mfma_f32_16x16x32_bf16 a[208:211], v[140:143], v[108:111], a[208:211]
    v_add_f32 v21, v21, v95
    v_cvt_pk_bf16_f32 v107, v94, v95
    s_waitcnt vmcnt(16) lgkmcnt(0)
    s_barrier
    v_mfma_f32_16x16x32_bf16 v[88:91], v[56:59], a[96:99], v[52:55]
    ds_read_b128 v[56:59], v8 offset:8448
    v_mfma_f32_16x16x32_bf16 v[88:91], v[60:63], a[100:103], v[88:91]
    ds_read_b128 v[60:63], v8 offset:8512
    v_exp_f32 v96, v96
    v_mfma_f32_16x16x32_bf16 v[88:91], v[64:67], a[104:107], v[88:91]
    ds_read_b128 v[64:67], v8 offset:8576
    v_exp_f32 v97, v97
    v_mfma_f32_16x16x32_bf16 v[88:91], v[68:71], a[108:111], v[88:91]
    ds_read_b128 v[68:71], v8 offset:8640
    v_exp_f32 v98, v98
    v_mfma_f32_16x16x32_bf16 v[92:95], v[84:87], a[108:111], v[52:55]
    ds_read_b128 v[84:87], v8 offset:9152
    v_exp_f32 v99, v99
    v_mfma_f32_16x16x32_bf16 v[92:95], v[80:83], a[104:107], v[92:95]
    ds_read_b128 v[80:83], v8 offset:9088
    v_add_f32 v22, v22, v96
    v_add_f32 v23, v23, v97
    v_mfma_f32_16x16x32_bf16 v[92:95], v[76:79], a[100:103], v[92:95]
    ds_read_b128 v[76:79], v8 offset:9024
    v_cvt_pk_bf16_f32 v108, v96, v97
    v_mfma_f32_16x16x32_bf16 v[92:95], v[72:75], a[96:99], v[92:95]
    ds_read_b128 v[72:75], v8 offset:8960
    v_exp_f32 v100, v100
    v_mfma_f32_16x16x32_bf16 v[160:163], v[112:115], v[104:107], v[160:163]
    v_exp_f32 v101, v101
    v_mfma_f32_16x16x32_bf16 v[188:191], v[116:119], v[104:107], v[188:191]
    v_add_f32 v22, v22, v98
    v_add_f32 v23, v23, v99
    v_mfma_f32_16x16x32_bf16 v[216:219], v[120:123], v[104:107], v[216:219]
    v_cvt_pk_bf16_f32 v109, v98, v99
    v_mfma_f32_16x16x32_bf16 v[244:247], v[124:127], v[104:107], v[244:247]
    v_exp_f32 v102, v102
    v_mfma_f32_16x16x32_bf16 a[128:131], v[128:131], v[104:107], a[128:131]
    v_exp_f32 v103, v103
    v_mfma_f32_16x16x32_bf16 a[156:159], v[132:135], v[104:107], a[156:159]
    v_add_f32 v22, v22, v100
    v_add_f32 v23, v23, v101
    v_mfma_f32_16x16x32_bf16 a[184:187], v[136:139], v[104:107], a[184:187]
    v_cvt_pk_bf16_f32 v110, v100, v101
    v_add_f32 v22, v22, v102
    v_mfma_f32_16x16x32_bf16 a[212:215], v[140:143], v[104:107], a[212:215]
    v_add_f32 v23, v23, v103
    v_cvt_pk_bf16_f32 v111, v102, v103
    s_waitcnt lgkmcnt(0)
    v_mfma_f32_16x16x32_bf16 v[96:99], v[56:59], a[0:3], v[28:31]
    v_mfma_f32_16x16x32_bf16 v[96:99], v[60:63], a[4:7], v[96:99]
    v_exp_f32 v88, v88
    v_mfma_f32_16x16x32_bf16 v[96:99], v[64:67], a[8:11], v[96:99]
    v_exp_f32 v89, v89
    v_mfma_f32_16x16x32_bf16 v[96:99], v[68:71], a[12:15], v[96:99]
    v_exp_f32 v90, v90
    v_mfma_f32_16x16x32_bf16 v[100:103], v[84:87], a[12:15], v[28:31]
    v_exp_f32 v91, v91
    v_mfma_f32_16x16x32_bf16 v[100:103], v[80:83], a[8:11], v[100:103]
    v_add_f32 v24, v24, v88
    v_add_f32 v25, v25, v89
    v_mfma_f32_16x16x32_bf16 v[100:103], v[76:79], a[4:7], v[100:103]
    v_cvt_pk_bf16_f32 v104, v88, v89
    v_mfma_f32_16x16x32_bf16 v[100:103], v[72:75], a[0:3], v[100:103]
    v_exp_f32 v92, v92
    v_mfma_f32_16x16x32_bf16 v[164:167], v[112:115], v[108:111], v[164:167]
    v_exp_f32 v93, v93
    v_mfma_f32_16x16x32_bf16 v[192:195], v[116:119], v[108:111], v[192:195]
    v_add_f32 v24, v24, v90
    v_add_f32 v25, v25, v91
    v_mfma_f32_16x16x32_bf16 v[220:223], v[120:123], v[108:111], v[220:223]
    v_cvt_pk_bf16_f32 v105, v90, v91
    v_mfma_f32_16x16x32_bf16 v[248:251], v[124:127], v[108:111], v[248:251]
    v_exp_f32 v94, v94
    v_mfma_f32_16x16x32_bf16 a[132:135], v[128:131], v[108:111], a[132:135]
    v_exp_f32 v95, v95
    v_mfma_f32_16x16x32_bf16 a[160:163], v[132:135], v[108:111], a[160:163]
    v_add_f32 v24, v24, v92
    v_add_f32 v25, v25, v93
    v_mfma_f32_16x16x32_bf16 a[188:191], v[136:139], v[108:111], a[188:191]
    v_cvt_pk_bf16_f32 v106, v92, v93
    v_add_f32 v24, v24, v94
    v_mfma_f32_16x16x32_bf16 a[216:219], v[140:143], v[108:111], a[216:219]
    v_add_f32 v25, v25, v95
    v_cvt_pk_bf16_f32 v107, v94, v95
    s_add_u32 s22, s22, 1
    s_cmp_lt_u32 s22, 7
    s_cbranch_scc1 L_at_loop
    s_add_u32 s21, s21, 1
    s_mul_i32 s50, s21, s52
    s_mov_b32 s101, s21
    s_add_u32 s50, s50, s55
    s_cmp_ge_u32 s21, 2
    s_cselect_b32 s28, 0x40000000, 0
    s_add_u32 s50, s50, s28
    s_mov_b32 s82, s26
    s_mul_i32 s28, s26, s51
    s_add_u32 s50, s50, s28
    s_cmp_eq_u32 s21, 2
    s_cbranch_scc1 L_at_wt0
L_at_wt0r:
    s_cmp_lg_u32 s69, 0
    s_cbranch_scc1 L_at_atailB
    v_mfma_f32_16x16x32_bf16 v[88:91], v[56:59], a[16:19], v[32:35]
    v_mfma_f32_16x16x32_bf16 v[88:91], v[60:63], a[20:23], v[88:91]
    v_exp_f32 v96, v96
    v_mfma_f32_16x16x32_bf16 v[88:91], v[64:67], a[24:27], v[88:91]
    v_exp_f32 v97, v97
    v_mfma_f32_16x16x32_bf16 v[88:91], v[68:71], a[28:31], v[88:91]
    v_exp_f32 v98, v98
    v_mfma_f32_16x16x32_bf16 v[92:95], v[84:87], a[28:31], v[32:35]
    v_exp_f32 v99, v99
    v_mfma_f32_16x16x32_bf16 v[92:95], v[80:83], a[24:27], v[92:95]
    v_add_f32 v12, v12, v96
    v_add_f32 v13, v13, v97
    v_mfma_f32_16x16x32_bf16 v[92:95], v[76:79], a[20:23], v[92:95]
    v_cvt_pk_bf16_f32 v108, v96, v97
    v_mfma_f32_16x16x32_bf16 v[92:95], v[72:75], a[16:19], v[92:95]
    v_exp_f32 v100, v100
    v_mfma_f32_16x16x32_bf16 v[168:171], v[112:115], v[104:107], v[168:171]
    ds_read_b64_tr_b16 v[112:113], v9 offset:8448
    ds_read_b64_tr_b16 v[114:115], v9 offset:8960
    v_exp_f32 v101, v101
    v_mfma_f32_16x16x32_bf16 v[196:199], v[116:119], v[104:107], v[196:199]
    ds_read_b64_tr_b16 v[116:117], v9 offset:8480
    ds_read_b64_tr_b16 v[118:119], v9 offset:8992
    v_add_f32 v12, v12, v98
    v_add_f32 v13, v13, v99
    v_mfma_f32_16x16x32_bf16 v[224:227], v[120:123], v[104:107], v[224:227]
    ds_read_b64_tr_b16 v[120:121], v9 offset:8512
    ds_read_b64_tr_b16 v[122:123], v9 offset:9024
    v_cvt_pk_bf16_f32 v109, v98, v99
    v_mfma_f32_16x16x32_bf16 v[252:255], v[124:127], v[104:107], v[252:255]
    ds_read_b64_tr_b16 v[124:125], v9 offset:8544
    ds_read_b64_tr_b16 v[126:127], v9 offset:9056
    v_exp_f32 v102, v102
    v_mfma_f32_16x16x32_bf16 a[136:139], v[128:131], v[104:107], a[136:139]
    ds_read_b64_tr_b16 v[128:129], v9 offset:8576
    ds_read_b64_tr_b16 v[130:131], v9 offset:9088
    v_exp_f32 v103, v103
    v_mfma_f32_16x16x32_bf16 a[164:167], v[132:135], v[104:107], a[164:167]
    ds_read_b64_tr_b16 v[132:133], v9 offset:8608
    ds_read_b64_tr_b16 v[134:135], v9 offset:9120
    v_add_f32 v12, v12, v100
    v_add_f32 v13, v13, v101
    v_mfma_f32_16x16x32_bf16 a[192:195], v[136:139], v[104:107], a[192:195]
    ds_read_b64_tr_b16 v[136:137], v9 offset:8640
    ds_read_b64_tr_b16 v[138:139], v9 offset:9152
    v_cvt_pk_bf16_f32 v110, v100, v101
    v_add_f32 v12, v12, v102
    v_mfma_f32_16x16x32_bf16 a[220:223], v[140:143], v[104:107], a[220:223]
    ds_read_b64_tr_b16 v[140:141], v9 offset:8672
    ds_read_b64_tr_b16 v[142:143], v9 offset:9184
    v_add_f32 v13, v13, v103
    v_cvt_pk_bf16_f32 v111, v102, v103
    v_mfma_f32_16x16x32_bf16 v[96:99], v[56:59], a[32:35], v[36:39]
    v_mfma_f32_16x16x32_bf16 v[96:99], v[60:63], a[36:39], v[96:99]
    s_add_u32 m0, s33, 0
    v_exp_f32 v88, v88
    v_mfma_f32_16x16x32_bf16 v[96:99], v[64:67], a[40:43], v[96:99]
    v_exp_f32 v89, v89
    v_mfma_f32_16x16x32_bf16 v[96:99], v[68:71], a[44:47], v[96:99]
    s_mov_b32 s49, s50
    v_exp_f32 v90, v90
    v_mfma_f32_16x16x32_bf16 v[100:103], v[84:87], a[44:47], v[36:39]
    v_exp_f32 v91, v91
    v_mfma_f32_16x16x32_bf16 v[100:103], v[80:83], a[40:43], v[100:103]
    s_add_u32 s28, s49, s88
    v_add_f32 v14, v14, v88
    v_add_f32 v15, v15, v89
    v_mfma_f32_16x16x32_bf16 v[100:103], v[76:79], a[36:39], v[100:103]
    v_cvt_pk_bf16_f32 v104, v88, v89
    v_mfma_f32_16x16x32_bf16 v[100:103], v[72:75], a[32:35], v[100:103]
    v_exp_f32 v92, v92
    s_waitcnt lgkmcnt(0)
    v_mfma_f32_16x16x32_bf16 v[144:147], v[112:115], v[108:111], v[144:147]
    buffer_load_dwordx4 v26, s[16:19], s28 offen lds
    v_exp_f32 v93, v93
    v_mfma_f32_16x16x32_bf16 v[172:175], v[116:119], v[108:111], v[172:175]
    v_add_f32 v14, v14, v90
    v_add_f32 v15, v15, v91
    v_mfma_f32_16x16x32_bf16 v[200:203], v[120:123], v[108:111], v[200:203]
    s_add_u32 m0, m0, s53
    v_cvt_pk_bf16_f32 v105, v90, v91
    v_mfma_f32_16x16x32_bf16 v[228:231], v[124:127], v[108:111], v[228:231]
    v_exp_f32 v94, v94
    v_mfma_f32_16x16x32_bf16 a[112:115], v[128:131], v[108:111], a[112:115]
    s_add_u32 s28, s49, s89
    v_exp_f32 v95, v95
    v_mfma_f32_16x16x32_bf16 a[140:143], v[132:135], v[108:111], a[140:143]
    v_add_f32 v14, v14, v92
    v_add_f32 v15, v15, v93
    v_mfma_f32_16x16x32_bf16 a[168:171], v[136:139], v[108:111], a[168:171]
    buffer_load_dwordx4 v26, s[16:19], s28 offen lds
    v_cvt_pk_bf16_f32 v106, v92, v93
    v_add_f32 v14, v14, v94
    v_mfma_f32_16x16x32_bf16 a[196:199], v[140:143], v[108:111], a[196:199]
    v_add_f32 v15, v15, v95
    v_cvt_pk_bf16_f32 v107, v94, v95
    v_mfma_f32_16x16x32_bf16 v[88:91], v[56:59], a[48:51], v[40:43]
    v_mfma_f32_16x16x32_bf16 v[88:91], v[60:63], a[52:55], v[88:91]
    s_add_u32 m0, m0, s53
    v_exp_f32 v96, v96
    v_mfma_f32_16x16x32_bf16 v[88:91], v[64:67], a[56:59], v[88:91]
    v_exp_f32 v97, v97
    v_mfma_f32_16x16x32_bf16 v[88:91], v[68:71], a[60:63], v[88:91]
    s_add_u32 s28, s49, s90
    v_exp_f32 v98, v98
    v_mfma_f32_16x16x32_bf16 v[92:95], v[84:87], a[60:63], v[40:43]
    v_exp_f32 v99, v99
    v_mfma_f32_16x16x32_bf16 v[92:95], v[80:83], a[56:59], v[92:95]
    buffer_load_dwordx4 v26, s[16:19], s28 offen lds
    v_add_f32 v16, v16, v96
    v_add_f32 v17, v17, v97
    v_mfma_f32_16x16x32_bf16 v[92:95], v[76:79], a[52:55], v[92:95]
    v_cvt_pk_bf16_f32 v108, v96, v97
    v_mfma_f32_16x16x32_bf16 v[92:95], v[72:75], a[48:51], v[92:95]
    v_exp_f32 v100, v100
    v_mfma_f32_16x16x32_bf16 v[148:151], v[112:115], v[104:107], v[148:151]
    s_add_u32 m0, m0, s53
    v_exp_f32 v101, v101
    v_mfma_f32_16x16x32_bf16 v[176:179], v[116:119], v[104:107], v[176:179]
    v_add_f32 v16, v16, v98
    v_add_f32 v17, v17, v99
    v_mfma_f32_16x16x32_bf16 v[204:207], v[120:123], v[104:107], v[204:207]
    s_add_u32 s28, s49, s91
    v_cvt_pk_bf16_f32 v109, v98, v99
    v_mfma_f32_16x16x32_bf16 v[232:235], v[124:127], v[104:107], v[232:235]
    v_exp_f32 v102, v102
    v_mfma_f32_16x16x32_bf16 a[116:119], v[128:131], v[104:107], a[116:119]
    buffer_load_dwordx4 v26, s[16:19], s28 offen lds
    v_exp_f32 v103, v103
    v_mfma_f32_16x16x32_bf16 a[144:147], v[132:135], v[104:107], a[144:147]
    v_add_f32 v16, v16, v100
    v_add_f32 v17, v17, v101
    v_mfma_f32_16x16x32_bf16 a[172:175], v[136:139], v[104:107], a[172:175]
    s_add_u32 m0, m0, s53
    v_cvt_pk_bf16_f32 v110, v100, v101
    v_add_f32 v16, v16, v102
    v_mfma_f32_16x16x32_bf16 a[200:203], v[140:143], v[104:107], a[200:203]
    v_add_f32 v17, v17, v103
    v_cvt_pk_bf16_f32 v111, v102, v103
    v_mfma_f32_16x16x32_bf16 v[96:99], v[56:59], a[64:67], v[44:47]
    v_mfma_f32_16x16x32_bf16 v[96:99], v[60:63], a[68:71], v[96:99]
    s_add_u32 s28, s49, s92
    v_exp_f32 v88, v88
    v_mfma_f32_16x16x32_bf16 v[96:99], v[64:67], a[72:75], v[96:99]
    v_exp_f32 v89, v89
    v_mfma_f32_16x16x32_bf16 v[96:99], v[68:71], a[76:79], v[96:99]
    buffer_load_dwordx4 v26, s[16:19], s28 offen lds
    v_exp_f32 v90, v90
    v_mfma_f32_16x16x32_bf16 v[100:103], v[84:87], a[76:79], v[44:47]
    v_exp_f32 v91, v91
    v_mfma_f32_16x16x32_bf16 v[100:103], v[80:83], a[72:75], v[100:103]
    s_add_u32 m0, m0, s53
    v_add_f32 v18, v18, v88
    v_add_f32 v19, v19, v89
    v_mfma_f32_16x16x32_bf16 v[100:103], v[76:79], a[68:71], v[100:103]
    v_cvt_pk_bf16_f32 v104, v88, v89
    v_mfma_f32_16x16x32_bf16 v[100:103], v[72:75], a[64:67], v[100:103]
    v_exp_f32 v92, v92
    v_mfma_f32_16x16x32_bf16 v[152:155], v[112:115], v[108:111], v[152:155]
    s_add_u32 s28, s49, s93
    v_exp_f32 v93, v93
    v_mfma_f32_16x16x32_bf16 v[180:183], v[116:119], v[108:111], v[180:183]
    v_add_f32 v18, v18, v90
    v_add_f32 v19, v19, v91
    v_mfma_f32_16x16x32_bf16 v[208:211], v[120:123], v[108:111], v[208:211]
    buffer_load_dwordx4 v26, s[16:19], s28 offen lds
    v_cvt_pk_bf16_f32 v105, v90, v91
    v_mfma_f32_16x16x32_bf16 v[236:239], v[124:127], v[108:111], v[236:239]
    v_exp_f32 v94, v94
    v_mfma_f32_16x16x32_bf16 a[120:123], v[128:131], v[108:111], a[120:123]
    s_add_u32 m0, m0, s53
    v_exp_f32 v95, v95
    v_mfma_f32_16x16x32_bf16 a[148:151], v[132:135], v[108:111], a[148:151]
    v_add_f32 v18, v18, v92
    v_add_f32 v19, v19, v93
    v_mfma_f32_16x16x32_bf16 a[176:179], v[136:139], v[108:111], a[176:179]
    s_add_u32 s28, s49, s94
    v_cvt_pk_bf16_f32 v106, v92, v93
    v_add_f32 v18, v18, v94
    v_mfma_f32_16x16x32_bf16 a[204:207], v[140:143], v[108:111], a[204:207]
    v_add_f32 v19, v19, v95
    v_cvt_pk_bf16_f32 v107, v94, v95
    v_mfma_f32_16x16x32_bf16 v[88:91], v[56:59], a[80:83], v[48:51]
    v_mfma_f32_16x16x32_bf16 v[88:91], v[60:63], a[84:87], v[88:91]
    buffer_load_dwordx4 v26, s[16:19], s28 offen lds
    v_exp_f32 v96, v96
    v_mfma_f32_16x16x32_bf16 v[88:91], v[64:67], a[88:91], v[88:91]
    v_exp_f32 v97, v97
    v_mfma_f32_16x16x32_bf16 v[88:91], v[68:71], a[92:95], v[88:91]
    s_add_u32 m0, m0, s53
    v_exp_f32 v98, v98
    v_mfma_f32_16x16x32_bf16 v[92:95], v[84:87], a[92:95], v[48:51]
    v_exp_f32 v99, v99
    v_mfma_f32_16x16x32_bf16 v[92:95], v[80:83], a[88:91], v[92:95]
    s_add_u32 s28, s49, s95
    v_add_f32 v20, v20, v96
    v_add_f32 v21, v21, v97
    v_mfma_f32_16x16x32_bf16 v[92:95], v[76:79], a[84:87], v[92:95]
    v_cvt_pk_bf16_f32 v108, v96, v97
    v_mfma_f32_16x16x32_bf16 v[92:95], v[72:75], a[80:83], v[92:95]
    v_exp_f32 v100, v100
    v_mfma_f32_16x16x32_bf16 v[156:159], v[112:115], v[104:107], v[156:159]
    buffer_load_dwordx4 v26, s[16:19], s28 offen lds
    v_exp_f32 v101, v101
    v_mfma_f32_16x16x32_bf16 v[184:187], v[116:119], v[104:107], v[184:187]
    v_add_f32 v20, v20, v98
    v_add_f32 v21, v21, v99
    v_mfma_f32_16x16x32_bf16 v[212:215], v[120:123], v[104:107], v[212:215]
    v_cvt_pk_bf16_f32 v109, v98, v99
    v_mfma_f32_16x16x32_bf16 v[240:243], v[124:127], v[104:107], v[240:243]
    v_exp_f32 v102, v102
    v_mfma_f32_16x16x32_bf16 a[124:127], v[128:131], v[104:107], a[124:127]
    v_exp_f32 v103, v103
    v_mfma_f32_16x16x32_bf16 a[152:155], v[132:135], v[104:107], a[152:155]
    v_add_f32 v20, v20, v100
    v_add_f32 v21, v21, v101
    v_mfma_f32_16x16x32_bf16 a[180:183], v[136:139], v[104:107], a[180:183]
    v_cvt_pk_bf16_f32 v110, v100, v101
    v_add_f32 v20, v20, v102
    v_mfma_f32_16x16x32_bf16 a[208:211], v[140:143], v[104:107], a[208:211]
    v_add_f32 v21, v21, v103
    v_cvt_pk_bf16_f32 v111, v102, v103
    s_waitcnt vmcnt(16) lgkmcnt(0)
    s_barrier
    v_mfma_f32_16x16x32_bf16 v[96:99], v[56:59], a[96:99], v[52:55]
    ds_read_b128 v[56:59], v8 offset:16896
    v_mfma_f32_16x16x32_bf16 v[96:99], v[60:63], a[100:103], v[96:99]
    ds_read_b128 v[60:63], v8 offset:16960
    v_exp_f32 v88, v88
    v_mfma_f32_16x16x32_bf16 v[96:99], v[64:67], a[104:107], v[96:99]
    ds_read_b128 v[64:67], v8 offset:17024
    v_exp_f32 v89, v89
    v_mfma_f32_16x16x32_bf16 v[96:99], v[68:71], a[108:111], v[96:99]
    ds_read_b128 v[68:71], v8 offset:17088
    v_exp_f32 v90, v90
    v_mfma_f32_16x16x32_bf16 v[100:103], v[84:87], a[108:111], v[52:55]
    ds_read_b128 v[84:87], v8 offset:17600
    v_exp_f32 v91, v91
    v_mfma_f32_16x16x32_bf16 v[100:103], v[80:83], a[104:107], v[100:103]
    ds_read_b128 v[80:83], v8 offset:17536
    v_add_f32 v22, v22, v88
    v_add_f32 v23, v23, v89
    v_mfma_f32_16x16x32_bf16 v[100:103], v[76:79], a[100:103], v[100:103]
    ds_read_b128 v[76:79], v8 offset:17472
    v_cvt_pk_bf16_f32 v104, v88, v89
    v_mfma_f32_16x16x32_bf16 v[100:103], v[72:75], a[96:99], v[100:103]
    ds_read_b128 v[72:75], v8 offset:17408
    v_exp_f32 v92, v92
    v_mfma_f32_16x16x32_bf16 v[160:163], v[112:115], v[108:111], v[160:163]
    v_exp_f32 v93, v93
    v_mfma_f32_16x16x32_bf16 v[188:191], v[116:119], v[108:111], v[188:191]
    v_add_f32 v22, v22, v90
    v_add_f32 v23, v23, v91
    v_mfma_f32_16x16x32_bf16 v[216:219], v[120:123], v[108:111], v[216:219]
    v_cvt_pk_bf16_f32 v105, v90, v91
    v_mfma_f32_16x16x32_bf16 v[244:247], v[124:127], v[108:111], v[244:247]
    v_exp_f32 v94, v94
    v_mfma_f32_16x16x32_bf16 a[128:131], v[128:131], v[108:111], a[128:131]
    v_exp_f32 v95, v95
    v_mfma_f32_16x16x32_bf16 a[156:159], v[132:135], v[108:111], a[156:159]
    v_add_f32 v22, v22, v92
    v_add_f32 v23, v23, v93
    v_mfma_f32_16x16x32_bf16 a[184:187], v[136:139], v[108:111], a[184:187]
    v_cvt_pk_bf16_f32 v106, v92, v93
    v_add_f32 v22, v22, v94
    v_mfma_f32_16x16x32_bf16 a[212:215], v[140:143], v[108:111], a[212:215]
    v_add_f32 v23, v23, v95
    v_cvt_pk_bf16_f32 v107, v94, v95
    s_waitcnt lgkmcnt(0)
    v_mfma_f32_16x16x32_bf16 v[88:91], v[56:59], a[0:3], v[28:31]
    v_mfma_f32_16x16x32_bf16 v[88:91], v[60:63], a[4:7], v[88:91]
    v_exp_f32 v96, v96
    v_mfma_f32_16x16x32_bf16 v[88:91], v[64:67], a[8:11], v[88:91]
    v_exp_f32 v97, v97
    v_mfma_f32_16x16x32_bf16 v[88:91], v[68:71], a[12:15], v[88:91]
    v_exp_f32 v98, v98
    v_mfma_f32_16x16x32_bf16 v[92:95], v[84:87], a[12:15], v[28:31]
    v_exp_f32 v99, v99
    v_mfma_f32_16x16x32_bf16 v[92:95], v[80:83], a[8:11], v[92:95]
    v_add_f32 v24, v24, v96
    v_add_f32 v25, v25, v97
    v_mfma_f32_16x16x32_bf16 v[92:95], v[76:79], a[4:7], v[92:95]
    v_cvt_pk_bf16_f32 v108, v96, v97
    v_mfma_f32_16x16x32_bf16 v[92:95], v[72:75], a[0:3], v[92:95]
    v_exp_f32 v100, v100
    v_mfma_f32_16x16x32_bf16 v[164:167], v[112:115], v[104:107], v[164:167]
    v_exp_f32 v101, v101
    v_mfma_f32_16x16x32_bf16 v[192:195], v[116:119], v[104:107], v[192:195]
    v_add_f32 v24, v24, v98
    v_add_f32 v25, v25, v99
    v_mfma_f32_16x16x32_bf16 v[220:223], v[120:123], v[104:107], v[220:223]
    v_cvt_pk_bf16_f32 v109, v98, v99
    v_mfma_f32_16x16x32_bf16 v[248:251], v[124:127], v[104:107], v[248:251]
    v_exp_f32 v102, v102
    v_mfma_f32_16x16x32_bf16 a[132:135], v[128:131], v[104:107], a[132:135]
    v_exp_f32 v103, v103
    v_mfma_f32_16x16x32_bf16 a[160:163], v[132:135], v[104:107], a[160:163]
    v_add_f32 v24, v24, v100
    v_add_f32 v25, v25, v101
    v_mfma_f32_16x16x32_bf16 a[188:191], v[136:139], v[104:107], a[188:191]
    v_cvt_pk_bf16_f32 v110, v100, v101
    v_add_f32 v24, v24, v102
    v_mfma_f32_16x16x32_bf16 a[216:219], v[140:143], v[104:107], a[216:219]
    v_add_f32 v25, v25, v103
    v_cvt_pk_bf16_f32 v111, v102, v103
    v_mfma_f32_16x16x32_bf16 v[96:99], v[56:59], a[16:19], v[32:35]
    v_mfma_f32_16x16x32_bf16 v[96:99], v[60:63], a[20:23], v[96:99]
    v_exp_f32 v88, v88
    v_mfma_f32_16x16x32_bf16 v[96:99], v[64:67], a[24:27], v[96:99]
    v_exp_f32 v89, v89
    v_mfma_f32_16x16x32_bf16 v[96:99], v[68:71], a[28:31], v[96:99]
    v_exp_f32 v90, v90
    v_mfma_f32_16x16x32_bf16 v[100:103], v[84:87], a[28:31], v[32:35]
    v_exp_f32 v91, v91
    v_mfma_f32_16x16x32_bf16 v[100:103], v[80:83], a[24:27], v[100:103]
    v_add_f32 v12, v12, v88
    v_add_f32 v13, v13, v89
    v_mfma_f32_16x16x32_bf16 v[100:103], v[76:79], a[20:23], v[100:103]
    v_cvt_pk_bf16_f32 v104, v88, v89
    v_mfma_f32_16x16x32_bf16 v[100:103], v[72:75], a[16:19], v[100:103]
    v_exp_f32 v92, v92
    v_mfma_f32_16x16x32_bf16 v[168:171], v[112:115], v[108:111], v[168:171]
    ds_read_b64_tr_b16 v[112:113], v9 offset:16896
    ds_read_b64_tr_b16 v[114:115], v9 offset:17408
    v_exp_f32 v93, v93
    v_mfma_f32_16x16x32_bf16 v[196:199], v[116:119], v[108:111], v[196:199]
    ds_read_b64_tr_b16 v[116:117], v9 offset:16928
    ds_read_b64_tr_b16 v[118:119], v9 offset:17440
    v_add_f32 v12, v12, v90
    v_add_f32 v13, v13, v91
    v_mfma_f32_16x16x32_bf16 v[224:227], v[120:123], v[108:111], v[224:227]
    ds_read_b64_tr_b16 v[120:121], v9 offset:16960
    ds_read_b64_tr_b16 v[122:123], v9 offset:17472
    v_cvt_pk_bf16_f32 v105, v90, v91
    v_mfma_f32_16x16x32_bf16 v[252:255], v[124:127], v[108:111], v[252:255]
    ds_read_b64_tr_b16 v[124:125], v9 offset:16992
    ds_read_b64_tr_b16 v[126:127], v9 offset:17504
    v_exp_f32 v94, v94
    v_mfma_f32_16x16x32_bf16 a[136:139], v[128:131], v[108:111], a[136:139]
    ds_read_b64_tr_b16 v[128:129], v9 offset:17024
    ds_read_b64_tr_b16 v[130:131], v9 offset:17536
    v_exp_f32 v95, v95
    v_mfma_f32_16x16x32_bf16 a[164:167], v[132:135], v[108:111], a[164:167]
    ds_read_b64_tr_b16 v[132:133], v9 offset:17056
    ds_read_b64_tr_b16 v[134:135], v9 offset:17568
    v_add_f32 v12, v12, v92
    v_add_f32 v13, v13, v93
    v_mfma_f32_16x16x32_bf16 a[192:195], v[136:139], v[108:111], a[192:195]
    ds_read_b64_tr_b16 v[136:137], v9 offset:17088
    ds_read_b64_tr_b16 v[138:139], v9 offset:17600
    v_cvt_pk_bf16_f32 v106, v92, v93
    v_add_f32 v12, v12, v94
    v_mfma_f32_16x16x32_bf16 a[220:223], v[140:143], v[108:111], a[220:223]
    ds_read_b64_tr_b16 v[140:141], v9 offset:17120
    ds_read_b64_tr_b16 v[142:143], v9 offset:17632
    v_add_f32 v13, v13, v95
    v_cvt_pk_bf16_f32 v107, v94, v95
    v_mfma_f32_16x16x32_bf16 v[88:91], v[56:59], a[32:35], v[36:39]
    v_mfma_f32_16x16x32_bf16 v[88:91], v[60:63], a[36:39], v[88:91]
    s_add_u32 m0, s33, 8448
    v_exp_f32 v96, v96
    v_mfma_f32_16x16x32_bf16 v[88:91], v[64:67], a[40:43], v[88:91]
    v_exp_f32 v97, v97
    v_mfma_f32_16x16x32_bf16 v[88:91], v[68:71], a[44:47], v[88:91]
    s_add_u32 s49, s50, s46
    v_exp_f32 v98, v98
    v_mfma_f32_16x16x32_bf16 v[92:95], v[84:87], a[44:47], v[36:39]
    v_exp_f32 v99, v99
    v_mfma_f32_16x16x32_bf16 v[92:95], v[80:83], a[40:43], v[92:95]
    s_lshl1_add_u32 s50, s51, s50
    v_add_f32 v14, v14, v96
    v_add_f32 v15, v15, v97
    v_mfma_f32_16x16x32_bf16 v[92:95], v[76:79], a[36:39], v[92:95]
    v_cvt_pk_bf16_f32 v108, v96, v97
    v_mfma_f32_16x16x32_bf16 v[92:95], v[72:75], a[32:35], v[92:95]
    s_add_u32 s82, s82, 2
    v_exp_f32 v100, v100
    s_waitcnt lgkmcnt(0)
    v_mfma_f32_16x16x32_bf16 v[144:147], v[112:115], v[104:107], v[144:147]
    v_exp_f32 v101, v101
    v_mfma_f32_16x16x32_bf16 v[172:175], v[116:119], v[104:107], v[172:175]
    s_cmp_eq_u32 s82, 20
    v_add_f32 v14, v14, v98
    v_add_f32 v15, v15, v99
    v_mfma_f32_16x16x32_bf16 v[200:203], v[120:123], v[104:107], v[200:203]
    v_cvt_pk_bf16_f32 v109, v98, v99
    v_mfma_f32_16x16x32_bf16 v[228:231], v[124:127], v[104:107], v[228:231]
    s_cselect_b32 s29, s83, 0
    v_exp_f32 v102, v102
    v_mfma_f32_16x16x32_bf16 a[112:115], v[128:131], v[104:107], a[112:115]
    v_exp_f32 v103, v103
    v_mfma_f32_16x16x32_bf16 a[140:143], v[132:135], v[104:107], a[140:143]
    s_sub_u32 s50, s50, s29
    v_add_f32 v14, v14, v100
    v_add_f32 v15, v15, v101
    v_mfma_f32_16x16x32_bf16 a[168:171], v[136:139], v[104:107], a[168:171]
    v_cvt_pk_bf16_f32 v110, v100, v101
    v_add_f32 v14, v14, v102
    v_mfma_f32_16x16x32_bf16 a[196:199], v[140:143], v[104:107], a[196:199]
    s_add_u32 s28, s49, s88
    v_add_f32 v15, v15, v103
    v_cvt_pk_bf16_f32 v111, v102, v103
    v_mfma_f32_16x16x32_bf16 v[96:99], v[56:59], a[48:51], v[40:43]
    v_mfma_f32_16x16x32_bf16 v[96:99], v[60:63], a[52:55], v[96:99]
    buffer_load_dwordx4 v26, s[16:19], s28 offen lds
    v_exp_f32 v88, v88
    v_mfma_f32_16x16x32_bf16 v[96:99], v[64:67], a[56:59], v[96:99]
    v_exp_f32 v89, v89
    v_mfma_f32_16x16x32_bf16 v[96:99], v[68:71], a[60:63], v[96:99]
    s_add_u32 m0, m0, s53
    v_exp_f32 v90, v90
    v_mfma_f32_16x16x32_bf16 v[100:103], v[84:87], a[60:63], v[40:43]
    v_exp_f32 v91, v91
    v_mfma_f32_16x16x32_bf16 v[100:103], v[80:83], a[56:59], v[100:103]
    s_add_u32 s28, s49, s89
    v_add_f32 v16, v16, v88
    v_add_f32 v17, v17, v89
    v_mfma_f32_16x16x32_bf16 v[100:103], v[76:79], a[52:55], v[100:103]
    v_cvt_pk_bf16_f32 v104, v88, v89
    v_mfma_f32_16x16x32_bf16 v[100:103], v[72:75], a[48:51], v[100:103]
    buffer_load_dwordx4 v26, s[16:19], s28 offen lds
    v_exp_f32 v92, v92
    v_mfma_f32_16x16x32_bf16 v[148:151], v[112:115], v[108:111], v[148:151]
    v_exp_f32 v93, v93
    v_mfma_f32_16x16x32_bf16 v[176:179], v[116:119], v[108:111], v[176:179]
    s_add_u32 m0, m0, s53
    v_add_f32 v16, v16, v90
    v_add_f32 v17, v17, v91
    v_mfma_f32_16x16x32_bf16 v[204:207], v[120:123], v[108:111], v[204:207]
    v_cvt_pk_bf16_f32 v105, v90, v91
    v_mfma_f32_16x16x32_bf16 v[232:235], v[124:127], v[108:111], v[232:235]
    s_add_u32 s28, s49, s90
    v_exp_f32 v94, v94
    v_mfma_f32_16x16x32_bf16 a[116:119], v[128:131], v[108:111], a[116:119]
    v_exp_f32 v95, v95
    v_mfma_f32_16x16x32_bf16 a[144:147], v[132:135], v[108:111], a[144:147]
    buffer_load_dwordx4 v26, s[16:19], s28 offen lds
    v_add_f32 v16, v16, v92
    v_add_f32 v17, v17, v93
    v_mfma_f32_16x16x32_bf16 a[172:175], v[136:139], v[108:111], a[172:175]
    v_cvt_pk_bf16_f32 v106, v92, v93
    v_add_f32 v16, v16, v94
    v_mfma_f32_16x16x32_bf16 a[200:203], v[140:143], v[108:111], a[200:203]
    s_add_u32 m0, m0, s53
    v_add_f32 v17, v17, v95
    v_cvt_pk_bf16_f32 v107, v94, v95
    v_mfma_f32_16x16x32_bf16 v[88:91], v[56:59], a[64:67], v[44:47]
    v_mfma_f32_16x16x32_bf16 v[88:91], v[60:63], a[68:71], v[88:91]
    s_add_u32 s28, s49, s91
    v_exp_f32 v96, v96
    v_mfma_f32_16x16x32_bf16 v[88:91], v[64:67], a[72:75], v[88:91]
    v_exp_f32 v97, v97
    v_mfma_f32_16x16x32_bf16 v[88:91], v[68:71], a[76:79], v[88:91]
    buffer_load_dwordx4 v26, s[16:19], s28 offen lds
    v_exp_f32 v98, v98
    v_mfma_f32_16x16x32_bf16 v[92:95], v[84:87], a[76:79], v[44:47]
    v_exp_f32 v99, v99
    v_mfma_f32_16x16x32_bf16 v[92:95], v[80:83], a[72:75], v[92:95]
    s_add_u32 m0, m0, s53
    v_add_f32 v18, v18, v96
    v_add_f32 v19, v19, v97
    v_mfma_f32_16x16x32_bf16 v[92:95], v[76:79], a[68:71], v[92:95]
    v_cvt_pk_bf16_f32 v108, v96, v97
    v_mfma_f32_16x16x32_bf16 v[92:95], v[72:75], a[64:67], v[92:95]
    s_add_u32 s28, s49, s92
    v_exp_f32 v100, v100
    v_mfma_f32_16x16x32_bf16 v[152:155], v[112:115], v[104:107], v[152:155]
    v_exp_f32 v101, v101
    v_mfma_f32_16x16x32_bf16 v[180:183], v[116:119], v[104:107], v[180:183]
    buffer_load_dwordx4 v26, s[16:19], s28 offen lds
    v_add_f32 v18, v18, v98
    v_add_f32 v19, v19, v99
    v_mfma_f32_16x16x32_bf16 v[208:211], v[120:123], v[104:107], v[208:211]
    v_cvt_pk_bf16_f32 v109, v98, v99
    v_mfma_f32_16x16x32_bf16 v[236:239], v[124:127], v[104:107], v[236:239]
    s_add_u32 m0, m0, s53
    v_exp_f32 v102, v102
    v_mfma_f32_16x16x32_bf16 a[120:123], v[128:131], v[104:107], a[120:123]
    v_exp_f32 v103, v103
    v_mfma_f32_16x16x32_bf16 a[148:151], v[132:135], v[104:107], a[148:151]
    s_add_u32 s28, s49, s93
    v_add_f32 v18, v18, v100
    v_add_f32 v19, v19, v101
    v_mfma_f32_16x16x32_bf16 a[176:179], v[136:139], v[104:107], a[176:179]
    v_cvt_pk_bf16_f32 v110, v100, v101
    v_add_f32 v18, v18, v102
    v_mfma_f32_16x16x32_bf16 a[204:207], v[140:143], v[104:107], a[204:207]
    buffer_load_dwordx4 v26, s[16:19], s28 offen lds
    v_add_f32 v19, v19, v103
    v_cvt_pk_bf16_f32 v111, v102, v103
    v_mfma_f32_16x16x32_bf16 v[96:99], v[56:59], a[80:83], v[48:51]
    v_mfma_f32_16x16x32_bf16 v[96:99], v[60:63], a[84:87], v[96:99]
    s_add_u32 m0, m0, s53
    v_exp_f32 v88, v88
    v_mfma_f32_16x16x32_bf16 v[96:99], v[64:67], a[88:91], v[96:99]
    v_exp_f32 v89, v89
    v_mfma_f32_16x16x32_bf16 v[96:99], v[68:71], a[92:95], v[96:99]
    s_add_u32 s28, s49, s47
    v_exp_f32 v90, v90
    v_mfma_f32_16x16x32_bf16 v[100:103], v[84:87], a[92:95], v[48:51]
    v_exp_f32 v91, v91
    v_mfma_f32_16x16x32_bf16 v[100:103], v[80:83], a[88:91], v[100:103]
    buffer_load_dwordx4 v26, s[16:19], s28 offen lds
    v_add_f32 v20, v20, v88
    v_add_f32 v21, v21, v89
    v_mfma_f32_16x16x32_bf16 v[100:103], v[76:79], a[84:87], v[100:103]
    v_cvt_pk_bf16_f32 v104, v88, v89
    v_mfma_f32_16x16x32_bf16 v[100:103], v[72:75], a[80:83], v[100:103]
    s_add_u32 m0, m0, s53
    v_exp_f32 v92, v92
    v_mfma_f32_16x16x32_bf16 v[156:159], v[112:115], v[108:111], v[156:159]
    v_exp_f32 v93, v93
    v_mfma_f32_16x16x32_bf16 v[184:187], v[116:119], v[108:111], v[184:187]
    s_add_u32 s28, s49, s98
    v_add_f32 v20, v20, v90
    v_add_f32 v21, v21, v91
    v_mfma_f32_16x16x32_bf16 v[212:215], v[120:123], v[108:111], v[212:215]
    v_cvt_pk_bf16_f32 v105, v90, v91
    v_mfma_f32_16x16x32_bf16 v[240:243], v[124:127], v[108:111], v[240:243]
    buffer_load_dwordx4 v26, s[16:19], s28 offen lds
    v_exp_f32 v94, v94
    v_mfma_f32_16x16x32_bf16 a[124:127], v[128:131], v[108:111], a[124:127]
    v_exp_f32 v95, v95
    v_mfma_f32_16x16x32_bf16 a[152:155], v[132:135], v[108:111], a[152:155]
    v_add_f32 v20, v20, v92
    v_add_f32 v21, v21, v93
    v_mfma_f32_16x16x32_bf16 a[180:183], v[136:139], v[108:111], a[180:183]
    v_cvt_pk_bf16_f32 v106, v92, v93
    v_add_f32 v20, v20, v94
    v_mfma_f32_16x16x32_bf16 a[208:211], v[140:143], v[108:111], a[208:211]
    v_add_f32 v21, v21, v95
    v_cvt_pk_bf16_f32 v107, v94, v95
    s_waitcnt vmcnt(16) lgkmcnt(0)
    s_barrier
    v_mfma_f32_16x16x32_bf16 v[88:91], v[56:59], a[96:99], v[52:55]
    ds_read_b128 v[56:59], v8 offset:25344
    v_mfma_f32_16x16x32_bf16 v[88:91], v[60:63], a[100:103], v[88:91]
    ds_read_b128 v[60:63], v8 offset:25408
    v_exp_f32 v96, v96
    v_mfma_f32_16x16x32_bf16 v[88:91], v[64:67], a[104:107], v[88:91]
    ds_read_b128 v[64:67], v8 offset:25472
    v_exp_f32 v97, v97
    v_mfma_f32_16x16x32_bf16 v[88:91], v[68:71], a[108:111], v[88:91]
    ds_read_b128 v[68:71], v8 offset:25536
    v_exp_f32 v98, v98
    v_mfma_f32_16x16x32_bf16 v[92:95], v[84:87], a[108:111], v[52:55]
    ds_read_b128 v[84:87], v8 offset:26048
    v_exp_f32 v99, v99
    v_mfma_f32_16x16x32_bf16 v[92:95], v[80:83], a[104:107], v[92:95]
    ds_read_b128 v[80:83], v8 offset:25984
    v_add_f32 v22, v22, v96
    v_add_f32 v23, v23, v97
    v_mfma_f32_16x16x32_bf16 v[92:95], v[76:79], a[100:103], v[92:95]
    ds_read_b128 v[76:79], v8 offset:25920
    v_cvt_pk_bf16_f32 v108, v96, v97
    v_mfma_f32_16x16x32_bf16 v[92:95], v[72:75], a[96:99], v[92:95]
    ds_read_b128 v[72:75], v8 offset:25856
    v_exp_f32 v100, v100
    v_mfma_f32_16x16x32_bf16 v[160:163], v[112:115], v[104:107], v[160:163]
    v_exp_f32 v101, v101
    v_mfma_f32_16x16x32_bf16 v[188:191], v[116:119], v[104:107], v[188:191]
    v_add_f32 v22, v22, v98
    v_add_f32 v23, v23, v99
    v_mfma_f32_16x16x32_bf16 v[216:219], v[120:123], v[104:107], v[216:219]
    v_cvt_pk_bf16_f32 v109, v98, v99
    v_mfma_f32_16x16x32_bf16 v[244:247], v[124:127], v[104:107], v[244:247]
    v_exp_f32 v102, v102
    v_mfma_f32_16x16x32_bf16 a[128:131], v[128:131], v[104:107], a[128:131]
    v_exp_f32 v103, v103
    v_mfma_f32_16x16x32_bf16 a[156:159], v[132:135], v[104:107], a[156:159]
    v_add_f32 v22, v22, v100
    v_add_f32 v23, v23, v101
    v_mfma_f32_16x16x32_bf16 a[184:187], v[136:139], v[104:107], a[184:187]
    v_cvt_pk_bf16_f32 v110, v100, v101
    v_add_f32 v22, v22, v102
    v_mfma_f32_16x16x32_bf16 a[212:215], v[140:143], v[104:107], a[212:215]
    v_add_f32 v23, v23, v103
    v_cvt_pk_bf16_f32 v111, v102, v103
    s_waitcnt lgkmcnt(0)
    v_mfma_f32_16x16x32_bf16 v[96:99], v[56:59], a[0:3], v[28:31]
    v_mfma_f32_16x16x32_bf16 v[96:99], v[60:63], a[4:7], v[96:99]
    v_exp_f32 v88, v88
    v_mfma_f32_16x16x32_bf16 v[96:99], v[64:67], a[8:11], v[96:99]
    v_exp_f32 v89, v89
    v_mfma_f32_16x16x32_bf16 v[96:99], v[68:71], a[12:15], v[96:99]
    v_exp_f32 v90, v90
    v_mfma_f32_16x16x32_bf16 v[100:103], v[84:87], a[12:15], v[28:31]
    v_exp_f32 v91, v91
    v_mfma_f32_16x16x32_bf16 v[100:103], v[80:83], a[8:11], v[100:103]
    v_add_f32 v24, v24, v88
    v_add_f32 v25, v25, v89
    v_mfma_f32_16x16x32_bf16 v[100:103], v[76:79], a[4:7], v[100:103]
    v_cvt_pk_bf16_f32 v104, v88, v89
    v_mfma_f32_16x16x32_bf16 v[100:103], v[72:75], a[0:3], v[100:103]
    v_exp_f32 v92, v92
    v_mfma_f32_16x16x32_bf16 v[164:167], v[112:115], v[108:111], v[164:167]
    v_exp_f32 v93, v93
    v_mfma_f32_16x16x32_bf16 v[192:195], v[116:119], v[108:111], v[192:195]
    v_add_f32 v24, v24, v90
    v_add_f32 v25, v25, v91
    v_mfma_f32_16x16x32_bf16 v[220:223], v[120:123], v[108:111], v[220:223]
    v_cvt_pk_bf16_f32 v105, v90, v91
    v_mfma_f32_16x16x32_bf16 v[248:251], v[124:127], v[108:111], v[248:251]
    v_exp_f32 v94, v94
    v_mfma_f32_16x16x32_bf16 a[132:135], v[128:131], v[108:111], a[132:135]
    v_exp_f32 v95, v95
    v_mfma_f32_16x16x32_bf16 a[160:163], v[132:135], v[108:111], a[160:163]
    v_add_f32 v24, v24, v92
    v_add_f32 v25, v25, v93
    v_mfma_f32_16x16x32_bf16 a[188:191], v[136:139], v[108:111], a[188:191]
    v_cvt_pk_bf16_f32 v106, v92, v93
    v_add_f32 v24, v24, v94
    v_mfma_f32_16x16x32_bf16 a[216:219], v[140:143], v[108:111], a[216:219]
    v_add_f32 v25, v25, v95
    v_cvt_pk_bf16_f32 v107, v94, v95
    v_mfma_f32_16x16x32_bf16 v[88:91], v[56:59], a[16:19], v[32:35]
    v_mfma_f32_16x16x32_bf16 v[88:91], v[60:63], a[20:23], v[88:91]
    v_exp_f32 v96, v96
    v_mfma_f32_16x16x32_bf16 v[88:91], v[64:67], a[24:27], v[88:91]
    v_exp_f32 v97, v97
    v_mfma_f32_16x16x32_bf16 v[88:91], v[68:71], a[28:31], v[88:91]
    v_exp_f32 v98, v98
    v_mfma_f32_16x16x32_bf16 v[92:95], v[84:87], a[28:31], v[32:35]
    v_exp_f32 v99, v99
    v_mfma_f32_16x16x32_bf16 v[92:95], v[80:83], a[24:27], v[92:95]
    v_add_f32 v12, v12, v96
    v_add_f32 v13, v13, v97
    v_mfma_f32_16x16x32_bf16 v[92:95], v[76:79], a[20:23], v[92:95]
    v_cvt_pk_bf16_f32 v108, v96, v97
    v_mfma_f32_16x16x32_bf16 v[92:95], v[72:75], a[16:19], v[92:95]
    v_exp_f32 v100, v100
    v_mfma_f32_16x16x32_bf16 v[168:171], v[112:115], v[104:107], v[168:171]
    ds_read_b64_tr_b16 v[112:113], v9 offset:25344
    ds_read_b64_tr_b16 v[114:115], v9 offset:25856
    v_exp_f32 v101, v101
    v_mfma_f32_16x16x32_bf16 v[196:199], v[116:119], v[104:107], v[196:199]
    ds_read_b64_tr_b16 v[116:117], v9 offset:25376
    ds_read_b64_tr_b16 v[118:119], v9 offset:25888
    v_add_f32 v12, v12, v98
    v_add_f32 v13, v13, v99
    v_mfma_f32_16x16x32_bf16 v[224:227], v[120:123], v[104:107], v[224:227]
    ds_read_b64_tr_b16 v[120:121], v9 offset:25408
    ds_read_b64_tr_b16 v[122:123], v9 offset:25920
    v_cvt_pk_bf16_f32 v109, v98, v99
    v_mfma_f32_16x16x32_bf16 v[252:255], v[124:127], v[104:107], v[252:255]
    ds_read_b64_tr_b16 v[124:125], v9 offset:25440
    ds_read_b64_tr_b16 v[126:127], v9 offset:25952
    v_exp_f32 v102, v102
    v_mfma_f32_16x16x32_bf16 a[136:139], v[128:131], v[104:107], a[136:139]
    ds_read_b64_tr_b16 v[128:129], v9 offset:25472
    ds_read_b64_tr_b16 v[130:131], v9 offset:25984
    v_exp_f32 v103, v103
    v_mfma_f32_16x16x32_bf16 a[164:167], v[132:135], v[104:107], a[164:167]
    ds_read_b64_tr_b16 v[132:133], v9 offset:25504
    ds_read_b64_tr_b16 v[134:135], v9 offset:26016
    v_add_f32 v12, v12, v100
    v_add_f32 v13, v13, v101
    v_mfma_f32_16x16x32_bf16 a[192:195], v[136:139], v[104:107], a[192:195]
    ds_read_b64_tr_b16 v[136:137], v9 offset:25536
    ds_read_b64_tr_b16 v[138:139], v9 offset:26048
    v_cvt_pk_bf16_f32 v110, v100, v101
    v_add_f32 v12, v12, v102
    v_mfma_f32_16x16x32_bf16 a[220:223], v[140:143], v[104:107], a[220:223]
    ds_read_b64_tr_b16 v[140:141], v9 offset:25568
    ds_read_b64_tr_b16 v[142:143], v9 offset:26080
    v_add_f32 v13, v13, v103
    v_cvt_pk_bf16_f32 v111, v102, v103
    v_mfma_f32_16x16x32_bf16 v[96:99], v[56:59], a[32:35], v[36:39]
    v_mfma_f32_16x16x32_bf16 v[96:99], v[60:63], a[36:39], v[96:99]
    s_add_u32 m0, s33, 16896
    v_exp_f32 v88, v88
    v_mfma_f32_16x16x32_bf16 v[96:99], v[64:67], a[40:43], v[96:99]
    v_exp_f32 v89, v89
    v_mfma_f32_16x16x32_bf16 v[96:99], v[68:71], a[44:47], v[96:99]
    s_mov_b32 s49, s50
    v_exp_f32 v90, v90
    v_mfma_f32_16x16x32_bf16 v[100:103], v[84:87], a[44:47], v[36:39]
    v_exp_f32 v91, v91
    v_mfma_f32_16x16x32_bf16 v[100:103], v[80:83], a[40:43], v[100:103]
    s_add_u32 s28, s49, s88
    v_add_f32 v14, v14, v88
    v_add_f32 v15, v15, v89
    v_mfma_f32_16x16x32_bf16 v[100:103], v[76:79], a[36:39], v[100:103]
    v_cvt_pk_bf16_f32 v104, v88, v89
    v_mfma_f32_16x16x32_bf16 v[100:103], v[72:75], a[32:35], v[100:103]
    v_exp_f32 v92, v92
    s_waitcnt lgkmcnt(0)
    v_mfma_f32_16x16x32_bf16 v[144:147], v[112:115], v[108:111], v[144:147]
    buffer_load_dwordx4 v26, s[16:19], s28 offen lds
    v_exp_f32 v93, v93
    v_mfma_f32_16x16x32_bf16 v[172:175], v[116:119], v[108:111], v[172:175]
    v_add_f32 v14, v14, v90
    v_add_f32 v15, v15, v91
    v_mfma_f32_16x16x32_bf16 v[200:203], v[120:123], v[108:111], v[200:203]
    s_add_u32 m0, m0, s53
    v_cvt_pk_bf16_f32 v105, v90, v91
    v_mfma_f32_16x16x32_bf16 v[228:231], v[124:127], v[108:111], v[228:231]
    v_exp_f32 v94, v94
    v_mfma_f32_16x16x32_bf16 a[112:115], v[128:131], v[108:111], a[112:115]
    s_add_u32 s28, s49, s89
    v_exp_f32 v95, v95
    v_mfma_f32_16x16x32_bf16 a[140:143], v[132:135], v[108:111], a[140:143]
    v_add_f32 v14, v14, v92
    v_add_f32 v15, v15, v93
    v_mfma_f32_16x16x32_bf16 a[168:171], v[136:139], v[108:111], a[168:171]
    buffer_load_dwordx4 v26, s[16:19], s28 offen lds
    v_cvt_pk_bf16_f32 v106, v92, v93
    v_add_f32 v14, v14, v94
    v_mfma_f32_16x16x32_bf16 a[196:199], v[140:143], v[108:111], a[196:199]
    v_add_f32 v15, v15, v95
    v_cvt_pk_bf16_f32 v107, v94, v95
    v_mfma_f32_16x16x32_bf16 v[88:91], v[56:59], a[48:51], v[40:43]
    v_mfma_f32_16x16x32_bf16 v[88:91], v[60:63], a[52:55], v[88:91]
    s_add_u32 m0, m0, s53
    v_exp_f32 v96, v96
    v_mfma_f32_16x16x32_bf16 v[88:91], v[64:67], a[56:59], v[88:91]
    v_exp_f32 v97, v97
    v_mfma_f32_16x16x32_bf16 v[88:91], v[68:71], a[60:63], v[88:91]
    s_add_u32 s28, s49, s90
    v_exp_f32 v98, v98
    v_mfma_f32_16x16x32_bf16 v[92:95], v[84:87], a[60:63], v[40:43]
    v_exp_f32 v99, v99
    v_mfma_f32_16x16x32_bf16 v[92:95], v[80:83], a[56:59], v[92:95]
    buffer_load_dwordx4 v26, s[16:19], s28 offen lds
    v_add_f32 v16, v16, v96
    v_add_f32 v17, v17, v97
    v_mfma_f32_16x16x32_bf16 v[92:95], v[76:79], a[52:55], v[92:95]
    v_cvt_pk_bf16_f32 v108, v96, v97
    v_mfma_f32_16x16x32_bf16 v[92:95], v[72:75], a[48:51], v[92:95]
    v_exp_f32 v100, v100
    v_mfma_f32_16x16x32_bf16 v[148:151], v[112:115], v[104:107], v[148:151]
    s_add_u32 m0, m0, s53
    v_exp_f32 v101, v101
    v_mfma_f32_16x16x32_bf16 v[176:179], v[116:119], v[104:107], v[176:179]
    v_add_f32 v16, v16, v98
    v_add_f32 v17, v17, v99
    v_mfma_f32_16x16x32_bf16 v[204:207], v[120:123], v[104:107], v[204:207]
    s_add_u32 s28, s49, s91
    v_cvt_pk_bf16_f32 v109, v98, v99
    v_mfma_f32_16x16x32_bf16 v[232:235], v[124:127], v[104:107], v[232:235]
    v_exp_f32 v102, v102
    v_mfma_f32_16x16x32_bf16 a[116:119], v[128:131], v[104:107], a[116:119]
    buffer_load_dwordx4 v26, s[16:19], s28 offen lds
    v_exp_f32 v103, v103
    v_mfma_f32_16x16x32_bf16 a[144:147], v[132:135], v[104:107], a[144:147]
    v_add_f32 v16, v16, v100
    v_add_f32 v17, v17, v101
    v_mfma_f32_16x16x32_bf16 a[172:175], v[136:139], v[104:107], a[172:175]
    s_add_u32 m0, m0, s53
    v_cvt_pk_bf16_f32 v110, v100, v101
    v_add_f32 v16, v16, v102
    v_mfma_f32_16x16x32_bf16 a[200:203], v[140:143], v[104:107], a[200:203]
    v_add_f32 v17, v17, v103
    v_cvt_pk_bf16_f32 v111, v102, v103
    v_mfma_f32_16x16x32_bf16 v[96:99], v[56:59], a[64:67], v[44:47]
    v_mfma_f32_16x16x32_bf16 v[96:99], v[60:63], a[68:71], v[96:99]
    s_add_u32 s28, s49, s92
    v_exp_f32 v88, v88
    v_mfma_f32_16x16x32_bf16 v[96:99], v[64:67], a[72:75], v[96:99]
    v_exp_f32 v89, v89
    v_mfma_f32_16x16x32_bf16 v[96:99], v[68:71], a[76:79], v[96:99]
    buffer_load_dwordx4 v26, s[16:19], s28 offen lds
    v_exp_f32 v90, v90
    v_mfma_f32_16x16x32_bf16 v[100:103], v[84:87], a[76:79], v[44:47]
    v_exp_f32 v91, v91
    v_mfma_f32_16x16x32_bf16 v[100:103], v[80:83], a[72:75], v[100:103]
    s_add_u32 m0, m0, s53
    v_add_f32 v18, v18, v88
    v_add_f32 v19, v19, v89
    v_mfma_f32_16x16x32_bf16 v[100:103], v[76:79], a[68:71], v[100:103]
    v_cvt_pk_bf16_f32 v104, v88, v89
    v_mfma_f32_16x16x32_bf16 v[100:103], v[72:75], a[64:67], v[100:103]
    v_exp_f32 v92, v92
    v_mfma_f32_16x16x32_bf16 v[152:155], v[112:115], v[108:111], v[152:155]
    s_add_u32 s28, s49, s93
    v_exp_f32 v93, v93
    v_mfma_f32_16x16x32_bf16 v[180:183], v[116:119], v[108:111], v[180:183]
    v_add_f32 v18, v18, v90
    v_add_f32 v19, v19, v91
    v_mfma_f32_16x16x32_bf16 v[208:211], v[120:123], v[108:111], v[208:211]
    buffer_load_dwordx4 v26, s[16:19], s28 offen lds
    v_cvt_pk_bf16_f32 v105, v90, v91
    v_mfma_f32_16x16x32_bf16 v[236:239], v[124:127], v[108:111], v[236:239]
    v_exp_f32 v94, v94
    v_mfma_f32_16x16x32_bf16 a[120:123], v[128:131], v[108:111], a[120:123]
    s_add_u32 m0, m0, s53
    v_exp_f32 v95, v95
    v_mfma_f32_16x16x32_bf16 a[148:151], v[132:135], v[108:111], a[148:151]
    v_add_f32 v18, v18, v92
    v_add_f32 v19, v19, v93
    v_mfma_f32_16x16x32_bf16 a[176:179], v[136:139], v[108:111], a[176:179]
    s_add_u32 s28, s49, s94
    v_cvt_pk_bf16_f32 v106, v92, v93
    v_add_f32 v18, v18, v94
    v_mfma_f32_16x16x32_bf16 a[204:207], v[140:143], v[108:111], a[204:207]
    v_add_f32 v19, v19, v95
    v_cvt_pk_bf16_f32 v107, v94, v95
    v_mfma_f32_16x16x32_bf16 v[88:91], v[56:59], a[80:83], v[48:51]
    v_mfma_f32_16x16x32_bf16 v[88:91], v[60:63], a[84:87], v[88:91]
    buffer_load_dwordx4 v26, s[16:19], s28 offen lds
    v_exp_f32 v96, v96
    v_mfma_f32_16x16x32_bf16 v[88:91], v[64:67], a[88:91], v[88:91]
    v_exp_f32 v97, v97
    v_mfma_f32_16x16x32_bf16 v[88:91], v[68:71], a[92:95], v[88:91]
    s_add_u32 m0, m0, s53
    v_exp_f32 v98, v98
    v_mfma_f32_16x16x32_bf16 v[92:95], v[84:87], a[92:95], v[48:51]
    v_exp_f32 v99, v99
    v_mfma_f32_16x16x32_bf16 v[92:95], v[80:83], a[88:91], v[92:95]
    s_add_u32 s28, s49, s95
    v_add_f32 v20, v20, v96
    v_add_f32 v21, v21, v97
    v_mfma_f32_16x16x32_bf16 v[92:95], v[76:79], a[84:87], v[92:95]
    v_cvt_pk_bf16_f32 v108, v96, v97
    v_mfma_f32_16x16x32_bf16 v[92:95], v[72:75], a[80:83], v[92:95]
    v_exp_f32 v100, v100
    v_mfma_f32_16x16x32_bf16 v[156:159], v[112:115], v[104:107], v[156:159]
    buffer_load_dwordx4 v26, s[16:19], s28 offen lds
    v_exp_f32 v101, v101
    v_mfma_f32_16x16x32_bf16 v[184:187], v[116:119], v[104:107], v[184:187]
    v_add_f32 v20, v20, v98
    v_add_f32 v21, v21, v99
    v_mfma_f32_16x16x32_bf16 v[212:215], v[120:123], v[104:107], v[212:215]
    v_cvt_pk_bf16_f32 v109, v98, v99
    v_mfma_f32_16x16x32_bf16 v[240:243], v[124:127], v[104:107], v[240:243]
    v_exp_f32 v102, v102
    v_mfma_f32_16x16x32_bf16 a[124:127], v[128:131], v[104:107], a[124:127]
    v_exp_f32 v103, v103
    v_mfma_f32_16x16x32_bf16 a[152:155], v[132:135], v[104:107], a[152:155]
    v_add_f32 v20, v20, v100
    v_add_f32 v21, v21, v101
    v_mfma_f32_16x16x32_bf16 a[180:183], v[136:139], v[104:107], a[180:183]
    v_cvt_pk_bf16_f32 v110, v100, v101
    v_add_f32 v20, v20, v102
    v_mfma_f32_16x16x32_bf16 a[208:211], v[140:143], v[104:107], a[208:211]
    v_add_f32 v21, v21, v103
    v_cvt_pk_bf16_f32 v111, v102, v103
    s_waitcnt vmcnt(8) lgkmcnt(0)
    s_barrier
    v_mfma_f32_16x16x32_bf16 v[96:99], v[56:59], a[96:99], v[52:55]
    s_add_u32 m0, s33, 25344
    v_mfma_f32_16x16x32_bf16 v[96:99], v[60:63], a[100:103], v[96:99]
    s_add_u32 s49, s50, s46
    v_exp_f32 v88, v88
    v_mfma_f32_16x16x32_bf16 v[96:99], v[64:67], a[104:107], v[96:99]
    s_lshl1_add_u32 s50, s51, s50
    v_exp_f32 v89, v89
    v_mfma_f32_16x16x32_bf16 v[96:99], v[68:71], a[108:111], v[96:99]
    s_add_u32 s82, s82, 2
    v_exp_f32 v90, v90
    v_mfma_f32_16x16x32_bf16 v[100:103], v[84:87], a[108:111], v[52:55]
    s_cmp_eq_u32 s82, 20
    v_exp_f32 v91, v91
    v_mfma_f32_16x16x32_bf16 v[100:103], v[80:83], a[104:107], v[100:103]
    s_cselect_b32 s29, s83, 0
    v_add_f32 v22, v22, v88
    v_add_f32 v23, v23, v89
    v_mfma_f32_16x16x32_bf16 v[100:103], v[76:79], a[100:103], v[100:103]
    s_sub_u32 s50, s50, s29
    v_cvt_pk_bf16_f32 v104, v88, v89
    v_mfma_f32_16x16x32_bf16 v[100:103], v[72:75], a[96:99], v[100:103]
    v_exp_f32 v92, v92
    v_mfma_f32_16x16x32_bf16 v[160:163], v[112:115], v[108:111], v[160:163]
    s_add_u32 s28, s49, s88
    v_exp_f32 v93, v93
    v_mfma_f32_16x16x32_bf16 v[188:191], v[116:119], v[108:111], v[188:191]
    buffer_load_dwordx4 v26, s[16:19], s28 offen lds
    v_add_f32 v22, v22, v90
    v_add_f32 v23, v23, v91
    v_mfma_f32_16x16x32_bf16 v[216:219], v[120:123], v[108:111], v[216:219]
    s_add_u32 m0, m0, s53
    v_cvt_pk_bf16_f32 v105, v90, v91
    v_mfma_f32_16x16x32_bf16 v[244:247], v[124:127], v[108:111], v[244:247]
    s_add_u32 s28, s49, s89
    v_exp_f32 v94, v94
    v_mfma_f32_16x16x32_bf16 a[128:131], v[128:131], v[108:111], a[128:131]
    buffer_load_dwordx4 v26, s[16:19], s28 offen lds
    v_exp_f32 v95, v95
    v_mfma_f32_16x16x32_bf16 a[156:159], v[132:135], v[108:111], a[156:159]
    s_add_u32 m0, m0, s53
    v_add_f32 v22, v22, v92
    v_add_f32 v23, v23, v93
    v_mfma_f32_16x16x32_bf16 a[184:187], v[136:139], v[108:111], a[184:187]
    s_add_u32 s28, s49, s90
    v_cvt_pk_bf16_f32 v106, v92, v93
    v_add_f32 v22, v22, v94
    v_mfma_f32_16x16x32_bf16 a[212:215], v[140:143], v[108:111], a[212:215]
    buffer_load_dwordx4 v26, s[16:19], s28 offen lds
    v_add_f32 v23, v23, v95
    v_cvt_pk_bf16_f32 v107, v94, v95
    s_nop 1
    v_mfma_f32_16x16x32_bf16 v[164:167], v[112:115], v[104:107], v[164:167]
    s_add_u32 m0, m0, s53
    s_add_u32 s28, s49, s91
    v_exp_f32 v96, v96
    v_mfma_f32_16x16x32_bf16 v[192:195], v[116:119], v[104:107], v[192:195]
    buffer_load_dwordx4 v26, s[16:19], s28 offen lds
    s_add_u32 m0, m0, s53
    v_exp_f32 v97, v97
    v_exp_f32 v98, v98
    v_mfma_f32_16x16x32_bf16 v[220:223], v[120:123], v[104:107], v[220:223]
    s_add_u32 s28, s49, s92
    buffer_load_dwordx4 v26, s[16:19], s28 offen lds
    v_exp_f32 v99, v99
    v_add_f32 v24, v24, v96
    v_add_f32 v25, v25, v97
    v_mfma_f32_16x16x32_bf16 v[248:251], v[124:127], v[104:107], v[248:251]
    s_add_u32 m0, m0, s53
    v_cvt_pk_bf16_f32 v108, v96, v97
    v_exp_f32 v100, v100
    v_mfma_f32_16x16x32_bf16 a[132:135], v[128:131], v[104:107], a[132:135]
    s_add_u32 s28, s49, s93
    buffer_load_dwordx4 v26, s[16:19], s28 offen lds
    v_exp_f32 v101, v101
    v_add_f32 v24, v24, v98
    v_add_f32 v25, v25, v99
    v_mfma_f32_16x16x32_bf16 a[160:163], v[132:135], v[104:107], a[160:163]
    s_add_u32 m0, m0, s53
    s_add_u32 s28, s49, s47
    v_cvt_pk_bf16_f32 v109, v98, v99
    v_exp_f32 v102, v102
    v_mfma_f32_16x16x32_bf16 a[188:191], v[136:139], v[104:107], a[188:191]
    buffer_load_dwordx4 v26, s[16:19], s28 offen lds
    s_add_u32 m0, m0, s53
    v_exp_f32 v103, v103
    v_add_f32 v24, v24, v100
    v_add_f32 v25, v25, v101
    v_mfma_f32_16x16x32_bf16 a[216:219], v[140:143], v[104:107], a[216:219]
    s_add_u32 s28, s49, s98
    buffer_load_dwordx4 v26, s[16:19], s28 offen lds
    v_cvt_pk_bf16_f32 v110, v100, v101
    v_add_f32 v24, v24, v102
    v_add_f32 v25, v25, v103
    v_cvt_pk_bf16_f32 v111, v102, v103
    s_branch L_at_aepi
L_at_atailB:
    v_mfma_f32_16x16x32_bf16 v[88:91], v[56:59], a[16:19], v[32:35]
    v_mfma_f32_16x16x32_bf16 v[88:91], v[60:63], a[20:23], v[88:91]
    v_exp_f32 v96, v96
    v_mfma_f32_16x16x32_bf16 v[88:91], v[64:67], a[24:27], v[88:91]
    v_exp_f32 v97, v97
    v_mfma_f32_16x16x32_bf16 v[88:91], v[68:71], a[28:31], v[88:91]
    v_exp_f32 v98, v98
    v_mfma_f32_16x16x32_bf16 v[92:95], v[84:87], a[28:31], v[32:35]
    v_exp_f32 v99, v99
    v_mfma_f32_16x16x32_bf16 v[92:95], v[80:83], a[24:27], v[92:95]
    v_add_f32 v12, v12, v96
    v_add_f32 v13, v13, v97
    v_mfma_f32_16x16x32_bf16 v[92:95], v[76:79], a[20:23], v[92:95]
    v_cvt_pk_bf16_f32 v108, v96, v97
    v_mfma_f32_16x16x32_bf16 v[92:95], v[72:75], a[16:19], v[92:95]
    v_exp_f32 v100, v100
    v_mfma_f32_16x16x32_bf16 v[168:171], v[112:115], v[104:107], v[168:171]
    ds_read_b64_tr_b16 v[112:113], v9 offset:8448
    ds_read_b64_tr_b16 v[114:115], v9 offset:8960
    v_exp_f32 v101, v101
    v_mfma_f32_16x16x32_bf16 v[196:199], v[116:119], v[104:107], v[196:199]
    ds_read_b64_tr_b16 v[116:117], v9 offset:8480
    ds_read_b64_tr_b16 v[118:119], v9 offset:8992
    v_add_f32 v12, v12, v98
    v_add_f32 v13, v13, v99
    v_mfma_f32_16x16x32_bf16 v[224:227], v[120:123], v[104:107], v[224:227]
    ds_read_b64_tr_b16 v[120:121], v9 offset:8512
    ds_read_b64_tr_b16 v[122:123], v9 offset:9024
    v_cvt_pk_bf16_f32 v109, v98, v99
    v_mfma_f32_16x16x32_bf16 v[252:255], v[124:127], v[104:107], v[252:255]
    ds_read_b64_tr_b16 v[124:125], v9 offset:8544
    ds_read_b64_tr_b16 v[126:127], v9 offset:9056
    v_exp_f32 v102, v102
    v_mfma_f32_16x16x32_bf16 a[136:139], v[128:131], v[104:107], a[136:139]
    ds_read_b64_tr_b16 v[128:129], v9 offset:8576
    ds_read_b64_tr_b16 v[130:131], v9 offset:9088
    v_exp_f32 v103, v103
    v_mfma_f32_16x16x32_bf16 a[164:167], v[132:135], v[104:107], a[164:167]
    ds_read_b64_tr_b16 v[132:133], v9 offset:8608
    ds_read_b64_tr_b16 v[134:135], v9 offset:9120
    v_add_f32 v12, v12, v100
    v_add_f32 v13, v13, v101
    v_mfma_f32_16x16x32_bf16 a[192:195], v[136:139], v[104:107], a[192:195]
    ds_read_b64_tr_b16 v[136:137], v9 offset:8640
    ds_read_b64_tr_b16 v[138:139], v9 offset:9152
    v_cvt_pk_bf16_f32 v110, v100, v101
    v_add_f32 v12, v12, v102
    v_mfma_f32_16x16x32_bf16 a[220:223], v[140:143], v[104:107], a[220:223]
    ds_read_b64_tr_b16 v[140:141], v9 offset:8672
    ds_read_b64_tr_b16 v[142:143], v9 offset:9184
    v_add_f32 v13, v13, v103
    v_cvt_pk_bf16_f32 v111, v102, v103
    v_mfma_f32_16x16x32_bf16 v[96:99], v[56:59], a[32:35], v[36:39]
    v_mfma_f32_16x16x32_bf16 v[96:99], v[60:63], a[36:39], v[96:99]
    s_add_u32 s29, s34, s100
    v_exp_f32 v88, v88
    v_mfma_f32_16x16x32_bf16 v[96:99], v[64:67], a[40:43], v[96:99]
    v_exp_f32 v89, v89
    v_mfma_f32_16x16x32_bf16 v[96:99], v[68:71], a[44:47], v[96:99]
    s_bfe_u32 s28, s29, 0x20003
    v_exp_f32 v90, v90
    v_mfma_f32_16x16x32_bf16 v[100:103], v[84:87], a[44:47], v[36:39]
    v_exp_f32 v91, v91
    v_mfma_f32_16x16x32_bf16 v[100:103], v[80:83], a[40:43], v[100:103]
    s_lshl_b32 s28, s28, 16
    v_add_f32 v14, v14, v88
    v_add_f32 v15, v15, v89
    v_mfma_f32_16x16x32_bf16 v[100:103], v[76:79], a[36:39], v[100:103]
    v_cvt_pk_bf16_f32 v104, v88, v89
    v_mfma_f32_16x16x32_bf16 v[100:103], v[72:75], a[32:35], v[100:103]
    v_exp_f32 v92, v92
    s_waitcnt lgkmcnt(0)
    v_mfma_f32_16x16x32_bf16 v[144:147], v[112:115], v[108:111], v[144:147]
    s_and_b32 s29, s29, 7
    v_exp_f32 v93, v93
    v_mfma_f32_16x16x32_bf16 v[172:175], v[116:119], v[108:111], v[172:175]
    v_add_f32 v14, v14, v90
    v_add_f32 v15, v15, v91
    v_mfma_f32_16x16x32_bf16 v[200:203], v[120:123], v[108:111], v[200:203]
    s_lshl_b32 s29, s29, 11
    v_cvt_pk_bf16_f32 v105, v90, v91
    v_mfma_f32_16x16x32_bf16 v[228:231], v[124:127], v[108:111], v[228:231]
    v_exp_f32 v94, v94
    v_mfma_f32_16x16x32_bf16 a[112:115], v[128:131], v[108:111], a[112:115]
    s_add_u32 s29, s28, s29
    v_exp_f32 v95, v95
    v_mfma_f32_16x16x32_bf16 a[140:143], v[132:135], v[108:111], a[140:143]
    v_add_f32 v14, v14, v92
    v_add_f32 v15, v15, v93
    v_mfma_f32_16x16x32_bf16 a[168:171], v[136:139], v[108:111], a[168:171]
    s_lshr_b32 s28, s34, 5
    v_cvt_pk_bf16_f32 v106, v92, v93
    v_add_f32 v14, v14, v94
    v_mfma_f32_16x16x32_bf16 a[196:199], v[140:143], v[108:111], a[196:199]
    v_add_f32 v15, v15, v95
    v_cvt_pk_bf16_f32 v107, v94, v95
    v_mfma_f32_16x16x32_bf16 v[88:91], v[56:59], a[48:51], v[40:43]
    v_mfma_f32_16x16x32_bf16 v[88:91], v[60:63], a[52:55], v[88:91]
    s_lshl_b32 s28, s28, 19
    v_exp_f32 v96, v96
    v_mfma_f32_16x16x32_bf16 v[88:91], v[64:67], a[56:59], v[88:91]
    v_exp_f32 v97, v97
    v_mfma_f32_16x16x32_bf16 v[88:91], v[68:71], a[60:63], v[88:91]
    s_add_u32 s49, s28, s29
    v_exp_f32 v98, v98
    v_mfma_f32_16x16x32_bf16 v[92:95], v[84:87], a[60:63], v[40:43]
    v_exp_f32 v99, v99
    v_mfma_f32_16x16x32_bf16 v[92:95], v[80:83], a[56:59], v[92:95]
    s_add_u32 m0, s33, 0
    v_add_f32 v16, v16, v96
    v_add_f32 v17, v17, v97
    v_mfma_f32_16x16x32_bf16 v[92:95], v[76:79], a[52:55], v[92:95]
    v_cvt_pk_bf16_f32 v108, v96, v97
    v_mfma_f32_16x16x32_bf16 v[92:95], v[72:75], a[48:51], v[92:95]
    v_exp_f32 v100, v100
    v_mfma_f32_16x16x32_bf16 v[148:151], v[112:115], v[104:107], v[148:151]
    s_add_u32 s34, s34, 1
    v_exp_f32 v101, v101
    v_mfma_f32_16x16x32_bf16 v[176:179], v[116:119], v[104:107], v[176:179]
    v_add_f32 v16, v16, v98
    v_add_f32 v17, v17, v99
    v_mfma_f32_16x16x32_bf16 v[204:207], v[120:123], v[104:107], v[204:207]
    buffer_load_dwordx4 v7, s[4:7], s49 offen offset:0 nt lds
    v_cvt_pk_bf16_f32 v109, v98, v99
    v_mfma_f32_16x16x32_bf16 v[232:235], v[124:127], v[104:107], v[232:235]
    v_exp_f32 v102, v102
    v_mfma_f32_16x16x32_bf16 a[116:119], v[128:131], v[104:107], a[116:119]
    s_add_u32 m0, m0, s96
    v_exp_f32 v103, v103
    v_mfma_f32_16x16x32_bf16 a[144:147], v[132:135], v[104:107], a[144:147]
    v_add_f32 v16, v16, v100
    v_add_f32 v17, v17, v101
    v_mfma_f32_16x16x32_bf16 a[172:175], v[136:139], v[104:107], a[172:175]
    buffer_load_dwordx4 v7, s[4:7], s49 offen offset:256 nt lds
    v_cvt_pk_bf16_f32 v110, v100, v101
    v_add_f32 v16, v16, v102
    v_mfma_f32_16x16x32_bf16 a[200:203], v[140:143], v[104:107], a[200:203]
    v_add_f32 v17, v17, v103
    v_cvt_pk_bf16_f32 v111, v102, v103
    v_mfma_f32_16x16x32_bf16 v[96:99], v[56:59], a[64:67], v[44:47]
    v_mfma_f32_16x16x32_bf16 v[96:99], v[60:63], a[68:71], v[96:99]
    s_add_u32 m0, m0, s97
    v_exp_f32 v88, v88
    v_mfma_f32_16x16x32_bf16 v[96:99], v[64:67], a[72:75], v[96:99]
    v_exp_f32 v89, v89
    v_mfma_f32_16x16x32_bf16 v[96:99], v[68:71], a[76:79], v[96:99]
    buffer_load_dwordx4 v7, s[4:7], s49 offen offset:512 nt lds
    v_exp_f32 v90, v90
    v_mfma_f32_16x16x32_bf16 v[100:103], v[84:87], a[76:79], v[44:47]
    v_exp_f32 v91, v91
    v_mfma_f32_16x16x32_bf16 v[100:103], v[80:83], a[72:75], v[100:103]
    s_add_u32 m0, m0, s96
    v_add_f32 v18, v18, v88
    v_add_f32 v19, v19, v89
    v_mfma_f32_16x16x32_bf16 v[100:103], v[76:79], a[68:71], v[100:103]
    v_cvt_pk_bf16_f32 v104, v88, v89
    v_mfma_f32_16x16x32_bf16 v[100:103], v[72:75], a[64:67], v[100:103]
    v_exp_f32 v92, v92
    v_mfma_f32_16x16x32_bf16 v[152:155], v[112:115], v[108:111], v[152:155]
    buffer_load_dwordx4 v7, s[4:7], s49 offen offset:768 nt lds
    v_exp_f32 v93, v93
    v_mfma_f32_16x16x32_bf16 v[180:183], v[116:119], v[108:111], v[180:183]
    v_add_f32 v18, v18, v90
    v_add_f32 v19, v19, v91
    v_mfma_f32_16x16x32_bf16 v[208:211], v[120:123], v[108:111], v[208:211]
    s_add_u32 m0, m0, s97
    v_cvt_pk_bf16_f32 v105, v90, v91
    v_mfma_f32_16x16x32_bf16 v[236:239], v[124:127], v[108:111], v[236:239]
    v_exp_f32 v94, v94
    v_mfma_f32_16x16x32_bf16 a[120:123], v[128:131], v[108:111], a[120:123]
    buffer_load_dwordx4 v7, s[4:7], s49 offen offset:1024 nt lds
    v_exp_f32 v95, v95
    v_mfma_f32_16x16x32_bf16 a[148:151], v[132:135], v[108:111], a[148:151]
    v_add_f32 v18, v18, v92
    v_add_f32 v19, v19, v93
    v_mfma_f32_16x16x32_bf16 a[176:179], v[136:139], v[108:111], a[176:179]
    s_add_u32 m0, m0, s96
    v_cvt_pk_bf16_f32 v106, v92, v93
    v_add_f32 v18, v18, v94
    v_mfma_f32_16x16x32_bf16 a[204:207], v[140:143], v[108:111], a[204:207]
    v_add_f32 v19, v19, v95
    v_cvt_pk_bf16_f32 v107, v94, v95
    v_mfma_f32_16x16x32_bf16 v[88:91], v[56:59], a[80:83], v[48:51]
    v_mfma_f32_16x16x32_bf16 v[88:91], v[60:63], a[84:87], v[88:91]
    buffer_load_dwordx4 v7, s[4:7], s49 offen offset:1280 nt lds
    v_exp_f32 v96, v96
    v_mfma_f32_16x16x32_bf16 v[88:91], v[64:67], a[88:91], v[88:91]
    v_exp_f32 v97, v97
    v_mfma_f32_16x16x32_bf16 v[88:91], v[68:71], a[92:95], v[88:91]
    s_add_u32 m0, m0, s97
    v_exp_f32 v98, v98
    v_mfma_f32_16x16x32_bf16 v[92:95], v[84:87], a[92:95], v[48:51]
    v_exp_f32 v99, v99
    v_mfma_f32_16x16x32_bf16 v[92:95], v[80:83], a[88:91], v[92:95]
    buffer_load_dwordx4 v7, s[4:7], s49 offen offset:1536 nt lds
    v_add_f32 v20, v20, v96
    v_add_f32 v21, v21, v97
    v_mfma_f32_16x16x32_bf16 v[92:95], v[76:79], a[84:87], v[92:95]
    v_cvt_pk_bf16_f32 v108, v96, v97
    v_mfma_f32_16x16x32_bf16 v[92:95], v[72:75], a[80:83], v[92:95]
    v_exp_f32 v100, v100
    v_mfma_f32_16x16x32_bf16 v[156:159], v[112:115], v[104:107], v[156:159]
    s_add_u32 m0, m0, s96
    v_exp_f32 v101, v101
    v_mfma_f32_16x16x32_bf16 v[184:187], v[116:119], v[104:107], v[184:187]
    v_add_f32 v20, v20, v98
    v_add_f32 v21, v21, v99
    v_mfma_f32_16x16x32_bf16 v[212:215], v[120:123], v[104:107], v[212:215]
    buffer_load_dwordx4 v7, s[4:7], s49 offen offset:1792 nt lds
    v_cvt_pk_bf16_f32 v109, v98, v99
    v_mfma_f32_16x16x32_bf16 v[240:243], v[124:127], v[104:107], v[240:243]
    v_exp_f32 v102, v102
    v_mfma_f32_16x16x32_bf16 a[124:127], v[128:131], v[104:107], a[124:127]
    v_exp_f32 v103, v103
    v_mfma_f32_16x16x32_bf16 a[152:155], v[132:135], v[104:107], a[152:155]
    v_add_f32 v20, v20, v100
    v_add_f32 v21, v21, v101
    v_mfma_f32_16x16x32_bf16 a[180:183], v[136:139], v[104:107], a[180:183]
    v_cvt_pk_bf16_f32 v110, v100, v101
    v_add_f32 v20, v20, v102
    v_mfma_f32_16x16x32_bf16 a[208:211], v[140:143], v[104:107], a[208:211]
    v_add_f32 v21, v21, v103
    v_cvt_pk_bf16_f32 v111, v102, v103
    s_waitcnt vmcnt(16) lgkmcnt(0)
    s_barrier
    v_mfma_f32_16x16x32_bf16 v[96:99], v[56:59], a[96:99], v[52:55]
    ds_read_b128 v[56:59], v8 offset:16896
    v_mfma_f32_16x16x32_bf16 v[96:99], v[60:63], a[100:103], v[96:99]
    ds_read_b128 v[60:63], v8 offset:16960
    v_exp_f32 v88, v88
    v_mfma_f32_16x16x32_bf16 v[96:99], v[64:67], a[104:107], v[96:99]
    ds_read_b128 v[64:67], v8 offset:17024
    v_exp_f32 v89, v89
    v_mfma_f32_16x16x32_bf16 v[96:99], v[68:71], a[108:111], v[96:99]
    ds_read_b128 v[68:71], v8 offset:17088
    v_exp_f32 v90, v90
    v_mfma_f32_16x16x32_bf16 v[100:103], v[84:87], a[108:111], v[52:55]
    ds_read_b128 v[84:87], v8 offset:17600
    v_exp_f32 v91, v91
    v_mfma_f32_16x16x32_bf16 v[100:103], v[80:83], a[104:107], v[100:103]
    ds_read_b128 v[80:83], v8 offset:17536
    v_add_f32 v22, v22, v88
    v_add_f32 v23, v23, v89
    v_mfma_f32_16x16x32_bf16 v[100:103], v[76:79], a[100:103], v[100:103]
    ds_read_b128 v[76:79], v8 offset:17472
    v_cvt_pk_bf16_f32 v104, v88, v89
    v_mfma_f32_16x16x32_bf16 v[100:103], v[72:75], a[96:99], v[100:103]
    ds_read_b128 v[72:75], v8 offset:17408
    v_exp_f32 v92, v92
    v_mfma_f32_16x16x32_bf16 v[160:163], v[112:115], v[108:111], v[160:163]
    v_exp_f32 v93, v93
    v_mfma_f32_16x16x32_bf16 v[188:191], v[116:119], v[108:111], v[188:191]
    v_add_f32 v22, v22, v90
    v_add_f32 v23, v23, v91
    v_mfma_f32_16x16x32_bf16 v[216:219], v[120:123], v[108:111], v[216:219]
    v_cvt_pk_bf16_f32 v105, v90, v91
    v_mfma_f32_16x16x32_bf16 v[244:247], v[124:127], v[108:111], v[244:247]
    v_exp_f32 v94, v94
    v_mfma_f32_16x16x32_bf16 a[128:131], v[128:131], v[108:111], a[128:131]
    v_exp_f32 v95, v95
    v_mfma_f32_16x16x32_bf16 a[156:159], v[132:135], v[108:111], a[156:159]
    v_add_f32 v22, v22, v92
    v_add_f32 v23, v23, v93
    v_mfma_f32_16x16x32_bf16 a[184:187], v[136:139], v[108:111], a[184:187]
    v_cvt_pk_bf16_f32 v106, v92, v93
    v_add_f32 v22, v22, v94
    v_mfma_f32_16x16x32_bf16 a[212:215], v[140:143], v[108:111], a[212:215]
    v_add_f32 v23, v23, v95
    v_cvt_pk_bf16_f32 v107, v94, v95
    s_waitcnt lgkmcnt(0)
    v_mfma_f32_16x16x32_bf16 v[88:91], v[56:59], a[0:3], v[28:31]
    v_mfma_f32_16x16x32_bf16 v[88:91], v[60:63], a[4:7], v[88:91]
    v_exp_f32 v96, v96
    v_mfma_f32_16x16x32_bf16 v[88:91], v[64:67], a[8:11], v[88:91]
    v_exp_f32 v97, v97
    v_mfma_f32_16x16x32_bf16 v[88:91], v[68:71], a[12:15], v[88:91]
    v_exp_f32 v98, v98
    v_mfma_f32_16x16x32_bf16 v[92:95], v[84:87], a[12:15], v[28:31]
    v_exp_f32 v99, v99
    v_mfma_f32_16x16x32_bf16 v[92:95], v[80:83], a[8:11], v[92:95]
    v_add_f32 v24, v24, v96
    v_add_f32 v25, v25, v97
    v_mfma_f32_16x16x32_bf16 v[92:95], v[76:79], a[4:7], v[92:95]
    v_cvt_pk_bf16_f32 v108, v96, v97
    v_mfma_f32_16x16x32_bf16 v[92:95], v[72:75], a[0:3], v[92:95]
    v_exp_f32 v100, v100
    v_mfma_f32_16x16x32_bf16 v[164:167], v[112:115], v[104:107], v[164:167]
    v_exp_f32 v101, v101
    v_mfma_f32_16x16x32_bf16 v[192:195], v[116:119], v[104:107], v[192:195]
    v_add_f32 v24, v24, v98
    v_add_f32 v25, v25, v99
    v_mfma_f32_16x16x32_bf16 v[220:223], v[120:123], v[104:107], v[220:223]
    v_cvt_pk_bf16_f32 v109, v98, v99
    v_mfma_f32_16x16x32_bf16 v[248:251], v[124:127], v[104:107], v[248:251]
    v_exp_f32 v102, v102
    v_mfma_f32_16x16x32_bf16 a[132:135], v[128:131], v[104:107], a[132:135]
    v_exp_f32 v103, v103
    v_mfma_f32_16x16x32_bf16 a[160:163], v[132:135], v[104:107], a[160:163]
    v_add_f32 v24, v24, v100
    v_add_f32 v25, v25, v101
    v_mfma_f32_16x16x32_bf16 a[188:191], v[136:139], v[104:107], a[188:191]
    v_cvt_pk_bf16_f32 v110, v100, v101
    v_add_f32 v24, v24, v102
    v_mfma_f32_16x16x32_bf16 a[216:219], v[140:143], v[104:107], a[216:219]
    v_add_f32 v25, v25, v103
    v_cvt_pk_bf16_f32 v111, v102, v103
    v_mfma_f32_16x16x32_bf16 v[96:99], v[56:59], a[16:19], v[32:35]
    v_mfma_f32_16x16x32_bf16 v[96:99], v[60:63], a[20:23], v[96:99]
    v_exp_f32 v88, v88
    v_mfma_f32_16x16x32_bf16 v[96:99], v[64:67], a[24:27], v[96:99]
    v_exp_f32 v89, v89
    v_mfma_f32_16x16x32_bf16 v[96:99], v[68:71], a[28:31], v[96:99]
    v_exp_f32 v90, v90
    v_mfma_f32_16x16x32_bf16 v[100:103], v[84:87], a[28:31], v[32:35]
    v_exp_f32 v91, v91
    v_mfma_f32_16x16x32_bf16 v[100:103], v[80:83], a[24:27], v[100:103]
    v_add_f32 v12, v12, v88
    v_add_f32 v13, v13, v89
    v_mfma_f32_16x16x32_bf16 v[100:103], v[76:79], a[20:23], v[100:103]
    v_cvt_pk_bf16_f32 v104, v88, v89
    v_mfma_f32_16x16x32_bf16 v[100:103], v[72:75], a[16:19], v[100:103]
    v_exp_f32 v92, v92
    v_mfma_f32_16x16x32_bf16 v[168:171], v[112:115], v[108:111], v[168:171]
    ds_read_b64_tr_b16 v[112:113], v9 offset:16896
    ds_read_b64_tr_b16 v[114:115], v9 offset:17408
    v_exp_f32 v93, v93
    v_mfma_f32_16x16x32_bf16 v[196:199], v[116:119], v[108:111], v[196:199]
    ds_read_b64_tr_b16 v[116:117], v9 offset:16928
    ds_read_b64_tr_b16 v[118:119], v9 offset:17440
    v_add_f32 v12, v12, v90
    v_add_f32 v13, v13, v91
    v_mfma_f32_16x16x32_bf16 v[224:227], v[120:123], v[108:111], v[224:227]
    ds_read_b64_tr_b16 v[120:121], v9 offset:16960
    ds_read_b64_tr_b16 v[122:123], v9 offset:17472
    v_cvt_pk_bf16_f32 v105, v90, v91
    v_mfma_f32_16x16x32_bf16 v[252:255], v[124:127], v[108:111], v[252:255]
    ds_read_b64_tr_b16 v[124:125], v9 offset:16992
    ds_read_b64_tr_b16 v[126:127], v9 offset:17504
    v_exp_f32 v94, v94
    v_mfma_f32_16x16x32_bf16 a[136:139], v[128:131], v[108:111], a[136:139]
    ds_read_b64_tr_b16 v[128:129], v9 offset:17024
    ds_read_b64_tr_b16 v[130:131], v9 offset:17536
    v_exp_f32 v95, v95
    v_mfma_f32_16x16x32_bf16 a[164:167], v[132:135], v[108:111], a[164:167]
    ds_read_b64_tr_b16 v[132:133], v9 offset:17056
    ds_read_b64_tr_b16 v[134:135], v9 offset:17568
    v_add_f32 v12, v12, v92
    v_add_f32 v13, v13, v93
    v_mfma_f32_16x16x32_bf16 a[192:195], v[136:139], v[108:111], a[192:195]
    ds_read_b64_tr_b16 v[136:137], v9 offset:17088
    ds_read_b64_tr_b16 v[138:139], v9 offset:17600
    v_cvt_pk_bf16_f32 v106, v92, v93
    v_add_f32 v12, v12, v94
    v_mfma_f32_16x16x32_bf16 a[220:223], v[140:143], v[108:111], a[220:223]
    ds_read_b64_tr_b16 v[140:141], v9 offset:17120
    ds_read_b64_tr_b16 v[142:143], v9 offset:17632
    v_add_f32 v13, v13, v95
    v_cvt_pk_bf16_f32 v107, v94, v95
    v_mfma_f32_16x16x32_bf16 v[88:91], v[56:59], a[32:35], v[36:39]
    v_mfma_f32_16x16x32_bf16 v[88:91], v[60:63], a[36:39], v[88:91]
    s_add_u32 s29, s34, s100
    v_exp_f32 v96, v96
    v_mfma_f32_16x16x32_bf16 v[88:91], v[64:67], a[40:43], v[88:91]
    v_exp_f32 v97, v97
    v_mfma_f32_16x16x32_bf16 v[88:91], v[68:71], a[44:47], v[88:91]
    s_bfe_u32 s28, s29, 0x20003
    v_exp_f32 v98, v98
    v_mfma_f32_16x16x32_bf16 v[92:95], v[84:87], a[44:47], v[36:39]
    v_exp_f32 v99, v99
    v_mfma_f32_16x16x32_bf16 v[92:95], v[80:83], a[40:43], v[92:95]
    s_lshl_b32 s28, s28, 16
    v_add_f32 v14, v14, v96
    v_add_f32 v15, v15, v97
    v_mfma_f32_16x16x32_bf16 v[92:95], v[76:79], a[36:39], v[92:95]
    v_cvt_pk_bf16_f32 v108, v96, v97
    v_mfma_f32_16x16x32_bf16 v[92:95], v[72:75], a[32:35], v[92:95]
    v_exp_f32 v100, v100
    s_waitcnt lgkmcnt(0)
    v_mfma_f32_16x16x32_bf16 v[144:147], v[112:115], v[104:107], v[144:147]
    s_and_b32 s29, s29, 7
    v_exp_f32 v101, v101
    v_mfma_f32_16x16x32_bf16 v[172:175], v[116:119], v[104:107], v[172:175]
    v_add_f32 v14, v14, v98
    v_add_f32 v15, v15, v99
    v_mfma_f32_16x16x32_bf16 v[200:203], v[120:123], v[104:107], v[200:203]
    s_lshl_b32 s29, s29, 11
    v_cvt_pk_bf16_f32 v109, v98, v99
    v_mfma_f32_16x16x32_bf16 v[228:231], v[124:127], v[104:107], v[228:231]
    v_exp_f32 v102, v102
    v_mfma_f32_16x16x32_bf16 a[112:115], v[128:131], v[104:107], a[112:115]
    s_add_u32 s29, s28, s29
    v_exp_f32 v103, v103
    v_mfma_f32_16x16x32_bf16 a[140:143], v[132:135], v[104:107], a[140:143]
    v_add_f32 v14, v14, v100
    v_add_f32 v15, v15, v101
    v_mfma_f32_16x16x32_bf16 a[168:171], v[136:139], v[104:107], a[168:171]
    s_lshr_b32 s28, s34, 5
    v_cvt_pk_bf16_f32 v110, v100, v101
    v_add_f32 v14, v14, v102
    v_mfma_f32_16x16x32_bf16 a[196:199], v[140:143], v[104:107], a[196:199]
    v_add_f32 v15, v15, v103
    v_cvt_pk_bf16_f32 v111, v102, v103
    v_mfma_f32_16x16x32_bf16 v[96:99], v[56:59], a[48:51], v[40:43]
    v_mfma_f32_16x16x32_bf16 v[96:99], v[60:63], a[52:55], v[96:99]
    s_lshl_b32 s28, s28, 19
    v_exp_f32 v88, v88
    v_mfma_f32_16x16x32_bf16 v[96:99], v[64:67], a[56:59], v[96:99]
    v_exp_f32 v89, v89
    v_mfma_f32_16x16x32_bf16 v[96:99], v[68:71], a[60:63], v[96:99]
    s_add_u32 s49, s28, s29
    v_exp_f32 v90, v90
    v_mfma_f32_16x16x32_bf16 v[100:103], v[84:87], a[60:63], v[40:43]
    v_exp_f32 v91, v91
    v_mfma_f32_16x16x32_bf16 v[100:103], v[80:83], a[56:59], v[100:103]
    s_add_u32 m0, s33, 8448
    v_add_f32 v16, v16, v88
    v_add_f32 v17, v17, v89
    v_mfma_f32_16x16x32_bf16 v[100:103], v[76:79], a[52:55], v[100:103]
    v_cvt_pk_bf16_f32 v104, v88, v89
    v_mfma_f32_16x16x32_bf16 v[100:103], v[72:75], a[48:51], v[100:103]
    v_exp_f32 v92, v92
    v_mfma_f32_16x16x32_bf16 v[148:151], v[112:115], v[108:111], v[148:151]
    s_add_u32 s34, s34, 1
    v_exp_f32 v93, v93
    v_mfma_f32_16x16x32_bf16 v[176:179], v[116:119], v[108:111], v[176:179]
    v_add_f32 v16, v16, v90
    v_add_f32 v17, v17, v91
    v_mfma_f32_16x16x32_bf16 v[204:207], v[120:123], v[108:111], v[204:207]
    buffer_load_dwordx4 v7, s[4:7], s49 offen offset:0 nt lds
    v_cvt_pk_bf16_f32 v105, v90, v91
    v_mfma_f32_16x16x32_bf16 v[232:235], v[124:127], v[108:111], v[232:235]
    v_exp_f32 v94, v94
    v_mfma_f32_16x16x32_bf16 a[116:119], v[128:131], v[108:111], a[116:119]
    s_add_u32 m0, m0, s96
    v_exp_f32 v95, v95
    v_mfma_f32_16x16x32_bf16 a[144:147], v[132:135], v[108:111], a[144:147]
    v_add_f32 v16, v16, v92
    v_add_f32 v17, v17, v93
    v_mfma_f32_16x16x32_bf16 a[172:175], v[136:139], v[108:111], a[172:175]
    buffer_load_dwordx4 v7, s[4:7], s49 offen offset:256 nt lds
    v_cvt_pk_bf16_f32 v106, v92, v93
    v_add_f32 v16, v16, v94
    v_mfma_f32_16x16x32_bf16 a[200:203], v[140:143], v[108:111], a[200:203]
    v_add_f32 v17, v17, v95
    v_cvt_pk_bf16_f32 v107, v94, v95
    v_mfma_f32_16x16x32_bf16 v[88:91], v[56:59], a[64:67], v[44:47]
    v_mfma_f32_16x16x32_bf16 v[88:91], v[60:63], a[68:71], v[88:91]
    s_add_u32 m0, m0, s97
    v_exp_f32 v96, v96
    v_mfma_f32_16x16x32_bf16 v[88:91], v[64:67], a[72:75], v[88:91]
    v_exp_f32 v97, v97
    v_mfma_f32_16x16x32_bf16 v[88:91], v[68:71], a[76:79], v[88:91]
    buffer_load_dwordx4 v7, s[4:7], s49 offen offset:512 nt lds
    v_exp_f32 v98, v98
    v_mfma_f32_16x16x32_bf16 v[92:95], v[84:87], a[76:79], v[44:47]
    v_exp_f32 v99, v99
    v_mfma_f32_16x16x32_bf16 v[92:95], v[80:83], a[72:75], v[92:95]
    s_add_u32 m0, m0, s96
    v_add_f32 v18, v18, v96
    v_add_f32 v19, v19, v97
    v_mfma_f32_16x16x32_bf16 v[92:95], v[76:79], a[68:71], v[92:95]
    v_cvt_pk_bf16_f32 v108, v96, v97
    v_mfma_f32_16x16x32_bf16 v[92:95], v[72:75], a[64:67], v[92:95]
    v_exp_f32 v100, v100
    v_mfma_f32_16x16x32_bf16 v[152:155], v[112:115], v[104:107], v[152:155]
    buffer_load_dwordx4 v7, s[4:7], s49 offen offset:768 nt lds
    v_exp_f32 v101, v101
    v_mfma_f32_16x16x32_bf16 v[180:183], v[116:119], v[104:107], v[180:183]
    v_add_f32 v18, v18, v98
    v_add_f32 v19, v19, v99
    v_mfma_f32_16x16x32_bf16 v[208:211], v[120:123], v[104:107], v[208:211]
    s_add_u32 m0, m0, s97
    v_cvt_pk_bf16_f32 v109, v98, v99
    v_mfma_f32_16x16x32_bf16 v[236:239], v[124:127], v[104:107], v[236:239]
    v_exp_f32 v102, v102
    v_mfma_f32_16x16x32_bf16 a[120:123], v[128:131], v[104:107], a[120:123]
    buffer_load_dwordx4 v7, s[4:7], s49 offen offset:1024 nt lds
    v_exp_f32 v103, v103
    v_mfma_f32_16x16x32_bf16 a[148:151], v[132:135], v[104:107], a[148:151]
    v_add_f32 v18, v18, v100
    v_add_f32 v19, v19, v101
    v_mfma_f32_16x16x32_bf16 a[176:179], v[136:139], v[104:107], a[176:179]
    s_add_u32 m0, m0, s96
    v_cvt_pk_bf16_f32 v110, v100, v101
    v_add_f32 v18, v18, v102
    v_mfma_f32_16x16x32_bf16 a[204:207], v[140:143], v[104:107], a[204:207]
    v_add_f32 v19, v19, v103
    v_cvt_pk_bf16_f32 v111, v102, v103
    v_mfma_f32_16x16x32_bf16 v[96:99], v[56:59], a[80:83], v[48:51]
    v_mfma_f32_16x16x32_bf16 v[96:99], v[60:63], a[84:87], v[96:99]
    buffer_load_dwordx4 v7, s[4:7], s49 offen offset:1280 nt lds
    v_exp_f32 v88, v88
    v_mfma_f32_16x16x32_bf16 v[96:99], v[64:67], a[88:91], v[96:99]
    v_exp_f32 v89, v89
    v_mfma_f32_16x16x32_bf16 v[96:99], v[68:71], a[92:95], v[96:99]
    s_add_u32 m0, m0, s97
    v_exp_f32 v90, v90
    v_mfma_f32_16x16x32_bf16 v[100:103], v[84:87], a[92:95], v[48:51]
    v_exp_f32 v91, v91
    v_mfma_f32_16x16x32_bf16 v[100:103], v[80:83], a[88:91], v[100:103]
    buffer_load_dwordx4 v7, s[4:7], s49 offen offset:1536 nt lds
    v_add_f32 v20, v20, v88
    v_add_f32 v21, v21, v89
    v_mfma_f32_16x16x32_bf16 v[100:103], v[76:79], a[84:87], v[100:103]
    v_cvt_pk_bf16_f32 v104, v88, v89
    v_mfma_f32_16x16x32_bf16 v[100:103], v[72:75], a[80:83], v[100:103]
    v_exp_f32 v92, v92
    v_mfma_f32_16x16x32_bf16 v[156:159], v[112:115], v[108:111], v[156:159]
    s_add_u32 m0, m0, s96
    v_exp_f32 v93, v93
    v_mfma_f32_16x16x32_bf16 v[184:187], v[116:119], v[108:111], v[184:187]
    v_add_f32 v20, v20, v90
    v_add_f32 v21, v21, v91
    v_mfma_f32_16x16x32_bf16 v[212:215], v[120:123], v[108:111], v[212:215]
    buffer_load_dwordx4 v7, s[4:7], s49 offen offset:1792 nt lds
    v_cvt_pk_bf16_f32 v105, v90, v91
    v_mfma_f32_16x16x32_bf16 v[240:243], v[124:127], v[108:111], v[240:243]
    v_exp_f32 v94, v94
    v_mfma_f32_16x16x32_bf16 a[124:127], v[128:131], v[108:111], a[124:127]
    v_exp_f32 v95, v95
    v_mfma_f32_16x16x32_bf16 a[152:155], v[132:135], v[108:111], a[152:155]
    v_add_f32 v20, v20, v92
    v_add_f32 v21, v21, v93
    v_mfma_f32_16x16x32_bf16 a[180:183], v[136:139], v[108:111], a[180:183]
    v_cvt_pk_bf16_f32 v106, v92, v93
    v_add_f32 v20, v20, v94
    v_mfma_f32_16x16x32_bf16 a[208:211], v[140:143], v[108:111], a[208:211]
    v_add_f32 v21, v21, v95
    v_cvt_pk_bf16_f32 v107, v94, v95
    s_waitcnt vmcnt(16) lgkmcnt(0)
    s_barrier
    v_mfma_f32_16x16x32_bf16 v[88:91], v[56:59], a[96:99], v[52:55]
    ds_read_b128 v[56:59], v8 offset:25344
    v_mfma_f32_16x16x32_bf16 v[88:91], v[60:63], a[100:103], v[88:91]
    ds_read_b128 v[60:63], v8 offset:25408
    v_exp_f32 v96, v96
    v_mfma_f32_16x16x32_bf16 v[88:91], v[64:67], a[104:107], v[88:91]
    ds_read_b128 v[64:67], v8 offset:25472
    v_exp_f32 v97, v97
    v_mfma_f32_16x16x32_bf16 v[88:91], v[68:71], a[108:111], v[88:91]
    ds_read_b128 v[68:71], v8 offset:25536
    v_exp_f32 v98, v98
    v_mfma_f32_16x16x32_bf16 v[92:95], v[84:87], a[108:111], v[52:55]
    ds_read_b128 v[84:87], v8 offset:26048
    v_exp_f32 v99, v99
    v_mfma_f32_16x16x32_bf16 v[92:95], v[80:83], a[104:107], v[92:95]
    ds_read_b128 v[80:83], v8 offset:25984
    v_add_f32 v22, v22, v96
    v_add_f32 v23, v23, v97
    v_mfma_f32_16x16x32_bf16 v[92:95], v[76:79], a[100:103], v[92:95]
    ds_read_b128 v[76:79], v8 offset:25920
    v_cvt_pk_bf16_f32 v108, v96, v97
    v_mfma_f32_16x16x32_bf16 v[92:95], v[72:75], a[96:99], v[92:95]
    ds_read_b128 v[72:75], v8 offset:25856
    v_exp_f32 v100, v100
    v_mfma_f32_16x16x32_bf16 v[160:163], v[112:115], v[104:107], v[160:163]
    v_exp_f32 v101, v101
    v_mfma_f32_16x16x32_bf16 v[188:191], v[116:119], v[104:107], v[188:191]
    v_add_f32 v22, v22, v98
    v_add_f32 v23, v23, v99
    v_mfma_f32_16x16x32_bf16 v[216:219], v[120:123], v[104:107], v[216:219]
    v_cvt_pk_bf16_f32 v109, v98, v99
    v_mfma_f32_16x16x32_bf16 v[244:247], v[124:127], v[104:107], v[244:247]
    v_exp_f32 v102, v102
    v_mfma_f32_16x16x32_bf16 a[128:131], v[128:131], v[104:107], a[128:131]
    v_exp_f32 v103, v103
    v_mfma_f32_16x16x32_bf16 a[156:159], v[132:135], v[104:107], a[156:159]
    v_add_f32 v22, v22, v100
    v_add_f32 v23, v23, v101
    v_mfma_f32_16x16x32_bf16 a[184:187], v[136:139], v[104:107], a[184:187]
    v_cvt_pk_bf16_f32 v110, v100, v101
    v_add_f32 v22, v22, v102
    v_mfma_f32_16x16x32_bf16 a[212:215], v[140:143], v[104:107], a[212:215]
    v_add_f32 v23, v23, v103
    v_cvt_pk_bf16_f32 v111, v102, v103
    s_waitcnt lgkmcnt(0)
    v_mfma_f32_16x16x32_bf16 v[96:99], v[56:59], a[0:3], v[28:31]
    v_mfma_f32_16x16x32_bf16 v[96:99], v[60:63], a[4:7], v[96:99]
    v_exp_f32 v88, v88
    v_mfma_f32_16x16x32_bf16 v[96:99], v[64:67], a[8:11], v[96:99]
    v_exp_f32 v89, v89
    v_mfma_f32_16x16x32_bf16 v[96:99], v[68:71], a[12:15], v[96:99]
    v_exp_f32 v90, v90
    v_mfma_f32_16x16x32_bf16 v[100:103], v[84:87], a[12:15], v[28:31]
    v_exp_f32 v91, v91
    v_mfma_f32_16x16x32_bf16 v[100:103], v[80:83], a[8:11], v[100:103]
    v_add_f32 v24, v24, v88
    v_add_f32 v25, v25, v89
    v_mfma_f32_16x16x32_bf16 v[100:103], v[76:79], a[4:7], v[100:103]
    v_cvt_pk_bf16_f32 v104, v88, v89
    v_mfma_f32_16x16x32_bf16 v[100:103], v[72:75], a[0:3], v[100:103]
    v_exp_f32 v92, v92
    v_mfma_f32_16x16x32_bf16 v[164:167], v[112:115], v[108:111], v[164:167]
    v_exp_f32 v93, v93
    v_mfma_f32_16x16x32_bf16 v[192:195], v[116:119], v[108:111], v[192:195]
    v_add_f32 v24, v24, v90
    v_add_f32 v25, v25, v91
    v_mfma_f32_16x16x32_bf16 v[220:223], v[120:123], v[108:111], v[220:223]
    v_cvt_pk_bf16_f32 v105, v90, v91
    v_mfma_f32_16x16x32_bf16 v[248:251], v[124:127], v[108:111], v[248:251]
    v_exp_f32 v94, v94
    v_mfma_f32_16x16x32_bf16 a[132:135], v[128:131], v[108:111], a[132:135]
    v_exp_f32 v95, v95
    v_mfma_f32_16x16x32_bf16 a[160:163], v[132:135], v[108:111], a[160:163]
    v_add_f32 v24, v24, v92
    v_add_f32 v25, v25, v93
    v_mfma_f32_16x16x32_bf16 a[188:191], v[136:139], v[108:111], a[188:191]
    v_cvt_pk_bf16_f32 v106, v92, v93
    v_add_f32 v24, v24, v94
    v_mfma_f32_16x16x32_bf16 a[216:219], v[140:143], v[108:111], a[216:219]
    v_add_f32 v25, v25, v95
    v_cvt_pk_bf16_f32 v107, v94, v95
    v_mfma_f32_16x16x32_bf16 v[88:91], v[56:59], a[16:19], v[32:35]
    v_mfma_f32_16x16x32_bf16 v[88:91], v[60:63], a[20:23], v[88:91]
    v_exp_f32 v96, v96
    v_mfma_f32_16x16x32_bf16 v[88:91], v[64:67], a[24:27], v[88:91]
    v_exp_f32 v97, v97
    v_mfma_f32_16x16x32_bf16 v[88:91], v[68:71], a[28:31], v[88:91]
    v_exp_f32 v98, v98
    v_mfma_f32_16x16x32_bf16 v[92:95], v[84:87], a[28:31], v[32:35]
    v_exp_f32 v99, v99
    v_mfma_f32_16x16x32_bf16 v[92:95], v[80:83], a[24:27], v[92:95]
    v_add_f32 v12, v12, v96
    v_add_f32 v13, v13, v97
    v_mfma_f32_16x16x32_bf16 v[92:95], v[76:79], a[20:23], v[92:95]
    v_cvt_pk_bf16_f32 v108, v96, v97
    v_mfma_f32_16x16x32_bf16 v[92:95], v[72:75], a[16:19], v[92:95]
    v_exp_f32 v100, v100
    v_mfma_f32_16x16x32_bf16 v[168:171], v[112:115], v[104:107], v[168:171]
    ds_read_b64_tr_b16 v[112:113], v9 offset:25344
    ds_read_b64_tr_b16 v[114:115], v9 offset:25856
    v_exp_f32 v101, v101
    v_mfma_f32_16x16x32_bf16 v[196:199], v[116:119], v[104:107], v[196:199]
    ds_read_b64_tr_b16 v[116:117], v9 offset:25376
    ds_read_b64_tr_b16 v[118:119], v9 offset:25888
    v_add_f32 v12, v12, v98
    v_add_f32 v13, v13, v99
    v_mfma_f32_16x16x32_bf16 v[224:227], v[120:123], v[104:107], v[224:227]
    ds_read_b64_tr_b16 v[120:121], v9 offset:25408
    ds_read_b64_tr_b16 v[122:123], v9 offset:25920
    v_cvt_pk_bf16_f32 v109, v98, v99
    v_mfma_f32_16x16x32_bf16 v[252:255], v[124:127], v[104:107], v[252:255]
    ds_read_b64_tr_b16 v[124:125], v9 offset:25440
    ds_read_b64_tr_b16 v[126:127], v9 offset:25952
    v_exp_f32 v102, v102
    v_mfma_f32_16x16x32_bf16 a[136:139], v[128:131], v[104:107], a[136:139]
    ds_read_b64_tr_b16 v[128:129], v9 offset:25472
    ds_read_b64_tr_b16 v[130:131], v9 offset:25984
    v_exp_f32 v103, v103
    v_mfma_f32_16x16x32_bf16 a[164:167], v[132:135], v[104:107], a[164:167]
    ds_read_b64_tr_b16 v[132:133], v9 offset:25504
    ds_read_b64_tr_b16 v[134:135], v9 offset:26016
    v_add_f32 v12, v12, v100
    v_add_f32 v13, v13, v101
    v_mfma_f32_16x16x32_bf16 a[192:195], v[136:139], v[104:107], a[192:195]
    ds_read_b64_tr_b16 v[136:137], v9 offset:25536
    ds_read_b64_tr_b16 v[138:139], v9 offset:26048
    v_cvt_pk_bf16_f32 v110, v100, v101
    v_add_f32 v12, v12, v102
    v_mfma_f32_16x16x32_bf16 a[220:223], v[140:143], v[104:107], a[220:223]
    ds_read_b64_tr_b16 v[140:141], v9 offset:25568
    ds_read_b64_tr_b16 v[142:143], v9 offset:26080
    v_add_f32 v13, v13, v103
    v_cvt_pk_bf16_f32 v111, v102, v103
    v_mfma_f32_16x16x32_bf16 v[96:99], v[56:59], a[32:35], v[36:39]
    v_mfma_f32_16x16x32_bf16 v[96:99], v[60:63], a[36:39], v[96:99]
    s_add_u32 s29, s34, s100
    v_exp_f32 v88, v88
    v_mfma_f32_16x16x32_bf16 v[96:99], v[64:67], a[40:43], v[96:99]
    v_exp_f32 v89, v89
    v_mfma_f32_16x16x32_bf16 v[96:99], v[68:71], a[44:47], v[96:99]
    s_bfe_u32 s28, s29, 0x20003
    v_exp_f32 v90, v90
    v_mfma_f32_16x16x32_bf16 v[100:103], v[84:87], a[44:47], v[36:39]
    v_exp_f32 v91, v91
    v_mfma_f32_16x16x32_bf16 v[100:103], v[80:83], a[40:43], v[100:103]
    s_lshl_b32 s28, s28, 16
    v_add_f32 v14, v14, v88
    v_add_f32 v15, v15, v89
    v_mfma_f32_16x16x32_bf16 v[100:103], v[76:79], a[36:39], v[100:103]
    v_cvt_pk_bf16_f32 v104, v88, v89
    v_mfma_f32_16x16x32_bf16 v[100:103], v[72:75], a[32:35], v[100:103]
    v_exp_f32 v92, v92
    s_waitcnt lgkmcnt(0)
    v_mfma_f32_16x16x32_bf16 v[144:147], v[112:115], v[108:111], v[144:147]
    s_and_b32 s29, s29, 7
    v_exp_f32 v93, v93
    v_mfma_f32_16x16x32_bf16 v[172:175], v[116:119], v[108:111], v[172:175]
    v_add_f32 v14, v14, v90
    v_add_f32 v15, v15, v91
    v_mfma_f32_16x16x32_bf16 v[200:203], v[120:123], v[108:111], v[200:203]
    s_lshl_b32 s29, s29, 11
    v_cvt_pk_bf16_f32 v105, v90, v91
    v_mfma_f32_16x16x32_bf16 v[228:231], v[124:127], v[108:111], v[228:231]
    v_exp_f32 v94, v94
    v_mfma_f32_16x16x32_bf16 a[112:115], v[128:131], v[108:111], a[112:115]
    s_add_u32 s29, s28, s29
    v_exp_f32 v95, v95
    v_mfma_f32_16x16x32_bf16 a[140:143], v[132:135], v[108:111], a[140:143]
    v_add_f32 v14, v14, v92
    v_add_f32 v15, v15, v93
    v_mfma_f32_16x16x32_bf16 a[168:171], v[136:139], v[108:111], a[168:171]
    s_lshr_b32 s28, s34, 5
    v_cvt_pk_bf16_f32 v106, v92, v93
    v_add_f32 v14, v14, v94
    v_mfma_f32_16x16x32_bf16 a[196:199], v[140:143], v[108:111], a[196:199]
    v_add_f32 v15, v15, v95
    v_cvt_pk_bf16_f32 v107, v94, v95
    v_mfma_f32_16x16x32_bf16 v[88:91], v[56:59], a[48:51], v[40:43]
    v_mfma_f32_16x16x32_bf16 v[88:91], v[60:63], a[52:55], v[88:91]
    s_lshl_b32 s28, s28, 19
    v_exp_f32 v96, v96
    v_mfma_f32_16x16x32_bf16 v[88:91], v[64:67], a[56:59], v[88:91]
    v_exp_f32 v97, v97
    v_mfma_f32_16x16x32_bf16 v[88:91], v[68:71], a[60:63], v[88:91]
    s_add_u32 s49, s28, s29
    v_exp_f32 v98, v98
    v_mfma_f32_16x16x32_bf16 v[92:95], v[84:87], a[60:63], v[40:43]
    v_exp_f32 v99, v99
    v_mfma_f32_16x16x32_bf16 v[92:95], v[80:83], a[56:59], v[92:95]
    s_add_u32 m0, s33, 16896
    v_add_f32 v16, v16, v96
    v_add_f32 v17, v17, v97
    v_mfma_f32_16x16x32_bf16 v[92:95], v[76:79], a[52:55], v[92:95]
    v_cvt_pk_bf16_f32 v108, v96, v97
    v_mfma_f32_16x16x32_bf16 v[92:95], v[72:75], a[48:51], v[92:95]
    v_exp_f32 v100, v100
    v_mfma_f32_16x16x32_bf16 v[148:151], v[112:115], v[104:107], v[148:151]
    s_add_u32 s34, s34, 1
    v_exp_f32 v101, v101
    v_mfma_f32_16x16x32_bf16 v[176:179], v[116:119], v[104:107], v[176:179]
    v_add_f32 v16, v16, v98
    v_add_f32 v17, v17, v99
    v_mfma_f32_16x16x32_bf16 v[204:207], v[120:123], v[104:107], v[204:207]
    buffer_load_dwordx4 v7, s[4:7], s49 offen offset:0 nt lds
    v_cvt_pk_bf16_f32 v109, v98, v99
    v_mfma_f32_16x16x32_bf16 v[232:235], v[124:127], v[104:107], v[232:235]
    v_exp_f32 v102, v102
    v_mfma_f32_16x16x32_bf16 a[116:119], v[128:131], v[104:107], a[116:119]
    s_add_u32 m0, m0, s96
    v_exp_f32 v103, v103
    v_mfma_f32_16x16x32_bf16 a[144:147], v[132:135], v[104:107], a[144:147]
    v_add_f32 v16, v16, v100
    v_add_f32 v17, v17, v101
    v_mfma_f32_16x16x32_bf16 a[172:175], v[136:139], v[104:107], a[172:175]
    buffer_load_dwordx4 v7, s[4:7], s49 offen offset:256 nt lds
    v_cvt_pk_bf16_f32 v110, v100, v101
    v_add_f32 v16, v16, v102
    v_mfma_f32_16x16x32_bf16 a[200:203], v[140:143], v[104:107], a[200:203]
    v_add_f32 v17, v17, v103
    v_cvt_pk_bf16_f32 v111, v102, v103
    v_mfma_f32_16x16x32_bf16 v[96:99], v[56:59], a[64:67], v[44:47]
    v_mfma_f32_16x16x32_bf16 v[96:99], v[60:63], a[68:71], v[96:99]
    s_add_u32 m0, m0, s97
    v_exp_f32 v88, v88
    v_mfma_f32_16x16x32_bf16 v[96:99], v[64:67], a[72:75], v[96:99]
    v_exp_f32 v89, v89
    v_mfma_f32_16x16x32_bf16 v[96:99], v[68:71], a[76:79], v[96:99]
    buffer_load_dwordx4 v7, s[4:7], s49 offen offset:512 nt lds
    v_exp_f32 v90, v90
    v_mfma_f32_16x16x32_bf16 v[100:103], v[84:87], a[76:79], v[44:47]
    v_exp_f32 v91, v91
    v_mfma_f32_16x16x32_bf16 v[100:103], v[80:83], a[72:75], v[100:103]
    s_add_u32 m0, m0, s96
    v_add_f32 v18, v18, v88
    v_add_f32 v19, v19, v89
    v_mfma_f32_16x16x32_bf16 v[100:103], v[76:79], a[68:71], v[100:103]
    v_cvt_pk_bf16_f32 v104, v88, v89
    v_mfma_f32_16x16x32_bf16 v[100:103], v[72:75], a[64:67], v[100:103]
    v_exp_f32 v92, v92
    v_mfma_f32_16x16x32_bf16 v[152:155], v[112:115], v[108:111], v[152:155]
    buffer_load_dwordx4 v7, s[4:7], s49 offen offset:768 nt lds
    v_exp_f32 v93, v93
    v_mfma_f32_16x16x32_bf16 v[180:183], v[116:119], v[108:111], v[180:183]
    v_add_f32 v18, v18, v90
    v_add_f32 v19, v19, v91
    v_mfma_f32_16x16x32_bf16 v[208:211], v[120:123], v[108:111], v[208:211]
    s_add_u32 m0, m0, s97
    v_cvt_pk_bf16_f32 v105, v90, v91
    v_mfma_f32_16x16x32_bf16 v[236:239], v[124:127], v[108:111], v[236:239]
    v_exp_f32 v94, v94
    v_mfma_f32_16x16x32_bf16 a[120:123], v[128:131], v[108:111], a[120:123]
    buffer_load_dwordx4 v7, s[4:7], s49 offen offset:1024 nt lds
    v_exp_f32 v95, v95
    v_mfma_f32_16x16x32_bf16 a[148:151], v[132:135], v[108:111], a[148:151]
    v_add_f32 v18, v18, v92
    v_add_f32 v19, v19, v93
    v_mfma_f32_16x16x32_bf16 a[176:179], v[136:139], v[108:111], a[176:179]
    s_add_u32 m0, m0, s96
    v_cvt_pk_bf16_f32 v106, v92, v93
    v_add_f32 v18, v18, v94
    v_mfma_f32_16x16x32_bf16 a[204:207], v[140:143], v[108:111], a[204:207]
    v_add_f32 v19, v19, v95
    v_cvt_pk_bf16_f32 v107, v94, v95
    v_mfma_f32_16x16x32_bf16 v[88:91], v[56:59], a[80:83], v[48:51]
    v_mfma_f32_16x16x32_bf16 v[88:91], v[60:63], a[84:87], v[88:91]
    buffer_load_dwordx4 v7, s[4:7], s49 offen offset:1280 nt lds
    v_exp_f32 v96, v96
    v_mfma_f32_16x16x32_bf16 v[88:91], v[64:67], a[88:91], v[88:91]
    v_exp_f32 v97, v97
    v_mfma_f32_16x16x32_bf16 v[88:91], v[68:71], a[92:95], v[88:91]
    s_add_u32 m0, m0, s97
    v_exp_f32 v98, v98
    v_mfma_f32_16x16x32_bf16 v[92:95], v[84:87], a[92:95], v[48:51]
    v_exp_f32 v99, v99
    v_mfma_f32_16x16x32_bf16 v[92:95], v[80:83], a[88:91], v[92:95]
    buffer_load_dwordx4 v7, s[4:7], s49 offen offset:1536 nt lds
    v_add_f32 v20, v20, v96
    v_add_f32 v21, v21, v97
    v_mfma_f32_16x16x32_bf16 v[92:95], v[76:79], a[84:87], v[92:95]
    v_cvt_pk_bf16_f32 v108, v96, v97
    v_mfma_f32_16x16x32_bf16 v[92:95], v[72:75], a[80:83], v[92:95]
    v_exp_f32 v100, v100
    v_mfma_f32_16x16x32_bf16 v[156:159], v[112:115], v[104:107], v[156:159]
    s_add_u32 m0, m0, s96
    v_exp_f32 v101, v101
    v_mfma_f32_16x16x32_bf16 v[184:187], v[116:119], v[104:107], v[184:187]
    v_add_f32 v20, v20, v98
    v_add_f32 v21, v21, v99
    v_mfma_f32_16x16x32_bf16 v[212:215], v[120:123], v[104:107], v[212:215]
    buffer_load_dwordx4 v7, s[4:7], s49 offen offset:1792 nt lds
    v_cvt_pk_bf16_f32 v109, v98, v99
    v_mfma_f32_16x16x32_bf16 v[240:243], v[124:127], v[104:107], v[240:243]
    v_exp_f32 v102, v102
    v_mfma_f32_16x16x32_bf16 a[124:127], v[128:131], v[104:107], a[124:127]
    v_exp_f32 v103, v103
    v_mfma_f32_16x16x32_bf16 a[152:155], v[132:135], v[104:107], a[152:155]
    v_add_f32 v20, v20, v100
    v_add_f32 v21, v21, v101
    v_mfma_f32_16x16x32_bf16 a[180:183], v[136:139], v[104:107], a[180:183]
    v_cvt_pk_bf16_f32 v110, v100, v101
    v_add_f32 v20, v20, v102
    v_mfma_f32_16x16x32_bf16 a[208:211], v[140:143], v[104:107], a[208:211]
    v_add_f32 v21, v21, v103
    v_cvt_pk_bf16_f32 v111, v102, v103
    s_waitcnt vmcnt(16) lgkmcnt(0)
    s_barrier
    v_mfma_f32_16x16x32_bf16 v[96:99], v[56:59], a[96:99], v[52:55]
    ds_read_b128 v[56:59], v8 offset:0
    s_add_u32 s29, s34, s100
    v_mfma_f32_16x16x32_bf16 v[96:99], v[60:63], a[100:103], v[96:99]
    ds_read_b128 v[60:63], v8 offset:64
    s_bfe_u32 s28, s29, 0x20003
    v_exp_f32 v88, v88
    v_mfma_f32_16x16x32_bf16 v[96:99], v[64:67], a[104:107], v[96:99]
    ds_read_b128 v[64:67], v8 offset:128
    s_lshl_b32 s28, s28, 16
    v_exp_f32 v89, v89
    v_mfma_f32_16x16x32_bf16 v[96:99], v[68:71], a[108:111], v[96:99]
    ds_read_b128 v[68:71], v8 offset:192
    s_and_b32 s29, s29, 7
    v_exp_f32 v90, v90
    v_mfma_f32_16x16x32_bf16 v[100:103], v[84:87], a[108:111], v[52:55]
    ds_read_b128 v[84:87], v8 offset:704
    s_lshl_b32 s29, s29, 11
    v_exp_f32 v91, v91
    v_mfma_f32_16x16x32_bf16 v[100:103], v[80:83], a[104:107], v[100:103]
    ds_read_b128 v[80:83], v8 offset:640
    s_add_u32 s29, s28, s29
    v_add_f32 v22, v22, v88
    v_add_f32 v23, v23, v89
    v_mfma_f32_16x16x32_bf16 v[100:103], v[76:79], a[100:103], v[100:103]
    ds_read_b128 v[76:79], v8 offset:576
    s_lshr_b32 s28, s34, 5
    v_cvt_pk_bf16_f32 v104, v88, v89
    v_mfma_f32_16x16x32_bf16 v[100:103], v[72:75], a[96:99], v[100:103]
    ds_read_b128 v[72:75], v8 offset:512
    s_lshl_b32 s28, s28, 19
    v_exp_f32 v92, v92
    v_mfma_f32_16x16x32_bf16 v[160:163], v[112:115], v[108:111], v[160:163]
    s_add_u32 s49, s28, s29
    s_add_u32 m0, s33, 25344
    v_exp_f32 v93, v93
    v_mfma_f32_16x16x32_bf16 v[188:191], v[116:119], v[108:111], v[188:191]
    s_add_u32 s34, s34, 1
    v_add_f32 v22, v22, v90
    v_add_f32 v23, v23, v91
    v_mfma_f32_16x16x32_bf16 v[216:219], v[120:123], v[108:111], v[216:219]
    s_nop 0
    v_cvt_pk_bf16_f32 v105, v90, v91
    v_mfma_f32_16x16x32_bf16 v[244:247], v[124:127], v[108:111], v[244:247]
    buffer_load_dwordx4 v7, s[4:7], s49 offen offset:0 nt lds
    v_exp_f32 v94, v94
    v_mfma_f32_16x16x32_bf16 a[128:131], v[128:131], v[108:111], a[128:131]
    s_add_u32 m0, m0, s96
    v_exp_f32 v95, v95
    v_mfma_f32_16x16x32_bf16 a[156:159], v[132:135], v[108:111], a[156:159]
    s_nop 0
    v_add_f32 v22, v22, v92
    v_add_f32 v23, v23, v93
    v_mfma_f32_16x16x32_bf16 a[184:187], v[136:139], v[108:111], a[184:187]
    buffer_load_dwordx4 v7, s[4:7], s49 offen offset:256 nt lds
    v_cvt_pk_bf16_f32 v106, v92, v93
    v_add_f32 v22, v22, v94
    v_mfma_f32_16x16x32_bf16 a[212:215], v[140:143], v[108:111], a[212:215]
    s_add_u32 m0, m0, s97
    v_add_f32 v23, v23, v95
    v_cvt_pk_bf16_f32 v107, v94, v95
    s_lshl_b32 s30, s2, 2
    s_add_u32 s30, s30, s20
    s_mul_i32 s30, s30, 28672
    v_lshlrev_b32 v4, 4, v1
    buffer_load_dwordx4 a[0:3], v4, s[12:15], s30 offen offset:0
    buffer_load_dwordx4 a[4:7], v4, s[12:15], s30 offen offset:1024
    buffer_load_dwordx4 a[8:11], v4, s[12:15], s30 offen offset:2048
    buffer_load_dwordx4 a[12:15], v4, s[12:15], s30 offen offset:3072
    s_add_u32 s30, s30, 4096
    buffer_load_dwordx4 a[16:19], v4, s[12:15], s30 offen offset:0
    buffer_load_dwordx4 a[20:23], v4, s[12:15], s30 offen offset:1024
    buffer_load_dwordx4 a[24:27], v4, s[12:15], s30 offen offset:2048
    buffer_load_dwordx4 a[28:31], v4, s[12:15], s30 offen offset:3072
    s_add_u32 s30, s30, 4096
    buffer_load_dwordx4 a[32:35], v4, s[12:15], s30 offen offset:0
    buffer_load_dwordx4 a[36:39], v4, s[12:15], s30 offen offset:1024
    buffer_load_dwordx4 a[40:43], v4, s[12:15], s30 offen offset:2048
    buffer_load_dwordx4 a[44:47], v4, s[12:15], s30 offen offset:3072
    s_add_u32 s30, s30, 4096
    buffer_load_dwordx4 a[48:51], v4, s[12:15], s30 offen offset:0
    buffer_load_dwordx4 a[52:55], v4, s[12:15], s30 offen offset:1024
    buffer_load_dwordx4 a[56:59], v4, s[12:15], s30 offen offset:2048
    buffer_load_dwordx4 a[60:63], v4, s[12:15], s30 offen offset:3072
    s_add_u32 s30, s30, 4096
    buffer_load_dwordx4 a[64:67], v4, s[12:15], s30 offen offset:0
    buffer_load_dwordx4 a[68:71], v4, s[12:15], s30 offen offset:1024
    buffer_load_dwordx4 a[72:75], v4, s[12:15], s30 offen offset:2048
    buffer_load_dwordx4 a[76:79], v4, s[12:15], s30 offen offset:3072
    s_add_u32 s30, s30, 4096
    buffer_load_dwordx4 a[80:83], v4, s[12:15], s30 offen offset:0
    buffer_load_dwordx4 a[84:87], v4, s[12:15], s30 offen offset:1024
    buffer_load_dwordx4 a[88:91], v4, s[12:15], s30 offen offset:2048
    buffer_load_dwordx4 a[92:95], v4, s[12:15], s30 offen offset:3072
    s_add_u32 s30, s30, 4096
    buffer_load_dwordx4 a[96:99], v4, s[12:15], s30 offen offset:0
    buffer_load_dwordx4 a[100:103], v4, s[12:15], s30 offen offset:1024
    buffer_load_dwordx4 a[104:107], v4, s[12:15], s30 offen offset:2048
    buffer_load_dwordx4 a[108:111], v4, s[12:15], s30 offen offset:3072
    s_nop 1
    v_mfma_f32_16x16x32_bf16 v[164:167], v[112:115], v[104:107], v[164:167]
    s_nop 0
    buffer_load_dwordx4 v7, s[4:7], s49 offen offset:512 nt lds
    v_exp_f32 v96, v96
    v_mfma_f32_16x16x32_bf16 v[192:195], v[116:119], v[104:107], v[192:195]
    s_add_u32 m0, m0, s96
    s_nop 0
    v_exp_f32 v97, v97
    v_exp_f32 v98, v98
    v_mfma_f32_16x16x32_bf16 v[220:223], v[120:123], v[104:107], v[220:223]
    buffer_load_dwordx4 v7, s[4:7], s49 offen offset:768 nt lds
    s_add_u32 m0, m0, s97
    v_exp_f32 v99, v99
    v_add_f32 v24, v24, v96
    v_add_f32 v25, v25, v97
    v_mfma_f32_16x16x32_bf16 v[248:251], v[124:127], v[104:107], v[248:251]
    s_nop 0
    buffer_load_dwordx4 v7, s[4:7], s49 offen offset:1024 nt lds
    v_cvt_pk_bf16_f32 v108, v96, v97
    v_exp_f32 v100, v100
    v_mfma_f32_16x16x32_bf16 a[132:135], v[128:131], v[104:107], a[132:135]
    s_add_u32 m0, m0, s96
    s_nop 0
    buffer_load_dwordx4 v7, s[4:7], s49 offen offset:1280 nt lds
    v_exp_f32 v101, v101
    v_add_f32 v24, v24, v98
    v_add_f32 v25, v25, v99
    v_mfma_f32_16x16x32_bf16 a[160:163], v[132:135], v[104:107], a[160:163]
    s_add_u32 m0, m0, s97
    s_nop 0
    v_cvt_pk_bf16_f32 v109, v98, v99
    v_exp_f32 v102, v102
    v_mfma_f32_16x16x32_bf16 a[188:191], v[136:139], v[104:107], a[188:191]
    buffer_load_dwordx4 v7, s[4:7], s49 offen offset:1536 nt lds
    s_add_u32 m0, m0, s96
    v_exp_f32 v103, v103
    v_add_f32 v24, v24, v100
    v_add_f32 v25, v25, v101
    v_mfma_f32_16x16x32_bf16 a[216:219], v[140:143], v[104:107], a[216:219]
    s_nop 0
    buffer_load_dwordx4 v7, s[4:7], s49 offen offset:1792 nt lds
    v_cvt_pk_bf16_f32 v110, v100, v101
    v_add_f32 v24, v24, v102
    v_add_f32 v25, v25, v103
    v_cvt_pk_bf16_f32 v111, v102, v103
L_at_aepi:
    s_nop 1
    s_waitcnt lgkmcnt(0)
    v_mfma_f32_16x16x32_bf16 v[168:171], v[112:115], v[108:111], v[168:171]
    v_add_f32 v12, v12, v13
    v_add_f32 v14, v14, v15
    v_add_f32 v16, v16, v17
    v_add_f32 v18, v18, v19
    v_add_f32 v20, v20, v21
    v_add_f32 v22, v22, v23
    v_mfma_f32_16x16x32_bf16 v[196:199], v[116:119], v[108:111], v[196:199]
    v_add_f32 v24, v24, v25
    v_mov_b32 v88, v12
    v_mov_b32 v89, v14
    v_mov_b32 v90, v16
    v_mov_b32 v91, v18
    v_mov_b32 v92, v20
    v_mfma_f32_16x16x32_bf16 v[224:227], v[120:123], v[108:111], v[224:227]
    v_mov_b32 v93, v22
    v_mov_b32 v94, v24
    v_permlane16_swap_b32 v12, v88
    v_permlane16_swap_b32 v14, v89
    v_permlane16_swap_b32 v16, v90
    v_permlane16_swap_b32 v18, v91
    v_mfma_f32_16x16x32_bf16 v[252:255], v[124:127], v[108:111], v[252:255]
    v_permlane16_swap_b32 v20, v92
    v_permlane16_swap_b32 v22, v93
    v_permlane16_swap_b32 v24, v94
    v_add_f32 v12, v12, v88
    v_add_f32 v14, v14, v89
    v_add_f32 v16, v16, v90
    v_mfma_f32_16x16x32_bf16 a[136:139], v[128:131], v[108:111], a[136:139]
    v_add_f32 v18, v18, v91
    v_add_f32 v20, v20, v92
    v_add_f32 v22, v22, v93
    v_add_f32 v24, v24, v94
    v_mov_b32 v88, v12
    v_mov_b32 v89, v14
    v_mfma_f32_16x16x32_bf16 a[164:167], v[132:135], v[108:111], a[164:167]
    v_mov_b32 v90, v16
    v_mov_b32 v91, v18
    v_mov_b32 v92, v20
    v_mov_b32 v93, v22
    v_mov_b32 v94, v24
    v_permlane32_swap_b32 v12, v88
    v_mfma_f32_16x16x32_bf16 a[192:195], v[136:139], v[108:111], a[192:195]
    v_permlane32_swap_b32 v14, v89
    v_permlane32_swap_b32 v16, v90
    v_permlane32_swap_b32 v18, v91
    v_permlane32_swap_b32 v20, v92
    v_permlane32_swap_b32 v22, v93
    v_permlane32_swap_b32 v24, v94
    v_mfma_f32_16x16x32_bf16 a[220:223], v[140:143], v[108:111], a[220:223]
    v_add_f32 v12, v12, v88
    v_add_f32 v14, v14, v89
    v_add_f32 v16, v16, v90
    v_add_f32 v18, v18, v91
    v_add_f32 v20, v20, v92
    v_add_f32 v22, v22, v93
    v_add_f32 v24, v24, v94
    v_rcp_f32 v28, v12
    v_rcp_f32 v32, v14
    v_rcp_f32 v36, v16
    v_rcp_f32 v40, v18
    v_rcp_f32 v44, v20
    v_rcp_f32 v48, v22
    v_rcp_f32 v52, v24
    v_add_f32 v90, v12, v14
    v_add_f32 v91, v16, v18
    v_add_f32 v92, v20, v22
    v_add_f32 v90, v90, v24
    v_add_f32 v91, v91, v92
    v_add_f32 v90, v90, v91
    v_cmp_nge_f32 vcc, s32, v90
    v_mov_b32 v12, 0xff800000
    v_mov_b32 v14, 0xff800000
    v_mov_b32 v16, 0xff800000
    v_mov_b32 v18, 0xff800000
    v_mov_b32 v20, 0xff800000
    v_mov_b32 v22, 0xff800000
    v_mov_b32 v24, 0xff800000
    s_cmp_eq_u64 vcc, 0
    s_cbranch_scc1 L_at_noflag
    s_lshl_b32 s29, s21, 2
    s_add_u32 s29, s29, 75996
    v_mov_b32 v90, s29
    v_mov_b32 v91, 1
    ds_write_b32 v90, v91
L_at_noflag:
    s_mul_i32 s31, s21, 114688
    s_add_u32 s31, s31, s24
    s_sub_u32 s31, s31, 114688
    v_pk_mul_f32 v[144:145], v[144:145], v[28:29] op_sel_hi:[1,0]
    v_pk_mul_f32 v[146:147], v[146:147], v[28:29] op_sel_hi:[1,0]
    v_pk_mul_f32 v[148:149], v[148:149], v[32:33] op_sel_hi:[1,0]
    v_pk_mul_f32 v[150:151], v[150:151], v[32:33] op_sel_hi:[1,0]
    v_pk_mul_f32 v[152:153], v[152:153], v[36:37] op_sel_hi:[1,0]
    v_pk_mul_f32 v[154:155], v[154:155], v[36:37] op_sel_hi:[1,0]
    v_pk_mul_f32 v[156:157], v[156:157], v[40:41] op_sel_hi:[1,0]
    v_pk_mul_f32 v[158:159], v[158:159], v[40:41] op_sel_hi:[1,0]
    v_pk_mul_f32 v[160:161], v[160:161], v[44:45] op_sel_hi:[1,0]
    v_pk_mul_f32 v[162:163], v[162:163], v[44:45] op_sel_hi:[1,0]
    v_pk_mul_f32 v[164:165], v[164:165], v[48:49] op_sel_hi:[1,0]
    v_pk_mul_f32 v[166:167], v[166:167], v[48:49] op_sel_hi:[1,0]
    v_pk_mul_f32 v[168:169], v[168:169], v[52:53] op_sel_hi:[1,0]
    v_pk_mul_f32 v[170:171], v[170:171], v[52:53] op_sel_hi:[1,0]
    v_pk_mul_f32 v[172:173], v[172:173], v[28:29] op_sel_hi:[1,0]
    v_pk_mul_f32 v[174:175], v[174:175], v[28:29] op_sel_hi:[1,0]
    v_pk_mul_f32 v[176:177], v[176:177], v[32:33] op_sel_hi:[1,0]
    v_pk_mul_f32 v[178:179], v[178:179], v[32:33] op_sel_hi:[1,0]
    v_pk_mul_f32 v[180:181], v[180:181], v[36:37] op_sel_hi:[1,0]
    v_pk_mul_f32 v[182:183], v[182:183], v[36:37] op_sel_hi:[1,0]
    v_pk_mul_f32 v[184:185], v[184:185], v[40:41] op_sel_hi:[1,0]
    v_pk_mul_f32 v[186:187], v[186:187], v[40:41] op_sel_hi:[1,0]
    v_pk_mul_f32 v[188:189], v[188:189], v[44:45] op_sel_hi:[1,0]
    v_pk_mul_f32 v[190:191], v[190:191], v[44:45] op_sel_hi:[1,0]
    v_pk_mul_f32 v[192:193], v[192:193], v[48:49] op_sel_hi:[1,0]
    v_pk_mul_f32 v[194:195], v[194:195], v[48:49] op_sel_hi:[1,0]
    v_pk_mul_f32 v[196:197], v[196:197], v[52:53] op_sel_hi:[1,0]
    v_pk_mul_f32 v[198:199], v[198:199], v[52:53] op_sel_hi:[1,0]
    v_cvt_pk_bf16_f32 v88, v144, v145
    v_cvt_pk_bf16_f32 v89, v146, v147
    v_cvt_pk_bf16_f32 v90, v172, v173
    v_cvt_pk_bf16_f32 v91, v174, v175
    v_cvt_pk_bf16_f32 v92, v148, v149
    v_cvt_pk_bf16_f32 v93, v150, v151
    v_cvt_pk_bf16_f32 v94, v176, v177
    v_cvt_pk_bf16_f32 v95, v178, v179
    v_cvt_pk_bf16_f32 v96, v152, v153
    v_cvt_pk_bf16_f32 v97, v154, v155
    v_cvt_pk_bf16_f32 v98, v180, v181
    v_cvt_pk_bf16_f32 v99, v182, v183
    v_cvt_pk_bf16_f32 v100, v156, v157
    v_cvt_pk_bf16_f32 v101, v158, v159
    v_cvt_pk_bf16_f32 v102, v184, v185
    v_cvt_pk_bf16_f32 v103, v186, v187
    v_cvt_pk_bf16_f32 v104, v160, v161
    v_cvt_pk_bf16_f32 v105, v162, v163
    v_cvt_pk_bf16_f32 v106, v188, v189
    v_cvt_pk_bf16_f32 v107, v190, v191
    v_cvt_pk_bf16_f32 v108, v164, v165
    v_cvt_pk_bf16_f32 v109, v166, v167
    v_cvt_pk_bf16_f32 v110, v192, v193
    v_cvt_pk_bf16_f32 v111, v194, v195
    v_cvt_pk_bf16_f32 v112, v168, v169
    v_cvt_pk_bf16_f32 v113, v170, v171
    v_cvt_pk_bf16_f32 v114, v196, v197
    v_cvt_pk_bf16_f32 v115, v198, v199
    s_mov_b32 s28, s31
    buffer_store_dwordx4 v[88:91], v10, s[12:15], s28 offen offset:0 sc0 sc1
    s_add_u32 s28, s28, 4096
    buffer_store_dwordx4 v[92:95], v10, s[12:15], s28 offen offset:0 sc0 sc1
    s_add_u32 s28, s28, 4096
    buffer_store_dwordx4 v[96:99], v10, s[12:15], s28 offen offset:0 sc0 sc1
    s_add_u32 s28, s28, 4096
    buffer_store_dwordx4 v[100:103], v10, s[12:15], s28 offen offset:0 sc0 sc1
    s_add_u32 s28, s28, 4096
    buffer_store_dwordx4 v[104:107], v10, s[12:15], s28 offen offset:0 sc0 sc1
    s_add_u32 s28, s28, 4096
    buffer_store_dwordx4 v[108:111], v10, s[12:15], s28 offen offset:0 sc0 sc1
    s_add_u32 s28, s28, 4096
    buffer_store_dwordx4 v[112:115], v10, s[12:15], s28 offen offset:0 sc0 sc1
    v_pk_mul_f32 v[200:201], v[200:201], v[28:29] op_sel_hi:[1,0]
    v_pk_mul_f32 v[202:203], v[202:203], v[28:29] op_sel_hi:[1,0]
    v_pk_mul_f32 v[204:205], v[204:205], v[32:33] op_sel_hi:[1,0]
    v_pk_mul_f32 v[206:207], v[206:207], v[32:33] op_sel_hi:[1,0]
    v_pk_mul_f32 v[208:209], v[208:209], v[36:37] op_sel_hi:[1,0]
    v_pk_mul_f32 v[210:211], v[210:211], v[36:37] op_sel_hi:[1,0]
    v_pk_mul_f32 v[212:213], v[212:213], v[40:41] op_sel_hi:[1,0]
    v_pk_mul_f32 v[214:215], v[214:215], v[40:41] op_sel_hi:[1,0]
    v_pk_mul_f32 v[216:217], v[216:217], v[44:45] op_sel_hi:[1,0]
    v_pk_mul_f32 v[218:219], v[218:219], v[44:45] op_sel_hi:[1,0]
    v_pk_mul_f32 v[220:221], v[220:221], v[48:49] op_sel_hi:[1,0]
    v_pk_mul_f32 v[222:223], v[222:223], v[48:49] op_sel_hi:[1,0]
    v_pk_mul_f32 v[224:225], v[224:225], v[52:53] op_sel_hi:[1,0]
    v_pk_mul_f32 v[226:227], v[226:227], v[52:53] op_sel_hi:[1,0]
    v_pk_mul_f32 v[228:229], v[228:229], v[28:29] op_sel_hi:[1,0]
    v_pk_mul_f32 v[230:231], v[230:231], v[28:29] op_sel_hi:[1,0]
    v_pk_mul_f32 v[232:233], v[232:233], v[32:33] op_sel_hi:[1,0]
    v_pk_mul_f32 v[234:235], v[234:235], v[32:33] op_sel_hi:[1,0]
    v_pk_mul_f32 v[236:237], v[236:237], v[36:37] op_sel_hi:[1,0]
    v_pk_mul_f32 v[238:239], v[238:239], v[36:37] op_sel_hi:[1,0]
    v_pk_mul_f32 v[240:241], v[240:241], v[40:41] op_sel_hi:[1,0]
    v_pk_mul_f32 v[242:243], v[242:243], v[40:41] op_sel_hi:[1,0]
    v_pk_mul_f32 v[244:245], v[244:245], v[44:45] op_sel_hi:[1,0]
    v_pk_mul_f32 v[246:247], v[246:247], v[44:45] op_sel_hi:[1,0]
    v_pk_mul_f32 v[248:249], v[248:249], v[48:49] op_sel_hi:[1,0]
    v_pk_mul_f32 v[250:251], v[250:251], v[48:49] op_sel_hi:[1,0]
    v_pk_mul_f32 v[252:253], v[252:253], v[52:53] op_sel_hi:[1,0]
    v_pk_mul_f32 v[254:255], v[254:255], v[52:53] op_sel_hi:[1,0]
    v_cvt_pk_bf16_f32 v116, v200, v201
    v_cvt_pk_bf16_f32 v117, v202, v203
    v_cvt_pk_bf16_f32 v118, v228, v229
    v_cvt_pk_bf16_f32 v119, v230, v231
    v_cvt_pk_bf16_f32 v120, v204, v205
    v_cvt_pk_bf16_f32 v121, v206, v207
    v_cvt_pk_bf16_f32 v122, v232, v233
    v_cvt_pk_bf16_f32 v123, v234, v235
    v_cvt_pk_bf16_f32 v124, v208, v209
    v_cvt_pk_bf16_f32 v125, v210, v211
    v_cvt_pk_bf16_f32 v126, v236, v237
    v_cvt_pk_bf16_f32 v127, v238, v239
    v_cvt_pk_bf16_f32 v128, v212, v213
    v_cvt_pk_bf16_f32 v129, v214, v215
    v_cvt_pk_bf16_f32 v130, v240, v241
    v_cvt_pk_bf16_f32 v131, v242, v243
    v_cvt_pk_bf16_f32 v132, v216, v217
    v_cvt_pk_bf16_f32 v133, v218, v219
    v_cvt_pk_bf16_f32 v134, v244, v245
    v_cvt_pk_bf16_f32 v135, v246, v247
    v_cvt_pk_bf16_f32 v136, v220, v221
    v_cvt_pk_bf16_f32 v137, v222, v223
    v_cvt_pk_bf16_f32 v138, v248, v249
    v_cvt_pk_bf16_f32 v139, v250, v251
    v_cvt_pk_bf16_f32 v140, v224, v225
    v_cvt_pk_bf16_f32 v141, v226, v227
    v_cvt_pk_bf16_f32 v142, v252, v253
    v_cvt_pk_bf16_f32 v143, v254, v255
    s_mov_b32 s28, s31
    buffer_store_dwordx4 v[116:119], v10, s[12:15], s28 offen offset:1024 sc0 sc1
    s_add_u32 s28, s28, 4096
    buffer_store_dwordx4 v[120:123], v10, s[12:15], s28 offen offset:1024 sc0 sc1
    s_add_u32 s28, s28, 4096
    buffer_store_dwordx4 v[124:127], v10, s[12:15], s28 offen offset:1024 sc0 sc1
    s_add_u32 s28, s28, 4096
    buffer_store_dwordx4 v[128:131], v10, s[12:15], s28 offen offset:1024 sc0 sc1
    s_add_u32 s28, s28, 4096
    buffer_store_dwordx4 v[132:135], v10, s[12:15], s28 offen offset:1024 sc0 sc1
    s_add_u32 s28, s28, 4096
    buffer_store_dwordx4 v[136:139], v10, s[12:15], s28 offen offset:1024 sc0 sc1
    s_add_u32 s28, s28, 4096
    buffer_store_dwordx4 v[140:143], v10, s[12:15], s28 offen offset:1024 sc0 sc1
    v_accvgpr_read_b32 v144, a112
    v_accvgpr_read_b32 v145, a113
    v_accvgpr_read_b32 v146, a114
    v_accvgpr_read_b32 v147, a115
    v_accvgpr_read_b32 v148, a116
    v_accvgpr_read_b32 v149, a117
    v_accvgpr_read_b32 v150, a118
    v_accvgpr_read_b32 v151, a119
    v_accvgpr_read_b32 v152, a120
    v_accvgpr_read_b32 v153, a121
    v_accvgpr_read_b32 v154, a122
    v_accvgpr_read_b32 v155, a123
    v_accvgpr_read_b32 v156, a124
    v_accvgpr_read_b32 v157, a125
    v_accvgpr_read_b32 v158, a126
    v_accvgpr_read_b32 v159, a127
    v_accvgpr_read_b32 v160, a128
    v_accvgpr_read_b32 v161, a129
    v_accvgpr_read_b32 v162, a130
    v_accvgpr_read_b32 v163, a131
    v_accvgpr_read_b32 v164, a132
    v_accvgpr_read_b32 v165, a133
    v_accvgpr_read_b32 v166, a134
    v_accvgpr_read_b32 v167, a135
    v_accvgpr_read_b32 v168, a136
    v_accvgpr_read_b32 v169, a137
    v_accvgpr_read_b32 v170, a138
    v_accvgpr_read_b32 v171, a139
    v_accvgpr_read_b32 v172, a140
    v_accvgpr_read_b32 v173, a141
    v_accvgpr_read_b32 v174, a142
    v_accvgpr_read_b32 v175, a143
    v_accvgpr_read_b32 v176, a144
    v_accvgpr_read_b32 v177, a145
    v_accvgpr_read_b32 v178, a146
    v_accvgpr_read_b32 v179, a147
    v_accvgpr_read_b32 v180, a148
    v_accvgpr_read_b32 v181, a149
    v_accvgpr_read_b32 v182, a150
    v_accvgpr_read_b32 v183, a151
    v_accvgpr_read_b32 v184, a152
    v_accvgpr_read_b32 v185, a153
    v_accvgpr_read_b32 v186, a154
    v_accvgpr_read_b32 v187, a155
    v_accvgpr_read_b32 v188, a156
    v_accvgpr_read_b32 v189, a157
    v_accvgpr_read_b32 v190, a158
    v_accvgpr_read_b32 v191, a159
    v_accvgpr_read_b32 v192, a160
    v_accvgpr_read_b32 v193, a161
    v_accvgpr_read_b32 v194, a162
    v_accvgpr_read_b32 v195, a163
    v_accvgpr_read_b32 v196, a164
    v_accvgpr_read_b32 v197, a165
    v_accvgpr_read_b32 v198, a166
    v_accvgpr_read_b32 v199, a167
    v_pk_mul_f32 v[144:145], v[144:145], v[28:29] op_sel_hi:[1,0]
    v_pk_mul_f32 v[146:147], v[146:147], v[28:29] op_sel_hi:[1,0]
    v_pk_mul_f32 v[148:149], v[148:149], v[32:33] op_sel_hi:[1,0]
    v_pk_mul_f32 v[150:151], v[150:151], v[32:33] op_sel_hi:[1,0]
    v_pk_mul_f32 v[152:153], v[152:153], v[36:37] op_sel_hi:[1,0]
    v_pk_mul_f32 v[154:155], v[154:155], v[36:37] op_sel_hi:[1,0]
    v_pk_mul_f32 v[156:157], v[156:157], v[40:41] op_sel_hi:[1,0]
    v_pk_mul_f32 v[158:159], v[158:159], v[40:41] op_sel_hi:[1,0]
    v_pk_mul_f32 v[160:161], v[160:161], v[44:45] op_sel_hi:[1,0]
    v_pk_mul_f32 v[162:163], v[162:163], v[44:45] op_sel_hi:[1,0]
    v_pk_mul_f32 v[164:165], v[164:165], v[48:49] op_sel_hi:[1,0]
    v_pk_mul_f32 v[166:167], v[166:167], v[48:49] op_sel_hi:[1,0]
    v_pk_mul_f32 v[168:169], v[168:169], v[52:53] op_sel_hi:[1,0]
    v_pk_mul_f32 v[170:171], v[170:171], v[52:53] op_sel_hi:[1,0]
    v_pk_mul_f32 v[172:173], v[172:173], v[28:29] op_sel_hi:[1,0]
    v_pk_mul_f32 v[174:175], v[174:175], v[28:29] op_sel_hi:[1,0]
    v_pk_mul_f32 v[176:177], v[176:177], v[32:33] op_sel_hi:[1,0]
    v_pk_mul_f32 v[178:179], v[178:179], v[32:33] op_sel_hi:[1,0]
    v_pk_mul_f32 v[180:181], v[180:181], v[36:37] op_sel_hi:[1,0]
    v_pk_mul_f32 v[182:183], v[182:183], v[36:37] op_sel_hi:[1,0]
    v_pk_mul_f32 v[184:185], v[184:185], v[40:41] op_sel_hi:[1,0]
    v_pk_mul_f32 v[186:187], v[186:187], v[40:41] op_sel_hi:[1,0]
    v_pk_mul_f32 v[188:189], v[188:189], v[44:45] op_sel_hi:[1,0]
    v_pk_mul_f32 v[190:191], v[190:191], v[44:45] op_sel_hi:[1,0]
    v_pk_mul_f32 v[192:193], v[192:193], v[48:49] op_sel_hi:[1,0]
    v_pk_mul_f32 v[194:195], v[194:195], v[48:49] op_sel_hi:[1,0]
    v_pk_mul_f32 v[196:197], v[196:197], v[52:53] op_sel_hi:[1,0]
    v_pk_mul_f32 v[198:199], v[198:199], v[52:53] op_sel_hi:[1,0]
    v_cvt_pk_bf16_f32 v88, v144, v145
    v_cvt_pk_bf16_f32 v89, v146, v147
    v_cvt_pk_bf16_f32 v90, v172, v173
    v_cvt_pk_bf16_f32 v91, v174, v175
    v_cvt_pk_bf16_f32 v92, v148, v149
    v_cvt_pk_bf16_f32 v93, v150, v151
    v_cvt_pk_bf16_f32 v94, v176, v177
    v_cvt_pk_bf16_f32 v95, v178, v179
    v_cvt_pk_bf16_f32 v96, v152, v153
    v_cvt_pk_bf16_f32 v97, v154, v155
    v_cvt_pk_bf16_f32 v98, v180, v181
    v_cvt_pk_bf16_f32 v99, v182, v183
    v_cvt_pk_bf16_f32 v100, v156, v157
    v_cvt_pk_bf16_f32 v101, v158, v159
    v_cvt_pk_bf16_f32 v102, v184, v185
    v_cvt_pk_bf16_f32 v103, v186, v187
    v_cvt_pk_bf16_f32 v104, v160, v161
    v_cvt_pk_bf16_f32 v105, v162, v163
    v_cvt_pk_bf16_f32 v106, v188, v189
    v_cvt_pk_bf16_f32 v107, v190, v191
    v_cvt_pk_bf16_f32 v108, v164, v165
    v_cvt_pk_bf16_f32 v109, v166, v167
    v_cvt_pk_bf16_f32 v110, v192, v193
    v_cvt_pk_bf16_f32 v111, v194, v195
    v_cvt_pk_bf16_f32 v112, v168, v169
    v_cvt_pk_bf16_f32 v113, v170, v171
    v_cvt_pk_bf16_f32 v114, v196, v197
    v_cvt_pk_bf16_f32 v115, v198, v199
    s_mov_b32 s28, s31
    buffer_store_dwordx4 v[88:91], v10, s[12:15], s28 offen offset:2048 sc0 sc1
    s_add_u32 s28, s28, 4096
    buffer_store_dwordx4 v[92:95], v10, s[12:15], s28 offen offset:2048 sc0 sc1
    s_add_u32 s28, s28, 4096
    buffer_store_dwordx4 v[96:99], v10, s[12:15], s28 offen offset:2048 sc0 sc1
    s_add_u32 s28, s28, 4096
    buffer_store_dwordx4 v[100:103], v10, s[12:15], s28 offen offset:2048 sc0 sc1
    s_add_u32 s28, s28, 4096
    buffer_store_dwordx4 v[104:107], v10, s[12:15], s28 offen offset:2048 sc0 sc1
    s_add_u32 s28, s28, 4096
    buffer_store_dwordx4 v[108:111], v10, s[12:15], s28 offen offset:2048 sc0 sc1
    s_add_u32 s28, s28, 4096
    buffer_store_dwordx4 v[112:115], v10, s[12:15], s28 offen offset:2048 sc0 sc1
    v_accvgpr_read_b32 v200, a168
    v_accvgpr_read_b32 v201, a169
    v_accvgpr_read_b32 v202, a170
    v_accvgpr_read_b32 v203, a171
    v_accvgpr_read_b32 v204, a172
    v_accvgpr_read_b32 v205, a173
    v_accvgpr_read_b32 v206, a174
    v_accvgpr_read_b32 v207, a175
    v_accvgpr_read_b32 v208, a176
    v_accvgpr_read_b32 v209, a177
    v_accvgpr_read_b32 v210, a178
    v_accvgpr_read_b32 v211, a179
    v_accvgpr_read_b32 v212, a180
    v_accvgpr_read_b32 v213, a181
    v_accvgpr_read_b32 v214, a182
    v_accvgpr_read_b32 v215, a183
    v_accvgpr_read_b32 v216, a184
    v_accvgpr_read_b32 v217, a185
    v_accvgpr_read_b32 v218, a186
    v_accvgpr_read_b32 v219, a187
    v_accvgpr_read_b32 v220, a188
    v_accvgpr_read_b32 v221, a189
    v_accvgpr_read_b32 v222, a190
    v_accvgpr_read_b32 v223, a191
    v_accvgpr_read_b32 v224, a192
    v_accvgpr_read_b32 v225, a193
    v_accvgpr_read_b32 v226, a194
    v_accvgpr_read_b32 v227, a195
    v_accvgpr_read_b32 v228, a196
    v_accvgpr_read_b32 v229, a197
    v_accvgpr_read_b32 v230, a198
    v_accvgpr_read_b32 v231, a199
    v_accvgpr_read_b32 v232, a200
    v_accvgpr_read_b32 v233, a201
    v_accvgpr_read_b32 v234, a202
    v_accvgpr_read_b32 v235, a203
    v_accvgpr_read_b32 v236, a204
    v_accvgpr_read_b32 v237, a205
    v_accvgpr_read_b32 v238, a206
    v_accvgpr_read_b32 v239, a207
    v_accvgpr_read_b32 v240, a208
    v_accvgpr_read_b32 v241, a209
    v_accvgpr_read_b32 v242, a210
    v_accvgpr_read_b32 v243, a211
    v_accvgpr_read_b32 v244, a212
    v_accvgpr_read_b32 v245, a213
    v_accvgpr_read_b32 v246, a214
    v_accvgpr_read_b32 v247, a215
    v_accvgpr_read_b32 v248, a216
    v_accvgpr_read_b32 v249, a217
    v_accvgpr_read_b32 v250, a218
    v_accvgpr_read_b32 v251, a219
    v_accvgpr_read_b32 v252, a220
    v_accvgpr_read_b32 v253, a221
    v_accvgpr_read_b32 v254, a222
    v_accvgpr_read_b32 v255, a223
    v_pk_mul_f32 v[200:201], v[200:201], v[28:29] op_sel_hi:[1,0]
    v_pk_mul_f32 v[202:203], v[202:203], v[28:29] op_sel_hi:[1,0]
    v_pk_mul_f32 v[204:205], v[204:205], v[32:33] op_sel_hi:[1,0]
    v_pk_mul_f32 v[206:207], v[206:207], v[32:33] op_sel_hi:[1,0]
    v_pk_mul_f32 v[208:209], v[208:209], v[36:37] op_sel_hi:[1,0]
    v_pk_mul_f32 v[210:211], v[210:211], v[36:37] op_sel_hi:[1,0]
    v_pk_mul_f32 v[212:213], v[212:213], v[40:41] op_sel_hi:[1,0]
    v_pk_mul_f32 v[214:215], v[214:215], v[40:41] op_sel_hi:[1,0]
    v_pk_mul_f32 v[216:217], v[216:217], v[44:45] op_sel_hi:[1,0]
    v_pk_mul_f32 v[218:219], v[218:219], v[44:45] op_sel_hi:[1,0]
    v_pk_mul_f32 v[220:221], v[220:221], v[48:49] op_sel_hi:[1,0]
    v_pk_mul_f32 v[222:223], v[222:223], v[48:49] op_sel_hi:[1,0]
    v_pk_mul_f32 v[224:225], v[224:225], v[52:53] op_sel_hi:[1,0]
    v_pk_mul_f32 v[226:227], v[226:227], v[52:53] op_sel_hi:[1,0]
    v_pk_mul_f32 v[228:229], v[228:229], v[28:29] op_sel_hi:[1,0]
    v_pk_mul_f32 v[230:231], v[230:231], v[28:29] op_sel_hi:[1,0]
    v_pk_mul_f32 v[232:233], v[232:233], v[32:33] op_sel_hi:[1,0]
    v_pk_mul_f32 v[234:235], v[234:235], v[32:33] op_sel_hi:[1,0]
    v_pk_mul_f32 v[236:237], v[236:237], v[36:37] op_sel_hi:[1,0]
    v_pk_mul_f32 v[238:239], v[238:239], v[36:37] op_sel_hi:[1,0]
    v_pk_mul_f32 v[240:241], v[240:241], v[40:41] op_sel_hi:[1,0]
    v_pk_mul_f32 v[242:243], v[242:243], v[40:41] op_sel_hi:[1,0]
    v_pk_mul_f32 v[244:245], v[244:245], v[44:45] op_sel_hi:[1,0]
    v_pk_mul_f32 v[246:247], v[246:247], v[44:45] op_sel_hi:[1,0]
    v_pk_mul_f32 v[248:249], v[248:249], v[48:49] op_sel_hi:[1,0]
    v_pk_mul_f32 v[250:251], v[250:251], v[48:49] op_sel_hi:[1,0]
    v_pk_mul_f32 v[252:253], v[252:253], v[52:53] op_sel_hi:[1,0]
    v_pk_mul_f32 v[254:255], v[254:255], v[52:53] op_sel_hi:[1,0]
    v_cvt_pk_bf16_f32 v116, v200, v201
    v_cvt_pk_bf16_f32 v117, v202, v203
    v_cvt_pk_bf16_f32 v118, v228, v229
    v_cvt_pk_bf16_f32 v119, v230, v231
    v_cvt_pk_bf16_f32 v120, v204, v205
    v_cvt_pk_bf16_f32 v121, v206, v207
    v_cvt_pk_bf16_f32 v122, v232, v233
    v_cvt_pk_bf16_f32 v123, v234, v235
    v_cvt_pk_bf16_f32 v124, v208, v209
    v_cvt_pk_bf16_f32 v125, v210, v211
    v_cvt_pk_bf16_f32 v126, v236, v237
    v_cvt_pk_bf16_f32 v127, v238, v239
    v_cvt_pk_bf16_f32 v128, v212, v213
    v_cvt_pk_bf16_f32 v129, v214, v215
    v_cvt_pk_bf16_f32 v130, v240, v241
    v_cvt_pk_bf16_f32 v131, v242, v243
    v_cvt_pk_bf16_f32 v132, v216, v217
    v_cvt_pk_bf16_f32 v133, v218, v219
    v_cvt_pk_bf16_f32 v134, v244, v245
    v_cvt_pk_bf16_f32 v135, v246, v247
    v_cvt_pk_bf16_f32 v136, v220, v221
    v_cvt_pk_bf16_f32 v137, v222, v223
    v_cvt_pk_bf16_f32 v138, v248, v249
    v_cvt_pk_bf16_f32 v139, v250, v251
    v_cvt_pk_bf16_f32 v140, v224, v225
    v_cvt_pk_bf16_f32 v141, v226, v227
    v_cvt_pk_bf16_f32 v142, v252, v253
    v_cvt_pk_bf16_f32 v143, v254, v255
    s_mov_b32 s28, s31
    buffer_store_dwordx4 v[116:119], v10, s[12:15], s28 offen offset:3072 sc0 sc1
    s_add_u32 s28, s28, 4096
    buffer_store_dwordx4 v[120:123], v10, s[12:15], s28 offen offset:3072 sc0 sc1
    s_add_u32 s28, s28, 4096
    buffer_store_dwordx4 v[124:127], v10, s[12:15], s28 offen offset:3072 sc0 sc1
    s_add_u32 s28, s28, 4096
    buffer_store_dwordx4 v[128:131], v10, s[12:15], s28 offen offset:3072 sc0 sc1
    s_add_u32 s28, s28, 4096
    buffer_store_dwordx4 v[132:135], v10, s[12:15], s28 offen offset:3072 sc0 sc1
    s_add_u32 s28, s28, 4096
    buffer_store_dwordx4 v[136:139], v10, s[12:15], s28 offen offset:3072 sc0 sc1
    s_add_u32 s28, s28, 4096
    buffer_store_dwordx4 v[140:143], v10, s[12:15], s28 offen offset:3072 sc0 sc1
    s_nop 1
L_at_nowo2:
    s_mov_b32 s68, 3
    s_cmp_ge_u32 s21, 2
    s_cbranch_scc1 L_at_fin
    s_cmp_eq_u32 s69, 0
    s_cbranch_scc1 L_at_round
    s_waitcnt vmcnt(28)
    s_branch L_at_pre
L_at_fin:
    s_waitcnt lgkmcnt(0)
    s_barrier
    s_cmp_le_u32 s21, s27
    s_cbranch_scc1 L_at_nofb_6866
    s_sub_u32 s28, s21, 1
    s_cmp_eq_u32 s28, s23
    s_cbranch_scc1 L_at_nofb_6866
    s_lshl_b32 s29, s28, 2
    s_add_u32 s29, s29, 76000
    v_mov_b32 v4, s29
    ds_read_b32 v4, v4
    s_waitcnt lgkmcnt(0)
    v_readfirstlane_b32 s29, v4
    s_nop 3
    s_cmp_lg_u32 s29, 0
    s_cbranch_scc1 L_at_fallback
L_at_nofb_6866:
    s_branch L_at_end
L_bw1_458:
    s_sub_u32 s68, s68, 1
    s_waitcnt vmcnt(44) lgkmcnt(0)
    s_branch L_bw2_458
L_bw1_574:
    s_sub_u32 s68, s68, 1
    s_waitcnt vmcnt(36) lgkmcnt(0)
    s_branch L_bw2_574
L_bw1_687:
    s_sub_u32 s68, s68, 1
    s_waitcnt vmcnt(44) lgkmcnt(0)
    s_branch L_bw2_687
L_bw1_3045:
    s_sub_u32 s68, s68, 1
    s_waitcnt vmcnt(44) lgkmcnt(0)
    s_branch L_bw2_3045
L_bw1_3427:
    s_sub_u32 s68, s68, 1
    s_waitcnt vmcnt(44) lgkmcnt(0)
    s_branch L_bw2_3427
L_bw1_3736:
    s_sub_u32 s68, s68, 1
    s_waitcnt vmcnt(44) lgkmcnt(0)
    s_branch L_bw2_3736
L_at_wt0:
    s_and_b32 s28, s2, 127
    s_mul_i32 s28, s28, 40960
    s_mul_i32 s29, s20, 10240
    s_add_u32 s28, s28, s29
    v_lshlrev_b32 v4, 7, v1
    v_and_b32 v5, 15, v1
    v_lshlrev_b32 v5, 7, v5
    buffer_load_dword a250, v4, s[84:87], s28 offen
    s_add_u32 s28, s28, 8192
    buffer_load_dword a251, v5, s[84:87], s28 offen
    s_lshl_b32 s28, s20, 13
    v_lshlrev_b32 v4, 7, v1
    v_add_u32 v4, s28, v4
    v_add_u32 v4, op_kernel - L_pc0, v4
    v_min_u32 v4, L_code_end - L_pc0 - 4, v4
    v_mov_b32 v5, s73
    v_add_co_u32 v4, vcc, s72, v4
    v_addc_co_u32 v5, vcc, 0, v5, vcc
    global_load_dword a250, v[4:5], off
    s_branch L_at_wt0r
L_at_fallback:
    s_sub_u32 s27, s21, 1
    s_mov_b32 s23, s27
    s_mov_b32 s25, 1
    s_mov_b32 s69, 0
    s_mov_b32 s70, 0
    s_mov_b32 s68, 0
    v_mov_b32 v12, 0xff800000
    v_mov_b32 v14, 0xff800000
    v_mov_b32 v16, 0xff800000
    v_mov_b32 v18, 0xff800000
    v_mov_b32 v20, 0xff800000
    v_mov_b32 v22, 0xff800000
    v_mov_b32 v24, 0xff800000
    s_waitcnt vmcnt(0) lgkmcnt(0)
    s_barrier
    s_branch L_at_start
L_at_maxpass:
    s_mov_b32 s25, 0
    s_waitcnt lgkmcnt(0)
    v_and_b32 v2, 15, v1
    v_lshlrev_b32 v2, 8, v2
    v_bfe_u32 v3, v1, 4, 1
    v_lshl_add_u32 v2, v3, 5, v2
    v_bfe_u32 v3, v1, 5, 1
    v_lshl_add_u32 v4, v3, 4, v2
    v_add_u32 v5, 4096, v4
    s_lshl_b32 s29, s21, 19
    s_mov_b32 s22, 0
L_at_mp:
    buffer_load_dwordx4 v[112:115], v4, s[8:11], s29 offen offset:0
    buffer_load_dwordx4 v[116:119], v4, s[8:11], s29 offen offset:64
    buffer_load_dwordx4 v[120:123], v4, s[8:11], s29 offen offset:128
    buffer_load_dwordx4 v[124:127], v4, s[8:11], s29 offen offset:192
    buffer_load_dwordx4 v[128:131], v5, s[8:11], s29 offen offset:0
    buffer_load_dwordx4 v[132:135], v5, s[8:11], s29 offen offset:64
    buffer_load_dwordx4 v[136:139], v5, s[8:11], s29 offen offset:128
    buffer_load_dwordx4 v[140:143], v5, s[8:11], s29 offen offset:192
    s_waitcnt vmcnt(0)
    v_mfma_f32_16x16x32_bf16 v[88:91], v[112:115], a[0:3], 0
    v_mfma_f32_16x16x32_bf16 v[88:91], v[116:119], a[4:7], v[88:91]
    v_mfma_f32_16x16x32_bf16 v[88:91], v[120:123], a[8:11], v[88:91]
    v_mfma_f32_16x16x32_bf16 v[88:91], v[124:127], a[12:15], v[88:91]
    v_mfma_f32_16x16x32_bf16 v[92:95], v[128:131], a[0:3], 0
    v_mfma_f32_16x16x32_bf16 v[92:95], v[132:135], a[4:7], v[92:95]
    v_mfma_f32_16x16x32_bf16 v[92:95], v[136:139], a[8:11], v[92:95]
    v_mfma_f32_16x16x32_bf16 v[92:95], v[140:143], a[12:15], v[92:95]
    s_nop 9
    v_max3_f32 v12, v88, v89, v12
    v_max3_f32 v12, v90, v91, v12
    v_max3_f32 v12, v92, v93, v12
    v_max3_f32 v12, v94, v95, v12
    s_nop 3
    v_mfma_f32_16x16x32_bf16 v[88:91], v[112:115], a[16:19], 0
    v_mfma_f32_16x16x32_bf16 v[88:91], v[116:119], a[20:23], v[88:91]
    v_mfma_f32_16x16x32_bf16 v[88:91], v[120:123], a[24:27], v[88:91]
    v_mfma_f32_16x16x32_bf16 v[88:91], v[124:127], a[28:31], v[88:91]
    v_mfma_f32_16x16x32_bf16 v[92:95], v[128:131], a[16:19], 0
    v_mfma_f32_16x16x32_bf16 v[92:95], v[132:135], a[20:23], v[92:95]
    v_mfma_f32_16x16x32_bf16 v[92:95], v[136:139], a[24:27], v[92:95]
    v_mfma_f32_16x16x32_bf16 v[92:95], v[140:143], a[28:31], v[92:95]
    s_nop 9
    v_max3_f32 v14, v88, v89, v14
    v_max3_f32 v14, v90, v91, v14
    v_max3_f32 v14, v92, v93, v14
    v_max3_f32 v14, v94, v95, v14
    s_nop 3
    v_mfma_f32_16x16x32_bf16 v[88:91], v[112:115], a[32:35], 0
    v_mfma_f32_16x16x32_bf16 v[88:91], v[116:119], a[36:39], v[88:91]
    v_mfma_f32_16x16x32_bf16 v[88:91], v[120:123], a[40:43], v[88:91]
    v_mfma_f32_16x16x32_bf16 v[88:91], v[124:127], a[44:47], v[88:91]
    v_mfma_f32_16x16x32_bf16 v[92:95], v[128:131], a[32:35], 0
    v_mfma_f32_16x16x32_bf16 v[92:95], v[132:135], a[36:39], v[92:95]
    v_mfma_f32_16x16x32_bf16 v[92:95], v[136:139], a[40:43], v[92:95]
    v_mfma_f32_16x16x32_bf16 v[92:95], v[140:143], a[44:47], v[92:95]
    s_nop 9
    v_max3_f32 v16, v88, v89, v16
    v_max3_f32 v16, v90, v91, v16
    v_max3_f32 v16, v92, v93, v16
    v_max3_f32 v16, v94, v95, v16
    s_nop 3
    v_mfma_f32_16x16x32_bf16 v[88:91], v[112:115], a[48:51], 0
    v_mfma_f32_16x16x32_bf16 v[88:91], v[116:119], a[52:55], v[88:91]
    v_mfma_f32_16x16x32_bf16 v[88:91], v[120:123], a[56:59], v[88:91]
    v_mfma_f32_16x16x32_bf16 v[88:91], v[124:127], a[60:63], v[88:91]
    v_mfma_f32_16x16x32_bf16 v[92:95], v[128:131], a[48:51], 0
    v_mfma_f32_16x16x32_bf16 v[92:95], v[132:135], a[52:55], v[92:95]
    v_mfma_f32_16x16x32_bf16 v[92:95], v[136:139], a[56:59], v[92:95]
    v_mfma_f32_16x16x32_bf16 v[92:95], v[140:143], a[60:63], v[92:95]
    s_nop 9
    v_max3_f32 v18, v88, v89, v18
    v_max3_f32 v18, v90, v91, v18
    v_max3_f32 v18, v92, v93, v18
    v_max3_f32 v18, v94, v95, v18
    s_nop 3
    v_mfma_f32_16x16x32_bf16 v[88:91], v[112:115], a[64:67], 0
    v_mfma_f32_16x16x32_bf16 v[88:91], v[116:119], a[68:71], v[88:91]
    v_mfma_f32_16x16x32_bf16 v[88:91], v[120:123], a[72:75], v[88:91]
    v_mfma_f32_16x16x32_bf16 v[88:91], v[124:127], a[76:79], v[88:91]
    v_mfma_f32_16x16x32_bf16 v[92:95], v[128:131], a[64:67], 0
    v_mfma_f32_16x16x32_bf16 v[92:95], v[132:135], a[68:71], v[92:95]
    v_mfma_f32_16x16x32_bf16 v[92:95], v[136:139], a[72:75], v[92:95]
    v_mfma_f32_16x16x32_bf16 v[92:95], v[140:143], a[76:79], v[92:95]
    s_nop 9
    v_max3_f32 v20, v88, v89, v20
    v_max3_f32 v20, v90, v91, v20
    v_max3_f32 v20, v92, v93, v20
    v_max3_f32 v20, v94, v95, v20
    s_nop 3
    v_mfma_f32_16x16x32_bf16 v[88:91], v[112:115], a[80:83], 0
    v_mfma_f32_16x16x32_bf16 v[88:91], v[116:119], a[84:87], v[88:91]
    v_mfma_f32_16x16x32_bf16 v[88:91], v[120:123], a[88:91], v[88:91]
    v_mfma_f32_16x16x32_bf16 v[88:91], v[124:127], a[92:95], v[88:91]
    v_mfma_f32_16x16x32_bf16 v[92:95], v[128:131], a[80:83], 0
    v_mfma_f32_16x16x32_bf16 v[92:95], v[132:135], a[84:87], v[92:95]
    v_mfma_f32_16x16x32_bf16 v[92:95], v[136:139], a[88:91], v[92:95]
    v_mfma_f32_16x16x32_bf16 v[92:95], v[140:143], a[92:95], v[92:95]
    s_nop 9
    v_max3_f32 v22, v88, v89, v22
    v_max3_f32 v22, v90, v91, v22
    v_max3_f32 v22, v92, v93, v22
    v_max3_f32 v22, v94, v95, v22
    s_nop 3
    v_mfma_f32_16x16x32_bf16 v[88:91], v[112:115], a[96:99], 0
    v_mfma_f32_16x16x32_bf16 v[88:91], v[116:119], a[100:103], v[88:91]
    v_mfma_f32_16x16x32_bf16 v[88:91], v[120:123], a[104:107], v[88:91]
    v_mfma_f32_16x16x32_bf16 v[88:91], v[124:127], a[108:111], v[88:91]
    v_mfma_f32_16x16x32_bf16 v[92:95], v[128:131], a[96:99], 0
    v_mfma_f32_16x16x32_bf16 v[92:95], v[132:135], a[100:103], v[92:95]
    v_mfma_f32_16x16x32_bf16 v[92:95], v[136:139], a[104:107], v[92:95]
    v_mfma_f32_16x16x32_bf16 v[92:95], v[140:143], a[108:111], v[92:95]
    s_nop 9
    v_max3_f32 v24, v88, v89, v24
    v_max3_f32 v24, v90, v91, v24
    v_max3_f32 v24, v92, v93, v24
    v_max3_f32 v24, v94, v95, v24
    s_nop 3
    s_add_u32 s29, s29, 8192
    s_add_u32 s22, s22, 1
    s_cmp_lt_u32 s22, 32
    s_cbranch_scc1 L_at_mp
    s_branch L_at_pre
L_at_end:
    s_endpgm
.globl op_kernel
.p2align 8
.type op_kernel,@function
op_kernel:
    s_cmp_ge_u32 s2, 256
    s_cbranch_scc1 L_op_end
    s_and_b32 s3, s2, 7
    s_lshl_b32 s3, s3, 5
    s_lshr_b32 s30, s2, 3
    s_add_u32 s3, s3, s30
    s_cmp_ge_u32 s3, 250
    s_cbranch_scc1 L_op_end
    s_load_dwordx2 s[36:37], s[0:1], 32
    s_load_dwordx2 s[38:39], s[0:1], 72
    s_load_dwordx2 s[40:41], s[0:1], 80
    s_load_dwordx2 s[44:45], s[0:1], 96
    v_and_b32 v1, 63, v0
    v_lshrrev_b32 v2, 6, v0
    s_nop 0
    v_readfirstlane_b32 s20, v2
    s_mul_i32 s28, s3, 13108
    s_lshr_b32 s28, s28, 16
    s_mul_i32 s22, s28, 5
    s_sub_u32 s29, s3, s22
    s_mov_b32 s61, s28
    s_cmp_ge_u32 s28, 25
    s_cselect_b32 s30, 1, 0
    s_cselect_b32 s22, 25, 0
    s_sub_u32 s28, s28, s22
    s_mul_i32 s31, s28, 9
    s_lshl_b32 s24, s20, 10
    s_add_u32 s24, s24, 58720256
    s_mul_i32 s23, s30, 29360128
    s_add_u32 s24, s24, s23
    s_cmp_lt_u32 s20, 2
    s_cselect_b32 s58, 5, 0
    s_add_u32 s22, s31, 0
    s_add_u32 s22, s22, s58
    s_mul_i32 s23, s22, 4682
    s_lshr_b32 s23, s23, 16
    s_mul_i32 s62, s23, 1777664
    s_lshl_b32 s48, s22, 12
    s_add_u32 s48, s48, s62
    s_add_u32 s48, s48, s24
    s_add_u32 s22, s31, 1
    s_add_u32 s22, s22, s58
    s_mul_i32 s23, s22, 4682
    s_lshr_b32 s23, s23, 16
    s_mul_i32 s62, s23, 1777664
    s_lshl_b32 s49, s22, 12
    s_add_u32 s49, s49, s62
    s_add_u32 s49, s49, s24
    s_add_u32 s22, s31, 2
    s_add_u32 s22, s22, s58
    s_mul_i32 s23, s22, 4682
    s_lshr_b32 s23, s23, 16
    s_mul_i32 s62, s23, 1777664
    s_lshl_b32 s50, s22, 12
    s_add_u32 s50, s50, s62
    s_add_u32 s50, s50, s24
    s_add_u32 s22, s31, 3
    s_add_u32 s22, s22, s58
    s_mul_i32 s23, s22, 4682
    s_lshr_b32 s23, s23, 16
    s_mul_i32 s62, s23, 1777664
    s_lshl_b32 s51, s22, 12
    s_add_u32 s51, s51, s62
    s_add_u32 s51, s51, s24
    s_cmp_ge_u32 s22, 224
    s_cselect_b32 s62, 0x40000000, 0
    s_add_u32 s51, s51, s62
    s_add_u32 s22, s31, 4
    s_mul_i32 s23, s22, 4682
    s_lshr_b32 s23, s23, 16
    s_mul_i32 s62, s23, 1777664
    s_lshl_b32 s52, s22, 12
    s_add_u32 s52, s52, s62
    s_add_u32 s52, s52, s24
    s_add_u32 s22, s31, 5
    s_sub_u32 s22, s22, s58
    s_mul_i32 s23, s22, 4682
    s_lshr_b32 s23, s23, 16
    s_mul_i32 s62, s23, 1777664
    s_lshl_b32 s53, s22, 12
    s_add_u32 s53, s53, s62
    s_add_u32 s53, s53, s24
    s_add_u32 s22, s31, 6
    s_sub_u32 s22, s22, s58
    s_mul_i32 s23, s22, 4682
    s_lshr_b32 s23, s23, 16
    s_mul_i32 s62, s23, 1777664
    s_lshl_b32 s54, s22, 12
    s_add_u32 s54, s54, s62
    s_add_u32 s54, s54, s24
    s_add_u32 s22, s31, 7
    s_sub_u32 s22, s22, s58
    s_mul_i32 s23, s22, 4682
    s_lshr_b32 s23, s23, 16
    s_mul_i32 s62, s23, 1777664
    s_lshl_b32 s55, s22, 12
    s_add_u32 s55, s55, s62
    s_add_u32 s55, s55, s24
    s_add_u32 s22, s31, 8
    s_sub_u32 s22, s22, s58
    s_mul_i32 s23, s22, 4682
    s_lshr_b32 s23, s23, 16
    s_mul_i32 s62, s23, 1777664
    s_lshl_b32 s56, s22, 12
    s_add_u32 s56, s56, s62
    s_add_u32 s56, s56, s24
    s_cmp_ge_u32 s22, 224
    s_cselect_b32 s62, 0x40000000, 0
    s_add_u32 s56, s56, s62
    v_lshlrev_b32 v6, 4, v1
    v_lshrrev_b32 v2, 4, v1
    v_and_b32 v3, 15, v1
    v_lshlrev_b32 v4, 1, v2
    v_xor_b32 v3, v3, v4
    v_lshlrev_b32 v3, 4, v3
    v_mul_u32_u24 v4, 1280, v2
    v_add_u32 v5, v4, v3
    v_xor_b32 v3, 128, v3
    v_add_u32 v4, v4, v3
    v_add_u32 v10, 0, v5
    v_add_u32 v11, 4096, v4
    v_add_u32 v12, 8192, v5
    v_add_u32 v13, 12288, v4
    v_add_u32 v14, 20480, v5
    v_add_u32 v15, 24576, v4
    v_add_u32 v16, 28672, v5
    v_add_u32 v17, 32768, v4
    s_mul_i32 s27, s20, 40960
    s_waitcnt lgkmcnt(0)
    s_cmp_lg_u32 s30, 0
    s_cselect_b32 s8, s38, s36
    s_cselect_b32 s9, s39, s37
    s_mov_b32 s10, 5242880
    s_mov_b32 s11, 0x20000
    s_mov_b32 s4, s44
    s_mov_b32 s5, s45
    s_mov_b32 s6, 127926272
    s_mov_b32 s7, 0x20000
    s_mov_b32 s12, s40
    s_mov_b32 s13, s41
    s_mov_b32 s14, 9175040
    s_mov_b32 s15, 0x20000
    s_mul_i32 s22, s20, 40960
    s_lshl_b32 s23, s29, 8
    s_add_u32 s26, s22, s23
    s_mov_b32 s25, 0
    v_add_u32 v7, s25, v6
    s_add_u32 m0, s27, 0
    s_nop 0
    buffer_load_dwordx4 v10, s[8:11], s26 offen offset:0 lds
    buffer_load_dwordx4 v11, s[8:11], s26 offen offset:1024 lds
    buffer_load_dwordx4 v12, s[8:11], s26 offen offset:2048 lds
    buffer_load_dwordx4 v13, s[8:11], s26 offen offset:3072 lds
    s_add_u32 m0, s27, 4096
    s_nop 0
    buffer_load_dwordx4 v14, s[8:11], s26 offen offset:0 lds
    buffer_load_dwordx4 v15, s[8:11], s26 offen offset:1024 lds
    buffer_load_dwordx4 v16, s[8:11], s26 offen offset:2048 lds
    buffer_load_dwordx4 v17, s[8:11], s26 offen offset:3072 lds
    s_add_u32 s26, s26, 163840
    buffer_load_dwordx4 v[92:95], v7, s[4:7], s48 offen
    buffer_load_dwordx4 v[96:99], v7, s[4:7], s49 offen
    buffer_load_dwordx4 v[100:103], v7, s[4:7], s50 offen
    buffer_load_dwordx4 v[104:107], v7, s[4:7], s51 offen
    buffer_load_dwordx4 v[108:111], v7, s[4:7], s52 offen
    buffer_load_dwordx4 v[112:115], v7, s[4:7], s53 offen
    buffer_load_dwordx4 v[116:119], v7, s[4:7], s54 offen
    buffer_load_dwordx4 v[120:123], v7, s[4:7], s55 offen
    buffer_load_dwordx4 v[124:127], v7, s[4:7], s56 offen
    v_add_u32 v7, 57344, v7
    s_add_u32 m0, s27, 8192
    s_nop 0
    buffer_load_dwordx4 v10, s[8:11], s26 offen offset:0 lds
    buffer_load_dwordx4 v11, s[8:11], s26 offen offset:1024 lds
    buffer_load_dwordx4 v12, s[8:11], s26 offen offset:2048 lds
    buffer_load_dwordx4 v13, s[8:11], s26 offen offset:3072 lds
    s_add_u32 m0, s27, 12288
    s_nop 0
    buffer_load_dwordx4 v14, s[8:11], s26 offen offset:0 lds
    buffer_load_dwordx4 v15, s[8:11], s26 offen offset:1024 lds
    buffer_load_dwordx4 v16, s[8:11], s26 offen offset:2048 lds
    buffer_load_dwordx4 v17, s[8:11], s26 offen offset:3072 lds
    s_add_u32 s26, s26, 163840
    v_lshrrev_b32 v2, 4, v1
    v_bfe_u32 v3, v1, 2, 2
    v_lshl_add_u32 v4, v2, 2, v3
    v_lshlrev_b32 v4, 8, v4
    v_and_b32 v2, 1, v2
    v_lshl_add_u32 v3, v2, 2, v3
    v_lshl_add_u32 v4, v3, 5, v4
    v_and_b32 v3, 3, v1
    v_lshl_add_u32 v4, v3, 3, v4
    v_add_u32 v4, s27, v4
    s_and_b32 s62, s20, 1
    s_lshl_b32 s62, s62, 1
    s_lshr_b32 s59, s20, 1
    s_add_u32 s59, s59, s62
    s_lshl_b32 s59, s59, 6
    s_xor_b32 s62, s59, 192
    v_xor_b32 v18, s62, v4
    s_xor_b32 s62, s59, 224
    v_xor_b32 v19, s62, v4
    s_xor_b32 s62, s59, 128
    v_xor_b32 v20, s62, v4
    s_xor_b32 s62, s59, 160
    v_xor_b32 v21, s62, v4
    s_xor_b32 s62, s59, 64
    v_xor_b32 v22, s62, v4
    s_xor_b32 s62, s59, 96
    v_xor_b32 v23, s62, v4
    s_xor_b32 s62, s59, 0
    v_xor_b32 v24, s62, v4
    s_xor_b32 s62, s59, 32
    v_xor_b32 v25, s62, v4
    v_add_u32 v8, s27, v6
    v_bfe_u32 v4, v1, 4, 1
    v_lshlrev_b32 v4, 5, v4
    v_and_b32 v2, 15, v1
    v_mul_u32_u24 v2, 2560, v2
    v_add_u32 v2, v2, v4
    v_bfe_u32 v4, v1, 5, 1
    v_lshl_add_u32 v9, v4, 4, v2
    s_xor_b32 s22, s20, 3
    s_mul_i32 s22, s22, 40960
    v_add_u32 v2, s22, v6
    s_xor_b32 s22, s20, 1
    s_mul_i32 s22, s22, 40960
    v_add_u32 v3, s22, v6
    s_xor_b32 s22, s20, 2
    s_mul_i32 s22, s22, 40960
    v_add_u32 v4, s22, v6
    v_and_b32 v26, 7, v1
    v_mul_u32_u24 v26, 2560, v26
    v_bfe_u32 v27, v1, 3, 1
    s_lshr_b32 s22, s20, 1
    s_xor_b32 s22, s22, 1
    v_xor_b32 v27, s22, v27
    v_lshl_add_u32 v26, v27, 6, v26
    v_bfe_u32 v27, v1, 4, 1
    v_lshl_add_u32 v26, v27, 5, v26
    v_bfe_u32 v27, v1, 5, 1
    v_lshl_add_u32 v26, v27, 4, v26
    v_xor_b32 v27, 64, v26
    v_add_u32 v27, 20480, v27
    s_mov_b32 s64, 0x00ff00ff
    s_mov_b32 s65, 0x00ff00ff
    s_mov_b32 s66, 0xff00ff00
    s_mov_b32 s67, 0xff00ff00
    s_mul_i32 s22, s28, 368640
    s_mul_i32 s23, s30, 1280
    s_add_u32 s22, s22, s23
    s_lshl_b32 s23, s29, 8
    s_add_u32 s24, s22, s23
    s_waitcnt vmcnt(17)
    ds_read_b64_tr_b16 v[60:61], v18 offset:0
    ds_read_b64_tr_b16 v[62:63], v18 offset:4096
    ds_read_b64_tr_b16 v[64:65], v19 offset:0
    ds_read_b64_tr_b16 v[66:67], v19 offset:4096
    ds_read_b64_tr_b16 v[68:69], v20 offset:0
    ds_read_b64_tr_b16 v[70:71], v20 offset:4096
    ds_read_b64_tr_b16 v[72:73], v21 offset:0
    ds_read_b64_tr_b16 v[74:75], v21 offset:4096
    ds_read_b64_tr_b16 v[76:77], v22 offset:0
    ds_read_b64_tr_b16 v[78:79], v22 offset:4096
    ds_read_b64_tr_b16 v[80:81], v23 offset:0
    ds_read_b64_tr_b16 v[82:83], v23 offset:4096
    ds_read_b64_tr_b16 v[84:85], v24 offset:0
    ds_read_b64_tr_b16 v[86:87], v24 offset:4096
    ds_read_b64_tr_b16 v[88:89], v25 offset:0
    ds_read_b64_tr_b16 v[90:91], v25 offset:4096
    s_waitcnt vmcnt(0) lgkmcnt(12)
    v_mfma_f32_16x16x32_bf16 a[0:3], v[60:63], v[92:95], 0
    buffer_load_dwordx4 v[128:131], v7, s[4:7], s48 offen
    v_mfma_f32_16x16x32_bf16 a[4:7], v[60:63], v[96:99], 0
    buffer_load_dwordx4 v[132:135], v7, s[4:7], s49 offen
    v_mfma_f32_16x16x32_bf16 a[8:11], v[60:63], v[100:103], 0
    buffer_load_dwordx4 v[136:139], v7, s[4:7], s50 offen
    v_mfma_f32_16x16x32_bf16 a[12:15], v[60:63], v[104:107], 0
    buffer_load_dwordx4 v[140:143], v7, s[4:7], s51 offen
    v_mfma_f32_16x16x32_bf16 a[16:19], v[60:63], v[108:111], 0
    buffer_load_dwordx4 v[144:147], v7, s[4:7], s52 offen
    v_mfma_f32_16x16x32_bf16 a[20:23], v[60:63], v[112:115], 0
    buffer_load_dwordx4 v[148:151], v7, s[4:7], s53 offen
    v_mfma_f32_16x16x32_bf16 a[24:27], v[60:63], v[116:119], 0
    buffer_load_dwordx4 v[152:155], v7, s[4:7], s54 offen
    v_mfma_f32_16x16x32_bf16 a[28:31], v[60:63], v[120:123], 0
    buffer_load_dwordx4 v[156:159], v7, s[4:7], s55 offen
    v_mfma_f32_16x16x32_bf16 a[32:35], v[60:63], v[124:127], 0
    ds_read_b64_tr_b16 v[60:61], v18 offset:8192
    ds_read_b64_tr_b16 v[62:63], v18 offset:12288
    v_mfma_f32_16x16x32_bf16 a[36:39], v[64:67], v[92:95], 0
    buffer_load_dwordx4 v[160:163], v7, s[4:7], s56 offen
    v_mfma_f32_16x16x32_bf16 a[40:43], v[64:67], v[96:99], 0
    v_add_u32 v7, 57344, v7
    v_mfma_f32_16x16x32_bf16 a[44:47], v[64:67], v[100:103], 0
    s_add_u32 m0, s27, 16384
    v_mfma_f32_16x16x32_bf16 a[48:51], v[64:67], v[104:107], 0
    s_nop 0
    v_mfma_f32_16x16x32_bf16 a[52:55], v[64:67], v[108:111], 0
    buffer_load_dwordx4 v10, s[8:11], s26 offen offset:0 lds
    v_mfma_f32_16x16x32_bf16 a[56:59], v[64:67], v[112:115], 0
    buffer_load_dwordx4 v11, s[8:11], s26 offen offset:1024 lds
    v_mfma_f32_16x16x32_bf16 a[60:63], v[64:67], v[116:119], 0
    buffer_load_dwordx4 v12, s[8:11], s26 offen offset:2048 lds
    v_mfma_f32_16x16x32_bf16 a[64:67], v[64:67], v[120:123], 0
    buffer_load_dwordx4 v13, s[8:11], s26 offen offset:3072 lds
    v_mfma_f32_16x16x32_bf16 a[68:71], v[64:67], v[124:127], 0
    ds_read_b64_tr_b16 v[64:65], v19 offset:8192
    ds_read_b64_tr_b16 v[66:67], v19 offset:12288
    s_waitcnt lgkmcnt(4)
    v_mfma_f32_16x16x32_bf16 a[72:75], v[68:71], v[92:95], 0
    s_add_u32 m0, s27, 20480
    v_mfma_f32_16x16x32_bf16 a[76:79], v[68:71], v[96:99], 0
    s_nop 0
    v_mfma_f32_16x16x32_bf16 a[80:83], v[68:71], v[100:103], 0
    buffer_load_dwordx4 v14, s[8:11], s26 offen offset:0 lds
    v_mfma_f32_16x16x32_bf16 a[84:87], v[68:71], v[104:107], 0
    buffer_load_dwordx4 v15, s[8:11], s26 offen offset:1024 lds
    v_mfma_f32_16x16x32_bf16 a[88:91], v[68:71], v[108:111], 0
    buffer_load_dwordx4 v16, s[8:11], s26 offen offset:2048 lds
    v_mfma_f32_16x16x32_bf16 a[92:95], v[68:71], v[112:115], 0
    buffer_load_dwordx4 v17, s[8:11], s26 offen offset:3072 lds
    v_mfma_f32_16x16x32_bf16 a[96:99], v[68:71], v[116:119], 0
    s_add_u32 s26, s26, 163840
    v_mfma_f32_16x16x32_bf16 a[100:103], v[68:71], v[120:123], 0
    s_add_u32 m0, s27, 24576
    v_mfma_f32_16x16x32_bf16 a[104:107], v[68:71], v[124:127], 0
    ds_read_b64_tr_b16 v[68:69], v20 offset:8192
    ds_read_b64_tr_b16 v[70:71], v20 offset:12288
    v_mfma_f32_16x16x32_bf16 a[108:111], v[72:75], v[92:95], 0
    s_nop 0
    v_mfma_f32_16x16x32_bf16 a[112:115], v[72:75], v[96:99], 0
    buffer_load_dwordx4 v10, s[8:11], s26 offen offset:0 lds
    v_mfma_f32_16x16x32_bf16 a[116:119], v[72:75], v[100:103], 0
    buffer_load_dwordx4 v11, s[8:11], s26 offen offset:1024 lds
    v_mfma_f32_16x16x32_bf16 a[120:123], v[72:75], v[104:107], 0
    buffer_load_dwordx4 v12, s[8:11], s26 offen offset:2048 lds
    v_mfma_f32_16x16x32_bf16 a[124:127], v[72:75], v[108:111], 0
    buffer_load_dwordx4 v13, s[8:11], s26 offen offset:3072 lds
    v_mfma_f32_16x16x32_bf16 a[128:131], v[72:75], v[112:115], 0
    s_add_u32 m0, s27, 28672
    v_mfma_f32_16x16x32_bf16 a[132:135], v[72:75], v[116:119], 0
    s_nop 0
    v_mfma_f32_16x16x32_bf16 a[136:139], v[72:75], v[120:123], 0
    buffer_load_dwordx4 v14, s[8:11], s26 offen offset:0 lds
    v_mfma_f32_16x16x32_bf16 a[140:143], v[72:75], v[124:127], 0
    ds_read_b64_tr_b16 v[72:73], v21 offset:8192
    ds_read_b64_tr_b16 v[74:75], v21 offset:12288
    v_mfma_f32_16x16x32_bf16 a[144:147], v[76:79], v[92:95], 0
    buffer_load_dwordx4 v15, s[8:11], s26 offen offset:1024 lds
    v_mfma_f32_16x16x32_bf16 a[148:151], v[76:79], v[96:99], 0
    buffer_load_dwordx4 v16, s[8:11], s26 offen offset:2048 lds
    v_mfma_f32_16x16x32_bf16 a[152:155], v[76:79], v[100:103], 0
    buffer_load_dwordx4 v17, s[8:11], s26 offen offset:3072 lds
    v_mfma_f32_16x16x32_bf16 a[156:159], v[76:79], v[104:107], 0
    s_add_u32 s26, s26, 163840
    v_mfma_f32_16x16x32_bf16 a[160:163], v[76:79], v[108:111], 0
    buffer_load_dwordx4 v[164:167], v7, s[4:7], s48 offen
    v_mfma_f32_16x16x32_bf16 a[164:167], v[76:79], v[112:115], 0
    buffer_load_dwordx4 v[168:171], v7, s[4:7], s49 offen
    v_mfma_f32_16x16x32_bf16 a[168:171], v[76:79], v[116:119], 0
    buffer_load_dwordx4 v[172:175], v7, s[4:7], s50 offen
    v_mfma_f32_16x16x32_bf16 v[36:39], v[76:79], v[120:123], 0
    buffer_load_dwordx4 v[176:179], v7, s[4:7], s51 offen
    v_mfma_f32_16x16x32_bf16 v[52:55], v[76:79], v[124:127], 0
    ds_read_b64_tr_b16 v[76:77], v22 offset:8192
    ds_read_b64_tr_b16 v[78:79], v22 offset:12288
    v_mfma_f32_16x16x32_bf16 a[172:175], v[80:83], v[92:95], 0
    buffer_load_dwordx4 v[180:183], v7, s[4:7], s52 offen
    v_mfma_f32_16x16x32_bf16 a[176:179], v[80:83], v[96:99], 0
    buffer_load_dwordx4 v[184:187], v7, s[4:7], s53 offen
    v_mfma_f32_16x16x32_bf16 a[180:183], v[80:83], v[100:103], 0
    buffer_load_dwordx4 v[188:191], v7, s[4:7], s54 offen
    v_mfma_f32_16x16x32_bf16 a[184:187], v[80:83], v[104:107], 0
    buffer_load_dwordx4 v[192:195], v7, s[4:7], s55 offen
    v_mfma_f32_16x16x32_bf16 a[188:191], v[80:83], v[108:111], 0
    buffer_load_dwordx4 v[196:199], v7, s[4:7], s56 offen
    v_mfma_f32_16x16x32_bf16 a[192:195], v[80:83], v[112:115], 0
    v_add_u32 v7, 57344, v7
    v_mfma_f32_16x16x32_bf16 a[196:199], v[80:83], v[116:119], 0
    buffer_load_dwordx4 v[200:203], v7, s[4:7], s48 offen
    v_mfma_f32_16x16x32_bf16 v[40:43], v[80:83], v[120:123], 0
    buffer_load_dwordx4 v[204:207], v7, s[4:7], s49 offen
    v_mfma_f32_16x16x32_bf16 v[56:59], v[80:83], v[124:127], 0
    ds_read_b64_tr_b16 v[80:81], v23 offset:8192
    ds_read_b64_tr_b16 v[82:83], v23 offset:12288
    v_mfma_f32_16x16x32_bf16 a[200:203], v[84:87], v[92:95], 0
    buffer_load_dwordx4 v[208:211], v7, s[4:7], s50 offen
    v_mfma_f32_16x16x32_bf16 a[204:207], v[84:87], v[96:99], 0
    buffer_load_dwordx4 v[212:215], v7, s[4:7], s51 offen
    v_mfma_f32_16x16x32_bf16 a[208:211], v[84:87], v[100:103], 0
    buffer_load_dwordx4 v[216:219], v7, s[4:7], s52 offen
    v_mfma_f32_16x16x32_bf16 a[212:215], v[84:87], v[104:107], 0
    buffer_load_dwordx4 v[220:223], v7, s[4:7], s53 offen
    v_mfma_f32_16x16x32_bf16 v[244:247], v[84:87], v[108:111], 0
    buffer_load_dwordx4 v[224:227], v7, s[4:7], s54 offen
    v_mfma_f32_16x16x32_bf16 a[216:219], v[84:87], v[112:115], 0
    buffer_load_dwordx4 v[228:231], v7, s[4:7], s55 offen
    v_mfma_f32_16x16x32_bf16 v[28:31], v[84:87], v[116:119], 0
    buffer_load_dwordx4 v[232:235], v7, s[4:7], s56 offen
    v_mfma_f32_16x16x32_bf16 v[44:47], v[84:87], v[120:123], 0
    v_add_u32 v7, 57344, v7
    v_mfma_f32_16x16x32_bf16 v[236:239], v[84:87], v[124:127], 0
    ds_read_b64_tr_b16 v[84:85], v24 offset:8192
    ds_read_b64_tr_b16 v[86:87], v24 offset:12288
    v_mfma_f32_16x16x32_bf16 a[220:223], v[88:91], v[92:95], 0
    v_mfma_f32_16x16x32_bf16 a[224:227], v[88:91], v[96:99], 0
    v_mfma_f32_16x16x32_bf16 a[228:231], v[88:91], v[100:103], 0
    v_mfma_f32_16x16x32_bf16 a[232:235], v[88:91], v[104:107], 0
    v_mfma_f32_16x16x32_bf16 v[248:251], v[88:91], v[108:111], 0
    v_mfma_f32_16x16x32_bf16 a[236:239], v[88:91], v[112:115], 0
    v_mfma_f32_16x16x32_bf16 v[32:35], v[88:91], v[116:119], 0
    v_mfma_f32_16x16x32_bf16 v[48:51], v[88:91], v[120:123], 0
    v_mfma_f32_16x16x32_bf16 v[240:243], v[88:91], v[124:127], 0
    ds_read_b64_tr_b16 v[88:89], v25 offset:8192
    ds_read_b64_tr_b16 v[90:91], v25 offset:12288
    s_waitcnt vmcnt(34) lgkmcnt(12)
    v_mfma_f32_16x16x32_bf16 a[0:3], v[60:63], v[128:131], a[0:3]
    v_mfma_f32_16x16x32_bf16 a[4:7], v[60:63], v[132:135], a[4:7]
    v_mfma_f32_16x16x32_bf16 a[8:11], v[60:63], v[136:139], a[8:11]
    v_mfma_f32_16x16x32_bf16 a[12:15], v[60:63], v[140:143], a[12:15]
    v_mfma_f32_16x16x32_bf16 a[16:19], v[60:63], v[144:147], a[16:19]
    v_mfma_f32_16x16x32_bf16 a[20:23], v[60:63], v[148:151], a[20:23]
    v_mfma_f32_16x16x32_bf16 a[24:27], v[60:63], v[152:155], a[24:27]
    v_mfma_f32_16x16x32_bf16 a[28:31], v[60:63], v[156:159], a[28:31]
    v_mfma_f32_16x16x32_bf16 a[32:35], v[60:63], v[160:163], a[32:35]
    v_mfma_f32_16x16x32_bf16 a[36:39], v[64:67], v[128:131], a[36:39]
    v_mfma_f32_16x16x32_bf16 a[40:43], v[64:67], v[132:135], a[40:43]
    v_mfma_f32_16x16x32_bf16 a[44:47], v[64:67], v[136:139], a[44:47]
    v_mfma_f32_16x16x32_bf16 a[48:51], v[64:67], v[140:143], a[48:51]
    v_mfma_f32_16x16x32_bf16 a[52:55], v[64:67], v[144:147], a[52:55]
    v_mfma_f32_16x16x32_bf16 a[56:59], v[64:67], v[148:151], a[56:59]
    v_mfma_f32_16x16x32_bf16 a[60:63], v[64:67], v[152:155], a[60:63]
    v_mfma_f32_16x16x32_bf16 a[64:67], v[64:67], v[156:159], a[64:67]
    v_mfma_f32_16x16x32_bf16 a[68:71], v[64:67], v[160:163], a[68:71]
    s_waitcnt vmcnt(18)
    ds_read_b64_tr_b16 v[60:61], v18 offset:16384
    ds_read_b64_tr_b16 v[62:63], v18 offset:20480
    ds_read_b64_tr_b16 v[64:65], v18 offset:24576
    ds_read_b64_tr_b16 v[66:67], v18 offset:28672
    s_waitcnt lgkmcnt(4)
    v_mfma_f32_16x16x32_bf16 a[72:75], v[68:71], v[128:131], a[72:75]
    s_add_u32 m0, s27, 0
    v_mfma_f32_16x16x32_bf16 a[76:79], v[68:71], v[132:135], a[76:79]
    s_nop 0
    v_mfma_f32_16x16x32_bf16 a[80:83], v[68:71], v[136:139], a[80:83]
    buffer_load_dwordx4 v10, s[8:11], s26 offen offset:0 lds
    v_mfma_f32_16x16x32_bf16 a[84:87], v[68:71], v[140:143], a[84:87]
    buffer_load_dwordx4 v11, s[8:11], s26 offen offset:1024 lds
    v_mfma_f32_16x16x32_bf16 a[88:91], v[68:71], v[144:147], a[88:91]
    buffer_load_dwordx4 v12, s[8:11], s26 offen offset:2048 lds
    v_mfma_f32_16x16x32_bf16 a[92:95], v[68:71], v[148:151], a[92:95]
    buffer_load_dwordx4 v13, s[8:11], s26 offen offset:3072 lds
    v_mfma_f32_16x16x32_bf16 a[96:99], v[68:71], v[152:155], a[96:99]
    s_add_u32 m0, s27, 4096
    v_mfma_f32_16x16x32_bf16 a[100:103], v[68:71], v[156:159], a[100:103]
    s_nop 0
    v_mfma_f32_16x16x32_bf16 a[104:107], v[68:71], v[160:163], a[104:107]
    buffer_load_dwordx4 v14, s[8:11], s26 offen offset:0 lds
    v_mfma_f32_16x16x32_bf16 a[108:111], v[72:75], v[128:131], a[108:111]
    buffer_load_dwordx4 v15, s[8:11], s26 offen offset:1024 lds
    v_mfma_f32_16x16x32_bf16 a[112:115], v[72:75], v[132:135], a[112:115]
    buffer_load_dwordx4 v16, s[8:11], s26 offen offset:2048 lds
    v_mfma_f32_16x16x32_bf16 a[116:119], v[72:75], v[136:139], a[116:119]
    buffer_load_dwordx4 v17, s[8:11], s26 offen offset:3072 lds
    v_mfma_f32_16x16x32_bf16 a[120:123], v[72:75], v[140:143], a[120:123]
    s_add_u32 s26, s26, 163840
    v_mfma_f32_16x16x32_bf16 a[124:127], v[72:75], v[144:147], a[124:127]
    s_add_u32 m0, s27, 8192
    v_mfma_f32_16x16x32_bf16 a[128:131], v[72:75], v[148:151], a[128:131]
    s_nop 0
    v_mfma_f32_16x16x32_bf16 a[132:135], v[72:75], v[152:155], a[132:135]
    buffer_load_dwordx4 v10, s[8:11], s26 offen offset:0 lds
    v_mfma_f32_16x16x32_bf16 a[136:139], v[72:75], v[156:159], a[136:139]
    buffer_load_dwordx4 v11, s[8:11], s26 offen offset:1024 lds
    v_mfma_f32_16x16x32_bf16 a[140:143], v[72:75], v[160:163], a[140:143]
    ds_read_b64_tr_b16 v[68:69], v19 offset:16384
    ds_read_b64_tr_b16 v[70:71], v19 offset:20480
    ds_read_b64_tr_b16 v[72:73], v19 offset:24576
    ds_read_b64_tr_b16 v[74:75], v19 offset:28672
    v_mfma_f32_16x16x32_bf16 a[144:147], v[76:79], v[128:131], a[144:147]
    buffer_load_dwordx4 v12, s[8:11], s26 offen offset:2048 lds
    v_mfma_f32_16x16x32_bf16 a[148:151], v[76:79], v[132:135], a[148:151]
    buffer_load_dwordx4 v13, s[8:11], s26 offen offset:3072 lds
    v_mfma_f32_16x16x32_bf16 a[152:155], v[76:79], v[136:139], a[152:155]
    s_add_u32 m0, s27, 12288
    v_mfma_f32_16x16x32_bf16 a[156:159], v[76:79], v[140:143], a[156:159]
    s_nop 0
    v_mfma_f32_16x16x32_bf16 a[160:163], v[76:79], v[144:147], a[160:163]
    buffer_load_dwordx4 v14, s[8:11], s26 offen offset:0 lds
    v_mfma_f32_16x16x32_bf16 a[164:167], v[76:79], v[148:151], a[164:167]
    buffer_load_dwordx4 v15, s[8:11], s26 offen offset:1024 lds
    v_mfma_f32_16x16x32_bf16 a[168:171], v[76:79], v[152:155], a[168:171]
    buffer_load_dwordx4 v16, s[8:11], s26 offen offset:2048 lds
    v_mfma_f32_16x16x32_bf16 v[36:39], v[76:79], v[156:159], v[36:39]
    buffer_load_dwordx4 v17, s[8:11], s26 offen offset:3072 lds
    v_mfma_f32_16x16x32_bf16 v[52:55], v[76:79], v[160:163], v[52:55]
    s_add_u32 s26, s26, 163840
    v_mfma_f32_16x16x32_bf16 a[172:175], v[80:83], v[128:131], a[172:175]
    v_mfma_f32_16x16x32_bf16 a[176:179], v[80:83], v[132:135], a[176:179]
    v_mfma_f32_16x16x32_bf16 a[180:183], v[80:83], v[136:139], a[180:183]
    v_mfma_f32_16x16x32_bf16 a[184:187], v[80:83], v[140:143], a[184:187]
    v_mfma_f32_16x16x32_bf16 a[188:191], v[80:83], v[144:147], a[188:191]
    v_mfma_f32_16x16x32_bf16 a[192:195], v[80:83], v[148:151], a[192:195]
    v_mfma_f32_16x16x32_bf16 a[196:199], v[80:83], v[152:155], a[196:199]
    v_mfma_f32_16x16x32_bf16 v[40:43], v[80:83], v[156:159], v[40:43]
    v_mfma_f32_16x16x32_bf16 v[56:59], v[80:83], v[160:163], v[56:59]
    ds_read_b64_tr_b16 v[76:77], v20 offset:16384
    ds_read_b64_tr_b16 v[78:79], v20 offset:20480
    ds_read_b64_tr_b16 v[80:81], v20 offset:24576
    ds_read_b64_tr_b16 v[82:83], v20 offset:28672
    v_mfma_f32_16x16x32_bf16 a[200:203], v[84:87], v[128:131], a[200:203]
    v_mfma_f32_16x16x32_bf16 a[204:207], v[84:87], v[132:135], a[204:207]
    v_mfma_f32_16x16x32_bf16 a[208:211], v[84:87], v[136:139], a[208:211]
    v_mfma_f32_16x16x32_bf16 a[212:215], v[84:87], v[140:143], a[212:215]
    v_mfma_f32_16x16x32_bf16 v[244:247], v[84:87], v[144:147], v[244:247]
    v_mfma_f32_16x16x32_bf16 a[216:219], v[84:87], v[148:151], a[216:219]
    v_mfma_f32_16x16x32_bf16 v[28:31], v[84:87], v[152:155], v[28:31]
    v_mfma_f32_16x16x32_bf16 v[44:47], v[84:87], v[156:159], v[44:47]
    v_mfma_f32_16x16x32_bf16 v[236:239], v[84:87], v[160:163], v[236:239]
    v_mfma_f32_16x16x32_bf16 a[220:223], v[88:91], v[128:131], a[220:223]
    v_mfma_f32_16x16x32_bf16 a[224:227], v[88:91], v[132:135], a[224:227]
    v_mfma_f32_16x16x32_bf16 a[228:231], v[88:91], v[136:139], a[228:231]
    v_mfma_f32_16x16x32_bf16 a[232:235], v[88:91], v[140:143], a[232:235]
    v_mfma_f32_16x16x32_bf16 v[248:251], v[88:91], v[144:147], v[248:251]
    v_mfma_f32_16x16x32_bf16 a[236:239], v[88:91], v[148:151], a[236:239]
    v_mfma_f32_16x16x32_bf16 v[32:35], v[88:91], v[152:155], v[32:35]
    v_mfma_f32_16x16x32_bf16 v[48:51], v[88:91], v[156:159], v[48:51]
    v_mfma_f32_16x16x32_bf16 v[240:243], v[88:91], v[160:163], v[240:243]
    ds_read_b64_tr_b16 v[84:85], v21 offset:16384
    ds_read_b64_tr_b16 v[86:87], v21 offset:20480
    ds_read_b64_tr_b16 v[88:89], v21 offset:24576
    ds_read_b64_tr_b16 v[90:91], v21 offset:28672
    s_waitcnt vmcnt(16) lgkmcnt(12)
    v_mfma_f32_16x16x32_bf16 a[0:3], v[60:63], v[164:167], a[0:3]
    buffer_load_dwordx4 v[92:95], v7, s[4:7], s48 offen
    v_mfma_f32_16x16x32_bf16 a[0:3], v[64:67], v[200:203], a[0:3]
    buffer_load_dwordx4 v[96:99], v7, s[4:7], s49 offen
    v_mfma_f32_16x16x32_bf16 a[4:7], v[60:63], v[168:171], a[4:7]
    buffer_load_dwordx4 v[100:103], v7, s[4:7], s50 offen
    v_mfma_f32_16x16x32_bf16 a[4:7], v[64:67], v[204:207], a[4:7]
    buffer_load_dwordx4 v[104:107], v7, s[4:7], s51 offen
    v_mfma_f32_16x16x32_bf16 a[8:11], v[60:63], v[172:175], a[8:11]
    buffer_load_dwordx4 v[108:111], v7, s[4:7], s52 offen
    v_mfma_f32_16x16x32_bf16 a[8:11], v[64:67], v[208:211], a[8:11]
    buffer_load_dwordx4 v[112:115], v7, s[4:7], s53 offen
    v_mfma_f32_16x16x32_bf16 a[12:15], v[60:63], v[176:179], a[12:15]
    buffer_load_dwordx4 v[116:119], v7, s[4:7], s54 offen
    v_mfma_f32_16x16x32_bf16 a[12:15], v[64:67], v[212:215], a[12:15]
    buffer_load_dwordx4 v[120:123], v7, s[4:7], s55 offen
    v_mfma_f32_16x16x32_bf16 a[16:19], v[60:63], v[180:183], a[16:19]
    buffer_load_dwordx4 v[124:127], v7, s[4:7], s56 offen
    v_mfma_f32_16x16x32_bf16 a[16:19], v[64:67], v[216:219], a[16:19]
    v_add_u32 v7, 57344, v7
    v_mfma_f32_16x16x32_bf16 a[20:23], v[60:63], v[184:187], a[20:23]
    buffer_load_dwordx4 v[128:131], v7, s[4:7], s48 offen
    v_mfma_f32_16x16x32_bf16 a[20:23], v[64:67], v[220:223], a[20:23]
    buffer_load_dwordx4 v[132:135], v7, s[4:7], s49 offen
    v_mfma_f32_16x16x32_bf16 a[24:27], v[60:63], v[188:191], a[24:27]
    buffer_load_dwordx4 v[136:139], v7, s[4:7], s50 offen
    v_mfma_f32_16x16x32_bf16 a[24:27], v[64:67], v[224:227], a[24:27]
    buffer_load_dwordx4 v[140:143], v7, s[4:7], s51 offen
    v_mfma_f32_16x16x32_bf16 a[28:31], v[60:63], v[192:195], a[28:31]
    buffer_load_dwordx4 v[144:147], v7, s[4:7], s52 offen
    v_mfma_f32_16x16x32_bf16 a[28:31], v[64:67], v[228:231], a[28:31]
    buffer_load_dwordx4 v[148:151], v7, s[4:7], s53 offen
    v_mfma_f32_16x16x32_bf16 a[32:35], v[60:63], v[196:199], a[32:35]
    buffer_load_dwordx4 v[152:155], v7, s[4:7], s54 offen
    v_mfma_f32_16x16x32_bf16 a[32:35], v[64:67], v[232:235], a[32:35]
    ds_read_b64_tr_b16 v[60:61], v22 offset:16384
    ds_read_b64_tr_b16 v[62:63], v22 offset:20480
    ds_read_b64_tr_b16 v[64:65], v22 offset:24576
    ds_read_b64_tr_b16 v[66:67], v22 offset:28672
    s_waitcnt lgkmcnt(12)
    v_mfma_f32_16x16x32_bf16 a[36:39], v[68:71], v[164:167], a[36:39]
    buffer_load_dwordx4 v[156:159], v7, s[4:7], s55 offen
    v_mfma_f32_16x16x32_bf16 a[36:39], v[72:75], v[200:203], a[36:39]
    buffer_load_dwordx4 v[160:163], v7, s[4:7], s56 offen
    v_mfma_f32_16x16x32_bf16 a[40:43], v[68:71], v[168:171], a[40:43]
    v_add_u32 v7, 57344, v7
    v_mfma_f32_16x16x32_bf16 a[40:43], v[72:75], v[204:207], a[40:43]
    v_mfma_f32_16x16x32_bf16 a[44:47], v[68:71], v[172:175], a[44:47]
    v_mfma_f32_16x16x32_bf16 a[44:47], v[72:75], v[208:211], a[44:47]
    v_mfma_f32_16x16x32_bf16 a[48:51], v[68:71], v[176:179], a[48:51]
    v_mfma_f32_16x16x32_bf16 a[48:51], v[72:75], v[212:215], a[48:51]
    v_mfma_f32_16x16x32_bf16 a[52:55], v[68:71], v[180:183], a[52:55]
    v_mfma_f32_16x16x32_bf16 a[52:55], v[72:75], v[216:219], a[52:55]
    v_mfma_f32_16x16x32_bf16 a[56:59], v[68:71], v[184:187], a[56:59]
    v_mfma_f32_16x16x32_bf16 a[56:59], v[72:75], v[220:223], a[56:59]
    v_mfma_f32_16x16x32_bf16 a[60:63], v[68:71], v[188:191], a[60:63]
    v_mfma_f32_16x16x32_bf16 a[60:63], v[72:75], v[224:227], a[60:63]
    v_mfma_f32_16x16x32_bf16 a[64:67], v[68:71], v[192:195], a[64:67]
    v_mfma_f32_16x16x32_bf16 a[64:67], v[72:75], v[228:231], a[64:67]
    v_mfma_f32_16x16x32_bf16 a[68:71], v[68:71], v[196:199], a[68:71]
    v_mfma_f32_16x16x32_bf16 a[68:71], v[72:75], v[232:235], a[68:71]
    ds_read_b64_tr_b16 v[68:69], v23 offset:16384
    ds_read_b64_tr_b16 v[70:71], v23 offset:20480
    ds_read_b64_tr_b16 v[72:73], v23 offset:24576
    ds_read_b64_tr_b16 v[74:75], v23 offset:28672
    s_waitcnt lgkmcnt(12)
    v_mfma_f32_16x16x32_bf16 a[72:75], v[76:79], v[164:167], a[72:75]
    v_mfma_f32_16x16x32_bf16 a[72:75], v[80:83], v[200:203], a[72:75]
    v_mfma_f32_16x16x32_bf16 a[76:79], v[76:79], v[168:171], a[76:79]
    v_mfma_f32_16x16x32_bf16 a[76:79], v[80:83], v[204:207], a[76:79]
    v_mfma_f32_16x16x32_bf16 a[80:83], v[76:79], v[172:175], a[80:83]
    v_mfma_f32_16x16x32_bf16 a[80:83], v[80:83], v[208:211], a[80:83]
    v_mfma_f32_16x16x32_bf16 a[84:87], v[76:79], v[176:179], a[84:87]
    v_mfma_f32_16x16x32_bf16 a[84:87], v[80:83], v[212:215], a[84:87]
    v_mfma_f32_16x16x32_bf16 a[88:91], v[76:79], v[180:183], a[88:91]
    v_mfma_f32_16x16x32_bf16 a[88:91], v[80:83], v[216:219], a[88:91]
    v_mfma_f32_16x16x32_bf16 a[92:95], v[76:79], v[184:187], a[92:95]
    v_mfma_f32_16x16x32_bf16 a[92:95], v[80:83], v[220:223], a[92:95]
    v_mfma_f32_16x16x32_bf16 a[96:99], v[76:79], v[188:191], a[96:99]
    v_mfma_f32_16x16x32_bf16 a[96:99], v[80:83], v[224:227], a[96:99]
    v_mfma_f32_16x16x32_bf16 a[100:103], v[76:79], v[192:195], a[100:103]
    v_mfma_f32_16x16x32_bf16 a[100:103], v[80:83], v[228:231], a[100:103]
    v_mfma_f32_16x16x32_bf16 a[104:107], v[76:79], v[196:199], a[104:107]
    v_mfma_f32_16x16x32_bf16 a[104:107], v[80:83], v[232:235], a[104:107]
    ds_read_b64_tr_b16 v[76:77], v24 offset:16384
    ds_read_b64_tr_b16 v[78:79], v24 offset:20480
    ds_read_b64_tr_b16 v[80:81], v24 offset:24576
    ds_read_b64_tr_b16 v[82:83], v24 offset:28672
    s_waitcnt lgkmcnt(12)
    v_mfma_f32_16x16x32_bf16 a[108:111], v[84:87], v[164:167], a[108:111]
    v_mfma_f32_16x16x32_bf16 a[108:111], v[88:91], v[200:203], a[108:111]
    v_mfma_f32_16x16x32_bf16 a[112:115], v[84:87], v[168:171], a[112:115]
    v_mfma_f32_16x16x32_bf16 a[112:115], v[88:91], v[204:207], a[112:115]
    v_mfma_f32_16x16x32_bf16 a[116:119], v[84:87], v[172:175], a[116:119]
    v_mfma_f32_16x16x32_bf16 a[116:119], v[88:91], v[208:211], a[116:119]
    v_mfma_f32_16x16x32_bf16 a[120:123], v[84:87], v[176:179], a[120:123]
    v_mfma_f32_16x16x32_bf16 a[120:123], v[88:91], v[212:215], a[120:123]
    v_mfma_f32_16x16x32_bf16 a[124:127], v[84:87], v[180:183], a[124:127]
    v_mfma_f32_16x16x32_bf16 a[124:127], v[88:91], v[216:219], a[124:127]
    v_mfma_f32_16x16x32_bf16 a[128:131], v[84:87], v[184:187], a[128:131]
    v_mfma_f32_16x16x32_bf16 a[128:131], v[88:91], v[220:223], a[128:131]
    v_mfma_f32_16x16x32_bf16 a[132:135], v[84:87], v[188:191], a[132:135]
    v_mfma_f32_16x16x32_bf16 a[132:135], v[88:91], v[224:227], a[132:135]
    v_mfma_f32_16x16x32_bf16 a[136:139], v[84:87], v[192:195], a[136:139]
    v_mfma_f32_16x16x32_bf16 a[136:139], v[88:91], v[228:231], a[136:139]
    v_mfma_f32_16x16x32_bf16 a[140:143], v[84:87], v[196:199], a[140:143]
    v_mfma_f32_16x16x32_bf16 a[140:143], v[88:91], v[232:235], a[140:143]
    ds_read_b64_tr_b16 v[84:85], v25 offset:16384
    ds_read_b64_tr_b16 v[86:87], v25 offset:20480
    ds_read_b64_tr_b16 v[88:89], v25 offset:24576
    ds_read_b64_tr_b16 v[90:91], v25 offset:28672
    s_waitcnt lgkmcnt(12)
    v_mfma_f32_16x16x32_bf16 a[144:147], v[60:63], v[164:167], a[144:147]
    v_mfma_f32_16x16x32_bf16 a[144:147], v[64:67], v[200:203], a[144:147]
    v_mfma_f32_16x16x32_bf16 a[148:151], v[60:63], v[168:171], a[148:151]
    v_mfma_f32_16x16x32_bf16 a[148:151], v[64:67], v[204:207], a[148:151]
    v_mfma_f32_16x16x32_bf16 a[152:155], v[60:63], v[172:175], a[152:155]
    v_mfma_f32_16x16x32_bf16 a[152:155], v[64:67], v[208:211], a[152:155]
    v_mfma_f32_16x16x32_bf16 a[156:159], v[60:63], v[176:179], a[156:159]
    v_mfma_f32_16x16x32_bf16 a[156:159], v[64:67], v[212:215], a[156:159]
    v_mfma_f32_16x16x32_bf16 a[160:163], v[60:63], v[180:183], a[160:163]
    v_mfma_f32_16x16x32_bf16 a[160:163], v[64:67], v[216:219], a[160:163]
    v_mfma_f32_16x16x32_bf16 a[164:167], v[60:63], v[184:187], a[164:167]
    v_mfma_f32_16x16x32_bf16 a[164:167], v[64:67], v[220:223], a[164:167]
    v_mfma_f32_16x16x32_bf16 a[168:171], v[60:63], v[188:191], a[168:171]
    v_mfma_f32_16x16x32_bf16 a[168:171], v[64:67], v[224:227], a[168:171]
    v_mfma_f32_16x16x32_bf16 v[36:39], v[60:63], v[192:195], v[36:39]
    v_mfma_f32_16x16x32_bf16 v[36:39], v[64:67], v[228:231], v[36:39]
    v_mfma_f32_16x16x32_bf16 v[52:55], v[60:63], v[196:199], v[52:55]
    v_mfma_f32_16x16x32_bf16 v[52:55], v[64:67], v[232:235], v[52:55]
    s_waitcnt vmcnt(18)
    ds_read_b64_tr_b16 v[60:61], v18 offset:0
    ds_read_b64_tr_b16 v[62:63], v18 offset:4096
    ds_read_b64_tr_b16 v[64:65], v18 offset:8192
    ds_read_b64_tr_b16 v[66:67], v18 offset:12288
    s_waitcnt lgkmcnt(4)
    v_mfma_f32_16x16x32_bf16 a[172:175], v[68:71], v[164:167], a[172:175]
    s_add_u32 m0, s27, 16384
    v_mfma_f32_16x16x32_bf16 a[172:175], v[72:75], v[200:203], a[172:175]
    s_nop 0
    v_mfma_f32_16x16x32_bf16 a[176:179], v[68:71], v[168:171], a[176:179]
    buffer_load_dwordx4 v10, s[8:11], s26 offen offset:0 lds
    v_mfma_f32_16x16x32_bf16 a[176:179], v[72:75], v[204:207], a[176:179]
    buffer_load_dwordx4 v11, s[8:11], s26 offen offset:1024 lds
    v_mfma_f32_16x16x32_bf16 a[180:183], v[68:71], v[172:175], a[180:183]
    buffer_load_dwordx4 v12, s[8:11], s26 offen offset:2048 lds
    v_mfma_f32_16x16x32_bf16 a[180:183], v[72:75], v[208:211], a[180:183]
    buffer_load_dwordx4 v13, s[8:11], s26 offen offset:3072 lds
    v_mfma_f32_16x16x32_bf16 a[184:187], v[68:71], v[176:179], a[184:187]
    s_add_u32 m0, s27, 20480
    v_mfma_f32_16x16x32_bf16 a[184:187], v[72:75], v[212:215], a[184:187]
    s_nop 0
    v_mfma_f32_16x16x32_bf16 a[188:191], v[68:71], v[180:183], a[188:191]
    buffer_load_dwordx4 v14, s[8:11], s26 offen offset:0 lds
    v_mfma_f32_16x16x32_bf16 a[188:191], v[72:75], v[216:219], a[188:191]
    buffer_load_dwordx4 v15, s[8:11], s26 offen offset:1024 lds
    v_mfma_f32_16x16x32_bf16 a[192:195], v[68:71], v[184:187], a[192:195]
    buffer_load_dwordx4 v16, s[8:11], s26 offen offset:2048 lds
    v_mfma_f32_16x16x32_bf16 a[192:195], v[72:75], v[220:223], a[192:195]
    buffer_load_dwordx4 v17, s[8:11], s26 offen offset:3072 lds
    v_mfma_f32_16x16x32_bf16 a[196:199], v[68:71], v[188:191], a[196:199]
    s_add_u32 s26, s26, 163840
    v_mfma_f32_16x16x32_bf16 a[196:199], v[72:75], v[224:227], a[196:199]
    s_add_u32 m0, s27, 24576
    v_mfma_f32_16x16x32_bf16 v[40:43], v[68:71], v[192:195], v[40:43]
    s_nop 0
    v_mfma_f32_16x16x32_bf16 v[40:43], v[72:75], v[228:231], v[40:43]
    buffer_load_dwordx4 v10, s[8:11], s26 offen offset:0 lds
    v_mfma_f32_16x16x32_bf16 v[56:59], v[68:71], v[196:199], v[56:59]
    buffer_load_dwordx4 v11, s[8:11], s26 offen offset:1024 lds
    v_mfma_f32_16x16x32_bf16 v[56:59], v[72:75], v[232:235], v[56:59]
    ds_read_b64_tr_b16 v[68:69], v19 offset:0
    ds_read_b64_tr_b16 v[70:71], v19 offset:4096
    ds_read_b64_tr_b16 v[72:73], v19 offset:8192
    ds_read_b64_tr_b16 v[74:75], v19 offset:12288
    s_waitcnt lgkmcnt(12)
    v_mfma_f32_16x16x32_bf16 a[200:203], v[76:79], v[164:167], a[200:203]
    buffer_load_dwordx4 v12, s[8:11], s26 offen offset:2048 lds
    v_mfma_f32_16x16x32_bf16 a[200:203], v[80:83], v[200:203], a[200:203]
    buffer_load_dwordx4 v13, s[8:11], s26 offen offset:3072 lds
    v_mfma_f32_16x16x32_bf16 a[204:207], v[76:79], v[168:171], a[204:207]
    s_add_u32 m0, s27, 28672
    v_mfma_f32_16x16x32_bf16 a[204:207], v[80:83], v[204:207], a[204:207]
    s_nop 0
    v_mfma_f32_16x16x32_bf16 a[208:211], v[76:79], v[172:175], a[208:211]
    buffer_load_dwordx4 v14, s[8:11], s26 offen offset:0 lds
    v_mfma_f32_16x16x32_bf16 a[208:211], v[80:83], v[208:211], a[208:211]
    buffer_load_dwordx4 v15, s[8:11], s26 offen offset:1024 lds
    v_mfma_f32_16x16x32_bf16 a[212:215], v[76:79], v[176:179], a[212:215]
    buffer_load_dwordx4 v16, s[8:11], s26 offen offset:2048 lds
    v_mfma_f32_16x16x32_bf16 a[212:215], v[80:83], v[212:215], a[212:215]
    buffer_load_dwordx4 v17, s[8:11], s26 offen offset:3072 lds
    v_mfma_f32_16x16x32_bf16 v[244:247], v[76:79], v[180:183], v[244:247]
    s_add_u32 s26, s26, 163840
    v_mfma_f32_16x16x32_bf16 v[244:247], v[80:83], v[216:219], v[244:247]
    v_mfma_f32_16x16x32_bf16 a[216:219], v[76:79], v[184:187], a[216:219]
    v_mfma_f32_16x16x32_bf16 a[216:219], v[80:83], v[220:223], a[216:219]
    v_mfma_f32_16x16x32_bf16 v[28:31], v[76:79], v[188:191], v[28:31]
    v_mfma_f32_16x16x32_bf16 v[28:31], v[80:83], v[224:227], v[28:31]
    v_mfma_f32_16x16x32_bf16 v[44:47], v[76:79], v[192:195], v[44:47]
    v_mfma_f32_16x16x32_bf16 v[44:47], v[80:83], v[228:231], v[44:47]
    v_mfma_f32_16x16x32_bf16 v[236:239], v[76:79], v[196:199], v[236:239]
    v_mfma_f32_16x16x32_bf16 v[236:239], v[80:83], v[232:235], v[236:239]
    ds_read_b64_tr_b16 v[76:77], v20 offset:0
    ds_read_b64_tr_b16 v[78:79], v20 offset:4096
    ds_read_b64_tr_b16 v[80:81], v20 offset:8192
    ds_read_b64_tr_b16 v[82:83], v20 offset:12288
    s_waitcnt lgkmcnt(12)
    v_mfma_f32_16x16x32_bf16 a[220:223], v[84:87], v[164:167], a[220:223]
    v_mfma_f32_16x16x32_bf16 a[220:223], v[88:91], v[200:203], a[220:223]
    v_mfma_f32_16x16x32_bf16 a[224:227], v[84:87], v[168:171], a[224:227]
    v_mfma_f32_16x16x32_bf16 a[224:227], v[88:91], v[204:207], a[224:227]
    v_mfma_f32_16x16x32_bf16 a[228:231], v[84:87], v[172:175], a[228:231]
    v_mfma_f32_16x16x32_bf16 a[228:231], v[88:91], v[208:211], a[228:231]
    v_mfma_f32_16x16x32_bf16 a[232:235], v[84:87], v[176:179], a[232:235]
    v_mfma_f32_16x16x32_bf16 a[232:235], v[88:91], v[212:215], a[232:235]
    v_mfma_f32_16x16x32_bf16 v[248:251], v[84:87], v[180:183], v[248:251]
    v_mfma_f32_16x16x32_bf16 v[248:251], v[88:91], v[216:219], v[248:251]
    v_mfma_f32_16x16x32_bf16 a[236:239], v[84:87], v[184:187], a[236:239]
    v_mfma_f32_16x16x32_bf16 a[236:239], v[88:91], v[220:223], a[236:239]
    v_mfma_f32_16x16x32_bf16 v[32:35], v[84:87], v[188:191], v[32:35]
    v_mfma_f32_16x16x32_bf16 v[32:35], v[88:91], v[224:227], v[32:35]
    v_mfma_f32_16x16x32_bf16 v[48:51], v[84:87], v[192:195], v[48:51]
    v_mfma_f32_16x16x32_bf16 v[48:51], v[88:91], v[228:231], v[48:51]
    v_mfma_f32_16x16x32_bf16 v[240:243], v[84:87], v[196:199], v[240:243]
    v_mfma_f32_16x16x32_bf16 v[240:243], v[88:91], v[232:235], v[240:243]
    ds_read_b64_tr_b16 v[84:85], v21 offset:0
    ds_read_b64_tr_b16 v[86:87], v21 offset:4096
    ds_read_b64_tr_b16 v[88:89], v21 offset:8192
    ds_read_b64_tr_b16 v[90:91], v21 offset:12288
    s_mov_b32 s21, 0
L_op_loop:
    s_waitcnt vmcnt(16) lgkmcnt(12)
    v_mfma_f32_16x16x32_bf16 a[0:3], v[60:63], v[92:95], a[0:3]
    buffer_load_dwordx4 v[164:167], v7, s[4:7], s48 offen
    v_mfma_f32_16x16x32_bf16 a[0:3], v[64:67], v[128:131], a[0:3]
    buffer_load_dwordx4 v[168:171], v7, s[4:7], s49 offen
    v_mfma_f32_16x16x32_bf16 a[4:7], v[60:63], v[96:99], a[4:7]
    buffer_load_dwordx4 v[172:175], v7, s[4:7], s50 offen
    v_mfma_f32_16x16x32_bf16 a[4:7], v[64:67], v[132:135], a[4:7]
    buffer_load_dwordx4 v[176:179], v7, s[4:7], s51 offen
    v_mfma_f32_16x16x32_bf16 a[8:11], v[60:63], v[100:103], a[8:11]
    buffer_load_dwordx4 v[180:183], v7, s[4:7], s52 offen
    v_mfma_f32_16x16x32_bf16 a[8:11], v[64:67], v[136:139], a[8:11]
    buffer_load_dwordx4 v[184:187], v7, s[4:7], s53 offen
    v_mfma_f32_16x16x32_bf16 a[12:15], v[60:63], v[104:107], a[12:15]
    buffer_load_dwordx4 v[188:191], v7, s[4:7], s54 offen
    v_mfma_f32_16x16x32_bf16 a[12:15], v[64:67], v[140:143], a[12:15]
    buffer_load_dwordx4 v[192:195], v7, s[4:7], s55 offen
    v_mfma_f32_16x16x32_bf16 a[16:19], v[60:63], v[108:111], a[16:19]
    buffer_load_dwordx4 v[196:199], v7, s[4:7], s56 offen
    v_mfma_f32_16x16x32_bf16 a[16:19], v[64:67], v[144:147], a[16:19]
    v_add_u32 v7, 57344, v7
    v_mfma_f32_16x16x32_bf16 a[20:23], v[60:63], v[112:115], a[20:23]
    buffer_load_dwordx4 v[200:203], v7, s[4:7], s48 offen
    v_mfma_f32_16x16x32_bf16 a[20:23], v[64:67], v[148:151], a[20:23]
    buffer_load_dwordx4 v[204:207], v7, s[4:7], s49 offen
    v_mfma_f32_16x16x32_bf16 a[24:27], v[60:63], v[116:119], a[24:27]
    buffer_load_dwordx4 v[208:211], v7, s[4:7], s50 offen
    v_mfma_f32_16x16x32_bf16 a[24:27], v[64:67], v[152:155], a[24:27]
    buffer_load_dwordx4 v[212:215], v7, s[4:7], s51 offen
    v_mfma_f32_16x16x32_bf16 a[28:31], v[60:63], v[120:123], a[28:31]
    buffer_load_dwordx4 v[216:219], v7, s[4:7], s52 offen
    v_mfma_f32_16x16x32_bf16 a[28:31], v[64:67], v[156:159], a[28:31]
    buffer_load_dwordx4 v[220:223], v7, s[4:7], s53 offen
    v_mfma_f32_16x16x32_bf16 a[32:35], v[60:63], v[124:127], a[32:35]
    buffer_load_dwordx4 v[224:227], v7, s[4:7], s54 offen
    v_mfma_f32_16x16x32_bf16 a[32:35], v[64:67], v[160:163], a[32:35]
    ds_read_b64_tr_b16 v[60:61], v22 offset:0
    ds_read_b64_tr_b16 v[62:63], v22 offset:4096
    ds_read_b64_tr_b16 v[64:65], v22 offset:8192
    ds_read_b64_tr_b16 v[66:67], v22 offset:12288
    s_waitcnt lgkmcnt(12)
    v_mfma_f32_16x16x32_bf16 a[36:39], v[68:71], v[92:95], a[36:39]
    buffer_load_dwordx4 v[228:231], v7, s[4:7], s55 offen
    v_mfma_f32_16x16x32_bf16 a[36:39], v[72:75], v[128:131], a[36:39]
    buffer_load_dwordx4 v[232:235], v7, s[4:7], s56 offen
    v_mfma_f32_16x16x32_bf16 a[40:43], v[68:71], v[96:99], a[40:43]
    v_add_u32 v7, 57344, v7
    v_mfma_f32_16x16x32_bf16 a[40:43], v[72:75], v[132:135], a[40:43]
    v_mfma_f32_16x16x32_bf16 a[44:47], v[68:71], v[100:103], a[44:47]
    v_mfma_f32_16x16x32_bf16 a[44:47], v[72:75], v[136:139], a[44:47]
    v_mfma_f32_16x16x32_bf16 a[48:51], v[68:71], v[104:107], a[48:51]
    v_mfma_f32_16x16x32_bf16 a[48:51], v[72:75], v[140:143], a[48:51]
    v_mfma_f32_16x16x32_bf16 a[52:55], v[68:71], v[108:111], a[52:55]
    v_mfma_f32_16x16x32_bf16 a[52:55], v[72:75], v[144:147], a[52:55]
    v_mfma_f32_16x16x32_bf16 a[56:59], v[68:71], v[112:115], a[56:59]
    v_mfma_f32_16x16x32_bf16 a[56:59], v[72:75], v[148:151], a[56:59]
    v_mfma_f32_16x16x32_bf16 a[60:63], v[68:71], v[116:119], a[60:63]
    v_mfma_f32_16x16x32_bf16 a[60:63], v[72:75], v[152:155], a[60:63]
    v_mfma_f32_16x16x32_bf16 a[64:67], v[68:71], v[120:123], a[64:67]
    v_mfma_f32_16x16x32_bf16 a[64:67], v[72:75], v[156:159], a[64:67]
    v_mfma_f32_16x16x32_bf16 a[68:71], v[68:71], v[124:127], a[68:71]
    v_mfma_f32_16x16x32_bf16 a[68:71], v[72:75], v[160:163], a[68:71]
    ds_read_b64_tr_b16 v[68:69], v23 offset:0
    ds_read_b64_tr_b16 v[70:71], v23 offset:4096
    ds_read_b64_tr_b16 v[72:73], v23 offset:8192
    ds_read_b64_tr_b16 v[74:75], v23 offset:12288
    s_waitcnt lgkmcnt(12)
    v_mfma_f32_16x16x32_bf16 a[72:75], v[76:79], v[92:95], a[72:75]
    v_mfma_f32_16x16x32_bf16 a[72:75], v[80:83], v[128:131], a[72:75]
    v_mfma_f32_16x16x32_bf16 a[76:79], v[76:79], v[96:99], a[76:79]
    v_mfma_f32_16x16x32_bf16 a[76:79], v[80:83], v[132:135], a[76:79]
    v_mfma_f32_16x16x32_bf16 a[80:83], v[76:79], v[100:103], a[80:83]
    v_mfma_f32_16x16x32_bf16 a[80:83], v[80:83], v[136:139], a[80:83]
    v_mfma_f32_16x16x32_bf16 a[84:87], v[76:79], v[104:107], a[84:87]
    v_mfma_f32_16x16x32_bf16 a[84:87], v[80:83], v[140:143], a[84:87]
    v_mfma_f32_16x16x32_bf16 a[88:91], v[76:79], v[108:111], a[88:91]
    v_mfma_f32_16x16x32_bf16 a[88:91], v[80:83], v[144:147], a[88:91]
    v_mfma_f32_16x16x32_bf16 a[92:95], v[76:79], v[112:115], a[92:95]
    v_mfma_f32_16x16x32_bf16 a[92:95], v[80:83], v[148:151], a[92:95]
    v_mfma_f32_16x16x32_bf16 a[96:99], v[76:79], v[116:119], a[96:99]
    v_mfma_f32_16x16x32_bf16 a[96:99], v[80:83], v[152:155], a[96:99]
    v_mfma_f32_16x16x32_bf16 a[100:103], v[76:79], v[120:123], a[100:103]
    v_mfma_f32_16x16x32_bf16 a[100:103], v[80:83], v[156:159], a[100:103]
    v_mfma_f32_16x16x32_bf16 a[104:107], v[76:79], v[124:127], a[104:107]
    v_mfma_f32_16x16x32_bf16 a[104:107], v[80:83], v[160:163], a[104:107]
    ds_read_b64_tr_b16 v[76:77], v24 offset:0
    ds_read_b64_tr_b16 v[78:79], v24 offset:4096
    ds_read_b64_tr_b16 v[80:81], v24 offset:8192
    ds_read_b64_tr_b16 v[82:83], v24 offset:12288
    s_waitcnt lgkmcnt(12)
    v_mfma_f32_16x16x32_bf16 a[108:111], v[84:87], v[92:95], a[108:111]
    v_mfma_f32_16x16x32_bf16 a[108:111], v[88:91], v[128:131], a[108:111]
    v_mfma_f32_16x16x32_bf16 a[112:115], v[84:87], v[96:99], a[112:115]
    v_mfma_f32_16x16x32_bf16 a[112:115], v[88:91], v[132:135], a[112:115]
    v_mfma_f32_16x16x32_bf16 a[116:119], v[84:87], v[100:103], a[116:119]
    v_mfma_f32_16x16x32_bf16 a[116:119], v[88:91], v[136:139], a[116:119]
    v_mfma_f32_16x16x32_bf16 a[120:123], v[84:87], v[104:107], a[120:123]
    v_mfma_f32_16x16x32_bf16 a[120:123], v[88:91], v[140:143], a[120:123]
    v_mfma_f32_16x16x32_bf16 a[124:127], v[84:87], v[108:111], a[124:127]
    v_mfma_f32_16x16x32_bf16 a[124:127], v[88:91], v[144:147], a[124:127]
    v_mfma_f32_16x16x32_bf16 a[128:131], v[84:87], v[112:115], a[128:131]
    v_mfma_f32_16x16x32_bf16 a[128:131], v[88:91], v[148:151], a[128:131]
    v_mfma_f32_16x16x32_bf16 a[132:135], v[84:87], v[116:119], a[132:135]
    v_mfma_f32_16x16x32_bf16 a[132:135], v[88:91], v[152:155], a[132:135]
    v_mfma_f32_16x16x32_bf16 a[136:139], v[84:87], v[120:123], a[136:139]
    v_mfma_f32_16x16x32_bf16 a[136:139], v[88:91], v[156:159], a[136:139]
    v_mfma_f32_16x16x32_bf16 a[140:143], v[84:87], v[124:127], a[140:143]
    v_mfma_f32_16x16x32_bf16 a[140:143], v[88:91], v[160:163], a[140:143]
    ds_read_b64_tr_b16 v[84:85], v25 offset:0
    ds_read_b64_tr_b16 v[86:87], v25 offset:4096
    ds_read_b64_tr_b16 v[88:89], v25 offset:8192
    ds_read_b64_tr_b16 v[90:91], v25 offset:12288
    s_waitcnt lgkmcnt(12)
    v_mfma_f32_16x16x32_bf16 a[144:147], v[60:63], v[92:95], a[144:147]
    v_mfma_f32_16x16x32_bf16 a[144:147], v[64:67], v[128:131], a[144:147]
    v_mfma_f32_16x16x32_bf16 a[148:151], v[60:63], v[96:99], a[148:151]
    v_mfma_f32_16x16x32_bf16 a[148:151], v[64:67], v[132:135], a[148:151]
    v_mfma_f32_16x16x32_bf16 a[152:155], v[60:63], v[100:103], a[152:155]
    v_mfma_f32_16x16x32_bf16 a[152:155], v[64:67], v[136:139], a[152:155]
    v_mfma_f32_16x16x32_bf16 a[156:159], v[60:63], v[104:107], a[156:159]
    v_mfma_f32_16x16x32_bf16 a[156:159], v[64:67], v[140:143], a[156:159]
    v_mfma_f32_16x16x32_bf16 a[160:163], v[60:63], v[108:111], a[160:163]
    v_mfma_f32_16x16x32_bf16 a[160:163], v[64:67], v[144:147], a[160:163]
    v_mfma_f32_16x16x32_bf16 a[164:167], v[60:63], v[112:115], a[164:167]
    v_mfma_f32_16x16x32_bf16 a[164:167], v[64:67], v[148:151], a[164:167]
    v_mfma_f32_16x16x32_bf16 a[168:171], v[60:63], v[116:119], a[168:171]
    v_mfma_f32_16x16x32_bf16 a[168:171], v[64:67], v[152:155], a[168:171]
    v_mfma_f32_16x16x32_bf16 v[36:39], v[60:63], v[120:123], v[36:39]
    v_mfma_f32_16x16x32_bf16 v[36:39], v[64:67], v[156:159], v[36:39]
    v_mfma_f32_16x16x32_bf16 v[52:55], v[60:63], v[124:127], v[52:55]
    v_mfma_f32_16x16x32_bf16 v[52:55], v[64:67], v[160:163], v[52:55]
    s_waitcnt vmcnt(18)
    ds_read_b64_tr_b16 v[60:61], v18 offset:16384
    ds_read_b64_tr_b16 v[62:63], v18 offset:20480
    ds_read_b64_tr_b16 v[64:65], v18 offset:24576
    ds_read_b64_tr_b16 v[66:67], v18 offset:28672
    s_waitcnt lgkmcnt(4)
    v_mfma_f32_16x16x32_bf16 a[172:175], v[68:71], v[92:95], a[172:175]
    s_add_u32 m0, s27, 0
    v_mfma_f32_16x16x32_bf16 a[172:175], v[72:75], v[128:131], a[172:175]
    s_nop 0
    v_mfma_f32_16x16x32_bf16 a[176:179], v[68:71], v[96:99], a[176:179]
    buffer_load_dwordx4 v10, s[8:11], s26 offen offset:0 lds
    v_mfma_f32_16x16x32_bf16 a[176:179], v[72:75], v[132:135], a[176:179]
    buffer_load_dwordx4 v11, s[8:11], s26 offen offset:1024 lds
    v_mfma_f32_16x16x32_bf16 a[180:183], v[68:71], v[100:103], a[180:183]
    buffer_load_dwordx4 v12, s[8:11], s26 offen offset:2048 lds
    v_mfma_f32_16x16x32_bf16 a[180:183], v[72:75], v[136:139], a[180:183]
    buffer_load_dwordx4 v13, s[8:11], s26 offen offset:3072 lds
    v_mfma_f32_16x16x32_bf16 a[184:187], v[68:71], v[104:107], a[184:187]
    s_add_u32 m0, s27, 4096
    v_mfma_f32_16x16x32_bf16 a[184:187], v[72:75], v[140:143], a[184:187]
    s_nop 0
    v_mfma_f32_16x16x32_bf16 a[188:191], v[68:71], v[108:111], a[188:191]
    buffer_load_dwordx4 v14, s[8:11], s26 offen offset:0 lds
    v_mfma_f32_16x16x32_bf16 a[188:191], v[72:75], v[144:147], a[188:191]
    buffer_load_dwordx4 v15, s[8:11], s26 offen offset:1024 lds
    v_mfma_f32_16x16x32_bf16 a[192:195], v[68:71], v[112:115], a[192:195]
    buffer_load_dwordx4 v16, s[8:11], s26 offen offset:2048 lds
    v_mfma_f32_16x16x32_bf16 a[192:195], v[72:75], v[148:151], a[192:195]
    buffer_load_dwordx4 v17, s[8:11], s26 offen offset:3072 lds
    v_mfma_f32_16x16x32_bf16 a[196:199], v[68:71], v[116:119], a[196:199]
    s_add_u32 s26, s26, 163840
    v_mfma_f32_16x16x32_bf16 a[196:199], v[72:75], v[152:155], a[196:199]
    s_add_u32 m0, s27, 8192
    v_mfma_f32_16x16x32_bf16 v[40:43], v[68:71], v[120:123], v[40:43]
    s_nop 0
    v_mfma_f32_16x16x32_bf16 v[40:43], v[72:75], v[156:159], v[40:43]
    buffer_load_dwordx4 v10, s[8:11], s26 offen offset:0 lds
    v_mfma_f32_16x16x32_bf16 v[56:59], v[68:71], v[124:127], v[56:59]
    buffer_load_dwordx4 v11, s[8:11], s26 offen offset:1024 lds
    v_mfma_f32_16x16x32_bf16 v[56:59], v[72:75], v[160:163], v[56:59]
    ds_read_b64_tr_b16 v[68:69], v19 offset:16384
    ds_read_b64_tr_b16 v[70:71], v19 offset:20480
    ds_read_b64_tr_b16 v[72:73], v19 offset:24576
    ds_read_b64_tr_b16 v[74:75], v19 offset:28672
    s_waitcnt lgkmcnt(12)
    v_mfma_f32_16x16x32_bf16 a[200:203], v[76:79], v[92:95], a[200:203]
    buffer_load_dwordx4 v12, s[8:11], s26 offen offset:2048 lds
    v_mfma_f32_16x16x32_bf16 a[200:203], v[80:83], v[128:131], a[200:203]
    buffer_load_dwordx4 v13, s[8:11], s26 offen offset:3072 lds
    v_mfma_f32_16x16x32_bf16 a[204:207], v[76:79], v[96:99], a[204:207]
    s_add_u32 m0, s27, 12288
    v_mfma_f32_16x16x32_bf16 a[204:207], v[80:83], v[132:135], a[204:207]
    s_nop 0
    v_mfma_f32_16x16x32_bf16 a[208:211], v[76:79], v[100:103], a[208:211]
    buffer_load_dwordx4 v14, s[8:11], s26 offen offset:0 lds
    v_mfma_f32_16x16x32_bf16 a[208:211], v[80:83], v[136:139], a[208:211]
    buffer_load_dwordx4 v15, s[8:11], s26 offen offset:1024 lds
    v_mfma_f32_16x16x32_bf16 a[212:215], v[76:79], v[104:107], a[212:215]
    buffer_load_dwordx4 v16, s[8:11], s26 offen offset:2048 lds
    v_mfma_f32_16x16x32_bf16 a[212:215], v[80:83], v[140:143], a[212:215]
    buffer_load_dwordx4 v17, s[8:11], s26 offen offset:3072 lds
    v_mfma_f32_16x16x32_bf16 v[244:247], v[76:79], v[108:111], v[244:247]
    s_add_u32 s26, s26, 163840
    v_mfma_f32_16x16x32_bf16 v[244:247], v[80:83], v[144:147], v[244:247]
    v_mfma_f32_16x16x32_bf16 a[216:219], v[76:79], v[112:115], a[216:219]
    v_mfma_f32_16x16x32_bf16 a[216:219], v[80:83], v[148:151], a[216:219]
    v_mfma_f32_16x16x32_bf16 v[28:31], v[76:79], v[116:119], v[28:31]
    v_mfma_f32_16x16x32_bf16 v[28:31], v[80:83], v[152:155], v[28:31]
    v_mfma_f32_16x16x32_bf16 v[44:47], v[76:79], v[120:123], v[44:47]
    v_mfma_f32_16x16x32_bf16 v[44:47], v[80:83], v[156:159], v[44:47]
    v_mfma_f32_16x16x32_bf16 v[236:239], v[76:79], v[124:127], v[236:239]
    v_mfma_f32_16x16x32_bf16 v[236:239], v[80:83], v[160:163], v[236:239]
    ds_read_b64_tr_b16 v[76:77], v20 offset:16384
    ds_read_b64_tr_b16 v[78:79], v20 offset:20480
    ds_read_b64_tr_b16 v[80:81], v20 offset:24576
    ds_read_b64_tr_b16 v[82:83], v20 offset:28672
    s_waitcnt lgkmcnt(12)
    v_mfma_f32_16x16x32_bf16 a[220:223], v[84:87], v[92:95], a[220:223]
    v_mfma_f32_16x16x32_bf16 a[220:223], v[88:91], v[128:131], a[220:223]
    v_mfma_f32_16x16x32_bf16 a[224:227], v[84:87], v[96:99], a[224:227]
    v_mfma_f32_16x16x32_bf16 a[224:227], v[88:91], v[132:135], a[224:227]
    v_mfma_f32_16x16x32_bf16 a[228:231], v[84:87], v[100:103], a[228:231]
    v_mfma_f32_16x16x32_bf16 a[228:231], v[88:91], v[136:139], a[228:231]
    v_mfma_f32_16x16x32_bf16 a[232:235], v[84:87], v[104:107], a[232:235]
    v_mfma_f32_16x16x32_bf16 a[232:235], v[88:91], v[140:143], a[232:235]
    v_mfma_f32_16x16x32_bf16 v[248:251], v[84:87], v[108:111], v[248:251]
    v_mfma_f32_16x16x32_bf16 v[248:251], v[88:91], v[144:147], v[248:251]
    v_mfma_f32_16x16x32_bf16 a[236:239], v[84:87], v[112:115], a[236:239]
    v_mfma_f32_16x16x32_bf16 a[236:239], v[88:91], v[148:151], a[236:239]
    v_mfma_f32_16x16x32_bf16 v[32:35], v[84:87], v[116:119], v[32:35]
    v_mfma_f32_16x16x32_bf16 v[32:35], v[88:91], v[152:155], v[32:35]
    v_mfma_f32_16x16x32_bf16 v[48:51], v[84:87], v[120:123], v[48:51]
    v_mfma_f32_16x16x32_bf16 v[48:51], v[88:91], v[156:159], v[48:51]
    v_mfma_f32_16x16x32_bf16 v[240:243], v[84:87], v[124:127], v[240:243]
    v_mfma_f32_16x16x32_bf16 v[240:243], v[88:91], v[160:163], v[240:243]
    ds_read_b64_tr_b16 v[84:85], v21 offset:16384
    ds_read_b64_tr_b16 v[86:87], v21 offset:20480
    ds_read_b64_tr_b16 v[88:89], v21 offset:24576
    ds_read_b64_tr_b16 v[90:91], v21 offset:28672
    s_waitcnt vmcnt(16) lgkmcnt(12)
    v_mfma_f32_16x16x32_bf16 a[0:3], v[60:63], v[164:167], a[0:3]
    buffer_load_dwordx4 v[92:95], v7, s[4:7], s48 offen
    v_mfma_f32_16x16x32_bf16 a[0:3], v[64:67], v[200:203], a[0:3]
    buffer_load_dwordx4 v[96:99], v7, s[4:7], s49 offen
    v_mfma_f32_16x16x32_bf16 a[4:7], v[60:63], v[168:171], a[4:7]
    buffer_load_dwordx4 v[100:103], v7, s[4:7], s50 offen
    v_mfma_f32_16x16x32_bf16 a[4:7], v[64:67], v[204:207], a[4:7]
    buffer_load_dwordx4 v[104:107], v7, s[4:7], s51 offen
    v_mfma_f32_16x16x32_bf16 a[8:11], v[60:63], v[172:175], a[8:11]
    buffer_load_dwordx4 v[108:111], v7, s[4:7], s52 offen
    v_mfma_f32_16x16x32_bf16 a[8:11], v[64:67], v[208:211], a[8:11]
    buffer_load_dwordx4 v[112:115], v7, s[4:7], s53 offen
    v_mfma_f32_16x16x32_bf16 a[12:15], v[60:63], v[176:179], a[12:15]
    buffer_load_dwordx4 v[116:119], v7, s[4:7], s54 offen
    v_mfma_f32_16x16x32_bf16 a[12:15], v[64:67], v[212:215], a[12:15]
    buffer_load_dwordx4 v[120:123], v7, s[4:7], s55 offen
    v_mfma_f32_16x16x32_bf16 a[16:19], v[60:63], v[180:183], a[16:19]
    buffer_load_dwordx4 v[124:127], v7, s[4:7], s56 offen
    v_mfma_f32_16x16x32_bf16 a[16:19], v[64:67], v[216:219], a[16:19]
    v_add_u32 v7, 57344, v7
    v_mfma_f32_16x16x32_bf16 a[20:23], v[60:63], v[184:187], a[20:23]
    buffer_load_dwordx4 v[128:131], v7, s[4:7], s48 offen
    v_mfma_f32_16x16x32_bf16 a[20:23], v[64:67], v[220:223], a[20:23]
    buffer_load_dwordx4 v[132:135], v7, s[4:7], s49 offen
    v_mfma_f32_16x16x32_bf16 a[24:27], v[60:63], v[188:191], a[24:27]
    buffer_load_dwordx4 v[136:139], v7, s[4:7], s50 offen
    v_mfma_f32_16x16x32_bf16 a[24:27], v[64:67], v[224:227], a[24:27]
    buffer_load_dwordx4 v[140:143], v7, s[4:7], s51 offen
    v_mfma_f32_16x16x32_bf16 a[28:31], v[60:63], v[192:195], a[28:31]
    buffer_load_dwordx4 v[144:147], v7, s[4:7], s52 offen
    v_mfma_f32_16x16x32_bf16 a[28:31], v[64:67], v[228:231], a[28:31]
    buffer_load_dwordx4 v[148:151], v7, s[4:7], s53 offen
    v_mfma_f32_16x16x32_bf16 a[32:35], v[60:63], v[196:199], a[32:35]
    buffer_load_dwordx4 v[152:155], v7, s[4:7], s54 offen
    v_mfma_f32_16x16x32_bf16 a[32:35], v[64:67], v[232:235], a[32:35]
    ds_read_b64_tr_b16 v[60:61], v22 offset:16384
    ds_read_b64_tr_b16 v[62:63], v22 offset:20480
    ds_read_b64_tr_b16 v[64:65], v22 offset:24576
    ds_read_b64_tr_b16 v[66:67], v22 offset:28672
    s_waitcnt lgkmcnt(12)
    v_mfma_f32_16x16x32_bf16 a[36:39], v[68:71], v[164:167], a[36:39]
    buffer_load_dwordx4 v[156:159], v7, s[4:7], s55 offen
    v_mfma_f32_16x16x32_bf16 a[36:39], v[72:75], v[200:203], a[36:39]
    buffer_load_dwordx4 v[160:163], v7, s[4:7], s56 offen
    v_mfma_f32_16x16x32_bf16 a[40:43], v[68:71], v[168:171], a[40:43]
    v_add_u32 v7, 57344, v7
    v_mfma_f32_16x16x32_bf16 a[40:43], v[72:75], v[204:207], a[40:43]
    v_mfma_f32_16x16x32_bf16 a[44:47], v[68:71], v[172:175], a[44:47]
    v_mfma_f32_16x16x32_bf16 a[44:47], v[72:75], v[208:211], a[44:47]
    v_mfma_f32_16x16x32_bf16 a[48:51], v[68:71], v[176:179], a[48:51]
    v_mfma_f32_16x16x32_bf16 a[48:51], v[72:75], v[212:215], a[48:51]
    v_mfma_f32_16x16x32_bf16 a[52:55], v[68:71], v[180:183], a[52:55]
    v_mfma_f32_16x16x32_bf16 a[52:55], v[72:75], v[216:219], a[52:55]
    v_mfma_f32_16x16x32_bf16 a[56:59], v[68:71], v[184:187], a[56:59]
    v_mfma_f32_16x16x32_bf16 a[56:59], v[72:75], v[220:223], a[56:59]
    v_mfma_f32_16x16x32_bf16 a[60:63], v[68:71], v[188:191], a[60:63]
    v_mfma_f32_16x16x32_bf16 a[60:63], v[72:75], v[224:227], a[60:63]
    v_mfma_f32_16x16x32_bf16 a[64:67], v[68:71], v[192:195], a[64:67]
    v_mfma_f32_16x16x32_bf16 a[64:67], v[72:75], v[228:231], a[64:67]
    v_mfma_f32_16x16x32_bf16 a[68:71], v[68:71], v[196:199], a[68:71]
    v_mfma_f32_16x16x32_bf16 a[68:71], v[72:75], v[232:235], a[68:71]
    ds_read_b64_tr_b16 v[68:69], v23 offset:16384
    ds_read_b64_tr_b16 v[70:71], v23 offset:20480
    ds_read_b64_tr_b16 v[72:73], v23 offset:24576
    ds_read_b64_tr_b16 v[74:75], v23 offset:28672
    s_waitcnt lgkmcnt(12)
    v_mfma_f32_16x16x32_bf16 a[72:75], v[76:79], v[164:167], a[72:75]
    v_mfma_f32_16x16x32_bf16 a[72:75], v[80:83], v[200:203], a[72:75]
    v_mfma_f32_16x16x32_bf16 a[76:79], v[76:79], v[168:171], a[76:79]
    v_mfma_f32_16x16x32_bf16 a[76:79], v[80:83], v[204:207], a[76:79]
    v_mfma_f32_16x16x32_bf16 a[80:83], v[76:79], v[172:175], a[80:83]
    v_mfma_f32_16x16x32_bf16 a[80:83], v[80:83], v[208:211], a[80:83]
    v_mfma_f32_16x16x32_bf16 a[84:87], v[76:79], v[176:179], a[84:87]
    v_mfma_f32_16x16x32_bf16 a[84:87], v[80:83], v[212:215], a[84:87]
    v_mfma_f32_16x16x32_bf16 a[88:91], v[76:79], v[180:183], a[88:91]
    v_mfma_f32_16x16x32_bf16 a[88:91], v[80:83], v[216:219], a[88:91]
    v_mfma_f32_16x16x32_bf16 a[92:95], v[76:79], v[184:187], a[92:95]
    v_mfma_f32_16x16x32_bf16 a[92:95], v[80:83], v[220:223], a[92:95]
    v_mfma_f32_16x16x32_bf16 a[96:99], v[76:79], v[188:191], a[96:99]
    v_mfma_f32_16x16x32_bf16 a[96:99], v[80:83], v[224:227], a[96:99]
    v_mfma_f32_16x16x32_bf16 a[100:103], v[76:79], v[192:195], a[100:103]
    v_mfma_f32_16x16x32_bf16 a[100:103], v[80:83], v[228:231], a[100:103]
    v_mfma_f32_16x16x32_bf16 a[104:107], v[76:79], v[196:199], a[104:107]
    v_mfma_f32_16x16x32_bf16 a[104:107], v[80:83], v[232:235], a[104:107]
    ds_read_b64_tr_b16 v[76:77], v24 offset:16384
    ds_read_b64_tr_b16 v[78:79], v24 offset:20480
    ds_read_b64_tr_b16 v[80:81], v24 offset:24576
    ds_read_b64_tr_b16 v[82:83], v24 offset:28672
    s_waitcnt lgkmcnt(12)
    v_mfma_f32_16x16x32_bf16 a[108:111], v[84:87], v[164:167], a[108:111]
    v_mfma_f32_16x16x32_bf16 a[108:111], v[88:91], v[200:203], a[108:111]
    v_mfma_f32_16x16x32_bf16 a[112:115], v[84:87], v[168:171], a[112:115]
    v_mfma_f32_16x16x32_bf16 a[112:115], v[88:91], v[204:207], a[112:115]
    v_mfma_f32_16x16x32_bf16 a[116:119], v[84:87], v[172:175], a[116:119]
    v_mfma_f32_16x16x32_bf16 a[116:119], v[88:91], v[208:211], a[116:119]
    v_mfma_f32_16x16x32_bf16 a[120:123], v[84:87], v[176:179], a[120:123]
    v_mfma_f32_16x16x32_bf16 a[120:123], v[88:91], v[212:215], a[120:123]
    v_mfma_f32_16x16x32_bf16 a[124:127], v[84:87], v[180:183], a[124:127]
    v_mfma_f32_16x16x32_bf16 a[124:127], v[88:91], v[216:219], a[124:127]
    v_mfma_f32_16x16x32_bf16 a[128:131], v[84:87], v[184:187], a[128:131]
    v_mfma_f32_16x16x32_bf16 a[128:131], v[88:91], v[220:223], a[128:131]
    v_mfma_f32_16x16x32_bf16 a[132:135], v[84:87], v[188:191], a[132:135]
    v_mfma_f32_16x16x32_bf16 a[132:135], v[88:91], v[224:227], a[132:135]
    v_mfma_f32_16x16x32_bf16 a[136:139], v[84:87], v[192:195], a[136:139]
    v_mfma_f32_16x16x32_bf16 a[136:139], v[88:91], v[228:231], a[136:139]
    v_mfma_f32_16x16x32_bf16 a[140:143], v[84:87], v[196:199], a[140:143]
    v_mfma_f32_16x16x32_bf16 a[140:143], v[88:91], v[232:235], a[140:143]
    ds_read_b64_tr_b16 v[84:85], v25 offset:16384
    ds_read_b64_tr_b16 v[86:87], v25 offset:20480
    ds_read_b64_tr_b16 v[88:89], v25 offset:24576
    ds_read_b64_tr_b16 v[90:91], v25 offset:28672
    s_waitcnt lgkmcnt(12)
    v_mfma_f32_16x16x32_bf16 a[144:147], v[60:63], v[164:167], a[144:147]
    v_mfma_f32_16x16x32_bf16 a[144:147], v[64:67], v[200:203], a[144:147]
    v_mfma_f32_16x16x32_bf16 a[148:151], v[60:63], v[168:171], a[148:151]
    v_mfma_f32_16x16x32_bf16 a[148:151], v[64:67], v[204:207], a[148:151]
    v_mfma_f32_16x16x32_bf16 a[152:155], v[60:63], v[172:175], a[152:155]
    v_mfma_f32_16x16x32_bf16 a[152:155], v[64:67], v[208:211], a[152:155]
    v_mfma_f32_16x16x32_bf16 a[156:159], v[60:63], v[176:179], a[156:159]
    v_mfma_f32_16x16x32_bf16 a[156:159], v[64:67], v[212:215], a[156:159]
    v_mfma_f32_16x16x32_bf16 a[160:163], v[60:63], v[180:183], a[160:163]
    v_mfma_f32_16x16x32_bf16 a[160:163], v[64:67], v[216:219], a[160:163]
    v_mfma_f32_16x16x32_bf16 a[164:167], v[60:63], v[184:187], a[164:167]
    v_mfma_f32_16x16x32_bf16 a[164:167], v[64:67], v[220:223], a[164:167]
    v_mfma_f32_16x16x32_bf16 a[168:171], v[60:63], v[188:191], a[168:171]
    v_mfma_f32_16x16x32_bf16 a[168:171], v[64:67], v[224:227], a[168:171]
    v_mfma_f32_16x16x32_bf16 v[36:39], v[60:63], v[192:195], v[36:39]
    v_mfma_f32_16x16x32_bf16 v[36:39], v[64:67], v[228:231], v[36:39]
    v_mfma_f32_16x16x32_bf16 v[52:55], v[60:63], v[196:199], v[52:55]
    v_mfma_f32_16x16x32_bf16 v[52:55], v[64:67], v[232:235], v[52:55]
    s_waitcnt vmcnt(18)
    ds_read_b64_tr_b16 v[60:61], v18 offset:0
    ds_read_b64_tr_b16 v[62:63], v18 offset:4096
    ds_read_b64_tr_b16 v[64:65], v18 offset:8192
    ds_read_b64_tr_b16 v[66:67], v18 offset:12288
    s_waitcnt lgkmcnt(4)
    v_mfma_f32_16x16x32_bf16 a[172:175], v[68:71], v[164:167], a[172:175]
    s_add_u32 m0, s27, 16384
    v_mfma_f32_16x16x32_bf16 a[172:175], v[72:75], v[200:203], a[172:175]
    s_nop 0
    v_mfma_f32_16x16x32_bf16 a[176:179], v[68:71], v[168:171], a[176:179]
    buffer_load_dwordx4 v10, s[8:11], s26 offen offset:0 lds
    v_mfma_f32_16x16x32_bf16 a[176:179], v[72:75], v[204:207], a[176:179]
    buffer_load_dwordx4 v11, s[8:11], s26 offen offset:1024 lds
    v_mfma_f32_16x16x32_bf16 a[180:183], v[68:71], v[172:175], a[180:183]
    buffer_load_dwordx4 v12, s[8:11], s26 offen offset:2048 lds
    v_mfma_f32_16x16x32_bf16 a[180:183], v[72:75], v[208:211], a[180:183]
    buffer_load_dwordx4 v13, s[8:11], s26 offen offset:3072 lds
    v_mfma_f32_16x16x32_bf16 a[184:187], v[68:71], v[176:179], a[184:187]
    s_add_u32 m0, s27, 20480
    v_mfma_f32_16x16x32_bf16 a[184:187], v[72:75], v[212:215], a[184:187]
    s_nop 0
    v_mfma_f32_16x16x32_bf16 a[188:191], v[68:71], v[180:183], a[188:191]
    buffer_load_dwordx4 v14, s[8:11], s26 offen offset:0 lds
    v_mfma_f32_16x16x32_bf16 a[188:191], v[72:75], v[216:219], a[188:191]
    buffer_load_dwordx4 v15, s[8:11], s26 offen offset:1024 lds
    v_mfma_f32_16x16x32_bf16 a[192:195], v[68:71], v[184:187], a[192:195]
    buffer_load_dwordx4 v16, s[8:11], s26 offen offset:2048 lds
    v_mfma_f32_16x16x32_bf16 a[192:195], v[72:75], v[220:223], a[192:195]
    buffer_load_dwordx4 v17, s[8:11], s26 offen offset:3072 lds
    v_mfma_f32_16x16x32_bf16 a[196:199], v[68:71], v[188:191], a[196:199]
    s_add_u32 s26, s26, 163840
    v_mfma_f32_16x16x32_bf16 a[196:199], v[72:75], v[224:227], a[196:199]
    s_add_u32 m0, s27, 24576
    v_mfma_f32_16x16x32_bf16 v[40:43], v[68:71], v[192:195], v[40:43]
    s_nop 0
    v_mfma_f32_16x16x32_bf16 v[40:43], v[72:75], v[228:231], v[40:43]
    buffer_load_dwordx4 v10, s[8:11], s26 offen offset:0 lds
    v_mfma_f32_16x16x32_bf16 v[56:59], v[68:71], v[196:199], v[56:59]
    buffer_load_dwordx4 v11, s[8:11], s26 offen offset:1024 lds
    v_mfma_f32_16x16x32_bf16 v[56:59], v[72:75], v[232:235], v[56:59]
    ds_read_b64_tr_b16 v[68:69], v19 offset:0
    ds_read_b64_tr_b16 v[70:71], v19 offset:4096
    ds_read_b64_tr_b16 v[72:73], v19 offset:8192
    ds_read_b64_tr_b16 v[74:75], v19 offset:12288
    s_waitcnt lgkmcnt(12)
    v_mfma_f32_16x16x32_bf16 a[200:203], v[76:79], v[164:167], a[200:203]
    buffer_load_dwordx4 v12, s[8:11], s26 offen offset:2048 lds
    v_mfma_f32_16x16x32_bf16 a[200:203], v[80:83], v[200:203], a[200:203]
    buffer_load_dwordx4 v13, s[8:11], s26 offen offset:3072 lds
    v_mfma_f32_16x16x32_bf16 a[204:207], v[76:79], v[168:171], a[204:207]
    s_add_u32 m0, s27, 28672
    v_mfma_f32_16x16x32_bf16 a[204:207], v[80:83], v[204:207], a[204:207]
    s_nop 0
    v_mfma_f32_16x16x32_bf16 a[208:211], v[76:79], v[172:175], a[208:211]
    buffer_load_dwordx4 v14, s[8:11], s26 offen offset:0 lds
    v_mfma_f32_16x16x32_bf16 a[208:211], v[80:83], v[208:211], a[208:211]
    buffer_load_dwordx4 v15, s[8:11], s26 offen offset:1024 lds
    v_mfma_f32_16x16x32_bf16 a[212:215], v[76:79], v[176:179], a[212:215]
    buffer_load_dwordx4 v16, s[8:11], s26 offen offset:2048 lds
    v_mfma_f32_16x16x32_bf16 a[212:215], v[80:83], v[212:215], a[212:215]
    buffer_load_dwordx4 v17, s[8:11], s26 offen offset:3072 lds
    v_mfma_f32_16x16x32_bf16 v[244:247], v[76:79], v[180:183], v[244:247]
    s_add_u32 s26, s26, 163840
    v_mfma_f32_16x16x32_bf16 v[244:247], v[80:83], v[216:219], v[244:247]
    v_mfma_f32_16x16x32_bf16 a[216:219], v[76:79], v[184:187], a[216:219]
    v_mfma_f32_16x16x32_bf16 a[216:219], v[80:83], v[220:223], a[216:219]
    v_mfma_f32_16x16x32_bf16 v[28:31], v[76:79], v[188:191], v[28:31]
    v_mfma_f32_16x16x32_bf16 v[28:31], v[80:83], v[224:227], v[28:31]
    v_mfma_f32_16x16x32_bf16 v[44:47], v[76:79], v[192:195], v[44:47]
    v_mfma_f32_16x16x32_bf16 v[44:47], v[80:83], v[228:231], v[44:47]
    v_mfma_f32_16x16x32_bf16 v[236:239], v[76:79], v[196:199], v[236:239]
    v_mfma_f32_16x16x32_bf16 v[236:239], v[80:83], v[232:235], v[236:239]
    ds_read_b64_tr_b16 v[76:77], v20 offset:0
    ds_read_b64_tr_b16 v[78:79], v20 offset:4096
    ds_read_b64_tr_b16 v[80:81], v20 offset:8192
    ds_read_b64_tr_b16 v[82:83], v20 offset:12288
    s_waitcnt lgkmcnt(12)
    v_mfma_f32_16x16x32_bf16 a[220:223], v[84:87], v[164:167], a[220:223]
    v_mfma_f32_16x16x32_bf16 a[220:223], v[88:91], v[200:203], a[220:223]
    v_mfma_f32_16x16x32_bf16 a[224:227], v[84:87], v[168:171], a[224:227]
    v_mfma_f32_16x16x32_bf16 a[224:227], v[88:91], v[204:207], a[224:227]
    v_mfma_f32_16x16x32_bf16 a[228:231], v[84:87], v[172:175], a[228:231]
    v_mfma_f32_16x16x32_bf16 a[228:231], v[88:91], v[208:211], a[228:231]
    v_mfma_f32_16x16x32_bf16 a[232:235], v[84:87], v[176:179], a[232:235]
    v_mfma_f32_16x16x32_bf16 a[232:235], v[88:91], v[212:215], a[232:235]
    v_mfma_f32_16x16x32_bf16 v[248:251], v[84:87], v[180:183], v[248:251]
    v_mfma_f32_16x16x32_bf16 v[248:251], v[88:91], v[216:219], v[248:251]
    v_mfma_f32_16x16x32_bf16 a[236:239], v[84:87], v[184:187], a[236:239]
    v_mfma_f32_16x16x32_bf16 a[236:239], v[88:91], v[220:223], a[236:239]
    v_mfma_f32_16x16x32_bf16 v[32:35], v[84:87], v[188:191], v[32:35]
    v_mfma_f32_16x16x32_bf16 v[32:35], v[88:91], v[224:227], v[32:35]
    v_mfma_f32_16x16x32_bf16 v[48:51], v[84:87], v[192:195], v[48:51]
    v_mfma_f32_16x16x32_bf16 v[48:51], v[88:91], v[228:231], v[48:51]
    v_mfma_f32_16x16x32_bf16 v[240:243], v[84:87], v[196:199], v[240:243]
    v_mfma_f32_16x16x32_bf16 v[240:243], v[88:91], v[232:235], v[240:243]
    ds_read_b64_tr_b16 v[84:85], v21 offset:0
    ds_read_b64_tr_b16 v[86:87], v21 offset:4096
    ds_read_b64_tr_b16 v[88:89], v21 offset:8192
    ds_read_b64_tr_b16 v[90:91], v21 offset:12288
    s_add_u32 s21, s21, 1
    s_cmp_lt_u32 s21, 6
    s_cbranch_scc1 L_op_loop
    s_waitcnt vmcnt(16) lgkmcnt(12)
    v_mfma_f32_16x16x32_bf16 a[0:3], v[60:63], v[92:95], a[0:3]
    buffer_load_dwordx4 v[164:167], v7, s[4:7], s48 offen
    v_mfma_f32_16x16x32_bf16 a[0:3], v[64:67], v[128:131], a[0:3]
    buffer_load_dwordx4 v[168:171], v7, s[4:7], s49 offen
    v_mfma_f32_16x16x32_bf16 a[4:7], v[60:63], v[96:99], a[4:7]
    buffer_load_dwordx4 v[172:175], v7, s[4:7], s50 offen
    v_mfma_f32_16x16x32_bf16 a[4:7], v[64:67], v[132:135], a[4:7]
    buffer_load_dwordx4 v[176:179], v7, s[4:7], s51 offen
    v_mfma_f32_16x16x32_bf16 a[8:11], v[60:63], v[100:103], a[8:11]
    buffer_load_dwordx4 v[180:183], v7, s[4:7], s52 offen
    v_mfma_f32_16x16x32_bf16 a[8:11], v[64:67], v[136:139], a[8:11]
    buffer_load_dwordx4 v[184:187], v7, s[4:7], s53 offen
    v_mfma_f32_16x16x32_bf16 a[12:15], v[60:63], v[104:107], a[12:15]
    buffer_load_dwordx4 v[188:191], v7, s[4:7], s54 offen
    v_mfma_f32_16x16x32_bf16 a[12:15], v[64:67], v[140:143], a[12:15]
    buffer_load_dwordx4 v[192:195], v7, s[4:7], s55 offen
    v_mfma_f32_16x16x32_bf16 a[16:19], v[60:63], v[108:111], a[16:19]
    buffer_load_dwordx4 v[196:199], v7, s[4:7], s56 offen
    v_mfma_f32_16x16x32_bf16 a[16:19], v[64:67], v[144:147], a[16:19]
    v_add_u32 v7, 57344, v7
    v_mfma_f32_16x16x32_bf16 a[20:23], v[60:63], v[112:115], a[20:23]
    buffer_load_dwordx4 v[200:203], v7, s[4:7], s48 offen
    v_mfma_f32_16x16x32_bf16 a[20:23], v[64:67], v[148:151], a[20:23]
    buffer_load_dwordx4 v[204:207], v7, s[4:7], s49 offen
    v_mfma_f32_16x16x32_bf16 a[24:27], v[60:63], v[116:119], a[24:27]
    buffer_load_dwordx4 v[208:211], v7, s[4:7], s50 offen
    v_mfma_f32_16x16x32_bf16 a[24:27], v[64:67], v[152:155], a[24:27]
    buffer_load_dwordx4 v[212:215], v7, s[4:7], s51 offen
    v_mfma_f32_16x16x32_bf16 a[28:31], v[60:63], v[120:123], a[28:31]
    buffer_load_dwordx4 v[216:219], v7, s[4:7], s52 offen
    v_mfma_f32_16x16x32_bf16 a[28:31], v[64:67], v[156:159], a[28:31]
    buffer_load_dwordx4 v[220:223], v7, s[4:7], s53 offen
    v_mfma_f32_16x16x32_bf16 a[32:35], v[60:63], v[124:127], a[32:35]
    buffer_load_dwordx4 v[224:227], v7, s[4:7], s54 offen
    v_mfma_f32_16x16x32_bf16 a[32:35], v[64:67], v[160:163], a[32:35]
    ds_read_b64_tr_b16 v[60:61], v22 offset:0
    ds_read_b64_tr_b16 v[62:63], v22 offset:4096
    ds_read_b64_tr_b16 v[64:65], v22 offset:8192
    ds_read_b64_tr_b16 v[66:67], v22 offset:12288
    s_waitcnt lgkmcnt(12)
    v_mfma_f32_16x16x32_bf16 a[36:39], v[68:71], v[92:95], a[36:39]
    buffer_load_dwordx4 v[228:231], v7, s[4:7], s55 offen
    v_mfma_f32_16x16x32_bf16 a[36:39], v[72:75], v[128:131], a[36:39]
    buffer_load_dwordx4 v[232:235], v7, s[4:7], s56 offen
    v_mfma_f32_16x16x32_bf16 a[40:43], v[68:71], v[96:99], a[40:43]
    v_add_u32 v7, 57344, v7
    v_mfma_f32_16x16x32_bf16 a[40:43], v[72:75], v[132:135], a[40:43]
    v_mfma_f32_16x16x32_bf16 a[44:47], v[68:71], v[100:103], a[44:47]
    v_mfma_f32_16x16x32_bf16 a[44:47], v[72:75], v[136:139], a[44:47]
    v_mfma_f32_16x16x32_bf16 a[48:51], v[68:71], v[104:107], a[48:51]
    v_mfma_f32_16x16x32_bf16 a[48:51], v[72:75], v[140:143], a[48:51]
    v_mfma_f32_16x16x32_bf16 a[52:55], v[68:71], v[108:111], a[52:55]
    v_mfma_f32_16x16x32_bf16 a[52:55], v[72:75], v[144:147], a[52:55]
    v_mfma_f32_16x16x32_bf16 a[56:59], v[68:71], v[112:115], a[56:59]
    v_mfma_f32_16x16x32_bf16 a[56:59], v[72:75], v[148:151], a[56:59]
    v_mfma_f32_16x16x32_bf16 a[60:63], v[68:71], v[116:119], a[60:63]
    v_mfma_f32_16x16x32_bf16 a[60:63], v[72:75], v[152:155], a[60:63]
    v_mfma_f32_16x16x32_bf16 a[64:67], v[68:71], v[120:123], a[64:67]
    v_mfma_f32_16x16x32_bf16 a[64:67], v[72:75], v[156:159], a[64:67]
    v_mfma_f32_16x16x32_bf16 a[68:71], v[68:71], v[124:127], a[68:71]
    v_mfma_f32_16x16x32_bf16 a[68:71], v[72:75], v[160:163], a[68:71]
    ds_read_b64_tr_b16 v[68:69], v23 offset:0
    ds_read_b64_tr_b16 v[70:71], v23 offset:4096
    ds_read_b64_tr_b16 v[72:73], v23 offset:8192
    ds_read_b64_tr_b16 v[74:75], v23 offset:12288
    s_waitcnt lgkmcnt(12)
    v_mfma_f32_16x16x32_bf16 a[72:75], v[76:79], v[92:95], a[72:75]
    v_mfma_f32_16x16x32_bf16 a[72:75], v[80:83], v[128:131], a[72:75]
    v_mfma_f32_16x16x32_bf16 a[76:79], v[76:79], v[96:99], a[76:79]
    v_mfma_f32_16x16x32_bf16 a[76:79], v[80:83], v[132:135], a[76:79]
    v_mfma_f32_16x16x32_bf16 a[80:83], v[76:79], v[100:103], a[80:83]
    v_mfma_f32_16x16x32_bf16 a[80:83], v[80:83], v[136:139], a[80:83]
    v_mfma_f32_16x16x32_bf16 a[84:87], v[76:79], v[104:107], a[84:87]
    v_mfma_f32_16x16x32_bf16 a[84:87], v[80:83], v[140:143], a[84:87]
    v_mfma_f32_16x16x32_bf16 a[88:91], v[76:79], v[108:111], a[88:91]
    v_mfma_f32_16x16x32_bf16 a[88:91], v[80:83], v[144:147], a[88:91]
    v_mfma_f32_16x16x32_bf16 a[92:95], v[76:79], v[112:115], a[92:95]
    v_mfma_f32_16x16x32_bf16 a[92:95], v[80:83], v[148:151], a[92:95]
    v_mfma_f32_16x16x32_bf16 a[96:99], v[76:79], v[116:119], a[96:99]
    v_mfma_f32_16x16x32_bf16 a[96:99], v[80:83], v[152:155], a[96:99]
    v_mfma_f32_16x16x32_bf16 a[100:103], v[76:79], v[120:123], a[100:103]
    v_mfma_f32_16x16x32_bf16 a[100:103], v[80:83], v[156:159], a[100:103]
    v_mfma_f32_16x16x32_bf16 a[104:107], v[76:79], v[124:127], a[104:107]
    v_mfma_f32_16x16x32_bf16 a[104:107], v[80:83], v[160:163], a[104:107]
    ds_read_b64_tr_b16 v[76:77], v24 offset:0
    ds_read_b64_tr_b16 v[78:79], v24 offset:4096
    ds_read_b64_tr_b16 v[80:81], v24 offset:8192
    ds_read_b64_tr_b16 v[82:83], v24 offset:12288
    s_waitcnt lgkmcnt(12)
    v_mfma_f32_16x16x32_bf16 a[108:111], v[84:87], v[92:95], a[108:111]
    v_mfma_f32_16x16x32_bf16 a[108:111], v[88:91], v[128:131], a[108:111]
    v_mfma_f32_16x16x32_bf16 a[112:115], v[84:87], v[96:99], a[112:115]
    v_mfma_f32_16x16x32_bf16 a[112:115], v[88:91], v[132:135], a[112:115]
    v_mfma_f32_16x16x32_bf16 a[116:119], v[84:87], v[100:103], a[116:119]
    v_mfma_f32_16x16x32_bf16 a[116:119], v[88:91], v[136:139], a[116:119]
    v_mfma_f32_16x16x32_bf16 a[120:123], v[84:87], v[104:107], a[120:123]
    v_mfma_f32_16x16x32_bf16 a[120:123], v[88:91], v[140:143], a[120:123]
    v_mfma_f32_16x16x32_bf16 a[124:127], v[84:87], v[108:111], a[124:127]
    v_mfma_f32_16x16x32_bf16 a[124:127], v[88:91], v[144:147], a[124:127]
    v_mfma_f32_16x16x32_bf16 a[128:131], v[84:87], v[112:115], a[128:131]
    v_mfma_f32_16x16x32_bf16 a[128:131], v[88:91], v[148:151], a[128:131]
    v_mfma_f32_16x16x32_bf16 a[132:135], v[84:87], v[116:119], a[132:135]
    v_mfma_f32_16x16x32_bf16 a[132:135], v[88:91], v[152:155], a[132:135]
    v_mfma_f32_16x16x32_bf16 a[136:139], v[84:87], v[120:123], a[136:139]
    v_mfma_f32_16x16x32_bf16 a[136:139], v[88:91], v[156:159], a[136:139]
    v_mfma_f32_16x16x32_bf16 a[140:143], v[84:87], v[124:127], a[140:143]
    v_mfma_f32_16x16x32_bf16 a[140:143], v[88:91], v[160:163], a[140:143]
    ds_read_b64_tr_b16 v[84:85], v25 offset:0
    ds_read_b64_tr_b16 v[86:87], v25 offset:4096
    ds_read_b64_tr_b16 v[88:89], v25 offset:8192
    ds_read_b64_tr_b16 v[90:91], v25 offset:12288
    s_waitcnt lgkmcnt(12)
    v_mfma_f32_16x16x32_bf16 a[144:147], v[60:63], v[92:95], a[144:147]
    v_mfma_f32_16x16x32_bf16 a[144:147], v[64:67], v[128:131], a[144:147]
    v_mfma_f32_16x16x32_bf16 a[148:151], v[60:63], v[96:99], a[148:151]
    v_mfma_f32_16x16x32_bf16 a[148:151], v[64:67], v[132:135], a[148:151]
    v_mfma_f32_16x16x32_bf16 a[152:155], v[60:63], v[100:103], a[152:155]
    v_mfma_f32_16x16x32_bf16 a[152:155], v[64:67], v[136:139], a[152:155]
    v_mfma_f32_16x16x32_bf16 a[156:159], v[60:63], v[104:107], a[156:159]
    v_mfma_f32_16x16x32_bf16 a[156:159], v[64:67], v[140:143], a[156:159]
    v_mfma_f32_16x16x32_bf16 a[160:163], v[60:63], v[108:111], a[160:163]
    v_mfma_f32_16x16x32_bf16 a[160:163], v[64:67], v[144:147], a[160:163]
    v_mfma_f32_16x16x32_bf16 a[164:167], v[60:63], v[112:115], a[164:167]
    v_mfma_f32_16x16x32_bf16 a[164:167], v[64:67], v[148:151], a[164:167]
    v_mfma_f32_16x16x32_bf16 a[168:171], v[60:63], v[116:119], a[168:171]
    v_mfma_f32_16x16x32_bf16 a[168:171], v[64:67], v[152:155], a[168:171]
    v_mfma_f32_16x16x32_bf16 v[36:39], v[60:63], v[120:123], v[36:39]
    v_mfma_f32_16x16x32_bf16 v[36:39], v[64:67], v[156:159], v[36:39]
    v_mfma_f32_16x16x32_bf16 v[52:55], v[60:63], v[124:127], v[52:55]
    v_mfma_f32_16x16x32_bf16 v[52:55], v[64:67], v[160:163], v[52:55]
    s_waitcnt vmcnt(18)
    ds_read_b64_tr_b16 v[60:61], v18 offset:16384
    ds_read_b64_tr_b16 v[62:63], v18 offset:20480
    ds_read_b64_tr_b16 v[64:65], v18 offset:24576
    ds_read_b64_tr_b16 v[66:67], v18 offset:28672
    s_waitcnt lgkmcnt(12)
    v_mfma_f32_16x16x32_bf16 a[172:175], v[68:71], v[92:95], a[172:175]
    v_mfma_f32_16x16x32_bf16 a[172:175], v[72:75], v[128:131], a[172:175]
    v_mfma_f32_16x16x32_bf16 a[176:179], v[68:71], v[96:99], a[176:179]
    v_mfma_f32_16x16x32_bf16 a[176:179], v[72:75], v[132:135], a[176:179]
    v_mfma_f32_16x16x32_bf16 a[180:183], v[68:71], v[100:103], a[180:183]
    v_mfma_f32_16x16x32_bf16 a[180:183], v[72:75], v[136:139], a[180:183]
    v_mfma_f32_16x16x32_bf16 a[184:187], v[68:71], v[104:107], a[184:187]
    v_mfma_f32_16x16x32_bf16 a[184:187], v[72:75], v[140:143], a[184:187]
    v_mfma_f32_16x16x32_bf16 a[188:191], v[68:71], v[108:111], a[188:191]
    v_mfma_f32_16x16x32_bf16 a[188:191], v[72:75], v[144:147], a[188:191]
    v_mfma_f32_16x16x32_bf16 a[192:195], v[68:71], v[112:115], a[192:195]
    v_mfma_f32_16x16x32_bf16 a[192:195], v[72:75], v[148:151], a[192:195]
    v_mfma_f32_16x16x32_bf16 a[196:199], v[68:71], v[116:119], a[196:199]
    v_mfma_f32_16x16x32_bf16 a[196:199], v[72:75], v[152:155], a[196:199]
    v_mfma_f32_16x16x32_bf16 v[40:43], v[68:71], v[120:123], v[40:43]
    v_mfma_f32_16x16x32_bf16 v[40:43], v[72:75], v[156:159], v[40:43]
    v_mfma_f32_16x16x32_bf16 v[56:59], v[68:71], v[124:127], v[56:59]
    v_mfma_f32_16x16x32_bf16 v[56:59], v[72:75], v[160:163], v[56:59]
    ds_read_b64_tr_b16 v[68:69], v19 offset:16384
    ds_read_b64_tr_b16 v[70:71], v19 offset:20480
    ds_read_b64_tr_b16 v[72:73], v19 offset:24576
    ds_read_b64_tr_b16 v[74:75], v19 offset:28672
    s_waitcnt lgkmcnt(12)
    v_mfma_f32_16x16x32_bf16 a[200:203], v[76:79], v[92:95], a[200:203]
    v_mfma_f32_16x16x32_bf16 a[200:203], v[80:83], v[128:131], a[200:203]
    v_mfma_f32_16x16x32_bf16 a[204:207], v[76:79], v[96:99], a[204:207]
    v_mfma_f32_16x16x32_bf16 a[204:207], v[80:83], v[132:135], a[204:207]
    v_mfma_f32_16x16x32_bf16 a[208:211], v[76:79], v[100:103], a[208:211]
    v_mfma_f32_16x16x32_bf16 a[208:211], v[80:83], v[136:139], a[208:211]
    v_mfma_f32_16x16x32_bf16 a[212:215], v[76:79], v[104:107], a[212:215]
    v_mfma_f32_16x16x32_bf16 a[212:215], v[80:83], v[140:143], a[212:215]
    v_mfma_f32_16x16x32_bf16 v[244:247], v[76:79], v[108:111], v[244:247]
    v_mfma_f32_16x16x32_bf16 v[244:247], v[80:83], v[144:147], v[244:247]
    v_mfma_f32_16x16x32_bf16 a[216:219], v[76:79], v[112:115], a[216:219]
    v_mfma_f32_16x16x32_bf16 a[216:219], v[80:83], v[148:151], a[216:219]
    v_mfma_f32_16x16x32_bf16 v[28:31], v[76:79], v[116:119], v[28:31]
    v_mfma_f32_16x16x32_bf16 v[28:31], v[80:83], v[152:155], v[28:31]
    v_mfma_f32_16x16x32_bf16 v[44:47], v[76:79], v[120:123], v[44:47]
    v_mfma_f32_16x16x32_bf16 v[44:47], v[80:83], v[156:159], v[44:47]
    v_mfma_f32_16x16x32_bf16 v[236:239], v[76:79], v[124:127], v[236:239]
    v_mfma_f32_16x16x32_bf16 v[236:239], v[80:83], v[160:163], v[236:239]
    ds_read_b64_tr_b16 v[76:77], v20 offset:16384
    ds_read_b64_tr_b16 v[78:79], v20 offset:20480
    ds_read_b64_tr_b16 v[80:81], v20 offset:24576
    ds_read_b64_tr_b16 v[82:83], v20 offset:28672
    s_waitcnt lgkmcnt(12)
    v_mfma_f32_16x16x32_bf16 a[220:223], v[84:87], v[92:95], a[220:223]
    v_mfma_f32_16x16x32_bf16 a[220:223], v[88:91], v[128:131], a[220:223]
    v_mfma_f32_16x16x32_bf16 a[224:227], v[84:87], v[96:99], a[224:227]
    v_mfma_f32_16x16x32_bf16 a[224:227], v[88:91], v[132:135], a[224:227]
    v_mfma_f32_16x16x32_bf16 a[228:231], v[84:87], v[100:103], a[228:231]
    v_mfma_f32_16x16x32_bf16 a[228:231], v[88:91], v[136:139], a[228:231]
    v_mfma_f32_16x16x32_bf16 a[232:235], v[84:87], v[104:107], a[232:235]
    v_mfma_f32_16x16x32_bf16 a[232:235], v[88:91], v[140:143], a[232:235]
    v_mfma_f32_16x16x32_bf16 v[248:251], v[84:87], v[108:111], v[248:251]
    v_mfma_f32_16x16x32_bf16 v[248:251], v[88:91], v[144:147], v[248:251]
    v_mfma_f32_16x16x32_bf16 a[236:239], v[84:87], v[112:115], a[236:239]
    v_mfma_f32_16x16x32_bf16 a[236:239], v[88:91], v[148:151], a[236:239]
    v_mfma_f32_16x16x32_bf16 v[32:35], v[84:87], v[116:119], v[32:35]
    v_mfma_f32_16x16x32_bf16 v[32:35], v[88:91], v[152:155], v[32:35]
    v_mfma_f32_16x16x32_bf16 v[48:51], v[84:87], v[120:123], v[48:51]
    v_mfma_f32_16x16x32_bf16 v[48:51], v[88:91], v[156:159], v[48:51]
    v_mfma_f32_16x16x32_bf16 v[240:243], v[84:87], v[124:127], v[240:243]
    v_mfma_f32_16x16x32_bf16 v[240:243], v[88:91], v[160:163], v[240:243]
    ds_read_b64_tr_b16 v[84:85], v21 offset:16384
    ds_read_b64_tr_b16 v[86:87], v21 offset:20480
    ds_read_b64_tr_b16 v[88:89], v21 offset:24576
    ds_read_b64_tr_b16 v[90:91], v21 offset:28672
    s_waitcnt vmcnt(0) lgkmcnt(12)
    v_mfma_f32_16x16x32_bf16 a[0:3], v[60:63], v[164:167], a[0:3]
    ds_read_b64_tr_b16 v[92:93], v22 offset:16384
    ds_read_b64_tr_b16 v[94:95], v22 offset:20480
    v_mfma_f32_16x16x32_bf16 a[0:3], v[64:67], v[200:203], a[0:3]
    ds_read_b64_tr_b16 v[96:97], v22 offset:24576
    ds_read_b64_tr_b16 v[98:99], v22 offset:28672
    v_mfma_f32_16x16x32_bf16 a[4:7], v[60:63], v[168:171], a[4:7]
    ds_read_b64_tr_b16 v[100:101], v23 offset:16384
    ds_read_b64_tr_b16 v[102:103], v23 offset:20480
    v_mfma_f32_16x16x32_bf16 a[4:7], v[64:67], v[204:207], a[4:7]
    ds_read_b64_tr_b16 v[104:105], v23 offset:24576
    ds_read_b64_tr_b16 v[106:107], v23 offset:28672
    v_mfma_f32_16x16x32_bf16 a[8:11], v[60:63], v[172:175], a[8:11]
    ds_read_b64_tr_b16 v[108:109], v24 offset:16384
    ds_read_b64_tr_b16 v[110:111], v24 offset:20480
    v_mfma_f32_16x16x32_bf16 a[8:11], v[64:67], v[208:211], a[8:11]
    ds_read_b64_tr_b16 v[112:113], v24 offset:24576
    ds_read_b64_tr_b16 v[114:115], v24 offset:28672
    v_mfma_f32_16x16x32_bf16 a[20:23], v[60:63], v[184:187], a[20:23]
    ds_read_b64_tr_b16 v[116:117], v25 offset:16384
    ds_read_b64_tr_b16 v[118:119], v25 offset:20480
    v_mfma_f32_16x16x32_bf16 a[20:23], v[64:67], v[220:223], a[20:23]
    ds_read_b64_tr_b16 v[120:121], v25 offset:24576
    ds_read_b64_tr_b16 v[122:123], v25 offset:28672
    v_mfma_f32_16x16x32_bf16 a[24:27], v[60:63], v[188:191], a[24:27]
    ds_write_b128 v8, a[0:3] offset:2048
    v_mfma_f32_16x16x32_bf16 a[24:27], v[64:67], v[224:227], a[24:27]
    v_mfma_f32_16x16x32_bf16 a[28:31], v[60:63], v[192:195], a[28:31]
    v_mfma_f32_16x16x32_bf16 a[28:31], v[64:67], v[228:231], a[28:31]
    ds_write_b128 v8, a[4:7] offset:6144
    v_mfma_f32_16x16x32_bf16 a[32:35], v[60:63], v[196:199], a[32:35]
    v_mfma_f32_16x16x32_bf16 a[32:35], v[64:67], v[232:235], a[32:35]
    s_waitcnt lgkmcnt(15)
    v_mfma_f32_16x16x32_bf16 a[36:39], v[68:71], v[164:167], a[36:39]
    ds_write_b128 v8, a[8:11] offset:10240
    v_mfma_f32_16x16x32_bf16 a[36:39], v[72:75], v[200:203], a[36:39]
    v_mfma_f32_16x16x32_bf16 a[40:43], v[68:71], v[168:171], a[40:43]
    v_mfma_f32_16x16x32_bf16 a[40:43], v[72:75], v[204:207], a[40:43]
    ds_write_b128 v8, a[20:23] offset:14336
    v_mfma_f32_16x16x32_bf16 a[44:47], v[68:71], v[172:175], a[44:47]
    v_mfma_f32_16x16x32_bf16 a[44:47], v[72:75], v[208:211], a[44:47]
    v_mfma_f32_16x16x32_bf16 a[56:59], v[68:71], v[184:187], a[56:59]
    ds_write_b128 v8, a[24:27] offset:18432
    v_mfma_f32_16x16x32_bf16 a[56:59], v[72:75], v[220:223], a[56:59]
    v_mfma_f32_16x16x32_bf16 a[60:63], v[68:71], v[188:191], a[60:63]
    v_mfma_f32_16x16x32_bf16 a[60:63], v[72:75], v[224:227], a[60:63]
    ds_write_b128 v8, a[28:31] offset:22528
    v_mfma_f32_16x16x32_bf16 a[64:67], v[68:71], v[192:195], a[64:67]
    v_mfma_f32_16x16x32_bf16 a[64:67], v[72:75], v[228:231], a[64:67]
    v_mfma_f32_16x16x32_bf16 a[72:75], v[76:79], v[164:167], a[72:75]
    ds_write_b128 v8, a[32:35] offset:26624
    v_mfma_f32_16x16x32_bf16 a[72:75], v[80:83], v[200:203], a[72:75]
    v_mfma_f32_16x16x32_bf16 a[76:79], v[76:79], v[168:171], a[76:79]
    v_mfma_f32_16x16x32_bf16 a[76:79], v[80:83], v[204:207], a[76:79]
    ds_write_b128 v8, a[36:39] offset:3072
    v_mfma_f32_16x16x32_bf16 a[80:83], v[76:79], v[172:175], a[80:83]
    v_mfma_f32_16x16x32_bf16 a[80:83], v[80:83], v[208:211], a[80:83]
    v_mfma_f32_16x16x32_bf16 a[84:87], v[76:79], v[176:179], a[84:87]
    ds_write_b128 v8, a[40:43] offset:7168
    v_mfma_f32_16x16x32_bf16 a[84:87], v[80:83], v[212:215], a[84:87]
    v_mfma_f32_16x16x32_bf16 a[92:95], v[76:79], v[184:187], a[92:95]
    v_mfma_f32_16x16x32_bf16 a[92:95], v[80:83], v[220:223], a[92:95]
    ds_write_b128 v8, a[44:47] offset:11264
    v_mfma_f32_16x16x32_bf16 a[96:99], v[76:79], v[188:191], a[96:99]
    v_mfma_f32_16x16x32_bf16 a[96:99], v[80:83], v[224:227], a[96:99]
    v_mfma_f32_16x16x32_bf16 a[100:103], v[76:79], v[192:195], a[100:103]
    ds_write_b128 v8, a[56:59] offset:15360
    v_mfma_f32_16x16x32_bf16 a[100:103], v[80:83], v[228:231], a[100:103]
    v_mfma_f32_16x16x32_bf16 a[108:111], v[84:87], v[164:167], a[108:111]
    v_mfma_f32_16x16x32_bf16 a[108:111], v[88:91], v[200:203], a[108:111]
    ds_write_b128 v8, a[60:63] offset:19456
    v_mfma_f32_16x16x32_bf16 a[112:115], v[84:87], v[168:171], a[112:115]
    v_mfma_f32_16x16x32_bf16 a[112:115], v[88:91], v[204:207], a[112:115]
    v_mfma_f32_16x16x32_bf16 a[116:119], v[84:87], v[172:175], a[116:119]
    ds_write_b128 v8, a[64:67] offset:23552
    v_mfma_f32_16x16x32_bf16 a[116:119], v[88:91], v[208:211], a[116:119]
    v_mfma_f32_16x16x32_bf16 a[120:123], v[84:87], v[176:179], a[120:123]
    v_mfma_f32_16x16x32_bf16 a[120:123], v[88:91], v[212:215], a[120:123]
    ds_write_b128 v8, a[72:75] offset:0
    v_mfma_f32_16x16x32_bf16 a[128:131], v[84:87], v[184:187], a[128:131]
    v_mfma_f32_16x16x32_bf16 a[128:131], v[88:91], v[220:223], a[128:131]
    v_mfma_f32_16x16x32_bf16 a[132:135], v[84:87], v[188:191], a[132:135]
    ds_write_b128 v8, a[76:79] offset:4096
    v_mfma_f32_16x16x32_bf16 a[132:135], v[88:91], v[224:227], a[132:135]
    v_mfma_f32_16x16x32_bf16 a[136:139], v[84:87], v[192:195], a[136:139]
    v_mfma_f32_16x16x32_bf16 a[136:139], v[88:91], v[228:231], a[136:139]
    ds_write_b128 v8, a[80:83] offset:8192
    s_waitcnt lgkmcnt(15)
    v_mfma_f32_16x16x32_bf16 a[200:203], v[108:111], v[164:167], a[200:203]
    v_mfma_f32_16x16x32_bf16 a[200:203], v[112:115], v[200:203], a[200:203]
    v_mfma_f32_16x16x32_bf16 a[220:223], v[116:119], v[164:167], a[220:223]
    ds_write_b128 v8, a[84:87] offset:12288
    v_mfma_f32_16x16x32_bf16 a[220:223], v[120:123], v[200:203], a[220:223]
    v_mfma_f32_16x16x32_bf16 a[144:147], v[92:95], v[164:167], a[144:147]
    v_mfma_f32_16x16x32_bf16 a[144:147], v[96:99], v[200:203], a[144:147]
    ds_write_b128 v8, a[92:95] offset:16384
    v_mfma_f32_16x16x32_bf16 a[172:175], v[100:103], v[164:167], a[172:175]
    v_mfma_f32_16x16x32_bf16 a[172:175], v[104:107], v[200:203], a[172:175]
    v_mfma_f32_16x16x32_bf16 a[204:207], v[108:111], v[168:171], a[204:207]
    ds_write_b128 v8, a[96:99] offset:20480
    v_mfma_f32_16x16x32_bf16 a[204:207], v[112:115], v[204:207], a[204:207]
    v_mfma_f32_16x16x32_bf16 a[224:227], v[116:119], v[168:171], a[224:227]
    v_mfma_f32_16x16x32_bf16 a[224:227], v[120:123], v[204:207], a[224:227]
    ds_write_b128 v8, a[100:103] offset:24576
    v_mfma_f32_16x16x32_bf16 a[148:151], v[92:95], v[168:171], a[148:151]
    v_mfma_f32_16x16x32_bf16 a[148:151], v[96:99], v[204:207], a[148:151]
    v_mfma_f32_16x16x32_bf16 a[176:179], v[100:103], v[168:171], a[176:179]
    ds_write_b128 v8, a[108:111] offset:1024
    v_mfma_f32_16x16x32_bf16 a[176:179], v[104:107], v[204:207], a[176:179]
    v_mfma_f32_16x16x32_bf16 a[208:211], v[108:111], v[172:175], a[208:211]
    v_mfma_f32_16x16x32_bf16 a[208:211], v[112:115], v[208:211], a[208:211]
    ds_write_b128 v8, a[112:115] offset:5120
    v_mfma_f32_16x16x32_bf16 a[228:231], v[116:119], v[172:175], a[228:231]
    v_mfma_f32_16x16x32_bf16 a[228:231], v[120:123], v[208:211], a[228:231]
    v_mfma_f32_16x16x32_bf16 a[152:155], v[92:95], v[172:175], a[152:155]
    ds_write_b128 v8, a[116:119] offset:9216
    v_mfma_f32_16x16x32_bf16 a[152:155], v[96:99], v[208:211], a[152:155]
    v_mfma_f32_16x16x32_bf16 a[180:183], v[100:103], v[172:175], a[180:183]
    v_mfma_f32_16x16x32_bf16 a[180:183], v[104:107], v[208:211], a[180:183]
    ds_write_b128 v8, a[120:123] offset:13312
    v_mfma_f32_16x16x32_bf16 a[212:215], v[108:111], v[176:179], a[212:215]
    v_mfma_f32_16x16x32_bf16 a[212:215], v[112:115], v[212:215], a[212:215]
    v_mfma_f32_16x16x32_bf16 a[12:15], v[60:63], v[176:179], a[12:15]
    ds_write_b128 v8, a[128:131] offset:17408
    v_mfma_f32_16x16x32_bf16 a[12:15], v[64:67], v[212:215], a[12:15]
    v_mfma_f32_16x16x32_bf16 a[48:51], v[68:71], v[176:179], a[48:51]
    v_mfma_f32_16x16x32_bf16 a[48:51], v[72:75], v[212:215], a[48:51]
    ds_write_b128 v8, a[132:135] offset:21504
    v_mfma_f32_16x16x32_bf16 a[16:19], v[60:63], v[180:183], a[16:19]
    v_mfma_f32_16x16x32_bf16 a[16:19], v[64:67], v[216:219], a[16:19]
    v_mfma_f32_16x16x32_bf16 a[52:55], v[68:71], v[180:183], a[52:55]
    ds_write_b128 v8, a[136:139] offset:25600
    v_mfma_f32_16x16x32_bf16 a[52:55], v[72:75], v[216:219], a[52:55]
    v_mfma_f32_16x16x32_bf16 a[68:71], v[68:71], v[196:199], a[68:71]
    v_mfma_f32_16x16x32_bf16 a[68:71], v[72:75], v[232:235], a[68:71]
    ds_write_b128 v8, a[200:203] offset:27648
    v_mfma_f32_16x16x32_bf16 a[104:107], v[76:79], v[196:199], a[104:107]
    v_mfma_f32_16x16x32_bf16 a[104:107], v[80:83], v[232:235], a[104:107]
    v_mfma_f32_16x16x32_bf16 a[140:143], v[84:87], v[196:199], a[140:143]
    ds_write_b128 v8, a[220:223] offset:28672
    v_mfma_f32_16x16x32_bf16 a[140:143], v[88:91], v[232:235], a[140:143]
    v_mfma_f32_16x16x32_bf16 a[88:91], v[76:79], v[180:183], a[88:91]
    v_mfma_f32_16x16x32_bf16 a[88:91], v[80:83], v[216:219], a[88:91]
    ds_write_b128 v8, a[144:147] offset:29696
    v_mfma_f32_16x16x32_bf16 a[124:127], v[84:87], v[180:183], a[124:127]
    v_mfma_f32_16x16x32_bf16 a[124:127], v[88:91], v[216:219], a[124:127]
    v_mfma_f32_16x16x32_bf16 a[232:235], v[116:119], v[176:179], a[232:235]
    ds_write_b128 v8, a[172:175] offset:30720
    v_mfma_f32_16x16x32_bf16 a[232:235], v[120:123], v[212:215], a[232:235]
    v_mfma_f32_16x16x32_bf16 a[156:159], v[92:95], v[176:179], a[156:159]
    v_mfma_f32_16x16x32_bf16 a[156:159], v[96:99], v[212:215], a[156:159]
    ds_write_b128 v8, a[204:207] offset:31744
    v_mfma_f32_16x16x32_bf16 a[184:187], v[100:103], v[176:179], a[184:187]
    v_mfma_f32_16x16x32_bf16 a[184:187], v[104:107], v[212:215], a[184:187]
    v_mfma_f32_16x16x32_bf16 a[160:163], v[92:95], v[180:183], a[160:163]
    ds_write_b128 v8, a[224:227] offset:32768
    v_mfma_f32_16x16x32_bf16 a[160:163], v[96:99], v[216:219], a[160:163]
    v_mfma_f32_16x16x32_bf16 a[188:191], v[100:103], v[180:183], a[188:191]
    v_mfma_f32_16x16x32_bf16 a[188:191], v[104:107], v[216:219], a[188:191]
    ds_write_b128 v8, a[148:151] offset:33792
    v_mfma_f32_16x16x32_bf16 a[164:167], v[92:95], v[184:187], a[164:167]
    v_mfma_f32_16x16x32_bf16 a[164:167], v[96:99], v[220:223], a[164:167]
    v_mfma_f32_16x16x32_bf16 a[192:195], v[100:103], v[184:187], a[192:195]
    ds_write_b128 v8, a[176:179] offset:34816
    v_mfma_f32_16x16x32_bf16 a[192:195], v[104:107], v[220:223], a[192:195]
    v_mfma_f32_16x16x32_bf16 a[216:219], v[108:111], v[184:187], a[216:219]
    v_mfma_f32_16x16x32_bf16 a[216:219], v[112:115], v[220:223], a[216:219]
    ds_write_b128 v8, a[208:211] offset:35840
    v_mfma_f32_16x16x32_bf16 a[236:239], v[116:119], v[184:187], a[236:239]
    v_mfma_f32_16x16x32_bf16 a[236:239], v[120:123], v[220:223], a[236:239]
    v_mfma_f32_16x16x32_bf16 a[168:171], v[92:95], v[188:191], a[168:171]
    ds_write_b128 v8, a[228:231] offset:36864
    v_mfma_f32_16x16x32_bf16 a[168:171], v[96:99], v[224:227], a[168:171]
    v_mfma_f32_16x16x32_bf16 a[196:199], v[100:103], v[188:191], a[196:199]
    v_mfma_f32_16x16x32_bf16 a[196:199], v[104:107], v[224:227], a[196:199]
    ds_write_b128 v8, a[152:155] offset:37888
    v_mfma_f32_16x16x32_bf16 v[28:31], v[108:111], v[188:191], v[28:31]
    v_mfma_f32_16x16x32_bf16 v[28:31], v[112:115], v[224:227], v[28:31]
    v_mfma_f32_16x16x32_bf16 v[32:35], v[116:119], v[188:191], v[32:35]
    ds_write_b128 v8, a[180:183] offset:38912
    v_mfma_f32_16x16x32_bf16 v[32:35], v[120:123], v[224:227], v[32:35]
    v_mfma_f32_16x16x32_bf16 v[36:39], v[92:95], v[192:195], v[36:39]
    v_mfma_f32_16x16x32_bf16 v[36:39], v[96:99], v[228:231], v[36:39]
    ds_write_b128 v8, a[212:215] offset:39936
    v_mfma_f32_16x16x32_bf16 v[40:43], v[100:103], v[192:195], v[40:43]
    v_mfma_f32_16x16x32_bf16 v[40:43], v[104:107], v[228:231], v[40:43]
    v_mfma_f32_16x16x32_bf16 v[44:47], v[108:111], v[192:195], v[44:47]
    v_mfma_f32_16x16x32_bf16 v[44:47], v[112:115], v[228:231], v[44:47]
    v_mfma_f32_16x16x32_bf16 v[48:51], v[116:119], v[192:195], v[48:51]
    v_mfma_f32_16x16x32_bf16 v[48:51], v[120:123], v[228:231], v[48:51]
    v_mfma_f32_16x16x32_bf16 v[52:55], v[92:95], v[196:199], v[52:55]
    v_mfma_f32_16x16x32_bf16 v[52:55], v[96:99], v[232:235], v[52:55]
    v_mfma_f32_16x16x32_bf16 v[56:59], v[100:103], v[196:199], v[56:59]
    v_mfma_f32_16x16x32_bf16 v[56:59], v[104:107], v[232:235], v[56:59]
    v_mfma_f32_16x16x32_bf16 v[236:239], v[108:111], v[196:199], v[236:239]
    v_mfma_f32_16x16x32_bf16 v[236:239], v[112:115], v[232:235], v[236:239]
    v_mfma_f32_16x16x32_bf16 v[240:243], v[116:119], v[196:199], v[240:243]
    v_mfma_f32_16x16x32_bf16 v[240:243], v[120:123], v[232:235], v[240:243]
    v_mfma_f32_16x16x32_bf16 v[244:247], v[108:111], v[180:183], v[244:247]
    v_mfma_f32_16x16x32_bf16 v[244:247], v[112:115], v[216:219], v[244:247]
    v_mfma_f32_16x16x32_bf16 v[248:251], v[116:119], v[180:183], v[248:251]
    v_mfma_f32_16x16x32_bf16 v[248:251], v[120:123], v[216:219], v[248:251]
    s_and_b32 s62, s20, 1
    s_lshl_b32 s62, s62, 7
    s_add_u32 s23, s24, s62
    s_lshr_b32 s62, s20, 1
    s_lshl_b32 s59, s62, 6
    s_add_u32 s59, s59, s23
    s_add_u32 s59, s59, 163840
    s_mul_i32 s62, s62, 5
    s_mul_i32 s22, s62, 40960
    s_add_u32 s23, s23, s22
    s_add_u32 s62, s62, s31
    s_add_u32 s62, s62, 3
    s_cmp_ge_u32 s62, 224
    s_cselect_b32 s22, 0x40000000, 0
    s_add_u32 s22, s22, 122880
    s_add_u32 s22, s22, s23
    s_waitcnt lgkmcnt(0)
    s_barrier
    ds_read_b128 v[60:63], v2 offset:0
    ds_read_b128 v[64:67], v2 offset:1024
    ds_read_b128 v[68:71], v2 offset:2048
    ds_read_b128 v[72:75], v2 offset:3072
    ds_read_b128 v[76:79], v3 offset:14336
    ds_read_b128 v[80:83], v3 offset:15360
    ds_read_b128 v[84:87], v3 offset:16384
    ds_read_b128 v[88:91], v3 offset:17408
    ds_read_b128 v[92:95], v4 offset:27648
    ds_read_b128 v[96:99], v4 offset:28672
    ds_read_b128 v[100:103], v4 offset:29696
    ds_read_b128 v[104:107], v4 offset:30720
    v_accvgpr_read_b32 v220, a164
    v_accvgpr_read_b32 v221, a165
    v_accvgpr_read_b32 v222, a166
    v_accvgpr_read_b32 v223, a167
    v_accvgpr_read_b32 v224, a192
    v_accvgpr_read_b32 v225, a193
    v_accvgpr_read_b32 v226, a194
    v_accvgpr_read_b32 v227, a195
    v_accvgpr_read_b32 v228, a216
    v_accvgpr_read_b32 v229, a217
    v_accvgpr_read_b32 v230, a218
    v_accvgpr_read_b32 v231, a219
    v_accvgpr_read_b32 v232, a236
    v_accvgpr_read_b32 v233, a237
    v_accvgpr_read_b32 v234, a238
    v_accvgpr_read_b32 v235, a239
    v_accvgpr_read_b32 v10, a168
    v_accvgpr_read_b32 v11, a169
    v_accvgpr_read_b32 v12, a170
    v_accvgpr_read_b32 v13, a171
    v_accvgpr_read_b32 v14, a196
    v_accvgpr_read_b32 v15, a197
    v_accvgpr_read_b32 v16, a198
    v_accvgpr_read_b32 v17, a199
    ds_read_b128 v[108:111], v2 offset:4096
    ds_read_b128 v[112:115], v2 offset:5120
    ds_read_b128 v[116:119], v2 offset:6144
    ds_read_b128 v[120:123], v2 offset:7168
    ds_read_b128 v[124:127], v3 offset:18432
    ds_read_b128 v[128:131], v3 offset:19456
    ds_read_b128 v[132:135], v3 offset:20480
    ds_read_b128 v[136:139], v3 offset:21504
    ds_read_b128 v[140:143], v4 offset:31744
    ds_read_b128 v[144:147], v4 offset:32768
    ds_read_b128 v[148:151], v4 offset:33792
    ds_read_b128 v[152:155], v4 offset:34816
    s_waitcnt lgkmcnt(12)
    v_pk_add_f32 v[76:77], v[76:77], v[92:93]
    v_pk_add_f32 v[78:79], v[78:79], v[94:95]
    ds_read_b128 v[156:159], v2 offset:8192
    v_pk_add_f32 v[80:81], v[80:81], v[96:97]
    v_pk_add_f32 v[82:83], v[82:83], v[98:99]
    ds_read_b128 v[160:163], v2 offset:9216
    v_pk_add_f32 v[84:85], v[84:85], v[100:101]
    v_pk_add_f32 v[86:87], v[86:87], v[102:103]
    ds_read_b128 v[164:167], v2 offset:10240
    v_pk_add_f32 v[88:89], v[88:89], v[104:105]
    v_pk_add_f32 v[90:91], v[90:91], v[106:107]
    ds_read_b128 v[168:171], v2 offset:11264
    v_pk_add_f32 v[220:221], v[220:221], v[60:61]
    v_pk_add_f32 v[222:223], v[222:223], v[62:63]
    ds_read_b128 v[172:175], v3 offset:22528
    v_pk_add_f32 v[224:225], v[224:225], v[64:65]
    v_pk_add_f32 v[226:227], v[226:227], v[66:67]
    ds_read_b128 v[176:179], v3 offset:23552
    v_pk_add_f32 v[228:229], v[228:229], v[68:69]
    v_pk_add_f32 v[230:231], v[230:231], v[70:71]
    ds_read_b128 v[180:183], v3 offset:24576
    v_pk_add_f32 v[232:233], v[232:233], v[72:73]
    v_pk_add_f32 v[234:235], v[234:235], v[74:75]
    ds_read_b128 v[184:187], v3 offset:25600
    v_pk_add_f32 v[220:221], v[220:221], v[76:77]
    v_pk_add_f32 v[222:223], v[222:223], v[78:79]
    ds_read_b128 v[188:191], v4 offset:35840
    v_pk_add_f32 v[224:225], v[224:225], v[80:81]
    v_pk_add_f32 v[226:227], v[226:227], v[82:83]
    ds_read_b128 v[192:195], v4 offset:36864
    v_pk_add_f32 v[228:229], v[228:229], v[84:85]
    v_pk_add_f32 v[230:231], v[230:231], v[86:87]
    ds_read_b128 v[196:199], v4 offset:37888
    v_pk_add_f32 v[232:233], v[232:233], v[88:89]
    v_pk_add_f32 v[234:235], v[234:235], v[90:91]
    ds_read_b128 v[200:203], v4 offset:38912
    v_cvt_pk_bf16_f32 v60, v220, v221
    v_cvt_pk_bf16_f32 v61, v222, v223
    v_cvt_pk_bf16_f32 v62, v224, v225
    ds_read_b128 v[204:207], v2 offset:12288
    v_cvt_pk_bf16_f32 v63, v226, v227
    v_cvt_pk_bf16_f32 v64, v228, v229
    v_cvt_pk_bf16_f32 v65, v230, v231
    ds_read_b128 v[208:211], v3 offset:26624
    v_cvt_pk_bf16_f32 v66, v232, v233
    v_cvt_pk_bf16_f32 v67, v234, v235
    s_add_u32 s62, s23, 0
    ds_read_b128 v[212:215], v4 offset:39936
    v_permlane16_swap_b32 v60, v62
    v_permlane16_swap_b32 v61, v63
    v_permlane16_swap_b32 v64, v66
    ds_read_b128 v[216:219], v2 offset:13312
    v_permlane16_swap_b32 v65, v67
    s_mov_b64 vcc, s[64:65]
    s_nop 0
    v_cndmask_b32_dpp v68, v64, v60, vcc row_ror:8 row_mask:0xf bank_mask:0xf
    v_cndmask_b32_dpp v69, v65, v61, vcc row_ror:8 row_mask:0xf bank_mask:0xf
    v_cndmask_b32_dpp v70, v66, v62, vcc row_ror:8 row_mask:0xf bank_mask:0xf
    v_cndmask_b32_dpp v71, v67, v63, vcc row_ror:8 row_mask:0xf bank_mask:0xf
    s_mov_b64 vcc, s[66:67]
    buffer_store_dwordx4 v[68:71], v26, s[12:15], s62 offen sc0 sc1
    v_cndmask_b32_dpp v72, v64, v60, vcc row_ror:8 row_mask:0xf bank_mask:0xf
    v_cndmask_b32_dpp v73, v65, v61, vcc row_ror:8 row_mask:0xf bank_mask:0xf
    v_cndmask_b32_dpp v74, v66, v62, vcc row_ror:8 row_mask:0xf bank_mask:0xf
    v_cndmask_b32_dpp v75, v67, v63, vcc row_ror:8 row_mask:0xf bank_mask:0xf
    buffer_store_dwordx4 v[72:75], v27, s[12:15], s62 offen sc0 sc1
    s_waitcnt lgkmcnt(15)
    v_pk_add_f32 v[124:125], v[124:125], v[140:141]
    v_pk_add_f32 v[126:127], v[126:127], v[142:143]
    v_pk_add_f32 v[128:129], v[128:129], v[144:145]
    ds_write_b128 v2, a[12:15] offset:0
    v_pk_add_f32 v[130:131], v[130:131], v[146:147]
    v_pk_add_f32 v[132:133], v[132:133], v[148:149]
    v_pk_add_f32 v[134:135], v[134:135], v[150:151]
    ds_write_b128 v2, a[48:51] offset:1024
    v_pk_add_f32 v[136:137], v[136:137], v[152:153]
    v_pk_add_f32 v[138:139], v[138:139], v[154:155]
    v_pk_add_f32 v[10:11], v[10:11], v[108:109]
    ds_write_b128 v2, a[16:19] offset:2048
    v_pk_add_f32 v[12:13], v[12:13], v[110:111]
    v_pk_add_f32 v[14:15], v[14:15], v[112:113]
    v_pk_add_f32 v[16:17], v[16:17], v[114:115]
    ds_write_b128 v2, a[52:55] offset:3072
    v_pk_add_f32 v[28:29], v[28:29], v[116:117]
    v_pk_add_f32 v[30:31], v[30:31], v[118:119]
    v_pk_add_f32 v[32:33], v[32:33], v[120:121]
    ds_write_b128 v2, a[68:71] offset:4096
    v_pk_add_f32 v[34:35], v[34:35], v[122:123]
    v_pk_add_f32 v[10:11], v[10:11], v[124:125]
    v_pk_add_f32 v[12:13], v[12:13], v[126:127]
    ds_write_b128 v2, a[104:107] offset:5120
    v_pk_add_f32 v[14:15], v[14:15], v[128:129]
    v_pk_add_f32 v[16:17], v[16:17], v[130:131]
    v_pk_add_f32 v[28:29], v[28:29], v[132:133]
    ds_write_b128 v2, a[140:143] offset:6144
    v_pk_add_f32 v[30:31], v[30:31], v[134:135]
    v_pk_add_f32 v[32:33], v[32:33], v[136:137]
    v_pk_add_f32 v[34:35], v[34:35], v[138:139]
    ds_write_b128 v2, a[88:91] offset:7168
    v_cvt_pk_bf16_f32 v108, v10, v11
    v_cvt_pk_bf16_f32 v109, v12, v13
    v_cvt_pk_bf16_f32 v110, v14, v15
    ds_write_b128 v2, a[124:127] offset:8192
    v_cvt_pk_bf16_f32 v111, v16, v17
    v_cvt_pk_bf16_f32 v112, v28, v29
    v_cvt_pk_bf16_f32 v113, v30, v31
    ds_write_b128 v2, a[232:235] offset:9216
    v_cvt_pk_bf16_f32 v114, v32, v33
    v_cvt_pk_bf16_f32 v115, v34, v35
    s_add_u32 s62, s23, 40960
    ds_write_b128 v2, a[156:159] offset:10240
    v_permlane16_swap_b32 v108, v110
    v_permlane16_swap_b32 v109, v111
    v_permlane16_swap_b32 v112, v114
    ds_write_b128 v2, a[184:187] offset:11264
    v_permlane16_swap_b32 v113, v115
    s_mov_b64 vcc, s[64:65]
    s_nop 0
    ds_write_b128 v2, a[160:163] offset:12288
    v_cndmask_b32_dpp v116, v112, v108, vcc row_ror:8 row_mask:0xf bank_mask:0xf
    v_cndmask_b32_dpp v117, v113, v109, vcc row_ror:8 row_mask:0xf bank_mask:0xf
    v_cndmask_b32_dpp v118, v114, v110, vcc row_ror:8 row_mask:0xf bank_mask:0xf
    ds_write_b128 v2, a[188:191] offset:13312
    v_cndmask_b32_dpp v119, v115, v111, vcc row_ror:8 row_mask:0xf bank_mask:0xf
    s_mov_b64 vcc, s[66:67]
    buffer_store_dwordx4 v[116:119], v26, s[12:15], s62 offen sc0 sc1
    v_cndmask_b32_dpp v120, v112, v108, vcc row_ror:8 row_mask:0xf bank_mask:0xf
    v_cndmask_b32_dpp v121, v113, v109, vcc row_ror:8 row_mask:0xf bank_mask:0xf
    v_cndmask_b32_dpp v122, v114, v110, vcc row_ror:8 row_mask:0xf bank_mask:0xf
    v_cndmask_b32_dpp v123, v115, v111, vcc row_ror:8 row_mask:0xf bank_mask:0xf
    buffer_store_dwordx4 v[120:123], v27, s[12:15], s62 offen sc0 sc1
    s_waitcnt lgkmcnt(15)
    v_pk_add_f32 v[172:173], v[172:173], v[188:189]
    v_pk_add_f32 v[174:175], v[174:175], v[190:191]
    v_pk_add_f32 v[176:177], v[176:177], v[192:193]
    v_pk_add_f32 v[178:179], v[178:179], v[194:195]
    v_pk_add_f32 v[180:181], v[180:181], v[196:197]
    v_pk_add_f32 v[182:183], v[182:183], v[198:199]
    v_pk_add_f32 v[184:185], v[184:185], v[200:201]
    v_pk_add_f32 v[186:187], v[186:187], v[202:203]
    v_pk_add_f32 v[36:37], v[36:37], v[156:157]
    v_pk_add_f32 v[38:39], v[38:39], v[158:159]
    v_pk_add_f32 v[40:41], v[40:41], v[160:161]
    v_pk_add_f32 v[42:43], v[42:43], v[162:163]
    v_pk_add_f32 v[44:45], v[44:45], v[164:165]
    v_pk_add_f32 v[46:47], v[46:47], v[166:167]
    v_pk_add_f32 v[48:49], v[48:49], v[168:169]
    v_pk_add_f32 v[50:51], v[50:51], v[170:171]
    v_pk_add_f32 v[36:37], v[36:37], v[172:173]
    v_pk_add_f32 v[38:39], v[38:39], v[174:175]
    v_pk_add_f32 v[40:41], v[40:41], v[176:177]
    v_pk_add_f32 v[42:43], v[42:43], v[178:179]
    v_pk_add_f32 v[44:45], v[44:45], v[180:181]
    v_pk_add_f32 v[46:47], v[46:47], v[182:183]
    v_pk_add_f32 v[48:49], v[48:49], v[184:185]
    v_pk_add_f32 v[50:51], v[50:51], v[186:187]
    v_cvt_pk_bf16_f32 v156, v36, v37
    v_cvt_pk_bf16_f32 v157, v38, v39
    v_cvt_pk_bf16_f32 v158, v40, v41
    v_cvt_pk_bf16_f32 v159, v42, v43
    v_cvt_pk_bf16_f32 v160, v44, v45
    v_cvt_pk_bf16_f32 v161, v46, v47
    v_cvt_pk_bf16_f32 v162, v48, v49
    v_cvt_pk_bf16_f32 v163, v50, v51
    s_add_u32 s62, s23, 81920
    v_permlane16_swap_b32 v156, v158
    v_permlane16_swap_b32 v157, v159
    v_permlane16_swap_b32 v160, v162
    v_permlane16_swap_b32 v161, v163
    s_mov_b64 vcc, s[64:65]
    s_nop 0
    v_cndmask_b32_dpp v164, v160, v156, vcc row_ror:8 row_mask:0xf bank_mask:0xf
    v_cndmask_b32_dpp v165, v161, v157, vcc row_ror:8 row_mask:0xf bank_mask:0xf
    v_cndmask_b32_dpp v166, v162, v158, vcc row_ror:8 row_mask:0xf bank_mask:0xf
    v_cndmask_b32_dpp v167, v163, v159, vcc row_ror:8 row_mask:0xf bank_mask:0xf
    s_mov_b64 vcc, s[66:67]
    buffer_store_dwordx4 v[164:167], v26, s[12:15], s62 offen sc0 sc1
    v_cndmask_b32_dpp v168, v160, v156, vcc row_ror:8 row_mask:0xf bank_mask:0xf
    v_cndmask_b32_dpp v169, v161, v157, vcc row_ror:8 row_mask:0xf bank_mask:0xf
    v_cndmask_b32_dpp v170, v162, v158, vcc row_ror:8 row_mask:0xf bank_mask:0xf
    v_cndmask_b32_dpp v171, v163, v159, vcc row_ror:8 row_mask:0xf bank_mask:0xf
    buffer_store_dwordx4 v[168:171], v27, s[12:15], s62 offen sc0 sc1
    s_waitcnt lgkmcnt(14)
    v_pk_add_f32 v[208:209], v[208:209], v[212:213]
    v_pk_add_f32 v[210:211], v[210:211], v[214:215]
    v_pk_add_f32 v[52:53], v[52:53], v[204:205]
    v_pk_add_f32 v[54:55], v[54:55], v[206:207]
    v_pk_add_f32 v[52:53], v[52:53], v[208:209]
    v_pk_add_f32 v[54:55], v[54:55], v[210:211]
    v_pk_add_f32 v[56:57], v[56:57], v[216:217]
    v_pk_add_f32 v[58:59], v[58:59], v[218:219]
    s_waitcnt lgkmcnt(0)
    s_barrier
    ds_read_b128 v[76:79], v4 offset:4096
    ds_read_b128 v[80:83], v3 offset:9216
    ds_read_b128 v[84:87], v8 offset:0
    ds_read_b128 v[88:91], v4 offset:5120
    ds_read_b128 v[92:95], v3 offset:10240
    ds_read_b128 v[96:99], v8 offset:1024
    ds_read_b128 v[100:103], v4 offset:6144
    ds_read_b128 v[104:107], v3 offset:11264
    ds_read_b128 v[124:127], v8 offset:2048
    ds_read_b128 v[128:131], v4 offset:7168
    ds_read_b128 v[132:135], v3 offset:12288
    ds_read_b128 v[136:139], v8 offset:3072
    ds_read_b128 v[140:143], v4 offset:8192
    ds_read_b128 v[144:147], v3 offset:13312
    s_waitcnt lgkmcnt(6)
    v_pk_add_f32 v[76:77], v[76:77], v[80:81]
    v_pk_add_f32 v[78:79], v[78:79], v[82:83]
    v_pk_add_f32 v[56:57], v[56:57], v[76:77]
    v_pk_add_f32 v[58:59], v[58:59], v[78:79]
    v_pk_add_f32 v[88:89], v[88:89], v[92:93]
    v_pk_add_f32 v[90:91], v[90:91], v[94:95]
    v_pk_add_f32 v[100:101], v[100:101], v[104:105]
    v_pk_add_f32 v[102:103], v[102:103], v[106:107]
    v_pk_add_f32 v[236:237], v[236:237], v[84:85]
    v_pk_add_f32 v[238:239], v[238:239], v[86:87]
    v_pk_add_f32 v[240:241], v[240:241], v[96:97]
    v_pk_add_f32 v[242:243], v[242:243], v[98:99]
    v_pk_add_f32 v[236:237], v[236:237], v[88:89]
    v_pk_add_f32 v[238:239], v[238:239], v[90:91]
    v_pk_add_f32 v[240:241], v[240:241], v[100:101]
    v_pk_add_f32 v[242:243], v[242:243], v[102:103]
    v_cvt_pk_bf16_f32 v204, v52, v53
    v_cvt_pk_bf16_f32 v205, v54, v55
    v_cvt_pk_bf16_f32 v206, v56, v57
    v_cvt_pk_bf16_f32 v207, v58, v59
    v_cvt_pk_bf16_f32 v208, v236, v237
    v_cvt_pk_bf16_f32 v209, v238, v239
    v_cvt_pk_bf16_f32 v210, v240, v241
    v_cvt_pk_bf16_f32 v211, v242, v243
    s_mov_b32 s62, s22
    v_permlane16_swap_b32 v204, v206
    v_permlane16_swap_b32 v205, v207
    v_permlane16_swap_b32 v208, v210
    v_permlane16_swap_b32 v209, v211
    s_mov_b64 vcc, s[64:65]
    s_nop 0
    v_cndmask_b32_dpp v212, v208, v204, vcc row_ror:8 row_mask:0xf bank_mask:0xf
    v_cndmask_b32_dpp v213, v209, v205, vcc row_ror:8 row_mask:0xf bank_mask:0xf
    v_cndmask_b32_dpp v214, v210, v206, vcc row_ror:8 row_mask:0xf bank_mask:0xf
    v_cndmask_b32_dpp v215, v211, v207, vcc row_ror:8 row_mask:0xf bank_mask:0xf
    s_mov_b64 vcc, s[66:67]
    buffer_store_dwordx4 v[212:215], v26, s[12:15], s62 offen sc0 sc1
    v_cndmask_b32_dpp v216, v208, v204, vcc row_ror:8 row_mask:0xf bank_mask:0xf
    v_cndmask_b32_dpp v217, v209, v205, vcc row_ror:8 row_mask:0xf bank_mask:0xf
    v_cndmask_b32_dpp v218, v210, v206, vcc row_ror:8 row_mask:0xf bank_mask:0xf
    v_cndmask_b32_dpp v219, v211, v207, vcc row_ror:8 row_mask:0xf bank_mask:0xf
    buffer_store_dwordx4 v[216:219], v27, s[12:15], s62 offen sc0 sc1
    s_waitcnt lgkmcnt(0)
    v_pk_add_f32 v[128:129], v[128:129], v[132:133]
    v_pk_add_f32 v[130:131], v[130:131], v[134:135]
    v_pk_add_f32 v[140:141], v[140:141], v[144:145]
    v_pk_add_f32 v[142:143], v[142:143], v[146:147]
    v_pk_add_f32 v[244:245], v[244:245], v[124:125]
    v_pk_add_f32 v[246:247], v[246:247], v[126:127]
    v_pk_add_f32 v[248:249], v[248:249], v[136:137]
    v_pk_add_f32 v[250:251], v[250:251], v[138:139]
    v_pk_add_f32 v[244:245], v[244:245], v[128:129]
    v_pk_add_f32 v[246:247], v[246:247], v[130:131]
    v_pk_add_f32 v[248:249], v[248:249], v[140:141]
    v_pk_add_f32 v[250:251], v[250:251], v[142:143]
    v_cvt_pk_bf16_f32 v60, v244, v245
    v_cvt_pk_bf16_f32 v61, v246, v247
    v_cvt_pk_bf16_f32 v62, v248, v249
    v_cvt_pk_bf16_f32 v63, v250, v251
    s_nop 1
    v_permlane16_swap_b32 v60, v62
    v_permlane16_swap_b32 v61, v63
    buffer_store_dwordx4 v[60:63], v9, s[12:15], s59 offen sc0 sc1
L_op_end:
    s_endpgm
L_code_end:
.section .rodata,"a"
.p2align 6
.amdhsa_kernel fused_kernel
  .amdhsa_next_free_vgpr 512
  .amdhsa_next_free_sgpr 102
  .amdhsa_accum_offset 256
  .amdhsa_group_segment_fixed_size 0
  .amdhsa_kernarg_size 104
  .amdhsa_user_sgpr_count 2
  .amdhsa_user_sgpr_kernarg_segment_ptr 1
  .amdhsa_system_sgpr_workgroup_id_x 1
.end_amdhsa_kernel
.p2align 6
.amdhsa_kernel op_kernel
  .amdhsa_next_free_vgpr 512
  .amdhsa_next_free_sgpr 102
  .amdhsa_accum_offset 256
  .amdhsa_group_segment_fixed_size 0
  .amdhsa_kernarg_size 104
  .amdhsa_user_sgpr_count 2
  .amdhsa_user_sgpr_kernarg_segment_ptr 1
  .amdhsa_system_sgpr_workgroup_id_x 1
.end_amdhsa_kernel
```

```asm
; @launch kernel=fused_kernel grid=(256,1,1) block=(256,1,1) lds=163840
; @launch kernel=op_kernel grid=(256,1,1) block=(256,1,1) lds=163840
.amdgcn_target "amdgcn-amd-amdhsa--gfx950"
.text
.globl fused_kernel
.p2align 8
.type fused_kernel,@function
fused_kernel:
    s_cmp_ge_u32 s2, 256
    s_cbranch_scc1 L_at_end
    s_and_b32 s3, s2, 7
    s_lshl_b32 s3, s3, 5
    s_lshr_b32 s36, s2, 6
    s_lshl_b32 s36, s36, 3
    s_or_b32 s3, s3, s36
    s_bfe_u32 s36, s2, 0x30003
    s_or_b32 s2, s3, s36
    s_load_dwordx8 s[36:43], s[0:1], 0
    s_load_dwordx8 s[56:63], s[0:1], 40
    s_load_dwordx2 s[44:45], s[0:1], 96
    s_load_dwordx2 s[84:85], s[0:1], 32
    s_load_dwordx2 s[86:87], s[0:1], 72
    s_getpc_b64 s[72:73]
L_pc0:
    v_lshlrev_b32 v105, 7, v0
    v_add_u32 v104, 0, v105
    v_min_u32 v104, L_code_end - L_pc0 - 4, v104
    v_mov_b32 v107, s73
    v_add_co_u32 v106, vcc, s72, v104
    v_addc_co_u32 v107, vcc, 0, v107, vcc
    global_load_dword v108, v[106:107], off
    v_add_u32 v104, 32768, v105
    v_min_u32 v104, L_code_end - L_pc0 - 4, v104
    v_mov_b32 v107, s73
    v_add_co_u32 v106, vcc, s72, v104
    v_addc_co_u32 v107, vcc, 0, v107, vcc
    global_load_dword v108, v[106:107], off
    v_add_u32 v104, 65536, v105
    v_min_u32 v104, L_code_end - L_pc0 - 4, v104
    v_mov_b32 v107, s73
    v_add_co_u32 v106, vcc, s72, v104
    v_addc_co_u32 v107, vcc, 0, v107, vcc
    global_load_dword v108, v[106:107], off
    v_and_b32 v1, 63, v0
    v_lshrrev_b32 v2, 6, v0
    s_nop 0
    v_readfirstlane_b32 s20, v2
    s_waitcnt lgkmcnt(0)
    s_and_b32 s48, s20, 1
    s_lshr_b32 s35, s20, 1
    s_cmp_ge_u32 s2, 128
    s_cselect_b32 s36, s56, s36
    s_cselect_b32 s37, s57, s37
    s_cselect_b32 s38, s58, s38
    s_cselect_b32 s39, s59, s39
    s_cselect_b32 s40, s60, s40
    s_cselect_b32 s41, s61, s41
    s_cselect_b32 s42, s62, s42
    s_cselect_b32 s43, s63, s43
    s_cselect_b32 s84, s86, s84
    s_cselect_b32 s85, s87, s85
    s_mov_b32 s86, 5242880
    s_mov_b32 s87, 0x20000
    s_and_b32 s28, s2, 127
    s_lshl_b32 s29, s28, 20
    s_lshl_b32 s30, s35, 18
    s_add_u32 s29, s29, s30
    s_add_u32 s38, s38, s29
    s_addc_u32 s39, s39, 0
    s_add_u32 s40, s40, s29
    s_addc_u32 s41, s41, 0
    s_sub_u32 s30, 0x100000, s30
    s_mov_b32 s8, s38
    s_mov_b32 s9, s39
    s_mov_b32 s10, s30
    s_mov_b32 s11, 0x20000
    s_cmp_eq_u32 s48, 0
    s_cselect_b32 s4, s38, s40
    s_cselect_b32 s5, s39, s41
    s_mov_b32 s6, s30
    s_mov_b32 s7, 0x20000
    s_cselect_b32 s16, s42, s36
    s_cselect_b32 s17, s43, s37
    s_mov_b32 s28, 5242880
    s_mov_b32 s29, 4587520
    s_cselect_b32 s18, s28, s29
    s_mov_b32 s19, 0x20000
    s_mov_b32 s28, 262144
    s_mov_b32 s29, 64
    s_cselect_b32 s51, s28, s29
    s_cselect_b32 s52, 512, 0
    s_mov_b32 s28, 81920
    s_cselect_b32 s46, 128, s28
    s_mov_b32 s28, 81920
    s_cselect_b32 s47, s28, 0x40000000
    s_mov_b32 s28, 90112
    s_cselect_b32 s98, s28, 0x40000000
    s_mov_b32 s28, 1056
    s_mov_b32 s29, 1024
    s_cselect_b32 s53, s28, s29
    s_mov_b32 s28, 0
    s_mov_b32 s29, 0
    s_cselect_b32 s88, s28, s29
    s_mov_b32 s28, 8192
    s_mov_b32 s29, 10240
    s_cselect_b32 s89, s28, s29
    s_mov_b32 s28, 16384
    s_mov_b32 s29, 20480
    s_cselect_b32 s90, s28, s29
    s_mov_b32 s28, 24576
    s_mov_b32 s29, 30720
    s_cselect_b32 s91, s28, s29
    s_mov_b32 s28, 65536
    s_mov_b32 s29, 40960
    s_cselect_b32 s92, s28, s29
    s_mov_b32 s28, 73728
    s_mov_b32 s29, 51200
    s_cselect_b32 s93, s28, s29
    s_mov_b32 s28, 81920
    s_mov_b32 s29, 61440
    s_cselect_b32 s94, s28, s29
    s_mov_b32 s28, 90112
    s_mov_b32 s29, 71680
    s_cselect_b32 s95, s28, s29
    s_and_b32 s28, s2, 7
    s_lshl_b32 s28, s28, 2
    s_add_u32 s28, s28, s35
    s_lshl_b32 s28, s28, 8
    s_bfe_u32 s29, s2, 262147
    s_lshl_b32 s29, s29, 1
    s_add_u32 s29, s29, s35
    s_mul_i32 s29, s29, 143360
    s_cmp_eq_u32 s48, 0
    s_cselect_b32 s55, s28, s29
    s_add_u32 s12, s44, 0
    s_addc_u32 s13, s45, 0
    s_mov_b32 s14, 127926272
    s_mov_b32 s15, 0x20000
    s_lshl_b32 s28, s2, 2
    s_add_u32 s28, s28, s35
    s_mul_i32 s24, s28, 57344
    s_mul_i32 s28, s48, 28672
    s_add_u32 s24, s24, s28
    s_add_u32 s24, s24, 58720256
    s_mov_b32 s23, -1
    s_mov_b32 s60, s42
    s_mov_b32 s61, s43
    s_mov_b32 s62, 5242880
    s_mov_b32 s63, 0x20000
    s_mov_b32 s27, 0
    s_mov_b32 s25, 0
    s_mov_b32 s68, 0
    s_mov_b32 s71, 0
    s_lshr_b32 s26, s2, 3
    s_lshr_b32 s28, s2, 1
    s_add_u32 s26, s26, s28
    s_and_b32 s26, s26, 3
    s_mul_i32 s26, s26, 5
    s_and_b32 s26, s26, 30
    s_mul_i32 s83, s51, 20
    s_and_b32 s69, s2, 1
    s_min_u32 s69, s69, 1
    s_bfe_u32 s3, s2, 0x10005
    s_lshl_b32 s3, s3, 3
    s_and_b32 s69, s2, 7
    s_add_u32 s69, s69, s3
    s_lshr_b32 s3, 0x11, s69
    s_and_b32 s69, s3, 1
    s_mov_b32 s70, s69
    s_mov_b32 s32, 0x4e800000
    s_mov_b32 s54, 0x3e0293ee
    s_lshl_b32 s28, s48, 1
    s_add_u32 s28, s28, s35
    s_mul_i32 s33, s28, 33792
    v_lshlrev_b32 v6, 4, v1
    v_lshrrev_b32 v2, 4, v1
    v_and_b32 v3, 15, v1
    v_lshlrev_b32 v4, 4, v3
    v_lshl_add_u32 v7, v2, 14, v4
    v_and_b32 v26, 7, v1
    v_lshlrev_b32 v26, 4, v26
    v_bfe_u32 v5, v1, 3, 1
    v_lshl_add_u32 v26, v5, 15, v26
    v_bfe_u32 v5, v1, 4, 1
    v_lshl_add_u32 v26, v5, 17, v26
    v_bfe_u32 v5, v1, 5, 1
    v_lshl_add_u32 v26, v5, 18, v26
    v_mul_u32_u24 v27, 1280, v3
    v_lshl_add_u32 v27, v2, 4, v27
    v_lshrrev_b32 v5, 3, v1
    v_and_b32 v27, 6, v5
    v_xor_b32 v27, v27, v1
    v_and_b32 v27, 7, v27
    v_lshlrev_b32 v27, 4, v27
    v_mul_u32_u24 v5, 1280, v5
    v_add_u32 v27, v27, v5
    s_cmp_eq_u32 s48, 0
    s_cselect_b64 vcc, -1, 0
    s_nop 1
    v_cndmask_b32 v26, v27, v26, vcc
    s_add_u32 s28, s48, 2
    s_mul_i32 s28, s28, 33792
    v_and_b32 v27, 6, v3
    v_xor_b32 v27, v27, v2
    v_lshlrev_b32 v27, 4, v27
    v_and_b32 v5, 7, v3
    v_lshl_add_u32 v27, v5, 7, v27
    v_lshrrev_b32 v5, 3, v3
    v_lshl_add_u32 v27, v5, 10, v27
    v_add_u32 v27, s28, v27
    v_lshl_add_u32 v10, v2, 8, v4
    v_and_b32 v4, 7, v3
    v_lshlrev_b32 v8, 10, v4
    v_and_b32 v5, 1, v3
    v_lshl_add_u32 v8, v5, 4, v8
    v_bfe_u32 v5, v3, 1, 2
    v_lshl_add_u32 v8, v5, 6, v8
    v_lshrrev_b32 v5, 3, v3
    v_lshl_add_u32 v8, v5, 8, v8
    v_bfe_u32 v5, v1, 4, 1
    v_lshl_add_u32 v8, v5, 5, v8
    v_bfe_u32 v5, v1, 5, 1
    v_lshl_add_u32 v8, v5, 4, v8
    s_mul_i32 s28, s35, 33792
    v_add_u32 v8, s28, v8
    v_bfe_u32 v3, v1, 2, 2
    v_bfe_u32 v5, v1, 4, 1
    v_lshl_add_u32 v4, v5, 2, v3
    v_mul_u32_u24 v4, 1056, v4
    v_bfe_u32 v5, v1, 5, 1
    v_lshl_add_u32 v4, v5, 8, v4
    v_and_b32 v5, 3, v1
    v_lshl_add_u32 v4, v5, 3, v4
    v_add_u32 v11, s28, v4
    v_lshl_add_u32 v3, v2, 2, v3
    v_and_b32 v4, 7, v3
    v_mul_u32_u24 v4, 1056, v4
    v_lshrrev_b32 v5, 3, v3
    v_lshl_add_u32 v4, v5, 8, v4
    v_and_b32 v5, 3, v1
    v_lshl_add_u32 v4, v5, 3, v4
    s_add_u32 s28, s28, 67584
    v_add_u32 v9, s28, v4
    v_mov_b32 v12, 0xff800000
    v_mov_b32 v14, 0xff800000
    v_mov_b32 v16, 0xff800000
    v_mov_b32 v18, 0xff800000
    v_mov_b32 v20, 0xff800000
    v_mov_b32 v22, 0xff800000
    v_mov_b32 v24, 0xff800000
    v_mov_b32 v2, 0x3f803f80
    v_accvgpr_write_b32 a252, v2
    v_accvgpr_write_b32 a253, v2
    v_accvgpr_write_b32 a254, v2
    v_accvgpr_write_b32 a255, v2
    v_and_b32 v2, 3, v1
    v_lshlrev_b32 v2, 2, v2
    v_add_u32 v2, 76000, v2
    v_mov_b32 v3, 0
    ds_write_b32 v2, v3
    s_cmp_eq_u32 s48, 0
    s_mov_b32 s28, 784
    s_mov_b32 s29, 800
    s_cselect_b32 s96, s28, s29
    s_mov_b32 s28, 816
    s_cselect_b32 s97, s28, s29
    v_lshrrev_b32 v2, 1, v1
    v_lshlrev_b32 v2, 13, v2
    v_and_b32 v3, 1, v1
    v_lshl_add_u32 v2, v3, 7, v2
    v_lshlrev_b32 v3, 7, v1
    s_bfe_u32 s28, s2, 0x20003
    s_lshl_b32 s28, s28, 18
    s_and_b32 s29, s2, 7
    s_mul_i32 s29, s29, 17920
    s_cmp_eq_u32 s48, 0
    s_cselect_b64 vcc, -1, 0
    s_cselect_b32 s100, s28, s29
    s_add_u32 s100, s100, s55
    s_cmp_eq_u32 s48, 0
    s_mov_b32 s28, 1048576
    s_mov_b32 s29, 8192
    s_cselect_b32 s99, s28, s29
    v_cndmask_b32 v6, v3, v2, vcc
    v_xor_b32 v6, 64, v27
    s_mul_i32 s100, s2, 11
    s_lshr_b32 s28, s2, 5
    s_mul_i32 s28, s28, 7
    s_add_u32 s100, s100, s28
    s_lshl_b32 s28, s35, 4
    s_add_u32 s100, s100, s28
    s_and_b32 s100, s100, 31
L_at_start:
    s_mov_b32 s21, s27
    s_lshl_b32 s34, s27, 5
    s_add_u32 s31, s21, s70
    s_mul_i32 s50, s31, s52
    s_mov_b32 s101, s31
    s_add_u32 s50, s50, s55
    s_cmp_ge_u32 s31, 2
    s_cselect_b32 s28, 0x40000000, 0
    s_add_u32 s50, s50, s28
    s_mov_b32 s82, s26
    s_mul_i32 s28, s26, s51
    s_add_u32 s50, s50, s28
    s_add_u32 m0, s33, 0
    s_mov_b32 s49, s50
    s_add_u32 s28, s49, s88
    buffer_load_dwordx4 v26, s[16:19], s28 offen lds
    s_add_u32 m0, m0, s53
    s_add_u32 s28, s49, s89
    buffer_load_dwordx4 v26, s[16:19], s28 offen lds
    s_add_u32 m0, m0, s53
    s_add_u32 s28, s49, s90
    buffer_load_dwordx4 v26, s[16:19], s28 offen lds
    s_add_u32 m0, m0, s53
    s_add_u32 s28, s49, s91
    buffer_load_dwordx4 v26, s[16:19], s28 offen lds
    s_add_u32 m0, m0, s53
    s_add_u32 s28, s49, s92
    buffer_load_dwordx4 v26, s[16:19], s28 offen lds
    s_add_u32 m0, m0, s53
    s_add_u32 s28, s49, s93
    buffer_load_dwordx4 v26, s[16:19], s28 offen lds
    s_add_u32 m0, m0, s53
    s_add_u32 s28, s49, s94
    buffer_load_dwordx4 v26, s[16:19], s28 offen lds
    s_add_u32 m0, m0, s53
    s_add_u32 s28, s49, s95
    buffer_load_dwordx4 v26, s[16:19], s28 offen lds
    s_add_u32 m0, s33, 8448
    s_add_u32 s49, s50, s46
    s_lshl1_add_u32 s50, s51, s50
    s_add_u32 s82, s82, 2
    s_cmp_eq_u32 s82, 20
    s_cselect_b32 s29, s83, 0
    s_sub_u32 s50, s50, s29
    s_add_u32 s28, s49, s88
    buffer_load_dwordx4 v26, s[16:19], s28 offen lds
    s_add_u32 m0, m0, s53
    s_add_u32 s28, s49, s89
    buffer_load_dwordx4 v26, s[16:19], s28 offen lds
    s_add_u32 m0, m0, s53
    s_add_u32 s28, s49, s90
    buffer_load_dwordx4 v26, s[16:19], s28 offen lds
    s_add_u32 m0, m0, s53
    s_add_u32 s28, s49, s91
    buffer_load_dwordx4 v26, s[16:19], s28 offen lds
    s_add_u32 m0, m0, s53
    s_add_u32 s28, s49, s92
    buffer_load_dwordx4 v26, s[16:19], s28 offen lds
    s_add_u32 m0, m0, s53
    s_add_u32 s28, s49, s93
    buffer_load_dwordx4 v26, s[16:19], s28 offen lds
    s_add_u32 m0, m0, s53
    s_add_u32 s28, s49, s47
    buffer_load_dwordx4 v26, s[16:19], s28 offen lds
    s_add_u32 m0, m0, s53
    s_add_u32 s28, s49, s98
    buffer_load_dwordx4 v26, s[16:19], s28 offen lds
    s_add_u32 m0, s33, 16896
    s_mov_b32 s49, s50
    s_add_u32 s28, s49, s88
    buffer_load_dwordx4 v26, s[16:19], s28 offen lds
    s_add_u32 m0, m0, s53
    s_add_u32 s28, s49, s89
    buffer_load_dwordx4 v26, s[16:19], s28 offen lds
    s_add_u32 m0, m0, s53
    s_add_u32 s28, s49, s90
    buffer_load_dwordx4 v26, s[16:19], s28 offen lds
    s_add_u32 m0, m0, s53
    s_add_u32 s28, s49, s91
    buffer_load_dwordx4 v26, s[16:19], s28 offen lds
    s_add_u32 m0, m0, s53
    s_add_u32 s28, s49, s92
    buffer_load_dwordx4 v26, s[16:19], s28 offen lds
    s_add_u32 m0, m0, s53
    s_add_u32 s28, s49, s93
    buffer_load_dwordx4 v26, s[16:19], s28 offen lds
    s_add_u32 m0, m0, s53
    s_add_u32 s28, s49, s94
    buffer_load_dwordx4 v26, s[16:19], s28 offen lds
    s_add_u32 m0, m0, s53
    s_add_u32 s28, s49, s95
    buffer_load_dwordx4 v26, s[16:19], s28 offen lds
    s_add_u32 m0, s33, 25344
    s_add_u32 s49, s50, s46
    s_lshl1_add_u32 s50, s51, s50
    s_add_u32 s82, s82, 2
    s_cmp_eq_u32 s82, 20
    s_cselect_b32 s29, s83, 0
    s_sub_u32 s50, s50, s29
    s_add_u32 s28, s49, s88
    buffer_load_dwordx4 v26, s[16:19], s28 offen lds
    s_add_u32 m0, m0, s53
    s_add_u32 s28, s49, s89
    buffer_load_dwordx4 v26, s[16:19], s28 offen lds
    s_add_u32 m0, m0, s53
    s_add_u32 s28, s49, s90
    buffer_load_dwordx4 v26, s[16:19], s28 offen lds
    s_add_u32 m0, m0, s53
    s_add_u32 s28, s49, s91
    buffer_load_dwordx4 v26, s[16:19], s28 offen lds
    s_add_u32 m0, m0, s53
    s_add_u32 s28, s49, s92
    buffer_load_dwordx4 v26, s[16:19], s28 offen lds
    s_add_u32 m0, m0, s53
    s_add_u32 s28, s49, s93
    buffer_load_dwordx4 v26, s[16:19], s28 offen lds
    s_add_u32 m0, m0, s53
    s_add_u32 s28, s49, s47
    buffer_load_dwordx4 v26, s[16:19], s28 offen lds
    s_add_u32 m0, m0, s53
    s_add_u32 s28, s49, s98
    buffer_load_dwordx4 v26, s[16:19], s28 offen lds
    s_waitcnt vmcnt(16) lgkmcnt(0)
    s_barrier
L_at_round:
    ds_read_b64_tr_b16 v[112:113], v11 offset:0
    ds_read_b64_tr_b16 v[114:115], v11 offset:128
    ds_read_b64_tr_b16 v[116:117], v11 offset:512
    ds_read_b64_tr_b16 v[118:119], v11 offset:640
    ds_read_b64_tr_b16 v[120:121], v11 offset:32
    ds_read_b64_tr_b16 v[122:123], v11 offset:160
    ds_read_b64_tr_b16 v[124:125], v11 offset:544
    ds_read_b64_tr_b16 v[126:127], v11 offset:672
    ds_read_b64_tr_b16 v[128:129], v11 offset:64
    ds_read_b64_tr_b16 v[130:131], v11 offset:192
    ds_read_b64_tr_b16 v[132:133], v11 offset:576
    ds_read_b64_tr_b16 v[134:135], v11 offset:704
    ds_read_b64_tr_b16 v[136:137], v11 offset:96
    ds_read_b64_tr_b16 v[138:139], v11 offset:224
    ds_read_b64_tr_b16 v[140:141], v11 offset:608
    ds_read_b64_tr_b16 v[142:143], v11 offset:736
    ds_read_b128 v[28:31], v27 offset:0
    ds_read_b128 v[32:35], v27 offset:2048
    ds_read_b128 v[36:39], v27 offset:4096
    ds_read_b128 v[40:43], v27 offset:6144
    ds_read_b128 v[44:47], v27 offset:8448
    ds_read_b128 v[48:51], v27 offset:10496
    ds_read_b128 v[52:55], v27 offset:12544
    ds_read_b128 v[56:59], v6 offset:0
    ds_read_b128 v[60:63], v6 offset:2048
    ds_read_b128 v[64:67], v6 offset:4096
    ds_read_b128 v[68:71], v6 offset:6144
    ds_read_b128 v[72:75], v6 offset:8448
    ds_read_b128 v[76:79], v6 offset:10496
    ds_read_b128 v[80:83], v6 offset:12544
    v_add_u32 v88, s88, v26
    v_add_u32 v89, s89, v26
    v_add_u32 v90, s90, v26
    v_add_u32 v91, s91, v26
    v_add_u32 v92, s92, v26
    v_add_u32 v93, s93, v26
    v_add_u32 v94, s94, v26
    v_add_u32 v95, s95, v26
    s_waitcnt lgkmcnt(0)
    v_mfma_f32_16x16x32_bf16 v[144:147], v[112:115], v[28:31], 0
    s_add_u32 m0, s33, 0
    v_mfma_f32_16x16x32_bf16 v[144:147], v[116:119], v[56:59], v[144:147]
    s_mov_b32 s49, s50
    v_mfma_f32_16x16x32_bf16 v[148:151], v[112:115], v[32:35], 0
    s_add_u32 s64, s16, s49
    v_mfma_f32_16x16x32_bf16 v[148:151], v[116:119], v[60:63], v[148:151]
    s_addc_u32 s65, s17, 0
    v_mfma_f32_16x16x32_bf16 v[152:155], v[112:115], v[36:39], 0
    v_mfma_f32_16x16x32_bf16 v[152:155], v[116:119], v[64:67], v[152:155]
    v_mfma_f32_16x16x32_bf16 v[156:159], v[112:115], v[40:43], 0
    s_cmp_eq_u32 s68, 0
    s_cbranch_scc0 L_bw1_460
    s_waitcnt vmcnt(16) lgkmcnt(0)
L_bw2_460:
    s_barrier
    s_cmp_le_u32 s21, s27
    s_cbranch_scc1 L_at_nofb_465
    s_sub_u32 s28, s21, 1
    s_cmp_eq_u32 s28, s23
    s_cbranch_scc1 L_at_nofb_465
    s_lshl_b32 s29, s28, 2
    s_add_u32 s29, s29, 76000
    v_mov_b32 v4, s29
    ds_read_b32 v4, v4
    s_waitcnt lgkmcnt(0)
    v_readfirstlane_b32 s29, v4
    s_nop 3
    s_cmp_lg_u32 s29, 0
    s_cbranch_scc1 L_at_fallback
L_at_nofb_465:
    v_mfma_f32_16x16x32_bf16 v[156:159], v[116:119], v[68:71], v[156:159]
    v_mfma_f32_16x16x32_bf16 v[160:163], v[112:115], v[44:47], 0
    v_mfma_f32_16x16x32_bf16 v[160:163], v[116:119], v[72:75], v[160:163]
    global_load_lds_dwordx4 v88, s[64:65]
    v_mfma_f32_16x16x32_bf16 v[164:167], v[112:115], v[48:51], 0
    s_add_u32 m0, m0, s53
    v_mfma_f32_16x16x32_bf16 v[164:167], v[116:119], v[76:79], v[164:167]
    v_mfma_f32_16x16x32_bf16 v[168:171], v[112:115], v[52:55], 0
    v_mfma_f32_16x16x32_bf16 v[168:171], v[116:119], v[80:83], v[168:171]
    ds_read_b64_tr_b16 v[112:113], v11 offset:8448
    v_mfma_f32_16x16x32_bf16 v[172:175], v[120:123], v[28:31], 0
    ds_read_b64_tr_b16 v[114:115], v11 offset:8576
    v_mfma_f32_16x16x32_bf16 v[172:175], v[124:127], v[56:59], v[172:175]
    global_load_lds_dwordx4 v89, s[64:65]
    v_mfma_f32_16x16x32_bf16 v[176:179], v[120:123], v[32:35], 0
    s_add_u32 m0, m0, s53
    ds_read_b64_tr_b16 v[116:117], v11 offset:8960
    v_mfma_f32_16x16x32_bf16 v[176:179], v[124:127], v[60:63], v[176:179]
    ds_read_b64_tr_b16 v[118:119], v11 offset:9088
    v_mfma_f32_16x16x32_bf16 v[180:183], v[120:123], v[36:39], 0
    v_mfma_f32_16x16x32_bf16 v[180:183], v[124:127], v[64:67], v[180:183]
    v_mfma_f32_16x16x32_bf16 v[184:187], v[120:123], v[40:43], 0
    v_mfma_f32_16x16x32_bf16 v[184:187], v[124:127], v[68:71], v[184:187]
    global_load_lds_dwordx4 v90, s[64:65]
    v_mfma_f32_16x16x32_bf16 v[188:191], v[120:123], v[44:47], 0
    s_add_u32 m0, m0, s53
    v_mfma_f32_16x16x32_bf16 v[188:191], v[124:127], v[72:75], v[188:191]
    v_mfma_f32_16x16x32_bf16 v[192:195], v[120:123], v[48:51], 0
    v_mfma_f32_16x16x32_bf16 v[192:195], v[124:127], v[76:79], v[192:195]
    v_mfma_f32_16x16x32_bf16 v[196:199], v[120:123], v[52:55], 0
    v_mfma_f32_16x16x32_bf16 v[196:199], v[124:127], v[80:83], v[196:199]
    global_load_lds_dwordx4 v91, s[64:65]
    v_mfma_f32_16x16x32_bf16 v[200:203], v[128:131], v[28:31], 0
    s_add_u32 m0, m0, s53
    ds_read_b64_tr_b16 v[120:121], v11 offset:8480
    v_mfma_f32_16x16x32_bf16 v[200:203], v[132:135], v[56:59], v[200:203]
    ds_read_b64_tr_b16 v[122:123], v11 offset:8608
    v_mfma_f32_16x16x32_bf16 v[204:207], v[128:131], v[32:35], 0
    ds_read_b64_tr_b16 v[124:125], v11 offset:8992
    v_mfma_f32_16x16x32_bf16 v[204:207], v[132:135], v[60:63], v[204:207]
    ds_read_b64_tr_b16 v[126:127], v11 offset:9120
    v_mfma_f32_16x16x32_bf16 v[208:211], v[128:131], v[36:39], 0
    v_mfma_f32_16x16x32_bf16 v[208:211], v[132:135], v[64:67], v[208:211]
    global_load_lds_dwordx4 v92, s[64:65]
    v_mfma_f32_16x16x32_bf16 v[212:215], v[128:131], v[40:43], 0
    s_add_u32 m0, m0, s53
    v_mfma_f32_16x16x32_bf16 v[212:215], v[132:135], v[68:71], v[212:215]
    v_mfma_f32_16x16x32_bf16 v[216:219], v[128:131], v[44:47], 0
    v_mfma_f32_16x16x32_bf16 v[216:219], v[132:135], v[72:75], v[216:219]
    v_mfma_f32_16x16x32_bf16 v[220:223], v[128:131], v[48:51], 0
    v_mfma_f32_16x16x32_bf16 v[220:223], v[132:135], v[76:79], v[220:223]
    global_load_lds_dwordx4 v93, s[64:65]
    v_mfma_f32_16x16x32_bf16 v[224:227], v[128:131], v[52:55], 0
    s_add_u32 m0, m0, s53
    v_mfma_f32_16x16x32_bf16 v[224:227], v[132:135], v[80:83], v[224:227]
    ds_read_b64_tr_b16 v[128:129], v11 offset:8512
    v_mfma_f32_16x16x32_bf16 v[228:231], v[136:139], v[28:31], 0
    ds_read_b64_tr_b16 v[130:131], v11 offset:8640
    v_mfma_f32_16x16x32_bf16 v[228:231], v[140:143], v[56:59], v[228:231]
    ds_read_b64_tr_b16 v[132:133], v11 offset:9024
    v_mfma_f32_16x16x32_bf16 v[232:235], v[136:139], v[32:35], 0
    ds_read_b64_tr_b16 v[134:135], v11 offset:9152
    v_mfma_f32_16x16x32_bf16 v[232:235], v[140:143], v[60:63], v[232:235]
    global_load_lds_dwordx4 v94, s[64:65]
    v_mfma_f32_16x16x32_bf16 v[236:239], v[136:139], v[36:39], 0
    s_add_u32 m0, m0, s53
    v_mfma_f32_16x16x32_bf16 v[236:239], v[140:143], v[64:67], v[236:239]
    v_mfma_f32_16x16x32_bf16 v[240:243], v[136:139], v[40:43], 0
    v_mfma_f32_16x16x32_bf16 v[240:243], v[140:143], v[68:71], v[240:243]
    v_mfma_f32_16x16x32_bf16 v[244:247], v[136:139], v[44:47], 0
    v_mfma_f32_16x16x32_bf16 v[244:247], v[140:143], v[72:75], v[244:247]
    global_load_lds_dwordx4 v95, s[64:65]
    v_mfma_f32_16x16x32_bf16 v[248:251], v[136:139], v[48:51], 0
    s_waitcnt lgkmcnt(4)
    v_mfma_f32_16x16x32_bf16 v[248:251], v[140:143], v[76:79], v[248:251]
    v_mfma_f32_16x16x32_bf16 v[252:255], v[136:139], v[52:55], 0
    ds_read_b64_tr_b16 v[136:137], v11 offset:8544
    ds_read_b64_tr_b16 v[138:139], v11 offset:8672
    v_mfma_f32_16x16x32_bf16 v[252:255], v[140:143], v[80:83], v[252:255]
    ds_read_b64_tr_b16 v[140:141], v11 offset:9056
    ds_read_b64_tr_b16 v[142:143], v11 offset:9184
    v_mfma_f32_16x16x32_bf16 a[112:115], v[112:115], v[28:31], 0
    s_add_u32 m0, s33, 8448
    v_mfma_f32_16x16x32_bf16 a[112:115], v[116:119], v[56:59], a[112:115]
    s_add_u32 s49, s50, s46
    v_mfma_f32_16x16x32_bf16 a[116:119], v[112:115], v[32:35], 0
    s_lshl1_add_u32 s50, s51, s50
    v_add_u32 v104, s49, v26
    v_mfma_f32_16x16x32_bf16 a[116:119], v[116:119], v[60:63], a[116:119]
    s_add_u32 s82, s82, 2
    v_mfma_f32_16x16x32_bf16 a[120:123], v[112:115], v[36:39], 0
    s_cmp_eq_u32 s82, 20
    v_mfma_f32_16x16x32_bf16 a[120:123], v[116:119], v[64:67], a[120:123]
    s_cselect_b32 s29, s83, 0
    v_mfma_f32_16x16x32_bf16 a[124:127], v[112:115], v[40:43], 0
    s_sub_u32 s50, s50, s29
    s_cmp_eq_u32 s68, 0
    s_cbranch_scc0 L_bw1_576
    s_waitcnt vmcnt(8) lgkmcnt(0)
L_bw2_576:
    s_barrier
    ds_read_b128 a[0:3], v27 offset:16896
    v_mfma_f32_16x16x32_bf16 a[124:127], v[116:119], v[68:71], a[124:127]
    s_add_u32 s64, s16, s49
    ds_read_b128 a[4:7], v27 offset:18944
    v_mfma_f32_16x16x32_bf16 a[128:131], v[112:115], v[44:47], 0
    s_addc_u32 s65, s17, 0
    ds_read_b128 a[8:11], v27 offset:20992
    v_mfma_f32_16x16x32_bf16 a[128:131], v[116:119], v[72:75], a[128:131]
    global_load_lds_dwordx4 v88, s[64:65]
    v_mfma_f32_16x16x32_bf16 a[132:135], v[112:115], v[48:51], 0
    s_add_u32 m0, m0, s53
    ds_read_b128 a[12:15], v27 offset:23040
    v_mfma_f32_16x16x32_bf16 a[132:135], v[116:119], v[76:79], a[132:135]
    ds_read_b128 a[16:19], v27 offset:25344
    v_mfma_f32_16x16x32_bf16 a[136:139], v[112:115], v[52:55], 0
    ds_read_b128 a[20:23], v27 offset:27392
    v_mfma_f32_16x16x32_bf16 a[136:139], v[116:119], v[80:83], a[136:139]
    ds_read_b128 a[24:27], v27 offset:29440
    v_mfma_f32_16x16x32_bf16 a[140:143], v[120:123], v[28:31], 0
    ds_read_b128 a[28:31], v6 offset:16896
    v_mfma_f32_16x16x32_bf16 a[140:143], v[124:127], v[56:59], a[140:143]
    global_load_lds_dwordx4 v89, s[64:65]
    v_mfma_f32_16x16x32_bf16 a[144:147], v[120:123], v[32:35], 0
    s_add_u32 m0, m0, s53
    ds_read_b128 a[32:35], v6 offset:18944
    v_mfma_f32_16x16x32_bf16 a[144:147], v[124:127], v[60:63], a[144:147]
    ds_read_b128 a[36:39], v6 offset:20992
    v_mfma_f32_16x16x32_bf16 a[148:151], v[120:123], v[36:39], 0
    ds_read_b128 a[40:43], v6 offset:23040
    v_mfma_f32_16x16x32_bf16 a[148:151], v[124:127], v[64:67], a[148:151]
    ds_read_b128 a[44:47], v6 offset:25344
    v_mfma_f32_16x16x32_bf16 a[152:155], v[120:123], v[40:43], 0
    ds_read_b128 a[48:51], v6 offset:27392
    v_mfma_f32_16x16x32_bf16 a[152:155], v[124:127], v[68:71], a[152:155]
    global_load_lds_dwordx4 v90, s[64:65]
    v_mfma_f32_16x16x32_bf16 a[156:159], v[120:123], v[44:47], 0
    s_add_u32 m0, m0, s53
    ds_read_b128 a[52:55], v6 offset:29440
    v_mfma_f32_16x16x32_bf16 a[156:159], v[124:127], v[72:75], a[156:159]
    ds_read_b64_tr_b16 v[112:113], v11 offset:16896
    v_mfma_f32_16x16x32_bf16 a[160:163], v[120:123], v[48:51], 0
    ds_read_b64_tr_b16 v[114:115], v11 offset:17024
    v_mfma_f32_16x16x32_bf16 a[160:163], v[124:127], v[76:79], a[160:163]
    ds_read_b64_tr_b16 v[116:117], v11 offset:17408
    v_mfma_f32_16x16x32_bf16 a[164:167], v[120:123], v[52:55], 0
    ds_read_b64_tr_b16 v[118:119], v11 offset:17536
    v_mfma_f32_16x16x32_bf16 a[164:167], v[124:127], v[80:83], a[164:167]
    global_load_lds_dwordx4 v91, s[64:65]
    v_mfma_f32_16x16x32_bf16 a[168:171], v[128:131], v[28:31], 0
    s_add_u32 m0, m0, s53
    ds_read_b64_tr_b16 v[120:121], v11 offset:16928
    v_mfma_f32_16x16x32_bf16 a[168:171], v[132:135], v[56:59], a[168:171]
    ds_read_b64_tr_b16 v[122:123], v11 offset:17056
    v_mfma_f32_16x16x32_bf16 a[172:175], v[128:131], v[32:35], 0
    ds_read_b64_tr_b16 v[124:125], v11 offset:17440
    v_mfma_f32_16x16x32_bf16 a[172:175], v[132:135], v[60:63], a[172:175]
    ds_read_b64_tr_b16 v[126:127], v11 offset:17568
    v_mfma_f32_16x16x32_bf16 a[176:179], v[128:131], v[36:39], 0
    v_mfma_f32_16x16x32_bf16 a[176:179], v[132:135], v[64:67], a[176:179]
    global_load_lds_dwordx4 v92, s[64:65]
    v_mfma_f32_16x16x32_bf16 a[180:183], v[128:131], v[40:43], 0
    s_add_u32 m0, m0, s53
    v_mfma_f32_16x16x32_bf16 a[180:183], v[132:135], v[68:71], a[180:183]
    v_mfma_f32_16x16x32_bf16 a[184:187], v[128:131], v[44:47], 0
    v_mfma_f32_16x16x32_bf16 a[184:187], v[132:135], v[72:75], a[184:187]
    v_mfma_f32_16x16x32_bf16 a[188:191], v[128:131], v[48:51], 0
    v_mfma_f32_16x16x32_bf16 a[188:191], v[132:135], v[76:79], a[188:191]
    global_load_lds_dwordx4 v93, s[64:65]
    v_mfma_f32_16x16x32_bf16 a[192:195], v[128:131], v[52:55], 0
    s_add_u32 m0, m0, s53
    v_mfma_f32_16x16x32_bf16 a[192:195], v[132:135], v[80:83], a[192:195]
    ds_read_b64_tr_b16 v[128:129], v11 offset:16960
    v_mfma_f32_16x16x32_bf16 a[196:199], v[136:139], v[28:31], 0
    ds_read_b64_tr_b16 v[130:131], v11 offset:17088
    v_mfma_f32_16x16x32_bf16 a[196:199], v[140:143], v[56:59], a[196:199]
    ds_read_b64_tr_b16 v[132:133], v11 offset:17472
    v_mfma_f32_16x16x32_bf16 a[200:203], v[136:139], v[32:35], 0
    ds_read_b64_tr_b16 v[134:135], v11 offset:17600
    v_mfma_f32_16x16x32_bf16 a[200:203], v[140:143], v[60:63], a[200:203]
    buffer_load_dwordx4 v104, s[16:19], s47 offen lds
    v_mfma_f32_16x16x32_bf16 a[204:207], v[136:139], v[36:39], 0
    s_add_u32 m0, m0, s53
    v_mfma_f32_16x16x32_bf16 a[204:207], v[140:143], v[64:67], a[204:207]
    v_mfma_f32_16x16x32_bf16 a[208:211], v[136:139], v[40:43], 0
    v_mfma_f32_16x16x32_bf16 a[208:211], v[140:143], v[68:71], a[208:211]
    v_mfma_f32_16x16x32_bf16 a[212:215], v[136:139], v[44:47], 0
    v_mfma_f32_16x16x32_bf16 a[212:215], v[140:143], v[72:75], a[212:215]
    buffer_load_dwordx4 v104, s[16:19], s98 offen lds
    v_mfma_f32_16x16x32_bf16 a[216:219], v[136:139], v[48:51], 0
    s_waitcnt lgkmcnt(4)
    v_mfma_f32_16x16x32_bf16 a[216:219], v[140:143], v[76:79], a[216:219]
    v_mfma_f32_16x16x32_bf16 a[220:223], v[136:139], v[52:55], 0
    ds_read_b64_tr_b16 v[136:137], v11 offset:16992
    ds_read_b64_tr_b16 v[138:139], v11 offset:17120
    v_mfma_f32_16x16x32_bf16 a[220:223], v[140:143], v[80:83], a[220:223]
    ds_read_b64_tr_b16 v[140:141], v11 offset:17504
    ds_read_b64_tr_b16 v[142:143], v11 offset:17632
    v_mfma_f32_16x16x32_bf16 v[144:147], v[112:115], a[0:3], v[144:147]
    s_add_u32 m0, s33, 16896
    v_mfma_f32_16x16x32_bf16 v[144:147], v[116:119], a[28:31], v[144:147]
    s_mov_b32 s49, s50
    v_mfma_f32_16x16x32_bf16 v[148:151], v[112:115], a[4:7], v[148:151]
    s_add_u32 s64, s16, s49
    v_mfma_f32_16x16x32_bf16 v[148:151], v[116:119], a[32:35], v[148:151]
    s_addc_u32 s65, s17, 0
    v_mfma_f32_16x16x32_bf16 v[152:155], v[112:115], a[8:11], v[152:155]
    v_mfma_f32_16x16x32_bf16 v[152:155], v[116:119], a[36:39], v[152:155]
    v_mfma_f32_16x16x32_bf16 v[156:159], v[112:115], a[12:15], v[156:159]
    s_cmp_eq_u32 s68, 0
    s_cbranch_scc0 L_bw1_689
    s_waitcnt vmcnt(16) lgkmcnt(0)
L_bw2_689:
    s_barrier
    v_mfma_f32_16x16x32_bf16 v[156:159], v[116:119], a[40:43], v[156:159]
    v_mfma_f32_16x16x32_bf16 v[160:163], v[112:115], a[16:19], v[160:163]
    v_mfma_f32_16x16x32_bf16 v[160:163], v[116:119], a[44:47], v[160:163]
    global_load_lds_dwordx4 v88, s[64:65]
    v_mfma_f32_16x16x32_bf16 v[164:167], v[112:115], a[20:23], v[164:167]
    s_add_u32 m0, m0, s53
    v_mfma_f32_16x16x32_bf16 v[164:167], v[116:119], a[48:51], v[164:167]
    v_mfma_f32_16x16x32_bf16 v[168:171], v[112:115], a[24:27], v[168:171]
    v_mfma_f32_16x16x32_bf16 v[168:171], v[116:119], a[52:55], v[168:171]
    ds_read_b64_tr_b16 v[112:113], v11 offset:25344
    v_mfma_f32_16x16x32_bf16 v[172:175], v[120:123], a[0:3], v[172:175]
    ds_read_b64_tr_b16 v[114:115], v11 offset:25472
    v_mfma_f32_16x16x32_bf16 v[172:175], v[124:127], a[28:31], v[172:175]
    global_load_lds_dwordx4 v89, s[64:65]
    v_mfma_f32_16x16x32_bf16 v[176:179], v[120:123], a[4:7], v[176:179]
    s_add_u32 m0, m0, s53
    ds_read_b64_tr_b16 v[116:117], v11 offset:25856
    v_mfma_f32_16x16x32_bf16 v[176:179], v[124:127], a[32:35], v[176:179]
    ds_read_b64_tr_b16 v[118:119], v11 offset:25984
    v_mfma_f32_16x16x32_bf16 v[180:183], v[120:123], a[8:11], v[180:183]
    v_mfma_f32_16x16x32_bf16 v[180:183], v[124:127], a[36:39], v[180:183]
    v_mfma_f32_16x16x32_bf16 v[184:187], v[120:123], a[12:15], v[184:187]
    v_mfma_f32_16x16x32_bf16 v[184:187], v[124:127], a[40:43], v[184:187]
    global_load_lds_dwordx4 v90, s[64:65]
    v_mfma_f32_16x16x32_bf16 v[188:191], v[120:123], a[16:19], v[188:191]
    s_add_u32 m0, m0, s53
    v_mfma_f32_16x16x32_bf16 v[188:191], v[124:127], a[44:47], v[188:191]
    v_mfma_f32_16x16x32_bf16 v[192:195], v[120:123], a[20:23], v[192:195]
    v_mfma_f32_16x16x32_bf16 v[192:195], v[124:127], a[48:51], v[192:195]
    v_mfma_f32_16x16x32_bf16 v[196:199], v[120:123], a[24:27], v[196:199]
    v_mfma_f32_16x16x32_bf16 v[196:199], v[124:127], a[52:55], v[196:199]
    global_load_lds_dwordx4 v91, s[64:65]
    v_mfma_f32_16x16x32_bf16 v[200:203], v[128:131], a[0:3], v[200:203]
    s_add_u32 m0, m0, s53
    ds_read_b64_tr_b16 v[120:121], v11 offset:25376
    v_mfma_f32_16x16x32_bf16 v[200:203], v[132:135], a[28:31], v[200:203]
    ds_read_b64_tr_b16 v[122:123], v11 offset:25504
    v_mfma_f32_16x16x32_bf16 v[204:207], v[128:131], a[4:7], v[204:207]
    ds_read_b64_tr_b16 v[124:125], v11 offset:25888
    v_mfma_f32_16x16x32_bf16 v[204:207], v[132:135], a[32:35], v[204:207]
    ds_read_b64_tr_b16 v[126:127], v11 offset:26016
    v_mfma_f32_16x16x32_bf16 v[208:211], v[128:131], a[8:11], v[208:211]
    v_mfma_f32_16x16x32_bf16 v[208:211], v[132:135], a[36:39], v[208:211]
    global_load_lds_dwordx4 v92, s[64:65]
    v_mfma_f32_16x16x32_bf16 v[212:215], v[128:131], a[12:15], v[212:215]
    s_add_u32 m0, m0, s53
    v_mfma_f32_16x16x32_bf16 v[212:215], v[132:135], a[40:43], v[212:215]
    v_mfma_f32_16x16x32_bf16 v[216:219], v[128:131], a[16:19], v[216:219]
    v_mfma_f32_16x16x32_bf16 v[216:219], v[132:135], a[44:47], v[216:219]
    v_mfma_f32_16x16x32_bf16 v[220:223], v[128:131], a[20:23], v[220:223]
    v_mfma_f32_16x16x32_bf16 v[220:223], v[132:135], a[48:51], v[220:223]
    global_load_lds_dwordx4 v93, s[64:65]
    v_mfma_f32_16x16x32_bf16 v[224:227], v[128:131], a[24:27], v[224:227]
    s_add_u32 m0, m0, s53
    v_mfma_f32_16x16x32_bf16 v[224:227], v[132:135], a[52:55], v[224:227]
    ds_read_b64_tr_b16 v[128:129], v11 offset:25408
    v_mfma_f32_16x16x32_bf16 v[228:231], v[136:139], a[0:3], v[228:231]
    ds_read_b64_tr_b16 v[130:131], v11 offset:25536
    v_mfma_f32_16x16x32_bf16 v[228:231], v[140:143], a[28:31], v[228:231]
    ds_read_b64_tr_b16 v[132:133], v11 offset:25920
    v_mfma_f32_16x16x32_bf16 v[232:235], v[136:139], a[4:7], v[232:235]
    ds_read_b64_tr_b16 v[134:135], v11 offset:26048
    v_mfma_f32_16x16x32_bf16 v[232:235], v[140:143], a[32:35], v[232:235]
    global_load_lds_dwordx4 v94, s[64:65]
    v_mfma_f32_16x16x32_bf16 v[236:239], v[136:139], a[8:11], v[236:239]
    s_add_u32 m0, m0, s53
    v_mfma_f32_16x16x32_bf16 v[236:239], v[140:143], a[36:39], v[236:239]
    v_mfma_f32_16x16x32_bf16 v[240:243], v[136:139], a[12:15], v[240:243]
    v_mfma_f32_16x16x32_bf16 v[240:243], v[140:143], a[40:43], v[240:243]
    v_mfma_f32_16x16x32_bf16 v[244:247], v[136:139], a[16:19], v[244:247]
    v_mfma_f32_16x16x32_bf16 v[244:247], v[140:143], a[44:47], v[244:247]
    global_load_lds_dwordx4 v95, s[64:65]
    v_mfma_f32_16x16x32_bf16 v[248:251], v[136:139], a[20:23], v[248:251]
    s_waitcnt lgkmcnt(4)
    v_mfma_f32_16x16x32_bf16 v[248:251], v[140:143], a[48:51], v[248:251]
    v_mfma_f32_16x16x32_bf16 v[252:255], v[136:139], a[24:27], v[252:255]
    ds_read_b64_tr_b16 v[136:137], v11 offset:25440
    ds_read_b64_tr_b16 v[138:139], v11 offset:25568
    v_mfma_f32_16x16x32_bf16 v[252:255], v[140:143], a[52:55], v[252:255]
    ds_read_b64_tr_b16 v[140:141], v11 offset:25952
    ds_read_b64_tr_b16 v[142:143], v11 offset:26080
    v_mfma_f32_16x16x32_bf16 a[112:115], v[112:115], a[0:3], a[112:115]
    s_add_u32 m0, s33, 25344
    v_mfma_f32_16x16x32_bf16 a[112:115], v[116:119], a[28:31], a[112:115]
    s_add_u32 s49, s50, s46
    v_mfma_f32_16x16x32_bf16 a[116:119], v[112:115], a[4:7], a[116:119]
    s_lshl1_add_u32 s50, s51, s50
    v_add_u32 v104, s49, v26
    v_mfma_f32_16x16x32_bf16 a[116:119], v[116:119], a[32:35], a[116:119]
    s_add_u32 s82, s82, 2
    v_mfma_f32_16x16x32_bf16 a[120:123], v[112:115], a[8:11], a[120:123]
    s_cmp_eq_u32 s82, 20
    v_mfma_f32_16x16x32_bf16 a[120:123], v[116:119], a[36:39], a[120:123]
    s_cselect_b32 s29, s83, 0
    v_mfma_f32_16x16x32_bf16 a[124:127], v[112:115], a[12:15], a[124:127]
    s_sub_u32 s50, s50, s29
    s_waitcnt vmcnt(8) lgkmcnt(0)
    s_barrier
    ds_read_b128 v[28:31], v27 offset:0
    v_mfma_f32_16x16x32_bf16 a[124:127], v[116:119], a[40:43], a[124:127]
    s_add_u32 s64, s16, s49
    ds_read_b128 v[32:35], v27 offset:2048
    v_mfma_f32_16x16x32_bf16 a[128:131], v[112:115], a[16:19], a[128:131]
    s_addc_u32 s65, s17, 0
    ds_read_b128 v[36:39], v27 offset:4096
    v_mfma_f32_16x16x32_bf16 a[128:131], v[116:119], a[44:47], a[128:131]
    global_load_lds_dwordx4 v88, s[64:65]
    v_mfma_f32_16x16x32_bf16 a[132:135], v[112:115], a[20:23], a[132:135]
    s_add_u32 m0, m0, s53
    ds_read_b128 v[40:43], v27 offset:6144
    v_mfma_f32_16x16x32_bf16 a[132:135], v[116:119], a[48:51], a[132:135]
    ds_read_b128 v[44:47], v27 offset:8448
    v_mfma_f32_16x16x32_bf16 a[136:139], v[112:115], a[24:27], a[136:139]
    ds_read_b128 v[48:51], v27 offset:10496
    v_mfma_f32_16x16x32_bf16 a[136:139], v[116:119], a[52:55], a[136:139]
    ds_read_b128 v[52:55], v27 offset:12544
    v_mfma_f32_16x16x32_bf16 a[140:143], v[120:123], a[0:3], a[140:143]
    ds_read_b128 v[56:59], v6 offset:0
    v_mfma_f32_16x16x32_bf16 a[140:143], v[124:127], a[28:31], a[140:143]
    global_load_lds_dwordx4 v89, s[64:65]
    v_mfma_f32_16x16x32_bf16 a[144:147], v[120:123], a[4:7], a[144:147]
    s_add_u32 m0, m0, s53
    ds_read_b128 v[60:63], v6 offset:2048
    v_mfma_f32_16x16x32_bf16 a[144:147], v[124:127], a[32:35], a[144:147]
    ds_read_b128 v[64:67], v6 offset:4096
    v_mfma_f32_16x16x32_bf16 a[148:151], v[120:123], a[8:11], a[148:151]
    ds_read_b128 v[68:71], v6 offset:6144
    v_mfma_f32_16x16x32_bf16 a[148:151], v[124:127], a[36:39], a[148:151]
    ds_read_b128 v[72:75], v6 offset:8448
    v_mfma_f32_16x16x32_bf16 a[152:155], v[120:123], a[12:15], a[152:155]
    ds_read_b128 v[76:79], v6 offset:10496
    v_mfma_f32_16x16x32_bf16 a[152:155], v[124:127], a[40:43], a[152:155]
    global_load_lds_dwordx4 v90, s[64:65]
    v_mfma_f32_16x16x32_bf16 a[156:159], v[120:123], a[16:19], a[156:159]
    s_add_u32 m0, m0, s53
    ds_read_b128 v[80:83], v6 offset:12544
    v_mfma_f32_16x16x32_bf16 a[156:159], v[124:127], a[44:47], a[156:159]
    ds_read_b64_tr_b16 v[112:113], v11 offset:0
    v_mfma_f32_16x16x32_bf16 a[160:163], v[120:123], a[20:23], a[160:163]
    ds_read_b64_tr_b16 v[114:115], v11 offset:128
    v_mfma_f32_16x16x32_bf16 a[160:163], v[124:127], a[48:51], a[160:163]
    ds_read_b64_tr_b16 v[116:117], v11 offset:512
    v_mfma_f32_16x16x32_bf16 a[164:167], v[120:123], a[24:27], a[164:167]
    ds_read_b64_tr_b16 v[118:119], v11 offset:640
    v_mfma_f32_16x16x32_bf16 a[164:167], v[124:127], a[52:55], a[164:167]
    global_load_lds_dwordx4 v91, s[64:65]
    v_mfma_f32_16x16x32_bf16 a[168:171], v[128:131], a[0:3], a[168:171]
    s_add_u32 m0, m0, s53
    ds_read_b64_tr_b16 v[120:121], v11 offset:32
    v_mfma_f32_16x16x32_bf16 a[168:171], v[132:135], a[28:31], a[168:171]
    ds_read_b64_tr_b16 v[122:123], v11 offset:160
    v_mfma_f32_16x16x32_bf16 a[172:175], v[128:131], a[4:7], a[172:175]
    ds_read_b64_tr_b16 v[124:125], v11 offset:544
    v_mfma_f32_16x16x32_bf16 a[172:175], v[132:135], a[32:35], a[172:175]
    ds_read_b64_tr_b16 v[126:127], v11 offset:672
    v_mfma_f32_16x16x32_bf16 a[176:179], v[128:131], a[8:11], a[176:179]
    v_mfma_f32_16x16x32_bf16 a[176:179], v[132:135], a[36:39], a[176:179]
    global_load_lds_dwordx4 v92, s[64:65]
    v_mfma_f32_16x16x32_bf16 a[180:183], v[128:131], a[12:15], a[180:183]
    s_add_u32 m0, m0, s53
    v_mfma_f32_16x16x32_bf16 a[180:183], v[132:135], a[40:43], a[180:183]
    v_mfma_f32_16x16x32_bf16 a[184:187], v[128:131], a[16:19], a[184:187]
    v_mfma_f32_16x16x32_bf16 a[184:187], v[132:135], a[44:47], a[184:187]
    v_mfma_f32_16x16x32_bf16 a[188:191], v[128:131], a[20:23], a[188:191]
    v_mfma_f32_16x16x32_bf16 a[188:191], v[132:135], a[48:51], a[188:191]
    global_load_lds_dwordx4 v93, s[64:65]
    v_mfma_f32_16x16x32_bf16 a[192:195], v[128:131], a[24:27], a[192:195]
    s_add_u32 m0, m0, s53
    v_mfma_f32_16x16x32_bf16 a[192:195], v[132:135], a[52:55], a[192:195]
    ds_read_b64_tr_b16 v[128:129], v11 offset:64
    v_mfma_f32_16x16x32_bf16 a[196:199], v[136:139], a[0:3], a[196:199]
    ds_read_b64_tr_b16 v[130:131], v11 offset:192
    v_mfma_f32_16x16x32_bf16 a[196:199], v[140:143], a[28:31], a[196:199]
    ds_read_b64_tr_b16 v[132:133], v11 offset:576
    v_mfma_f32_16x16x32_bf16 a[200:203], v[136:139], a[4:7], a[200:203]
    ds_read_b64_tr_b16 v[134:135], v11 offset:704
    v_mfma_f32_16x16x32_bf16 a[200:203], v[140:143], a[32:35], a[200:203]
    buffer_load_dwordx4 v104, s[16:19], s47 offen lds
    v_mfma_f32_16x16x32_bf16 a[204:207], v[136:139], a[8:11], a[204:207]
    s_add_u32 m0, m0, s53
    v_mfma_f32_16x16x32_bf16 a[204:207], v[140:143], a[36:39], a[204:207]
    v_mfma_f32_16x16x32_bf16 a[208:211], v[136:139], a[12:15], a[208:211]
    v_mfma_f32_16x16x32_bf16 a[208:211], v[140:143], a[40:43], a[208:211]
    v_mfma_f32_16x16x32_bf16 a[212:215], v[136:139], a[16:19], a[212:215]
    v_mfma_f32_16x16x32_bf16 a[212:215], v[140:143], a[44:47], a[212:215]
    buffer_load_dwordx4 v104, s[16:19], s98 offen lds
    v_mfma_f32_16x16x32_bf16 a[216:219], v[136:139], a[20:23], a[216:219]
    s_waitcnt lgkmcnt(4)
    v_mfma_f32_16x16x32_bf16 a[216:219], v[140:143], a[48:51], a[216:219]
    v_mfma_f32_16x16x32_bf16 a[220:223], v[136:139], a[24:27], a[220:223]
    ds_read_b64_tr_b16 v[136:137], v11 offset:96
    ds_read_b64_tr_b16 v[138:139], v11 offset:224
    v_mfma_f32_16x16x32_bf16 a[220:223], v[140:143], a[52:55], a[220:223]
    ds_read_b64_tr_b16 v[140:141], v11 offset:608
    ds_read_b64_tr_b16 v[142:143], v11 offset:736
    s_mov_b32 s22, 0
L_at_qploop:
    v_mfma_f32_16x16x32_bf16 v[144:147], v[112:115], v[28:31], v[144:147]
    s_add_u32 m0, s33, 0
    v_mfma_f32_16x16x32_bf16 v[144:147], v[116:119], v[56:59], v[144:147]
    s_mov_b32 s49, s50
    v_mfma_f32_16x16x32_bf16 v[148:151], v[112:115], v[32:35], v[148:151]
    s_add_u32 s64, s16, s49
    v_mfma_f32_16x16x32_bf16 v[148:151], v[116:119], v[60:63], v[148:151]
    s_addc_u32 s65, s17, 0
    v_mfma_f32_16x16x32_bf16 v[152:155], v[112:115], v[36:39], v[152:155]
    v_mfma_f32_16x16x32_bf16 v[152:155], v[116:119], v[64:67], v[152:155]
    v_mfma_f32_16x16x32_bf16 v[156:159], v[112:115], v[40:43], v[156:159]
    s_waitcnt vmcnt(16) lgkmcnt(0)
    s_barrier
    v_mfma_f32_16x16x32_bf16 v[156:159], v[116:119], v[68:71], v[156:159]
    v_mfma_f32_16x16x32_bf16 v[160:163], v[112:115], v[44:47], v[160:163]
    v_mfma_f32_16x16x32_bf16 v[160:163], v[116:119], v[72:75], v[160:163]
    global_load_lds_dwordx4 v88, s[64:65]
    v_mfma_f32_16x16x32_bf16 v[164:167], v[112:115], v[48:51], v[164:167]
    s_add_u32 m0, m0, s53
    v_mfma_f32_16x16x32_bf16 v[164:167], v[116:119], v[76:79], v[164:167]
    v_mfma_f32_16x16x32_bf16 v[168:171], v[112:115], v[52:55], v[168:171]
    v_mfma_f32_16x16x32_bf16 v[168:171], v[116:119], v[80:83], v[168:171]
    ds_read_b64_tr_b16 v[112:113], v11 offset:8448
    v_mfma_f32_16x16x32_bf16 v[172:175], v[120:123], v[28:31], v[172:175]
    ds_read_b64_tr_b16 v[114:115], v11 offset:8576
    v_mfma_f32_16x16x32_bf16 v[172:175], v[124:127], v[56:59], v[172:175]
    global_load_lds_dwordx4 v89, s[64:65]
    v_mfma_f32_16x16x32_bf16 v[176:179], v[120:123], v[32:35], v[176:179]
    s_add_u32 m0, m0, s53
    ds_read_b64_tr_b16 v[116:117], v11 offset:8960
    v_mfma_f32_16x16x32_bf16 v[176:179], v[124:127], v[60:63], v[176:179]
    ds_read_b64_tr_b16 v[118:119], v11 offset:9088
    v_mfma_f32_16x16x32_bf16 v[180:183], v[120:123], v[36:39], v[180:183]
    v_mfma_f32_16x16x32_bf16 v[180:183], v[124:127], v[64:67], v[180:183]
    v_mfma_f32_16x16x32_bf16 v[184:187], v[120:123], v[40:43], v[184:187]
    v_mfma_f32_16x16x32_bf16 v[184:187], v[124:127], v[68:71], v[184:187]
    global_load_lds_dwordx4 v90, s[64:65]
    v_mfma_f32_16x16x32_bf16 v[188:191], v[120:123], v[44:47], v[188:191]
    s_add_u32 m0, m0, s53
    v_mfma_f32_16x16x32_bf16 v[188:191], v[124:127], v[72:75], v[188:191]
    v_mfma_f32_16x16x32_bf16 v[192:195], v[120:123], v[48:51], v[192:195]
    v_mfma_f32_16x16x32_bf16 v[192:195], v[124:127], v[76:79], v[192:195]
    v_mfma_f32_16x16x32_bf16 v[196:199], v[120:123], v[52:55], v[196:199]
    v_mfma_f32_16x16x32_bf16 v[196:199], v[124:127], v[80:83], v[196:199]
    global_load_lds_dwordx4 v91, s[64:65]
    v_mfma_f32_16x16x32_bf16 v[200:203], v[128:131], v[28:31], v[200:203]
    s_add_u32 m0, m0, s53
    ds_read_b64_tr_b16 v[120:121], v11 offset:8480
    v_mfma_f32_16x16x32_bf16 v[200:203], v[132:135], v[56:59], v[200:203]
    ds_read_b64_tr_b16 v[122:123], v11 offset:8608
    v_mfma_f32_16x16x32_bf16 v[204:207], v[128:131], v[32:35], v[204:207]
    ds_read_b64_tr_b16 v[124:125], v11 offset:8992
    v_mfma_f32_16x16x32_bf16 v[204:207], v[132:135], v[60:63], v[204:207]
    ds_read_b64_tr_b16 v[126:127], v11 offset:9120
    v_mfma_f32_16x16x32_bf16 v[208:211], v[128:131], v[36:39], v[208:211]
    v_mfma_f32_16x16x32_bf16 v[208:211], v[132:135], v[64:67], v[208:211]
    global_load_lds_dwordx4 v92, s[64:65]
    v_mfma_f32_16x16x32_bf16 v[212:215], v[128:131], v[40:43], v[212:215]
    s_add_u32 m0, m0, s53
    v_mfma_f32_16x16x32_bf16 v[212:215], v[132:135], v[68:71], v[212:215]
    v_mfma_f32_16x16x32_bf16 v[216:219], v[128:131], v[44:47], v[216:219]
    v_mfma_f32_16x16x32_bf16 v[216:219], v[132:135], v[72:75], v[216:219]
    v_mfma_f32_16x16x32_bf16 v[220:223], v[128:131], v[48:51], v[220:223]
    v_mfma_f32_16x16x32_bf16 v[220:223], v[132:135], v[76:79], v[220:223]
    global_load_lds_dwordx4 v93, s[64:65]
    v_mfma_f32_16x16x32_bf16 v[224:227], v[128:131], v[52:55], v[224:227]
    s_add_u32 m0, m0, s53
    v_mfma_f32_16x16x32_bf16 v[224:227], v[132:135], v[80:83], v[224:227]
    ds_read_b64_tr_b16 v[128:129], v11 offset:8512
    v_mfma_f32_16x16x32_bf16 v[228:231], v[136:139], v[28:31], v[228:231]
    ds_read_b64_tr_b16 v[130:131], v11 offset:8640
    v_mfma_f32_16x16x32_bf16 v[228:231], v[140:143], v[56:59], v[228:231]
    ds_read_b64_tr_b16 v[132:133], v11 offset:9024
    v_mfma_f32_16x16x32_bf16 v[232:235], v[136:139], v[32:35], v[232:235]
    ds_read_b64_tr_b16 v[134:135], v11 offset:9152
    v_mfma_f32_16x16x32_bf16 v[232:235], v[140:143], v[60:63], v[232:235]
    global_load_lds_dwordx4 v94, s[64:65]
    v_mfma_f32_16x16x32_bf16 v[236:239], v[136:139], v[36:39], v[236:239]
    s_add_u32 m0, m0, s53
    v_mfma_f32_16x16x32_bf16 v[236:239], v[140:143], v[64:67], v[236:239]
    v_mfma_f32_16x16x32_bf16 v[240:243], v[136:139], v[40:43], v[240:243]
    v_mfma_f32_16x16x32_bf16 v[240:243], v[140:143], v[68:71], v[240:243]
    v_mfma_f32_16x16x32_bf16 v[244:247], v[136:139], v[44:47], v[244:247]
    v_mfma_f32_16x16x32_bf16 v[244:247], v[140:143], v[72:75], v[244:247]
    global_load_lds_dwordx4 v95, s[64:65]
    v_mfma_f32_16x16x32_bf16 v[248:251], v[136:139], v[48:51], v[248:251]
    s_waitcnt lgkmcnt(4)
    v_mfma_f32_16x16x32_bf16 v[248:251], v[140:143], v[76:79], v[248:251]
    v_mfma_f32_16x16x32_bf16 v[252:255], v[136:139], v[52:55], v[252:255]
    ds_read_b64_tr_b16 v[136:137], v11 offset:8544
    ds_read_b64_tr_b16 v[138:139], v11 offset:8672
    v_mfma_f32_16x16x32_bf16 v[252:255], v[140:143], v[80:83], v[252:255]
    ds_read_b64_tr_b16 v[140:141], v11 offset:9056
    ds_read_b64_tr_b16 v[142:143], v11 offset:9184
    v_mfma_f32_16x16x32_bf16 a[112:115], v[112:115], v[28:31], a[112:115]
    s_add_u32 m0, s33, 8448
    v_mfma_f32_16x16x32_bf16 a[112:115], v[116:119], v[56:59], a[112:115]
    s_add_u32 s49, s50, s46
    v_mfma_f32_16x16x32_bf16 a[116:119], v[112:115], v[32:35], a[116:119]
    s_lshl1_add_u32 s50, s51, s50
    v_add_u32 v104, s49, v26
    v_mfma_f32_16x16x32_bf16 a[116:119], v[116:119], v[60:63], a[116:119]
    s_add_u32 s82, s82, 2
    v_mfma_f32_16x16x32_bf16 a[120:123], v[112:115], v[36:39], a[120:123]
    s_cmp_eq_u32 s82, 20
    v_mfma_f32_16x16x32_bf16 a[120:123], v[116:119], v[64:67], a[120:123]
    s_cselect_b32 s29, s83, 0
    v_mfma_f32_16x16x32_bf16 a[124:127], v[112:115], v[40:43], a[124:127]
    s_sub_u32 s50, s50, s29
    s_waitcnt vmcnt(8) lgkmcnt(0)
    s_barrier
    ds_read_b128 a[0:3], v27 offset:16896
    v_mfma_f32_16x16x32_bf16 a[124:127], v[116:119], v[68:71], a[124:127]
    s_add_u32 s64, s16, s49
    ds_read_b128 a[4:7], v27 offset:18944
    v_mfma_f32_16x16x32_bf16 a[128:131], v[112:115], v[44:47], a[128:131]
    s_addc_u32 s65, s17, 0
    ds_read_b128 a[8:11], v27 offset:20992
    v_mfma_f32_16x16x32_bf16 a[128:131], v[116:119], v[72:75], a[128:131]
    global_load_lds_dwordx4 v88, s[64:65]
    v_mfma_f32_16x16x32_bf16 a[132:135], v[112:115], v[48:51], a[132:135]
    s_add_u32 m0, m0, s53
    ds_read_b128 a[12:15], v27 offset:23040
    v_mfma_f32_16x16x32_bf16 a[132:135], v[116:119], v[76:79], a[132:135]
    ds_read_b128 a[16:19], v27 offset:25344
    v_mfma_f32_16x16x32_bf16 a[136:139], v[112:115], v[52:55], a[136:139]
    ds_read_b128 a[20:23], v27 offset:27392
    v_mfma_f32_16x16x32_bf16 a[136:139], v[116:119], v[80:83], a[136:139]
    ds_read_b128 a[24:27], v27 offset:29440
    v_mfma_f32_16x16x32_bf16 a[140:143], v[120:123], v[28:31], a[140:143]
    ds_read_b128 a[28:31], v6 offset:16896
    v_mfma_f32_16x16x32_bf16 a[140:143], v[124:127], v[56:59], a[140:143]
    global_load_lds_dwordx4 v89, s[64:65]
    v_mfma_f32_16x16x32_bf16 a[144:147], v[120:123], v[32:35], a[144:147]
    s_add_u32 m0, m0, s53
    ds_read_b128 a[32:35], v6 offset:18944
    v_mfma_f32_16x16x32_bf16 a[144:147], v[124:127], v[60:63], a[144:147]
    ds_read_b128 a[36:39], v6 offset:20992
    v_mfma_f32_16x16x32_bf16 a[148:151], v[120:123], v[36:39], a[148:151]
    ds_read_b128 a[40:43], v6 offset:23040
    v_mfma_f32_16x16x32_bf16 a[148:151], v[124:127], v[64:67], a[148:151]
    ds_read_b128 a[44:47], v6 offset:25344
    v_mfma_f32_16x16x32_bf16 a[152:155], v[120:123], v[40:43], a[152:155]
    ds_read_b128 a[48:51], v6 offset:27392
    v_mfma_f32_16x16x32_bf16 a[152:155], v[124:127], v[68:71], a[152:155]
    global_load_lds_dwordx4 v90, s[64:65]
    v_mfma_f32_16x16x32_bf16 a[156:159], v[120:123], v[44:47], a[156:159]
    s_add_u32 m0, m0, s53
    ds_read_b128 a[52:55], v6 offset:29440
    v_mfma_f32_16x16x32_bf16 a[156:159], v[124:127], v[72:75], a[156:159]
    ds_read_b64_tr_b16 v[112:113], v11 offset:16896
    v_mfma_f32_16x16x32_bf16 a[160:163], v[120:123], v[48:51], a[160:163]
    ds_read_b64_tr_b16 v[114:115], v11 offset:17024
    v_mfma_f32_16x16x32_bf16 a[160:163], v[124:127], v[76:79], a[160:163]
    ds_read_b64_tr_b16 v[116:117], v11 offset:17408
    v_mfma_f32_16x16x32_bf16 a[164:167], v[120:123], v[52:55], a[164:167]
    ds_read_b64_tr_b16 v[118:119], v11 offset:17536
    v_mfma_f32_16x16x32_bf16 a[164:167], v[124:127], v[80:83], a[164:167]
    global_load_lds_dwordx4 v91, s[64:65]
    v_mfma_f32_16x16x32_bf16 a[168:171], v[128:131], v[28:31], a[168:171]
    s_add_u32 m0, m0, s53
    ds_read_b64_tr_b16 v[120:121], v11 offset:16928
    v_mfma_f32_16x16x32_bf16 a[168:171], v[132:135], v[56:59], a[168:171]
    ds_read_b64_tr_b16 v[122:123], v11 offset:17056
    v_mfma_f32_16x16x32_bf16 a[172:175], v[128:131], v[32:35], a[172:175]
    ds_read_b64_tr_b16 v[124:125], v11 offset:17440
    v_mfma_f32_16x16x32_bf16 a[172:175], v[132:135], v[60:63], a[172:175]
    ds_read_b64_tr_b16 v[126:127], v11 offset:17568
    v_mfma_f32_16x16x32_bf16 a[176:179], v[128:131], v[36:39], a[176:179]
    v_mfma_f32_16x16x32_bf16 a[176:179], v[132:135], v[64:67], a[176:179]
    global_load_lds_dwordx4 v92, s[64:65]
    v_mfma_f32_16x16x32_bf16 a[180:183], v[128:131], v[40:43], a[180:183]
    s_add_u32 m0, m0, s53
    v_mfma_f32_16x16x32_bf16 a[180:183], v[132:135], v[68:71], a[180:183]
    v_mfma_f32_16x16x32_bf16 a[184:187], v[128:131], v[44:47], a[184:187]
    v_mfma_f32_16x16x32_bf16 a[184:187], v[132:135], v[72:75], a[184:187]
    v_mfma_f32_16x16x32_bf16 a[188:191], v[128:131], v[48:51], a[188:191]
    v_mfma_f32_16x16x32_bf16 a[188:191], v[132:135], v[76:79], a[188:191]
    global_load_lds_dwordx4 v93, s[64:65]
    v_mfma_f32_16x16x32_bf16 a[192:195], v[128:131], v[52:55], a[192:195]
    s_add_u32 m0, m0, s53
    v_mfma_f32_16x16x32_bf16 a[192:195], v[132:135], v[80:83], a[192:195]
    ds_read_b64_tr_b16 v[128:129], v11 offset:16960
    v_mfma_f32_16x16x32_bf16 a[196:199], v[136:139], v[28:31], a[196:199]
    ds_read_b64_tr_b16 v[130:131], v11 offset:17088
    v_mfma_f32_16x16x32_bf16 a[196:199], v[140:143], v[56:59], a[196:199]
    ds_read_b64_tr_b16 v[132:133], v11 offset:17472
    v_mfma_f32_16x16x32_bf16 a[200:203], v[136:139], v[32:35], a[200:203]
    ds_read_b64_tr_b16 v[134:135], v11 offset:17600
    v_mfma_f32_16x16x32_bf16 a[200:203], v[140:143], v[60:63], a[200:203]
    buffer_load_dwordx4 v104, s[16:19], s47 offen lds
    v_mfma_f32_16x16x32_bf16 a[204:207], v[136:139], v[36:39], a[204:207]
    s_add_u32 m0, m0, s53
    v_mfma_f32_16x16x32_bf16 a[204:207], v[140:143], v[64:67], a[204:207]
    v_mfma_f32_16x16x32_bf16 a[208:211], v[136:139], v[40:43], a[208:211]
    v_mfma_f32_16x16x32_bf16 a[208:211], v[140:143], v[68:71], a[208:211]
    v_mfma_f32_16x16x32_bf16 a[212:215], v[136:139], v[44:47], a[212:215]
    v_mfma_f32_16x16x32_bf16 a[212:215], v[140:143], v[72:75], a[212:215]
    buffer_load_dwordx4 v104, s[16:19], s98 offen lds
    v_mfma_f32_16x16x32_bf16 a[216:219], v[136:139], v[48:51], a[216:219]
    s_waitcnt lgkmcnt(4)
    v_mfma_f32_16x16x32_bf16 a[216:219], v[140:143], v[76:79], a[216:219]
    v_mfma_f32_16x16x32_bf16 a[220:223], v[136:139], v[52:55], a[220:223]
    ds_read_b64_tr_b16 v[136:137], v11 offset:16992
    ds_read_b64_tr_b16 v[138:139], v11 offset:17120
    v_mfma_f32_16x16x32_bf16 a[220:223], v[140:143], v[80:83], a[220:223]
    ds_read_b64_tr_b16 v[140:141], v11 offset:17504
    ds_read_b64_tr_b16 v[142:143], v11 offset:17632
    v_mfma_f32_16x16x32_bf16 v[144:147], v[112:115], a[0:3], v[144:147]
    s_add_u32 m0, s33, 16896
    v_mfma_f32_16x16x32_bf16 v[144:147], v[116:119], a[28:31], v[144:147]
    s_mov_b32 s49, s50
    v_mfma_f32_16x16x32_bf16 v[148:151], v[112:115], a[4:7], v[148:151]
    s_add_u32 s64, s16, s49
    v_mfma_f32_16x16x32_bf16 v[148:151], v[116:119], a[32:35], v[148:151]
    s_addc_u32 s65, s17, 0
    v_mfma_f32_16x16x32_bf16 v[152:155], v[112:115], a[8:11], v[152:155]
    v_mfma_f32_16x16x32_bf16 v[152:155], v[116:119], a[36:39], v[152:155]
    v_mfma_f32_16x16x32_bf16 v[156:159], v[112:115], a[12:15], v[156:159]
    s_waitcnt vmcnt(16) lgkmcnt(0)
    s_barrier
    v_mfma_f32_16x16x32_bf16 v[156:159], v[116:119], a[40:43], v[156:159]
    v_mfma_f32_16x16x32_bf16 v[160:163], v[112:115], a[16:19], v[160:163]
    v_mfma_f32_16x16x32_bf16 v[160:163], v[116:119], a[44:47], v[160:163]
    global_load_lds_dwordx4 v88, s[64:65]
    v_mfma_f32_16x16x32_bf16 v[164:167], v[112:115], a[20:23], v[164:167]
    s_add_u32 m0, m0, s53
    v_mfma_f32_16x16x32_bf16 v[164:167], v[116:119], a[48:51], v[164:167]
    v_mfma_f32_16x16x32_bf16 v[168:171], v[112:115], a[24:27], v[168:171]
    v_mfma_f32_16x16x32_bf16 v[168:171], v[116:119], a[52:55], v[168:171]
    ds_read_b64_tr_b16 v[112:113], v11 offset:25344
    v_mfma_f32_16x16x32_bf16 v[172:175], v[120:123], a[0:3], v[172:175]
    ds_read_b64_tr_b16 v[114:115], v11 offset:25472
    v_mfma_f32_16x16x32_bf16 v[172:175], v[124:127], a[28:31], v[172:175]
    global_load_lds_dwordx4 v89, s[64:65]
    v_mfma_f32_16x16x32_bf16 v[176:179], v[120:123], a[4:7], v[176:179]
    s_add_u32 m0, m0, s53
    ds_read_b64_tr_b16 v[116:117], v11 offset:25856
    v_mfma_f32_16x16x32_bf16 v[176:179], v[124:127], a[32:35], v[176:179]
    ds_read_b64_tr_b16 v[118:119], v11 offset:25984
    v_mfma_f32_16x16x32_bf16 v[180:183], v[120:123], a[8:11], v[180:183]
    v_mfma_f32_16x16x32_bf16 v[180:183], v[124:127], a[36:39], v[180:183]
    v_mfma_f32_16x16x32_bf16 v[184:187], v[120:123], a[12:15], v[184:187]
    v_mfma_f32_16x16x32_bf16 v[184:187], v[124:127], a[40:43], v[184:187]
    global_load_lds_dwordx4 v90, s[64:65]
    v_mfma_f32_16x16x32_bf16 v[188:191], v[120:123], a[16:19], v[188:191]
    s_add_u32 m0, m0, s53
    v_mfma_f32_16x16x32_bf16 v[188:191], v[124:127], a[44:47], v[188:191]
    v_mfma_f32_16x16x32_bf16 v[192:195], v[120:123], a[20:23], v[192:195]
    v_mfma_f32_16x16x32_bf16 v[192:195], v[124:127], a[48:51], v[192:195]
    v_mfma_f32_16x16x32_bf16 v[196:199], v[120:123], a[24:27], v[196:199]
    v_mfma_f32_16x16x32_bf16 v[196:199], v[124:127], a[52:55], v[196:199]
    global_load_lds_dwordx4 v91, s[64:65]
    v_mfma_f32_16x16x32_bf16 v[200:203], v[128:131], a[0:3], v[200:203]
    s_add_u32 m0, m0, s53
    ds_read_b64_tr_b16 v[120:121], v11 offset:25376
    v_mfma_f32_16x16x32_bf16 v[200:203], v[132:135], a[28:31], v[200:203]
    ds_read_b64_tr_b16 v[122:123], v11 offset:25504
    v_mfma_f32_16x16x32_bf16 v[204:207], v[128:131], a[4:7], v[204:207]
    ds_read_b64_tr_b16 v[124:125], v11 offset:25888
    v_mfma_f32_16x16x32_bf16 v[204:207], v[132:135], a[32:35], v[204:207]
    ds_read_b64_tr_b16 v[126:127], v11 offset:26016
    v_mfma_f32_16x16x32_bf16 v[208:211], v[128:131], a[8:11], v[208:211]
    v_mfma_f32_16x16x32_bf16 v[208:211], v[132:135], a[36:39], v[208:211]
    global_load_lds_dwordx4 v92, s[64:65]
    v_mfma_f32_16x16x32_bf16 v[212:215], v[128:131], a[12:15], v[212:215]
    s_add_u32 m0, m0, s53
    v_mfma_f32_16x16x32_bf16 v[212:215], v[132:135], a[40:43], v[212:215]
    v_mfma_f32_16x16x32_bf16 v[216:219], v[128:131], a[16:19], v[216:219]
    v_mfma_f32_16x16x32_bf16 v[216:219], v[132:135], a[44:47], v[216:219]
    v_mfma_f32_16x16x32_bf16 v[220:223], v[128:131], a[20:23], v[220:223]
    v_mfma_f32_16x16x32_bf16 v[220:223], v[132:135], a[48:51], v[220:223]
    global_load_lds_dwordx4 v93, s[64:65]
    v_mfma_f32_16x16x32_bf16 v[224:227], v[128:131], a[24:27], v[224:227]
    s_add_u32 m0, m0, s53
    v_mfma_f32_16x16x32_bf16 v[224:227], v[132:135], a[52:55], v[224:227]
    ds_read_b64_tr_b16 v[128:129], v11 offset:25408
    v_mfma_f32_16x16x32_bf16 v[228:231], v[136:139], a[0:3], v[228:231]
    ds_read_b64_tr_b16 v[130:131], v11 offset:25536
    v_mfma_f32_16x16x32_bf16 v[228:231], v[140:143], a[28:31], v[228:231]
    ds_read_b64_tr_b16 v[132:133], v11 offset:25920
    v_mfma_f32_16x16x32_bf16 v[232:235], v[136:139], a[4:7], v[232:235]
    ds_read_b64_tr_b16 v[134:135], v11 offset:26048
    v_mfma_f32_16x16x32_bf16 v[232:235], v[140:143], a[32:35], v[232:235]
    global_load_lds_dwordx4 v94, s[64:65]
    v_mfma_f32_16x16x32_bf16 v[236:239], v[136:139], a[8:11], v[236:239]
    s_add_u32 m0, m0, s53
    v_mfma_f32_16x16x32_bf16 v[236:239], v[140:143], a[36:39], v[236:239]
    v_mfma_f32_16x16x32_bf16 v[240:243], v[136:139], a[12:15], v[240:243]
    v_mfma_f32_16x16x32_bf16 v[240:243], v[140:143], a[40:43], v[240:243]
    v_mfma_f32_16x16x32_bf16 v[244:247], v[136:139], a[16:19], v[244:247]
    v_mfma_f32_16x16x32_bf16 v[244:247], v[140:143], a[44:47], v[244:247]
    global_load_lds_dwordx4 v95, s[64:65]
    v_mfma_f32_16x16x32_bf16 v[248:251], v[136:139], a[20:23], v[248:251]
    s_waitcnt lgkmcnt(4)
    v_mfma_f32_16x16x32_bf16 v[248:251], v[140:143], a[48:51], v[248:251]
    v_mfma_f32_16x16x32_bf16 v[252:255], v[136:139], a[24:27], v[252:255]
    ds_read_b64_tr_b16 v[136:137], v11 offset:25440
    ds_read_b64_tr_b16 v[138:139], v11 offset:25568
    v_mfma_f32_16x16x32_bf16 v[252:255], v[140:143], a[52:55], v[252:255]
    ds_read_b64_tr_b16 v[140:141], v11 offset:25952
    ds_read_b64_tr_b16 v[142:143], v11 offset:26080
    v_mfma_f32_16x16x32_bf16 a[112:115], v[112:115], a[0:3], a[112:115]
    s_add_u32 m0, s33, 25344
    v_mfma_f32_16x16x32_bf16 a[112:115], v[116:119], a[28:31], a[112:115]
    s_add_u32 s49, s50, s46
    v_mfma_f32_16x16x32_bf16 a[116:119], v[112:115], a[4:7], a[116:119]
    s_lshl1_add_u32 s50, s51, s50
    v_add_u32 v104, s49, v26
    v_mfma_f32_16x16x32_bf16 a[116:119], v[116:119], a[32:35], a[116:119]
    s_add_u32 s82, s82, 2
    v_mfma_f32_16x16x32_bf16 a[120:123], v[112:115], a[8:11], a[120:123]
    s_cmp_eq_u32 s82, 20
    v_mfma_f32_16x16x32_bf16 a[120:123], v[116:119], a[36:39], a[120:123]
    s_cselect_b32 s29, s83, 0
    v_mfma_f32_16x16x32_bf16 a[124:127], v[112:115], a[12:15], a[124:127]
    s_sub_u32 s50, s50, s29
    s_waitcnt vmcnt(8) lgkmcnt(0)
    s_barrier
    ds_read_b128 v[28:31], v27 offset:0
    v_mfma_f32_16x16x32_bf16 a[124:127], v[116:119], a[40:43], a[124:127]
    s_add_u32 s64, s16, s49
    ds_read_b128 v[32:35], v27 offset:2048
    v_mfma_f32_16x16x32_bf16 a[128:131], v[112:115], a[16:19], a[128:131]
    s_addc_u32 s65, s17, 0
    ds_read_b128 v[36:39], v27 offset:4096
    v_mfma_f32_16x16x32_bf16 a[128:131], v[116:119], a[44:47], a[128:131]
    global_load_lds_dwordx4 v88, s[64:65]
    v_mfma_f32_16x16x32_bf16 a[132:135], v[112:115], a[20:23], a[132:135]
    s_add_u32 m0, m0, s53
    ds_read_b128 v[40:43], v27 offset:6144
    v_mfma_f32_16x16x32_bf16 a[132:135], v[116:119], a[48:51], a[132:135]
    ds_read_b128 v[44:47], v27 offset:8448
    v_mfma_f32_16x16x32_bf16 a[136:139], v[112:115], a[24:27], a[136:139]
    ds_read_b128 v[48:51], v27 offset:10496
    v_mfma_f32_16x16x32_bf16 a[136:139], v[116:119], a[52:55], a[136:139]
    ds_read_b128 v[52:55], v27 offset:12544
    v_mfma_f32_16x16x32_bf16 a[140:143], v[120:123], a[0:3], a[140:143]
    ds_read_b128 v[56:59], v6 offset:0
    v_mfma_f32_16x16x32_bf16 a[140:143], v[124:127], a[28:31], a[140:143]
    global_load_lds_dwordx4 v89, s[64:65]
    v_mfma_f32_16x16x32_bf16 a[144:147], v[120:123], a[4:7], a[144:147]
    s_add_u32 m0, m0, s53
    ds_read_b128 v[60:63], v6 offset:2048
    v_mfma_f32_16x16x32_bf16 a[144:147], v[124:127], a[32:35], a[144:147]
    ds_read_b128 v[64:67], v6 offset:4096
    v_mfma_f32_16x16x32_bf16 a[148:151], v[120:123], a[8:11], a[148:151]
    ds_read_b128 v[68:71], v6 offset:6144
    v_mfma_f32_16x16x32_bf16 a[148:151], v[124:127], a[36:39], a[148:151]
    ds_read_b128 v[72:75], v6 offset:8448
    v_mfma_f32_16x16x32_bf16 a[152:155], v[120:123], a[12:15], a[152:155]
    ds_read_b128 v[76:79], v6 offset:10496
    v_mfma_f32_16x16x32_bf16 a[152:155], v[124:127], a[40:43], a[152:155]
    global_load_lds_dwordx4 v90, s[64:65]
    v_mfma_f32_16x16x32_bf16 a[156:159], v[120:123], a[16:19], a[156:159]
    s_add_u32 m0, m0, s53
    ds_read_b128 v[80:83], v6 offset:12544
    v_mfma_f32_16x16x32_bf16 a[156:159], v[124:127], a[44:47], a[156:159]
    ds_read_b64_tr_b16 v[112:113], v11 offset:0
    v_mfma_f32_16x16x32_bf16 a[160:163], v[120:123], a[20:23], a[160:163]
    ds_read_b64_tr_b16 v[114:115], v11 offset:128
    v_mfma_f32_16x16x32_bf16 a[160:163], v[124:127], a[48:51], a[160:163]
    ds_read_b64_tr_b16 v[116:117], v11 offset:512
    v_mfma_f32_16x16x32_bf16 a[164:167], v[120:123], a[24:27], a[164:167]
    ds_read_b64_tr_b16 v[118:119], v11 offset:640
    v_mfma_f32_16x16x32_bf16 a[164:167], v[124:127], a[52:55], a[164:167]
    global_load_lds_dwordx4 v91, s[64:65]
    v_mfma_f32_16x16x32_bf16 a[168:171], v[128:131], a[0:3], a[168:171]
    s_add_u32 m0, m0, s53
    ds_read_b64_tr_b16 v[120:121], v11 offset:32
    v_mfma_f32_16x16x32_bf16 a[168:171], v[132:135], a[28:31], a[168:171]
    ds_read_b64_tr_b16 v[122:123], v11 offset:160
    v_mfma_f32_16x16x32_bf16 a[172:175], v[128:131], a[4:7], a[172:175]
    ds_read_b64_tr_b16 v[124:125], v11 offset:544
    v_mfma_f32_16x16x32_bf16 a[172:175], v[132:135], a[32:35], a[172:175]
    ds_read_b64_tr_b16 v[126:127], v11 offset:672
    v_mfma_f32_16x16x32_bf16 a[176:179], v[128:131], a[8:11], a[176:179]
    v_mfma_f32_16x16x32_bf16 a[176:179], v[132:135], a[36:39], a[176:179]
    global_load_lds_dwordx4 v92, s[64:65]
    v_mfma_f32_16x16x32_bf16 a[180:183], v[128:131], a[12:15], a[180:183]
    s_add_u32 m0, m0, s53
    v_mfma_f32_16x16x32_bf16 a[180:183], v[132:135], a[40:43], a[180:183]
    v_mfma_f32_16x16x32_bf16 a[184:187], v[128:131], a[16:19], a[184:187]
    v_mfma_f32_16x16x32_bf16 a[184:187], v[132:135], a[44:47], a[184:187]
    v_mfma_f32_16x16x32_bf16 a[188:191], v[128:131], a[20:23], a[188:191]
    v_mfma_f32_16x16x32_bf16 a[188:191], v[132:135], a[48:51], a[188:191]
    global_load_lds_dwordx4 v93, s[64:65]
    v_mfma_f32_16x16x32_bf16 a[192:195], v[128:131], a[24:27], a[192:195]
    s_add_u32 m0, m0, s53
    v_mfma_f32_16x16x32_bf16 a[192:195], v[132:135], a[52:55], a[192:195]
    ds_read_b64_tr_b16 v[128:129], v11 offset:64
    v_mfma_f32_16x16x32_bf16 a[196:199], v[136:139], a[0:3], a[196:199]
    ds_read_b64_tr_b16 v[130:131], v11 offset:192
    v_mfma_f32_16x16x32_bf16 a[196:199], v[140:143], a[28:31], a[196:199]
    ds_read_b64_tr_b16 v[132:133], v11 offset:576
    v_mfma_f32_16x16x32_bf16 a[200:203], v[136:139], a[4:7], a[200:203]
    ds_read_b64_tr_b16 v[134:135], v11 offset:704
    v_mfma_f32_16x16x32_bf16 a[200:203], v[140:143], a[32:35], a[200:203]
    buffer_load_dwordx4 v104, s[16:19], s47 offen lds
    v_mfma_f32_16x16x32_bf16 a[204:207], v[136:139], a[8:11], a[204:207]
    s_add_u32 m0, m0, s53
    v_mfma_f32_16x16x32_bf16 a[204:207], v[140:143], a[36:39], a[204:207]
    v_mfma_f32_16x16x32_bf16 a[208:211], v[136:139], a[12:15], a[208:211]
    v_mfma_f32_16x16x32_bf16 a[208:211], v[140:143], a[40:43], a[208:211]
    v_mfma_f32_16x16x32_bf16 a[212:215], v[136:139], a[16:19], a[212:215]
    v_mfma_f32_16x16x32_bf16 a[212:215], v[140:143], a[44:47], a[212:215]
    buffer_load_dwordx4 v104, s[16:19], s98 offen lds
    v_mfma_f32_16x16x32_bf16 a[216:219], v[136:139], a[20:23], a[216:219]
    s_waitcnt lgkmcnt(4)
    v_mfma_f32_16x16x32_bf16 a[216:219], v[140:143], a[48:51], a[216:219]
    v_mfma_f32_16x16x32_bf16 a[220:223], v[136:139], a[24:27], a[220:223]
    ds_read_b64_tr_b16 v[136:137], v11 offset:96
    ds_read_b64_tr_b16 v[138:139], v11 offset:224
    v_mfma_f32_16x16x32_bf16 a[220:223], v[140:143], a[52:55], a[220:223]
    ds_read_b64_tr_b16 v[140:141], v11 offset:608
    ds_read_b64_tr_b16 v[142:143], v11 offset:736
    s_add_u32 s22, s22, 1
    s_cmp_lt_u32 s22, 3
    s_cbranch_scc1 L_at_qploop
    s_cmp_lg_u32 s70, 0
    s_cbranch_scc1 L_at_qptailB
    v_mfma_f32_16x16x32_bf16 v[144:147], v[112:115], v[28:31], v[144:147]
    s_add_u32 s29, s34, s100
    v_mfma_f32_16x16x32_bf16 v[144:147], v[116:119], v[56:59], v[144:147]
    s_bfe_u32 s28, s29, 0x20003
    v_mfma_f32_16x16x32_bf16 v[148:151], v[112:115], v[32:35], v[148:151]
    s_lshl_b32 s28, s28, 16
    v_mfma_f32_16x16x32_bf16 v[148:151], v[116:119], v[60:63], v[148:151]
    s_and_b32 s29, s29, 7
    v_mfma_f32_16x16x32_bf16 v[152:155], v[112:115], v[36:39], v[152:155]
    s_lshl_b32 s29, s29, 11
    v_mfma_f32_16x16x32_bf16 v[152:155], v[116:119], v[64:67], v[152:155]
    s_add_u32 s29, s28, s29
    v_mfma_f32_16x16x32_bf16 v[156:159], v[112:115], v[40:43], v[156:159]
    s_lshr_b32 s28, s34, 5
    s_waitcnt vmcnt(16) lgkmcnt(0)
    s_barrier
    v_mfma_f32_16x16x32_bf16 v[156:159], v[116:119], v[68:71], v[156:159]
    s_lshl_b32 s28, s28, 19
    v_mfma_f32_16x16x32_bf16 v[160:163], v[112:115], v[44:47], v[160:163]
    s_add_u32 s49, s28, s29
    v_mfma_f32_16x16x32_bf16 v[160:163], v[116:119], v[72:75], v[160:163]
    s_add_u32 m0, s33, 0
    v_mfma_f32_16x16x32_bf16 v[164:167], v[112:115], v[48:51], v[164:167]
    s_add_u32 s34, s34, 1
    v_mfma_f32_16x16x32_bf16 v[164:167], v[116:119], v[76:79], v[164:167]
    buffer_load_dwordx4 v7, s[4:7], s49 offen offset:0 nt lds
    v_mfma_f32_16x16x32_bf16 v[168:171], v[112:115], v[52:55], v[168:171]
    s_add_u32 m0, m0, s96
    v_mfma_f32_16x16x32_bf16 v[168:171], v[116:119], v[80:83], v[168:171]
    ds_read_b64_tr_b16 v[112:113], v11 offset:8448
    v_mfma_f32_16x16x32_bf16 v[172:175], v[120:123], v[28:31], v[172:175]
    ds_read_b64_tr_b16 v[114:115], v11 offset:8576
    v_mfma_f32_16x16x32_bf16 v[172:175], v[124:127], v[56:59], v[172:175]
    buffer_load_dwordx4 v7, s[4:7], s49 offen offset:256 nt lds
    v_mfma_f32_16x16x32_bf16 v[176:179], v[120:123], v[32:35], v[176:179]
    s_add_u32 m0, m0, s97
    ds_read_b64_tr_b16 v[116:117], v11 offset:8960
    v_mfma_f32_16x16x32_bf16 v[176:179], v[124:127], v[60:63], v[176:179]
    ds_read_b64_tr_b16 v[118:119], v11 offset:9088
    v_mfma_f32_16x16x32_bf16 v[180:183], v[120:123], v[36:39], v[180:183]
    v_mfma_f32_16x16x32_bf16 v[180:183], v[124:127], v[64:67], v[180:183]
    v_mfma_f32_16x16x32_bf16 v[184:187], v[120:123], v[40:43], v[184:187]
    v_mfma_f32_16x16x32_bf16 v[184:187], v[124:127], v[68:71], v[184:187]
    buffer_load_dwordx4 v7, s[4:7], s49 offen offset:512 nt lds
    v_mfma_f32_16x16x32_bf16 v[188:191], v[120:123], v[44:47], v[188:191]
    s_add_u32 m0, m0, s96
    v_mfma_f32_16x16x32_bf16 v[188:191], v[124:127], v[72:75], v[188:191]
    v_mfma_f32_16x16x32_bf16 v[192:195], v[120:123], v[48:51], v[192:195]
    v_mfma_f32_16x16x32_bf16 v[192:195], v[124:127], v[76:79], v[192:195]
    v_mfma_f32_16x16x32_bf16 v[196:199], v[120:123], v[52:55], v[196:199]
    v_mfma_f32_16x16x32_bf16 v[196:199], v[124:127], v[80:83], v[196:199]
    buffer_load_dwordx4 v7, s[4:7], s49 offen offset:768 nt lds
    v_mfma_f32_16x16x32_bf16 v[200:203], v[128:131], v[28:31], v[200:203]
    s_add_u32 m0, m0, s97
    ds_read_b64_tr_b16 v[120:121], v11 offset:8480
    v_mfma_f32_16x16x32_bf16 v[200:203], v[132:135], v[56:59], v[200:203]
    ds_read_b64_tr_b16 v[122:123], v11 offset:8608
    v_mfma_f32_16x16x32_bf16 v[204:207], v[128:131], v[32:35], v[204:207]
    ds_read_b64_tr_b16 v[124:125], v11 offset:8992
    v_mfma_f32_16x16x32_bf16 v[204:207], v[132:135], v[60:63], v[204:207]
    ds_read_b64_tr_b16 v[126:127], v11 offset:9120
    v_mfma_f32_16x16x32_bf16 v[208:211], v[128:131], v[36:39], v[208:211]
    v_mfma_f32_16x16x32_bf16 v[208:211], v[132:135], v[64:67], v[208:211]
    buffer_load_dwordx4 v7, s[4:7], s49 offen offset:1024 nt lds
    v_mfma_f32_16x16x32_bf16 v[212:215], v[128:131], v[40:43], v[212:215]
    s_add_u32 m0, m0, s96
    v_mfma_f32_16x16x32_bf16 v[212:215], v[132:135], v[68:71], v[212:215]
    v_mfma_f32_16x16x32_bf16 v[216:219], v[128:131], v[44:47], v[216:219]
    v_mfma_f32_16x16x32_bf16 v[216:219], v[132:135], v[72:75], v[216:219]
    v_mfma_f32_16x16x32_bf16 v[220:223], v[128:131], v[48:51], v[220:223]
    v_mfma_f32_16x16x32_bf16 v[220:223], v[132:135], v[76:79], v[220:223]
    buffer_load_dwordx4 v7, s[4:7], s49 offen offset:1280 nt lds
    v_mfma_f32_16x16x32_bf16 v[224:227], v[128:131], v[52:55], v[224:227]
    s_add_u32 m0, m0, s97
    v_mfma_f32_16x16x32_bf16 v[224:227], v[132:135], v[80:83], v[224:227]
    ds_read_b64_tr_b16 v[128:129], v11 offset:8512
    v_mfma_f32_16x16x32_bf16 v[228:231], v[136:139], v[28:31], v[228:231]
    ds_read_b64_tr_b16 v[130:131], v11 offset:8640
    v_mfma_f32_16x16x32_bf16 v[228:231], v[140:143], v[56:59], v[228:231]
    ds_read_b64_tr_b16 v[132:133], v11 offset:9024
    v_mfma_f32_16x16x32_bf16 v[232:235], v[136:139], v[32:35], v[232:235]
    ds_read_b64_tr_b16 v[134:135], v11 offset:9152
    v_mfma_f32_16x16x32_bf16 v[232:235], v[140:143], v[60:63], v[232:235]
    buffer_load_dwordx4 v7, s[4:7], s49 offen offset:1536 nt lds
    v_mfma_f32_16x16x32_bf16 v[236:239], v[136:139], v[36:39], v[236:239]
    s_add_u32 m0, m0, s96
    v_mfma_f32_16x16x32_bf16 v[236:239], v[140:143], v[64:67], v[236:239]
    v_mfma_f32_16x16x32_bf16 v[240:243], v[136:139], v[40:43], v[240:243]
    v_mfma_f32_16x16x32_bf16 v[240:243], v[140:143], v[68:71], v[240:243]
    v_mfma_f32_16x16x32_bf16 v[244:247], v[136:139], v[44:47], v[244:247]
    v_mfma_f32_16x16x32_bf16 v[244:247], v[140:143], v[72:75], v[244:247]
    buffer_load_dwordx4 v7, s[4:7], s49 offen offset:1792 nt lds
    v_mfma_f32_16x16x32_bf16 v[248:251], v[136:139], v[48:51], v[248:251]
    s_waitcnt lgkmcnt(4)
    v_mfma_f32_16x16x32_bf16 v[248:251], v[140:143], v[76:79], v[248:251]
    v_mfma_f32_16x16x32_bf16 v[252:255], v[136:139], v[52:55], v[252:255]
    ds_read_b64_tr_b16 v[136:137], v11 offset:8544
    ds_read_b64_tr_b16 v[138:139], v11 offset:8672
    v_mfma_f32_16x16x32_bf16 v[252:255], v[140:143], v[80:83], v[252:255]
    ds_read_b64_tr_b16 v[140:141], v11 offset:9056
    ds_read_b64_tr_b16 v[142:143], v11 offset:9184
    v_mfma_f32_16x16x32_bf16 a[112:115], v[112:115], v[28:31], a[112:115]
    s_add_u32 s29, s34, s100
    v_mfma_f32_16x16x32_bf16 a[112:115], v[116:119], v[56:59], a[112:115]
    s_bfe_u32 s28, s29, 0x20003
    v_mfma_f32_16x16x32_bf16 a[116:119], v[112:115], v[32:35], a[116:119]
    s_lshl_b32 s28, s28, 16
    v_mfma_f32_16x16x32_bf16 a[116:119], v[116:119], v[60:63], a[116:119]
    s_and_b32 s29, s29, 7
    v_mfma_f32_16x16x32_bf16 a[120:123], v[112:115], v[36:39], a[120:123]
    s_lshl_b32 s29, s29, 11
    v_mfma_f32_16x16x32_bf16 a[120:123], v[116:119], v[64:67], a[120:123]
    s_add_u32 s29, s28, s29
    v_mfma_f32_16x16x32_bf16 a[124:127], v[112:115], v[40:43], a[124:127]
    s_lshr_b32 s28, s34, 5
    s_waitcnt vmcnt(8) lgkmcnt(0)
    s_barrier
    ds_read_b128 a[0:3], v27 offset:16896
    v_mfma_f32_16x16x32_bf16 a[124:127], v[116:119], v[68:71], a[124:127]
    s_lshl_b32 s28, s28, 19
    ds_read_b128 a[4:7], v27 offset:18944
    v_mfma_f32_16x16x32_bf16 a[128:131], v[112:115], v[44:47], a[128:131]
    s_add_u32 s49, s28, s29
    ds_read_b128 a[8:11], v27 offset:20992
    v_mfma_f32_16x16x32_bf16 a[128:131], v[116:119], v[72:75], a[128:131]
    s_add_u32 m0, s33, 8448
    ds_read_b128 a[12:15], v27 offset:23040
    v_mfma_f32_16x16x32_bf16 a[132:135], v[112:115], v[48:51], a[132:135]
    s_add_u32 s34, s34, 1
    ds_read_b128 a[16:19], v27 offset:25344
    v_mfma_f32_16x16x32_bf16 a[132:135], v[116:119], v[76:79], a[132:135]
    buffer_load_dwordx4 v7, s[4:7], s49 offen offset:0 nt lds
    v_mfma_f32_16x16x32_bf16 a[136:139], v[112:115], v[52:55], a[136:139]
    s_add_u32 m0, m0, s96
    ds_read_b128 a[20:23], v27 offset:27392
    v_mfma_f32_16x16x32_bf16 a[136:139], v[116:119], v[80:83], a[136:139]
    ds_read_b128 a[24:27], v27 offset:29440
    v_mfma_f32_16x16x32_bf16 a[140:143], v[120:123], v[28:31], a[140:143]
    ds_read_b128 a[28:31], v6 offset:16896
    v_mfma_f32_16x16x32_bf16 a[140:143], v[124:127], v[56:59], a[140:143]
    buffer_load_dwordx4 v7, s[4:7], s49 offen offset:256 nt lds
    v_mfma_f32_16x16x32_bf16 a[144:147], v[120:123], v[32:35], a[144:147]
    s_add_u32 m0, m0, s97
    ds_read_b128 a[32:35], v6 offset:18944
    v_mfma_f32_16x16x32_bf16 a[144:147], v[124:127], v[60:63], a[144:147]
    ds_read_b128 a[36:39], v6 offset:20992
    v_mfma_f32_16x16x32_bf16 a[148:151], v[120:123], v[36:39], a[148:151]
    ds_read_b128 a[40:43], v6 offset:23040
    v_mfma_f32_16x16x32_bf16 a[148:151], v[124:127], v[64:67], a[148:151]
    ds_read_b128 a[44:47], v6 offset:25344
    v_mfma_f32_16x16x32_bf16 a[152:155], v[120:123], v[40:43], a[152:155]
    ds_read_b128 a[48:51], v6 offset:27392
    v_mfma_f32_16x16x32_bf16 a[152:155], v[124:127], v[68:71], a[152:155]
    buffer_load_dwordx4 v7, s[4:7], s49 offen offset:512 nt lds
    v_mfma_f32_16x16x32_bf16 a[156:159], v[120:123], v[44:47], a[156:159]
    s_add_u32 m0, m0, s96
    ds_read_b128 a[52:55], v6 offset:29440
    v_mfma_f32_16x16x32_bf16 a[156:159], v[124:127], v[72:75], a[156:159]
    ds_read_b64_tr_b16 v[112:113], v11 offset:16896
    v_mfma_f32_16x16x32_bf16 a[160:163], v[120:123], v[48:51], a[160:163]
    ds_read_b64_tr_b16 v[114:115], v11 offset:17024
    v_mfma_f32_16x16x32_bf16 a[160:163], v[124:127], v[76:79], a[160:163]
    ds_read_b64_tr_b16 v[116:117], v11 offset:17408
    v_mfma_f32_16x16x32_bf16 a[164:167], v[120:123], v[52:55], a[164:167]
    ds_read_b64_tr_b16 v[118:119], v11 offset:17536
    v_mfma_f32_16x16x32_bf16 a[164:167], v[124:127], v[80:83], a[164:167]
    buffer_load_dwordx4 v7, s[4:7], s49 offen offset:768 nt lds
    v_mfma_f32_16x16x32_bf16 a[168:171], v[128:131], v[28:31], a[168:171]
    s_add_u32 m0, m0, s97
    ds_read_b64_tr_b16 v[120:121], v11 offset:16928
    v_mfma_f32_16x16x32_bf16 a[168:171], v[132:135], v[56:59], a[168:171]
    ds_read_b64_tr_b16 v[122:123], v11 offset:17056
    v_mfma_f32_16x16x32_bf16 a[172:175], v[128:131], v[32:35], a[172:175]
    ds_read_b64_tr_b16 v[124:125], v11 offset:17440
    v_mfma_f32_16x16x32_bf16 a[172:175], v[132:135], v[60:63], a[172:175]
    ds_read_b64_tr_b16 v[126:127], v11 offset:17568
    v_mfma_f32_16x16x32_bf16 a[176:179], v[128:131], v[36:39], a[176:179]
    v_mfma_f32_16x16x32_bf16 a[176:179], v[132:135], v[64:67], a[176:179]
    buffer_load_dwordx4 v7, s[4:7], s49 offen offset:1024 nt lds
    v_mfma_f32_16x16x32_bf16 a[180:183], v[128:131], v[40:43], a[180:183]
    s_add_u32 m0, m0, s96
    v_mfma_f32_16x16x32_bf16 a[180:183], v[132:135], v[68:71], a[180:183]
    v_mfma_f32_16x16x32_bf16 a[184:187], v[128:131], v[44:47], a[184:187]
    v_mfma_f32_16x16x32_bf16 a[184:187], v[132:135], v[72:75], a[184:187]
    v_mfma_f32_16x16x32_bf16 a[188:191], v[128:131], v[48:51], a[188:191]
    v_mfma_f32_16x16x32_bf16 a[188:191], v[132:135], v[76:79], a[188:191]
    buffer_load_dwordx4 v7, s[4:7], s49 offen offset:1280 nt lds
    v_mfma_f32_16x16x32_bf16 a[192:195], v[128:131], v[52:55], a[192:195]
    s_add_u32 m0, m0, s97
    v_mfma_f32_16x16x32_bf16 a[192:195], v[132:135], v[80:83], a[192:195]
    ds_read_b64_tr_b16 v[128:129], v11 offset:16960
    v_mfma_f32_16x16x32_bf16 a[196:199], v[136:139], v[28:31], a[196:199]
    ds_read_b64_tr_b16 v[130:131], v11 offset:17088
    v_mfma_f32_16x16x32_bf16 a[196:199], v[140:143], v[56:59], a[196:199]
    ds_read_b64_tr_b16 v[132:133], v11 offset:17472
    v_mfma_f32_16x16x32_bf16 a[200:203], v[136:139], v[32:35], a[200:203]
    ds_read_b64_tr_b16 v[134:135], v11 offset:17600
    v_mfma_f32_16x16x32_bf16 a[200:203], v[140:143], v[60:63], a[200:203]
    buffer_load_dwordx4 v7, s[4:7], s49 offen offset:1536 nt lds
    v_mfma_f32_16x16x32_bf16 a[204:207], v[136:139], v[36:39], a[204:207]
    s_add_u32 m0, m0, s96
    v_mfma_f32_16x16x32_bf16 a[204:207], v[140:143], v[64:67], a[204:207]
    v_mfma_f32_16x16x32_bf16 a[208:211], v[136:139], v[40:43], a[208:211]
    v_mfma_f32_16x16x32_bf16 a[208:211], v[140:143], v[68:71], a[208:211]
    v_mfma_f32_16x16x32_bf16 a[212:215], v[136:139], v[44:47], a[212:215]
    v_mfma_f32_16x16x32_bf16 a[212:215], v[140:143], v[72:75], a[212:215]
    buffer_load_dwordx4 v7, s[4:7], s49 offen offset:1792 nt lds
    v_mfma_f32_16x16x32_bf16 a[216:219], v[136:139], v[48:51], a[216:219]
    s_waitcnt lgkmcnt(4)
    v_mfma_f32_16x16x32_bf16 a[216:219], v[140:143], v[76:79], a[216:219]
    v_mfma_f32_16x16x32_bf16 a[220:223], v[136:139], v[52:55], a[220:223]
    ds_read_b64_tr_b16 v[136:137], v11 offset:16992
    ds_read_b64_tr_b16 v[138:139], v11 offset:17120
    v_mfma_f32_16x16x32_bf16 a[220:223], v[140:143], v[80:83], a[220:223]
    ds_read_b64_tr_b16 v[140:141], v11 offset:17504
    ds_read_b64_tr_b16 v[142:143], v11 offset:17632
    v_mfma_f32_16x16x32_bf16 v[144:147], v[112:115], a[0:3], v[144:147]
    s_add_u32 s29, s34, s100
    v_mfma_f32_16x16x32_bf16 v[144:147], v[116:119], a[28:31], v[144:147]
    s_bfe_u32 s28, s29, 0x20003
    v_mfma_f32_16x16x32_bf16 v[148:151], v[112:115], a[4:7], v[148:151]
    s_lshl_b32 s28, s28, 16
    v_mfma_f32_16x16x32_bf16 v[148:151], v[116:119], a[32:35], v[148:151]
    s_and_b32 s29, s29, 7
    v_mfma_f32_16x16x32_bf16 v[152:155], v[112:115], a[8:11], v[152:155]
    s_lshl_b32 s29, s29, 11
    v_mfma_f32_16x16x32_bf16 v[152:155], v[116:119], a[36:39], v[152:155]
    s_add_u32 s29, s28, s29
    v_mfma_f32_16x16x32_bf16 v[156:159], v[112:115], a[12:15], v[156:159]
    s_lshr_b32 s28, s34, 5
    s_waitcnt vmcnt(16) lgkmcnt(0)
    s_barrier
    v_mfma_f32_16x16x32_bf16 v[156:159], v[116:119], a[40:43], v[156:159]
    s_lshl_b32 s28, s28, 19
    v_mfma_f32_16x16x32_bf16 v[160:163], v[112:115], a[16:19], v[160:163]
    s_add_u32 s49, s28, s29
    v_mfma_f32_16x16x32_bf16 v[160:163], v[116:119], a[44:47], v[160:163]
    s_add_u32 m0, s33, 16896
    v_mfma_f32_16x16x32_bf16 v[164:167], v[112:115], a[20:23], v[164:167]
    s_add_u32 s34, s34, 1
    v_mfma_f32_16x16x32_bf16 v[164:167], v[116:119], a[48:51], v[164:167]
    buffer_load_dwordx4 v7, s[4:7], s49 offen offset:0 nt lds
    v_mfma_f32_16x16x32_bf16 v[168:171], v[112:115], a[24:27], v[168:171]
    s_add_u32 m0, m0, s96
    v_mfma_f32_16x16x32_bf16 v[168:171], v[116:119], a[52:55], v[168:171]
    ds_read_b64_tr_b16 v[112:113], v11 offset:25344
    v_mfma_f32_16x16x32_bf16 v[172:175], v[120:123], a[0:3], v[172:175]
    ds_read_b64_tr_b16 v[114:115], v11 offset:25472
    v_mfma_f32_16x16x32_bf16 v[172:175], v[124:127], a[28:31], v[172:175]
    buffer_load_dwordx4 v7, s[4:7], s49 offen offset:256 nt lds
    v_mfma_f32_16x16x32_bf16 v[176:179], v[120:123], a[4:7], v[176:179]
    s_add_u32 m0, m0, s97
    ds_read_b64_tr_b16 v[116:117], v11 offset:25856
    v_mfma_f32_16x16x32_bf16 v[176:179], v[124:127], a[32:35], v[176:179]
    ds_read_b64_tr_b16 v[118:119], v11 offset:25984
    v_mfma_f32_16x16x32_bf16 v[180:183], v[120:123], a[8:11], v[180:183]
    v_mfma_f32_16x16x32_bf16 v[180:183], v[124:127], a[36:39], v[180:183]
    v_mfma_f32_16x16x32_bf16 v[184:187], v[120:123], a[12:15], v[184:187]
    v_mfma_f32_16x16x32_bf16 v[184:187], v[124:127], a[40:43], v[184:187]
    buffer_load_dwordx4 v7, s[4:7], s49 offen offset:512 nt lds
    v_mfma_f32_16x16x32_bf16 v[188:191], v[120:123], a[16:19], v[188:191]
    s_add_u32 m0, m0, s96
    v_mfma_f32_16x16x32_bf16 v[188:191], v[124:127], a[44:47], v[188:191]
    v_mfma_f32_16x16x32_bf16 v[192:195], v[120:123], a[20:23], v[192:195]
    v_mfma_f32_16x16x32_bf16 v[192:195], v[124:127], a[48:51], v[192:195]
    v_mfma_f32_16x16x32_bf16 v[196:199], v[120:123], a[24:27], v[196:199]
    v_mfma_f32_16x16x32_bf16 v[196:199], v[124:127], a[52:55], v[196:199]
    buffer_load_dwordx4 v7, s[4:7], s49 offen offset:768 nt lds
    v_mfma_f32_16x16x32_bf16 v[200:203], v[128:131], a[0:3], v[200:203]
    s_add_u32 m0, m0, s97
    ds_read_b64_tr_b16 v[120:121], v11 offset:25376
    v_mfma_f32_16x16x32_bf16 v[200:203], v[132:135], a[28:31], v[200:203]
    ds_read_b64_tr_b16 v[122:123], v11 offset:25504
    v_mfma_f32_16x16x32_bf16 v[204:207], v[128:131], a[4:7], v[204:207]
    ds_read_b64_tr_b16 v[124:125], v11 offset:25888
    v_mfma_f32_16x16x32_bf16 v[204:207], v[132:135], a[32:35], v[204:207]
    ds_read_b64_tr_b16 v[126:127], v11 offset:26016
    v_mfma_f32_16x16x32_bf16 v[208:211], v[128:131], a[8:11], v[208:211]
    v_mfma_f32_16x16x32_bf16 v[208:211], v[132:135], a[36:39], v[208:211]
    buffer_load_dwordx4 v7, s[4:7], s49 offen offset:1024 nt lds
    v_mfma_f32_16x16x32_bf16 v[212:215], v[128:131], a[12:15], v[212:215]
    s_add_u32 m0, m0, s96
    v_mfma_f32_16x16x32_bf16 v[212:215], v[132:135], a[40:43], v[212:215]
    v_mfma_f32_16x16x32_bf16 v[216:219], v[128:131], a[16:19], v[216:219]
    v_mfma_f32_16x16x32_bf16 v[216:219], v[132:135], a[44:47], v[216:219]
    v_mfma_f32_16x16x32_bf16 v[220:223], v[128:131], a[20:23], v[220:223]
    v_mfma_f32_16x16x32_bf16 v[220:223], v[132:135], a[48:51], v[220:223]
    buffer_load_dwordx4 v7, s[4:7], s49 offen offset:1280 nt lds
    v_mfma_f32_16x16x32_bf16 v[224:227], v[128:131], a[24:27], v[224:227]
    s_add_u32 m0, m0, s97
    v_mfma_f32_16x16x32_bf16 v[224:227], v[132:135], a[52:55], v[224:227]
    ds_read_b64_tr_b16 v[128:129], v11 offset:25408
    v_mfma_f32_16x16x32_bf16 v[228:231], v[136:139], a[0:3], v[228:231]
    ds_read_b64_tr_b16 v[130:131], v11 offset:25536
    v_mfma_f32_16x16x32_bf16 v[228:231], v[140:143], a[28:31], v[228:231]
    ds_read_b64_tr_b16 v[132:133], v11 offset:25920
    v_mfma_f32_16x16x32_bf16 v[232:235], v[136:139], a[4:7], v[232:235]
    ds_read_b64_tr_b16 v[134:135], v11 offset:26048
    v_mfma_f32_16x16x32_bf16 v[232:235], v[140:143], a[32:35], v[232:235]
    buffer_load_dwordx4 v7, s[4:7], s49 offen offset:1536 nt lds
    v_mfma_f32_16x16x32_bf16 v[236:239], v[136:139], a[8:11], v[236:239]
    s_add_u32 m0, m0, s96
    v_mfma_f32_16x16x32_bf16 v[236:239], v[140:143], a[36:39], v[236:239]
    v_mfma_f32_16x16x32_bf16 v[240:243], v[136:139], a[12:15], v[240:243]
    v_mfma_f32_16x16x32_bf16 v[240:243], v[140:143], a[40:43], v[240:243]
    v_mfma_f32_16x16x32_bf16 v[244:247], v[136:139], a[16:19], v[244:247]
    v_mfma_f32_16x16x32_bf16 v[244:247], v[140:143], a[44:47], v[244:247]
    buffer_load_dwordx4 v7, s[4:7], s49 offen offset:1792 nt lds
    v_mfma_f32_16x16x32_bf16 v[248:251], v[136:139], a[20:23], v[248:251]
    s_waitcnt lgkmcnt(4)
    v_mfma_f32_16x16x32_bf16 v[248:251], v[140:143], a[48:51], v[248:251]
    v_mfma_f32_16x16x32_bf16 v[252:255], v[136:139], a[24:27], v[252:255]
    ds_read_b64_tr_b16 v[136:137], v11 offset:25440
    ds_read_b64_tr_b16 v[138:139], v11 offset:25568
    v_mfma_f32_16x16x32_bf16 v[252:255], v[140:143], a[52:55], v[252:255]
    ds_read_b64_tr_b16 v[140:141], v11 offset:25952
    ds_read_b64_tr_b16 v[142:143], v11 offset:26080
    v_mfma_f32_16x16x32_bf16 a[112:115], v[112:115], a[0:3], a[112:115]
    s_add_u32 s29, s34, s100
    v_mfma_f32_16x16x32_bf16 a[112:115], v[116:119], a[28:31], a[112:115]
    s_bfe_u32 s28, s29, 0x20003
    v_mfma_f32_16x16x32_bf16 a[116:119], v[112:115], a[4:7], a[116:119]
    s_lshl_b32 s28, s28, 16
    v_mfma_f32_16x16x32_bf16 a[116:119], v[116:119], a[32:35], a[116:119]
    s_and_b32 s29, s29, 7
    v_mfma_f32_16x16x32_bf16 a[120:123], v[112:115], a[8:11], a[120:123]
    s_lshl_b32 s29, s29, 11
    v_mfma_f32_16x16x32_bf16 a[120:123], v[116:119], a[36:39], a[120:123]
    s_add_u32 s29, s28, s29
    v_mfma_f32_16x16x32_bf16 a[124:127], v[112:115], a[12:15], a[124:127]
    s_lshr_b32 s28, s34, 5
    s_waitcnt vmcnt(16) lgkmcnt(0)
    s_barrier
    ds_read_b128 v[56:59], v8 offset:0
    v_mfma_f32_16x16x32_bf16 a[124:127], v[116:119], a[40:43], a[124:127]
    s_lshl_b32 s28, s28, 19
    ds_read_b128 v[60:63], v8 offset:64
    v_mfma_f32_16x16x32_bf16 a[128:131], v[112:115], a[16:19], a[128:131]
    s_add_u32 s49, s28, s29
    ds_read_b128 v[64:67], v8 offset:128
    v_mfma_f32_16x16x32_bf16 a[128:131], v[116:119], a[44:47], a[128:131]
    s_add_u32 m0, s33, 25344
    ds_read_b128 v[68:71], v8 offset:192
    v_mfma_f32_16x16x32_bf16 a[132:135], v[112:115], a[20:23], a[132:135]
    s_add_u32 s34, s34, 1
    ds_read_b128 v[72:75], v8 offset:512
    v_mfma_f32_16x16x32_bf16 a[132:135], v[116:119], a[48:51], a[132:135]
    buffer_load_dwordx4 v7, s[4:7], s49 offen offset:0 nt lds
    v_mfma_f32_16x16x32_bf16 a[136:139], v[112:115], a[24:27], a[136:139]
    s_add_u32 m0, m0, s96
    ds_read_b128 v[76:79], v8 offset:576
    v_mfma_f32_16x16x32_bf16 a[136:139], v[116:119], a[52:55], a[136:139]
    ds_read_b128 v[80:83], v8 offset:640
    v_mfma_f32_16x16x32_bf16 a[140:143], v[120:123], a[0:3], a[140:143]
    ds_read_b128 v[84:87], v8 offset:704
    v_mfma_f32_16x16x32_bf16 a[140:143], v[124:127], a[28:31], a[140:143]
    buffer_load_dwordx4 v7, s[4:7], s49 offen offset:256 nt lds
    v_mfma_f32_16x16x32_bf16 a[144:147], v[120:123], a[4:7], a[144:147]
    s_add_u32 m0, m0, s97
    v_mfma_f32_16x16x32_bf16 a[144:147], v[124:127], a[32:35], a[144:147]
    v_mfma_f32_16x16x32_bf16 a[148:151], v[120:123], a[8:11], a[148:151]
    v_mfma_f32_16x16x32_bf16 a[148:151], v[124:127], a[36:39], a[148:151]
    v_mfma_f32_16x16x32_bf16 a[152:155], v[120:123], a[12:15], a[152:155]
    v_mfma_f32_16x16x32_bf16 a[152:155], v[124:127], a[40:43], a[152:155]
    buffer_load_dwordx4 v7, s[4:7], s49 offen offset:512 nt lds
    v_mfma_f32_16x16x32_bf16 a[156:159], v[120:123], a[16:19], a[156:159]
    s_add_u32 m0, m0, s96
    v_mfma_f32_16x16x32_bf16 a[156:159], v[124:127], a[44:47], a[156:159]
    v_mfma_f32_16x16x32_bf16 a[160:163], v[120:123], a[20:23], a[160:163]
    v_mfma_f32_16x16x32_bf16 a[160:163], v[124:127], a[48:51], a[160:163]
    v_mfma_f32_16x16x32_bf16 a[164:167], v[120:123], a[24:27], a[164:167]
    v_mfma_f32_16x16x32_bf16 a[164:167], v[124:127], a[52:55], a[164:167]
    buffer_load_dwordx4 v7, s[4:7], s49 offen offset:768 nt lds
    v_mfma_f32_16x16x32_bf16 a[168:171], v[128:131], a[0:3], a[168:171]
    s_add_u32 m0, m0, s97
    v_mfma_f32_16x16x32_bf16 a[168:171], v[132:135], a[28:31], a[168:171]
    v_mfma_f32_16x16x32_bf16 a[172:175], v[128:131], a[4:7], a[172:175]
    v_mfma_f32_16x16x32_bf16 a[172:175], v[132:135], a[32:35], a[172:175]
    v_mfma_f32_16x16x32_bf16 a[176:179], v[128:131], a[8:11], a[176:179]
    v_mfma_f32_16x16x32_bf16 a[176:179], v[132:135], a[36:39], a[176:179]
    buffer_load_dwordx4 v7, s[4:7], s49 offen offset:1024 nt lds
    v_mfma_f32_16x16x32_bf16 a[180:183], v[128:131], a[12:15], a[180:183]
    s_add_u32 m0, m0, s96
    v_mfma_f32_16x16x32_bf16 a[180:183], v[132:135], a[40:43], a[180:183]
    v_mfma_f32_16x16x32_bf16 a[184:187], v[128:131], a[16:19], a[184:187]
    v_mfma_f32_16x16x32_bf16 a[184:187], v[132:135], a[44:47], a[184:187]
    v_mfma_f32_16x16x32_bf16 a[188:191], v[128:131], a[20:23], a[188:191]
    v_mfma_f32_16x16x32_bf16 a[188:191], v[132:135], a[48:51], a[188:191]
    buffer_load_dwordx4 v7, s[4:7], s49 offen offset:1280 nt lds
    v_mfma_f32_16x16x32_bf16 a[192:195], v[128:131], a[24:27], a[192:195]
    s_add_u32 m0, m0, s97
    v_mfma_f32_16x16x32_bf16 a[192:195], v[132:135], a[52:55], a[192:195]
    v_mfma_f32_16x16x32_bf16 a[196:199], v[136:139], a[0:3], a[196:199]
    v_mfma_f32_16x16x32_bf16 a[196:199], v[140:143], a[28:31], a[196:199]
    v_mfma_f32_16x16x32_bf16 a[200:203], v[136:139], a[4:7], a[200:203]
    v_mfma_f32_16x16x32_bf16 a[200:203], v[140:143], a[32:35], a[200:203]
    buffer_load_dwordx4 v7, s[4:7], s49 offen offset:1536 nt lds
    v_mfma_f32_16x16x32_bf16 a[204:207], v[136:139], a[8:11], a[204:207]
    s_add_u32 m0, m0, s96
    v_mfma_f32_16x16x32_bf16 a[204:207], v[140:143], a[36:39], a[204:207]
    v_mfma_f32_16x16x32_bf16 a[208:211], v[136:139], a[12:15], a[208:211]
    v_mfma_f32_16x16x32_bf16 a[208:211], v[140:143], a[40:43], a[208:211]
    v_mfma_f32_16x16x32_bf16 a[212:215], v[136:139], a[16:19], a[212:215]
    v_mfma_f32_16x16x32_bf16 a[212:215], v[140:143], a[44:47], a[212:215]
    buffer_load_dwordx4 v7, s[4:7], s49 offen offset:1792 nt lds
    v_mfma_f32_16x16x32_bf16 a[216:219], v[136:139], a[20:23], a[216:219]
    v_mfma_f32_16x16x32_bf16 a[216:219], v[140:143], a[48:51], a[216:219]
    v_mfma_f32_16x16x32_bf16 a[220:223], v[136:139], a[24:27], a[220:223]
    v_mfma_f32_16x16x32_bf16 a[220:223], v[140:143], a[52:55], a[220:223]
    s_branch L_at_qpepi
L_at_qptailB:
    s_mul_i32 s50, s21, s52
    s_mov_b32 s101, s21
    s_add_u32 s50, s50, s55
    s_cmp_ge_u32 s21, 2
    s_cselect_b32 s28, 0x40000000, 0
    s_add_u32 s50, s50, s28
    s_mov_b32 s82, s26
    s_mul_i32 s28, s26, s51
    s_add_u32 s50, s50, s28
    v_mfma_f32_16x16x32_bf16 v[144:147], v[112:115], v[28:31], v[144:147]
    s_add_u32 m0, s33, 0
    v_mfma_f32_16x16x32_bf16 v[144:147], v[116:119], v[56:59], v[144:147]
    s_mov_b32 s49, s50
    v_mfma_f32_16x16x32_bf16 v[148:151], v[112:115], v[32:35], v[148:151]
    s_add_u32 s64, s16, s49
    v_mfma_f32_16x16x32_bf16 v[148:151], v[116:119], v[60:63], v[148:151]
    s_addc_u32 s65, s17, 0
    v_mfma_f32_16x16x32_bf16 v[152:155], v[112:115], v[36:39], v[152:155]
    v_mfma_f32_16x16x32_bf16 v[152:155], v[116:119], v[64:67], v[152:155]
    v_mfma_f32_16x16x32_bf16 v[156:159], v[112:115], v[40:43], v[156:159]
    s_waitcnt vmcnt(16) lgkmcnt(0)
    s_barrier
    v_mfma_f32_16x16x32_bf16 v[156:159], v[116:119], v[68:71], v[156:159]
    v_mfma_f32_16x16x32_bf16 v[160:163], v[112:115], v[44:47], v[160:163]
    v_mfma_f32_16x16x32_bf16 v[160:163], v[116:119], v[72:75], v[160:163]
    global_load_lds_dwordx4 v88, s[64:65]
    v_mfma_f32_16x16x32_bf16 v[164:167], v[112:115], v[48:51], v[164:167]
    s_add_u32 m0, m0, s53
    v_mfma_f32_16x16x32_bf16 v[164:167], v[116:119], v[76:79], v[164:167]
    v_mfma_f32_16x16x32_bf16 v[168:171], v[112:115], v[52:55], v[168:171]
    v_mfma_f32_16x16x32_bf16 v[168:171], v[116:119], v[80:83], v[168:171]
    ds_read_b64_tr_b16 v[112:113], v11 offset:8448
    v_mfma_f32_16x16x32_bf16 v[172:175], v[120:123], v[28:31], v[172:175]
    ds_read_b64_tr_b16 v[114:115], v11 offset:8576
    v_mfma_f32_16x16x32_bf16 v[172:175], v[124:127], v[56:59], v[172:175]
    global_load_lds_dwordx4 v89, s[64:65]
    v_mfma_f32_16x16x32_bf16 v[176:179], v[120:123], v[32:35], v[176:179]
    s_add_u32 m0, m0, s53
    ds_read_b64_tr_b16 v[116:117], v11 offset:8960
    v_mfma_f32_16x16x32_bf16 v[176:179], v[124:127], v[60:63], v[176:179]
    ds_read_b64_tr_b16 v[118:119], v11 offset:9088
    v_mfma_f32_16x16x32_bf16 v[180:183], v[120:123], v[36:39], v[180:183]
    v_mfma_f32_16x16x32_bf16 v[180:183], v[124:127], v[64:67], v[180:183]
    v_mfma_f32_16x16x32_bf16 v[184:187], v[120:123], v[40:43], v[184:187]
    v_mfma_f32_16x16x32_bf16 v[184:187], v[124:127], v[68:71], v[184:187]
    global_load_lds_dwordx4 v90, s[64:65]
    v_mfma_f32_16x16x32_bf16 v[188:191], v[120:123], v[44:47], v[188:191]
    s_add_u32 m0, m0, s53
    v_mfma_f32_16x16x32_bf16 v[188:191], v[124:127], v[72:75], v[188:191]
    v_mfma_f32_16x16x32_bf16 v[192:195], v[120:123], v[48:51], v[192:195]
    v_mfma_f32_16x16x32_bf16 v[192:195], v[124:127], v[76:79], v[192:195]
    v_mfma_f32_16x16x32_bf16 v[196:199], v[120:123], v[52:55], v[196:199]
    v_mfma_f32_16x16x32_bf16 v[196:199], v[124:127], v[80:83], v[196:199]
    global_load_lds_dwordx4 v91, s[64:65]
    v_mfma_f32_16x16x32_bf16 v[200:203], v[128:131], v[28:31], v[200:203]
    s_add_u32 m0, m0, s53
    ds_read_b64_tr_b16 v[120:121], v11 offset:8480
    v_mfma_f32_16x16x32_bf16 v[200:203], v[132:135], v[56:59], v[200:203]
    ds_read_b64_tr_b16 v[122:123], v11 offset:8608
    v_mfma_f32_16x16x32_bf16 v[204:207], v[128:131], v[32:35], v[204:207]
    ds_read_b64_tr_b16 v[124:125], v11 offset:8992
    v_mfma_f32_16x16x32_bf16 v[204:207], v[132:135], v[60:63], v[204:207]
    ds_read_b64_tr_b16 v[126:127], v11 offset:9120
    v_mfma_f32_16x16x32_bf16 v[208:211], v[128:131], v[36:39], v[208:211]
    v_mfma_f32_16x16x32_bf16 v[208:211], v[132:135], v[64:67], v[208:211]
    global_load_lds_dwordx4 v92, s[64:65]
    v_mfma_f32_16x16x32_bf16 v[212:215], v[128:131], v[40:43], v[212:215]
    s_add_u32 m0, m0, s53
    v_mfma_f32_16x16x32_bf16 v[212:215], v[132:135], v[68:71], v[212:215]
    v_mfma_f32_16x16x32_bf16 v[216:219], v[128:131], v[44:47], v[216:219]
    v_mfma_f32_16x16x32_bf16 v[216:219], v[132:135], v[72:75], v[216:219]
    v_mfma_f32_16x16x32_bf16 v[220:223], v[128:131], v[48:51], v[220:223]
    v_mfma_f32_16x16x32_bf16 v[220:223], v[132:135], v[76:79], v[220:223]
    global_load_lds_dwordx4 v93, s[64:65]
    v_mfma_f32_16x16x32_bf16 v[224:227], v[128:131], v[52:55], v[224:227]
    s_add_u32 m0, m0, s53
    v_mfma_f32_16x16x32_bf16 v[224:227], v[132:135], v[80:83], v[224:227]
    ds_read_b64_tr_b16 v[128:129], v11 offset:8512
    v_mfma_f32_16x16x32_bf16 v[228:231], v[136:139], v[28:31], v[228:231]
    ds_read_b64_tr_b16 v[130:131], v11 offset:8640
    v_mfma_f32_16x16x32_bf16 v[228:231], v[140:143], v[56:59], v[228:231]
    ds_read_b64_tr_b16 v[132:133], v11 offset:9024
    v_mfma_f32_16x16x32_bf16 v[232:235], v[136:139], v[32:35], v[232:235]
    ds_read_b64_tr_b16 v[134:135], v11 offset:9152
    v_mfma_f32_16x16x32_bf16 v[232:235], v[140:143], v[60:63], v[232:235]
    global_load_lds_dwordx4 v94, s[64:65]
    v_mfma_f32_16x16x32_bf16 v[236:239], v[136:139], v[36:39], v[236:239]
    s_add_u32 m0, m0, s53
    v_mfma_f32_16x16x32_bf16 v[236:239], v[140:143], v[64:67], v[236:239]
    v_mfma_f32_16x16x32_bf16 v[240:243], v[136:139], v[40:43], v[240:243]
    v_mfma_f32_16x16x32_bf16 v[240:243], v[140:143], v[68:71], v[240:243]
    v_mfma_f32_16x16x32_bf16 v[244:247], v[136:139], v[44:47], v[244:247]
    v_mfma_f32_16x16x32_bf16 v[244:247], v[140:143], v[72:75], v[244:247]
    global_load_lds_dwordx4 v95, s[64:65]
    v_mfma_f32_16x16x32_bf16 v[248:251], v[136:139], v[48:51], v[248:251]
    s_waitcnt lgkmcnt(4)
    v_mfma_f32_16x16x32_bf16 v[248:251], v[140:143], v[76:79], v[248:251]
    v_mfma_f32_16x16x32_bf16 v[252:255], v[136:139], v[52:55], v[252:255]
    ds_read_b64_tr_b16 v[136:137], v11 offset:8544
    ds_read_b64_tr_b16 v[138:139], v11 offset:8672
    v_mfma_f32_16x16x32_bf16 v[252:255], v[140:143], v[80:83], v[252:255]
    ds_read_b64_tr_b16 v[140:141], v11 offset:9056
    ds_read_b64_tr_b16 v[142:143], v11 offset:9184
    v_mfma_f32_16x16x32_bf16 a[112:115], v[112:115], v[28:31], a[112:115]
    s_add_u32 m0, s33, 8448
    v_mfma_f32_16x16x32_bf16 a[112:115], v[116:119], v[56:59], a[112:115]
    s_add_u32 s49, s50, s46
    v_mfma_f32_16x16x32_bf16 a[116:119], v[112:115], v[32:35], a[116:119]
    s_lshl1_add_u32 s50, s51, s50
    v_add_u32 v104, s49, v26
    v_mfma_f32_16x16x32_bf16 a[116:119], v[116:119], v[60:63], a[116:119]
    s_add_u32 s82, s82, 2
    v_mfma_f32_16x16x32_bf16 a[120:123], v[112:115], v[36:39], a[120:123]
    s_cmp_eq_u32 s82, 20
    v_mfma_f32_16x16x32_bf16 a[120:123], v[116:119], v[64:67], a[120:123]
    s_cselect_b32 s29, s83, 0
    v_mfma_f32_16x16x32_bf16 a[124:127], v[112:115], v[40:43], a[124:127]
    s_sub_u32 s50, s50, s29
    s_waitcnt vmcnt(8) lgkmcnt(0)
    s_barrier
    ds_read_b128 a[0:3], v27 offset:16896
    v_mfma_f32_16x16x32_bf16 a[124:127], v[116:119], v[68:71], a[124:127]
    s_add_u32 s64, s16, s49
    ds_read_b128 a[4:7], v27 offset:18944
    v_mfma_f32_16x16x32_bf16 a[128:131], v[112:115], v[44:47], a[128:131]
    s_addc_u32 s65, s17, 0
    ds_read_b128 a[8:11], v27 offset:20992
    v_mfma_f32_16x16x32_bf16 a[128:131], v[116:119], v[72:75], a[128:131]
    global_load_lds_dwordx4 v88, s[64:65]
    v_mfma_f32_16x16x32_bf16 a[132:135], v[112:115], v[48:51], a[132:135]
    s_add_u32 m0, m0, s53
    ds_read_b128 a[12:15], v27 offset:23040
    v_mfma_f32_16x16x32_bf16 a[132:135], v[116:119], v[76:79], a[132:135]
    ds_read_b128 a[16:19], v27 offset:25344
    v_mfma_f32_16x16x32_bf16 a[136:139], v[112:115], v[52:55], a[136:139]
    ds_read_b128 a[20:23], v27 offset:27392
    v_mfma_f32_16x16x32_bf16 a[136:139], v[116:119], v[80:83], a[136:139]
    ds_read_b128 a[24:27], v27 offset:29440
    v_mfma_f32_16x16x32_bf16 a[140:143], v[120:123], v[28:31], a[140:143]
    ds_read_b128 a[28:31], v6 offset:16896
    v_mfma_f32_16x16x32_bf16 a[140:143], v[124:127], v[56:59], a[140:143]
    global_load_lds_dwordx4 v89, s[64:65]
    v_mfma_f32_16x16x32_bf16 a[144:147], v[120:123], v[32:35], a[144:147]
    s_add_u32 m0, m0, s53
    ds_read_b128 a[32:35], v6 offset:18944
    v_mfma_f32_16x16x32_bf16 a[144:147], v[124:127], v[60:63], a[144:147]
    ds_read_b128 a[36:39], v6 offset:20992
    v_mfma_f32_16x16x32_bf16 a[148:151], v[120:123], v[36:39], a[148:151]
    ds_read_b128 a[40:43], v6 offset:23040
    v_mfma_f32_16x16x32_bf16 a[148:151], v[124:127], v[64:67], a[148:151]
    ds_read_b128 a[44:47], v6 offset:25344
    v_mfma_f32_16x16x32_bf16 a[152:155], v[120:123], v[40:43], a[152:155]
    ds_read_b128 a[48:51], v6 offset:27392
    v_mfma_f32_16x16x32_bf16 a[152:155], v[124:127], v[68:71], a[152:155]
    global_load_lds_dwordx4 v90, s[64:65]
    v_mfma_f32_16x16x32_bf16 a[156:159], v[120:123], v[44:47], a[156:159]
    s_add_u32 m0, m0, s53
    ds_read_b128 a[52:55], v6 offset:29440
    v_mfma_f32_16x16x32_bf16 a[156:159], v[124:127], v[72:75], a[156:159]
    ds_read_b64_tr_b16 v[112:113], v11 offset:16896
    v_mfma_f32_16x16x32_bf16 a[160:163], v[120:123], v[48:51], a[160:163]
    ds_read_b64_tr_b16 v[114:115], v11 offset:17024
    v_mfma_f32_16x16x32_bf16 a[160:163], v[124:127], v[76:79], a[160:163]
    ds_read_b64_tr_b16 v[116:117], v11 offset:17408
    v_mfma_f32_16x16x32_bf16 a[164:167], v[120:123], v[52:55], a[164:167]
    ds_read_b64_tr_b16 v[118:119], v11 offset:17536
    v_mfma_f32_16x16x32_bf16 a[164:167], v[124:127], v[80:83], a[164:167]
    global_load_lds_dwordx4 v91, s[64:65]
    v_mfma_f32_16x16x32_bf16 a[168:171], v[128:131], v[28:31], a[168:171]
    s_add_u32 m0, m0, s53
    ds_read_b64_tr_b16 v[120:121], v11 offset:16928
    v_mfma_f32_16x16x32_bf16 a[168:171], v[132:135], v[56:59], a[168:171]
    ds_read_b64_tr_b16 v[122:123], v11 offset:17056
    v_mfma_f32_16x16x32_bf16 a[172:175], v[128:131], v[32:35], a[172:175]
    ds_read_b64_tr_b16 v[124:125], v11 offset:17440
    v_mfma_f32_16x16x32_bf16 a[172:175], v[132:135], v[60:63], a[172:175]
    ds_read_b64_tr_b16 v[126:127], v11 offset:17568
    v_mfma_f32_16x16x32_bf16 a[176:179], v[128:131], v[36:39], a[176:179]
    v_mfma_f32_16x16x32_bf16 a[176:179], v[132:135], v[64:67], a[176:179]
    global_load_lds_dwordx4 v92, s[64:65]
    v_mfma_f32_16x16x32_bf16 a[180:183], v[128:131], v[40:43], a[180:183]
    s_add_u32 m0, m0, s53
    v_mfma_f32_16x16x32_bf16 a[180:183], v[132:135], v[68:71], a[180:183]
    v_mfma_f32_16x16x32_bf16 a[184:187], v[128:131], v[44:47], a[184:187]
    v_mfma_f32_16x16x32_bf16 a[184:187], v[132:135], v[72:75], a[184:187]
    v_mfma_f32_16x16x32_bf16 a[188:191], v[128:131], v[48:51], a[188:191]
    v_mfma_f32_16x16x32_bf16 a[188:191], v[132:135], v[76:79], a[188:191]
    global_load_lds_dwordx4 v93, s[64:65]
    v_mfma_f32_16x16x32_bf16 a[192:195], v[128:131], v[52:55], a[192:195]
    s_add_u32 m0, m0, s53
    v_mfma_f32_16x16x32_bf16 a[192:195], v[132:135], v[80:83], a[192:195]
    ds_read_b64_tr_b16 v[128:129], v11 offset:16960
    v_mfma_f32_16x16x32_bf16 a[196:199], v[136:139], v[28:31], a[196:199]
    ds_read_b64_tr_b16 v[130:131], v11 offset:17088
    v_mfma_f32_16x16x32_bf16 a[196:199], v[140:143], v[56:59], a[196:199]
    ds_read_b64_tr_b16 v[132:133], v11 offset:17472
    v_mfma_f32_16x16x32_bf16 a[200:203], v[136:139], v[32:35], a[200:203]
    ds_read_b64_tr_b16 v[134:135], v11 offset:17600
    v_mfma_f32_16x16x32_bf16 a[200:203], v[140:143], v[60:63], a[200:203]
    buffer_load_dwordx4 v104, s[16:19], s47 offen lds
    v_mfma_f32_16x16x32_bf16 a[204:207], v[136:139], v[36:39], a[204:207]
    s_add_u32 m0, m0, s53
    v_mfma_f32_16x16x32_bf16 a[204:207], v[140:143], v[64:67], a[204:207]
    v_mfma_f32_16x16x32_bf16 a[208:211], v[136:139], v[40:43], a[208:211]
    v_mfma_f32_16x16x32_bf16 a[208:211], v[140:143], v[68:71], a[208:211]
    v_mfma_f32_16x16x32_bf16 a[212:215], v[136:139], v[44:47], a[212:215]
    v_mfma_f32_16x16x32_bf16 a[212:215], v[140:143], v[72:75], a[212:215]
    buffer_load_dwordx4 v104, s[16:19], s98 offen lds
    v_mfma_f32_16x16x32_bf16 a[216:219], v[136:139], v[48:51], a[216:219]
    s_waitcnt lgkmcnt(4)
    v_mfma_f32_16x16x32_bf16 a[216:219], v[140:143], v[76:79], a[216:219]
    v_mfma_f32_16x16x32_bf16 a[220:223], v[136:139], v[52:55], a[220:223]
    ds_read_b64_tr_b16 v[136:137], v11 offset:16992
    ds_read_b64_tr_b16 v[138:139], v11 offset:17120
    v_mfma_f32_16x16x32_bf16 a[220:223], v[140:143], v[80:83], a[220:223]
    ds_read_b64_tr_b16 v[140:141], v11 offset:17504
    ds_read_b64_tr_b16 v[142:143], v11 offset:17632
    v_mfma_f32_16x16x32_bf16 v[144:147], v[112:115], a[0:3], v[144:147]
    s_add_u32 m0, s33, 16896
    v_mfma_f32_16x16x32_bf16 v[144:147], v[116:119], a[28:31], v[144:147]
    s_mov_b32 s49, s50
    v_mfma_f32_16x16x32_bf16 v[148:151], v[112:115], a[4:7], v[148:151]
    s_add_u32 s64, s16, s49
    v_mfma_f32_16x16x32_bf16 v[148:151], v[116:119], a[32:35], v[148:151]
    s_addc_u32 s65, s17, 0
    v_mfma_f32_16x16x32_bf16 v[152:155], v[112:115], a[8:11], v[152:155]
    v_mfma_f32_16x16x32_bf16 v[152:155], v[116:119], a[36:39], v[152:155]
    v_mfma_f32_16x16x32_bf16 v[156:159], v[112:115], a[12:15], v[156:159]
    s_waitcnt vmcnt(16) lgkmcnt(0)
    s_barrier
    v_mfma_f32_16x16x32_bf16 v[156:159], v[116:119], a[40:43], v[156:159]
    v_mfma_f32_16x16x32_bf16 v[160:163], v[112:115], a[16:19], v[160:163]
    v_mfma_f32_16x16x32_bf16 v[160:163], v[116:119], a[44:47], v[160:163]
    global_load_lds_dwordx4 v88, s[64:65]
    v_mfma_f32_16x16x32_bf16 v[164:167], v[112:115], a[20:23], v[164:167]
    s_add_u32 m0, m0, s53
    v_mfma_f32_16x16x32_bf16 v[164:167], v[116:119], a[48:51], v[164:167]
    v_mfma_f32_16x16x32_bf16 v[168:171], v[112:115], a[24:27], v[168:171]
    v_mfma_f32_16x16x32_bf16 v[168:171], v[116:119], a[52:55], v[168:171]
    ds_read_b64_tr_b16 v[112:113], v11 offset:25344
    v_mfma_f32_16x16x32_bf16 v[172:175], v[120:123], a[0:3], v[172:175]
    ds_read_b64_tr_b16 v[114:115], v11 offset:25472
    v_mfma_f32_16x16x32_bf16 v[172:175], v[124:127], a[28:31], v[172:175]
    global_load_lds_dwordx4 v89, s[64:65]
    v_mfma_f32_16x16x32_bf16 v[176:179], v[120:123], a[4:7], v[176:179]
    s_add_u32 m0, m0, s53
    ds_read_b64_tr_b16 v[116:117], v11 offset:25856
    v_mfma_f32_16x16x32_bf16 v[176:179], v[124:127], a[32:35], v[176:179]
    ds_read_b64_tr_b16 v[118:119], v11 offset:25984
    v_mfma_f32_16x16x32_bf16 v[180:183], v[120:123], a[8:11], v[180:183]
    v_mfma_f32_16x16x32_bf16 v[180:183], v[124:127], a[36:39], v[180:183]
    v_mfma_f32_16x16x32_bf16 v[184:187], v[120:123], a[12:15], v[184:187]
    v_mfma_f32_16x16x32_bf16 v[184:187], v[124:127], a[40:43], v[184:187]
    global_load_lds_dwordx4 v90, s[64:65]
    v_mfma_f32_16x16x32_bf16 v[188:191], v[120:123], a[16:19], v[188:191]
    s_add_u32 m0, m0, s53
    v_mfma_f32_16x16x32_bf16 v[188:191], v[124:127], a[44:47], v[188:191]
    v_mfma_f32_16x16x32_bf16 v[192:195], v[120:123], a[20:23], v[192:195]
    v_mfma_f32_16x16x32_bf16 v[192:195], v[124:127], a[48:51], v[192:195]
    v_mfma_f32_16x16x32_bf16 v[196:199], v[120:123], a[24:27], v[196:199]
    v_mfma_f32_16x16x32_bf16 v[196:199], v[124:127], a[52:55], v[196:199]
    global_load_lds_dwordx4 v91, s[64:65]
    v_mfma_f32_16x16x32_bf16 v[200:203], v[128:131], a[0:3], v[200:203]
    s_add_u32 m0, m0, s53
    ds_read_b64_tr_b16 v[120:121], v11 offset:25376
    v_mfma_f32_16x16x32_bf16 v[200:203], v[132:135], a[28:31], v[200:203]
    ds_read_b64_tr_b16 v[122:123], v11 offset:25504
    v_mfma_f32_16x16x32_bf16 v[204:207], v[128:131], a[4:7], v[204:207]
    ds_read_b64_tr_b16 v[124:125], v11 offset:25888
    v_mfma_f32_16x16x32_bf16 v[204:207], v[132:135], a[32:35], v[204:207]
    ds_read_b64_tr_b16 v[126:127], v11 offset:26016
    v_mfma_f32_16x16x32_bf16 v[208:211], v[128:131], a[8:11], v[208:211]
    v_mfma_f32_16x16x32_bf16 v[208:211], v[132:135], a[36:39], v[208:211]
    global_load_lds_dwordx4 v92, s[64:65]
    v_mfma_f32_16x16x32_bf16 v[212:215], v[128:131], a[12:15], v[212:215]
    s_add_u32 m0, m0, s53
    v_mfma_f32_16x16x32_bf16 v[212:215], v[132:135], a[40:43], v[212:215]
    v_mfma_f32_16x16x32_bf16 v[216:219], v[128:131], a[16:19], v[216:219]
    v_mfma_f32_16x16x32_bf16 v[216:219], v[132:135], a[44:47], v[216:219]
    v_mfma_f32_16x16x32_bf16 v[220:223], v[128:131], a[20:23], v[220:223]
    v_mfma_f32_16x16x32_bf16 v[220:223], v[132:135], a[48:51], v[220:223]
    global_load_lds_dwordx4 v93, s[64:65]
    v_mfma_f32_16x16x32_bf16 v[224:227], v[128:131], a[24:27], v[224:227]
    s_add_u32 m0, m0, s53
    v_mfma_f32_16x16x32_bf16 v[224:227], v[132:135], a[52:55], v[224:227]
    ds_read_b64_tr_b16 v[128:129], v11 offset:25408
    v_mfma_f32_16x16x32_bf16 v[228:231], v[136:139], a[0:3], v[228:231]
    ds_read_b64_tr_b16 v[130:131], v11 offset:25536
    v_mfma_f32_16x16x32_bf16 v[228:231], v[140:143], a[28:31], v[228:231]
    ds_read_b64_tr_b16 v[132:133], v11 offset:25920
    v_mfma_f32_16x16x32_bf16 v[232:235], v[136:139], a[4:7], v[232:235]
    ds_read_b64_tr_b16 v[134:135], v11 offset:26048
    v_mfma_f32_16x16x32_bf16 v[232:235], v[140:143], a[32:35], v[232:235]
    global_load_lds_dwordx4 v94, s[64:65]
    v_mfma_f32_16x16x32_bf16 v[236:239], v[136:139], a[8:11], v[236:239]
    s_add_u32 m0, m0, s53
    v_mfma_f32_16x16x32_bf16 v[236:239], v[140:143], a[36:39], v[236:239]
    v_mfma_f32_16x16x32_bf16 v[240:243], v[136:139], a[12:15], v[240:243]
    v_mfma_f32_16x16x32_bf16 v[240:243], v[140:143], a[40:43], v[240:243]
    v_mfma_f32_16x16x32_bf16 v[244:247], v[136:139], a[16:19], v[244:247]
    v_mfma_f32_16x16x32_bf16 v[244:247], v[140:143], a[44:47], v[244:247]
    global_load_lds_dwordx4 v95, s[64:65]
    v_mfma_f32_16x16x32_bf16 v[248:251], v[136:139], a[20:23], v[248:251]
    s_waitcnt lgkmcnt(4)
    v_mfma_f32_16x16x32_bf16 v[248:251], v[140:143], a[48:51], v[248:251]
    v_mfma_f32_16x16x32_bf16 v[252:255], v[136:139], a[24:27], v[252:255]
    ds_read_b64_tr_b16 v[136:137], v11 offset:25440
    ds_read_b64_tr_b16 v[138:139], v11 offset:25568
    v_mfma_f32_16x16x32_bf16 v[252:255], v[140:143], a[52:55], v[252:255]
    ds_read_b64_tr_b16 v[140:141], v11 offset:25952
    ds_read_b64_tr_b16 v[142:143], v11 offset:26080
    v_mfma_f32_16x16x32_bf16 a[112:115], v[112:115], a[0:3], a[112:115]
    s_add_u32 m0, s33, 25344
    v_mfma_f32_16x16x32_bf16 a[112:115], v[116:119], a[28:31], a[112:115]
    s_add_u32 s49, s50, s46
    v_mfma_f32_16x16x32_bf16 a[116:119], v[112:115], a[4:7], a[116:119]
    s_lshl1_add_u32 s50, s51, s50
    v_add_u32 v104, s49, v26
    v_mfma_f32_16x16x32_bf16 a[116:119], v[116:119], a[32:35], a[116:119]
    s_add_u32 s82, s82, 2
    v_mfma_f32_16x16x32_bf16 a[120:123], v[112:115], a[8:11], a[120:123]
    s_cmp_eq_u32 s82, 20
    v_mfma_f32_16x16x32_bf16 a[120:123], v[116:119], a[36:39], a[120:123]
    s_cselect_b32 s29, s83, 0
    v_mfma_f32_16x16x32_bf16 a[124:127], v[112:115], a[12:15], a[124:127]
    s_sub_u32 s50, s50, s29
    s_waitcnt vmcnt(8) lgkmcnt(0)
    s_barrier
    v_mfma_f32_16x16x32_bf16 a[124:127], v[116:119], a[40:43], a[124:127]
    s_add_u32 s64, s16, s49
    v_mfma_f32_16x16x32_bf16 a[128:131], v[112:115], a[16:19], a[128:131]
    s_addc_u32 s65, s17, 0
    v_mfma_f32_16x16x32_bf16 a[128:131], v[116:119], a[44:47], a[128:131]
    global_load_lds_dwordx4 v88, s[64:65]
    v_mfma_f32_16x16x32_bf16 a[132:135], v[112:115], a[20:23], a[132:135]
    s_add_u32 m0, m0, s53
    v_mfma_f32_16x16x32_bf16 a[132:135], v[116:119], a[48:51], a[132:135]
    v_mfma_f32_16x16x32_bf16 a[136:139], v[112:115], a[24:27], a[136:139]
    v_mfma_f32_16x16x32_bf16 a[136:139], v[116:119], a[52:55], a[136:139]
    v_mfma_f32_16x16x32_bf16 a[140:143], v[120:123], a[0:3], a[140:143]
    v_mfma_f32_16x16x32_bf16 a[140:143], v[124:127], a[28:31], a[140:143]
    global_load_lds_dwordx4 v89, s[64:65]
    v_mfma_f32_16x16x32_bf16 a[144:147], v[120:123], a[4:7], a[144:147]
    s_add_u32 m0, m0, s53
    v_mfma_f32_16x16x32_bf16 a[144:147], v[124:127], a[32:35], a[144:147]
    v_mfma_f32_16x16x32_bf16 a[148:151], v[120:123], a[8:11], a[148:151]
    v_mfma_f32_16x16x32_bf16 a[148:151], v[124:127], a[36:39], a[148:151]
    v_mfma_f32_16x16x32_bf16 a[152:155], v[120:123], a[12:15], a[152:155]
    v_mfma_f32_16x16x32_bf16 a[152:155], v[124:127], a[40:43], a[152:155]
    global_load_lds_dwordx4 v90, s[64:65]
    v_mfma_f32_16x16x32_bf16 a[156:159], v[120:123], a[16:19], a[156:159]
    s_add_u32 m0, m0, s53
    v_mfma_f32_16x16x32_bf16 a[156:159], v[124:127], a[44:47], a[156:159]
    v_mfma_f32_16x16x32_bf16 a[160:163], v[120:123], a[20:23], a[160:163]
    v_mfma_f32_16x16x32_bf16 a[160:163], v[124:127], a[48:51], a[160:163]
    v_mfma_f32_16x16x32_bf16 a[164:167], v[120:123], a[24:27], a[164:167]
    v_mfma_f32_16x16x32_bf16 a[164:167], v[124:127], a[52:55], a[164:167]
    global_load_lds_dwordx4 v91, s[64:65]
    v_mfma_f32_16x16x32_bf16 a[168:171], v[128:131], a[0:3], a[168:171]
    s_add_u32 m0, m0, s53
    v_mfma_f32_16x16x32_bf16 a[168:171], v[132:135], a[28:31], a[168:171]
    v_mfma_f32_16x16x32_bf16 a[172:175], v[128:131], a[4:7], a[172:175]
    v_mfma_f32_16x16x32_bf16 a[172:175], v[132:135], a[32:35], a[172:175]
    v_mfma_f32_16x16x32_bf16 a[176:179], v[128:131], a[8:11], a[176:179]
    v_mfma_f32_16x16x32_bf16 a[176:179], v[132:135], a[36:39], a[176:179]
    global_load_lds_dwordx4 v92, s[64:65]
    v_mfma_f32_16x16x32_bf16 a[180:183], v[128:131], a[12:15], a[180:183]
    s_add_u32 m0, m0, s53
    v_mfma_f32_16x16x32_bf16 a[180:183], v[132:135], a[40:43], a[180:183]
    v_mfma_f32_16x16x32_bf16 a[184:187], v[128:131], a[16:19], a[184:187]
    v_mfma_f32_16x16x32_bf16 a[184:187], v[132:135], a[44:47], a[184:187]
    v_mfma_f32_16x16x32_bf16 a[188:191], v[128:131], a[20:23], a[188:191]
    v_mfma_f32_16x16x32_bf16 a[188:191], v[132:135], a[48:51], a[188:191]
    global_load_lds_dwordx4 v93, s[64:65]
    v_mfma_f32_16x16x32_bf16 a[192:195], v[128:131], a[24:27], a[192:195]
    s_add_u32 m0, m0, s53
    v_mfma_f32_16x16x32_bf16 a[192:195], v[132:135], a[52:55], a[192:195]
    v_mfma_f32_16x16x32_bf16 a[196:199], v[136:139], a[0:3], a[196:199]
    v_mfma_f32_16x16x32_bf16 a[196:199], v[140:143], a[28:31], a[196:199]
    v_mfma_f32_16x16x32_bf16 a[200:203], v[136:139], a[4:7], a[200:203]
    v_mfma_f32_16x16x32_bf16 a[200:203], v[140:143], a[32:35], a[200:203]
    buffer_load_dwordx4 v104, s[16:19], s47 offen lds
    v_mfma_f32_16x16x32_bf16 a[204:207], v[136:139], a[8:11], a[204:207]
    s_add_u32 m0, m0, s53
    v_mfma_f32_16x16x32_bf16 a[204:207], v[140:143], a[36:39], a[204:207]
    v_mfma_f32_16x16x32_bf16 a[208:211], v[136:139], a[12:15], a[208:211]
    v_mfma_f32_16x16x32_bf16 a[208:211], v[140:143], a[40:43], a[208:211]
    v_mfma_f32_16x16x32_bf16 a[212:215], v[136:139], a[16:19], a[212:215]
    v_mfma_f32_16x16x32_bf16 a[212:215], v[140:143], a[44:47], a[212:215]
    buffer_load_dwordx4 v104, s[16:19], s98 offen lds
    v_mfma_f32_16x16x32_bf16 a[216:219], v[136:139], a[20:23], a[216:219]
    v_mfma_f32_16x16x32_bf16 a[216:219], v[140:143], a[48:51], a[216:219]
    v_mfma_f32_16x16x32_bf16 a[220:223], v[136:139], a[24:27], a[220:223]
    v_mfma_f32_16x16x32_bf16 a[220:223], v[140:143], a[52:55], a[220:223]
L_at_qpepi:
    v_mov_b32 v4, s54
    v_mov_b32 v5, s54
    s_nop 6
    v_pk_mul_f32 v[144:145], v[144:145], v[4:5]
    v_pk_mul_f32 v[146:147], v[146:147], v[4:5]
    v_pk_mul_f32 v[148:149], v[148:149], v[4:5]
    v_pk_mul_f32 v[150:151], v[150:151], v[4:5]
    v_pk_mul_f32 v[152:153], v[152:153], v[4:5]
    v_pk_mul_f32 v[154:155], v[154:155], v[4:5]
    v_pk_mul_f32 v[156:157], v[156:157], v[4:5]
    v_pk_mul_f32 v[158:159], v[158:159], v[4:5]
    v_pk_mul_f32 v[160:161], v[160:161], v[4:5]
    v_pk_mul_f32 v[162:163], v[162:163], v[4:5]
    v_pk_mul_f32 v[164:165], v[164:165], v[4:5]
    v_pk_mul_f32 v[166:167], v[166:167], v[4:5]
    v_pk_mul_f32 v[168:169], v[168:169], v[4:5]
    v_pk_mul_f32 v[170:171], v[170:171], v[4:5]
    v_pk_mul_f32 v[172:173], v[172:173], v[4:5]
    v_pk_mul_f32 v[174:175], v[174:175], v[4:5]
    v_pk_mul_f32 v[176:177], v[176:177], v[4:5]
    v_pk_mul_f32 v[178:179], v[178:179], v[4:5]
    v_pk_mul_f32 v[180:181], v[180:181], v[4:5]
    v_pk_mul_f32 v[182:183], v[182:183], v[4:5]
    v_pk_mul_f32 v[184:185], v[184:185], v[4:5]
    v_pk_mul_f32 v[186:187], v[186:187], v[4:5]
    v_pk_mul_f32 v[188:189], v[188:189], v[4:5]
    v_pk_mul_f32 v[190:191], v[190:191], v[4:5]
    v_pk_mul_f32 v[192:193], v[192:193], v[4:5]
    v_pk_mul_f32 v[194:195], v[194:195], v[4:5]
    v_pk_mul_f32 v[196:197], v[196:197], v[4:5]
    v_pk_mul_f32 v[198:199], v[198:199], v[4:5]
    v_cvt_pk_bf16_f32 v88, v144, v145
    v_cvt_pk_bf16_f32 v89, v146, v147
    v_cvt_pk_bf16_f32 v90, v172, v173
    v_cvt_pk_bf16_f32 v91, v174, v175
    v_cvt_pk_bf16_f32 v92, v148, v149
    v_cvt_pk_bf16_f32 v93, v150, v151
    v_cvt_pk_bf16_f32 v94, v176, v177
    v_cvt_pk_bf16_f32 v95, v178, v179
    v_cvt_pk_bf16_f32 v96, v152, v153
    v_cvt_pk_bf16_f32 v97, v154, v155
    v_cvt_pk_bf16_f32 v98, v180, v181
    v_cvt_pk_bf16_f32 v99, v182, v183
    v_cvt_pk_bf16_f32 v100, v156, v157
    v_cvt_pk_bf16_f32 v101, v158, v159
    v_cvt_pk_bf16_f32 v102, v184, v185
    v_cvt_pk_bf16_f32 v103, v186, v187
    v_cvt_pk_bf16_f32 v104, v160, v161
    v_cvt_pk_bf16_f32 v105, v162, v163
    v_cvt_pk_bf16_f32 v106, v188, v189
    v_cvt_pk_bf16_f32 v107, v190, v191
    v_cvt_pk_bf16_f32 v108, v164, v165
    v_cvt_pk_bf16_f32 v109, v166, v167
    v_cvt_pk_bf16_f32 v110, v192, v193
    v_cvt_pk_bf16_f32 v111, v194, v195
    v_cvt_pk_bf16_f32 v112, v168, v169
    v_cvt_pk_bf16_f32 v113, v170, v171
    v_cvt_pk_bf16_f32 v114, v196, v197
    v_cvt_pk_bf16_f32 v115, v198, v199
    s_nop 1
    v_permlane16_swap_b32 v88, v90
    v_permlane16_swap_b32 v89, v91
    v_permlane16_swap_b32 v92, v94
    v_permlane16_swap_b32 v93, v95
    v_permlane16_swap_b32 v96, v98
    v_permlane16_swap_b32 v97, v99
    v_permlane16_swap_b32 v100, v102
    v_permlane16_swap_b32 v101, v103
    v_permlane16_swap_b32 v104, v106
    v_permlane16_swap_b32 v105, v107
    v_permlane16_swap_b32 v108, v110
    v_permlane16_swap_b32 v109, v111
    v_permlane16_swap_b32 v112, v114
    v_permlane16_swap_b32 v113, v115
    v_accvgpr_write_b32 a0, v88
    v_accvgpr_write_b32 a1, v89
    v_accvgpr_write_b32 a2, v90
    v_accvgpr_write_b32 a3, v91
    v_accvgpr_write_b32 a16, v92
    v_accvgpr_write_b32 a17, v93
    v_accvgpr_write_b32 a18, v94
    v_accvgpr_write_b32 a19, v95
    v_accvgpr_write_b32 a32, v96
    v_accvgpr_write_b32 a33, v97
    v_accvgpr_write_b32 a34, v98
    v_accvgpr_write_b32 a35, v99
    v_accvgpr_write_b32 a48, v100
    v_accvgpr_write_b32 a49, v101
    v_accvgpr_write_b32 a50, v102
    v_accvgpr_write_b32 a51, v103
    v_accvgpr_write_b32 a64, v104
    v_accvgpr_write_b32 a65, v105
    v_accvgpr_write_b32 a66, v106
    v_accvgpr_write_b32 a67, v107
    v_accvgpr_write_b32 a80, v108
    v_accvgpr_write_b32 a81, v109
    v_accvgpr_write_b32 a82, v110
    v_accvgpr_write_b32 a83, v111
    v_accvgpr_write_b32 a96, v112
    v_accvgpr_write_b32 a97, v113
    v_accvgpr_write_b32 a98, v114
    v_accvgpr_write_b32 a99, v115
    v_pk_mul_f32 v[200:201], v[200:201], v[4:5]
    v_pk_mul_f32 v[202:203], v[202:203], v[4:5]
    v_pk_mul_f32 v[204:205], v[204:205], v[4:5]
    v_pk_mul_f32 v[206:207], v[206:207], v[4:5]
    v_pk_mul_f32 v[208:209], v[208:209], v[4:5]
    v_pk_mul_f32 v[210:211], v[210:211], v[4:5]
    v_pk_mul_f32 v[212:213], v[212:213], v[4:5]
    v_pk_mul_f32 v[214:215], v[214:215], v[4:5]
    v_pk_mul_f32 v[216:217], v[216:217], v[4:5]
    v_pk_mul_f32 v[218:219], v[218:219], v[4:5]
    v_pk_mul_f32 v[220:221], v[220:221], v[4:5]
    v_pk_mul_f32 v[222:223], v[222:223], v[4:5]
    v_pk_mul_f32 v[224:225], v[224:225], v[4:5]
    v_pk_mul_f32 v[226:227], v[226:227], v[4:5]
    v_pk_mul_f32 v[228:229], v[228:229], v[4:5]
    v_pk_mul_f32 v[230:231], v[230:231], v[4:5]
    v_pk_mul_f32 v[232:233], v[232:233], v[4:5]
    v_pk_mul_f32 v[234:235], v[234:235], v[4:5]
    v_pk_mul_f32 v[236:237], v[236:237], v[4:5]
    v_pk_mul_f32 v[238:239], v[238:239], v[4:5]
    v_pk_mul_f32 v[240:241], v[240:241], v[4:5]
    v_pk_mul_f32 v[242:243], v[242:243], v[4:5]
    v_pk_mul_f32 v[244:245], v[244:245], v[4:5]
    v_pk_mul_f32 v[246:247], v[246:247], v[4:5]
    v_pk_mul_f32 v[248:249], v[248:249], v[4:5]
    v_pk_mul_f32 v[250:251], v[250:251], v[4:5]
    v_pk_mul_f32 v[252:253], v[252:253], v[4:5]
    v_pk_mul_f32 v[254:255], v[254:255], v[4:5]
    v_cvt_pk_bf16_f32 v116, v200, v201
    v_cvt_pk_bf16_f32 v117, v202, v203
    v_cvt_pk_bf16_f32 v118, v228, v229
    v_cvt_pk_bf16_f32 v119, v230, v231
    v_cvt_pk_bf16_f32 v120, v204, v205
    v_cvt_pk_bf16_f32 v121, v206, v207
    v_cvt_pk_bf16_f32 v122, v232, v233
    v_cvt_pk_bf16_f32 v123, v234, v235
    v_cvt_pk_bf16_f32 v124, v208, v209
    v_cvt_pk_bf16_f32 v125, v210, v211
    v_cvt_pk_bf16_f32 v126, v236, v237
    v_cvt_pk_bf16_f32 v127, v238, v239
    v_cvt_pk_bf16_f32 v128, v212, v213
    v_cvt_pk_bf16_f32 v129, v214, v215
    v_cvt_pk_bf16_f32 v130, v240, v241
    v_cvt_pk_bf16_f32 v131, v242, v243
    v_cvt_pk_bf16_f32 v132, v216, v217
    v_cvt_pk_bf16_f32 v133, v218, v219
    v_cvt_pk_bf16_f32 v134, v244, v245
    v_cvt_pk_bf16_f32 v135, v246, v247
    v_cvt_pk_bf16_f32 v136, v220, v221
    v_cvt_pk_bf16_f32 v137, v222, v223
    v_cvt_pk_bf16_f32 v138, v248, v249
    v_cvt_pk_bf16_f32 v139, v250, v251
    v_cvt_pk_bf16_f32 v140, v224, v225
    v_cvt_pk_bf16_f32 v141, v226, v227
    v_cvt_pk_bf16_f32 v142, v252, v253
    v_cvt_pk_bf16_f32 v143, v254, v255
    s_nop 1
    v_permlane16_swap_b32 v116, v118
    v_permlane16_swap_b32 v117, v119
    v_permlane16_swap_b32 v120, v122
    v_permlane16_swap_b32 v121, v123
    v_permlane16_swap_b32 v124, v126
    v_permlane16_swap_b32 v125, v127
    v_permlane16_swap_b32 v128, v130
    v_permlane16_swap_b32 v129, v131
    v_permlane16_swap_b32 v132, v134
    v_permlane16_swap_b32 v133, v135
    v_permlane16_swap_b32 v136, v138
    v_permlane16_swap_b32 v137, v139
    v_permlane16_swap_b32 v140, v142
    v_permlane16_swap_b32 v141, v143
    v_accvgpr_write_b32 a4, v116
    v_accvgpr_write_b32 a5, v117
    v_accvgpr_write_b32 a6, v118
    v_accvgpr_write_b32 a7, v119
    v_accvgpr_write_b32 a20, v120
    v_accvgpr_write_b32 a21, v121
    v_accvgpr_write_b32 a22, v122
    v_accvgpr_write_b32 a23, v123
    v_accvgpr_write_b32 a36, v124
    v_accvgpr_write_b32 a37, v125
    v_accvgpr_write_b32 a38, v126
    v_accvgpr_write_b32 a39, v127
    v_accvgpr_write_b32 a52, v128
    v_accvgpr_write_b32 a53, v129
    v_accvgpr_write_b32 a54, v130
    v_accvgpr_write_b32 a55, v131
    v_accvgpr_write_b32 a68, v132
    v_accvgpr_write_b32 a69, v133
    v_accvgpr_write_b32 a70, v134
    v_accvgpr_write_b32 a71, v135
    v_accvgpr_write_b32 a84, v136
    v_accvgpr_write_b32 a85, v137
    v_accvgpr_write_b32 a86, v138
    v_accvgpr_write_b32 a87, v139
    v_accvgpr_write_b32 a100, v140
    v_accvgpr_write_b32 a101, v141
    v_accvgpr_write_b32 a102, v142
    v_accvgpr_write_b32 a103, v143
    v_accvgpr_read_b32 v144, a112
    v_accvgpr_read_b32 v145, a113
    v_accvgpr_read_b32 v146, a114
    v_accvgpr_read_b32 v147, a115
    v_accvgpr_read_b32 v148, a116
    v_accvgpr_read_b32 v149, a117
    v_accvgpr_read_b32 v150, a118
    v_accvgpr_read_b32 v151, a119
    v_accvgpr_read_b32 v152, a120
    v_accvgpr_read_b32 v153, a121
    v_accvgpr_read_b32 v154, a122
    v_accvgpr_read_b32 v155, a123
    v_accvgpr_read_b32 v156, a124
    v_accvgpr_read_b32 v157, a125
    v_accvgpr_read_b32 v158, a126
    v_accvgpr_read_b32 v159, a127
    v_accvgpr_read_b32 v160, a128
    v_accvgpr_read_b32 v161, a129
    v_accvgpr_read_b32 v162, a130
    v_accvgpr_read_b32 v163, a131
    v_accvgpr_read_b32 v164, a132
    v_accvgpr_read_b32 v165, a133
    v_accvgpr_read_b32 v166, a134
    v_accvgpr_read_b32 v167, a135
    v_accvgpr_read_b32 v168, a136
    v_accvgpr_read_b32 v169, a137
    v_accvgpr_read_b32 v170, a138
    v_accvgpr_read_b32 v171, a139
    v_accvgpr_read_b32 v172, a140
    v_accvgpr_read_b32 v173, a141
    v_accvgpr_read_b32 v174, a142
    v_accvgpr_read_b32 v175, a143
    v_accvgpr_read_b32 v176, a144
    v_accvgpr_read_b32 v177, a145
    v_accvgpr_read_b32 v178, a146
    v_accvgpr_read_b32 v179, a147
    v_accvgpr_read_b32 v180, a148
    v_accvgpr_read_b32 v181, a149
    v_accvgpr_read_b32 v182, a150
    v_accvgpr_read_b32 v183, a151
    v_accvgpr_read_b32 v184, a152
    v_accvgpr_read_b32 v185, a153
    v_accvgpr_read_b32 v186, a154
    v_accvgpr_read_b32 v187, a155
    v_accvgpr_read_b32 v188, a156
    v_accvgpr_read_b32 v189, a157
    v_accvgpr_read_b32 v190, a158
    v_accvgpr_read_b32 v191, a159
    v_accvgpr_read_b32 v192, a160
    v_accvgpr_read_b32 v193, a161
    v_accvgpr_read_b32 v194, a162
    v_accvgpr_read_b32 v195, a163
    v_accvgpr_read_b32 v196, a164
    v_accvgpr_read_b32 v197, a165
    v_accvgpr_read_b32 v198, a166
    v_accvgpr_read_b32 v199, a167
    v_pk_mul_f32 v[144:145], v[144:145], v[4:5]
    v_pk_mul_f32 v[146:147], v[146:147], v[4:5]
    v_pk_mul_f32 v[148:149], v[148:149], v[4:5]
    v_pk_mul_f32 v[150:151], v[150:151], v[4:5]
    v_pk_mul_f32 v[152:153], v[152:153], v[4:5]
    v_pk_mul_f32 v[154:155], v[154:155], v[4:5]
    v_pk_mul_f32 v[156:157], v[156:157], v[4:5]
    v_pk_mul_f32 v[158:159], v[158:159], v[4:5]
    v_pk_mul_f32 v[160:161], v[160:161], v[4:5]
    v_pk_mul_f32 v[162:163], v[162:163], v[4:5]
    v_pk_mul_f32 v[164:165], v[164:165], v[4:5]
    v_pk_mul_f32 v[166:167], v[166:167], v[4:5]
    v_pk_mul_f32 v[168:169], v[168:169], v[4:5]
    v_pk_mul_f32 v[170:171], v[170:171], v[4:5]
    v_pk_mul_f32 v[172:173], v[172:173], v[4:5]
    v_pk_mul_f32 v[174:175], v[174:175], v[4:5]
    v_pk_mul_f32 v[176:177], v[176:177], v[4:5]
    v_pk_mul_f32 v[178:179], v[178:179], v[4:5]
    v_pk_mul_f32 v[180:181], v[180:181], v[4:5]
    v_pk_mul_f32 v[182:183], v[182:183], v[4:5]
    v_pk_mul_f32 v[184:185], v[184:185], v[4:5]
    v_pk_mul_f32 v[186:187], v[186:187], v[4:5]
    v_pk_mul_f32 v[188:189], v[188:189], v[4:5]
    v_pk_mul_f32 v[190:191], v[190:191], v[4:5]
    v_pk_mul_f32 v[192:193], v[192:193], v[4:5]
    v_pk_mul_f32 v[194:195], v[194:195], v[4:5]
    v_pk_mul_f32 v[196:197], v[196:197], v[4:5]
    v_pk_mul_f32 v[198:199], v[198:199], v[4:5]
    v_cvt_pk_bf16_f32 v88, v144, v145
    v_cvt_pk_bf16_f32 v89, v146, v147
    v_cvt_pk_bf16_f32 v90, v172, v173
    v_cvt_pk_bf16_f32 v91, v174, v175
    v_cvt_pk_bf16_f32 v92, v148, v149
    v_cvt_pk_bf16_f32 v93, v150, v151
    v_cvt_pk_bf16_f32 v94, v176, v177
    v_cvt_pk_bf16_f32 v95, v178, v179
    v_cvt_pk_bf16_f32 v96, v152, v153
    v_cvt_pk_bf16_f32 v97, v154, v155
    v_cvt_pk_bf16_f32 v98, v180, v181
    v_cvt_pk_bf16_f32 v99, v182, v183
    v_cvt_pk_bf16_f32 v100, v156, v157
    v_cvt_pk_bf16_f32 v101, v158, v159
    v_cvt_pk_bf16_f32 v102, v184, v185
    v_cvt_pk_bf16_f32 v103, v186, v187
    v_cvt_pk_bf16_f32 v104, v160, v161
    v_cvt_pk_bf16_f32 v105, v162, v163
    v_cvt_pk_bf16_f32 v106, v188, v189
    v_cvt_pk_bf16_f32 v107, v190, v191
    v_cvt_pk_bf16_f32 v108, v164, v165
    v_cvt_pk_bf16_f32 v109, v166, v167
    v_cvt_pk_bf16_f32 v110, v192, v193
    v_cvt_pk_bf16_f32 v111, v194, v195
    v_cvt_pk_bf16_f32 v112, v168, v169
    v_cvt_pk_bf16_f32 v113, v170, v171
    v_cvt_pk_bf16_f32 v114, v196, v197
    v_cvt_pk_bf16_f32 v115, v198, v199
    s_nop 1
    v_permlane16_swap_b32 v88, v90
    v_permlane16_swap_b32 v89, v91
    v_permlane16_swap_b32 v92, v94
    v_permlane16_swap_b32 v93, v95
    v_permlane16_swap_b32 v96, v98
    v_permlane16_swap_b32 v97, v99
    v_permlane16_swap_b32 v100, v102
    v_permlane16_swap_b32 v101, v103
    v_permlane16_swap_b32 v104, v106
    v_permlane16_swap_b32 v105, v107
    v_permlane16_swap_b32 v108, v110
    v_permlane16_swap_b32 v109, v111
    v_permlane16_swap_b32 v112, v114
    v_permlane16_swap_b32 v113, v115
    v_accvgpr_write_b32 a8, v88
    v_accvgpr_write_b32 a9, v89
    v_accvgpr_write_b32 a10, v90
    v_accvgpr_write_b32 a11, v91
    v_accvgpr_write_b32 a24, v92
    v_accvgpr_write_b32 a25, v93
    v_accvgpr_write_b32 a26, v94
    v_accvgpr_write_b32 a27, v95
    v_accvgpr_write_b32 a40, v96
    v_accvgpr_write_b32 a41, v97
    v_accvgpr_write_b32 a42, v98
    v_accvgpr_write_b32 a43, v99
    v_accvgpr_write_b32 a56, v100
    v_accvgpr_write_b32 a57, v101
    v_accvgpr_write_b32 a58, v102
    v_accvgpr_write_b32 a59, v103
    v_accvgpr_write_b32 a72, v104
    v_accvgpr_write_b32 a73, v105
    v_accvgpr_write_b32 a74, v106
    v_accvgpr_write_b32 a75, v107
    v_accvgpr_write_b32 a88, v108
    v_accvgpr_write_b32 a89, v109
    v_accvgpr_write_b32 a90, v110
    v_accvgpr_write_b32 a91, v111
    v_accvgpr_write_b32 a104, v112
    v_accvgpr_write_b32 a105, v113
    v_accvgpr_write_b32 a106, v114
    v_accvgpr_write_b32 a107, v115
    v_accvgpr_read_b32 v200, a168
    v_accvgpr_read_b32 v201, a169
    v_accvgpr_read_b32 v202, a170
    v_accvgpr_read_b32 v203, a171
    v_accvgpr_read_b32 v204, a172
    v_accvgpr_read_b32 v205, a173
    v_accvgpr_read_b32 v206, a174
    v_accvgpr_read_b32 v207, a175
    v_accvgpr_read_b32 v208, a176
    v_accvgpr_read_b32 v209, a177
    v_accvgpr_read_b32 v210, a178
    v_accvgpr_read_b32 v211, a179
    v_accvgpr_read_b32 v212, a180
    v_accvgpr_read_b32 v213, a181
    v_accvgpr_read_b32 v214, a182
    v_accvgpr_read_b32 v215, a183
    v_accvgpr_read_b32 v216, a184
    v_accvgpr_read_b32 v217, a185
    v_accvgpr_read_b32 v218, a186
    v_accvgpr_read_b32 v219, a187
    v_accvgpr_read_b32 v220, a188
    v_accvgpr_read_b32 v221, a189
    v_accvgpr_read_b32 v222, a190
    v_accvgpr_read_b32 v223, a191
    v_accvgpr_read_b32 v224, a192
    v_accvgpr_read_b32 v225, a193
    v_accvgpr_read_b32 v226, a194
    v_accvgpr_read_b32 v227, a195
    v_accvgpr_read_b32 v228, a196
    v_accvgpr_read_b32 v229, a197
    v_accvgpr_read_b32 v230, a198
    v_accvgpr_read_b32 v231, a199
    v_accvgpr_read_b32 v232, a200
    v_accvgpr_read_b32 v233, a201
    v_accvgpr_read_b32 v234, a202
    v_accvgpr_read_b32 v235, a203
    v_accvgpr_read_b32 v236, a204
    v_accvgpr_read_b32 v237, a205
    v_accvgpr_read_b32 v238, a206
    v_accvgpr_read_b32 v239, a207
    v_accvgpr_read_b32 v240, a208
    v_accvgpr_read_b32 v241, a209
    v_accvgpr_read_b32 v242, a210
    v_accvgpr_read_b32 v243, a211
    v_accvgpr_read_b32 v244, a212
    v_accvgpr_read_b32 v245, a213
    v_accvgpr_read_b32 v246, a214
    v_accvgpr_read_b32 v247, a215
    v_accvgpr_read_b32 v248, a216
    v_accvgpr_read_b32 v249, a217
    v_accvgpr_read_b32 v250, a218
    v_accvgpr_read_b32 v251, a219
    v_accvgpr_read_b32 v252, a220
    v_accvgpr_read_b32 v253, a221
    v_accvgpr_read_b32 v254, a222
    v_accvgpr_read_b32 v255, a223
    v_pk_mul_f32 v[200:201], v[200:201], v[4:5]
    v_pk_mul_f32 v[202:203], v[202:203], v[4:5]
    v_pk_mul_f32 v[204:205], v[204:205], v[4:5]
    v_pk_mul_f32 v[206:207], v[206:207], v[4:5]
    v_pk_mul_f32 v[208:209], v[208:209], v[4:5]
    v_pk_mul_f32 v[210:211], v[210:211], v[4:5]
    v_pk_mul_f32 v[212:213], v[212:213], v[4:5]
    v_pk_mul_f32 v[214:215], v[214:215], v[4:5]
    v_pk_mul_f32 v[216:217], v[216:217], v[4:5]
    v_pk_mul_f32 v[218:219], v[218:219], v[4:5]
    v_pk_mul_f32 v[220:221], v[220:221], v[4:5]
    v_pk_mul_f32 v[222:223], v[222:223], v[4:5]
    v_pk_mul_f32 v[224:225], v[224:225], v[4:5]
    v_pk_mul_f32 v[226:227], v[226:227], v[4:5]
    v_pk_mul_f32 v[228:229], v[228:229], v[4:5]
    v_pk_mul_f32 v[230:231], v[230:231], v[4:5]
    v_pk_mul_f32 v[232:233], v[232:233], v[4:5]
    v_pk_mul_f32 v[234:235], v[234:235], v[4:5]
    v_pk_mul_f32 v[236:237], v[236:237], v[4:5]
    v_pk_mul_f32 v[238:239], v[238:239], v[4:5]
    v_pk_mul_f32 v[240:241], v[240:241], v[4:5]
    v_pk_mul_f32 v[242:243], v[242:243], v[4:5]
    v_pk_mul_f32 v[244:245], v[244:245], v[4:5]
    v_pk_mul_f32 v[246:247], v[246:247], v[4:5]
    v_pk_mul_f32 v[248:249], v[248:249], v[4:5]
    v_pk_mul_f32 v[250:251], v[250:251], v[4:5]
    v_pk_mul_f32 v[252:253], v[252:253], v[4:5]
    v_pk_mul_f32 v[254:255], v[254:255], v[4:5]
    v_cvt_pk_bf16_f32 v116, v200, v201
    v_cvt_pk_bf16_f32 v117, v202, v203
    v_cvt_pk_bf16_f32 v118, v228, v229
    v_cvt_pk_bf16_f32 v119, v230, v231
    v_cvt_pk_bf16_f32 v120, v204, v205
    v_cvt_pk_bf16_f32 v121, v206, v207
    v_cvt_pk_bf16_f32 v122, v232, v233
    v_cvt_pk_bf16_f32 v123, v234, v235
    v_cvt_pk_bf16_f32 v124, v208, v209
    v_cvt_pk_bf16_f32 v125, v210, v211
    v_cvt_pk_bf16_f32 v126, v236, v237
    v_cvt_pk_bf16_f32 v127, v238, v239
    v_cvt_pk_bf16_f32 v128, v212, v213
    v_cvt_pk_bf16_f32 v129, v214, v215
    v_cvt_pk_bf16_f32 v130, v240, v241
    v_cvt_pk_bf16_f32 v131, v242, v243
    v_cvt_pk_bf16_f32 v132, v216, v217
    v_cvt_pk_bf16_f32 v133, v218, v219
    v_cvt_pk_bf16_f32 v134, v244, v245
    v_cvt_pk_bf16_f32 v135, v246, v247
    v_cvt_pk_bf16_f32 v136, v220, v221
    v_cvt_pk_bf16_f32 v137, v222, v223
    v_cvt_pk_bf16_f32 v138, v248, v249
    v_cvt_pk_bf16_f32 v139, v250, v251
    v_cvt_pk_bf16_f32 v140, v224, v225
    v_cvt_pk_bf16_f32 v141, v226, v227
    v_cvt_pk_bf16_f32 v142, v252, v253
    v_cvt_pk_bf16_f32 v143, v254, v255
    s_nop 1
    v_permlane16_swap_b32 v116, v118
    v_permlane16_swap_b32 v117, v119
    v_permlane16_swap_b32 v120, v122
    v_permlane16_swap_b32 v121, v123
    v_permlane16_swap_b32 v124, v126
    v_permlane16_swap_b32 v125, v127
    v_permlane16_swap_b32 v128, v130
    v_permlane16_swap_b32 v129, v131
    v_permlane16_swap_b32 v132, v134
    v_permlane16_swap_b32 v133, v135
    v_permlane16_swap_b32 v136, v138
    v_permlane16_swap_b32 v137, v139
    v_permlane16_swap_b32 v140, v142
    v_permlane16_swap_b32 v141, v143
    v_accvgpr_write_b32 a12, v116
    v_accvgpr_write_b32 a13, v117
    v_accvgpr_write_b32 a14, v118
    v_accvgpr_write_b32 a15, v119
    v_accvgpr_write_b32 a28, v120
    v_accvgpr_write_b32 a29, v121
    v_accvgpr_write_b32 a30, v122
    v_accvgpr_write_b32 a31, v123
    v_accvgpr_write_b32 a44, v124
    v_accvgpr_write_b32 a45, v125
    v_accvgpr_write_b32 a46, v126
    v_accvgpr_write_b32 a47, v127
    v_accvgpr_write_b32 a60, v128
    v_accvgpr_write_b32 a61, v129
    v_accvgpr_write_b32 a62, v130
    v_accvgpr_write_b32 a63, v131
    v_accvgpr_write_b32 a76, v132
    v_accvgpr_write_b32 a77, v133
    v_accvgpr_write_b32 a78, v134
    v_accvgpr_write_b32 a79, v135
    v_accvgpr_write_b32 a92, v136
    v_accvgpr_write_b32 a93, v137
    v_accvgpr_write_b32 a94, v138
    v_accvgpr_write_b32 a95, v139
    v_accvgpr_write_b32 a108, v140
    v_accvgpr_write_b32 a109, v141
    v_accvgpr_write_b32 a110, v142
    v_accvgpr_write_b32 a111, v143
    s_cmp_eq_u32 s70, 0
    s_cbranch_scc1 L_at_nostash
    s_mov_b32 s70, 0
    s_lshl_b32 s30, s2, 2
    s_add_u32 s30, s30, s20
    s_mul_i32 s30, s30, 28672
    v_lshlrev_b32 v4, 4, v1
    buffer_store_dwordx4 a[0:3], v4, s[12:15], s30 offen offset:0
    buffer_store_dwordx4 a[4:7], v4, s[12:15], s30 offen offset:1024
    buffer_store_dwordx4 a[8:11], v4, s[12:15], s30 offen offset:2048
    buffer_store_dwordx4 a[12:15], v4, s[12:15], s30 offen offset:3072
    s_add_u32 s30, s30, 4096
    buffer_store_dwordx4 a[16:19], v4, s[12:15], s30 offen offset:0
    buffer_store_dwordx4 a[20:23], v4, s[12:15], s30 offen offset:1024
    buffer_store_dwordx4 a[24:27], v4, s[12:15], s30 offen offset:2048
    buffer_store_dwordx4 a[28:31], v4, s[12:15], s30 offen offset:3072
    s_add_u32 s30, s30, 4096
    buffer_store_dwordx4 a[32:35], v4, s[12:15], s30 offen offset:0
    buffer_store_dwordx4 a[36:39], v4, s[12:15], s30 offen offset:1024
    buffer_store_dwordx4 a[40:43], v4, s[12:15], s30 offen offset:2048
    buffer_store_dwordx4 a[44:47], v4, s[12:15], s30 offen offset:3072
    s_add_u32 s30, s30, 4096
    buffer_store_dwordx4 a[48:51], v4, s[12:15], s30 offen offset:0
    buffer_store_dwordx4 a[52:55], v4, s[12:15], s30 offen offset:1024
    buffer_store_dwordx4 a[56:59], v4, s[12:15], s30 offen offset:2048
    buffer_store_dwordx4 a[60:63], v4, s[12:15], s30 offen offset:3072
    s_add_u32 s30, s30, 4096
    buffer_store_dwordx4 a[64:67], v4, s[12:15], s30 offen offset:0
    buffer_store_dwordx4 a[68:71], v4, s[12:15], s30 offen offset:1024
    buffer_store_dwordx4 a[72:75], v4, s[12:15], s30 offen offset:2048
    buffer_store_dwordx4 a[76:79], v4, s[12:15], s30 offen offset:3072
    s_add_u32 s30, s30, 4096
    buffer_store_dwordx4 a[80:83], v4, s[12:15], s30 offen offset:0
    buffer_store_dwordx4 a[84:87], v4, s[12:15], s30 offen offset:1024
    buffer_store_dwordx4 a[88:91], v4, s[12:15], s30 offen offset:2048
    buffer_store_dwordx4 a[92:95], v4, s[12:15], s30 offen offset:3072
    s_add_u32 s30, s30, 4096
    buffer_store_dwordx4 a[96:99], v4, s[12:15], s30 offen offset:0
    buffer_store_dwordx4 a[100:103], v4, s[12:15], s30 offen offset:1024
    buffer_store_dwordx4 a[104:107], v4, s[12:15], s30 offen offset:2048
    buffer_store_dwordx4 a[108:111], v4, s[12:15], s30 offen offset:3072
    s_mov_b32 s68, 3
    s_branch L_at_round
L_at_nostash:
    s_cmp_lg_u32 s25, 0
    s_cbranch_scc1 L_at_maxpass
L_at_pre:
L_at_nowo1:
    s_waitcnt lgkmcnt(0)
    v_mfma_f32_16x16x32_bf16 v[88:91], v[56:59], a[0:3], 0
    v_mov_b32 v168, 0
    v_mov_b32 v169, 0
    v_mfma_f32_16x16x32_bf16 v[88:91], v[60:63], a[4:7], v[88:91]
    v_mov_b32 v170, 0
    v_mov_b32 v171, 0
    v_mfma_f32_16x16x32_bf16 v[88:91], v[64:67], a[8:11], v[88:91]
    v_mov_b32 v196, 0
    v_mov_b32 v197, 0
    v_mfma_f32_16x16x32_bf16 v[88:91], v[68:71], a[12:15], v[88:91]
    v_mov_b32 v198, 0
    v_mov_b32 v199, 0
    v_mfma_f32_16x16x32_bf16 v[92:95], v[84:87], a[12:15], 0
    v_mov_b32 v224, 0
    v_mov_b32 v225, 0
    v_mfma_f32_16x16x32_bf16 v[92:95], v[80:83], a[8:11], v[92:95]
    v_mov_b32 v226, 0
    v_mov_b32 v227, 0
    v_mfma_f32_16x16x32_bf16 v[92:95], v[76:79], a[4:7], v[92:95]
    v_mov_b32 v252, 0
    v_mov_b32 v253, 0
    v_mfma_f32_16x16x32_bf16 v[92:95], v[72:75], a[0:3], v[92:95]
    v_mov_b32 v254, 0
    v_mov_b32 v255, 0
    v_accvgpr_write_b32 a136, 0
    v_accvgpr_write_b32 a137, 0
    v_accvgpr_write_b32 a138, 0
    v_accvgpr_write_b32 a139, 0
    v_accvgpr_write_b32 a164, 0
    v_accvgpr_write_b32 a165, 0
    v_accvgpr_write_b32 a166, 0
    v_accvgpr_write_b32 a167, 0
    v_accvgpr_write_b32 a192, 0
    v_accvgpr_write_b32 a193, 0
    v_accvgpr_write_b32 a194, 0
    v_accvgpr_write_b32 a195, 0
    v_accvgpr_write_b32 a220, 0
    v_accvgpr_write_b32 a221, 0
    v_accvgpr_write_b32 a222, 0
    v_accvgpr_write_b32 a223, 0
    v_mfma_f32_16x16x32_bf16 v[96:99], v[56:59], a[16:19], 0
    v_max3_f32 v2, v88, v89, v12
    v_max3_f32 v3, v90, v91, v92
    v_max3_f32 v2, v93, v94, v2
    v_mfma_f32_16x16x32_bf16 v[96:99], v[60:63], a[20:23], v[96:99]
    v_max3_f32 v2, v95, v2, v3
    v_mov_b32 v3, v2
    s_nop 1
    v_permlane16_swap_b32 v2, v3
    v_mfma_f32_16x16x32_bf16 v[96:99], v[64:67], a[24:27], v[96:99]
    s_nop 1
    v_max_f32 v2, v2, v3
    v_mov_b32 v3, v2
    v_mfma_f32_16x16x32_bf16 v[96:99], v[68:71], a[28:31], v[96:99]
    s_nop 1
    v_permlane32_swap_b32 v2, v3
    s_nop 1
    v_max_f32 v2, v2, v3
    v_mfma_f32_16x16x32_bf16 v[100:103], v[84:87], a[28:31], 0
    v_mov_b32 v12, 0
    v_mov_b32 v13, 0
    v_sub_f32 v88, v88, v2
    v_mfma_f32_16x16x32_bf16 v[100:103], v[80:83], a[24:27], v[100:103]
    v_sub_f32 v89, v89, v2
    v_sub_f32 v90, v90, v2
    v_sub_f32 v91, v91, v2
    v_sub_f32 v92, v92, v2
    v_mfma_f32_16x16x32_bf16 v[100:103], v[76:79], a[20:23], v[100:103]
    v_sub_f32 v93, v93, v2
    v_sub_f32 v94, v94, v2
    v_sub_f32 v95, v95, v2
    v_mfma_f32_16x16x32_bf16 v[100:103], v[72:75], a[16:19], v[100:103]
    v_sub_f32 v28, 0, v2
    v_sub_f32 v29, 0, v2
    v_sub_f32 v30, 0, v2
    v_sub_f32 v31, 0, v2
    ds_read_b64_tr_b16 v[112:113], v9 offset:0
    ds_read_b64_tr_b16 v[114:115], v9 offset:512
    v_exp_f32 v88, v88
    ds_read_b64_tr_b16 v[116:117], v9 offset:32
    ds_read_b64_tr_b16 v[118:119], v9 offset:544
    v_exp_f32 v89, v89
    v_exp_f32 v90, v90
    ds_read_b64_tr_b16 v[120:121], v9 offset:64
    ds_read_b64_tr_b16 v[122:123], v9 offset:576
    v_exp_f32 v91, v91
    v_add_f32 v12, v12, v88
    v_add_f32 v13, v13, v89
    ds_read_b64_tr_b16 v[124:125], v9 offset:96
    ds_read_b64_tr_b16 v[126:127], v9 offset:608
    v_cvt_pk_bf16_f32 v104, v88, v89
    v_exp_f32 v92, v92
    ds_read_b64_tr_b16 v[128:129], v9 offset:128
    ds_read_b64_tr_b16 v[130:131], v9 offset:640
    v_exp_f32 v93, v93
    v_add_f32 v12, v12, v90
    v_add_f32 v13, v13, v91
    ds_read_b64_tr_b16 v[132:133], v9 offset:160
    ds_read_b64_tr_b16 v[134:135], v9 offset:672
    v_cvt_pk_bf16_f32 v105, v90, v91
    v_exp_f32 v94, v94
    ds_read_b64_tr_b16 v[136:137], v9 offset:192
    ds_read_b64_tr_b16 v[138:139], v9 offset:704
    v_exp_f32 v95, v95
    v_add_f32 v12, v12, v92
    v_add_f32 v13, v13, v93
    ds_read_b64_tr_b16 v[140:141], v9 offset:224
    ds_read_b64_tr_b16 v[142:143], v9 offset:736
    v_cvt_pk_bf16_f32 v106, v92, v93
    v_add_f32 v12, v12, v94
    v_add_f32 v13, v13, v95
    v_cvt_pk_bf16_f32 v107, v94, v95
    v_mfma_f32_16x16x32_bf16 v[88:91], v[56:59], a[32:35], 0
    v_max3_f32 v2, v96, v97, v14
    v_max3_f32 v3, v98, v99, v100
    v_max3_f32 v2, v101, v102, v2
    v_mfma_f32_16x16x32_bf16 v[88:91], v[60:63], a[36:39], v[88:91]
    v_max3_f32 v2, v103, v2, v3
    v_mov_b32 v3, v2
    s_nop 1
    v_permlane16_swap_b32 v2, v3
    v_mfma_f32_16x16x32_bf16 v[88:91], v[64:67], a[40:43], v[88:91]
    s_nop 1
    v_max_f32 v2, v2, v3
    v_mov_b32 v3, v2
    v_mfma_f32_16x16x32_bf16 v[88:91], v[68:71], a[44:47], v[88:91]
    s_nop 1
    v_permlane32_swap_b32 v2, v3
    s_nop 1
    v_max_f32 v2, v2, v3
    v_mfma_f32_16x16x32_bf16 v[92:95], v[84:87], a[44:47], 0
    v_mov_b32 v14, 0
    v_mov_b32 v15, 0
    v_sub_f32 v96, v96, v2
    v_mfma_f32_16x16x32_bf16 v[92:95], v[80:83], a[40:43], v[92:95]
    v_sub_f32 v97, v97, v2
    v_sub_f32 v98, v98, v2
    v_sub_f32 v99, v99, v2
    v_sub_f32 v100, v100, v2
    v_mfma_f32_16x16x32_bf16 v[92:95], v[76:79], a[36:39], v[92:95]
    v_sub_f32 v101, v101, v2
    v_sub_f32 v102, v102, v2
    v_sub_f32 v103, v103, v2
    v_mfma_f32_16x16x32_bf16 v[92:95], v[72:75], a[32:35], v[92:95]
    v_sub_f32 v32, 0, v2
    v_sub_f32 v33, 0, v2
    v_sub_f32 v34, 0, v2
    v_sub_f32 v35, 0, v2
    s_waitcnt lgkmcnt(0)
    v_mfma_f32_16x16x32_bf16 v[144:147], v[112:115], v[104:107], 0
    v_exp_f32 v96, v96
    v_mfma_f32_16x16x32_bf16 v[172:175], v[116:119], v[104:107], 0
    v_exp_f32 v97, v97
    v_exp_f32 v98, v98
    v_mfma_f32_16x16x32_bf16 v[200:203], v[120:123], v[104:107], 0
    v_exp_f32 v99, v99
    v_add_f32 v14, v14, v96
    v_add_f32 v15, v15, v97
    v_mfma_f32_16x16x32_bf16 v[228:231], v[124:127], v[104:107], 0
    v_cvt_pk_bf16_f32 v108, v96, v97
    v_exp_f32 v100, v100
    v_mfma_f32_16x16x32_bf16 a[112:115], v[128:131], v[104:107], 0
    v_exp_f32 v101, v101
    v_add_f32 v14, v14, v98
    v_add_f32 v15, v15, v99
    v_mfma_f32_16x16x32_bf16 a[140:143], v[132:135], v[104:107], 0
    v_cvt_pk_bf16_f32 v109, v98, v99
    v_exp_f32 v102, v102
    v_mfma_f32_16x16x32_bf16 a[168:171], v[136:139], v[104:107], 0
    v_exp_f32 v103, v103
    v_add_f32 v14, v14, v100
    v_add_f32 v15, v15, v101
    v_mfma_f32_16x16x32_bf16 a[196:199], v[140:143], v[104:107], 0
    v_cvt_pk_bf16_f32 v110, v100, v101
    v_add_f32 v14, v14, v102
    v_add_f32 v15, v15, v103
    v_cvt_pk_bf16_f32 v111, v102, v103
    v_mfma_f32_16x16x32_bf16 v[96:99], v[56:59], a[48:51], 0
    v_max3_f32 v2, v88, v89, v16
    v_max3_f32 v3, v90, v91, v92
    v_max3_f32 v2, v93, v94, v2
    v_mfma_f32_16x16x32_bf16 v[96:99], v[60:63], a[52:55], v[96:99]
    v_max3_f32 v2, v95, v2, v3
    v_mov_b32 v3, v2
    s_nop 1
    v_permlane16_swap_b32 v2, v3
    v_mfma_f32_16x16x32_bf16 v[96:99], v[64:67], a[56:59], v[96:99]
    s_nop 1
    v_max_f32 v2, v2, v3
    v_mov_b32 v3, v2
    v_mfma_f32_16x16x32_bf16 v[96:99], v[68:71], a[60:63], v[96:99]
    s_nop 1
    v_permlane32_swap_b32 v2, v3
    s_nop 1
    v_max_f32 v2, v2, v3
    v_mfma_f32_16x16x32_bf16 v[100:103], v[84:87], a[60:63], 0
    v_mov_b32 v16, 0
    v_mov_b32 v17, 0
    v_sub_f32 v88, v88, v2
    v_mfma_f32_16x16x32_bf16 v[100:103], v[80:83], a[56:59], v[100:103]
    v_sub_f32 v89, v89, v2
    v_sub_f32 v90, v90, v2
    v_sub_f32 v91, v91, v2
    v_sub_f32 v92, v92, v2
    v_mfma_f32_16x16x32_bf16 v[100:103], v[76:79], a[52:55], v[100:103]
    v_sub_f32 v93, v93, v2
    v_sub_f32 v94, v94, v2
    v_sub_f32 v95, v95, v2
    v_mfma_f32_16x16x32_bf16 v[100:103], v[72:75], a[48:51], v[100:103]
    v_sub_f32 v36, 0, v2
    v_sub_f32 v37, 0, v2
    v_sub_f32 v38, 0, v2
    v_sub_f32 v39, 0, v2
    v_mfma_f32_16x16x32_bf16 v[148:151], v[112:115], v[108:111], 0
    v_exp_f32 v88, v88
    v_mfma_f32_16x16x32_bf16 v[176:179], v[116:119], v[108:111], 0
    v_exp_f32 v89, v89
    v_exp_f32 v90, v90
    v_mfma_f32_16x16x32_bf16 v[204:207], v[120:123], v[108:111], 0
    v_exp_f32 v91, v91
    v_add_f32 v16, v16, v88
    v_add_f32 v17, v17, v89
    v_mfma_f32_16x16x32_bf16 v[232:235], v[124:127], v[108:111], 0
    v_cvt_pk_bf16_f32 v104, v88, v89
    v_exp_f32 v92, v92
    v_mfma_f32_16x16x32_bf16 a[116:119], v[128:131], v[108:111], 0
    v_exp_f32 v93, v93
    v_add_f32 v16, v16, v90
    v_add_f32 v17, v17, v91
    v_mfma_f32_16x16x32_bf16 a[144:147], v[132:135], v[108:111], 0
    v_cvt_pk_bf16_f32 v105, v90, v91
    v_exp_f32 v94, v94
    v_mfma_f32_16x16x32_bf16 a[172:175], v[136:139], v[108:111], 0
    v_exp_f32 v95, v95
    v_add_f32 v16, v16, v92
    v_add_f32 v17, v17, v93
    v_mfma_f32_16x16x32_bf16 a[200:203], v[140:143], v[108:111], 0
    v_cvt_pk_bf16_f32 v106, v92, v93
    v_add_f32 v16, v16, v94
    v_add_f32 v17, v17, v95
    v_cvt_pk_bf16_f32 v107, v94, v95
    v_mfma_f32_16x16x32_bf16 v[88:91], v[56:59], a[64:67], 0
    v_max3_f32 v2, v96, v97, v18
    v_max3_f32 v3, v98, v99, v100
    v_max3_f32 v2, v101, v102, v2
    v_mfma_f32_16x16x32_bf16 v[88:91], v[60:63], a[68:71], v[88:91]
    v_max3_f32 v2, v103, v2, v3
    v_mov_b32 v3, v2
    s_nop 1
    v_permlane16_swap_b32 v2, v3
    v_mfma_f32_16x16x32_bf16 v[88:91], v[64:67], a[72:75], v[88:91]
    s_nop 1
    v_max_f32 v2, v2, v3
    v_mov_b32 v3, v2
    v_mfma_f32_16x16x32_bf16 v[88:91], v[68:71], a[76:79], v[88:91]
    s_nop 1
    v_permlane32_swap_b32 v2, v3
    s_nop 1
    v_max_f32 v2, v2, v3
    v_mfma_f32_16x16x32_bf16 v[92:95], v[84:87], a[76:79], 0
    v_mov_b32 v18, 0
    v_mov_b32 v19, 0
    v_sub_f32 v96, v96, v2
    v_mfma_f32_16x16x32_bf16 v[92:95], v[80:83], a[72:75], v[92:95]
    v_sub_f32 v97, v97, v2
    v_sub_f32 v98, v98, v2
    v_sub_f32 v99, v99, v2
    v_sub_f32 v100, v100, v2
    v_mfma_f32_16x16x32_bf16 v[92:95], v[76:79], a[68:71], v[92:95]
    v_sub_f32 v101, v101, v2
    v_sub_f32 v102, v102, v2
    v_sub_f32 v103, v103, v2
    v_mfma_f32_16x16x32_bf16 v[92:95], v[72:75], a[64:67], v[92:95]
    v_sub_f32 v40, 0, v2
    v_sub_f32 v41, 0, v2
    v_sub_f32 v42, 0, v2
    v_sub_f32 v43, 0, v2
    v_mfma_f32_16x16x32_bf16 v[152:155], v[112:115], v[104:107], 0
    v_exp_f32 v96, v96
    v_mfma_f32_16x16x32_bf16 v[180:183], v[116:119], v[104:107], 0
    v_exp_f32 v97, v97
    v_exp_f32 v98, v98
    v_mfma_f32_16x16x32_bf16 v[208:211], v[120:123], v[104:107], 0
    v_exp_f32 v99, v99
    v_add_f32 v18, v18, v96
    v_add_f32 v19, v19, v97
    v_mfma_f32_16x16x32_bf16 v[236:239], v[124:127], v[104:107], 0
    v_cvt_pk_bf16_f32 v108, v96, v97
    v_exp_f32 v100, v100
    v_mfma_f32_16x16x32_bf16 a[120:123], v[128:131], v[104:107], 0
    v_exp_f32 v101, v101
    v_add_f32 v18, v18, v98
    v_add_f32 v19, v19, v99
    v_mfma_f32_16x16x32_bf16 a[148:151], v[132:135], v[104:107], 0
    v_cvt_pk_bf16_f32 v109, v98, v99
    v_exp_f32 v102, v102
    v_mfma_f32_16x16x32_bf16 a[176:179], v[136:139], v[104:107], 0
    v_exp_f32 v103, v103
    v_add_f32 v18, v18, v100
    v_add_f32 v19, v19, v101
    v_mfma_f32_16x16x32_bf16 a[204:207], v[140:143], v[104:107], 0
    v_cvt_pk_bf16_f32 v110, v100, v101
    v_add_f32 v18, v18, v102
    v_add_f32 v19, v19, v103
    v_cvt_pk_bf16_f32 v111, v102, v103
    v_mfma_f32_16x16x32_bf16 v[96:99], v[56:59], a[80:83], 0
    v_max3_f32 v2, v88, v89, v20
    v_max3_f32 v3, v90, v91, v92
    v_max3_f32 v2, v93, v94, v2
    v_mfma_f32_16x16x32_bf16 v[96:99], v[60:63], a[84:87], v[96:99]
    v_max3_f32 v2, v95, v2, v3
    v_mov_b32 v3, v2
    s_nop 1
    v_permlane16_swap_b32 v2, v3
    v_mfma_f32_16x16x32_bf16 v[96:99], v[64:67], a[88:91], v[96:99]
    s_nop 1
    v_max_f32 v2, v2, v3
    v_mov_b32 v3, v2
    v_mfma_f32_16x16x32_bf16 v[96:99], v[68:71], a[92:95], v[96:99]
    s_nop 1
    v_permlane32_swap_b32 v2, v3
    s_nop 1
    v_max_f32 v2, v2, v3
    v_mfma_f32_16x16x32_bf16 v[100:103], v[84:87], a[92:95], 0
    v_mov_b32 v20, 0
    v_mov_b32 v21, 0
    v_sub_f32 v88, v88, v2
    v_mfma_f32_16x16x32_bf16 v[100:103], v[80:83], a[88:91], v[100:103]
    v_sub_f32 v89, v89, v2
    v_sub_f32 v90, v90, v2
    v_sub_f32 v91, v91, v2
    v_sub_f32 v92, v92, v2
    v_mfma_f32_16x16x32_bf16 v[100:103], v[76:79], a[84:87], v[100:103]
    v_sub_f32 v93, v93, v2
    v_sub_f32 v94, v94, v2
    v_sub_f32 v95, v95, v2
    v_mfma_f32_16x16x32_bf16 v[100:103], v[72:75], a[80:83], v[100:103]
    v_sub_f32 v44, 0, v2
    v_sub_f32 v45, 0, v2
    v_sub_f32 v46, 0, v2
    v_sub_f32 v47, 0, v2
    v_mfma_f32_16x16x32_bf16 v[156:159], v[112:115], v[108:111], 0
    v_exp_f32 v88, v88
    v_mfma_f32_16x16x32_bf16 v[184:187], v[116:119], v[108:111], 0
    v_exp_f32 v89, v89
    v_exp_f32 v90, v90
    v_mfma_f32_16x16x32_bf16 v[212:215], v[120:123], v[108:111], 0
    v_exp_f32 v91, v91
    v_add_f32 v20, v20, v88
    v_add_f32 v21, v21, v89
    v_mfma_f32_16x16x32_bf16 v[240:243], v[124:127], v[108:111], 0
    v_cvt_pk_bf16_f32 v104, v88, v89
    v_exp_f32 v92, v92
    v_mfma_f32_16x16x32_bf16 a[124:127], v[128:131], v[108:111], 0
    v_exp_f32 v93, v93
    v_add_f32 v20, v20, v90
    v_add_f32 v21, v21, v91
    v_mfma_f32_16x16x32_bf16 a[152:155], v[132:135], v[108:111], 0
    v_cvt_pk_bf16_f32 v105, v90, v91
    v_exp_f32 v94, v94
    v_mfma_f32_16x16x32_bf16 a[180:183], v[136:139], v[108:111], 0
    v_exp_f32 v95, v95
    v_add_f32 v20, v20, v92
    v_add_f32 v21, v21, v93
    v_mfma_f32_16x16x32_bf16 a[208:211], v[140:143], v[108:111], 0
    v_cvt_pk_bf16_f32 v106, v92, v93
    v_add_f32 v20, v20, v94
    v_add_f32 v21, v21, v95
    v_cvt_pk_bf16_f32 v107, v94, v95
    s_cmp_eq_u32 s68, 0
    s_cbranch_scc0 L_bw1_3047
    s_waitcnt vmcnt(16) lgkmcnt(0)
L_bw2_3047:
    s_barrier
    s_cmp_le_u32 s21, s27
    s_cbranch_scc1 L_at_nofb_3052
    s_sub_u32 s28, s21, 1
    s_cmp_eq_u32 s28, s23
    s_cbranch_scc1 L_at_nofb_3052
    s_lshl_b32 s29, s28, 2
    s_add_u32 s29, s29, 76000
    v_mov_b32 v4, s29
    ds_read_b32 v4, v4
    s_waitcnt lgkmcnt(0)
    v_readfirstlane_b32 s29, v4
    s_nop 3
    s_cmp_lg_u32 s29, 0
    s_cbranch_scc1 L_at_fallback
L_at_nofb_3052:
    v_mfma_f32_16x16x32_bf16 v[88:91], v[56:59], a[96:99], 0
    ds_read_b128 v[56:59], v8 offset:8448
    v_max3_f32 v2, v96, v97, v22
    v_max3_f32 v3, v98, v99, v100
    v_max3_f32 v2, v101, v102, v2
    v_mfma_f32_16x16x32_bf16 v[88:91], v[60:63], a[100:103], v[88:91]
    ds_read_b128 v[60:63], v8 offset:8512
    v_max3_f32 v2, v103, v2, v3
    v_mov_b32 v3, v2
    s_nop 1
    v_permlane16_swap_b32 v2, v3
    v_mfma_f32_16x16x32_bf16 v[88:91], v[64:67], a[104:107], v[88:91]
    ds_read_b128 v[64:67], v8 offset:8576
    s_nop 1
    v_max_f32 v2, v2, v3
    v_mov_b32 v3, v2
    v_mfma_f32_16x16x32_bf16 v[88:91], v[68:71], a[108:111], v[88:91]
    ds_read_b128 v[68:71], v8 offset:8640
    s_nop 1
    v_permlane32_swap_b32 v2, v3
    s_nop 1
    v_max_f32 v2, v2, v3
    v_mfma_f32_16x16x32_bf16 v[92:95], v[84:87], a[108:111], 0
    ds_read_b128 v[84:87], v8 offset:9152
    v_mov_b32 v22, 0
    v_mov_b32 v23, 0
    v_sub_f32 v96, v96, v2
    v_mfma_f32_16x16x32_bf16 v[92:95], v[80:83], a[104:107], v[92:95]
    ds_read_b128 v[80:83], v8 offset:9088
    v_sub_f32 v97, v97, v2
    v_sub_f32 v98, v98, v2
    v_sub_f32 v99, v99, v2
    v_sub_f32 v100, v100, v2
    v_mfma_f32_16x16x32_bf16 v[92:95], v[76:79], a[100:103], v[92:95]
    ds_read_b128 v[76:79], v8 offset:9024
    v_sub_f32 v101, v101, v2
    v_sub_f32 v102, v102, v2
    v_sub_f32 v103, v103, v2
    v_mfma_f32_16x16x32_bf16 v[92:95], v[72:75], a[96:99], v[92:95]
    ds_read_b128 v[72:75], v8 offset:8960
    v_sub_f32 v48, 0, v2
    v_sub_f32 v49, 0, v2
    v_sub_f32 v50, 0, v2
    v_sub_f32 v51, 0, v2
    v_mfma_f32_16x16x32_bf16 v[160:163], v[112:115], v[104:107], 0
    v_exp_f32 v96, v96
    v_mfma_f32_16x16x32_bf16 v[188:191], v[116:119], v[104:107], 0
    v_exp_f32 v97, v97
    v_exp_f32 v98, v98
    v_mfma_f32_16x16x32_bf16 v[216:219], v[120:123], v[104:107], 0
    v_exp_f32 v99, v99
    v_add_f32 v22, v22, v96
    v_add_f32 v23, v23, v97
    v_mfma_f32_16x16x32_bf16 v[244:247], v[124:127], v[104:107], 0
    v_cvt_pk_bf16_f32 v108, v96, v97
    v_exp_f32 v100, v100
    v_mfma_f32_16x16x32_bf16 a[128:131], v[128:131], v[104:107], 0
    v_exp_f32 v101, v101
    v_add_f32 v22, v22, v98
    v_add_f32 v23, v23, v99
    v_mfma_f32_16x16x32_bf16 a[156:159], v[132:135], v[104:107], 0
    v_cvt_pk_bf16_f32 v109, v98, v99
    v_exp_f32 v102, v102
    v_mfma_f32_16x16x32_bf16 a[184:187], v[136:139], v[104:107], 0
    v_exp_f32 v103, v103
    v_add_f32 v22, v22, v100
    v_add_f32 v23, v23, v101
    v_mfma_f32_16x16x32_bf16 a[212:215], v[140:143], v[104:107], 0
    v_cvt_pk_bf16_f32 v110, v100, v101
    v_add_f32 v22, v22, v102
    v_add_f32 v23, v23, v103
    v_cvt_pk_bf16_f32 v111, v102, v103
    s_waitcnt lgkmcnt(0)
    v_mfma_f32_16x16x32_bf16 v[96:99], v[56:59], a[0:3], v[28:31]
    v_max3_f32 v2, v88, v89, v24
    v_max3_f32 v3, v90, v91, v92
    v_max3_f32 v2, v93, v94, v2
    v_mfma_f32_16x16x32_bf16 v[96:99], v[60:63], a[4:7], v[96:99]
    v_max3_f32 v2, v95, v2, v3
    v_mov_b32 v3, v2
    s_nop 1
    v_permlane16_swap_b32 v2, v3
    v_mfma_f32_16x16x32_bf16 v[96:99], v[64:67], a[8:11], v[96:99]
    s_nop 1
    v_max_f32 v2, v2, v3
    v_mov_b32 v3, v2
    v_mfma_f32_16x16x32_bf16 v[96:99], v[68:71], a[12:15], v[96:99]
    s_nop 1
    v_permlane32_swap_b32 v2, v3
    s_nop 1
    v_max_f32 v2, v2, v3
    v_mfma_f32_16x16x32_bf16 v[100:103], v[84:87], a[12:15], v[28:31]
    v_mov_b32 v24, 0
    v_mov_b32 v25, 0
    v_sub_f32 v88, v88, v2
    v_mfma_f32_16x16x32_bf16 v[100:103], v[80:83], a[8:11], v[100:103]
    v_sub_f32 v89, v89, v2
    v_sub_f32 v90, v90, v2
    v_sub_f32 v91, v91, v2
    v_sub_f32 v92, v92, v2
    v_mfma_f32_16x16x32_bf16 v[100:103], v[76:79], a[4:7], v[100:103]
    v_sub_f32 v93, v93, v2
    v_sub_f32 v94, v94, v2
    v_sub_f32 v95, v95, v2
    v_mfma_f32_16x16x32_bf16 v[100:103], v[72:75], a[0:3], v[100:103]
    v_sub_f32 v52, 0, v2
    v_sub_f32 v53, 0, v2
    v_sub_f32 v54, 0, v2
    v_sub_f32 v55, 0, v2
    v_mfma_f32_16x16x32_bf16 v[164:167], v[112:115], v[108:111], 0
    v_exp_f32 v88, v88
    v_mfma_f32_16x16x32_bf16 v[192:195], v[116:119], v[108:111], 0
    v_exp_f32 v89, v89
    v_exp_f32 v90, v90
    v_mfma_f32_16x16x32_bf16 v[220:223], v[120:123], v[108:111], 0
    v_exp_f32 v91, v91
    v_add_f32 v24, v24, v88
    v_add_f32 v25, v25, v89
    v_mfma_f32_16x16x32_bf16 v[248:251], v[124:127], v[108:111], 0
    v_cvt_pk_bf16_f32 v104, v88, v89
    v_exp_f32 v92, v92
    v_mfma_f32_16x16x32_bf16 a[132:135], v[128:131], v[108:111], 0
    v_exp_f32 v93, v93
    v_add_f32 v24, v24, v90
    v_add_f32 v25, v25, v91
    v_mfma_f32_16x16x32_bf16 a[160:163], v[132:135], v[108:111], 0
    v_cvt_pk_bf16_f32 v105, v90, v91
    v_exp_f32 v94, v94
    v_mfma_f32_16x16x32_bf16 a[188:191], v[136:139], v[108:111], 0
    v_exp_f32 v95, v95
    v_add_f32 v24, v24, v92
    v_add_f32 v25, v25, v93
    v_mfma_f32_16x16x32_bf16 a[216:219], v[140:143], v[108:111], 0
    v_cvt_pk_bf16_f32 v106, v92, v93
    v_add_f32 v24, v24, v94
    v_add_f32 v25, v25, v95
    v_cvt_pk_bf16_f32 v107, v94, v95
    s_mov_b32 s22, 0
L_at_loop:
    v_mfma_f32_16x16x32_bf16 v[88:91], v[56:59], a[16:19], v[32:35]
    v_mfma_f32_16x16x32_bf16 v[88:91], v[60:63], a[20:23], v[88:91]
    v_exp_f32 v96, v96
    v_mfma_f32_16x16x32_bf16 v[88:91], v[64:67], a[24:27], v[88:91]
    v_exp_f32 v97, v97
    v_mfma_f32_16x16x32_bf16 v[88:91], v[68:71], a[28:31], v[88:91]
    v_exp_f32 v98, v98
    v_mfma_f32_16x16x32_bf16 v[92:95], v[84:87], a[28:31], v[32:35]
    v_exp_f32 v99, v99
    v_mfma_f32_16x16x32_bf16 v[92:95], v[80:83], a[24:27], v[92:95]
    v_add_f32 v12, v12, v96
    v_add_f32 v13, v13, v97
    v_mfma_f32_16x16x32_bf16 v[92:95], v[76:79], a[20:23], v[92:95]
    v_cvt_pk_bf16_f32 v108, v96, v97
    v_mfma_f32_16x16x32_bf16 v[92:95], v[72:75], a[16:19], v[92:95]
    v_exp_f32 v100, v100
    v_mfma_f32_16x16x32_bf16 v[168:171], v[112:115], v[104:107], v[168:171]
    ds_read_b64_tr_b16 v[112:113], v9 offset:8448
    ds_read_b64_tr_b16 v[114:115], v9 offset:8960
    v_exp_f32 v101, v101
    v_mfma_f32_16x16x32_bf16 v[196:199], v[116:119], v[104:107], v[196:199]
    ds_read_b64_tr_b16 v[116:117], v9 offset:8480
    ds_read_b64_tr_b16 v[118:119], v9 offset:8992
    v_add_f32 v12, v12, v98
    v_add_f32 v13, v13, v99
    v_mfma_f32_16x16x32_bf16 v[224:227], v[120:123], v[104:107], v[224:227]
    ds_read_b64_tr_b16 v[120:121], v9 offset:8512
    ds_read_b64_tr_b16 v[122:123], v9 offset:9024
    v_cvt_pk_bf16_f32 v109, v98, v99
    v_mfma_f32_16x16x32_bf16 v[252:255], v[124:127], v[104:107], v[252:255]
    ds_read_b64_tr_b16 v[124:125], v9 offset:8544
    ds_read_b64_tr_b16 v[126:127], v9 offset:9056
    v_exp_f32 v102, v102
    v_mfma_f32_16x16x32_bf16 a[136:139], v[128:131], v[104:107], a[136:139]
    ds_read_b64_tr_b16 v[128:129], v9 offset:8576
    ds_read_b64_tr_b16 v[130:131], v9 offset:9088
    v_exp_f32 v103, v103
    v_mfma_f32_16x16x32_bf16 a[164:167], v[132:135], v[104:107], a[164:167]
    ds_read_b64_tr_b16 v[132:133], v9 offset:8608
    ds_read_b64_tr_b16 v[134:135], v9 offset:9120
    v_add_f32 v12, v12, v100
    v_add_f32 v13, v13, v101
    v_mfma_f32_16x16x32_bf16 a[192:195], v[136:139], v[104:107], a[192:195]
    ds_read_b64_tr_b16 v[136:137], v9 offset:8640
    ds_read_b64_tr_b16 v[138:139], v9 offset:9152
    v_cvt_pk_bf16_f32 v110, v100, v101
    v_add_f32 v12, v12, v102
    v_mfma_f32_16x16x32_bf16 a[220:223], v[140:143], v[104:107], a[220:223]
    ds_read_b64_tr_b16 v[140:141], v9 offset:8672
    ds_read_b64_tr_b16 v[142:143], v9 offset:9184
    v_add_f32 v13, v13, v103
    v_cvt_pk_bf16_f32 v111, v102, v103
    v_mfma_f32_16x16x32_bf16 v[96:99], v[56:59], a[32:35], v[36:39]
    v_mfma_f32_16x16x32_bf16 v[96:99], v[60:63], a[36:39], v[96:99]
    s_add_u32 s29, s34, s100
    v_exp_f32 v88, v88
    v_mfma_f32_16x16x32_bf16 v[96:99], v[64:67], a[40:43], v[96:99]
    v_exp_f32 v89, v89
    v_mfma_f32_16x16x32_bf16 v[96:99], v[68:71], a[44:47], v[96:99]
    s_bfe_u32 s28, s29, 0x20003
    v_exp_f32 v90, v90
    v_mfma_f32_16x16x32_bf16 v[100:103], v[84:87], a[44:47], v[36:39]
    v_exp_f32 v91, v91
    v_mfma_f32_16x16x32_bf16 v[100:103], v[80:83], a[40:43], v[100:103]
    s_lshl_b32 s28, s28, 16
    v_add_f32 v14, v14, v88
    v_add_f32 v15, v15, v89
    v_mfma_f32_16x16x32_bf16 v[100:103], v[76:79], a[36:39], v[100:103]
    v_cvt_pk_bf16_f32 v104, v88, v89
    v_mfma_f32_16x16x32_bf16 v[100:103], v[72:75], a[32:35], v[100:103]
    v_exp_f32 v92, v92
    s_waitcnt lgkmcnt(0)
    v_mfma_f32_16x16x32_bf16 v[144:147], v[112:115], v[108:111], v[144:147]
    s_and_b32 s29, s29, 7
    v_exp_f32 v93, v93
    v_mfma_f32_16x16x32_bf16 v[172:175], v[116:119], v[108:111], v[172:175]
    v_add_f32 v14, v14, v90
    v_add_f32 v15, v15, v91
    v_mfma_f32_16x16x32_bf16 v[200:203], v[120:123], v[108:111], v[200:203]
    s_lshl_b32 s29, s29, 11
    v_cvt_pk_bf16_f32 v105, v90, v91
    v_mfma_f32_16x16x32_bf16 v[228:231], v[124:127], v[108:111], v[228:231]
    v_exp_f32 v94, v94
    v_mfma_f32_16x16x32_bf16 a[112:115], v[128:131], v[108:111], a[112:115]
    s_add_u32 s29, s28, s29
    v_exp_f32 v95, v95
    v_mfma_f32_16x16x32_bf16 a[140:143], v[132:135], v[108:111], a[140:143]
    v_add_f32 v14, v14, v92
    v_add_f32 v15, v15, v93
    v_mfma_f32_16x16x32_bf16 a[168:171], v[136:139], v[108:111], a[168:171]
    s_lshr_b32 s28, s34, 5
    v_cvt_pk_bf16_f32 v106, v92, v93
    v_add_f32 v14, v14, v94
    v_mfma_f32_16x16x32_bf16 a[196:199], v[140:143], v[108:111], a[196:199]
    v_add_f32 v15, v15, v95
    v_cvt_pk_bf16_f32 v107, v94, v95
    v_mfma_f32_16x16x32_bf16 v[88:91], v[56:59], a[48:51], v[40:43]
    v_mfma_f32_16x16x32_bf16 v[88:91], v[60:63], a[52:55], v[88:91]
    s_lshl_b32 s28, s28, 19
    v_exp_f32 v96, v96
    v_mfma_f32_16x16x32_bf16 v[88:91], v[64:67], a[56:59], v[88:91]
    v_exp_f32 v97, v97
    v_mfma_f32_16x16x32_bf16 v[88:91], v[68:71], a[60:63], v[88:91]
    s_add_u32 s49, s28, s29
    v_exp_f32 v98, v98
    v_mfma_f32_16x16x32_bf16 v[92:95], v[84:87], a[60:63], v[40:43]
    v_exp_f32 v99, v99
    v_mfma_f32_16x16x32_bf16 v[92:95], v[80:83], a[56:59], v[92:95]
    s_add_u32 m0, s33, 0
    v_add_f32 v16, v16, v96
    v_add_f32 v17, v17, v97
    v_mfma_f32_16x16x32_bf16 v[92:95], v[76:79], a[52:55], v[92:95]
    v_cvt_pk_bf16_f32 v108, v96, v97
    v_mfma_f32_16x16x32_bf16 v[92:95], v[72:75], a[48:51], v[92:95]
    v_exp_f32 v100, v100
    v_mfma_f32_16x16x32_bf16 v[148:151], v[112:115], v[104:107], v[148:151]
    s_add_u32 s34, s34, 1
    v_exp_f32 v101, v101
    v_mfma_f32_16x16x32_bf16 v[176:179], v[116:119], v[104:107], v[176:179]
    v_add_f32 v16, v16, v98
    v_add_f32 v17, v17, v99
    v_mfma_f32_16x16x32_bf16 v[204:207], v[120:123], v[104:107], v[204:207]
    buffer_load_dwordx4 v7, s[4:7], s49 offen offset:0 nt lds
    v_cvt_pk_bf16_f32 v109, v98, v99
    v_mfma_f32_16x16x32_bf16 v[232:235], v[124:127], v[104:107], v[232:235]
    v_exp_f32 v102, v102
    v_mfma_f32_16x16x32_bf16 a[116:119], v[128:131], v[104:107], a[116:119]
    s_add_u32 m0, m0, s96
    v_exp_f32 v103, v103
    v_mfma_f32_16x16x32_bf16 a[144:147], v[132:135], v[104:107], a[144:147]
    v_add_f32 v16, v16, v100
    v_add_f32 v17, v17, v101
    v_mfma_f32_16x16x32_bf16 a[172:175], v[136:139], v[104:107], a[172:175]
    buffer_load_dwordx4 v7, s[4:7], s49 offen offset:256 nt lds
    v_cvt_pk_bf16_f32 v110, v100, v101
    v_add_f32 v16, v16, v102
    v_mfma_f32_16x16x32_bf16 a[200:203], v[140:143], v[104:107], a[200:203]
    v_add_f32 v17, v17, v103
    v_cvt_pk_bf16_f32 v111, v102, v103
    v_mfma_f32_16x16x32_bf16 v[96:99], v[56:59], a[64:67], v[44:47]
    v_mfma_f32_16x16x32_bf16 v[96:99], v[60:63], a[68:71], v[96:99]
    s_add_u32 m0, m0, s97
    v_exp_f32 v88, v88
    v_mfma_f32_16x16x32_bf16 v[96:99], v[64:67], a[72:75], v[96:99]
    v_exp_f32 v89, v89
    v_mfma_f32_16x16x32_bf16 v[96:99], v[68:71], a[76:79], v[96:99]
    buffer_load_dwordx4 v7, s[4:7], s49 offen offset:512 nt lds
    v_exp_f32 v90, v90
    v_mfma_f32_16x16x32_bf16 v[100:103], v[84:87], a[76:79], v[44:47]
    v_exp_f32 v91, v91
    v_mfma_f32_16x16x32_bf16 v[100:103], v[80:83], a[72:75], v[100:103]
    s_add_u32 m0, m0, s96
    v_add_f32 v18, v18, v88
    v_add_f32 v19, v19, v89
    v_mfma_f32_16x16x32_bf16 v[100:103], v[76:79], a[68:71], v[100:103]
    v_cvt_pk_bf16_f32 v104, v88, v89
    v_mfma_f32_16x16x32_bf16 v[100:103], v[72:75], a[64:67], v[100:103]
    v_exp_f32 v92, v92
    v_mfma_f32_16x16x32_bf16 v[152:155], v[112:115], v[108:111], v[152:155]
    buffer_load_dwordx4 v7, s[4:7], s49 offen offset:768 nt lds
    v_exp_f32 v93, v93
    v_mfma_f32_16x16x32_bf16 v[180:183], v[116:119], v[108:111], v[180:183]
    v_add_f32 v18, v18, v90
    v_add_f32 v19, v19, v91
    v_mfma_f32_16x16x32_bf16 v[208:211], v[120:123], v[108:111], v[208:211]
    s_add_u32 m0, m0, s97
    v_cvt_pk_bf16_f32 v105, v90, v91
    v_mfma_f32_16x16x32_bf16 v[236:239], v[124:127], v[108:111], v[236:239]
    v_exp_f32 v94, v94
    v_mfma_f32_16x16x32_bf16 a[120:123], v[128:131], v[108:111], a[120:123]
    buffer_load_dwordx4 v7, s[4:7], s49 offen offset:1024 nt lds
    v_exp_f32 v95, v95
    v_mfma_f32_16x16x32_bf16 a[148:151], v[132:135], v[108:111], a[148:151]
    v_add_f32 v18, v18, v92
    v_add_f32 v19, v19, v93
    v_mfma_f32_16x16x32_bf16 a[176:179], v[136:139], v[108:111], a[176:179]
    s_add_u32 m0, m0, s96
    v_cvt_pk_bf16_f32 v106, v92, v93
    v_add_f32 v18, v18, v94
    v_mfma_f32_16x16x32_bf16 a[204:207], v[140:143], v[108:111], a[204:207]
    v_add_f32 v19, v19, v95
    v_cvt_pk_bf16_f32 v107, v94, v95
    v_mfma_f32_16x16x32_bf16 v[88:91], v[56:59], a[80:83], v[48:51]
    v_mfma_f32_16x16x32_bf16 v[88:91], v[60:63], a[84:87], v[88:91]
    buffer_load_dwordx4 v7, s[4:7], s49 offen offset:1280 nt lds
    v_exp_f32 v96, v96
    v_mfma_f32_16x16x32_bf16 v[88:91], v[64:67], a[88:91], v[88:91]
    v_exp_f32 v97, v97
    v_mfma_f32_16x16x32_bf16 v[88:91], v[68:71], a[92:95], v[88:91]
    s_add_u32 m0, m0, s97
    v_exp_f32 v98, v98
    v_mfma_f32_16x16x32_bf16 v[92:95], v[84:87], a[92:95], v[48:51]
    v_exp_f32 v99, v99
    v_mfma_f32_16x16x32_bf16 v[92:95], v[80:83], a[88:91], v[92:95]
    buffer_load_dwordx4 v7, s[4:7], s49 offen offset:1536 nt lds
    v_add_f32 v20, v20, v96
    v_add_f32 v21, v21, v97
    v_mfma_f32_16x16x32_bf16 v[92:95], v[76:79], a[84:87], v[92:95]
    v_cvt_pk_bf16_f32 v108, v96, v97
    v_mfma_f32_16x16x32_bf16 v[92:95], v[72:75], a[80:83], v[92:95]
    v_exp_f32 v100, v100
    v_mfma_f32_16x16x32_bf16 v[156:159], v[112:115], v[104:107], v[156:159]
    s_add_u32 m0, m0, s96
    v_exp_f32 v101, v101
    v_mfma_f32_16x16x32_bf16 v[184:187], v[116:119], v[104:107], v[184:187]
    v_add_f32 v20, v20, v98
    v_add_f32 v21, v21, v99
    v_mfma_f32_16x16x32_bf16 v[212:215], v[120:123], v[104:107], v[212:215]
    buffer_load_dwordx4 v7, s[4:7], s49 offen offset:1792 nt lds
    v_cvt_pk_bf16_f32 v109, v98, v99
    v_mfma_f32_16x16x32_bf16 v[240:243], v[124:127], v[104:107], v[240:243]
    v_exp_f32 v102, v102
    v_mfma_f32_16x16x32_bf16 a[124:127], v[128:131], v[104:107], a[124:127]
    v_exp_f32 v103, v103
    v_mfma_f32_16x16x32_bf16 a[152:155], v[132:135], v[104:107], a[152:155]
    v_add_f32 v20, v20, v100
    v_add_f32 v21, v21, v101
    v_mfma_f32_16x16x32_bf16 a[180:183], v[136:139], v[104:107], a[180:183]
    v_cvt_pk_bf16_f32 v110, v100, v101
    v_add_f32 v20, v20, v102
    v_mfma_f32_16x16x32_bf16 a[208:211], v[140:143], v[104:107], a[208:211]
    v_add_f32 v21, v21, v103
    v_cvt_pk_bf16_f32 v111, v102, v103
    s_cmp_eq_u32 s68, 0
    s_cbranch_scc0 L_bw1_3429
    s_waitcnt vmcnt(16) lgkmcnt(0)
L_bw2_3429:
    s_barrier
    v_mfma_f32_16x16x32_bf16 v[96:99], v[56:59], a[96:99], v[52:55]
    ds_read_b128 v[56:59], v8 offset:16896
    v_mfma_f32_16x16x32_bf16 v[96:99], v[60:63], a[100:103], v[96:99]
    ds_read_b128 v[60:63], v8 offset:16960
    v_exp_f32 v88, v88
    v_mfma_f32_16x16x32_bf16 v[96:99], v[64:67], a[104:107], v[96:99]
    ds_read_b128 v[64:67], v8 offset:17024
    v_exp_f32 v89, v89
    v_mfma_f32_16x16x32_bf16 v[96:99], v[68:71], a[108:111], v[96:99]
    ds_read_b128 v[68:71], v8 offset:17088
    v_exp_f32 v90, v90
    v_mfma_f32_16x16x32_bf16 v[100:103], v[84:87], a[108:111], v[52:55]
    ds_read_b128 v[84:87], v8 offset:17600
    v_exp_f32 v91, v91
    v_mfma_f32_16x16x32_bf16 v[100:103], v[80:83], a[104:107], v[100:103]
    ds_read_b128 v[80:83], v8 offset:17536
    v_add_f32 v22, v22, v88
    v_add_f32 v23, v23, v89
    v_mfma_f32_16x16x32_bf16 v[100:103], v[76:79], a[100:103], v[100:103]
    ds_read_b128 v[76:79], v8 offset:17472
    v_cvt_pk_bf16_f32 v104, v88, v89
    v_mfma_f32_16x16x32_bf16 v[100:103], v[72:75], a[96:99], v[100:103]
    ds_read_b128 v[72:75], v8 offset:17408
    v_exp_f32 v92, v92
    v_mfma_f32_16x16x32_bf16 v[160:163], v[112:115], v[108:111], v[160:163]
    v_exp_f32 v93, v93
    v_mfma_f32_16x16x32_bf16 v[188:191], v[116:119], v[108:111], v[188:191]
    v_add_f32 v22, v22, v90
    v_add_f32 v23, v23, v91
    v_mfma_f32_16x16x32_bf16 v[216:219], v[120:123], v[108:111], v[216:219]
    v_cvt_pk_bf16_f32 v105, v90, v91
    v_mfma_f32_16x16x32_bf16 v[244:247], v[124:127], v[108:111], v[244:247]
    v_exp_f32 v94, v94
    v_mfma_f32_16x16x32_bf16 a[128:131], v[128:131], v[108:111], a[128:131]
    v_exp_f32 v95, v95
    v_mfma_f32_16x16x32_bf16 a[156:159], v[132:135], v[108:111], a[156:159]
    v_add_f32 v22, v22, v92
    v_add_f32 v23, v23, v93
    v_mfma_f32_16x16x32_bf16 a[184:187], v[136:139], v[108:111], a[184:187]
    v_cvt_pk_bf16_f32 v106, v92, v93
    v_add_f32 v22, v22, v94
    v_mfma_f32_16x16x32_bf16 a[212:215], v[140:143], v[108:111], a[212:215]
    v_add_f32 v23, v23, v95
    v_cvt_pk_bf16_f32 v107, v94, v95
    s_waitcnt lgkmcnt(0)
    v_mfma_f32_16x16x32_bf16 v[88:91], v[56:59], a[0:3], v[28:31]
    v_mfma_f32_16x16x32_bf16 v[88:91], v[60:63], a[4:7], v[88:91]
    v_exp_f32 v96, v96
    v_mfma_f32_16x16x32_bf16 v[88:91], v[64:67], a[8:11], v[88:91]
    v_exp_f32 v97, v97
    v_mfma_f32_16x16x32_bf16 v[88:91], v[68:71], a[12:15], v[88:91]
    v_exp_f32 v98, v98
    v_mfma_f32_16x16x32_bf16 v[92:95], v[84:87], a[12:15], v[28:31]
    v_exp_f32 v99, v99
    v_mfma_f32_16x16x32_bf16 v[92:95], v[80:83], a[8:11], v[92:95]
    v_add_f32 v24, v24, v96
    v_add_f32 v25, v25, v97
    v_mfma_f32_16x16x32_bf16 v[92:95], v[76:79], a[4:7], v[92:95]
    v_cvt_pk_bf16_f32 v108, v96, v97
    v_mfma_f32_16x16x32_bf16 v[92:95], v[72:75], a[0:3], v[92:95]
    v_exp_f32 v100, v100
    v_mfma_f32_16x16x32_bf16 v[164:167], v[112:115], v[104:107], v[164:167]
    v_exp_f32 v101, v101
    v_mfma_f32_16x16x32_bf16 v[192:195], v[116:119], v[104:107], v[192:195]
    v_add_f32 v24, v24, v98
    v_add_f32 v25, v25, v99
    v_mfma_f32_16x16x32_bf16 v[220:223], v[120:123], v[104:107], v[220:223]
    v_cvt_pk_bf16_f32 v109, v98, v99
    v_mfma_f32_16x16x32_bf16 v[248:251], v[124:127], v[104:107], v[248:251]
    v_exp_f32 v102, v102
    v_mfma_f32_16x16x32_bf16 a[132:135], v[128:131], v[104:107], a[132:135]
    v_exp_f32 v103, v103
    v_mfma_f32_16x16x32_bf16 a[160:163], v[132:135], v[104:107], a[160:163]
    v_add_f32 v24, v24, v100
    v_add_f32 v25, v25, v101
    v_mfma_f32_16x16x32_bf16 a[188:191], v[136:139], v[104:107], a[188:191]
    v_cvt_pk_bf16_f32 v110, v100, v101
    v_add_f32 v24, v24, v102
    v_mfma_f32_16x16x32_bf16 a[216:219], v[140:143], v[104:107], a[216:219]
    v_add_f32 v25, v25, v103
    v_cvt_pk_bf16_f32 v111, v102, v103
    v_mfma_f32_16x16x32_bf16 v[96:99], v[56:59], a[16:19], v[32:35]
    v_mfma_f32_16x16x32_bf16 v[96:99], v[60:63], a[20:23], v[96:99]
    v_exp_f32 v88, v88
    v_mfma_f32_16x16x32_bf16 v[96:99], v[64:67], a[24:27], v[96:99]
    v_exp_f32 v89, v89
    v_mfma_f32_16x16x32_bf16 v[96:99], v[68:71], a[28:31], v[96:99]
    v_exp_f32 v90, v90
    v_mfma_f32_16x16x32_bf16 v[100:103], v[84:87], a[28:31], v[32:35]
    v_exp_f32 v91, v91
    v_mfma_f32_16x16x32_bf16 v[100:103], v[80:83], a[24:27], v[100:103]
    v_add_f32 v12, v12, v88
    v_add_f32 v13, v13, v89
    v_mfma_f32_16x16x32_bf16 v[100:103], v[76:79], a[20:23], v[100:103]
    v_cvt_pk_bf16_f32 v104, v88, v89
    v_mfma_f32_16x16x32_bf16 v[100:103], v[72:75], a[16:19], v[100:103]
    v_exp_f32 v92, v92
    v_mfma_f32_16x16x32_bf16 v[168:171], v[112:115], v[108:111], v[168:171]
    ds_read_b64_tr_b16 v[112:113], v9 offset:16896
    ds_read_b64_tr_b16 v[114:115], v9 offset:17408
    v_exp_f32 v93, v93
    v_mfma_f32_16x16x32_bf16 v[196:199], v[116:119], v[108:111], v[196:199]
    ds_read_b64_tr_b16 v[116:117], v9 offset:16928
    ds_read_b64_tr_b16 v[118:119], v9 offset:17440
    v_add_f32 v12, v12, v90
    v_add_f32 v13, v13, v91
    v_mfma_f32_16x16x32_bf16 v[224:227], v[120:123], v[108:111], v[224:227]
    ds_read_b64_tr_b16 v[120:121], v9 offset:16960
    ds_read_b64_tr_b16 v[122:123], v9 offset:17472
    v_cvt_pk_bf16_f32 v105, v90, v91
    v_mfma_f32_16x16x32_bf16 v[252:255], v[124:127], v[108:111], v[252:255]
    ds_read_b64_tr_b16 v[124:125], v9 offset:16992
    ds_read_b64_tr_b16 v[126:127], v9 offset:17504
    v_exp_f32 v94, v94
    v_mfma_f32_16x16x32_bf16 a[136:139], v[128:131], v[108:111], a[136:139]
    ds_read_b64_tr_b16 v[128:129], v9 offset:17024
    ds_read_b64_tr_b16 v[130:131], v9 offset:17536
    v_exp_f32 v95, v95
    v_mfma_f32_16x16x32_bf16 a[164:167], v[132:135], v[108:111], a[164:167]
    ds_read_b64_tr_b16 v[132:133], v9 offset:17056
    ds_read_b64_tr_b16 v[134:135], v9 offset:17568
    v_add_f32 v12, v12, v92
    v_add_f32 v13, v13, v93
    v_mfma_f32_16x16x32_bf16 a[192:195], v[136:139], v[108:111], a[192:195]
    ds_read_b64_tr_b16 v[136:137], v9 offset:17088
    ds_read_b64_tr_b16 v[138:139], v9 offset:17600
    v_cvt_pk_bf16_f32 v106, v92, v93
    v_add_f32 v12, v12, v94
    v_mfma_f32_16x16x32_bf16 a[220:223], v[140:143], v[108:111], a[220:223]
    ds_read_b64_tr_b16 v[140:141], v9 offset:17120
    ds_read_b64_tr_b16 v[142:143], v9 offset:17632
    v_add_f32 v13, v13, v95
    v_cvt_pk_bf16_f32 v107, v94, v95
    v_mfma_f32_16x16x32_bf16 v[88:91], v[56:59], a[32:35], v[36:39]
    v_mfma_f32_16x16x32_bf16 v[88:91], v[60:63], a[36:39], v[88:91]
    s_add_u32 s29, s34, s100
    v_exp_f32 v96, v96
    v_mfma_f32_16x16x32_bf16 v[88:91], v[64:67], a[40:43], v[88:91]
    v_exp_f32 v97, v97
    v_mfma_f32_16x16x32_bf16 v[88:91], v[68:71], a[44:47], v[88:91]
    s_bfe_u32 s28, s29, 0x20003
    v_exp_f32 v98, v98
    v_mfma_f32_16x16x32_bf16 v[92:95], v[84:87], a[44:47], v[36:39]
    v_exp_f32 v99, v99
    v_mfma_f32_16x16x32_bf16 v[92:95], v[80:83], a[40:43], v[92:95]
    s_lshl_b32 s28, s28, 16
    v_add_f32 v14, v14, v96
    v_add_f32 v15, v15, v97
    v_mfma_f32_16x16x32_bf16 v[92:95], v[76:79], a[36:39], v[92:95]
    v_cvt_pk_bf16_f32 v108, v96, v97
    v_mfma_f32_16x16x32_bf16 v[92:95], v[72:75], a[32:35], v[92:95]
    v_exp_f32 v100, v100
    s_waitcnt lgkmcnt(0)
    v_mfma_f32_16x16x32_bf16 v[144:147], v[112:115], v[104:107], v[144:147]
    s_and_b32 s29, s29, 7
    v_exp_f32 v101, v101
    v_mfma_f32_16x16x32_bf16 v[172:175], v[116:119], v[104:107], v[172:175]
    v_add_f32 v14, v14, v98
    v_add_f32 v15, v15, v99
    v_mfma_f32_16x16x32_bf16 v[200:203], v[120:123], v[104:107], v[200:203]
    s_lshl_b32 s29, s29, 11
    v_cvt_pk_bf16_f32 v109, v98, v99
    v_mfma_f32_16x16x32_bf16 v[228:231], v[124:127], v[104:107], v[228:231]
    v_exp_f32 v102, v102
    v_mfma_f32_16x16x32_bf16 a[112:115], v[128:131], v[104:107], a[112:115]
    s_add_u32 s29, s28, s29
    v_exp_f32 v103, v103
    v_mfma_f32_16x16x32_bf16 a[140:143], v[132:135], v[104:107], a[140:143]
    v_add_f32 v14, v14, v100
    v_add_f32 v15, v15, v101
    v_mfma_f32_16x16x32_bf16 a[168:171], v[136:139], v[104:107], a[168:171]
    s_lshr_b32 s28, s34, 5
    v_cvt_pk_bf16_f32 v110, v100, v101
    v_add_f32 v14, v14, v102
    v_mfma_f32_16x16x32_bf16 a[196:199], v[140:143], v[104:107], a[196:199]
    v_add_f32 v15, v15, v103
    v_cvt_pk_bf16_f32 v111, v102, v103
    v_mfma_f32_16x16x32_bf16 v[96:99], v[56:59], a[48:51], v[40:43]
    v_mfma_f32_16x16x32_bf16 v[96:99], v[60:63], a[52:55], v[96:99]
    s_lshl_b32 s28, s28, 19
    v_exp_f32 v88, v88
    v_mfma_f32_16x16x32_bf16 v[96:99], v[64:67], a[56:59], v[96:99]
    v_exp_f32 v89, v89
    v_mfma_f32_16x16x32_bf16 v[96:99], v[68:71], a[60:63], v[96:99]
    s_add_u32 s49, s28, s29
    v_exp_f32 v90, v90
    v_mfma_f32_16x16x32_bf16 v[100:103], v[84:87], a[60:63], v[40:43]
    v_exp_f32 v91, v91
    v_mfma_f32_16x16x32_bf16 v[100:103], v[80:83], a[56:59], v[100:103]
    s_add_u32 m0, s33, 8448
    v_add_f32 v16, v16, v88
    v_add_f32 v17, v17, v89
    v_mfma_f32_16x16x32_bf16 v[100:103], v[76:79], a[52:55], v[100:103]
    v_cvt_pk_bf16_f32 v104, v88, v89
    v_mfma_f32_16x16x32_bf16 v[100:103], v[72:75], a[48:51], v[100:103]
    v_exp_f32 v92, v92
    v_mfma_f32_16x16x32_bf16 v[148:151], v[112:115], v[108:111], v[148:151]
    s_add_u32 s34, s34, 1
    v_exp_f32 v93, v93
    v_mfma_f32_16x16x32_bf16 v[176:179], v[116:119], v[108:111], v[176:179]
    v_add_f32 v16, v16, v90
    v_add_f32 v17, v17, v91
    v_mfma_f32_16x16x32_bf16 v[204:207], v[120:123], v[108:111], v[204:207]
    buffer_load_dwordx4 v7, s[4:7], s49 offen offset:0 nt lds
    v_cvt_pk_bf16_f32 v105, v90, v91
    v_mfma_f32_16x16x32_bf16 v[232:235], v[124:127], v[108:111], v[232:235]
    v_exp_f32 v94, v94
    v_mfma_f32_16x16x32_bf16 a[116:119], v[128:131], v[108:111], a[116:119]
    s_add_u32 m0, m0, s96
    v_exp_f32 v95, v95
    v_mfma_f32_16x16x32_bf16 a[144:147], v[132:135], v[108:111], a[144:147]
    v_add_f32 v16, v16, v92
    v_add_f32 v17, v17, v93
    v_mfma_f32_16x16x32_bf16 a[172:175], v[136:139], v[108:111], a[172:175]
    buffer_load_dwordx4 v7, s[4:7], s49 offen offset:256 nt lds
    v_cvt_pk_bf16_f32 v106, v92, v93
    v_add_f32 v16, v16, v94
    v_mfma_f32_16x16x32_bf16 a[200:203], v[140:143], v[108:111], a[200:203]
    v_add_f32 v17, v17, v95
    v_cvt_pk_bf16_f32 v107, v94, v95
    v_mfma_f32_16x16x32_bf16 v[88:91], v[56:59], a[64:67], v[44:47]
    v_mfma_f32_16x16x32_bf16 v[88:91], v[60:63], a[68:71], v[88:91]
    s_add_u32 m0, m0, s97
    v_exp_f32 v96, v96
    v_mfma_f32_16x16x32_bf16 v[88:91], v[64:67], a[72:75], v[88:91]
    v_exp_f32 v97, v97
    v_mfma_f32_16x16x32_bf16 v[88:91], v[68:71], a[76:79], v[88:91]
    buffer_load_dwordx4 v7, s[4:7], s49 offen offset:512 nt lds
    v_exp_f32 v98, v98
    v_mfma_f32_16x16x32_bf16 v[92:95], v[84:87], a[76:79], v[44:47]
    v_exp_f32 v99, v99
    v_mfma_f32_16x16x32_bf16 v[92:95], v[80:83], a[72:75], v[92:95]
    s_add_u32 m0, m0, s96
    v_add_f32 v18, v18, v96
    v_add_f32 v19, v19, v97
    v_mfma_f32_16x16x32_bf16 v[92:95], v[76:79], a[68:71], v[92:95]
    v_cvt_pk_bf16_f32 v108, v96, v97
    v_mfma_f32_16x16x32_bf16 v[92:95], v[72:75], a[64:67], v[92:95]
    v_exp_f32 v100, v100
    v_mfma_f32_16x16x32_bf16 v[152:155], v[112:115], v[104:107], v[152:155]
    buffer_load_dwordx4 v7, s[4:7], s49 offen offset:768 nt lds
    v_exp_f32 v101, v101
    v_mfma_f32_16x16x32_bf16 v[180:183], v[116:119], v[104:107], v[180:183]
    v_add_f32 v18, v18, v98
    v_add_f32 v19, v19, v99
    v_mfma_f32_16x16x32_bf16 v[208:211], v[120:123], v[104:107], v[208:211]
    s_add_u32 m0, m0, s97
    v_cvt_pk_bf16_f32 v109, v98, v99
    v_mfma_f32_16x16x32_bf16 v[236:239], v[124:127], v[104:107], v[236:239]
    v_exp_f32 v102, v102
    v_mfma_f32_16x16x32_bf16 a[120:123], v[128:131], v[104:107], a[120:123]
    buffer_load_dwordx4 v7, s[4:7], s49 offen offset:1024 nt lds
    v_exp_f32 v103, v103
    v_mfma_f32_16x16x32_bf16 a[148:151], v[132:135], v[104:107], a[148:151]
    v_add_f32 v18, v18, v100
    v_add_f32 v19, v19, v101
    v_mfma_f32_16x16x32_bf16 a[176:179], v[136:139], v[104:107], a[176:179]
    s_add_u32 m0, m0, s96
    v_cvt_pk_bf16_f32 v110, v100, v101
    v_add_f32 v18, v18, v102
    v_mfma_f32_16x16x32_bf16 a[204:207], v[140:143], v[104:107], a[204:207]
    v_add_f32 v19, v19, v103
    v_cvt_pk_bf16_f32 v111, v102, v103
    v_mfma_f32_16x16x32_bf16 v[96:99], v[56:59], a[80:83], v[48:51]
    v_mfma_f32_16x16x32_bf16 v[96:99], v[60:63], a[84:87], v[96:99]
    buffer_load_dwordx4 v7, s[4:7], s49 offen offset:1280 nt lds
    v_exp_f32 v88, v88
    v_mfma_f32_16x16x32_bf16 v[96:99], v[64:67], a[88:91], v[96:99]
    v_exp_f32 v89, v89
    v_mfma_f32_16x16x32_bf16 v[96:99], v[68:71], a[92:95], v[96:99]
    s_add_u32 m0, m0, s97
    v_exp_f32 v90, v90
    v_mfma_f32_16x16x32_bf16 v[100:103], v[84:87], a[92:95], v[48:51]
    v_exp_f32 v91, v91
    v_mfma_f32_16x16x32_bf16 v[100:103], v[80:83], a[88:91], v[100:103]
    buffer_load_dwordx4 v7, s[4:7], s49 offen offset:1536 nt lds
    v_add_f32 v20, v20, v88
    v_add_f32 v21, v21, v89
    v_mfma_f32_16x16x32_bf16 v[100:103], v[76:79], a[84:87], v[100:103]
    v_cvt_pk_bf16_f32 v104, v88, v89
    v_mfma_f32_16x16x32_bf16 v[100:103], v[72:75], a[80:83], v[100:103]
    v_exp_f32 v92, v92
    v_mfma_f32_16x16x32_bf16 v[156:159], v[112:115], v[108:111], v[156:159]
    s_add_u32 m0, m0, s96
    v_exp_f32 v93, v93
    v_mfma_f32_16x16x32_bf16 v[184:187], v[116:119], v[108:111], v[184:187]
    v_add_f32 v20, v20, v90
    v_add_f32 v21, v21, v91
    v_mfma_f32_16x16x32_bf16 v[212:215], v[120:123], v[108:111], v[212:215]
    buffer_load_dwordx4 v7, s[4:7], s49 offen offset:1792 nt lds
    v_cvt_pk_bf16_f32 v105, v90, v91
    v_mfma_f32_16x16x32_bf16 v[240:243], v[124:127], v[108:111], v[240:243]
    v_exp_f32 v94, v94
    v_mfma_f32_16x16x32_bf16 a[124:127], v[128:131], v[108:111], a[124:127]
    v_exp_f32 v95, v95
    v_mfma_f32_16x16x32_bf16 a[152:155], v[132:135], v[108:111], a[152:155]
    v_add_f32 v20, v20, v92
    v_add_f32 v21, v21, v93
    v_mfma_f32_16x16x32_bf16 a[180:183], v[136:139], v[108:111], a[180:183]
    v_cvt_pk_bf16_f32 v106, v92, v93
    v_add_f32 v20, v20, v94
    v_mfma_f32_16x16x32_bf16 a[208:211], v[140:143], v[108:111], a[208:211]
    v_add_f32 v21, v21, v95
    v_cvt_pk_bf16_f32 v107, v94, v95
    s_cmp_eq_u32 s68, 0
    s_cbranch_scc0 L_bw1_3738
    s_waitcnt vmcnt(16) lgkmcnt(0)
L_bw2_3738:
    s_barrier
    v_mfma_f32_16x16x32_bf16 v[88:91], v[56:59], a[96:99], v[52:55]
    ds_read_b128 v[56:59], v8 offset:25344
    v_mfma_f32_16x16x32_bf16 v[88:91], v[60:63], a[100:103], v[88:91]
    ds_read_b128 v[60:63], v8 offset:25408
    v_exp_f32 v96, v96
    v_mfma_f32_16x16x32_bf16 v[88:91], v[64:67], a[104:107], v[88:91]
    ds_read_b128 v[64:67], v8 offset:25472
    v_exp_f32 v97, v97
    v_mfma_f32_16x16x32_bf16 v[88:91], v[68:71], a[108:111], v[88:91]
    ds_read_b128 v[68:71], v8 offset:25536
    v_exp_f32 v98, v98
    v_mfma_f32_16x16x32_bf16 v[92:95], v[84:87], a[108:111], v[52:55]
    ds_read_b128 v[84:87], v8 offset:26048
    v_exp_f32 v99, v99
    v_mfma_f32_16x16x32_bf16 v[92:95], v[80:83], a[104:107], v[92:95]
    ds_read_b128 v[80:83], v8 offset:25984
    v_add_f32 v22, v22, v96
    v_add_f32 v23, v23, v97
    v_mfma_f32_16x16x32_bf16 v[92:95], v[76:79], a[100:103], v[92:95]
    ds_read_b128 v[76:79], v8 offset:25920
    v_cvt_pk_bf16_f32 v108, v96, v97
    v_mfma_f32_16x16x32_bf16 v[92:95], v[72:75], a[96:99], v[92:95]
    ds_read_b128 v[72:75], v8 offset:25856
    v_exp_f32 v100, v100
    v_mfma_f32_16x16x32_bf16 v[160:163], v[112:115], v[104:107], v[160:163]
    v_exp_f32 v101, v101
    v_mfma_f32_16x16x32_bf16 v[188:191], v[116:119], v[104:107], v[188:191]
    v_add_f32 v22, v22, v98
    v_add_f32 v23, v23, v99
    v_mfma_f32_16x16x32_bf16 v[216:219], v[120:123], v[104:107], v[216:219]
    v_cvt_pk_bf16_f32 v109, v98, v99
    v_mfma_f32_16x16x32_bf16 v[244:247], v[124:127], v[104:107], v[244:247]
    v_exp_f32 v102, v102
    v_mfma_f32_16x16x32_bf16 a[128:131], v[128:131], v[104:107], a[128:131]
    v_exp_f32 v103, v103
    v_mfma_f32_16x16x32_bf16 a[156:159], v[132:135], v[104:107], a[156:159]
    v_add_f32 v22, v22, v100
    v_add_f32 v23, v23, v101
    v_mfma_f32_16x16x32_bf16 a[184:187], v[136:139], v[104:107], a[184:187]
    v_cvt_pk_bf16_f32 v110, v100, v101
    v_add_f32 v22, v22, v102
    v_mfma_f32_16x16x32_bf16 a[212:215], v[140:143], v[104:107], a[212:215]
    v_add_f32 v23, v23, v103
    v_cvt_pk_bf16_f32 v111, v102, v103
    s_waitcnt lgkmcnt(0)
    v_mfma_f32_16x16x32_bf16 v[96:99], v[56:59], a[0:3], v[28:31]
    v_mfma_f32_16x16x32_bf16 v[96:99], v[60:63], a[4:7], v[96:99]
    v_exp_f32 v88, v88
    v_mfma_f32_16x16x32_bf16 v[96:99], v[64:67], a[8:11], v[96:99]
    v_exp_f32 v89, v89
    v_mfma_f32_16x16x32_bf16 v[96:99], v[68:71], a[12:15], v[96:99]
    v_exp_f32 v90, v90
    v_mfma_f32_16x16x32_bf16 v[100:103], v[84:87], a[12:15], v[28:31]
    v_exp_f32 v91, v91
    v_mfma_f32_16x16x32_bf16 v[100:103], v[80:83], a[8:11], v[100:103]
    v_add_f32 v24, v24, v88
    v_add_f32 v25, v25, v89
    v_mfma_f32_16x16x32_bf16 v[100:103], v[76:79], a[4:7], v[100:103]
    v_cvt_pk_bf16_f32 v104, v88, v89
    v_mfma_f32_16x16x32_bf16 v[100:103], v[72:75], a[0:3], v[100:103]
    v_exp_f32 v92, v92
    v_mfma_f32_16x16x32_bf16 v[164:167], v[112:115], v[108:111], v[164:167]
    v_exp_f32 v93, v93
    v_mfma_f32_16x16x32_bf16 v[192:195], v[116:119], v[108:111], v[192:195]
    v_add_f32 v24, v24, v90
    v_add_f32 v25, v25, v91
    v_mfma_f32_16x16x32_bf16 v[220:223], v[120:123], v[108:111], v[220:223]
    v_cvt_pk_bf16_f32 v105, v90, v91
    v_mfma_f32_16x16x32_bf16 v[248:251], v[124:127], v[108:111], v[248:251]
    v_exp_f32 v94, v94
    v_mfma_f32_16x16x32_bf16 a[132:135], v[128:131], v[108:111], a[132:135]
    v_exp_f32 v95, v95
    v_mfma_f32_16x16x32_bf16 a[160:163], v[132:135], v[108:111], a[160:163]
    v_add_f32 v24, v24, v92
    v_add_f32 v25, v25, v93
    v_mfma_f32_16x16x32_bf16 a[188:191], v[136:139], v[108:111], a[188:191]
    v_cvt_pk_bf16_f32 v106, v92, v93
    v_add_f32 v24, v24, v94
    v_mfma_f32_16x16x32_bf16 a[216:219], v[140:143], v[108:111], a[216:219]
    v_add_f32 v25, v25, v95
    v_cvt_pk_bf16_f32 v107, v94, v95
    v_mfma_f32_16x16x32_bf16 v[88:91], v[56:59], a[16:19], v[32:35]
    v_mfma_f32_16x16x32_bf16 v[88:91], v[60:63], a[20:23], v[88:91]
    v_exp_f32 v96, v96
    v_mfma_f32_16x16x32_bf16 v[88:91], v[64:67], a[24:27], v[88:91]
    v_exp_f32 v97, v97
    v_mfma_f32_16x16x32_bf16 v[88:91], v[68:71], a[28:31], v[88:91]
    v_exp_f32 v98, v98
    v_mfma_f32_16x16x32_bf16 v[92:95], v[84:87], a[28:31], v[32:35]
    v_exp_f32 v99, v99
    v_mfma_f32_16x16x32_bf16 v[92:95], v[80:83], a[24:27], v[92:95]
    v_add_f32 v12, v12, v96
    v_add_f32 v13, v13, v97
    v_mfma_f32_16x16x32_bf16 v[92:95], v[76:79], a[20:23], v[92:95]
    v_cvt_pk_bf16_f32 v108, v96, v97
    v_mfma_f32_16x16x32_bf16 v[92:95], v[72:75], a[16:19], v[92:95]
    v_exp_f32 v100, v100
    v_mfma_f32_16x16x32_bf16 v[168:171], v[112:115], v[104:107], v[168:171]
    ds_read_b64_tr_b16 v[112:113], v9 offset:25344
    ds_read_b64_tr_b16 v[114:115], v9 offset:25856
    v_exp_f32 v101, v101
    v_mfma_f32_16x16x32_bf16 v[196:199], v[116:119], v[104:107], v[196:199]
    ds_read_b64_tr_b16 v[116:117], v9 offset:25376
    ds_read_b64_tr_b16 v[118:119], v9 offset:25888
    v_add_f32 v12, v12, v98
    v_add_f32 v13, v13, v99
    v_mfma_f32_16x16x32_bf16 v[224:227], v[120:123], v[104:107], v[224:227]
    ds_read_b64_tr_b16 v[120:121], v9 offset:25408
    ds_read_b64_tr_b16 v[122:123], v9 offset:25920
    v_cvt_pk_bf16_f32 v109, v98, v99
    v_mfma_f32_16x16x32_bf16 v[252:255], v[124:127], v[104:107], v[252:255]
    ds_read_b64_tr_b16 v[124:125], v9 offset:25440
    ds_read_b64_tr_b16 v[126:127], v9 offset:25952
    v_exp_f32 v102, v102
    v_mfma_f32_16x16x32_bf16 a[136:139], v[128:131], v[104:107], a[136:139]
    ds_read_b64_tr_b16 v[128:129], v9 offset:25472
    ds_read_b64_tr_b16 v[130:131], v9 offset:25984
    v_exp_f32 v103, v103
    v_mfma_f32_16x16x32_bf16 a[164:167], v[132:135], v[104:107], a[164:167]
    ds_read_b64_tr_b16 v[132:133], v9 offset:25504
    ds_read_b64_tr_b16 v[134:135], v9 offset:26016
    v_add_f32 v12, v12, v100
    v_add_f32 v13, v13, v101
    v_mfma_f32_16x16x32_bf16 a[192:195], v[136:139], v[104:107], a[192:195]
    ds_read_b64_tr_b16 v[136:137], v9 offset:25536
    ds_read_b64_tr_b16 v[138:139], v9 offset:26048
    v_cvt_pk_bf16_f32 v110, v100, v101
    v_add_f32 v12, v12, v102
    v_mfma_f32_16x16x32_bf16 a[220:223], v[140:143], v[104:107], a[220:223]
    ds_read_b64_tr_b16 v[140:141], v9 offset:25568
    ds_read_b64_tr_b16 v[142:143], v9 offset:26080
    v_add_f32 v13, v13, v103
    v_cvt_pk_bf16_f32 v111, v102, v103
    v_mfma_f32_16x16x32_bf16 v[96:99], v[56:59], a[32:35], v[36:39]
    v_mfma_f32_16x16x32_bf16 v[96:99], v[60:63], a[36:39], v[96:99]
    s_add_u32 s29, s34, s100
    v_exp_f32 v88, v88
    v_mfma_f32_16x16x32_bf16 v[96:99], v[64:67], a[40:43], v[96:99]
    v_exp_f32 v89, v89
    v_mfma_f32_16x16x32_bf16 v[96:99], v[68:71], a[44:47], v[96:99]
    s_bfe_u32 s28, s29, 0x20003
    v_exp_f32 v90, v90
    v_mfma_f32_16x16x32_bf16 v[100:103], v[84:87], a[44:47], v[36:39]
    v_exp_f32 v91, v91
    v_mfma_f32_16x16x32_bf16 v[100:103], v[80:83], a[40:43], v[100:103]
    s_lshl_b32 s28, s28, 16
    v_add_f32 v14, v14, v88
    v_add_f32 v15, v15, v89
    v_mfma_f32_16x16x32_bf16 v[100:103], v[76:79], a[36:39], v[100:103]
    v_cvt_pk_bf16_f32 v104, v88, v89
    v_mfma_f32_16x16x32_bf16 v[100:103], v[72:75], a[32:35], v[100:103]
    v_exp_f32 v92, v92
    s_waitcnt lgkmcnt(0)
    v_mfma_f32_16x16x32_bf16 v[144:147], v[112:115], v[108:111], v[144:147]
    s_and_b32 s29, s29, 7
    v_exp_f32 v93, v93
    v_mfma_f32_16x16x32_bf16 v[172:175], v[116:119], v[108:111], v[172:175]
    v_add_f32 v14, v14, v90
    v_add_f32 v15, v15, v91
    v_mfma_f32_16x16x32_bf16 v[200:203], v[120:123], v[108:111], v[200:203]
    s_lshl_b32 s29, s29, 11
    v_cvt_pk_bf16_f32 v105, v90, v91
    v_mfma_f32_16x16x32_bf16 v[228:231], v[124:127], v[108:111], v[228:231]
    v_exp_f32 v94, v94
    v_mfma_f32_16x16x32_bf16 a[112:115], v[128:131], v[108:111], a[112:115]
    s_add_u32 s29, s28, s29
    v_exp_f32 v95, v95
    v_mfma_f32_16x16x32_bf16 a[140:143], v[132:135], v[108:111], a[140:143]
    v_add_f32 v14, v14, v92
    v_add_f32 v15, v15, v93
    v_mfma_f32_16x16x32_bf16 a[168:171], v[136:139], v[108:111], a[168:171]
    s_lshr_b32 s28, s34, 5
    v_cvt_pk_bf16_f32 v106, v92, v93
    v_add_f32 v14, v14, v94
    v_mfma_f32_16x16x32_bf16 a[196:199], v[140:143], v[108:111], a[196:199]
    v_add_f32 v15, v15, v95
    v_cvt_pk_bf16_f32 v107, v94, v95
    v_mfma_f32_16x16x32_bf16 v[88:91], v[56:59], a[48:51], v[40:43]
    v_mfma_f32_16x16x32_bf16 v[88:91], v[60:63], a[52:55], v[88:91]
    s_lshl_b32 s28, s28, 19
    v_exp_f32 v96, v96
    v_mfma_f32_16x16x32_bf16 v[88:91], v[64:67], a[56:59], v[88:91]
    v_exp_f32 v97, v97
    v_mfma_f32_16x16x32_bf16 v[88:91], v[68:71], a[60:63], v[88:91]
    s_add_u32 s49, s28, s29
    v_exp_f32 v98, v98
    v_mfma_f32_16x16x32_bf16 v[92:95], v[84:87], a[60:63], v[40:43]
    v_exp_f32 v99, v99
    v_mfma_f32_16x16x32_bf16 v[92:95], v[80:83], a[56:59], v[92:95]
    s_add_u32 m0, s33, 16896
    v_add_f32 v16, v16, v96
    v_add_f32 v17, v17, v97
    v_mfma_f32_16x16x32_bf16 v[92:95], v[76:79], a[52:55], v[92:95]
    v_cvt_pk_bf16_f32 v108, v96, v97
    v_mfma_f32_16x16x32_bf16 v[92:95], v[72:75], a[48:51], v[92:95]
    v_exp_f32 v100, v100
    v_mfma_f32_16x16x32_bf16 v[148:151], v[112:115], v[104:107], v[148:151]
    s_add_u32 s34, s34, 1
    v_exp_f32 v101, v101
    v_mfma_f32_16x16x32_bf16 v[176:179], v[116:119], v[104:107], v[176:179]
    v_add_f32 v16, v16, v98
    v_add_f32 v17, v17, v99
    v_mfma_f32_16x16x32_bf16 v[204:207], v[120:123], v[104:107], v[204:207]
    buffer_load_dwordx4 v7, s[4:7], s49 offen offset:0 nt lds
    v_cvt_pk_bf16_f32 v109, v98, v99
    v_mfma_f32_16x16x32_bf16 v[232:235], v[124:127], v[104:107], v[232:235]
    v_exp_f32 v102, v102
    v_mfma_f32_16x16x32_bf16 a[116:119], v[128:131], v[104:107], a[116:119]
    s_add_u32 m0, m0, s96
    v_exp_f32 v103, v103
    v_mfma_f32_16x16x32_bf16 a[144:147], v[132:135], v[104:107], a[144:147]
    v_add_f32 v16, v16, v100
    v_add_f32 v17, v17, v101
    v_mfma_f32_16x16x32_bf16 a[172:175], v[136:139], v[104:107], a[172:175]
    buffer_load_dwordx4 v7, s[4:7], s49 offen offset:256 nt lds
    v_cvt_pk_bf16_f32 v110, v100, v101
    v_add_f32 v16, v16, v102
    v_mfma_f32_16x16x32_bf16 a[200:203], v[140:143], v[104:107], a[200:203]
    v_add_f32 v17, v17, v103
    v_cvt_pk_bf16_f32 v111, v102, v103
    v_mfma_f32_16x16x32_bf16 v[96:99], v[56:59], a[64:67], v[44:47]
    v_mfma_f32_16x16x32_bf16 v[96:99], v[60:63], a[68:71], v[96:99]
    s_add_u32 m0, m0, s97
    v_exp_f32 v88, v88
    v_mfma_f32_16x16x32_bf16 v[96:99], v[64:67], a[72:75], v[96:99]
    v_exp_f32 v89, v89
    v_mfma_f32_16x16x32_bf16 v[96:99], v[68:71], a[76:79], v[96:99]
    buffer_load_dwordx4 v7, s[4:7], s49 offen offset:512 nt lds
    v_exp_f32 v90, v90
    v_mfma_f32_16x16x32_bf16 v[100:103], v[84:87], a[76:79], v[44:47]
    v_exp_f32 v91, v91
    v_mfma_f32_16x16x32_bf16 v[100:103], v[80:83], a[72:75], v[100:103]
    s_add_u32 m0, m0, s96
    v_add_f32 v18, v18, v88
    v_add_f32 v19, v19, v89
    v_mfma_f32_16x16x32_bf16 v[100:103], v[76:79], a[68:71], v[100:103]
    v_cvt_pk_bf16_f32 v104, v88, v89
    v_mfma_f32_16x16x32_bf16 v[100:103], v[72:75], a[64:67], v[100:103]
    v_exp_f32 v92, v92
    v_mfma_f32_16x16x32_bf16 v[152:155], v[112:115], v[108:111], v[152:155]
    buffer_load_dwordx4 v7, s[4:7], s49 offen offset:768 nt lds
    v_exp_f32 v93, v93
    v_mfma_f32_16x16x32_bf16 v[180:183], v[116:119], v[108:111], v[180:183]
    v_add_f32 v18, v18, v90
    v_add_f32 v19, v19, v91
    v_mfma_f32_16x16x32_bf16 v[208:211], v[120:123], v[108:111], v[208:211]
    s_add_u32 m0, m0, s97
    v_cvt_pk_bf16_f32 v105, v90, v91
    v_mfma_f32_16x16x32_bf16 v[236:239], v[124:127], v[108:111], v[236:239]
    v_exp_f32 v94, v94
    v_mfma_f32_16x16x32_bf16 a[120:123], v[128:131], v[108:111], a[120:123]
    buffer_load_dwordx4 v7, s[4:7], s49 offen offset:1024 nt lds
    v_exp_f32 v95, v95
    v_mfma_f32_16x16x32_bf16 a[148:151], v[132:135], v[108:111], a[148:151]
    v_add_f32 v18, v18, v92
    v_add_f32 v19, v19, v93
    v_mfma_f32_16x16x32_bf16 a[176:179], v[136:139], v[108:111], a[176:179]
    s_add_u32 m0, m0, s96
    v_cvt_pk_bf16_f32 v106, v92, v93
    v_add_f32 v18, v18, v94
    v_mfma_f32_16x16x32_bf16 a[204:207], v[140:143], v[108:111], a[204:207]
    v_add_f32 v19, v19, v95
    v_cvt_pk_bf16_f32 v107, v94, v95
    v_mfma_f32_16x16x32_bf16 v[88:91], v[56:59], a[80:83], v[48:51]
    v_mfma_f32_16x16x32_bf16 v[88:91], v[60:63], a[84:87], v[88:91]
    buffer_load_dwordx4 v7, s[4:7], s49 offen offset:1280 nt lds
    v_exp_f32 v96, v96
    v_mfma_f32_16x16x32_bf16 v[88:91], v[64:67], a[88:91], v[88:91]
    v_exp_f32 v97, v97
    v_mfma_f32_16x16x32_bf16 v[88:91], v[68:71], a[92:95], v[88:91]
    s_add_u32 m0, m0, s97
    v_exp_f32 v98, v98
    v_mfma_f32_16x16x32_bf16 v[92:95], v[84:87], a[92:95], v[48:51]
    v_exp_f32 v99, v99
    v_mfma_f32_16x16x32_bf16 v[92:95], v[80:83], a[88:91], v[92:95]
    buffer_load_dwordx4 v7, s[4:7], s49 offen offset:1536 nt lds
    v_add_f32 v20, v20, v96
    v_add_f32 v21, v21, v97
    v_mfma_f32_16x16x32_bf16 v[92:95], v[76:79], a[84:87], v[92:95]
    v_cvt_pk_bf16_f32 v108, v96, v97
    v_mfma_f32_16x16x32_bf16 v[92:95], v[72:75], a[80:83], v[92:95]
    v_exp_f32 v100, v100
    v_mfma_f32_16x16x32_bf16 v[156:159], v[112:115], v[104:107], v[156:159]
    s_add_u32 m0, m0, s96
    v_exp_f32 v101, v101
    v_mfma_f32_16x16x32_bf16 v[184:187], v[116:119], v[104:107], v[184:187]
    v_add_f32 v20, v20, v98
    v_add_f32 v21, v21, v99
    v_mfma_f32_16x16x32_bf16 v[212:215], v[120:123], v[104:107], v[212:215]
    buffer_load_dwordx4 v7, s[4:7], s49 offen offset:1792 nt lds
    v_cvt_pk_bf16_f32 v109, v98, v99
    v_mfma_f32_16x16x32_bf16 v[240:243], v[124:127], v[104:107], v[240:243]
    v_exp_f32 v102, v102
    v_mfma_f32_16x16x32_bf16 a[124:127], v[128:131], v[104:107], a[124:127]
    v_exp_f32 v103, v103
    v_mfma_f32_16x16x32_bf16 a[152:155], v[132:135], v[104:107], a[152:155]
    v_add_f32 v20, v20, v100
    v_add_f32 v21, v21, v101
    v_mfma_f32_16x16x32_bf16 a[180:183], v[136:139], v[104:107], a[180:183]
    v_cvt_pk_bf16_f32 v110, v100, v101
    v_add_f32 v20, v20, v102
    v_mfma_f32_16x16x32_bf16 a[208:211], v[140:143], v[104:107], a[208:211]
    v_add_f32 v21, v21, v103
    v_cvt_pk_bf16_f32 v111, v102, v103
    s_waitcnt vmcnt(16) lgkmcnt(0)
    s_barrier
    v_mfma_f32_16x16x32_bf16 v[96:99], v[56:59], a[96:99], v[52:55]
    ds_read_b128 v[56:59], v8 offset:0
    v_mfma_f32_16x16x32_bf16 v[96:99], v[60:63], a[100:103], v[96:99]
    ds_read_b128 v[60:63], v8 offset:64
    v_exp_f32 v88, v88
    v_mfma_f32_16x16x32_bf16 v[96:99], v[64:67], a[104:107], v[96:99]
    ds_read_b128 v[64:67], v8 offset:128
    v_exp_f32 v89, v89
    v_mfma_f32_16x16x32_bf16 v[96:99], v[68:71], a[108:111], v[96:99]
    ds_read_b128 v[68:71], v8 offset:192
    v_exp_f32 v90, v90
    v_mfma_f32_16x16x32_bf16 v[100:103], v[84:87], a[108:111], v[52:55]
    ds_read_b128 v[84:87], v8 offset:704
    v_exp_f32 v91, v91
    v_mfma_f32_16x16x32_bf16 v[100:103], v[80:83], a[104:107], v[100:103]
    ds_read_b128 v[80:83], v8 offset:640
    v_add_f32 v22, v22, v88
    v_add_f32 v23, v23, v89
    v_mfma_f32_16x16x32_bf16 v[100:103], v[76:79], a[100:103], v[100:103]
    ds_read_b128 v[76:79], v8 offset:576
    v_cvt_pk_bf16_f32 v104, v88, v89
    v_mfma_f32_16x16x32_bf16 v[100:103], v[72:75], a[96:99], v[100:103]
    ds_read_b128 v[72:75], v8 offset:512
    v_exp_f32 v92, v92
    v_mfma_f32_16x16x32_bf16 v[160:163], v[112:115], v[108:111], v[160:163]
    v_exp_f32 v93, v93
    v_mfma_f32_16x16x32_bf16 v[188:191], v[116:119], v[108:111], v[188:191]
    v_add_f32 v22, v22, v90
    v_add_f32 v23, v23, v91
    v_mfma_f32_16x16x32_bf16 v[216:219], v[120:123], v[108:111], v[216:219]
    v_cvt_pk_bf16_f32 v105, v90, v91
    v_mfma_f32_16x16x32_bf16 v[244:247], v[124:127], v[108:111], v[244:247]
    v_exp_f32 v94, v94
    v_mfma_f32_16x16x32_bf16 a[128:131], v[128:131], v[108:111], a[128:131]
    v_exp_f32 v95, v95
    v_mfma_f32_16x16x32_bf16 a[156:159], v[132:135], v[108:111], a[156:159]
    v_add_f32 v22, v22, v92
    v_add_f32 v23, v23, v93
    v_mfma_f32_16x16x32_bf16 a[184:187], v[136:139], v[108:111], a[184:187]
    v_cvt_pk_bf16_f32 v106, v92, v93
    v_add_f32 v22, v22, v94
    v_mfma_f32_16x16x32_bf16 a[212:215], v[140:143], v[108:111], a[212:215]
    v_add_f32 v23, v23, v95
    v_cvt_pk_bf16_f32 v107, v94, v95
    s_waitcnt lgkmcnt(0)
    v_mfma_f32_16x16x32_bf16 v[88:91], v[56:59], a[0:3], v[28:31]
    v_mfma_f32_16x16x32_bf16 v[88:91], v[60:63], a[4:7], v[88:91]
    v_exp_f32 v96, v96
    v_mfma_f32_16x16x32_bf16 v[88:91], v[64:67], a[8:11], v[88:91]
    v_exp_f32 v97, v97
    v_mfma_f32_16x16x32_bf16 v[88:91], v[68:71], a[12:15], v[88:91]
    v_exp_f32 v98, v98
    v_mfma_f32_16x16x32_bf16 v[92:95], v[84:87], a[12:15], v[28:31]
    v_exp_f32 v99, v99
    v_mfma_f32_16x16x32_bf16 v[92:95], v[80:83], a[8:11], v[92:95]
    v_add_f32 v24, v24, v96
    v_add_f32 v25, v25, v97
    v_mfma_f32_16x16x32_bf16 v[92:95], v[76:79], a[4:7], v[92:95]
    v_cvt_pk_bf16_f32 v108, v96, v97
    v_mfma_f32_16x16x32_bf16 v[92:95], v[72:75], a[0:3], v[92:95]
    v_exp_f32 v100, v100
    v_mfma_f32_16x16x32_bf16 v[164:167], v[112:115], v[104:107], v[164:167]
    v_exp_f32 v101, v101
    v_mfma_f32_16x16x32_bf16 v[192:195], v[116:119], v[104:107], v[192:195]
    v_add_f32 v24, v24, v98
    v_add_f32 v25, v25, v99
    v_mfma_f32_16x16x32_bf16 v[220:223], v[120:123], v[104:107], v[220:223]
    v_cvt_pk_bf16_f32 v109, v98, v99
    v_mfma_f32_16x16x32_bf16 v[248:251], v[124:127], v[104:107], v[248:251]
    v_exp_f32 v102, v102
    v_mfma_f32_16x16x32_bf16 a[132:135], v[128:131], v[104:107], a[132:135]
    v_exp_f32 v103, v103
    v_mfma_f32_16x16x32_bf16 a[160:163], v[132:135], v[104:107], a[160:163]
    v_add_f32 v24, v24, v100
    v_add_f32 v25, v25, v101
    v_mfma_f32_16x16x32_bf16 a[188:191], v[136:139], v[104:107], a[188:191]
    v_cvt_pk_bf16_f32 v110, v100, v101
    v_add_f32 v24, v24, v102
    v_mfma_f32_16x16x32_bf16 a[216:219], v[140:143], v[104:107], a[216:219]
    v_add_f32 v25, v25, v103
    v_cvt_pk_bf16_f32 v111, v102, v103
    v_mfma_f32_16x16x32_bf16 v[96:99], v[56:59], a[16:19], v[32:35]
    v_mfma_f32_16x16x32_bf16 v[96:99], v[60:63], a[20:23], v[96:99]
    v_exp_f32 v88, v88
    v_mfma_f32_16x16x32_bf16 v[96:99], v[64:67], a[24:27], v[96:99]
    v_exp_f32 v89, v89
    v_mfma_f32_16x16x32_bf16 v[96:99], v[68:71], a[28:31], v[96:99]
    v_exp_f32 v90, v90
    v_mfma_f32_16x16x32_bf16 v[100:103], v[84:87], a[28:31], v[32:35]
    v_exp_f32 v91, v91
    v_mfma_f32_16x16x32_bf16 v[100:103], v[80:83], a[24:27], v[100:103]
    v_add_f32 v12, v12, v88
    v_add_f32 v13, v13, v89
    v_mfma_f32_16x16x32_bf16 v[100:103], v[76:79], a[20:23], v[100:103]
    v_cvt_pk_bf16_f32 v104, v88, v89
    v_mfma_f32_16x16x32_bf16 v[100:103], v[72:75], a[16:19], v[100:103]
    v_exp_f32 v92, v92
    v_mfma_f32_16x16x32_bf16 v[168:171], v[112:115], v[108:111], v[168:171]
    ds_read_b64_tr_b16 v[112:113], v9 offset:0
    ds_read_b64_tr_b16 v[114:115], v9 offset:512
    v_exp_f32 v93, v93
    v_mfma_f32_16x16x32_bf16 v[196:199], v[116:119], v[108:111], v[196:199]
    ds_read_b64_tr_b16 v[116:117], v9 offset:32
    ds_read_b64_tr_b16 v[118:119], v9 offset:544
    v_add_f32 v12, v12, v90
    v_add_f32 v13, v13, v91
    v_mfma_f32_16x16x32_bf16 v[224:227], v[120:123], v[108:111], v[224:227]
    ds_read_b64_tr_b16 v[120:121], v9 offset:64
    ds_read_b64_tr_b16 v[122:123], v9 offset:576
    v_cvt_pk_bf16_f32 v105, v90, v91
    v_mfma_f32_16x16x32_bf16 v[252:255], v[124:127], v[108:111], v[252:255]
    ds_read_b64_tr_b16 v[124:125], v9 offset:96
    ds_read_b64_tr_b16 v[126:127], v9 offset:608
    v_exp_f32 v94, v94
    v_mfma_f32_16x16x32_bf16 a[136:139], v[128:131], v[108:111], a[136:139]
    ds_read_b64_tr_b16 v[128:129], v9 offset:128
    ds_read_b64_tr_b16 v[130:131], v9 offset:640
    v_exp_f32 v95, v95
    v_mfma_f32_16x16x32_bf16 a[164:167], v[132:135], v[108:111], a[164:167]
    ds_read_b64_tr_b16 v[132:133], v9 offset:160
    ds_read_b64_tr_b16 v[134:135], v9 offset:672
    v_add_f32 v12, v12, v92
    v_add_f32 v13, v13, v93
    v_mfma_f32_16x16x32_bf16 a[192:195], v[136:139], v[108:111], a[192:195]
    ds_read_b64_tr_b16 v[136:137], v9 offset:192
    ds_read_b64_tr_b16 v[138:139], v9 offset:704
    v_cvt_pk_bf16_f32 v106, v92, v93
    v_add_f32 v12, v12, v94
    v_mfma_f32_16x16x32_bf16 a[220:223], v[140:143], v[108:111], a[220:223]
    ds_read_b64_tr_b16 v[140:141], v9 offset:224
    ds_read_b64_tr_b16 v[142:143], v9 offset:736
    v_add_f32 v13, v13, v95
    v_cvt_pk_bf16_f32 v107, v94, v95
    v_mfma_f32_16x16x32_bf16 v[88:91], v[56:59], a[32:35], v[36:39]
    v_mfma_f32_16x16x32_bf16 v[88:91], v[60:63], a[36:39], v[88:91]
    s_add_u32 s29, s34, s100
    v_exp_f32 v96, v96
    v_mfma_f32_16x16x32_bf16 v[88:91], v[64:67], a[40:43], v[88:91]
    v_exp_f32 v97, v97
    v_mfma_f32_16x16x32_bf16 v[88:91], v[68:71], a[44:47], v[88:91]
    s_bfe_u32 s28, s29, 0x20003
    v_exp_f32 v98, v98
    v_mfma_f32_16x16x32_bf16 v[92:95], v[84:87], a[44:47], v[36:39]
    v_exp_f32 v99, v99
    v_mfma_f32_16x16x32_bf16 v[92:95], v[80:83], a[40:43], v[92:95]
    s_lshl_b32 s28, s28, 16
    v_add_f32 v14, v14, v96
    v_add_f32 v15, v15, v97
    v_mfma_f32_16x16x32_bf16 v[92:95], v[76:79], a[36:39], v[92:95]
    v_cvt_pk_bf16_f32 v108, v96, v97
    v_mfma_f32_16x16x32_bf16 v[92:95], v[72:75], a[32:35], v[92:95]
    v_exp_f32 v100, v100
    s_waitcnt lgkmcnt(0)
    v_mfma_f32_16x16x32_bf16 v[144:147], v[112:115], v[104:107], v[144:147]
    s_and_b32 s29, s29, 7
    v_exp_f32 v101, v101
    v_mfma_f32_16x16x32_bf16 v[172:175], v[116:119], v[104:107], v[172:175]
    v_add_f32 v14, v14, v98
    v_add_f32 v15, v15, v99
    v_mfma_f32_16x16x32_bf16 v[200:203], v[120:123], v[104:107], v[200:203]
    s_lshl_b32 s29, s29, 11
    v_cvt_pk_bf16_f32 v109, v98, v99
    v_mfma_f32_16x16x32_bf16 v[228:231], v[124:127], v[104:107], v[228:231]
    v_exp_f32 v102, v102
    v_mfma_f32_16x16x32_bf16 a[112:115], v[128:131], v[104:107], a[112:115]
    s_add_u32 s29, s28, s29
    v_exp_f32 v103, v103
    v_mfma_f32_16x16x32_bf16 a[140:143], v[132:135], v[104:107], a[140:143]
    v_add_f32 v14, v14, v100
    v_add_f32 v15, v15, v101
    v_mfma_f32_16x16x32_bf16 a[168:171], v[136:139], v[104:107], a[168:171]
    s_lshr_b32 s28, s34, 5
    v_cvt_pk_bf16_f32 v110, v100, v101
    v_add_f32 v14, v14, v102
    v_mfma_f32_16x16x32_bf16 a[196:199], v[140:143], v[104:107], a[196:199]
    v_add_f32 v15, v15, v103
    v_cvt_pk_bf16_f32 v111, v102, v103
    v_mfma_f32_16x16x32_bf16 v[96:99], v[56:59], a[48:51], v[40:43]
    v_mfma_f32_16x16x32_bf16 v[96:99], v[60:63], a[52:55], v[96:99]
    s_lshl_b32 s28, s28, 19
    v_exp_f32 v88, v88
    v_mfma_f32_16x16x32_bf16 v[96:99], v[64:67], a[56:59], v[96:99]
    v_exp_f32 v89, v89
    v_mfma_f32_16x16x32_bf16 v[96:99], v[68:71], a[60:63], v[96:99]
    s_add_u32 s49, s28, s29
    v_exp_f32 v90, v90
    v_mfma_f32_16x16x32_bf16 v[100:103], v[84:87], a[60:63], v[40:43]
    v_exp_f32 v91, v91
    v_mfma_f32_16x16x32_bf16 v[100:103], v[80:83], a[56:59], v[100:103]
    s_add_u32 m0, s33, 25344
    v_add_f32 v16, v16, v88
    v_add_f32 v17, v17, v89
    v_mfma_f32_16x16x32_bf16 v[100:103], v[76:79], a[52:55], v[100:103]
    v_cvt_pk_bf16_f32 v104, v88, v89
    v_mfma_f32_16x16x32_bf16 v[100:103], v[72:75], a[48:51], v[100:103]
    v_exp_f32 v92, v92
    v_mfma_f32_16x16x32_bf16 v[148:151], v[112:115], v[108:111], v[148:151]
    s_add_u32 s34, s34, 1
    v_exp_f32 v93, v93
    v_mfma_f32_16x16x32_bf16 v[176:179], v[116:119], v[108:111], v[176:179]
    v_add_f32 v16, v16, v90
    v_add_f32 v17, v17, v91
    v_mfma_f32_16x16x32_bf16 v[204:207], v[120:123], v[108:111], v[204:207]
    buffer_load_dwordx4 v7, s[4:7], s49 offen offset:0 nt lds
    v_cvt_pk_bf16_f32 v105, v90, v91
    v_mfma_f32_16x16x32_bf16 v[232:235], v[124:127], v[108:111], v[232:235]
    v_exp_f32 v94, v94
    v_mfma_f32_16x16x32_bf16 a[116:119], v[128:131], v[108:111], a[116:119]
    s_add_u32 m0, m0, s96
    v_exp_f32 v95, v95
    v_mfma_f32_16x16x32_bf16 a[144:147], v[132:135], v[108:111], a[144:147]
    v_add_f32 v16, v16, v92
    v_add_f32 v17, v17, v93
    v_mfma_f32_16x16x32_bf16 a[172:175], v[136:139], v[108:111], a[172:175]
    buffer_load_dwordx4 v7, s[4:7], s49 offen offset:256 nt lds
    v_cvt_pk_bf16_f32 v106, v92, v93
    v_add_f32 v16, v16, v94
    v_mfma_f32_16x16x32_bf16 a[200:203], v[140:143], v[108:111], a[200:203]
    v_add_f32 v17, v17, v95
    v_cvt_pk_bf16_f32 v107, v94, v95
    v_mfma_f32_16x16x32_bf16 v[88:91], v[56:59], a[64:67], v[44:47]
    v_mfma_f32_16x16x32_bf16 v[88:91], v[60:63], a[68:71], v[88:91]
    s_add_u32 m0, m0, s97
    v_exp_f32 v96, v96
    v_mfma_f32_16x16x32_bf16 v[88:91], v[64:67], a[72:75], v[88:91]
    v_exp_f32 v97, v97
    v_mfma_f32_16x16x32_bf16 v[88:91], v[68:71], a[76:79], v[88:91]
    buffer_load_dwordx4 v7, s[4:7], s49 offen offset:512 nt lds
    v_exp_f32 v98, v98
    v_mfma_f32_16x16x32_bf16 v[92:95], v[84:87], a[76:79], v[44:47]
    v_exp_f32 v99, v99
    v_mfma_f32_16x16x32_bf16 v[92:95], v[80:83], a[72:75], v[92:95]
    s_add_u32 m0, m0, s96
    v_add_f32 v18, v18, v96
    v_add_f32 v19, v19, v97
    v_mfma_f32_16x16x32_bf16 v[92:95], v[76:79], a[68:71], v[92:95]
    v_cvt_pk_bf16_f32 v108, v96, v97
    v_mfma_f32_16x16x32_bf16 v[92:95], v[72:75], a[64:67], v[92:95]
    v_exp_f32 v100, v100
    v_mfma_f32_16x16x32_bf16 v[152:155], v[112:115], v[104:107], v[152:155]
    buffer_load_dwordx4 v7, s[4:7], s49 offen offset:768 nt lds
    v_exp_f32 v101, v101
    v_mfma_f32_16x16x32_bf16 v[180:183], v[116:119], v[104:107], v[180:183]
    v_add_f32 v18, v18, v98
    v_add_f32 v19, v19, v99
    v_mfma_f32_16x16x32_bf16 v[208:211], v[120:123], v[104:107], v[208:211]
    s_add_u32 m0, m0, s97
    v_cvt_pk_bf16_f32 v109, v98, v99
    v_mfma_f32_16x16x32_bf16 v[236:239], v[124:127], v[104:107], v[236:239]
    v_exp_f32 v102, v102
    v_mfma_f32_16x16x32_bf16 a[120:123], v[128:131], v[104:107], a[120:123]
    buffer_load_dwordx4 v7, s[4:7], s49 offen offset:1024 nt lds
    v_exp_f32 v103, v103
    v_mfma_f32_16x16x32_bf16 a[148:151], v[132:135], v[104:107], a[148:151]
    v_add_f32 v18, v18, v100
    v_add_f32 v19, v19, v101
    v_mfma_f32_16x16x32_bf16 a[176:179], v[136:139], v[104:107], a[176:179]
    s_add_u32 m0, m0, s96
    v_cvt_pk_bf16_f32 v110, v100, v101
    v_add_f32 v18, v18, v102
    v_mfma_f32_16x16x32_bf16 a[204:207], v[140:143], v[104:107], a[204:207]
    v_add_f32 v19, v19, v103
    v_cvt_pk_bf16_f32 v111, v102, v103
    v_mfma_f32_16x16x32_bf16 v[96:99], v[56:59], a[80:83], v[48:51]
    v_mfma_f32_16x16x32_bf16 v[96:99], v[60:63], a[84:87], v[96:99]
    buffer_load_dwordx4 v7, s[4:7], s49 offen offset:1280 nt lds
    v_exp_f32 v88, v88
    v_mfma_f32_16x16x32_bf16 v[96:99], v[64:67], a[88:91], v[96:99]
    v_exp_f32 v89, v89
    v_mfma_f32_16x16x32_bf16 v[96:99], v[68:71], a[92:95], v[96:99]
    s_add_u32 m0, m0, s97
    v_exp_f32 v90, v90
    v_mfma_f32_16x16x32_bf16 v[100:103], v[84:87], a[92:95], v[48:51]
    v_exp_f32 v91, v91
    v_mfma_f32_16x16x32_bf16 v[100:103], v[80:83], a[88:91], v[100:103]
    buffer_load_dwordx4 v7, s[4:7], s49 offen offset:1536 nt lds
    v_add_f32 v20, v20, v88
    v_add_f32 v21, v21, v89
    v_mfma_f32_16x16x32_bf16 v[100:103], v[76:79], a[84:87], v[100:103]
    v_cvt_pk_bf16_f32 v104, v88, v89
    v_mfma_f32_16x16x32_bf16 v[100:103], v[72:75], a[80:83], v[100:103]
    v_exp_f32 v92, v92
    v_mfma_f32_16x16x32_bf16 v[156:159], v[112:115], v[108:111], v[156:159]
    s_add_u32 m0, m0, s96
    v_exp_f32 v93, v93
    v_mfma_f32_16x16x32_bf16 v[184:187], v[116:119], v[108:111], v[184:187]
    v_add_f32 v20, v20, v90
    v_add_f32 v21, v21, v91
    v_mfma_f32_16x16x32_bf16 v[212:215], v[120:123], v[108:111], v[212:215]
    buffer_load_dwordx4 v7, s[4:7], s49 offen offset:1792 nt lds
    v_cvt_pk_bf16_f32 v105, v90, v91
    v_mfma_f32_16x16x32_bf16 v[240:243], v[124:127], v[108:111], v[240:243]
    v_exp_f32 v94, v94
    v_mfma_f32_16x16x32_bf16 a[124:127], v[128:131], v[108:111], a[124:127]
    v_exp_f32 v95, v95
    v_mfma_f32_16x16x32_bf16 a[152:155], v[132:135], v[108:111], a[152:155]
    v_add_f32 v20, v20, v92
    v_add_f32 v21, v21, v93
    v_mfma_f32_16x16x32_bf16 a[180:183], v[136:139], v[108:111], a[180:183]
    v_cvt_pk_bf16_f32 v106, v92, v93
    v_add_f32 v20, v20, v94
    v_mfma_f32_16x16x32_bf16 a[208:211], v[140:143], v[108:111], a[208:211]
    v_add_f32 v21, v21, v95
    v_cvt_pk_bf16_f32 v107, v94, v95
    s_waitcnt vmcnt(16) lgkmcnt(0)
    s_barrier
    v_mfma_f32_16x16x32_bf16 v[88:91], v[56:59], a[96:99], v[52:55]
    ds_read_b128 v[56:59], v8 offset:8448
    v_mfma_f32_16x16x32_bf16 v[88:91], v[60:63], a[100:103], v[88:91]
    ds_read_b128 v[60:63], v8 offset:8512
    v_exp_f32 v96, v96
    v_mfma_f32_16x16x32_bf16 v[88:91], v[64:67], a[104:107], v[88:91]
    ds_read_b128 v[64:67], v8 offset:8576
    v_exp_f32 v97, v97
    v_mfma_f32_16x16x32_bf16 v[88:91], v[68:71], a[108:111], v[88:91]
    ds_read_b128 v[68:71], v8 offset:8640
    v_exp_f32 v98, v98
    v_mfma_f32_16x16x32_bf16 v[92:95], v[84:87], a[108:111], v[52:55]
    ds_read_b128 v[84:87], v8 offset:9152
    v_exp_f32 v99, v99
    v_mfma_f32_16x16x32_bf16 v[92:95], v[80:83], a[104:107], v[92:95]
    ds_read_b128 v[80:83], v8 offset:9088
    v_add_f32 v22, v22, v96
    v_add_f32 v23, v23, v97
    v_mfma_f32_16x16x32_bf16 v[92:95], v[76:79], a[100:103], v[92:95]
    ds_read_b128 v[76:79], v8 offset:9024
    v_cvt_pk_bf16_f32 v108, v96, v97
    v_mfma_f32_16x16x32_bf16 v[92:95], v[72:75], a[96:99], v[92:95]
    ds_read_b128 v[72:75], v8 offset:8960
    v_exp_f32 v100, v100
    v_mfma_f32_16x16x32_bf16 v[160:163], v[112:115], v[104:107], v[160:163]
    v_exp_f32 v101, v101
    v_mfma_f32_16x16x32_bf16 v[188:191], v[116:119], v[104:107], v[188:191]
    v_add_f32 v22, v22, v98
    v_add_f32 v23, v23, v99
    v_mfma_f32_16x16x32_bf16 v[216:219], v[120:123], v[104:107], v[216:219]
    v_cvt_pk_bf16_f32 v109, v98, v99
    v_mfma_f32_16x16x32_bf16 v[244:247], v[124:127], v[104:107], v[244:247]
    v_exp_f32 v102, v102
    v_mfma_f32_16x16x32_bf16 a[128:131], v[128:131], v[104:107], a[128:131]
    v_exp_f32 v103, v103
    v_mfma_f32_16x16x32_bf16 a[156:159], v[132:135], v[104:107], a[156:159]
    v_add_f32 v22, v22, v100
    v_add_f32 v23, v23, v101
    v_mfma_f32_16x16x32_bf16 a[184:187], v[136:139], v[104:107], a[184:187]
    v_cvt_pk_bf16_f32 v110, v100, v101
    v_add_f32 v22, v22, v102
    v_mfma_f32_16x16x32_bf16 a[212:215], v[140:143], v[104:107], a[212:215]
    v_add_f32 v23, v23, v103
    v_cvt_pk_bf16_f32 v111, v102, v103
    s_waitcnt lgkmcnt(0)
    v_mfma_f32_16x16x32_bf16 v[96:99], v[56:59], a[0:3], v[28:31]
    v_mfma_f32_16x16x32_bf16 v[96:99], v[60:63], a[4:7], v[96:99]
    v_exp_f32 v88, v88
    v_mfma_f32_16x16x32_bf16 v[96:99], v[64:67], a[8:11], v[96:99]
    v_exp_f32 v89, v89
    v_mfma_f32_16x16x32_bf16 v[96:99], v[68:71], a[12:15], v[96:99]
    v_exp_f32 v90, v90
    v_mfma_f32_16x16x32_bf16 v[100:103], v[84:87], a[12:15], v[28:31]
    v_exp_f32 v91, v91
    v_mfma_f32_16x16x32_bf16 v[100:103], v[80:83], a[8:11], v[100:103]
    v_add_f32 v24, v24, v88
    v_add_f32 v25, v25, v89
    v_mfma_f32_16x16x32_bf16 v[100:103], v[76:79], a[4:7], v[100:103]
    v_cvt_pk_bf16_f32 v104, v88, v89
    v_mfma_f32_16x16x32_bf16 v[100:103], v[72:75], a[0:3], v[100:103]
    v_exp_f32 v92, v92
    v_mfma_f32_16x16x32_bf16 v[164:167], v[112:115], v[108:111], v[164:167]
    v_exp_f32 v93, v93
    v_mfma_f32_16x16x32_bf16 v[192:195], v[116:119], v[108:111], v[192:195]
    v_add_f32 v24, v24, v90
    v_add_f32 v25, v25, v91
    v_mfma_f32_16x16x32_bf16 v[220:223], v[120:123], v[108:111], v[220:223]
    v_cvt_pk_bf16_f32 v105, v90, v91
    v_mfma_f32_16x16x32_bf16 v[248:251], v[124:127], v[108:111], v[248:251]
    v_exp_f32 v94, v94
    v_mfma_f32_16x16x32_bf16 a[132:135], v[128:131], v[108:111], a[132:135]
    v_exp_f32 v95, v95
    v_mfma_f32_16x16x32_bf16 a[160:163], v[132:135], v[108:111], a[160:163]
    v_add_f32 v24, v24, v92
    v_add_f32 v25, v25, v93
    v_mfma_f32_16x16x32_bf16 a[188:191], v[136:139], v[108:111], a[188:191]
    v_cvt_pk_bf16_f32 v106, v92, v93
    v_add_f32 v24, v24, v94
    v_mfma_f32_16x16x32_bf16 a[216:219], v[140:143], v[108:111], a[216:219]
    v_add_f32 v25, v25, v95
    v_cvt_pk_bf16_f32 v107, v94, v95
    s_add_u32 s22, s22, 1
    s_cmp_lt_u32 s22, 7
    s_cbranch_scc1 L_at_loop
    s_add_u32 s21, s21, 1
    s_mul_i32 s50, s21, s52
    s_mov_b32 s101, s21
    s_add_u32 s50, s50, s55
    s_cmp_ge_u32 s21, 2
    s_cselect_b32 s28, 0x40000000, 0
    s_add_u32 s50, s50, s28
    s_mov_b32 s82, s26
    s_mul_i32 s28, s26, s51
    s_add_u32 s50, s50, s28
    s_cmp_eq_u32 s21, 2
    s_cbranch_scc1 L_at_wt0
L_at_wt0r:
    s_cmp_lg_u32 s69, 0
    s_cbranch_scc1 L_at_atailB
    v_mfma_f32_16x16x32_bf16 v[88:91], v[56:59], a[16:19], v[32:35]
    v_mfma_f32_16x16x32_bf16 v[88:91], v[60:63], a[20:23], v[88:91]
    v_exp_f32 v96, v96
    v_mfma_f32_16x16x32_bf16 v[88:91], v[64:67], a[24:27], v[88:91]
    v_exp_f32 v97, v97
    v_mfma_f32_16x16x32_bf16 v[88:91], v[68:71], a[28:31], v[88:91]
    v_exp_f32 v98, v98
    v_mfma_f32_16x16x32_bf16 v[92:95], v[84:87], a[28:31], v[32:35]
    v_exp_f32 v99, v99
    v_mfma_f32_16x16x32_bf16 v[92:95], v[80:83], a[24:27], v[92:95]
    v_add_f32 v12, v12, v96
    v_add_f32 v13, v13, v97
    v_mfma_f32_16x16x32_bf16 v[92:95], v[76:79], a[20:23], v[92:95]
    v_cvt_pk_bf16_f32 v108, v96, v97
    v_mfma_f32_16x16x32_bf16 v[92:95], v[72:75], a[16:19], v[92:95]
    v_exp_f32 v100, v100
    v_mfma_f32_16x16x32_bf16 v[168:171], v[112:115], v[104:107], v[168:171]
    ds_read_b64_tr_b16 v[112:113], v9 offset:8448
    ds_read_b64_tr_b16 v[114:115], v9 offset:8960
    v_exp_f32 v101, v101
    v_mfma_f32_16x16x32_bf16 v[196:199], v[116:119], v[104:107], v[196:199]
    ds_read_b64_tr_b16 v[116:117], v9 offset:8480
    ds_read_b64_tr_b16 v[118:119], v9 offset:8992
    v_add_f32 v12, v12, v98
    v_add_f32 v13, v13, v99
    v_mfma_f32_16x16x32_bf16 v[224:227], v[120:123], v[104:107], v[224:227]
    ds_read_b64_tr_b16 v[120:121], v9 offset:8512
    ds_read_b64_tr_b16 v[122:123], v9 offset:9024
    v_cvt_pk_bf16_f32 v109, v98, v99
    v_mfma_f32_16x16x32_bf16 v[252:255], v[124:127], v[104:107], v[252:255]
    ds_read_b64_tr_b16 v[124:125], v9 offset:8544
    ds_read_b64_tr_b16 v[126:127], v9 offset:9056
    v_exp_f32 v102, v102
    v_mfma_f32_16x16x32_bf16 a[136:139], v[128:131], v[104:107], a[136:139]
    ds_read_b64_tr_b16 v[128:129], v9 offset:8576
    ds_read_b64_tr_b16 v[130:131], v9 offset:9088
    v_exp_f32 v103, v103
    v_mfma_f32_16x16x32_bf16 a[164:167], v[132:135], v[104:107], a[164:167]
    ds_read_b64_tr_b16 v[132:133], v9 offset:8608
    ds_read_b64_tr_b16 v[134:135], v9 offset:9120
    v_add_f32 v12, v12, v100
    v_add_f32 v13, v13, v101
    v_mfma_f32_16x16x32_bf16 a[192:195], v[136:139], v[104:107], a[192:195]
    ds_read_b64_tr_b16 v[136:137], v9 offset:8640
    ds_read_b64_tr_b16 v[138:139], v9 offset:9152
    v_cvt_pk_bf16_f32 v110, v100, v101
    v_add_f32 v12, v12, v102
    v_mfma_f32_16x16x32_bf16 a[220:223], v[140:143], v[104:107], a[220:223]
    ds_read_b64_tr_b16 v[140:141], v9 offset:8672
    ds_read_b64_tr_b16 v[142:143], v9 offset:9184
    v_add_f32 v13, v13, v103
    v_cvt_pk_bf16_f32 v111, v102, v103
    v_mfma_f32_16x16x32_bf16 v[96:99], v[56:59], a[32:35], v[36:39]
    v_mfma_f32_16x16x32_bf16 v[96:99], v[60:63], a[36:39], v[96:99]
    s_add_u32 m0, s33, 0
    v_exp_f32 v88, v88
    v_mfma_f32_16x16x32_bf16 v[96:99], v[64:67], a[40:43], v[96:99]
    v_exp_f32 v89, v89
    v_mfma_f32_16x16x32_bf16 v[96:99], v[68:71], a[44:47], v[96:99]
    s_mov_b32 s49, s50
    v_exp_f32 v90, v90
    v_mfma_f32_16x16x32_bf16 v[100:103], v[84:87], a[44:47], v[36:39]
    v_exp_f32 v91, v91
    v_mfma_f32_16x16x32_bf16 v[100:103], v[80:83], a[40:43], v[100:103]
    s_add_u32 s28, s49, s88
    v_add_f32 v14, v14, v88
    v_add_f32 v15, v15, v89
    v_mfma_f32_16x16x32_bf16 v[100:103], v[76:79], a[36:39], v[100:103]
    v_cvt_pk_bf16_f32 v104, v88, v89
    v_mfma_f32_16x16x32_bf16 v[100:103], v[72:75], a[32:35], v[100:103]
    v_exp_f32 v92, v92
    s_waitcnt lgkmcnt(0)
    v_mfma_f32_16x16x32_bf16 v[144:147], v[112:115], v[108:111], v[144:147]
    buffer_load_dwordx4 v26, s[16:19], s28 offen lds
    v_exp_f32 v93, v93
    v_mfma_f32_16x16x32_bf16 v[172:175], v[116:119], v[108:111], v[172:175]
    v_add_f32 v14, v14, v90
    v_add_f32 v15, v15, v91
    v_mfma_f32_16x16x32_bf16 v[200:203], v[120:123], v[108:111], v[200:203]
    s_add_u32 m0, m0, s53
    v_cvt_pk_bf16_f32 v105, v90, v91
    v_mfma_f32_16x16x32_bf16 v[228:231], v[124:127], v[108:111], v[228:231]
    v_exp_f32 v94, v94
    v_mfma_f32_16x16x32_bf16 a[112:115], v[128:131], v[108:111], a[112:115]
    s_add_u32 s28, s49, s89
    v_exp_f32 v95, v95
    v_mfma_f32_16x16x32_bf16 a[140:143], v[132:135], v[108:111], a[140:143]
    v_add_f32 v14, v14, v92
    v_add_f32 v15, v15, v93
    v_mfma_f32_16x16x32_bf16 a[168:171], v[136:139], v[108:111], a[168:171]
    buffer_load_dwordx4 v26, s[16:19], s28 offen lds
    v_cvt_pk_bf16_f32 v106, v92, v93
    v_add_f32 v14, v14, v94
    v_mfma_f32_16x16x32_bf16 a[196:199], v[140:143], v[108:111], a[196:199]
    v_add_f32 v15, v15, v95
    v_cvt_pk_bf16_f32 v107, v94, v95
    v_mfma_f32_16x16x32_bf16 v[88:91], v[56:59], a[48:51], v[40:43]
    v_mfma_f32_16x16x32_bf16 v[88:91], v[60:63], a[52:55], v[88:91]
    s_add_u32 m0, m0, s53
    v_exp_f32 v96, v96
    v_mfma_f32_16x16x32_bf16 v[88:91], v[64:67], a[56:59], v[88:91]
    v_exp_f32 v97, v97
    v_mfma_f32_16x16x32_bf16 v[88:91], v[68:71], a[60:63], v[88:91]
    s_add_u32 s28, s49, s90
    v_exp_f32 v98, v98
    v_mfma_f32_16x16x32_bf16 v[92:95], v[84:87], a[60:63], v[40:43]
    v_exp_f32 v99, v99
    v_mfma_f32_16x16x32_bf16 v[92:95], v[80:83], a[56:59], v[92:95]
    buffer_load_dwordx4 v26, s[16:19], s28 offen lds
    v_add_f32 v16, v16, v96
    v_add_f32 v17, v17, v97
    v_mfma_f32_16x16x32_bf16 v[92:95], v[76:79], a[52:55], v[92:95]
    v_cvt_pk_bf16_f32 v108, v96, v97
    v_mfma_f32_16x16x32_bf16 v[92:95], v[72:75], a[48:51], v[92:95]
    v_exp_f32 v100, v100
    v_mfma_f32_16x16x32_bf16 v[148:151], v[112:115], v[104:107], v[148:151]
    s_add_u32 m0, m0, s53
    v_exp_f32 v101, v101
    v_mfma_f32_16x16x32_bf16 v[176:179], v[116:119], v[104:107], v[176:179]
    v_add_f32 v16, v16, v98
    v_add_f32 v17, v17, v99
    v_mfma_f32_16x16x32_bf16 v[204:207], v[120:123], v[104:107], v[204:207]
    s_add_u32 s28, s49, s91
    v_cvt_pk_bf16_f32 v109, v98, v99
    v_mfma_f32_16x16x32_bf16 v[232:235], v[124:127], v[104:107], v[232:235]
    v_exp_f32 v102, v102
    v_mfma_f32_16x16x32_bf16 a[116:119], v[128:131], v[104:107], a[116:119]
    buffer_load_dwordx4 v26, s[16:19], s28 offen lds
    v_exp_f32 v103, v103
    v_mfma_f32_16x16x32_bf16 a[144:147], v[132:135], v[104:107], a[144:147]
    v_add_f32 v16, v16, v100
    v_add_f32 v17, v17, v101
    v_mfma_f32_16x16x32_bf16 a[172:175], v[136:139], v[104:107], a[172:175]
    s_add_u32 m0, m0, s53
    v_cvt_pk_bf16_f32 v110, v100, v101
    v_add_f32 v16, v16, v102
    v_mfma_f32_16x16x32_bf16 a[200:203], v[140:143], v[104:107], a[200:203]
    v_add_f32 v17, v17, v103
    v_cvt_pk_bf16_f32 v111, v102, v103
    v_mfma_f32_16x16x32_bf16 v[96:99], v[56:59], a[64:67], v[44:47]
    v_mfma_f32_16x16x32_bf16 v[96:99], v[60:63], a[68:71], v[96:99]
    s_add_u32 s28, s49, s92
    v_exp_f32 v88, v88
    v_mfma_f32_16x16x32_bf16 v[96:99], v[64:67], a[72:75], v[96:99]
    v_exp_f32 v89, v89
    v_mfma_f32_16x16x32_bf16 v[96:99], v[68:71], a[76:79], v[96:99]
    buffer_load_dwordx4 v26, s[16:19], s28 offen lds
    v_exp_f32 v90, v90
    v_mfma_f32_16x16x32_bf16 v[100:103], v[84:87], a[76:79], v[44:47]
    v_exp_f32 v91, v91
    v_mfma_f32_16x16x32_bf16 v[100:103], v[80:83], a[72:75], v[100:103]
    s_add_u32 m0, m0, s53
    v_add_f32 v18, v18, v88
    v_add_f32 v19, v19, v89
    v_mfma_f32_16x16x32_bf16 v[100:103], v[76:79], a[68:71], v[100:103]
    v_cvt_pk_bf16_f32 v104, v88, v89
    v_mfma_f32_16x16x32_bf16 v[100:103], v[72:75], a[64:67], v[100:103]
    v_exp_f32 v92, v92
    v_mfma_f32_16x16x32_bf16 v[152:155], v[112:115], v[108:111], v[152:155]
    s_add_u32 s28, s49, s93
    v_exp_f32 v93, v93
    v_mfma_f32_16x16x32_bf16 v[180:183], v[116:119], v[108:111], v[180:183]
    v_add_f32 v18, v18, v90
    v_add_f32 v19, v19, v91
    v_mfma_f32_16x16x32_bf16 v[208:211], v[120:123], v[108:111], v[208:211]
    buffer_load_dwordx4 v26, s[16:19], s28 offen lds
    v_cvt_pk_bf16_f32 v105, v90, v91
    v_mfma_f32_16x16x32_bf16 v[236:239], v[124:127], v[108:111], v[236:239]
    v_exp_f32 v94, v94
    v_mfma_f32_16x16x32_bf16 a[120:123], v[128:131], v[108:111], a[120:123]
    s_add_u32 m0, m0, s53
    v_exp_f32 v95, v95
    v_mfma_f32_16x16x32_bf16 a[148:151], v[132:135], v[108:111], a[148:151]
    v_add_f32 v18, v18, v92
    v_add_f32 v19, v19, v93
    v_mfma_f32_16x16x32_bf16 a[176:179], v[136:139], v[108:111], a[176:179]
    s_add_u32 s28, s49, s94
    v_cvt_pk_bf16_f32 v106, v92, v93
    v_add_f32 v18, v18, v94
    v_mfma_f32_16x16x32_bf16 a[204:207], v[140:143], v[108:111], a[204:207]
    v_add_f32 v19, v19, v95
    v_cvt_pk_bf16_f32 v107, v94, v95
    v_mfma_f32_16x16x32_bf16 v[88:91], v[56:59], a[80:83], v[48:51]
    v_mfma_f32_16x16x32_bf16 v[88:91], v[60:63], a[84:87], v[88:91]
    buffer_load_dwordx4 v26, s[16:19], s28 offen lds
    v_exp_f32 v96, v96
    v_mfma_f32_16x16x32_bf16 v[88:91], v[64:67], a[88:91], v[88:91]
    v_exp_f32 v97, v97
    v_mfma_f32_16x16x32_bf16 v[88:91], v[68:71], a[92:95], v[88:91]
    s_add_u32 m0, m0, s53
    v_exp_f32 v98, v98
    v_mfma_f32_16x16x32_bf16 v[92:95], v[84:87], a[92:95], v[48:51]
    v_exp_f32 v99, v99
    v_mfma_f32_16x16x32_bf16 v[92:95], v[80:83], a[88:91], v[92:95]
    s_add_u32 s28, s49, s95
    v_add_f32 v20, v20, v96
    v_add_f32 v21, v21, v97
    v_mfma_f32_16x16x32_bf16 v[92:95], v[76:79], a[84:87], v[92:95]
    v_cvt_pk_bf16_f32 v108, v96, v97
    v_mfma_f32_16x16x32_bf16 v[92:95], v[72:75], a[80:83], v[92:95]
    v_exp_f32 v100, v100
    v_mfma_f32_16x16x32_bf16 v[156:159], v[112:115], v[104:107], v[156:159]
    buffer_load_dwordx4 v26, s[16:19], s28 offen lds
    v_exp_f32 v101, v101
    v_mfma_f32_16x16x32_bf16 v[184:187], v[116:119], v[104:107], v[184:187]
    v_add_f32 v20, v20, v98
    v_add_f32 v21, v21, v99
    v_mfma_f32_16x16x32_bf16 v[212:215], v[120:123], v[104:107], v[212:215]
    v_cvt_pk_bf16_f32 v109, v98, v99
    v_mfma_f32_16x16x32_bf16 v[240:243], v[124:127], v[104:107], v[240:243]
    v_exp_f32 v102, v102
    v_mfma_f32_16x16x32_bf16 a[124:127], v[128:131], v[104:107], a[124:127]
    v_exp_f32 v103, v103
    v_mfma_f32_16x16x32_bf16 a[152:155], v[132:135], v[104:107], a[152:155]
    v_add_f32 v20, v20, v100
    v_add_f32 v21, v21, v101
    v_mfma_f32_16x16x32_bf16 a[180:183], v[136:139], v[104:107], a[180:183]
    v_cvt_pk_bf16_f32 v110, v100, v101
    v_add_f32 v20, v20, v102
    v_mfma_f32_16x16x32_bf16 a[208:211], v[140:143], v[104:107], a[208:211]
    v_add_f32 v21, v21, v103
    v_cvt_pk_bf16_f32 v111, v102, v103
    s_waitcnt vmcnt(16) lgkmcnt(0)
    s_barrier
    v_mfma_f32_16x16x32_bf16 v[96:99], v[56:59], a[96:99], v[52:55]
    ds_read_b128 v[56:59], v8 offset:16896
    v_mfma_f32_16x16x32_bf16 v[96:99], v[60:63], a[100:103], v[96:99]
    ds_read_b128 v[60:63], v8 offset:16960
    v_exp_f32 v88, v88
    v_mfma_f32_16x16x32_bf16 v[96:99], v[64:67], a[104:107], v[96:99]
    ds_read_b128 v[64:67], v8 offset:17024
    v_exp_f32 v89, v89
    v_mfma_f32_16x16x32_bf16 v[96:99], v[68:71], a[108:111], v[96:99]
    ds_read_b128 v[68:71], v8 offset:17088
    v_exp_f32 v90, v90
    v_mfma_f32_16x16x32_bf16 v[100:103], v[84:87], a[108:111], v[52:55]
    ds_read_b128 v[84:87], v8 offset:17600
    v_exp_f32 v91, v91
    v_mfma_f32_16x16x32_bf16 v[100:103], v[80:83], a[104:107], v[100:103]
    ds_read_b128 v[80:83], v8 offset:17536
    v_add_f32 v22, v22, v88
    v_add_f32 v23, v23, v89
    v_mfma_f32_16x16x32_bf16 v[100:103], v[76:79], a[100:103], v[100:103]
    ds_read_b128 v[76:79], v8 offset:17472
    v_cvt_pk_bf16_f32 v104, v88, v89
    v_mfma_f32_16x16x32_bf16 v[100:103], v[72:75], a[96:99], v[100:103]
    ds_read_b128 v[72:75], v8 offset:17408
    v_exp_f32 v92, v92
    v_mfma_f32_16x16x32_bf16 v[160:163], v[112:115], v[108:111], v[160:163]
    v_exp_f32 v93, v93
    v_mfma_f32_16x16x32_bf16 v[188:191], v[116:119], v[108:111], v[188:191]
    v_add_f32 v22, v22, v90
    v_add_f32 v23, v23, v91
    v_mfma_f32_16x16x32_bf16 v[216:219], v[120:123], v[108:111], v[216:219]
    v_cvt_pk_bf16_f32 v105, v90, v91
    v_mfma_f32_16x16x32_bf16 v[244:247], v[124:127], v[108:111], v[244:247]
    v_exp_f32 v94, v94
    v_mfma_f32_16x16x32_bf16 a[128:131], v[128:131], v[108:111], a[128:131]
    v_exp_f32 v95, v95
    v_mfma_f32_16x16x32_bf16 a[156:159], v[132:135], v[108:111], a[156:159]
    v_add_f32 v22, v22, v92
    v_add_f32 v23, v23, v93
    v_mfma_f32_16x16x32_bf16 a[184:187], v[136:139], v[108:111], a[184:187]
    v_cvt_pk_bf16_f32 v106, v92, v93
    v_add_f32 v22, v22, v94
    v_mfma_f32_16x16x32_bf16 a[212:215], v[140:143], v[108:111], a[212:215]
    v_add_f32 v23, v23, v95
    v_cvt_pk_bf16_f32 v107, v94, v95
    s_waitcnt lgkmcnt(0)
    v_mfma_f32_16x16x32_bf16 v[88:91], v[56:59], a[0:3], v[28:31]
    v_mfma_f32_16x16x32_bf16 v[88:91], v[60:63], a[4:7], v[88:91]
    v_exp_f32 v96, v96
    v_mfma_f32_16x16x32_bf16 v[88:91], v[64:67], a[8:11], v[88:91]
    v_exp_f32 v97, v97
    v_mfma_f32_16x16x32_bf16 v[88:91], v[68:71], a[12:15], v[88:91]
    v_exp_f32 v98, v98
    v_mfma_f32_16x16x32_bf16 v[92:95], v[84:87], a[12:15], v[28:31]
    v_exp_f32 v99, v99
    v_mfma_f32_16x16x32_bf16 v[92:95], v[80:83], a[8:11], v[92:95]
    v_add_f32 v24, v24, v96
    v_add_f32 v25, v25, v97
    v_mfma_f32_16x16x32_bf16 v[92:95], v[76:79], a[4:7], v[92:95]
    v_cvt_pk_bf16_f32 v108, v96, v97
    v_mfma_f32_16x16x32_bf16 v[92:95], v[72:75], a[0:3], v[92:95]
    v_exp_f32 v100, v100
    v_mfma_f32_16x16x32_bf16 v[164:167], v[112:115], v[104:107], v[164:167]
    v_exp_f32 v101, v101
    v_mfma_f32_16x16x32_bf16 v[192:195], v[116:119], v[104:107], v[192:195]
    v_add_f32 v24, v24, v98
    v_add_f32 v25, v25, v99
    v_mfma_f32_16x16x32_bf16 v[220:223], v[120:123], v[104:107], v[220:223]
    v_cvt_pk_bf16_f32 v109, v98, v99
    v_mfma_f32_16x16x32_bf16 v[248:251], v[124:127], v[104:107], v[248:251]
    v_exp_f32 v102, v102
    v_mfma_f32_16x16x32_bf16 a[132:135], v[128:131], v[104:107], a[132:135]
    v_exp_f32 v103, v103
    v_mfma_f32_16x16x32_bf16 a[160:163], v[132:135], v[104:107], a[160:163]
    v_add_f32 v24, v24, v100
    v_add_f32 v25, v25, v101
    v_mfma_f32_16x16x32_bf16 a[188:191], v[136:139], v[104:107], a[188:191]
    v_cvt_pk_bf16_f32 v110, v100, v101
    v_add_f32 v24, v24, v102
    v_mfma_f32_16x16x32_bf16 a[216:219], v[140:143], v[104:107], a[216:219]
    v_add_f32 v25, v25, v103
    v_cvt_pk_bf16_f32 v111, v102, v103
    v_mfma_f32_16x16x32_bf16 v[96:99], v[56:59], a[16:19], v[32:35]
    v_mfma_f32_16x16x32_bf16 v[96:99], v[60:63], a[20:23], v[96:99]
    v_exp_f32 v88, v88
    v_mfma_f32_16x16x32_bf16 v[96:99], v[64:67], a[24:27], v[96:99]
    v_exp_f32 v89, v89
    v_mfma_f32_16x16x32_bf16 v[96:99], v[68:71], a[28:31], v[96:99]
    v_exp_f32 v90, v90
    v_mfma_f32_16x16x32_bf16 v[100:103], v[84:87], a[28:31], v[32:35]
    v_exp_f32 v91, v91
    v_mfma_f32_16x16x32_bf16 v[100:103], v[80:83], a[24:27], v[100:103]
    v_add_f32 v12, v12, v88
    v_add_f32 v13, v13, v89
    v_mfma_f32_16x16x32_bf16 v[100:103], v[76:79], a[20:23], v[100:103]
    v_cvt_pk_bf16_f32 v104, v88, v89
    v_mfma_f32_16x16x32_bf16 v[100:103], v[72:75], a[16:19], v[100:103]
    v_exp_f32 v92, v92
    v_mfma_f32_16x16x32_bf16 v[168:171], v[112:115], v[108:111], v[168:171]
    ds_read_b64_tr_b16 v[112:113], v9 offset:16896
    ds_read_b64_tr_b16 v[114:115], v9 offset:17408
    v_exp_f32 v93, v93
    v_mfma_f32_16x16x32_bf16 v[196:199], v[116:119], v[108:111], v[196:199]
    ds_read_b64_tr_b16 v[116:117], v9 offset:16928
    ds_read_b64_tr_b16 v[118:119], v9 offset:17440
    v_add_f32 v12, v12, v90
    v_add_f32 v13, v13, v91
    v_mfma_f32_16x16x32_bf16 v[224:227], v[120:123], v[108:111], v[224:227]
    ds_read_b64_tr_b16 v[120:121], v9 offset:16960
    ds_read_b64_tr_b16 v[122:123], v9 offset:17472
    v_cvt_pk_bf16_f32 v105, v90, v91
    v_mfma_f32_16x16x32_bf16 v[252:255], v[124:127], v[108:111], v[252:255]
    ds_read_b64_tr_b16 v[124:125], v9 offset:16992
    ds_read_b64_tr_b16 v[126:127], v9 offset:17504
    v_exp_f32 v94, v94
    v_mfma_f32_16x16x32_bf16 a[136:139], v[128:131], v[108:111], a[136:139]
    ds_read_b64_tr_b16 v[128:129], v9 offset:17024
    ds_read_b64_tr_b16 v[130:131], v9 offset:17536
    v_exp_f32 v95, v95
    v_mfma_f32_16x16x32_bf16 a[164:167], v[132:135], v[108:111], a[164:167]
    ds_read_b64_tr_b16 v[132:133], v9 offset:17056
    ds_read_b64_tr_b16 v[134:135], v9 offset:17568
    v_add_f32 v12, v12, v92
    v_add_f32 v13, v13, v93
    v_mfma_f32_16x16x32_bf16 a[192:195], v[136:139], v[108:111], a[192:195]
    ds_read_b64_tr_b16 v[136:137], v9 offset:17088
    ds_read_b64_tr_b16 v[138:139], v9 offset:17600
    v_cvt_pk_bf16_f32 v106, v92, v93
    v_add_f32 v12, v12, v94
    v_mfma_f32_16x16x32_bf16 a[220:223], v[140:143], v[108:111], a[220:223]
    ds_read_b64_tr_b16 v[140:141], v9 offset:17120
    ds_read_b64_tr_b16 v[142:143], v9 offset:17632
    v_add_f32 v13, v13, v95
    v_cvt_pk_bf16_f32 v107, v94, v95
    v_mfma_f32_16x16x32_bf16 v[88:91], v[56:59], a[32:35], v[36:39]
    v_mfma_f32_16x16x32_bf16 v[88:91], v[60:63], a[36:39], v[88:91]
    s_add_u32 m0, s33, 8448
    v_exp_f32 v96, v96
    v_mfma_f32_16x16x32_bf16 v[88:91], v[64:67], a[40:43], v[88:91]
    v_exp_f32 v97, v97
    v_mfma_f32_16x16x32_bf16 v[88:91], v[68:71], a[44:47], v[88:91]
    s_add_u32 s49, s50, s46
    v_exp_f32 v98, v98
    v_mfma_f32_16x16x32_bf16 v[92:95], v[84:87], a[44:47], v[36:39]
    v_exp_f32 v99, v99
    v_mfma_f32_16x16x32_bf16 v[92:95], v[80:83], a[40:43], v[92:95]
    s_lshl1_add_u32 s50, s51, s50
    v_add_f32 v14, v14, v96
    v_add_f32 v15, v15, v97
    v_mfma_f32_16x16x32_bf16 v[92:95], v[76:79], a[36:39], v[92:95]
    v_cvt_pk_bf16_f32 v108, v96, v97
    v_mfma_f32_16x16x32_bf16 v[92:95], v[72:75], a[32:35], v[92:95]
    s_add_u32 s82, s82, 2
    v_exp_f32 v100, v100
    s_waitcnt lgkmcnt(0)
    v_mfma_f32_16x16x32_bf16 v[144:147], v[112:115], v[104:107], v[144:147]
    v_exp_f32 v101, v101
    v_mfma_f32_16x16x32_bf16 v[172:175], v[116:119], v[104:107], v[172:175]
    s_cmp_eq_u32 s82, 20
    v_add_f32 v14, v14, v98
    v_add_f32 v15, v15, v99
    v_mfma_f32_16x16x32_bf16 v[200:203], v[120:123], v[104:107], v[200:203]
    v_cvt_pk_bf16_f32 v109, v98, v99
    v_mfma_f32_16x16x32_bf16 v[228:231], v[124:127], v[104:107], v[228:231]
    s_cselect_b32 s29, s83, 0
    v_exp_f32 v102, v102
    v_mfma_f32_16x16x32_bf16 a[112:115], v[128:131], v[104:107], a[112:115]
    v_exp_f32 v103, v103
    v_mfma_f32_16x16x32_bf16 a[140:143], v[132:135], v[104:107], a[140:143]
    s_sub_u32 s50, s50, s29
    v_add_f32 v14, v14, v100
    v_add_f32 v15, v15, v101
    v_mfma_f32_16x16x32_bf16 a[168:171], v[136:139], v[104:107], a[168:171]
    v_cvt_pk_bf16_f32 v110, v100, v101
    v_add_f32 v14, v14, v102
    v_mfma_f32_16x16x32_bf16 a[196:199], v[140:143], v[104:107], a[196:199]
    s_add_u32 s28, s49, s88
    v_add_f32 v15, v15, v103
    v_cvt_pk_bf16_f32 v111, v102, v103
    v_mfma_f32_16x16x32_bf16 v[96:99], v[56:59], a[48:51], v[40:43]
    v_mfma_f32_16x16x32_bf16 v[96:99], v[60:63], a[52:55], v[96:99]
    buffer_load_dwordx4 v26, s[16:19], s28 offen lds
    v_exp_f32 v88, v88
    v_mfma_f32_16x16x32_bf16 v[96:99], v[64:67], a[56:59], v[96:99]
    v_exp_f32 v89, v89
    v_mfma_f32_16x16x32_bf16 v[96:99], v[68:71], a[60:63], v[96:99]
    s_add_u32 m0, m0, s53
    v_exp_f32 v90, v90
    v_mfma_f32_16x16x32_bf16 v[100:103], v[84:87], a[60:63], v[40:43]
    v_exp_f32 v91, v91
    v_mfma_f32_16x16x32_bf16 v[100:103], v[80:83], a[56:59], v[100:103]
    s_add_u32 s28, s49, s89
    v_add_f32 v16, v16, v88
    v_add_f32 v17, v17, v89
    v_mfma_f32_16x16x32_bf16 v[100:103], v[76:79], a[52:55], v[100:103]
    v_cvt_pk_bf16_f32 v104, v88, v89
    v_mfma_f32_16x16x32_bf16 v[100:103], v[72:75], a[48:51], v[100:103]
    buffer_load_dwordx4 v26, s[16:19], s28 offen lds
    v_exp_f32 v92, v92
    v_mfma_f32_16x16x32_bf16 v[148:151], v[112:115], v[108:111], v[148:151]
    v_exp_f32 v93, v93
    v_mfma_f32_16x16x32_bf16 v[176:179], v[116:119], v[108:111], v[176:179]
    s_add_u32 m0, m0, s53
    v_add_f32 v16, v16, v90
    v_add_f32 v17, v17, v91
    v_mfma_f32_16x16x32_bf16 v[204:207], v[120:123], v[108:111], v[204:207]
    v_cvt_pk_bf16_f32 v105, v90, v91
    v_mfma_f32_16x16x32_bf16 v[232:235], v[124:127], v[108:111], v[232:235]
    s_add_u32 s28, s49, s90
    v_exp_f32 v94, v94
    v_mfma_f32_16x16x32_bf16 a[116:119], v[128:131], v[108:111], a[116:119]
    v_exp_f32 v95, v95
    v_mfma_f32_16x16x32_bf16 a[144:147], v[132:135], v[108:111], a[144:147]
    buffer_load_dwordx4 v26, s[16:19], s28 offen lds
    v_add_f32 v16, v16, v92
    v_add_f32 v17, v17, v93
    v_mfma_f32_16x16x32_bf16 a[172:175], v[136:139], v[108:111], a[172:175]
    v_cvt_pk_bf16_f32 v106, v92, v93
    v_add_f32 v16, v16, v94
    v_mfma_f32_16x16x32_bf16 a[200:203], v[140:143], v[108:111], a[200:203]
    s_add_u32 m0, m0, s53
    v_add_f32 v17, v17, v95
    v_cvt_pk_bf16_f32 v107, v94, v95
    v_mfma_f32_16x16x32_bf16 v[88:91], v[56:59], a[64:67], v[44:47]
    v_mfma_f32_16x16x32_bf16 v[88:91], v[60:63], a[68:71], v[88:91]
    s_add_u32 s28, s49, s91
    v_exp_f32 v96, v96
    v_mfma_f32_16x16x32_bf16 v[88:91], v[64:67], a[72:75], v[88:91]
    v_exp_f32 v97, v97
    v_mfma_f32_16x16x32_bf16 v[88:91], v[68:71], a[76:79], v[88:91]
    buffer_load_dwordx4 v26, s[16:19], s28 offen lds
    v_exp_f32 v98, v98
    v_mfma_f32_16x16x32_bf16 v[92:95], v[84:87], a[76:79], v[44:47]
    v_exp_f32 v99, v99
    v_mfma_f32_16x16x32_bf16 v[92:95], v[80:83], a[72:75], v[92:95]
    s_add_u32 m0, m0, s53
    v_add_f32 v18, v18, v96
    v_add_f32 v19, v19, v97
    v_mfma_f32_16x16x32_bf16 v[92:95], v[76:79], a[68:71], v[92:95]
    v_cvt_pk_bf16_f32 v108, v96, v97
    v_mfma_f32_16x16x32_bf16 v[92:95], v[72:75], a[64:67], v[92:95]
    s_add_u32 s28, s49, s92
    v_exp_f32 v100, v100
    v_mfma_f32_16x16x32_bf16 v[152:155], v[112:115], v[104:107], v[152:155]
    v_exp_f32 v101, v101
    v_mfma_f32_16x16x32_bf16 v[180:183], v[116:119], v[104:107], v[180:183]
    buffer_load_dwordx4 v26, s[16:19], s28 offen lds
    v_add_f32 v18, v18, v98
    v_add_f32 v19, v19, v99
    v_mfma_f32_16x16x32_bf16 v[208:211], v[120:123], v[104:107], v[208:211]
    v_cvt_pk_bf16_f32 v109, v98, v99
    v_mfma_f32_16x16x32_bf16 v[236:239], v[124:127], v[104:107], v[236:239]
    s_add_u32 m0, m0, s53
    v_exp_f32 v102, v102
    v_mfma_f32_16x16x32_bf16 a[120:123], v[128:131], v[104:107], a[120:123]
    v_exp_f32 v103, v103
    v_mfma_f32_16x16x32_bf16 a[148:151], v[132:135], v[104:107], a[148:151]
    s_add_u32 s28, s49, s93
    v_add_f32 v18, v18, v100
    v_add_f32 v19, v19, v101
    v_mfma_f32_16x16x32_bf16 a[176:179], v[136:139], v[104:107], a[176:179]
    v_cvt_pk_bf16_f32 v110, v100, v101
    v_add_f32 v18, v18, v102
    v_mfma_f32_16x16x32_bf16 a[204:207], v[140:143], v[104:107], a[204:207]
    buffer_load_dwordx4 v26, s[16:19], s28 offen lds
    v_add_f32 v19, v19, v103
    v_cvt_pk_bf16_f32 v111, v102, v103
    v_mfma_f32_16x16x32_bf16 v[96:99], v[56:59], a[80:83], v[48:51]
    v_mfma_f32_16x16x32_bf16 v[96:99], v[60:63], a[84:87], v[96:99]
    s_add_u32 m0, m0, s53
    v_exp_f32 v88, v88
    v_mfma_f32_16x16x32_bf16 v[96:99], v[64:67], a[88:91], v[96:99]
    v_exp_f32 v89, v89
    v_mfma_f32_16x16x32_bf16 v[96:99], v[68:71], a[92:95], v[96:99]
    s_add_u32 s28, s49, s47
    v_exp_f32 v90, v90
    v_mfma_f32_16x16x32_bf16 v[100:103], v[84:87], a[92:95], v[48:51]
    v_exp_f32 v91, v91
    v_mfma_f32_16x16x32_bf16 v[100:103], v[80:83], a[88:91], v[100:103]
    buffer_load_dwordx4 v26, s[16:19], s28 offen lds
    v_add_f32 v20, v20, v88
    v_add_f32 v21, v21, v89
    v_mfma_f32_16x16x32_bf16 v[100:103], v[76:79], a[84:87], v[100:103]
    v_cvt_pk_bf16_f32 v104, v88, v89
    v_mfma_f32_16x16x32_bf16 v[100:103], v[72:75], a[80:83], v[100:103]
    s_add_u32 m0, m0, s53
    v_exp_f32 v92, v92
    v_mfma_f32_16x16x32_bf16 v[156:159], v[112:115], v[108:111], v[156:159]
    v_exp_f32 v93, v93
    v_mfma_f32_16x16x32_bf16 v[184:187], v[116:119], v[108:111], v[184:187]
    s_add_u32 s28, s49, s98
    v_add_f32 v20, v20, v90
    v_add_f32 v21, v21, v91
    v_mfma_f32_16x16x32_bf16 v[212:215], v[120:123], v[108:111], v[212:215]
    v_cvt_pk_bf16_f32 v105, v90, v91
    v_mfma_f32_16x16x32_bf16 v[240:243], v[124:127], v[108:111], v[240:243]
    buffer_load_dwordx4 v26, s[16:19], s28 offen lds
    v_exp_f32 v94, v94
    v_mfma_f32_16x16x32_bf16 a[124:127], v[128:131], v[108:111], a[124:127]
    v_exp_f32 v95, v95
    v_mfma_f32_16x16x32_bf16 a[152:155], v[132:135], v[108:111], a[152:155]
    v_add_f32 v20, v20, v92
    v_add_f32 v21, v21, v93
    v_mfma_f32_16x16x32_bf16 a[180:183], v[136:139], v[108:111], a[180:183]
    v_cvt_pk_bf16_f32 v106, v92, v93
    v_add_f32 v20, v20, v94
    v_mfma_f32_16x16x32_bf16 a[208:211], v[140:143], v[108:111], a[208:211]
    v_add_f32 v21, v21, v95
    v_cvt_pk_bf16_f32 v107, v94, v95
    s_waitcnt vmcnt(16) lgkmcnt(0)
    s_barrier
    v_mfma_f32_16x16x32_bf16 v[88:91], v[56:59], a[96:99], v[52:55]
    ds_read_b128 v[56:59], v8 offset:25344
    v_mfma_f32_16x16x32_bf16 v[88:91], v[60:63], a[100:103], v[88:91]
    ds_read_b128 v[60:63], v8 offset:25408
    v_exp_f32 v96, v96
    v_mfma_f32_16x16x32_bf16 v[88:91], v[64:67], a[104:107], v[88:91]
    ds_read_b128 v[64:67], v8 offset:25472
    v_exp_f32 v97, v97
    v_mfma_f32_16x16x32_bf16 v[88:91], v[68:71], a[108:111], v[88:91]
    ds_read_b128 v[68:71], v8 offset:25536
    v_exp_f32 v98, v98
    v_mfma_f32_16x16x32_bf16 v[92:95], v[84:87], a[108:111], v[52:55]
    ds_read_b128 v[84:87], v8 offset:26048
    v_exp_f32 v99, v99
    v_mfma_f32_16x16x32_bf16 v[92:95], v[80:83], a[104:107], v[92:95]
    ds_read_b128 v[80:83], v8 offset:25984
    v_add_f32 v22, v22, v96
    v_add_f32 v23, v23, v97
    v_mfma_f32_16x16x32_bf16 v[92:95], v[76:79], a[100:103], v[92:95]
    ds_read_b128 v[76:79], v8 offset:25920
    v_cvt_pk_bf16_f32 v108, v96, v97
    v_mfma_f32_16x16x32_bf16 v[92:95], v[72:75], a[96:99], v[92:95]
    ds_read_b128 v[72:75], v8 offset:25856
    v_exp_f32 v100, v100
    v_mfma_f32_16x16x32_bf16 v[160:163], v[112:115], v[104:107], v[160:163]
    v_exp_f32 v101, v101
    v_mfma_f32_16x16x32_bf16 v[188:191], v[116:119], v[104:107], v[188:191]
    v_add_f32 v22, v22, v98
    v_add_f32 v23, v23, v99
    v_mfma_f32_16x16x32_bf16 v[216:219], v[120:123], v[104:107], v[216:219]
    v_cvt_pk_bf16_f32 v109, v98, v99
    v_mfma_f32_16x16x32_bf16 v[244:247], v[124:127], v[104:107], v[244:247]
    v_exp_f32 v102, v102
    v_mfma_f32_16x16x32_bf16 a[128:131], v[128:131], v[104:107], a[128:131]
    v_exp_f32 v103, v103
    v_mfma_f32_16x16x32_bf16 a[156:159], v[132:135], v[104:107], a[156:159]
    v_add_f32 v22, v22, v100
    v_add_f32 v23, v23, v101
    v_mfma_f32_16x16x32_bf16 a[184:187], v[136:139], v[104:107], a[184:187]
    v_cvt_pk_bf16_f32 v110, v100, v101
    v_add_f32 v22, v22, v102
    v_mfma_f32_16x16x32_bf16 a[212:215], v[140:143], v[104:107], a[212:215]
    v_add_f32 v23, v23, v103
    v_cvt_pk_bf16_f32 v111, v102, v103
    s_waitcnt lgkmcnt(0)
    v_mfma_f32_16x16x32_bf16 v[96:99], v[56:59], a[0:3], v[28:31]
    v_mfma_f32_16x16x32_bf16 v[96:99], v[60:63], a[4:7], v[96:99]
    v_exp_f32 v88, v88
    v_mfma_f32_16x16x32_bf16 v[96:99], v[64:67], a[8:11], v[96:99]
    v_exp_f32 v89, v89
    v_mfma_f32_16x16x32_bf16 v[96:99], v[68:71], a[12:15], v[96:99]
    v_exp_f32 v90, v90
    v_mfma_f32_16x16x32_bf16 v[100:103], v[84:87], a[12:15], v[28:31]
    v_exp_f32 v91, v91
    v_mfma_f32_16x16x32_bf16 v[100:103], v[80:83], a[8:11], v[100:103]
    v_add_f32 v24, v24, v88
    v_add_f32 v25, v25, v89
    v_mfma_f32_16x16x32_bf16 v[100:103], v[76:79], a[4:7], v[100:103]
    v_cvt_pk_bf16_f32 v104, v88, v89
    v_mfma_f32_16x16x32_bf16 v[100:103], v[72:75], a[0:3], v[100:103]
    v_exp_f32 v92, v92
    v_mfma_f32_16x16x32_bf16 v[164:167], v[112:115], v[108:111], v[164:167]
    v_exp_f32 v93, v93
    v_mfma_f32_16x16x32_bf16 v[192:195], v[116:119], v[108:111], v[192:195]
    v_add_f32 v24, v24, v90
    v_add_f32 v25, v25, v91
    v_mfma_f32_16x16x32_bf16 v[220:223], v[120:123], v[108:111], v[220:223]
    v_cvt_pk_bf16_f32 v105, v90, v91
    v_mfma_f32_16x16x32_bf16 v[248:251], v[124:127], v[108:111], v[248:251]
    v_exp_f32 v94, v94
    v_mfma_f32_16x16x32_bf16 a[132:135], v[128:131], v[108:111], a[132:135]
    v_exp_f32 v95, v95
    v_mfma_f32_16x16x32_bf16 a[160:163], v[132:135], v[108:111], a[160:163]
    v_add_f32 v24, v24, v92
    v_add_f32 v25, v25, v93
    v_mfma_f32_16x16x32_bf16 a[188:191], v[136:139], v[108:111], a[188:191]
    v_cvt_pk_bf16_f32 v106, v92, v93
    v_add_f32 v24, v24, v94
    v_mfma_f32_16x16x32_bf16 a[216:219], v[140:143], v[108:111], a[216:219]
    v_add_f32 v25, v25, v95
    v_cvt_pk_bf16_f32 v107, v94, v95
    v_mfma_f32_16x16x32_bf16 v[88:91], v[56:59], a[16:19], v[32:35]
    v_mfma_f32_16x16x32_bf16 v[88:91], v[60:63], a[20:23], v[88:91]
    v_exp_f32 v96, v96
    v_mfma_f32_16x16x32_bf16 v[88:91], v[64:67], a[24:27], v[88:91]
    v_exp_f32 v97, v97
    v_mfma_f32_16x16x32_bf16 v[88:91], v[68:71], a[28:31], v[88:91]
    v_exp_f32 v98, v98
    v_mfma_f32_16x16x32_bf16 v[92:95], v[84:87], a[28:31], v[32:35]
    v_exp_f32 v99, v99
    v_mfma_f32_16x16x32_bf16 v[92:95], v[80:83], a[24:27], v[92:95]
    v_add_f32 v12, v12, v96
    v_add_f32 v13, v13, v97
    v_mfma_f32_16x16x32_bf16 v[92:95], v[76:79], a[20:23], v[92:95]
    v_cvt_pk_bf16_f32 v108, v96, v97
    v_mfma_f32_16x16x32_bf16 v[92:95], v[72:75], a[16:19], v[92:95]
    v_exp_f32 v100, v100
    v_mfma_f32_16x16x32_bf16 v[168:171], v[112:115], v[104:107], v[168:171]
    ds_read_b64_tr_b16 v[112:113], v9 offset:25344
    ds_read_b64_tr_b16 v[114:115], v9 offset:25856
    v_exp_f32 v101, v101
    v_mfma_f32_16x16x32_bf16 v[196:199], v[116:119], v[104:107], v[196:199]
    ds_read_b64_tr_b16 v[116:117], v9 offset:25376
    ds_read_b64_tr_b16 v[118:119], v9 offset:25888
    v_add_f32 v12, v12, v98
    v_add_f32 v13, v13, v99
    v_mfma_f32_16x16x32_bf16 v[224:227], v[120:123], v[104:107], v[224:227]
    ds_read_b64_tr_b16 v[120:121], v9 offset:25408
    ds_read_b64_tr_b16 v[122:123], v9 offset:25920
    v_cvt_pk_bf16_f32 v109, v98, v99
    v_mfma_f32_16x16x32_bf16 v[252:255], v[124:127], v[104:107], v[252:255]
    ds_read_b64_tr_b16 v[124:125], v9 offset:25440
    ds_read_b64_tr_b16 v[126:127], v9 offset:25952
    v_exp_f32 v102, v102
    v_mfma_f32_16x16x32_bf16 a[136:139], v[128:131], v[104:107], a[136:139]
    ds_read_b64_tr_b16 v[128:129], v9 offset:25472
    ds_read_b64_tr_b16 v[130:131], v9 offset:25984
    v_exp_f32 v103, v103
    v_mfma_f32_16x16x32_bf16 a[164:167], v[132:135], v[104:107], a[164:167]
    ds_read_b64_tr_b16 v[132:133], v9 offset:25504
    ds_read_b64_tr_b16 v[134:135], v9 offset:26016
    v_add_f32 v12, v12, v100
    v_add_f32 v13, v13, v101
    v_mfma_f32_16x16x32_bf16 a[192:195], v[136:139], v[104:107], a[192:195]
    ds_read_b64_tr_b16 v[136:137], v9 offset:25536
    ds_read_b64_tr_b16 v[138:139], v9 offset:26048
    v_cvt_pk_bf16_f32 v110, v100, v101
    v_add_f32 v12, v12, v102
    v_mfma_f32_16x16x32_bf16 a[220:223], v[140:143], v[104:107], a[220:223]
    ds_read_b64_tr_b16 v[140:141], v9 offset:25568
    ds_read_b64_tr_b16 v[142:143], v9 offset:26080
    v_add_f32 v13, v13, v103
    v_cvt_pk_bf16_f32 v111, v102, v103
    v_mfma_f32_16x16x32_bf16 v[96:99], v[56:59], a[32:35], v[36:39]
    v_mfma_f32_16x16x32_bf16 v[96:99], v[60:63], a[36:39], v[96:99]
    s_add_u32 m0, s33, 16896
    v_exp_f32 v88, v88
    v_mfma_f32_16x16x32_bf16 v[96:99], v[64:67], a[40:43], v[96:99]
    v_exp_f32 v89, v89
    v_mfma_f32_16x16x32_bf16 v[96:99], v[68:71], a[44:47], v[96:99]
    s_mov_b32 s49, s50
    v_exp_f32 v90, v90
    v_mfma_f32_16x16x32_bf16 v[100:103], v[84:87], a[44:47], v[36:39]
    v_exp_f32 v91, v91
    v_mfma_f32_16x16x32_bf16 v[100:103], v[80:83], a[40:43], v[100:103]
    s_add_u32 s28, s49, s88
    v_add_f32 v14, v14, v88
    v_add_f32 v15, v15, v89
    v_mfma_f32_16x16x32_bf16 v[100:103], v[76:79], a[36:39], v[100:103]
    v_cvt_pk_bf16_f32 v104, v88, v89
    v_mfma_f32_16x16x32_bf16 v[100:103], v[72:75], a[32:35], v[100:103]
    v_exp_f32 v92, v92
    s_waitcnt lgkmcnt(0)
    v_mfma_f32_16x16x32_bf16 v[144:147], v[112:115], v[108:111], v[144:147]
    buffer_load_dwordx4 v26, s[16:19], s28 offen lds
    v_exp_f32 v93, v93
    v_mfma_f32_16x16x32_bf16 v[172:175], v[116:119], v[108:111], v[172:175]
    v_add_f32 v14, v14, v90
    v_add_f32 v15, v15, v91
    v_mfma_f32_16x16x32_bf16 v[200:203], v[120:123], v[108:111], v[200:203]
    s_add_u32 m0, m0, s53
    v_cvt_pk_bf16_f32 v105, v90, v91
    v_mfma_f32_16x16x32_bf16 v[228:231], v[124:127], v[108:111], v[228:231]
    v_exp_f32 v94, v94
    v_mfma_f32_16x16x32_bf16 a[112:115], v[128:131], v[108:111], a[112:115]
    s_add_u32 s28, s49, s89
    v_exp_f32 v95, v95
    v_mfma_f32_16x16x32_bf16 a[140:143], v[132:135], v[108:111], a[140:143]
    v_add_f32 v14, v14, v92
    v_add_f32 v15, v15, v93
    v_mfma_f32_16x16x32_bf16 a[168:171], v[136:139], v[108:111], a[168:171]
    buffer_load_dwordx4 v26, s[16:19], s28 offen lds
    v_cvt_pk_bf16_f32 v106, v92, v93
    v_add_f32 v14, v14, v94
    v_mfma_f32_16x16x32_bf16 a[196:199], v[140:143], v[108:111], a[196:199]
    v_add_f32 v15, v15, v95
    v_cvt_pk_bf16_f32 v107, v94, v95
    v_mfma_f32_16x16x32_bf16 v[88:91], v[56:59], a[48:51], v[40:43]
    v_mfma_f32_16x16x32_bf16 v[88:91], v[60:63], a[52:55], v[88:91]
    s_add_u32 m0, m0, s53
    v_exp_f32 v96, v96
    v_mfma_f32_16x16x32_bf16 v[88:91], v[64:67], a[56:59], v[88:91]
    v_exp_f32 v97, v97
    v_mfma_f32_16x16x32_bf16 v[88:91], v[68:71], a[60:63], v[88:91]
    s_add_u32 s28, s49, s90
    v_exp_f32 v98, v98
    v_mfma_f32_16x16x32_bf16 v[92:95], v[84:87], a[60:63], v[40:43]
    v_exp_f32 v99, v99
    v_mfma_f32_16x16x32_bf16 v[92:95], v[80:83], a[56:59], v[92:95]
    buffer_load_dwordx4 v26, s[16:19], s28 offen lds
    v_add_f32 v16, v16, v96
    v_add_f32 v17, v17, v97
    v_mfma_f32_16x16x32_bf16 v[92:95], v[76:79], a[52:55], v[92:95]
    v_cvt_pk_bf16_f32 v108, v96, v97
    v_mfma_f32_16x16x32_bf16 v[92:95], v[72:75], a[48:51], v[92:95]
    v_exp_f32 v100, v100
    v_mfma_f32_16x16x32_bf16 v[148:151], v[112:115], v[104:107], v[148:151]
    s_add_u32 m0, m0, s53
    v_exp_f32 v101, v101
    v_mfma_f32_16x16x32_bf16 v[176:179], v[116:119], v[104:107], v[176:179]
    v_add_f32 v16, v16, v98
    v_add_f32 v17, v17, v99
    v_mfma_f32_16x16x32_bf16 v[204:207], v[120:123], v[104:107], v[204:207]
    s_add_u32 s28, s49, s91
    v_cvt_pk_bf16_f32 v109, v98, v99
    v_mfma_f32_16x16x32_bf16 v[232:235], v[124:127], v[104:107], v[232:235]
    v_exp_f32 v102, v102
    v_mfma_f32_16x16x32_bf16 a[116:119], v[128:131], v[104:107], a[116:119]
    buffer_load_dwordx4 v26, s[16:19], s28 offen lds
    v_exp_f32 v103, v103
    v_mfma_f32_16x16x32_bf16 a[144:147], v[132:135], v[104:107], a[144:147]
    v_add_f32 v16, v16, v100
    v_add_f32 v17, v17, v101
    v_mfma_f32_16x16x32_bf16 a[172:175], v[136:139], v[104:107], a[172:175]
    s_add_u32 m0, m0, s53
    v_cvt_pk_bf16_f32 v110, v100, v101
    v_add_f32 v16, v16, v102
    v_mfma_f32_16x16x32_bf16 a[200:203], v[140:143], v[104:107], a[200:203]
    v_add_f32 v17, v17, v103
    v_cvt_pk_bf16_f32 v111, v102, v103
    v_mfma_f32_16x16x32_bf16 v[96:99], v[56:59], a[64:67], v[44:47]
    v_mfma_f32_16x16x32_bf16 v[96:99], v[60:63], a[68:71], v[96:99]
    s_add_u32 s28, s49, s92
    v_exp_f32 v88, v88
    v_mfma_f32_16x16x32_bf16 v[96:99], v[64:67], a[72:75], v[96:99]
    v_exp_f32 v89, v89
    v_mfma_f32_16x16x32_bf16 v[96:99], v[68:71], a[76:79], v[96:99]
    buffer_load_dwordx4 v26, s[16:19], s28 offen lds
    v_exp_f32 v90, v90
    v_mfma_f32_16x16x32_bf16 v[100:103], v[84:87], a[76:79], v[44:47]
    v_exp_f32 v91, v91
    v_mfma_f32_16x16x32_bf16 v[100:103], v[80:83], a[72:75], v[100:103]
    s_add_u32 m0, m0, s53
    v_add_f32 v18, v18, v88
    v_add_f32 v19, v19, v89
    v_mfma_f32_16x16x32_bf16 v[100:103], v[76:79], a[68:71], v[100:103]
    v_cvt_pk_bf16_f32 v104, v88, v89
    v_mfma_f32_16x16x32_bf16 v[100:103], v[72:75], a[64:67], v[100:103]
    v_exp_f32 v92, v92
    v_mfma_f32_16x16x32_bf16 v[152:155], v[112:115], v[108:111], v[152:155]
    s_add_u32 s28, s49, s93
    v_exp_f32 v93, v93
    v_mfma_f32_16x16x32_bf16 v[180:183], v[116:119], v[108:111], v[180:183]
    v_add_f32 v18, v18, v90
    v_add_f32 v19, v19, v91
    v_mfma_f32_16x16x32_bf16 v[208:211], v[120:123], v[108:111], v[208:211]
    buffer_load_dwordx4 v26, s[16:19], s28 offen lds
    v_cvt_pk_bf16_f32 v105, v90, v91
    v_mfma_f32_16x16x32_bf16 v[236:239], v[124:127], v[108:111], v[236:239]
    v_exp_f32 v94, v94
    v_mfma_f32_16x16x32_bf16 a[120:123], v[128:131], v[108:111], a[120:123]
    s_add_u32 m0, m0, s53
    v_exp_f32 v95, v95
    v_mfma_f32_16x16x32_bf16 a[148:151], v[132:135], v[108:111], a[148:151]
    v_add_f32 v18, v18, v92
    v_add_f32 v19, v19, v93
    v_mfma_f32_16x16x32_bf16 a[176:179], v[136:139], v[108:111], a[176:179]
    s_add_u32 s28, s49, s94
    v_cvt_pk_bf16_f32 v106, v92, v93
    v_add_f32 v18, v18, v94
    v_mfma_f32_16x16x32_bf16 a[204:207], v[140:143], v[108:111], a[204:207]
    v_add_f32 v19, v19, v95
    v_cvt_pk_bf16_f32 v107, v94, v95
    v_mfma_f32_16x16x32_bf16 v[88:91], v[56:59], a[80:83], v[48:51]
    v_mfma_f32_16x16x32_bf16 v[88:91], v[60:63], a[84:87], v[88:91]
    buffer_load_dwordx4 v26, s[16:19], s28 offen lds
    v_exp_f32 v96, v96
    v_mfma_f32_16x16x32_bf16 v[88:91], v[64:67], a[88:91], v[88:91]
    v_exp_f32 v97, v97
    v_mfma_f32_16x16x32_bf16 v[88:91], v[68:71], a[92:95], v[88:91]
    s_add_u32 m0, m0, s53
    v_exp_f32 v98, v98
    v_mfma_f32_16x16x32_bf16 v[92:95], v[84:87], a[92:95], v[48:51]
    v_exp_f32 v99, v99
    v_mfma_f32_16x16x32_bf16 v[92:95], v[80:83], a[88:91], v[92:95]
    s_add_u32 s28, s49, s95
    v_add_f32 v20, v20, v96
    v_add_f32 v21, v21, v97
    v_mfma_f32_16x16x32_bf16 v[92:95], v[76:79], a[84:87], v[92:95]
    v_cvt_pk_bf16_f32 v108, v96, v97
    v_mfma_f32_16x16x32_bf16 v[92:95], v[72:75], a[80:83], v[92:95]
    v_exp_f32 v100, v100
    v_mfma_f32_16x16x32_bf16 v[156:159], v[112:115], v[104:107], v[156:159]
    buffer_load_dwordx4 v26, s[16:19], s28 offen lds
    v_exp_f32 v101, v101
    v_mfma_f32_16x16x32_bf16 v[184:187], v[116:119], v[104:107], v[184:187]
    v_add_f32 v20, v20, v98
    v_add_f32 v21, v21, v99
    v_mfma_f32_16x16x32_bf16 v[212:215], v[120:123], v[104:107], v[212:215]
    v_cvt_pk_bf16_f32 v109, v98, v99
    v_mfma_f32_16x16x32_bf16 v[240:243], v[124:127], v[104:107], v[240:243]
    v_exp_f32 v102, v102
    v_mfma_f32_16x16x32_bf16 a[124:127], v[128:131], v[104:107], a[124:127]
    v_exp_f32 v103, v103
    v_mfma_f32_16x16x32_bf16 a[152:155], v[132:135], v[104:107], a[152:155]
    v_add_f32 v20, v20, v100
    v_add_f32 v21, v21, v101
    v_mfma_f32_16x16x32_bf16 a[180:183], v[136:139], v[104:107], a[180:183]
    v_cvt_pk_bf16_f32 v110, v100, v101
    v_add_f32 v20, v20, v102
    v_mfma_f32_16x16x32_bf16 a[208:211], v[140:143], v[104:107], a[208:211]
    v_add_f32 v21, v21, v103
    v_cvt_pk_bf16_f32 v111, v102, v103
    s_waitcnt vmcnt(8) lgkmcnt(0)
    s_barrier
    v_mfma_f32_16x16x32_bf16 v[96:99], v[56:59], a[96:99], v[52:55]
    s_add_u32 m0, s33, 25344
    v_mfma_f32_16x16x32_bf16 v[96:99], v[60:63], a[100:103], v[96:99]
    s_add_u32 s49, s50, s46
    v_exp_f32 v88, v88
    v_mfma_f32_16x16x32_bf16 v[96:99], v[64:67], a[104:107], v[96:99]
    s_lshl1_add_u32 s50, s51, s50
    v_exp_f32 v89, v89
    v_mfma_f32_16x16x32_bf16 v[96:99], v[68:71], a[108:111], v[96:99]
    s_add_u32 s82, s82, 2
    v_exp_f32 v90, v90
    v_mfma_f32_16x16x32_bf16 v[100:103], v[84:87], a[108:111], v[52:55]
    s_cmp_eq_u32 s82, 20
    v_exp_f32 v91, v91
    v_mfma_f32_16x16x32_bf16 v[100:103], v[80:83], a[104:107], v[100:103]
    s_cselect_b32 s29, s83, 0
    v_add_f32 v22, v22, v88
    v_add_f32 v23, v23, v89
    v_mfma_f32_16x16x32_bf16 v[100:103], v[76:79], a[100:103], v[100:103]
    s_sub_u32 s50, s50, s29
    v_cvt_pk_bf16_f32 v104, v88, v89
    v_mfma_f32_16x16x32_bf16 v[100:103], v[72:75], a[96:99], v[100:103]
    v_exp_f32 v92, v92
    v_mfma_f32_16x16x32_bf16 v[160:163], v[112:115], v[108:111], v[160:163]
    s_add_u32 s28, s49, s88
    v_exp_f32 v93, v93
    v_mfma_f32_16x16x32_bf16 v[188:191], v[116:119], v[108:111], v[188:191]
    buffer_load_dwordx4 v26, s[16:19], s28 offen lds
    v_add_f32 v22, v22, v90
    v_add_f32 v23, v23, v91
    v_mfma_f32_16x16x32_bf16 v[216:219], v[120:123], v[108:111], v[216:219]
    s_add_u32 m0, m0, s53
    v_cvt_pk_bf16_f32 v105, v90, v91
    v_mfma_f32_16x16x32_bf16 v[244:247], v[124:127], v[108:111], v[244:247]
    s_add_u32 s28, s49, s89
    v_exp_f32 v94, v94
    v_mfma_f32_16x16x32_bf16 a[128:131], v[128:131], v[108:111], a[128:131]
    buffer_load_dwordx4 v26, s[16:19], s28 offen lds
    v_exp_f32 v95, v95
    v_mfma_f32_16x16x32_bf16 a[156:159], v[132:135], v[108:111], a[156:159]
    s_add_u32 m0, m0, s53
    v_add_f32 v22, v22, v92
    v_add_f32 v23, v23, v93
    v_mfma_f32_16x16x32_bf16 a[184:187], v[136:139], v[108:111], a[184:187]
    s_add_u32 s28, s49, s90
    v_cvt_pk_bf16_f32 v106, v92, v93
    v_add_f32 v22, v22, v94
    v_mfma_f32_16x16x32_bf16 a[212:215], v[140:143], v[108:111], a[212:215]
    buffer_load_dwordx4 v26, s[16:19], s28 offen lds
    v_add_f32 v23, v23, v95
    v_cvt_pk_bf16_f32 v107, v94, v95
    s_nop 1
    v_mfma_f32_16x16x32_bf16 v[164:167], v[112:115], v[104:107], v[164:167]
    s_add_u32 m0, m0, s53
    s_add_u32 s28, s49, s91
    v_exp_f32 v96, v96
    v_mfma_f32_16x16x32_bf16 v[192:195], v[116:119], v[104:107], v[192:195]
    buffer_load_dwordx4 v26, s[16:19], s28 offen lds
    s_add_u32 m0, m0, s53
    v_exp_f32 v97, v97
    v_exp_f32 v98, v98
    v_mfma_f32_16x16x32_bf16 v[220:223], v[120:123], v[104:107], v[220:223]
    s_add_u32 s28, s49, s92
    buffer_load_dwordx4 v26, s[16:19], s28 offen lds
    v_exp_f32 v99, v99
    v_add_f32 v24, v24, v96
    v_add_f32 v25, v25, v97
    v_mfma_f32_16x16x32_bf16 v[248:251], v[124:127], v[104:107], v[248:251]
    s_add_u32 m0, m0, s53
    v_cvt_pk_bf16_f32 v108, v96, v97
    v_exp_f32 v100, v100
    v_mfma_f32_16x16x32_bf16 a[132:135], v[128:131], v[104:107], a[132:135]
    s_add_u32 s28, s49, s93
    buffer_load_dwordx4 v26, s[16:19], s28 offen lds
    v_exp_f32 v101, v101
    v_add_f32 v24, v24, v98
    v_add_f32 v25, v25, v99
    v_mfma_f32_16x16x32_bf16 a[160:163], v[132:135], v[104:107], a[160:163]
    s_add_u32 m0, m0, s53
    s_add_u32 s28, s49, s47
    v_cvt_pk_bf16_f32 v109, v98, v99
    v_exp_f32 v102, v102
    v_mfma_f32_16x16x32_bf16 a[188:191], v[136:139], v[104:107], a[188:191]
    buffer_load_dwordx4 v26, s[16:19], s28 offen lds
    s_add_u32 m0, m0, s53
    v_exp_f32 v103, v103
    v_add_f32 v24, v24, v100
    v_add_f32 v25, v25, v101
    v_mfma_f32_16x16x32_bf16 a[216:219], v[140:143], v[104:107], a[216:219]
    s_add_u32 s28, s49, s98
    buffer_load_dwordx4 v26, s[16:19], s28 offen lds
    v_cvt_pk_bf16_f32 v110, v100, v101
    v_add_f32 v24, v24, v102
    v_add_f32 v25, v25, v103
    v_cvt_pk_bf16_f32 v111, v102, v103
    s_branch L_at_aepi
L_at_atailB:
    v_mfma_f32_16x16x32_bf16 v[88:91], v[56:59], a[16:19], v[32:35]
    v_mfma_f32_16x16x32_bf16 v[88:91], v[60:63], a[20:23], v[88:91]
    v_exp_f32 v96, v96
    v_mfma_f32_16x16x32_bf16 v[88:91], v[64:67], a[24:27], v[88:91]
    v_exp_f32 v97, v97
    v_mfma_f32_16x16x32_bf16 v[88:91], v[68:71], a[28:31], v[88:91]
    v_exp_f32 v98, v98
    v_mfma_f32_16x16x32_bf16 v[92:95], v[84:87], a[28:31], v[32:35]
    v_exp_f32 v99, v99
    v_mfma_f32_16x16x32_bf16 v[92:95], v[80:83], a[24:27], v[92:95]
    v_add_f32 v12, v12, v96
    v_add_f32 v13, v13, v97
    v_mfma_f32_16x16x32_bf16 v[92:95], v[76:79], a[20:23], v[92:95]
    v_cvt_pk_bf16_f32 v108, v96, v97
    v_mfma_f32_16x16x32_bf16 v[92:95], v[72:75], a[16:19], v[92:95]
    v_exp_f32 v100, v100
    v_mfma_f32_16x16x32_bf16 v[168:171], v[112:115], v[104:107], v[168:171]
    ds_read_b64_tr_b16 v[112:113], v9 offset:8448
    ds_read_b64_tr_b16 v[114:115], v9 offset:8960
    v_exp_f32 v101, v101
    v_mfma_f32_16x16x32_bf16 v[196:199], v[116:119], v[104:107], v[196:199]
    ds_read_b64_tr_b16 v[116:117], v9 offset:8480
    ds_read_b64_tr_b16 v[118:119], v9 offset:8992
    v_add_f32 v12, v12, v98
    v_add_f32 v13, v13, v99
    v_mfma_f32_16x16x32_bf16 v[224:227], v[120:123], v[104:107], v[224:227]
    ds_read_b64_tr_b16 v[120:121], v9 offset:8512
    ds_read_b64_tr_b16 v[122:123], v9 offset:9024
    v_cvt_pk_bf16_f32 v109, v98, v99
    v_mfma_f32_16x16x32_bf16 v[252:255], v[124:127], v[104:107], v[252:255]
    ds_read_b64_tr_b16 v[124:125], v9 offset:8544
    ds_read_b64_tr_b16 v[126:127], v9 offset:9056
    v_exp_f32 v102, v102
    v_mfma_f32_16x16x32_bf16 a[136:139], v[128:131], v[104:107], a[136:139]
    ds_read_b64_tr_b16 v[128:129], v9 offset:8576
    ds_read_b64_tr_b16 v[130:131], v9 offset:9088
    v_exp_f32 v103, v103
    v_mfma_f32_16x16x32_bf16 a[164:167], v[132:135], v[104:107], a[164:167]
    ds_read_b64_tr_b16 v[132:133], v9 offset:8608
    ds_read_b64_tr_b16 v[134:135], v9 offset:9120
    v_add_f32 v12, v12, v100
    v_add_f32 v13, v13, v101
    v_mfma_f32_16x16x32_bf16 a[192:195], v[136:139], v[104:107], a[192:195]
    ds_read_b64_tr_b16 v[136:137], v9 offset:8640
    ds_read_b64_tr_b16 v[138:139], v9 offset:9152
    v_cvt_pk_bf16_f32 v110, v100, v101
    v_add_f32 v12, v12, v102
    v_mfma_f32_16x16x32_bf16 a[220:223], v[140:143], v[104:107], a[220:223]
    ds_read_b64_tr_b16 v[140:141], v9 offset:8672
    ds_read_b64_tr_b16 v[142:143], v9 offset:9184
    v_add_f32 v13, v13, v103
    v_cvt_pk_bf16_f32 v111, v102, v103
    v_mfma_f32_16x16x32_bf16 v[96:99], v[56:59], a[32:35], v[36:39]
    v_mfma_f32_16x16x32_bf16 v[96:99], v[60:63], a[36:39], v[96:99]
    s_add_u32 s29, s34, s100
    v_exp_f32 v88, v88
    v_mfma_f32_16x16x32_bf16 v[96:99], v[64:67], a[40:43], v[96:99]
    v_exp_f32 v89, v89
    v_mfma_f32_16x16x32_bf16 v[96:99], v[68:71], a[44:47], v[96:99]
    s_bfe_u32 s28, s29, 0x20003
    v_exp_f32 v90, v90
    v_mfma_f32_16x16x32_bf16 v[100:103], v[84:87], a[44:47], v[36:39]
    v_exp_f32 v91, v91
    v_mfma_f32_16x16x32_bf16 v[100:103], v[80:83], a[40:43], v[100:103]
    s_lshl_b32 s28, s28, 16
    v_add_f32 v14, v14, v88
    v_add_f32 v15, v15, v89
    v_mfma_f32_16x16x32_bf16 v[100:103], v[76:79], a[36:39], v[100:103]
    v_cvt_pk_bf16_f32 v104, v88, v89
    v_mfma_f32_16x16x32_bf16 v[100:103], v[72:75], a[32:35], v[100:103]
    v_exp_f32 v92, v92
    s_waitcnt lgkmcnt(0)
    v_mfma_f32_16x16x32_bf16 v[144:147], v[112:115], v[108:111], v[144:147]
    s_and_b32 s29, s29, 7
    v_exp_f32 v93, v93
    v_mfma_f32_16x16x32_bf16 v[172:175], v[116:119], v[108:111], v[172:175]
    v_add_f32 v14, v14, v90
    v_add_f32 v15, v15, v91
    v_mfma_f32_16x16x32_bf16 v[200:203], v[120:123], v[108:111], v[200:203]
    s_lshl_b32 s29, s29, 11
    v_cvt_pk_bf16_f32 v105, v90, v91
    v_mfma_f32_16x16x32_bf16 v[228:231], v[124:127], v[108:111], v[228:231]
    v_exp_f32 v94, v94
    v_mfma_f32_16x16x32_bf16 a[112:115], v[128:131], v[108:111], a[112:115]
    s_add_u32 s29, s28, s29
    v_exp_f32 v95, v95
    v_mfma_f32_16x16x32_bf16 a[140:143], v[132:135], v[108:111], a[140:143]
    v_add_f32 v14, v14, v92
    v_add_f32 v15, v15, v93
    v_mfma_f32_16x16x32_bf16 a[168:171], v[136:139], v[108:111], a[168:171]
    s_lshr_b32 s28, s34, 5
    v_cvt_pk_bf16_f32 v106, v92, v93
    v_add_f32 v14, v14, v94
    v_mfma_f32_16x16x32_bf16 a[196:199], v[140:143], v[108:111], a[196:199]
    v_add_f32 v15, v15, v95
    v_cvt_pk_bf16_f32 v107, v94, v95
    v_mfma_f32_16x16x32_bf16 v[88:91], v[56:59], a[48:51], v[40:43]
    v_mfma_f32_16x16x32_bf16 v[88:91], v[60:63], a[52:55], v[88:91]
    s_lshl_b32 s28, s28, 19
    v_exp_f32 v96, v96
    v_mfma_f32_16x16x32_bf16 v[88:91], v[64:67], a[56:59], v[88:91]
    v_exp_f32 v97, v97
    v_mfma_f32_16x16x32_bf16 v[88:91], v[68:71], a[60:63], v[88:91]
    s_add_u32 s49, s28, s29
    v_exp_f32 v98, v98
    v_mfma_f32_16x16x32_bf16 v[92:95], v[84:87], a[60:63], v[40:43]
    v_exp_f32 v99, v99
    v_mfma_f32_16x16x32_bf16 v[92:95], v[80:83], a[56:59], v[92:95]
    s_add_u32 m0, s33, 0
    v_add_f32 v16, v16, v96
    v_add_f32 v17, v17, v97
    v_mfma_f32_16x16x32_bf16 v[92:95], v[76:79], a[52:55], v[92:95]
    v_cvt_pk_bf16_f32 v108, v96, v97
    v_mfma_f32_16x16x32_bf16 v[92:95], v[72:75], a[48:51], v[92:95]
    v_exp_f32 v100, v100
    v_mfma_f32_16x16x32_bf16 v[148:151], v[112:115], v[104:107], v[148:151]
    s_add_u32 s34, s34, 1
    v_exp_f32 v101, v101
    v_mfma_f32_16x16x32_bf16 v[176:179], v[116:119], v[104:107], v[176:179]
    v_add_f32 v16, v16, v98
    v_add_f32 v17, v17, v99
    v_mfma_f32_16x16x32_bf16 v[204:207], v[120:123], v[104:107], v[204:207]
    buffer_load_dwordx4 v7, s[4:7], s49 offen offset:0 nt lds
    v_cvt_pk_bf16_f32 v109, v98, v99
    v_mfma_f32_16x16x32_bf16 v[232:235], v[124:127], v[104:107], v[232:235]
    v_exp_f32 v102, v102
    v_mfma_f32_16x16x32_bf16 a[116:119], v[128:131], v[104:107], a[116:119]
    s_add_u32 m0, m0, s96
    v_exp_f32 v103, v103
    v_mfma_f32_16x16x32_bf16 a[144:147], v[132:135], v[104:107], a[144:147]
    v_add_f32 v16, v16, v100
    v_add_f32 v17, v17, v101
    v_mfma_f32_16x16x32_bf16 a[172:175], v[136:139], v[104:107], a[172:175]
    buffer_load_dwordx4 v7, s[4:7], s49 offen offset:256 nt lds
    v_cvt_pk_bf16_f32 v110, v100, v101
    v_add_f32 v16, v16, v102
    v_mfma_f32_16x16x32_bf16 a[200:203], v[140:143], v[104:107], a[200:203]
    v_add_f32 v17, v17, v103
    v_cvt_pk_bf16_f32 v111, v102, v103
    v_mfma_f32_16x16x32_bf16 v[96:99], v[56:59], a[64:67], v[44:47]
    v_mfma_f32_16x16x32_bf16 v[96:99], v[60:63], a[68:71], v[96:99]
    s_add_u32 m0, m0, s97
    v_exp_f32 v88, v88
    v_mfma_f32_16x16x32_bf16 v[96:99], v[64:67], a[72:75], v[96:99]
    v_exp_f32 v89, v89
    v_mfma_f32_16x16x32_bf16 v[96:99], v[68:71], a[76:79], v[96:99]
    buffer_load_dwordx4 v7, s[4:7], s49 offen offset:512 nt lds
    v_exp_f32 v90, v90
    v_mfma_f32_16x16x32_bf16 v[100:103], v[84:87], a[76:79], v[44:47]
    v_exp_f32 v91, v91
    v_mfma_f32_16x16x32_bf16 v[100:103], v[80:83], a[72:75], v[100:103]
    s_add_u32 m0, m0, s96
    v_add_f32 v18, v18, v88
    v_add_f32 v19, v19, v89
    v_mfma_f32_16x16x32_bf16 v[100:103], v[76:79], a[68:71], v[100:103]
    v_cvt_pk_bf16_f32 v104, v88, v89
    v_mfma_f32_16x16x32_bf16 v[100:103], v[72:75], a[64:67], v[100:103]
    v_exp_f32 v92, v92
    v_mfma_f32_16x16x32_bf16 v[152:155], v[112:115], v[108:111], v[152:155]
    buffer_load_dwordx4 v7, s[4:7], s49 offen offset:768 nt lds
    v_exp_f32 v93, v93
    v_mfma_f32_16x16x32_bf16 v[180:183], v[116:119], v[108:111], v[180:183]
    v_add_f32 v18, v18, v90
    v_add_f32 v19, v19, v91
    v_mfma_f32_16x16x32_bf16 v[208:211], v[120:123], v[108:111], v[208:211]
    s_add_u32 m0, m0, s97
    v_cvt_pk_bf16_f32 v105, v90, v91
    v_mfma_f32_16x16x32_bf16 v[236:239], v[124:127], v[108:111], v[236:239]
    v_exp_f32 v94, v94
    v_mfma_f32_16x16x32_bf16 a[120:123], v[128:131], v[108:111], a[120:123]
    buffer_load_dwordx4 v7, s[4:7], s49 offen offset:1024 nt lds
    v_exp_f32 v95, v95
    v_mfma_f32_16x16x32_bf16 a[148:151], v[132:135], v[108:111], a[148:151]
    v_add_f32 v18, v18, v92
    v_add_f32 v19, v19, v93
    v_mfma_f32_16x16x32_bf16 a[176:179], v[136:139], v[108:111], a[176:179]
    s_add_u32 m0, m0, s96
    v_cvt_pk_bf16_f32 v106, v92, v93
    v_add_f32 v18, v18, v94
    v_mfma_f32_16x16x32_bf16 a[204:207], v[140:143], v[108:111], a[204:207]
    v_add_f32 v19, v19, v95
    v_cvt_pk_bf16_f32 v107, v94, v95
    v_mfma_f32_16x16x32_bf16 v[88:91], v[56:59], a[80:83], v[48:51]
    v_mfma_f32_16x16x32_bf16 v[88:91], v[60:63], a[84:87], v[88:91]
    buffer_load_dwordx4 v7, s[4:7], s49 offen offset:1280 nt lds
    v_exp_f32 v96, v96
    v_mfma_f32_16x16x32_bf16 v[88:91], v[64:67], a[88:91], v[88:91]
    v_exp_f32 v97, v97
    v_mfma_f32_16x16x32_bf16 v[88:91], v[68:71], a[92:95], v[88:91]
    s_add_u32 m0, m0, s97
    v_exp_f32 v98, v98
    v_mfma_f32_16x16x32_bf16 v[92:95], v[84:87], a[92:95], v[48:51]
    v_exp_f32 v99, v99
    v_mfma_f32_16x16x32_bf16 v[92:95], v[80:83], a[88:91], v[92:95]
    buffer_load_dwordx4 v7, s[4:7], s49 offen offset:1536 nt lds
    v_add_f32 v20, v20, v96
    v_add_f32 v21, v21, v97
    v_mfma_f32_16x16x32_bf16 v[92:95], v[76:79], a[84:87], v[92:95]
    v_cvt_pk_bf16_f32 v108, v96, v97
    v_mfma_f32_16x16x32_bf16 v[92:95], v[72:75], a[80:83], v[92:95]
    v_exp_f32 v100, v100
    v_mfma_f32_16x16x32_bf16 v[156:159], v[112:115], v[104:107], v[156:159]
    s_add_u32 m0, m0, s96
    v_exp_f32 v101, v101
    v_mfma_f32_16x16x32_bf16 v[184:187], v[116:119], v[104:107], v[184:187]
    v_add_f32 v20, v20, v98
    v_add_f32 v21, v21, v99
    v_mfma_f32_16x16x32_bf16 v[212:215], v[120:123], v[104:107], v[212:215]
    buffer_load_dwordx4 v7, s[4:7], s49 offen offset:1792 nt lds
    v_cvt_pk_bf16_f32 v109, v98, v99
    v_mfma_f32_16x16x32_bf16 v[240:243], v[124:127], v[104:107], v[240:243]
    v_exp_f32 v102, v102
    v_mfma_f32_16x16x32_bf16 a[124:127], v[128:131], v[104:107], a[124:127]
    v_exp_f32 v103, v103
    v_mfma_f32_16x16x32_bf16 a[152:155], v[132:135], v[104:107], a[152:155]
    v_add_f32 v20, v20, v100
    v_add_f32 v21, v21, v101
    v_mfma_f32_16x16x32_bf16 a[180:183], v[136:139], v[104:107], a[180:183]
    v_cvt_pk_bf16_f32 v110, v100, v101
    v_add_f32 v20, v20, v102
    v_mfma_f32_16x16x32_bf16 a[208:211], v[140:143], v[104:107], a[208:211]
    v_add_f32 v21, v21, v103
    v_cvt_pk_bf16_f32 v111, v102, v103
    s_waitcnt vmcnt(16) lgkmcnt(0)
    s_barrier
    v_mfma_f32_16x16x32_bf16 v[96:99], v[56:59], a[96:99], v[52:55]
    ds_read_b128 v[56:59], v8 offset:16896
    v_mfma_f32_16x16x32_bf16 v[96:99], v[60:63], a[100:103], v[96:99]
    ds_read_b128 v[60:63], v8 offset:16960
    v_exp_f32 v88, v88
    v_mfma_f32_16x16x32_bf16 v[96:99], v[64:67], a[104:107], v[96:99]
    ds_read_b128 v[64:67], v8 offset:17024
    v_exp_f32 v89, v89
    v_mfma_f32_16x16x32_bf16 v[96:99], v[68:71], a[108:111], v[96:99]
    ds_read_b128 v[68:71], v8 offset:17088
    v_exp_f32 v90, v90
    v_mfma_f32_16x16x32_bf16 v[100:103], v[84:87], a[108:111], v[52:55]
    ds_read_b128 v[84:87], v8 offset:17600
    v_exp_f32 v91, v91
    v_mfma_f32_16x16x32_bf16 v[100:103], v[80:83], a[104:107], v[100:103]
    ds_read_b128 v[80:83], v8 offset:17536
    v_add_f32 v22, v22, v88
    v_add_f32 v23, v23, v89
    v_mfma_f32_16x16x32_bf16 v[100:103], v[76:79], a[100:103], v[100:103]
    ds_read_b128 v[76:79], v8 offset:17472
    v_cvt_pk_bf16_f32 v104, v88, v89
    v_mfma_f32_16x16x32_bf16 v[100:103], v[72:75], a[96:99], v[100:103]
    ds_read_b128 v[72:75], v8 offset:17408
    v_exp_f32 v92, v92
    v_mfma_f32_16x16x32_bf16 v[160:163], v[112:115], v[108:111], v[160:163]
    v_exp_f32 v93, v93
    v_mfma_f32_16x16x32_bf16 v[188:191], v[116:119], v[108:111], v[188:191]
    v_add_f32 v22, v22, v90
    v_add_f32 v23, v23, v91
    v_mfma_f32_16x16x32_bf16 v[216:219], v[120:123], v[108:111], v[216:219]
    v_cvt_pk_bf16_f32 v105, v90, v91
    v_mfma_f32_16x16x32_bf16 v[244:247], v[124:127], v[108:111], v[244:247]
    v_exp_f32 v94, v94
    v_mfma_f32_16x16x32_bf16 a[128:131], v[128:131], v[108:111], a[128:131]
    v_exp_f32 v95, v95
    v_mfma_f32_16x16x32_bf16 a[156:159], v[132:135], v[108:111], a[156:159]
    v_add_f32 v22, v22, v92
    v_add_f32 v23, v23, v93
    v_mfma_f32_16x16x32_bf16 a[184:187], v[136:139], v[108:111], a[184:187]
    v_cvt_pk_bf16_f32 v106, v92, v93
    v_add_f32 v22, v22, v94
    v_mfma_f32_16x16x32_bf16 a[212:215], v[140:143], v[108:111], a[212:215]
    v_add_f32 v23, v23, v95
    v_cvt_pk_bf16_f32 v107, v94, v95
    s_waitcnt lgkmcnt(0)
    v_mfma_f32_16x16x32_bf16 v[88:91], v[56:59], a[0:3], v[28:31]
    v_mfma_f32_16x16x32_bf16 v[88:91], v[60:63], a[4:7], v[88:91]
    v_exp_f32 v96, v96
    v_mfma_f32_16x16x32_bf16 v[88:91], v[64:67], a[8:11], v[88:91]
    v_exp_f32 v97, v97
    v_mfma_f32_16x16x32_bf16 v[88:91], v[68:71], a[12:15], v[88:91]
    v_exp_f32 v98, v98
    v_mfma_f32_16x16x32_bf16 v[92:95], v[84:87], a[12:15], v[28:31]
    v_exp_f32 v99, v99
    v_mfma_f32_16x16x32_bf16 v[92:95], v[80:83], a[8:11], v[92:95]
    v_add_f32 v24, v24, v96
    v_add_f32 v25, v25, v97
    v_mfma_f32_16x16x32_bf16 v[92:95], v[76:79], a[4:7], v[92:95]
    v_cvt_pk_bf16_f32 v108, v96, v97
    v_mfma_f32_16x16x32_bf16 v[92:95], v[72:75], a[0:3], v[92:95]
    v_exp_f32 v100, v100
    v_mfma_f32_16x16x32_bf16 v[164:167], v[112:115], v[104:107], v[164:167]
    v_exp_f32 v101, v101
    v_mfma_f32_16x16x32_bf16 v[192:195], v[116:119], v[104:107], v[192:195]
    v_add_f32 v24, v24, v98
    v_add_f32 v25, v25, v99
    v_mfma_f32_16x16x32_bf16 v[220:223], v[120:123], v[104:107], v[220:223]
    v_cvt_pk_bf16_f32 v109, v98, v99
    v_mfma_f32_16x16x32_bf16 v[248:251], v[124:127], v[104:107], v[248:251]
    v_exp_f32 v102, v102
    v_mfma_f32_16x16x32_bf16 a[132:135], v[128:131], v[104:107], a[132:135]
    v_exp_f32 v103, v103
    v_mfma_f32_16x16x32_bf16 a[160:163], v[132:135], v[104:107], a[160:163]
    v_add_f32 v24, v24, v100
    v_add_f32 v25, v25, v101
    v_mfma_f32_16x16x32_bf16 a[188:191], v[136:139], v[104:107], a[188:191]
    v_cvt_pk_bf16_f32 v110, v100, v101
    v_add_f32 v24, v24, v102
    v_mfma_f32_16x16x32_bf16 a[216:219], v[140:143], v[104:107], a[216:219]
    v_add_f32 v25, v25, v103
    v_cvt_pk_bf16_f32 v111, v102, v103
    v_mfma_f32_16x16x32_bf16 v[96:99], v[56:59], a[16:19], v[32:35]
    v_mfma_f32_16x16x32_bf16 v[96:99], v[60:63], a[20:23], v[96:99]
    v_exp_f32 v88, v88
    v_mfma_f32_16x16x32_bf16 v[96:99], v[64:67], a[24:27], v[96:99]
    v_exp_f32 v89, v89
    v_mfma_f32_16x16x32_bf16 v[96:99], v[68:71], a[28:31], v[96:99]
    v_exp_f32 v90, v90
    v_mfma_f32_16x16x32_bf16 v[100:103], v[84:87], a[28:31], v[32:35]
    v_exp_f32 v91, v91
    v_mfma_f32_16x16x32_bf16 v[100:103], v[80:83], a[24:27], v[100:103]
    v_add_f32 v12, v12, v88
    v_add_f32 v13, v13, v89
    v_mfma_f32_16x16x32_bf16 v[100:103], v[76:79], a[20:23], v[100:103]
    v_cvt_pk_bf16_f32 v104, v88, v89
    v_mfma_f32_16x16x32_bf16 v[100:103], v[72:75], a[16:19], v[100:103]
    v_exp_f32 v92, v92
    v_mfma_f32_16x16x32_bf16 v[168:171], v[112:115], v[108:111], v[168:171]
    ds_read_b64_tr_b16 v[112:113], v9 offset:16896
    ds_read_b64_tr_b16 v[114:115], v9 offset:17408
    v_exp_f32 v93, v93
    v_mfma_f32_16x16x32_bf16 v[196:199], v[116:119], v[108:111], v[196:199]
    ds_read_b64_tr_b16 v[116:117], v9 offset:16928
    ds_read_b64_tr_b16 v[118:119], v9 offset:17440
    v_add_f32 v12, v12, v90
    v_add_f32 v13, v13, v91
    v_mfma_f32_16x16x32_bf16 v[224:227], v[120:123], v[108:111], v[224:227]
    ds_read_b64_tr_b16 v[120:121], v9 offset:16960
    ds_read_b64_tr_b16 v[122:123], v9 offset:17472
    v_cvt_pk_bf16_f32 v105, v90, v91
    v_mfma_f32_16x16x32_bf16 v[252:255], v[124:127], v[108:111], v[252:255]
    ds_read_b64_tr_b16 v[124:125], v9 offset:16992
    ds_read_b64_tr_b16 v[126:127], v9 offset:17504
    v_exp_f32 v94, v94
    v_mfma_f32_16x16x32_bf16 a[136:139], v[128:131], v[108:111], a[136:139]
    ds_read_b64_tr_b16 v[128:129], v9 offset:17024
    ds_read_b64_tr_b16 v[130:131], v9 offset:17536
    v_exp_f32 v95, v95
    v_mfma_f32_16x16x32_bf16 a[164:167], v[132:135], v[108:111], a[164:167]
    ds_read_b64_tr_b16 v[132:133], v9 offset:17056
    ds_read_b64_tr_b16 v[134:135], v9 offset:17568
    v_add_f32 v12, v12, v92
    v_add_f32 v13, v13, v93
    v_mfma_f32_16x16x32_bf16 a[192:195], v[136:139], v[108:111], a[192:195]
    ds_read_b64_tr_b16 v[136:137], v9 offset:17088
    ds_read_b64_tr_b16 v[138:139], v9 offset:17600
    v_cvt_pk_bf16_f32 v106, v92, v93
    v_add_f32 v12, v12, v94
    v_mfma_f32_16x16x32_bf16 a[220:223], v[140:143], v[108:111], a[220:223]
    ds_read_b64_tr_b16 v[140:141], v9 offset:17120
    ds_read_b64_tr_b16 v[142:143], v9 offset:17632
    v_add_f32 v13, v13, v95
    v_cvt_pk_bf16_f32 v107, v94, v95
    v_mfma_f32_16x16x32_bf16 v[88:91], v[56:59], a[32:35], v[36:39]
    v_mfma_f32_16x16x32_bf16 v[88:91], v[60:63], a[36:39], v[88:91]
    s_add_u32 s29, s34, s100
    v_exp_f32 v96, v96
    v_mfma_f32_16x16x32_bf16 v[88:91], v[64:67], a[40:43], v[88:91]
    v_exp_f32 v97, v97
    v_mfma_f32_16x16x32_bf16 v[88:91], v[68:71], a[44:47], v[88:91]
    s_bfe_u32 s28, s29, 0x20003
    v_exp_f32 v98, v98
    v_mfma_f32_16x16x32_bf16 v[92:95], v[84:87], a[44:47], v[36:39]
    v_exp_f32 v99, v99
    v_mfma_f32_16x16x32_bf16 v[92:95], v[80:83], a[40:43], v[92:95]
    s_lshl_b32 s28, s28, 16
    v_add_f32 v14, v14, v96
    v_add_f32 v15, v15, v97
    v_mfma_f32_16x16x32_bf16 v[92:95], v[76:79], a[36:39], v[92:95]
    v_cvt_pk_bf16_f32 v108, v96, v97
    v_mfma_f32_16x16x32_bf16 v[92:95], v[72:75], a[32:35], v[92:95]
    v_exp_f32 v100, v100
    s_waitcnt lgkmcnt(0)
    v_mfma_f32_16x16x32_bf16 v[144:147], v[112:115], v[104:107], v[144:147]
    s_and_b32 s29, s29, 7
    v_exp_f32 v101, v101
    v_mfma_f32_16x16x32_bf16 v[172:175], v[116:119], v[104:107], v[172:175]
    v_add_f32 v14, v14, v98
    v_add_f32 v15, v15, v99
    v_mfma_f32_16x16x32_bf16 v[200:203], v[120:123], v[104:107], v[200:203]
    s_lshl_b32 s29, s29, 11
    v_cvt_pk_bf16_f32 v109, v98, v99
    v_mfma_f32_16x16x32_bf16 v[228:231], v[124:127], v[104:107], v[228:231]
    v_exp_f32 v102, v102
    v_mfma_f32_16x16x32_bf16 a[112:115], v[128:131], v[104:107], a[112:115]
    s_add_u32 s29, s28, s29
    v_exp_f32 v103, v103
    v_mfma_f32_16x16x32_bf16 a[140:143], v[132:135], v[104:107], a[140:143]
    v_add_f32 v14, v14, v100
    v_add_f32 v15, v15, v101
    v_mfma_f32_16x16x32_bf16 a[168:171], v[136:139], v[104:107], a[168:171]
    s_lshr_b32 s28, s34, 5
    v_cvt_pk_bf16_f32 v110, v100, v101
    v_add_f32 v14, v14, v102
    v_mfma_f32_16x16x32_bf16 a[196:199], v[140:143], v[104:107], a[196:199]
    v_add_f32 v15, v15, v103
    v_cvt_pk_bf16_f32 v111, v102, v103
    v_mfma_f32_16x16x32_bf16 v[96:99], v[56:59], a[48:51], v[40:43]
    v_mfma_f32_16x16x32_bf16 v[96:99], v[60:63], a[52:55], v[96:99]
    s_lshl_b32 s28, s28, 19
    v_exp_f32 v88, v88
    v_mfma_f32_16x16x32_bf16 v[96:99], v[64:67], a[56:59], v[96:99]
    v_exp_f32 v89, v89
    v_mfma_f32_16x16x32_bf16 v[96:99], v[68:71], a[60:63], v[96:99]
    s_add_u32 s49, s28, s29
    v_exp_f32 v90, v90
    v_mfma_f32_16x16x32_bf16 v[100:103], v[84:87], a[60:63], v[40:43]
    v_exp_f32 v91, v91
    v_mfma_f32_16x16x32_bf16 v[100:103], v[80:83], a[56:59], v[100:103]
    s_add_u32 m0, s33, 8448
    v_add_f32 v16, v16, v88
    v_add_f32 v17, v17, v89
    v_mfma_f32_16x16x32_bf16 v[100:103], v[76:79], a[52:55], v[100:103]
    v_cvt_pk_bf16_f32 v104, v88, v89
    v_mfma_f32_16x16x32_bf16 v[100:103], v[72:75], a[48:51], v[100:103]
    v_exp_f32 v92, v92
    v_mfma_f32_16x16x32_bf16 v[148:151], v[112:115], v[108:111], v[148:151]
    s_add_u32 s34, s34, 1
    v_exp_f32 v93, v93
    v_mfma_f32_16x16x32_bf16 v[176:179], v[116:119], v[108:111], v[176:179]
    v_add_f32 v16, v16, v90
    v_add_f32 v17, v17, v91
    v_mfma_f32_16x16x32_bf16 v[204:207], v[120:123], v[108:111], v[204:207]
    buffer_load_dwordx4 v7, s[4:7], s49 offen offset:0 nt lds
    v_cvt_pk_bf16_f32 v105, v90, v91
    v_mfma_f32_16x16x32_bf16 v[232:235], v[124:127], v[108:111], v[232:235]
    v_exp_f32 v94, v94
    v_mfma_f32_16x16x32_bf16 a[116:119], v[128:131], v[108:111], a[116:119]
    s_add_u32 m0, m0, s96
    v_exp_f32 v95, v95
    v_mfma_f32_16x16x32_bf16 a[144:147], v[132:135], v[108:111], a[144:147]
    v_add_f32 v16, v16, v92
    v_add_f32 v17, v17, v93
    v_mfma_f32_16x16x32_bf16 a[172:175], v[136:139], v[108:111], a[172:175]
    buffer_load_dwordx4 v7, s[4:7], s49 offen offset:256 nt lds
    v_cvt_pk_bf16_f32 v106, v92, v93
    v_add_f32 v16, v16, v94
    v_mfma_f32_16x16x32_bf16 a[200:203], v[140:143], v[108:111], a[200:203]
    v_add_f32 v17, v17, v95
    v_cvt_pk_bf16_f32 v107, v94, v95
    v_mfma_f32_16x16x32_bf16 v[88:91], v[56:59], a[64:67], v[44:47]
    v_mfma_f32_16x16x32_bf16 v[88:91], v[60:63], a[68:71], v[88:91]
    s_add_u32 m0, m0, s97
    v_exp_f32 v96, v96
    v_mfma_f32_16x16x32_bf16 v[88:91], v[64:67], a[72:75], v[88:91]
    v_exp_f32 v97, v97
    v_mfma_f32_16x16x32_bf16 v[88:91], v[68:71], a[76:79], v[88:91]
    buffer_load_dwordx4 v7, s[4:7], s49 offen offset:512 nt lds
    v_exp_f32 v98, v98
    v_mfma_f32_16x16x32_bf16 v[92:95], v[84:87], a[76:79], v[44:47]
    v_exp_f32 v99, v99
    v_mfma_f32_16x16x32_bf16 v[92:95], v[80:83], a[72:75], v[92:95]
    s_add_u32 m0, m0, s96
    v_add_f32 v18, v18, v96
    v_add_f32 v19, v19, v97
    v_mfma_f32_16x16x32_bf16 v[92:95], v[76:79], a[68:71], v[92:95]
    v_cvt_pk_bf16_f32 v108, v96, v97
    v_mfma_f32_16x16x32_bf16 v[92:95], v[72:75], a[64:67], v[92:95]
    v_exp_f32 v100, v100
    v_mfma_f32_16x16x32_bf16 v[152:155], v[112:115], v[104:107], v[152:155]
    buffer_load_dwordx4 v7, s[4:7], s49 offen offset:768 nt lds
    v_exp_f32 v101, v101
    v_mfma_f32_16x16x32_bf16 v[180:183], v[116:119], v[104:107], v[180:183]
    v_add_f32 v18, v18, v98
    v_add_f32 v19, v19, v99
    v_mfma_f32_16x16x32_bf16 v[208:211], v[120:123], v[104:107], v[208:211]
    s_add_u32 m0, m0, s97
    v_cvt_pk_bf16_f32 v109, v98, v99
    v_mfma_f32_16x16x32_bf16 v[236:239], v[124:127], v[104:107], v[236:239]
    v_exp_f32 v102, v102
    v_mfma_f32_16x16x32_bf16 a[120:123], v[128:131], v[104:107], a[120:123]
    buffer_load_dwordx4 v7, s[4:7], s49 offen offset:1024 nt lds
    v_exp_f32 v103, v103
    v_mfma_f32_16x16x32_bf16 a[148:151], v[132:135], v[104:107], a[148:151]
    v_add_f32 v18, v18, v100
    v_add_f32 v19, v19, v101
    v_mfma_f32_16x16x32_bf16 a[176:179], v[136:139], v[104:107], a[176:179]
    s_add_u32 m0, m0, s96
    v_cvt_pk_bf16_f32 v110, v100, v101
    v_add_f32 v18, v18, v102
    v_mfma_f32_16x16x32_bf16 a[204:207], v[140:143], v[104:107], a[204:207]
    v_add_f32 v19, v19, v103
    v_cvt_pk_bf16_f32 v111, v102, v103
    v_mfma_f32_16x16x32_bf16 v[96:99], v[56:59], a[80:83], v[48:51]
    v_mfma_f32_16x16x32_bf16 v[96:99], v[60:63], a[84:87], v[96:99]
    buffer_load_dwordx4 v7, s[4:7], s49 offen offset:1280 nt lds
    v_exp_f32 v88, v88
    v_mfma_f32_16x16x32_bf16 v[96:99], v[64:67], a[88:91], v[96:99]
    v_exp_f32 v89, v89
    v_mfma_f32_16x16x32_bf16 v[96:99], v[68:71], a[92:95], v[96:99]
    s_add_u32 m0, m0, s97
    v_exp_f32 v90, v90
    v_mfma_f32_16x16x32_bf16 v[100:103], v[84:87], a[92:95], v[48:51]
    v_exp_f32 v91, v91
    v_mfma_f32_16x16x32_bf16 v[100:103], v[80:83], a[88:91], v[100:103]
    buffer_load_dwordx4 v7, s[4:7], s49 offen offset:1536 nt lds
    v_add_f32 v20, v20, v88
    v_add_f32 v21, v21, v89
    v_mfma_f32_16x16x32_bf16 v[100:103], v[76:79], a[84:87], v[100:103]
    v_cvt_pk_bf16_f32 v104, v88, v89
    v_mfma_f32_16x16x32_bf16 v[100:103], v[72:75], a[80:83], v[100:103]
    v_exp_f32 v92, v92
    v_mfma_f32_16x16x32_bf16 v[156:159], v[112:115], v[108:111], v[156:159]
    s_add_u32 m0, m0, s96
    v_exp_f32 v93, v93
    v_mfma_f32_16x16x32_bf16 v[184:187], v[116:119], v[108:111], v[184:187]
    v_add_f32 v20, v20, v90
    v_add_f32 v21, v21, v91
    v_mfma_f32_16x16x32_bf16 v[212:215], v[120:123], v[108:111], v[212:215]
    buffer_load_dwordx4 v7, s[4:7], s49 offen offset:1792 nt lds
    v_cvt_pk_bf16_f32 v105, v90, v91
    v_mfma_f32_16x16x32_bf16 v[240:243], v[124:127], v[108:111], v[240:243]
    v_exp_f32 v94, v94
    v_mfma_f32_16x16x32_bf16 a[124:127], v[128:131], v[108:111], a[124:127]
    v_exp_f32 v95, v95
    v_mfma_f32_16x16x32_bf16 a[152:155], v[132:135], v[108:111], a[152:155]
    v_add_f32 v20, v20, v92
    v_add_f32 v21, v21, v93
    v_mfma_f32_16x16x32_bf16 a[180:183], v[136:139], v[108:111], a[180:183]
    v_cvt_pk_bf16_f32 v106, v92, v93
    v_add_f32 v20, v20, v94
    v_mfma_f32_16x16x32_bf16 a[208:211], v[140:143], v[108:111], a[208:211]
    v_add_f32 v21, v21, v95
    v_cvt_pk_bf16_f32 v107, v94, v95
    s_waitcnt vmcnt(16) lgkmcnt(0)
    s_barrier
    v_mfma_f32_16x16x32_bf16 v[88:91], v[56:59], a[96:99], v[52:55]
    ds_read_b128 v[56:59], v8 offset:25344
    v_mfma_f32_16x16x32_bf16 v[88:91], v[60:63], a[100:103], v[88:91]
    ds_read_b128 v[60:63], v8 offset:25408
    v_exp_f32 v96, v96
    v_mfma_f32_16x16x32_bf16 v[88:91], v[64:67], a[104:107], v[88:91]
    ds_read_b128 v[64:67], v8 offset:25472
    v_exp_f32 v97, v97
    v_mfma_f32_16x16x32_bf16 v[88:91], v[68:71], a[108:111], v[88:91]
    ds_read_b128 v[68:71], v8 offset:25536
    v_exp_f32 v98, v98
    v_mfma_f32_16x16x32_bf16 v[92:95], v[84:87], a[108:111], v[52:55]
    ds_read_b128 v[84:87], v8 offset:26048
    v_exp_f32 v99, v99
    v_mfma_f32_16x16x32_bf16 v[92:95], v[80:83], a[104:107], v[92:95]
    ds_read_b128 v[80:83], v8 offset:25984
    v_add_f32 v22, v22, v96
    v_add_f32 v23, v23, v97
    v_mfma_f32_16x16x32_bf16 v[92:95], v[76:79], a[100:103], v[92:95]
    ds_read_b128 v[76:79], v8 offset:25920
    v_cvt_pk_bf16_f32 v108, v96, v97
    v_mfma_f32_16x16x32_bf16 v[92:95], v[72:75], a[96:99], v[92:95]
    ds_read_b128 v[72:75], v8 offset:25856
    v_exp_f32 v100, v100
    v_mfma_f32_16x16x32_bf16 v[160:163], v[112:115], v[104:107], v[160:163]
    v_exp_f32 v101, v101
    v_mfma_f32_16x16x32_bf16 v[188:191], v[116:119], v[104:107], v[188:191]
    v_add_f32 v22, v22, v98
    v_add_f32 v23, v23, v99
    v_mfma_f32_16x16x32_bf16 v[216:219], v[120:123], v[104:107], v[216:219]
    v_cvt_pk_bf16_f32 v109, v98, v99
    v_mfma_f32_16x16x32_bf16 v[244:247], v[124:127], v[104:107], v[244:247]
    v_exp_f32 v102, v102
    v_mfma_f32_16x16x32_bf16 a[128:131], v[128:131], v[104:107], a[128:131]
    v_exp_f32 v103, v103
    v_mfma_f32_16x16x32_bf16 a[156:159], v[132:135], v[104:107], a[156:159]
    v_add_f32 v22, v22, v100
    v_add_f32 v23, v23, v101
    v_mfma_f32_16x16x32_bf16 a[184:187], v[136:139], v[104:107], a[184:187]
    v_cvt_pk_bf16_f32 v110, v100, v101
    v_add_f32 v22, v22, v102
    v_mfma_f32_16x16x32_bf16 a[212:215], v[140:143], v[104:107], a[212:215]
    v_add_f32 v23, v23, v103
    v_cvt_pk_bf16_f32 v111, v102, v103
    s_waitcnt lgkmcnt(0)
    v_mfma_f32_16x16x32_bf16 v[96:99], v[56:59], a[0:3], v[28:31]
    v_mfma_f32_16x16x32_bf16 v[96:99], v[60:63], a[4:7], v[96:99]
    v_exp_f32 v88, v88
    v_mfma_f32_16x16x32_bf16 v[96:99], v[64:67], a[8:11], v[96:99]
    v_exp_f32 v89, v89
    v_mfma_f32_16x16x32_bf16 v[96:99], v[68:71], a[12:15], v[96:99]
    v_exp_f32 v90, v90
    v_mfma_f32_16x16x32_bf16 v[100:103], v[84:87], a[12:15], v[28:31]
    v_exp_f32 v91, v91
    v_mfma_f32_16x16x32_bf16 v[100:103], v[80:83], a[8:11], v[100:103]
    v_add_f32 v24, v24, v88
    v_add_f32 v25, v25, v89
    v_mfma_f32_16x16x32_bf16 v[100:103], v[76:79], a[4:7], v[100:103]
    v_cvt_pk_bf16_f32 v104, v88, v89
    v_mfma_f32_16x16x32_bf16 v[100:103], v[72:75], a[0:3], v[100:103]
    v_exp_f32 v92, v92
    v_mfma_f32_16x16x32_bf16 v[164:167], v[112:115], v[108:111], v[164:167]
    v_exp_f32 v93, v93
    v_mfma_f32_16x16x32_bf16 v[192:195], v[116:119], v[108:111], v[192:195]
    v_add_f32 v24, v24, v90
    v_add_f32 v25, v25, v91
    v_mfma_f32_16x16x32_bf16 v[220:223], v[120:123], v[108:111], v[220:223]
    v_cvt_pk_bf16_f32 v105, v90, v91
    v_mfma_f32_16x16x32_bf16 v[248:251], v[124:127], v[108:111], v[248:251]
    v_exp_f32 v94, v94
    v_mfma_f32_16x16x32_bf16 a[132:135], v[128:131], v[108:111], a[132:135]
    v_exp_f32 v95, v95
    v_mfma_f32_16x16x32_bf16 a[160:163], v[132:135], v[108:111], a[160:163]
    v_add_f32 v24, v24, v92
    v_add_f32 v25, v25, v93
    v_mfma_f32_16x16x32_bf16 a[188:191], v[136:139], v[108:111], a[188:191]
    v_cvt_pk_bf16_f32 v106, v92, v93
    v_add_f32 v24, v24, v94
    v_mfma_f32_16x16x32_bf16 a[216:219], v[140:143], v[108:111], a[216:219]
    v_add_f32 v25, v25, v95
    v_cvt_pk_bf16_f32 v107, v94, v95
    v_mfma_f32_16x16x32_bf16 v[88:91], v[56:59], a[16:19], v[32:35]
    v_mfma_f32_16x16x32_bf16 v[88:91], v[60:63], a[20:23], v[88:91]
    v_exp_f32 v96, v96
    v_mfma_f32_16x16x32_bf16 v[88:91], v[64:67], a[24:27], v[88:91]
    v_exp_f32 v97, v97
    v_mfma_f32_16x16x32_bf16 v[88:91], v[68:71], a[28:31], v[88:91]
    v_exp_f32 v98, v98
    v_mfma_f32_16x16x32_bf16 v[92:95], v[84:87], a[28:31], v[32:35]
    v_exp_f32 v99, v99
    v_mfma_f32_16x16x32_bf16 v[92:95], v[80:83], a[24:27], v[92:95]
    v_add_f32 v12, v12, v96
    v_add_f32 v13, v13, v97
    v_mfma_f32_16x16x32_bf16 v[92:95], v[76:79], a[20:23], v[92:95]
    v_cvt_pk_bf16_f32 v108, v96, v97
    v_mfma_f32_16x16x32_bf16 v[92:95], v[72:75], a[16:19], v[92:95]
    v_exp_f32 v100, v100
    v_mfma_f32_16x16x32_bf16 v[168:171], v[112:115], v[104:107], v[168:171]
    ds_read_b64_tr_b16 v[112:113], v9 offset:25344
    ds_read_b64_tr_b16 v[114:115], v9 offset:25856
    v_exp_f32 v101, v101
    v_mfma_f32_16x16x32_bf16 v[196:199], v[116:119], v[104:107], v[196:199]
    ds_read_b64_tr_b16 v[116:117], v9 offset:25376
    ds_read_b64_tr_b16 v[118:119], v9 offset:25888
    v_add_f32 v12, v12, v98
    v_add_f32 v13, v13, v99
    v_mfma_f32_16x16x32_bf16 v[224:227], v[120:123], v[104:107], v[224:227]
    ds_read_b64_tr_b16 v[120:121], v9 offset:25408
    ds_read_b64_tr_b16 v[122:123], v9 offset:25920
    v_cvt_pk_bf16_f32 v109, v98, v99
    v_mfma_f32_16x16x32_bf16 v[252:255], v[124:127], v[104:107], v[252:255]
    ds_read_b64_tr_b16 v[124:125], v9 offset:25440
    ds_read_b64_tr_b16 v[126:127], v9 offset:25952
    v_exp_f32 v102, v102
    v_mfma_f32_16x16x32_bf16 a[136:139], v[128:131], v[104:107], a[136:139]
    ds_read_b64_tr_b16 v[128:129], v9 offset:25472
    ds_read_b64_tr_b16 v[130:131], v9 offset:25984
    v_exp_f32 v103, v103
    v_mfma_f32_16x16x32_bf16 a[164:167], v[132:135], v[104:107], a[164:167]
    ds_read_b64_tr_b16 v[132:133], v9 offset:25504
    ds_read_b64_tr_b16 v[134:135], v9 offset:26016
    v_add_f32 v12, v12, v100
    v_add_f32 v13, v13, v101
    v_mfma_f32_16x16x32_bf16 a[192:195], v[136:139], v[104:107], a[192:195]
    ds_read_b64_tr_b16 v[136:137], v9 offset:25536
    ds_read_b64_tr_b16 v[138:139], v9 offset:26048
    v_cvt_pk_bf16_f32 v110, v100, v101
    v_add_f32 v12, v12, v102
    v_mfma_f32_16x16x32_bf16 a[220:223], v[140:143], v[104:107], a[220:223]
    ds_read_b64_tr_b16 v[140:141], v9 offset:25568
    ds_read_b64_tr_b16 v[142:143], v9 offset:26080
    v_add_f32 v13, v13, v103
    v_cvt_pk_bf16_f32 v111, v102, v103
    v_mfma_f32_16x16x32_bf16 v[96:99], v[56:59], a[32:35], v[36:39]
    v_mfma_f32_16x16x32_bf16 v[96:99], v[60:63], a[36:39], v[96:99]
    s_add_u32 s29, s34, s100
    v_exp_f32 v88, v88
    v_mfma_f32_16x16x32_bf16 v[96:99], v[64:67], a[40:43], v[96:99]
    v_exp_f32 v89, v89
    v_mfma_f32_16x16x32_bf16 v[96:99], v[68:71], a[44:47], v[96:99]
    s_bfe_u32 s28, s29, 0x20003
    v_exp_f32 v90, v90
    v_mfma_f32_16x16x32_bf16 v[100:103], v[84:87], a[44:47], v[36:39]
    v_exp_f32 v91, v91
    v_mfma_f32_16x16x32_bf16 v[100:103], v[80:83], a[40:43], v[100:103]
    s_lshl_b32 s28, s28, 16
    v_add_f32 v14, v14, v88
    v_add_f32 v15, v15, v89
    v_mfma_f32_16x16x32_bf16 v[100:103], v[76:79], a[36:39], v[100:103]
    v_cvt_pk_bf16_f32 v104, v88, v89
    v_mfma_f32_16x16x32_bf16 v[100:103], v[72:75], a[32:35], v[100:103]
    v_exp_f32 v92, v92
    s_waitcnt lgkmcnt(0)
    v_mfma_f32_16x16x32_bf16 v[144:147], v[112:115], v[108:111], v[144:147]
    s_and_b32 s29, s29, 7
    v_exp_f32 v93, v93
    v_mfma_f32_16x16x32_bf16 v[172:175], v[116:119], v[108:111], v[172:175]
    v_add_f32 v14, v14, v90
    v_add_f32 v15, v15, v91
    v_mfma_f32_16x16x32_bf16 v[200:203], v[120:123], v[108:111], v[200:203]
    s_lshl_b32 s29, s29, 11
    v_cvt_pk_bf16_f32 v105, v90, v91
    v_mfma_f32_16x16x32_bf16 v[228:231], v[124:127], v[108:111], v[228:231]
    v_exp_f32 v94, v94
    v_mfma_f32_16x16x32_bf16 a[112:115], v[128:131], v[108:111], a[112:115]
    s_add_u32 s29, s28, s29
    v_exp_f32 v95, v95
    v_mfma_f32_16x16x32_bf16 a[140:143], v[132:135], v[108:111], a[140:143]
    v_add_f32 v14, v14, v92
    v_add_f32 v15, v15, v93
    v_mfma_f32_16x16x32_bf16 a[168:171], v[136:139], v[108:111], a[168:171]
    s_lshr_b32 s28, s34, 5
    v_cvt_pk_bf16_f32 v106, v92, v93
    v_add_f32 v14, v14, v94
    v_mfma_f32_16x16x32_bf16 a[196:199], v[140:143], v[108:111], a[196:199]
    v_add_f32 v15, v15, v95
    v_cvt_pk_bf16_f32 v107, v94, v95
    v_mfma_f32_16x16x32_bf16 v[88:91], v[56:59], a[48:51], v[40:43]
    v_mfma_f32_16x16x32_bf16 v[88:91], v[60:63], a[52:55], v[88:91]
    s_lshl_b32 s28, s28, 19
    v_exp_f32 v96, v96
    v_mfma_f32_16x16x32_bf16 v[88:91], v[64:67], a[56:59], v[88:91]
    v_exp_f32 v97, v97
    v_mfma_f32_16x16x32_bf16 v[88:91], v[68:71], a[60:63], v[88:91]
    s_add_u32 s49, s28, s29
    v_exp_f32 v98, v98
    v_mfma_f32_16x16x32_bf16 v[92:95], v[84:87], a[60:63], v[40:43]
    v_exp_f32 v99, v99
    v_mfma_f32_16x16x32_bf16 v[92:95], v[80:83], a[56:59], v[92:95]
    s_add_u32 m0, s33, 16896
    v_add_f32 v16, v16, v96
    v_add_f32 v17, v17, v97
    v_mfma_f32_16x16x32_bf16 v[92:95], v[76:79], a[52:55], v[92:95]
    v_cvt_pk_bf16_f32 v108, v96, v97
    v_mfma_f32_16x16x32_bf16 v[92:95], v[72:75], a[48:51], v[92:95]
    v_exp_f32 v100, v100
    v_mfma_f32_16x16x32_bf16 v[148:151], v[112:115], v[104:107], v[148:151]
    s_add_u32 s34, s34, 1
    v_exp_f32 v101, v101
    v_mfma_f32_16x16x32_bf16 v[176:179], v[116:119], v[104:107], v[176:179]
    v_add_f32 v16, v16, v98
    v_add_f32 v17, v17, v99
    v_mfma_f32_16x16x32_bf16 v[204:207], v[120:123], v[104:107], v[204:207]
    buffer_load_dwordx4 v7, s[4:7], s49 offen offset:0 nt lds
    v_cvt_pk_bf16_f32 v109, v98, v99
    v_mfma_f32_16x16x32_bf16 v[232:235], v[124:127], v[104:107], v[232:235]
    v_exp_f32 v102, v102
    v_mfma_f32_16x16x32_bf16 a[116:119], v[128:131], v[104:107], a[116:119]
    s_add_u32 m0, m0, s96
    v_exp_f32 v103, v103
    v_mfma_f32_16x16x32_bf16 a[144:147], v[132:135], v[104:107], a[144:147]
    v_add_f32 v16, v16, v100
    v_add_f32 v17, v17, v101
    v_mfma_f32_16x16x32_bf16 a[172:175], v[136:139], v[104:107], a[172:175]
    buffer_load_dwordx4 v7, s[4:7], s49 offen offset:256 nt lds
    v_cvt_pk_bf16_f32 v110, v100, v101
    v_add_f32 v16, v16, v102
    v_mfma_f32_16x16x32_bf16 a[200:203], v[140:143], v[104:107], a[200:203]
    v_add_f32 v17, v17, v103
    v_cvt_pk_bf16_f32 v111, v102, v103
    v_mfma_f32_16x16x32_bf16 v[96:99], v[56:59], a[64:67], v[44:47]
    v_mfma_f32_16x16x32_bf16 v[96:99], v[60:63], a[68:71], v[96:99]
    s_add_u32 m0, m0, s97
    v_exp_f32 v88, v88
    v_mfma_f32_16x16x32_bf16 v[96:99], v[64:67], a[72:75], v[96:99]
    v_exp_f32 v89, v89
    v_mfma_f32_16x16x32_bf16 v[96:99], v[68:71], a[76:79], v[96:99]
    buffer_load_dwordx4 v7, s[4:7], s49 offen offset:512 nt lds
    v_exp_f32 v90, v90
    v_mfma_f32_16x16x32_bf16 v[100:103], v[84:87], a[76:79], v[44:47]
    v_exp_f32 v91, v91
    v_mfma_f32_16x16x32_bf16 v[100:103], v[80:83], a[72:75], v[100:103]
    s_add_u32 m0, m0, s96
    v_add_f32 v18, v18, v88
    v_add_f32 v19, v19, v89
    v_mfma_f32_16x16x32_bf16 v[100:103], v[76:79], a[68:71], v[100:103]
    v_cvt_pk_bf16_f32 v104, v88, v89
    v_mfma_f32_16x16x32_bf16 v[100:103], v[72:75], a[64:67], v[100:103]
    v_exp_f32 v92, v92
    v_mfma_f32_16x16x32_bf16 v[152:155], v[112:115], v[108:111], v[152:155]
    buffer_load_dwordx4 v7, s[4:7], s49 offen offset:768 nt lds
    v_exp_f32 v93, v93
    v_mfma_f32_16x16x32_bf16 v[180:183], v[116:119], v[108:111], v[180:183]
    v_add_f32 v18, v18, v90
    v_add_f32 v19, v19, v91
    v_mfma_f32_16x16x32_bf16 v[208:211], v[120:123], v[108:111], v[208:211]
    s_add_u32 m0, m0, s97
    v_cvt_pk_bf16_f32 v105, v90, v91
    v_mfma_f32_16x16x32_bf16 v[236:239], v[124:127], v[108:111], v[236:239]
    v_exp_f32 v94, v94
    v_mfma_f32_16x16x32_bf16 a[120:123], v[128:131], v[108:111], a[120:123]
    buffer_load_dwordx4 v7, s[4:7], s49 offen offset:1024 nt lds
    v_exp_f32 v95, v95
    v_mfma_f32_16x16x32_bf16 a[148:151], v[132:135], v[108:111], a[148:151]
    v_add_f32 v18, v18, v92
    v_add_f32 v19, v19, v93
    v_mfma_f32_16x16x32_bf16 a[176:179], v[136:139], v[108:111], a[176:179]
    s_add_u32 m0, m0, s96
    v_cvt_pk_bf16_f32 v106, v92, v93
    v_add_f32 v18, v18, v94
    v_mfma_f32_16x16x32_bf16 a[204:207], v[140:143], v[108:111], a[204:207]
    v_add_f32 v19, v19, v95
    v_cvt_pk_bf16_f32 v107, v94, v95
    v_mfma_f32_16x16x32_bf16 v[88:91], v[56:59], a[80:83], v[48:51]
    v_mfma_f32_16x16x32_bf16 v[88:91], v[60:63], a[84:87], v[88:91]
    buffer_load_dwordx4 v7, s[4:7], s49 offen offset:1280 nt lds
    v_exp_f32 v96, v96
    v_mfma_f32_16x16x32_bf16 v[88:91], v[64:67], a[88:91], v[88:91]
    v_exp_f32 v97, v97
    v_mfma_f32_16x16x32_bf16 v[88:91], v[68:71], a[92:95], v[88:91]
    s_add_u32 m0, m0, s97
    v_exp_f32 v98, v98
    v_mfma_f32_16x16x32_bf16 v[92:95], v[84:87], a[92:95], v[48:51]
    v_exp_f32 v99, v99
    v_mfma_f32_16x16x32_bf16 v[92:95], v[80:83], a[88:91], v[92:95]
    buffer_load_dwordx4 v7, s[4:7], s49 offen offset:1536 nt lds
    v_add_f32 v20, v20, v96
    v_add_f32 v21, v21, v97
    v_mfma_f32_16x16x32_bf16 v[92:95], v[76:79], a[84:87], v[92:95]
    v_cvt_pk_bf16_f32 v108, v96, v97
    v_mfma_f32_16x16x32_bf16 v[92:95], v[72:75], a[80:83], v[92:95]
    v_exp_f32 v100, v100
    v_mfma_f32_16x16x32_bf16 v[156:159], v[112:115], v[104:107], v[156:159]
    s_add_u32 m0, m0, s96
    v_exp_f32 v101, v101
    v_mfma_f32_16x16x32_bf16 v[184:187], v[116:119], v[104:107], v[184:187]
    v_add_f32 v20, v20, v98
    v_add_f32 v21, v21, v99
    v_mfma_f32_16x16x32_bf16 v[212:215], v[120:123], v[104:107], v[212:215]
    buffer_load_dwordx4 v7, s[4:7], s49 offen offset:1792 nt lds
    v_cvt_pk_bf16_f32 v109, v98, v99
    v_mfma_f32_16x16x32_bf16 v[240:243], v[124:127], v[104:107], v[240:243]
    v_exp_f32 v102, v102
    v_mfma_f32_16x16x32_bf16 a[124:127], v[128:131], v[104:107], a[124:127]
    v_exp_f32 v103, v103
    v_mfma_f32_16x16x32_bf16 a[152:155], v[132:135], v[104:107], a[152:155]
    v_add_f32 v20, v20, v100
    v_add_f32 v21, v21, v101
    v_mfma_f32_16x16x32_bf16 a[180:183], v[136:139], v[104:107], a[180:183]
    v_cvt_pk_bf16_f32 v110, v100, v101
    v_add_f32 v20, v20, v102
    v_mfma_f32_16x16x32_bf16 a[208:211], v[140:143], v[104:107], a[208:211]
    v_add_f32 v21, v21, v103
    v_cvt_pk_bf16_f32 v111, v102, v103
    s_waitcnt vmcnt(16) lgkmcnt(0)
    s_barrier
    v_mfma_f32_16x16x32_bf16 v[96:99], v[56:59], a[96:99], v[52:55]
    ds_read_b128 v[56:59], v8 offset:0
    s_add_u32 s29, s34, s100
    v_mfma_f32_16x16x32_bf16 v[96:99], v[60:63], a[100:103], v[96:99]
    ds_read_b128 v[60:63], v8 offset:64
    s_bfe_u32 s28, s29, 0x20003
    v_exp_f32 v88, v88
    v_mfma_f32_16x16x32_bf16 v[96:99], v[64:67], a[104:107], v[96:99]
    ds_read_b128 v[64:67], v8 offset:128
    s_lshl_b32 s28, s28, 16
    v_exp_f32 v89, v89
    v_mfma_f32_16x16x32_bf16 v[96:99], v[68:71], a[108:111], v[96:99]
    ds_read_b128 v[68:71], v8 offset:192
    s_and_b32 s29, s29, 7
    v_exp_f32 v90, v90
    v_mfma_f32_16x16x32_bf16 v[100:103], v[84:87], a[108:111], v[52:55]
    ds_read_b128 v[84:87], v8 offset:704
    s_lshl_b32 s29, s29, 11
    v_exp_f32 v91, v91
    v_mfma_f32_16x16x32_bf16 v[100:103], v[80:83], a[104:107], v[100:103]
    ds_read_b128 v[80:83], v8 offset:640
    s_add_u32 s29, s28, s29
    v_add_f32 v22, v22, v88
    v_add_f32 v23, v23, v89
    v_mfma_f32_16x16x32_bf16 v[100:103], v[76:79], a[100:103], v[100:103]
    ds_read_b128 v[76:79], v8 offset:576
    s_lshr_b32 s28, s34, 5
    v_cvt_pk_bf16_f32 v104, v88, v89
    v_mfma_f32_16x16x32_bf16 v[100:103], v[72:75], a[96:99], v[100:103]
    ds_read_b128 v[72:75], v8 offset:512
    s_lshl_b32 s28, s28, 19
    v_exp_f32 v92, v92
    v_mfma_f32_16x16x32_bf16 v[160:163], v[112:115], v[108:111], v[160:163]
    s_add_u32 s49, s28, s29
    s_add_u32 m0, s33, 25344
    v_exp_f32 v93, v93
    v_mfma_f32_16x16x32_bf16 v[188:191], v[116:119], v[108:111], v[188:191]
    s_add_u32 s34, s34, 1
    v_add_f32 v22, v22, v90
    v_add_f32 v23, v23, v91
    v_mfma_f32_16x16x32_bf16 v[216:219], v[120:123], v[108:111], v[216:219]
    s_nop 0
    v_cvt_pk_bf16_f32 v105, v90, v91
    v_mfma_f32_16x16x32_bf16 v[244:247], v[124:127], v[108:111], v[244:247]
    buffer_load_dwordx4 v7, s[4:7], s49 offen offset:0 nt lds
    v_exp_f32 v94, v94
    v_mfma_f32_16x16x32_bf16 a[128:131], v[128:131], v[108:111], a[128:131]
    s_add_u32 m0, m0, s96
    v_exp_f32 v95, v95
    v_mfma_f32_16x16x32_bf16 a[156:159], v[132:135], v[108:111], a[156:159]
    s_nop 0
    v_add_f32 v22, v22, v92
    v_add_f32 v23, v23, v93
    v_mfma_f32_16x16x32_bf16 a[184:187], v[136:139], v[108:111], a[184:187]
    buffer_load_dwordx4 v7, s[4:7], s49 offen offset:256 nt lds
    v_cvt_pk_bf16_f32 v106, v92, v93
    v_add_f32 v22, v22, v94
    v_mfma_f32_16x16x32_bf16 a[212:215], v[140:143], v[108:111], a[212:215]
    s_add_u32 m0, m0, s97
    v_add_f32 v23, v23, v95
    v_cvt_pk_bf16_f32 v107, v94, v95
    s_lshl_b32 s30, s2, 2
    s_add_u32 s30, s30, s20
    s_mul_i32 s30, s30, 28672
    v_lshlrev_b32 v4, 4, v1
    buffer_load_dwordx4 a[0:3], v4, s[12:15], s30 offen offset:0
    buffer_load_dwordx4 a[4:7], v4, s[12:15], s30 offen offset:1024
    buffer_load_dwordx4 a[8:11], v4, s[12:15], s30 offen offset:2048
    buffer_load_dwordx4 a[12:15], v4, s[12:15], s30 offen offset:3072
    s_add_u32 s30, s30, 4096
    buffer_load_dwordx4 a[16:19], v4, s[12:15], s30 offen offset:0
    buffer_load_dwordx4 a[20:23], v4, s[12:15], s30 offen offset:1024
    buffer_load_dwordx4 a[24:27], v4, s[12:15], s30 offen offset:2048
    buffer_load_dwordx4 a[28:31], v4, s[12:15], s30 offen offset:3072
    s_add_u32 s30, s30, 4096
    buffer_load_dwordx4 a[32:35], v4, s[12:15], s30 offen offset:0
    buffer_load_dwordx4 a[36:39], v4, s[12:15], s30 offen offset:1024
    buffer_load_dwordx4 a[40:43], v4, s[12:15], s30 offen offset:2048
    buffer_load_dwordx4 a[44:47], v4, s[12:15], s30 offen offset:3072
    s_add_u32 s30, s30, 4096
    buffer_load_dwordx4 a[48:51], v4, s[12:15], s30 offen offset:0
    buffer_load_dwordx4 a[52:55], v4, s[12:15], s30 offen offset:1024
    buffer_load_dwordx4 a[56:59], v4, s[12:15], s30 offen offset:2048
    buffer_load_dwordx4 a[60:63], v4, s[12:15], s30 offen offset:3072
    s_add_u32 s30, s30, 4096
    buffer_load_dwordx4 a[64:67], v4, s[12:15], s30 offen offset:0
    buffer_load_dwordx4 a[68:71], v4, s[12:15], s30 offen offset:1024
    buffer_load_dwordx4 a[72:75], v4, s[12:15], s30 offen offset:2048
    buffer_load_dwordx4 a[76:79], v4, s[12:15], s30 offen offset:3072
    s_add_u32 s30, s30, 4096
    buffer_load_dwordx4 a[80:83], v4, s[12:15], s30 offen offset:0
    buffer_load_dwordx4 a[84:87], v4, s[12:15], s30 offen offset:1024
    buffer_load_dwordx4 a[88:91], v4, s[12:15], s30 offen offset:2048
    buffer_load_dwordx4 a[92:95], v4, s[12:15], s30 offen offset:3072
    s_add_u32 s30, s30, 4096
    buffer_load_dwordx4 a[96:99], v4, s[12:15], s30 offen offset:0
    buffer_load_dwordx4 a[100:103], v4, s[12:15], s30 offen offset:1024
    buffer_load_dwordx4 a[104:107], v4, s[12:15], s30 offen offset:2048
    buffer_load_dwordx4 a[108:111], v4, s[12:15], s30 offen offset:3072
    s_nop 1
    v_mfma_f32_16x16x32_bf16 v[164:167], v[112:115], v[104:107], v[164:167]
    s_nop 0
    buffer_load_dwordx4 v7, s[4:7], s49 offen offset:512 nt lds
    v_exp_f32 v96, v96
    v_mfma_f32_16x16x32_bf16 v[192:195], v[116:119], v[104:107], v[192:195]
    s_add_u32 m0, m0, s96
    s_nop 0
    v_exp_f32 v97, v97
    v_exp_f32 v98, v98
    v_mfma_f32_16x16x32_bf16 v[220:223], v[120:123], v[104:107], v[220:223]
    buffer_load_dwordx4 v7, s[4:7], s49 offen offset:768 nt lds
    s_add_u32 m0, m0, s97
    v_exp_f32 v99, v99
    v_add_f32 v24, v24, v96
    v_add_f32 v25, v25, v97
    v_mfma_f32_16x16x32_bf16 v[248:251], v[124:127], v[104:107], v[248:251]
    s_nop 0
    buffer_load_dwordx4 v7, s[4:7], s49 offen offset:1024 nt lds
    v_cvt_pk_bf16_f32 v108, v96, v97
    v_exp_f32 v100, v100
    v_mfma_f32_16x16x32_bf16 a[132:135], v[128:131], v[104:107], a[132:135]
    s_add_u32 m0, m0, s96
    s_nop 0
    buffer_load_dwordx4 v7, s[4:7], s49 offen offset:1280 nt lds
    v_exp_f32 v101, v101
    v_add_f32 v24, v24, v98
    v_add_f32 v25, v25, v99
    v_mfma_f32_16x16x32_bf16 a[160:163], v[132:135], v[104:107], a[160:163]
    s_add_u32 m0, m0, s97
    s_nop 0
    v_cvt_pk_bf16_f32 v109, v98, v99
    v_exp_f32 v102, v102
    v_mfma_f32_16x16x32_bf16 a[188:191], v[136:139], v[104:107], a[188:191]
    buffer_load_dwordx4 v7, s[4:7], s49 offen offset:1536 nt lds
    s_add_u32 m0, m0, s96
    v_exp_f32 v103, v103
    v_add_f32 v24, v24, v100
    v_add_f32 v25, v25, v101
    v_mfma_f32_16x16x32_bf16 a[216:219], v[140:143], v[104:107], a[216:219]
    s_nop 0
    buffer_load_dwordx4 v7, s[4:7], s49 offen offset:1792 nt lds
    v_cvt_pk_bf16_f32 v110, v100, v101
    v_add_f32 v24, v24, v102
    v_add_f32 v25, v25, v103
    v_cvt_pk_bf16_f32 v111, v102, v103
L_at_aepi:
    s_nop 1
    s_waitcnt lgkmcnt(0)
    v_mfma_f32_16x16x32_bf16 v[168:171], v[112:115], v[108:111], v[168:171]
    v_add_f32 v12, v12, v13
    v_add_f32 v14, v14, v15
    v_add_f32 v16, v16, v17
    v_add_f32 v18, v18, v19
    v_add_f32 v20, v20, v21
    v_add_f32 v22, v22, v23
    v_mfma_f32_16x16x32_bf16 v[196:199], v[116:119], v[108:111], v[196:199]
    v_add_f32 v24, v24, v25
    v_mov_b32 v88, v12
    v_mov_b32 v89, v14
    v_mov_b32 v90, v16
    v_mov_b32 v91, v18
    v_mov_b32 v92, v20
    v_mfma_f32_16x16x32_bf16 v[224:227], v[120:123], v[108:111], v[224:227]
    v_mov_b32 v93, v22
    v_mov_b32 v94, v24
    v_permlane16_swap_b32 v12, v88
    v_permlane16_swap_b32 v14, v89
    v_permlane16_swap_b32 v16, v90
    v_permlane16_swap_b32 v18, v91
    v_mfma_f32_16x16x32_bf16 v[252:255], v[124:127], v[108:111], v[252:255]
    v_permlane16_swap_b32 v20, v92
    v_permlane16_swap_b32 v22, v93
    v_permlane16_swap_b32 v24, v94
    v_add_f32 v12, v12, v88
    v_add_f32 v14, v14, v89
    v_add_f32 v16, v16, v90
    v_mfma_f32_16x16x32_bf16 a[136:139], v[128:131], v[108:111], a[136:139]
    v_add_f32 v18, v18, v91
    v_add_f32 v20, v20, v92
    v_add_f32 v22, v22, v93
    v_add_f32 v24, v24, v94
    v_mov_b32 v88, v12
    v_mov_b32 v89, v14
    v_mfma_f32_16x16x32_bf16 a[164:167], v[132:135], v[108:111], a[164:167]
    v_mov_b32 v90, v16
    v_mov_b32 v91, v18
    v_mov_b32 v92, v20
    v_mov_b32 v93, v22
    v_mov_b32 v94, v24
    v_permlane32_swap_b32 v12, v88
    v_mfma_f32_16x16x32_bf16 a[192:195], v[136:139], v[108:111], a[192:195]
    v_permlane32_swap_b32 v14, v89
    v_permlane32_swap_b32 v16, v90
    v_permlane32_swap_b32 v18, v91
    v_permlane32_swap_b32 v20, v92
    v_permlane32_swap_b32 v22, v93
    v_permlane32_swap_b32 v24, v94
    v_mfma_f32_16x16x32_bf16 a[220:223], v[140:143], v[108:111], a[220:223]
    v_add_f32 v12, v12, v88
    v_add_f32 v14, v14, v89
    v_add_f32 v16, v16, v90
    v_add_f32 v18, v18, v91
    v_add_f32 v20, v20, v92
    v_add_f32 v22, v22, v93
    v_add_f32 v24, v24, v94
    v_rcp_f32 v28, v12
    v_rcp_f32 v32, v14
    v_rcp_f32 v36, v16
    v_rcp_f32 v40, v18
    v_rcp_f32 v44, v20
    v_rcp_f32 v48, v22
    v_rcp_f32 v52, v24
    v_add_f32 v90, v12, v14
    v_add_f32 v91, v16, v18
    v_add_f32 v92, v20, v22
    v_add_f32 v90, v90, v24
    v_add_f32 v91, v91, v92
    v_add_f32 v90, v90, v91
    v_cmp_nge_f32 vcc, s32, v90
    v_mov_b32 v12, 0xff800000
    v_mov_b32 v14, 0xff800000
    v_mov_b32 v16, 0xff800000
    v_mov_b32 v18, 0xff800000
    v_mov_b32 v20, 0xff800000
    v_mov_b32 v22, 0xff800000
    v_mov_b32 v24, 0xff800000
    s_cmp_eq_u64 vcc, 0
    s_cbranch_scc1 L_at_noflag
    s_lshl_b32 s29, s21, 2
    s_add_u32 s29, s29, 75996
    v_mov_b32 v90, s29
    v_mov_b32 v91, 1
    ds_write_b32 v90, v91
L_at_noflag:
    s_mul_i32 s31, s21, 114688
    s_add_u32 s31, s31, s24
    s_sub_u32 s31, s31, 114688
    v_pk_mul_f32 v[144:145], v[144:145], v[28:29] op_sel_hi:[1,0]
    v_pk_mul_f32 v[146:147], v[146:147], v[28:29] op_sel_hi:[1,0]
    v_pk_mul_f32 v[148:149], v[148:149], v[32:33] op_sel_hi:[1,0]
    v_pk_mul_f32 v[150:151], v[150:151], v[32:33] op_sel_hi:[1,0]
    v_pk_mul_f32 v[152:153], v[152:153], v[36:37] op_sel_hi:[1,0]
    v_pk_mul_f32 v[154:155], v[154:155], v[36:37] op_sel_hi:[1,0]
    v_pk_mul_f32 v[156:157], v[156:157], v[40:41] op_sel_hi:[1,0]
    v_pk_mul_f32 v[158:159], v[158:159], v[40:41] op_sel_hi:[1,0]
    v_pk_mul_f32 v[160:161], v[160:161], v[44:45] op_sel_hi:[1,0]
    v_pk_mul_f32 v[162:163], v[162:163], v[44:45] op_sel_hi:[1,0]
    v_pk_mul_f32 v[164:165], v[164:165], v[48:49] op_sel_hi:[1,0]
    v_pk_mul_f32 v[166:167], v[166:167], v[48:49] op_sel_hi:[1,0]
    v_pk_mul_f32 v[168:169], v[168:169], v[52:53] op_sel_hi:[1,0]
    v_pk_mul_f32 v[170:171], v[170:171], v[52:53] op_sel_hi:[1,0]
    v_pk_mul_f32 v[172:173], v[172:173], v[28:29] op_sel_hi:[1,0]
    v_pk_mul_f32 v[174:175], v[174:175], v[28:29] op_sel_hi:[1,0]
    v_pk_mul_f32 v[176:177], v[176:177], v[32:33] op_sel_hi:[1,0]
    v_pk_mul_f32 v[178:179], v[178:179], v[32:33] op_sel_hi:[1,0]
    v_pk_mul_f32 v[180:181], v[180:181], v[36:37] op_sel_hi:[1,0]
    v_pk_mul_f32 v[182:183], v[182:183], v[36:37] op_sel_hi:[1,0]
    v_pk_mul_f32 v[184:185], v[184:185], v[40:41] op_sel_hi:[1,0]
    v_pk_mul_f32 v[186:187], v[186:187], v[40:41] op_sel_hi:[1,0]
    v_pk_mul_f32 v[188:189], v[188:189], v[44:45] op_sel_hi:[1,0]
    v_pk_mul_f32 v[190:191], v[190:191], v[44:45] op_sel_hi:[1,0]
    v_pk_mul_f32 v[192:193], v[192:193], v[48:49] op_sel_hi:[1,0]
    v_pk_mul_f32 v[194:195], v[194:195], v[48:49] op_sel_hi:[1,0]
    v_pk_mul_f32 v[196:197], v[196:197], v[52:53] op_sel_hi:[1,0]
    v_pk_mul_f32 v[198:199], v[198:199], v[52:53] op_sel_hi:[1,0]
    v_cvt_pk_bf16_f32 v88, v144, v145
    v_cvt_pk_bf16_f32 v89, v146, v147
    v_cvt_pk_bf16_f32 v90, v172, v173
    v_cvt_pk_bf16_f32 v91, v174, v175
    v_cvt_pk_bf16_f32 v92, v148, v149
    v_cvt_pk_bf16_f32 v93, v150, v151
    v_cvt_pk_bf16_f32 v94, v176, v177
    v_cvt_pk_bf16_f32 v95, v178, v179
    v_cvt_pk_bf16_f32 v96, v152, v153
    v_cvt_pk_bf16_f32 v97, v154, v155
    v_cvt_pk_bf16_f32 v98, v180, v181
    v_cvt_pk_bf16_f32 v99, v182, v183
    v_cvt_pk_bf16_f32 v100, v156, v157
    v_cvt_pk_bf16_f32 v101, v158, v159
    v_cvt_pk_bf16_f32 v102, v184, v185
    v_cvt_pk_bf16_f32 v103, v186, v187
    v_cvt_pk_bf16_f32 v104, v160, v161
    v_cvt_pk_bf16_f32 v105, v162, v163
    v_cvt_pk_bf16_f32 v106, v188, v189
    v_cvt_pk_bf16_f32 v107, v190, v191
    v_cvt_pk_bf16_f32 v108, v164, v165
    v_cvt_pk_bf16_f32 v109, v166, v167
    v_cvt_pk_bf16_f32 v110, v192, v193
    v_cvt_pk_bf16_f32 v111, v194, v195
    v_cvt_pk_bf16_f32 v112, v168, v169
    v_cvt_pk_bf16_f32 v113, v170, v171
    v_cvt_pk_bf16_f32 v114, v196, v197
    v_cvt_pk_bf16_f32 v115, v198, v199
    s_mov_b32 s28, s31
    buffer_store_dwordx4 v[88:91], v10, s[12:15], s28 offen offset:0 sc0 sc1
    s_add_u32 s28, s28, 4096
    buffer_store_dwordx4 v[92:95], v10, s[12:15], s28 offen offset:0 sc0 sc1
    s_add_u32 s28, s28, 4096
    buffer_store_dwordx4 v[96:99], v10, s[12:15], s28 offen offset:0 sc0 sc1
    s_add_u32 s28, s28, 4096
    buffer_store_dwordx4 v[100:103], v10, s[12:15], s28 offen offset:0 sc0 sc1
    s_add_u32 s28, s28, 4096
    buffer_store_dwordx4 v[104:107], v10, s[12:15], s28 offen offset:0 sc0 sc1
    s_add_u32 s28, s28, 4096
    buffer_store_dwordx4 v[108:111], v10, s[12:15], s28 offen offset:0 sc0 sc1
    s_add_u32 s28, s28, 4096
    buffer_store_dwordx4 v[112:115], v10, s[12:15], s28 offen offset:0 sc0 sc1
    v_pk_mul_f32 v[200:201], v[200:201], v[28:29] op_sel_hi:[1,0]
    v_pk_mul_f32 v[202:203], v[202:203], v[28:29] op_sel_hi:[1,0]
    v_pk_mul_f32 v[204:205], v[204:205], v[32:33] op_sel_hi:[1,0]
    v_pk_mul_f32 v[206:207], v[206:207], v[32:33] op_sel_hi:[1,0]
    v_pk_mul_f32 v[208:209], v[208:209], v[36:37] op_sel_hi:[1,0]
    v_pk_mul_f32 v[210:211], v[210:211], v[36:37] op_sel_hi:[1,0]
    v_pk_mul_f32 v[212:213], v[212:213], v[40:41] op_sel_hi:[1,0]
    v_pk_mul_f32 v[214:215], v[214:215], v[40:41] op_sel_hi:[1,0]
    v_pk_mul_f32 v[216:217], v[216:217], v[44:45] op_sel_hi:[1,0]
    v_pk_mul_f32 v[218:219], v[218:219], v[44:45] op_sel_hi:[1,0]
    v_pk_mul_f32 v[220:221], v[220:221], v[48:49] op_sel_hi:[1,0]
    v_pk_mul_f32 v[222:223], v[222:223], v[48:49] op_sel_hi:[1,0]
    v_pk_mul_f32 v[224:225], v[224:225], v[52:53] op_sel_hi:[1,0]
    v_pk_mul_f32 v[226:227], v[226:227], v[52:53] op_sel_hi:[1,0]
    v_pk_mul_f32 v[228:229], v[228:229], v[28:29] op_sel_hi:[1,0]
    v_pk_mul_f32 v[230:231], v[230:231], v[28:29] op_sel_hi:[1,0]
    v_pk_mul_f32 v[232:233], v[232:233], v[32:33] op_sel_hi:[1,0]
    v_pk_mul_f32 v[234:235], v[234:235], v[32:33] op_sel_hi:[1,0]
    v_pk_mul_f32 v[236:237], v[236:237], v[36:37] op_sel_hi:[1,0]
    v_pk_mul_f32 v[238:239], v[238:239], v[36:37] op_sel_hi:[1,0]
    v_pk_mul_f32 v[240:241], v[240:241], v[40:41] op_sel_hi:[1,0]
    v_pk_mul_f32 v[242:243], v[242:243], v[40:41] op_sel_hi:[1,0]
    v_pk_mul_f32 v[244:245], v[244:245], v[44:45] op_sel_hi:[1,0]
    v_pk_mul_f32 v[246:247], v[246:247], v[44:45] op_sel_hi:[1,0]
    v_pk_mul_f32 v[248:249], v[248:249], v[48:49] op_sel_hi:[1,0]
    v_pk_mul_f32 v[250:251], v[250:251], v[48:49] op_sel_hi:[1,0]
    v_pk_mul_f32 v[252:253], v[252:253], v[52:53] op_sel_hi:[1,0]
    v_pk_mul_f32 v[254:255], v[254:255], v[52:53] op_sel_hi:[1,0]
    v_cvt_pk_bf16_f32 v116, v200, v201
    v_cvt_pk_bf16_f32 v117, v202, v203
    v_cvt_pk_bf16_f32 v118, v228, v229
    v_cvt_pk_bf16_f32 v119, v230, v231
    v_cvt_pk_bf16_f32 v120, v204, v205
    v_cvt_pk_bf16_f32 v121, v206, v207
    v_cvt_pk_bf16_f32 v122, v232, v233
    v_cvt_pk_bf16_f32 v123, v234, v235
    v_cvt_pk_bf16_f32 v124, v208, v209
    v_cvt_pk_bf16_f32 v125, v210, v211
    v_cvt_pk_bf16_f32 v126, v236, v237
    v_cvt_pk_bf16_f32 v127, v238, v239
    v_cvt_pk_bf16_f32 v128, v212, v213
    v_cvt_pk_bf16_f32 v129, v214, v215
    v_cvt_pk_bf16_f32 v130, v240, v241
    v_cvt_pk_bf16_f32 v131, v242, v243
    v_cvt_pk_bf16_f32 v132, v216, v217
    v_cvt_pk_bf16_f32 v133, v218, v219
    v_cvt_pk_bf16_f32 v134, v244, v245
    v_cvt_pk_bf16_f32 v135, v246, v247
    v_cvt_pk_bf16_f32 v136, v220, v221
    v_cvt_pk_bf16_f32 v137, v222, v223
    v_cvt_pk_bf16_f32 v138, v248, v249
    v_cvt_pk_bf16_f32 v139, v250, v251
    v_cvt_pk_bf16_f32 v140, v224, v225
    v_cvt_pk_bf16_f32 v141, v226, v227
    v_cvt_pk_bf16_f32 v142, v252, v253
    v_cvt_pk_bf16_f32 v143, v254, v255
    s_mov_b32 s28, s31
    buffer_store_dwordx4 v[116:119], v10, s[12:15], s28 offen offset:1024 sc0 sc1
    s_add_u32 s28, s28, 4096
    buffer_store_dwordx4 v[120:123], v10, s[12:15], s28 offen offset:1024 sc0 sc1
    s_add_u32 s28, s28, 4096
    buffer_store_dwordx4 v[124:127], v10, s[12:15], s28 offen offset:1024 sc0 sc1
    s_add_u32 s28, s28, 4096
    buffer_store_dwordx4 v[128:131], v10, s[12:15], s28 offen offset:1024 sc0 sc1
    s_add_u32 s28, s28, 4096
    buffer_store_dwordx4 v[132:135], v10, s[12:15], s28 offen offset:1024 sc0 sc1
    s_add_u32 s28, s28, 4096
    buffer_store_dwordx4 v[136:139], v10, s[12:15], s28 offen offset:1024 sc0 sc1
    s_add_u32 s28, s28, 4096
    buffer_store_dwordx4 v[140:143], v10, s[12:15], s28 offen offset:1024 sc0 sc1
    v_accvgpr_read_b32 v144, a112
    v_accvgpr_read_b32 v145, a113
    v_accvgpr_read_b32 v146, a114
    v_accvgpr_read_b32 v147, a115
    v_accvgpr_read_b32 v148, a116
    v_accvgpr_read_b32 v149, a117
    v_accvgpr_read_b32 v150, a118
    v_accvgpr_read_b32 v151, a119
    v_accvgpr_read_b32 v152, a120
    v_accvgpr_read_b32 v153, a121
    v_accvgpr_read_b32 v154, a122
    v_accvgpr_read_b32 v155, a123
    v_accvgpr_read_b32 v156, a124
    v_accvgpr_read_b32 v157, a125
    v_accvgpr_read_b32 v158, a126
    v_accvgpr_read_b32 v159, a127
    v_accvgpr_read_b32 v160, a128
    v_accvgpr_read_b32 v161, a129
    v_accvgpr_read_b32 v162, a130
    v_accvgpr_read_b32 v163, a131
    v_accvgpr_read_b32 v164, a132
    v_accvgpr_read_b32 v165, a133
    v_accvgpr_read_b32 v166, a134
    v_accvgpr_read_b32 v167, a135
    v_accvgpr_read_b32 v168, a136
    v_accvgpr_read_b32 v169, a137
    v_accvgpr_read_b32 v170, a138
    v_accvgpr_read_b32 v171, a139
    v_accvgpr_read_b32 v172, a140
    v_accvgpr_read_b32 v173, a141
    v_accvgpr_read_b32 v174, a142
    v_accvgpr_read_b32 v175, a143
    v_accvgpr_read_b32 v176, a144
    v_accvgpr_read_b32 v177, a145
    v_accvgpr_read_b32 v178, a146
    v_accvgpr_read_b32 v179, a147
    v_accvgpr_read_b32 v180, a148
    v_accvgpr_read_b32 v181, a149
    v_accvgpr_read_b32 v182, a150
    v_accvgpr_read_b32 v183, a151
    v_accvgpr_read_b32 v184, a152
    v_accvgpr_read_b32 v185, a153
    v_accvgpr_read_b32 v186, a154
    v_accvgpr_read_b32 v187, a155
    v_accvgpr_read_b32 v188, a156
    v_accvgpr_read_b32 v189, a157
    v_accvgpr_read_b32 v190, a158
    v_accvgpr_read_b32 v191, a159
    v_accvgpr_read_b32 v192, a160
    v_accvgpr_read_b32 v193, a161
    v_accvgpr_read_b32 v194, a162
    v_accvgpr_read_b32 v195, a163
    v_accvgpr_read_b32 v196, a164
    v_accvgpr_read_b32 v197, a165
    v_accvgpr_read_b32 v198, a166
    v_accvgpr_read_b32 v199, a167
    v_pk_mul_f32 v[144:145], v[144:145], v[28:29] op_sel_hi:[1,0]
    v_pk_mul_f32 v[146:147], v[146:147], v[28:29] op_sel_hi:[1,0]
    v_pk_mul_f32 v[148:149], v[148:149], v[32:33] op_sel_hi:[1,0]
    v_pk_mul_f32 v[150:151], v[150:151], v[32:33] op_sel_hi:[1,0]
    v_pk_mul_f32 v[152:153], v[152:153], v[36:37] op_sel_hi:[1,0]
    v_pk_mul_f32 v[154:155], v[154:155], v[36:37] op_sel_hi:[1,0]
    v_pk_mul_f32 v[156:157], v[156:157], v[40:41] op_sel_hi:[1,0]
    v_pk_mul_f32 v[158:159], v[158:159], v[40:41] op_sel_hi:[1,0]
    v_pk_mul_f32 v[160:161], v[160:161], v[44:45] op_sel_hi:[1,0]
    v_pk_mul_f32 v[162:163], v[162:163], v[44:45] op_sel_hi:[1,0]
    v_pk_mul_f32 v[164:165], v[164:165], v[48:49] op_sel_hi:[1,0]
    v_pk_mul_f32 v[166:167], v[166:167], v[48:49] op_sel_hi:[1,0]
    v_pk_mul_f32 v[168:169], v[168:169], v[52:53] op_sel_hi:[1,0]
    v_pk_mul_f32 v[170:171], v[170:171], v[52:53] op_sel_hi:[1,0]
    v_pk_mul_f32 v[172:173], v[172:173], v[28:29] op_sel_hi:[1,0]
    v_pk_mul_f32 v[174:175], v[174:175], v[28:29] op_sel_hi:[1,0]
    v_pk_mul_f32 v[176:177], v[176:177], v[32:33] op_sel_hi:[1,0]
    v_pk_mul_f32 v[178:179], v[178:179], v[32:33] op_sel_hi:[1,0]
    v_pk_mul_f32 v[180:181], v[180:181], v[36:37] op_sel_hi:[1,0]
    v_pk_mul_f32 v[182:183], v[182:183], v[36:37] op_sel_hi:[1,0]
    v_pk_mul_f32 v[184:185], v[184:185], v[40:41] op_sel_hi:[1,0]
    v_pk_mul_f32 v[186:187], v[186:187], v[40:41] op_sel_hi:[1,0]
    v_pk_mul_f32 v[188:189], v[188:189], v[44:45] op_sel_hi:[1,0]
    v_pk_mul_f32 v[190:191], v[190:191], v[44:45] op_sel_hi:[1,0]
    v_pk_mul_f32 v[192:193], v[192:193], v[48:49] op_sel_hi:[1,0]
    v_pk_mul_f32 v[194:195], v[194:195], v[48:49] op_sel_hi:[1,0]
    v_pk_mul_f32 v[196:197], v[196:197], v[52:53] op_sel_hi:[1,0]
    v_pk_mul_f32 v[198:199], v[198:199], v[52:53] op_sel_hi:[1,0]
    v_cvt_pk_bf16_f32 v88, v144, v145
    v_cvt_pk_bf16_f32 v89, v146, v147
    v_cvt_pk_bf16_f32 v90, v172, v173
    v_cvt_pk_bf16_f32 v91, v174, v175
    v_cvt_pk_bf16_f32 v92, v148, v149
    v_cvt_pk_bf16_f32 v93, v150, v151
    v_cvt_pk_bf16_f32 v94, v176, v177
    v_cvt_pk_bf16_f32 v95, v178, v179
    v_cvt_pk_bf16_f32 v96, v152, v153
    v_cvt_pk_bf16_f32 v97, v154, v155
    v_cvt_pk_bf16_f32 v98, v180, v181
    v_cvt_pk_bf16_f32 v99, v182, v183
    v_cvt_pk_bf16_f32 v100, v156, v157
    v_cvt_pk_bf16_f32 v101, v158, v159
    v_cvt_pk_bf16_f32 v102, v184, v185
    v_cvt_pk_bf16_f32 v103, v186, v187
    v_cvt_pk_bf16_f32 v104, v160, v161
    v_cvt_pk_bf16_f32 v105, v162, v163
    v_cvt_pk_bf16_f32 v106, v188, v189
    v_cvt_pk_bf16_f32 v107, v190, v191
    v_cvt_pk_bf16_f32 v108, v164, v165
    v_cvt_pk_bf16_f32 v109, v166, v167
    v_cvt_pk_bf16_f32 v110, v192, v193
    v_cvt_pk_bf16_f32 v111, v194, v195
    v_cvt_pk_bf16_f32 v112, v168, v169
    v_cvt_pk_bf16_f32 v113, v170, v171
    v_cvt_pk_bf16_f32 v114, v196, v197
    v_cvt_pk_bf16_f32 v115, v198, v199
    s_mov_b32 s28, s31
    buffer_store_dwordx4 v[88:91], v10, s[12:15], s28 offen offset:2048 sc0 sc1
    s_add_u32 s28, s28, 4096
    buffer_store_dwordx4 v[92:95], v10, s[12:15], s28 offen offset:2048 sc0 sc1
    s_add_u32 s28, s28, 4096
    buffer_store_dwordx4 v[96:99], v10, s[12:15], s28 offen offset:2048 sc0 sc1
    s_add_u32 s28, s28, 4096
    buffer_store_dwordx4 v[100:103], v10, s[12:15], s28 offen offset:2048 sc0 sc1
    s_add_u32 s28, s28, 4096
    buffer_store_dwordx4 v[104:107], v10, s[12:15], s28 offen offset:2048 sc0 sc1
    s_add_u32 s28, s28, 4096
    buffer_store_dwordx4 v[108:111], v10, s[12:15], s28 offen offset:2048 sc0 sc1
    s_add_u32 s28, s28, 4096
    buffer_store_dwordx4 v[112:115], v10, s[12:15], s28 offen offset:2048 sc0 sc1
    v_accvgpr_read_b32 v200, a168
    v_accvgpr_read_b32 v201, a169
    v_accvgpr_read_b32 v202, a170
    v_accvgpr_read_b32 v203, a171
    v_accvgpr_read_b32 v204, a172
    v_accvgpr_read_b32 v205, a173
    v_accvgpr_read_b32 v206, a174
    v_accvgpr_read_b32 v207, a175
    v_accvgpr_read_b32 v208, a176
    v_accvgpr_read_b32 v209, a177
    v_accvgpr_read_b32 v210, a178
    v_accvgpr_read_b32 v211, a179
    v_accvgpr_read_b32 v212, a180
    v_accvgpr_read_b32 v213, a181
    v_accvgpr_read_b32 v214, a182
    v_accvgpr_read_b32 v215, a183
    v_accvgpr_read_b32 v216, a184
    v_accvgpr_read_b32 v217, a185
    v_accvgpr_read_b32 v218, a186
    v_accvgpr_read_b32 v219, a187
    v_accvgpr_read_b32 v220, a188
    v_accvgpr_read_b32 v221, a189
    v_accvgpr_read_b32 v222, a190
    v_accvgpr_read_b32 v223, a191
    v_accvgpr_read_b32 v224, a192
    v_accvgpr_read_b32 v225, a193
    v_accvgpr_read_b32 v226, a194
    v_accvgpr_read_b32 v227, a195
    v_accvgpr_read_b32 v228, a196
    v_accvgpr_read_b32 v229, a197
    v_accvgpr_read_b32 v230, a198
    v_accvgpr_read_b32 v231, a199
    v_accvgpr_read_b32 v232, a200
    v_accvgpr_read_b32 v233, a201
    v_accvgpr_read_b32 v234, a202
    v_accvgpr_read_b32 v235, a203
    v_accvgpr_read_b32 v236, a204
    v_accvgpr_read_b32 v237, a205
    v_accvgpr_read_b32 v238, a206
    v_accvgpr_read_b32 v239, a207
    v_accvgpr_read_b32 v240, a208
    v_accvgpr_read_b32 v241, a209
    v_accvgpr_read_b32 v242, a210
    v_accvgpr_read_b32 v243, a211
    v_accvgpr_read_b32 v244, a212
    v_accvgpr_read_b32 v245, a213
    v_accvgpr_read_b32 v246, a214
    v_accvgpr_read_b32 v247, a215
    v_accvgpr_read_b32 v248, a216
    v_accvgpr_read_b32 v249, a217
    v_accvgpr_read_b32 v250, a218
    v_accvgpr_read_b32 v251, a219
    v_accvgpr_read_b32 v252, a220
    v_accvgpr_read_b32 v253, a221
    v_accvgpr_read_b32 v254, a222
    v_accvgpr_read_b32 v255, a223
    v_pk_mul_f32 v[200:201], v[200:201], v[28:29] op_sel_hi:[1,0]
    v_pk_mul_f32 v[202:203], v[202:203], v[28:29] op_sel_hi:[1,0]
    v_pk_mul_f32 v[204:205], v[204:205], v[32:33] op_sel_hi:[1,0]
    v_pk_mul_f32 v[206:207], v[206:207], v[32:33] op_sel_hi:[1,0]
    v_pk_mul_f32 v[208:209], v[208:209], v[36:37] op_sel_hi:[1,0]
    v_pk_mul_f32 v[210:211], v[210:211], v[36:37] op_sel_hi:[1,0]
    v_pk_mul_f32 v[212:213], v[212:213], v[40:41] op_sel_hi:[1,0]
    v_pk_mul_f32 v[214:215], v[214:215], v[40:41] op_sel_hi:[1,0]
    v_pk_mul_f32 v[216:217], v[216:217], v[44:45] op_sel_hi:[1,0]
    v_pk_mul_f32 v[218:219], v[218:219], v[44:45] op_sel_hi:[1,0]
    v_pk_mul_f32 v[220:221], v[220:221], v[48:49] op_sel_hi:[1,0]
    v_pk_mul_f32 v[222:223], v[222:223], v[48:49] op_sel_hi:[1,0]
    v_pk_mul_f32 v[224:225], v[224:225], v[52:53] op_sel_hi:[1,0]
    v_pk_mul_f32 v[226:227], v[226:227], v[52:53] op_sel_hi:[1,0]
    v_pk_mul_f32 v[228:229], v[228:229], v[28:29] op_sel_hi:[1,0]
    v_pk_mul_f32 v[230:231], v[230:231], v[28:29] op_sel_hi:[1,0]
    v_pk_mul_f32 v[232:233], v[232:233], v[32:33] op_sel_hi:[1,0]
    v_pk_mul_f32 v[234:235], v[234:235], v[32:33] op_sel_hi:[1,0]
    v_pk_mul_f32 v[236:237], v[236:237], v[36:37] op_sel_hi:[1,0]
    v_pk_mul_f32 v[238:239], v[238:239], v[36:37] op_sel_hi:[1,0]
    v_pk_mul_f32 v[240:241], v[240:241], v[40:41] op_sel_hi:[1,0]
    v_pk_mul_f32 v[242:243], v[242:243], v[40:41] op_sel_hi:[1,0]
    v_pk_mul_f32 v[244:245], v[244:245], v[44:45] op_sel_hi:[1,0]
    v_pk_mul_f32 v[246:247], v[246:247], v[44:45] op_sel_hi:[1,0]
    v_pk_mul_f32 v[248:249], v[248:249], v[48:49] op_sel_hi:[1,0]
    v_pk_mul_f32 v[250:251], v[250:251], v[48:49] op_sel_hi:[1,0]
    v_pk_mul_f32 v[252:253], v[252:253], v[52:53] op_sel_hi:[1,0]
    v_pk_mul_f32 v[254:255], v[254:255], v[52:53] op_sel_hi:[1,0]
    v_cvt_pk_bf16_f32 v116, v200, v201
    v_cvt_pk_bf16_f32 v117, v202, v203
    v_cvt_pk_bf16_f32 v118, v228, v229
    v_cvt_pk_bf16_f32 v119, v230, v231
    v_cvt_pk_bf16_f32 v120, v204, v205
    v_cvt_pk_bf16_f32 v121, v206, v207
    v_cvt_pk_bf16_f32 v122, v232, v233
    v_cvt_pk_bf16_f32 v123, v234, v235
    v_cvt_pk_bf16_f32 v124, v208, v209
    v_cvt_pk_bf16_f32 v125, v210, v211
    v_cvt_pk_bf16_f32 v126, v236, v237
    v_cvt_pk_bf16_f32 v127, v238, v239
    v_cvt_pk_bf16_f32 v128, v212, v213
    v_cvt_pk_bf16_f32 v129, v214, v215
    v_cvt_pk_bf16_f32 v130, v240, v241
    v_cvt_pk_bf16_f32 v131, v242, v243
    v_cvt_pk_bf16_f32 v132, v216, v217
    v_cvt_pk_bf16_f32 v133, v218, v219
    v_cvt_pk_bf16_f32 v134, v244, v245
    v_cvt_pk_bf16_f32 v135, v246, v247
    v_cvt_pk_bf16_f32 v136, v220, v221
    v_cvt_pk_bf16_f32 v137, v222, v223
    v_cvt_pk_bf16_f32 v138, v248, v249
    v_cvt_pk_bf16_f32 v139, v250, v251
    v_cvt_pk_bf16_f32 v140, v224, v225
    v_cvt_pk_bf16_f32 v141, v226, v227
    v_cvt_pk_bf16_f32 v142, v252, v253
    v_cvt_pk_bf16_f32 v143, v254, v255
    s_mov_b32 s28, s31
    buffer_store_dwordx4 v[116:119], v10, s[12:15], s28 offen offset:3072 sc0 sc1
    s_add_u32 s28, s28, 4096
    buffer_store_dwordx4 v[120:123], v10, s[12:15], s28 offen offset:3072 sc0 sc1
    s_add_u32 s28, s28, 4096
    buffer_store_dwordx4 v[124:127], v10, s[12:15], s28 offen offset:3072 sc0 sc1
    s_add_u32 s28, s28, 4096
    buffer_store_dwordx4 v[128:131], v10, s[12:15], s28 offen offset:3072 sc0 sc1
    s_add_u32 s28, s28, 4096
    buffer_store_dwordx4 v[132:135], v10, s[12:15], s28 offen offset:3072 sc0 sc1
    s_add_u32 s28, s28, 4096
    buffer_store_dwordx4 v[136:139], v10, s[12:15], s28 offen offset:3072 sc0 sc1
    s_add_u32 s28, s28, 4096
    buffer_store_dwordx4 v[140:143], v10, s[12:15], s28 offen offset:3072 sc0 sc1
    s_nop 1
L_at_nowo2:
    s_mov_b32 s68, 3
    s_cmp_ge_u32 s21, 2
    s_cbranch_scc1 L_at_fin
    s_cmp_eq_u32 s69, 0
    s_cbranch_scc1 L_at_round
    s_waitcnt vmcnt(28)
    s_branch L_at_pre
L_at_fin:
    s_waitcnt lgkmcnt(0)
    s_barrier
    s_cmp_le_u32 s21, s27
    s_cbranch_scc1 L_at_nofb_6868
    s_sub_u32 s28, s21, 1
    s_cmp_eq_u32 s28, s23
    s_cbranch_scc1 L_at_nofb_6868
    s_lshl_b32 s29, s28, 2
    s_add_u32 s29, s29, 76000
    v_mov_b32 v4, s29
    ds_read_b32 v4, v4
    s_waitcnt lgkmcnt(0)
    v_readfirstlane_b32 s29, v4
    s_nop 3
    s_cmp_lg_u32 s29, 0
    s_cbranch_scc1 L_at_fallback
L_at_nofb_6868:
    s_branch L_at_end
L_bw1_460:
    s_sub_u32 s68, s68, 1
    s_waitcnt vmcnt(44) lgkmcnt(0)
    s_branch L_bw2_460
L_bw1_576:
    s_sub_u32 s68, s68, 1
    s_waitcnt vmcnt(36) lgkmcnt(0)
    s_branch L_bw2_576
L_bw1_689:
    s_sub_u32 s68, s68, 1
    s_waitcnt vmcnt(44) lgkmcnt(0)
    s_branch L_bw2_689
L_bw1_3047:
    s_sub_u32 s68, s68, 1
    s_waitcnt vmcnt(44) lgkmcnt(0)
    s_branch L_bw2_3047
L_bw1_3429:
    s_sub_u32 s68, s68, 1
    s_waitcnt vmcnt(44) lgkmcnt(0)
    s_branch L_bw2_3429
L_bw1_3738:
    s_sub_u32 s68, s68, 1
    s_waitcnt vmcnt(44) lgkmcnt(0)
    s_branch L_bw2_3738
L_at_wt0:
    s_and_b32 s28, s2, 127
    s_mul_i32 s28, s28, 40960
    s_mul_i32 s29, s20, 10240
    s_add_u32 s28, s28, s29
    v_lshlrev_b32 v4, 7, v1
    v_and_b32 v5, 15, v1
    v_lshlrev_b32 v5, 7, v5
    buffer_load_dword a250, v4, s[84:87], s28 offen
    s_add_u32 s28, s28, 8192
    buffer_load_dword a251, v5, s[84:87], s28 offen
    s_lshl_b32 s28, s20, 13
    v_lshlrev_b32 v4, 7, v1
    v_add_u32 v4, s28, v4
    v_add_u32 v4, op_kernel - L_pc0, v4
    v_min_u32 v4, L_code_end - L_pc0 - 4, v4
    v_mov_b32 v5, s73
    v_add_co_u32 v4, vcc, s72, v4
    v_addc_co_u32 v5, vcc, 0, v5, vcc
    global_load_dword a250, v[4:5], off
    s_branch L_at_wt0r
L_at_fallback:
    s_sub_u32 s27, s21, 1
    s_mov_b32 s23, s27
    s_mov_b32 s25, 1
    s_mov_b32 s69, 0
    s_mov_b32 s70, 0
    s_mov_b32 s68, 0
    v_mov_b32 v12, 0xff800000
    v_mov_b32 v14, 0xff800000
    v_mov_b32 v16, 0xff800000
    v_mov_b32 v18, 0xff800000
    v_mov_b32 v20, 0xff800000
    v_mov_b32 v22, 0xff800000
    v_mov_b32 v24, 0xff800000
    s_waitcnt vmcnt(0) lgkmcnt(0)
    s_barrier
    s_branch L_at_start
L_at_maxpass:
    s_mov_b32 s25, 0
    s_waitcnt lgkmcnt(0)
    v_and_b32 v2, 15, v1
    v_lshlrev_b32 v2, 8, v2
    v_bfe_u32 v3, v1, 4, 1
    v_lshl_add_u32 v2, v3, 5, v2
    v_bfe_u32 v3, v1, 5, 1
    v_lshl_add_u32 v4, v3, 4, v2
    v_add_u32 v5, 4096, v4
    s_lshl_b32 s29, s21, 19
    s_mov_b32 s22, 0
L_at_mp:
    buffer_load_dwordx4 v[112:115], v4, s[8:11], s29 offen offset:0
    buffer_load_dwordx4 v[116:119], v4, s[8:11], s29 offen offset:64
    buffer_load_dwordx4 v[120:123], v4, s[8:11], s29 offen offset:128
    buffer_load_dwordx4 v[124:127], v4, s[8:11], s29 offen offset:192
    buffer_load_dwordx4 v[128:131], v5, s[8:11], s29 offen offset:0
    buffer_load_dwordx4 v[132:135], v5, s[8:11], s29 offen offset:64
    buffer_load_dwordx4 v[136:139], v5, s[8:11], s29 offen offset:128
    buffer_load_dwordx4 v[140:143], v5, s[8:11], s29 offen offset:192
    s_waitcnt vmcnt(0)
    v_mfma_f32_16x16x32_bf16 v[88:91], v[112:115], a[0:3], 0
    v_mfma_f32_16x16x32_bf16 v[88:91], v[116:119], a[4:7], v[88:91]
    v_mfma_f32_16x16x32_bf16 v[88:91], v[120:123], a[8:11], v[88:91]
    v_mfma_f32_16x16x32_bf16 v[88:91], v[124:127], a[12:15], v[88:91]
    v_mfma_f32_16x16x32_bf16 v[92:95], v[128:131], a[0:3], 0
    v_mfma_f32_16x16x32_bf16 v[92:95], v[132:135], a[4:7], v[92:95]
    v_mfma_f32_16x16x32_bf16 v[92:95], v[136:139], a[8:11], v[92:95]
    v_mfma_f32_16x16x32_bf16 v[92:95], v[140:143], a[12:15], v[92:95]
    s_nop 9
    v_max3_f32 v12, v88, v89, v12
    v_max3_f32 v12, v90, v91, v12
    v_max3_f32 v12, v92, v93, v12
    v_max3_f32 v12, v94, v95, v12
    s_nop 3
    v_mfma_f32_16x16x32_bf16 v[88:91], v[112:115], a[16:19], 0
    v_mfma_f32_16x16x32_bf16 v[88:91], v[116:119], a[20:23], v[88:91]
    v_mfma_f32_16x16x32_bf16 v[88:91], v[120:123], a[24:27], v[88:91]
    v_mfma_f32_16x16x32_bf16 v[88:91], v[124:127], a[28:31], v[88:91]
    v_mfma_f32_16x16x32_bf16 v[92:95], v[128:131], a[16:19], 0
    v_mfma_f32_16x16x32_bf16 v[92:95], v[132:135], a[20:23], v[92:95]
    v_mfma_f32_16x16x32_bf16 v[92:95], v[136:139], a[24:27], v[92:95]
    v_mfma_f32_16x16x32_bf16 v[92:95], v[140:143], a[28:31], v[92:95]
    s_nop 9
    v_max3_f32 v14, v88, v89, v14
    v_max3_f32 v14, v90, v91, v14
    v_max3_f32 v14, v92, v93, v14
    v_max3_f32 v14, v94, v95, v14
    s_nop 3
    v_mfma_f32_16x16x32_bf16 v[88:91], v[112:115], a[32:35], 0
    v_mfma_f32_16x16x32_bf16 v[88:91], v[116:119], a[36:39], v[88:91]
    v_mfma_f32_16x16x32_bf16 v[88:91], v[120:123], a[40:43], v[88:91]
    v_mfma_f32_16x16x32_bf16 v[88:91], v[124:127], a[44:47], v[88:91]
    v_mfma_f32_16x16x32_bf16 v[92:95], v[128:131], a[32:35], 0
    v_mfma_f32_16x16x32_bf16 v[92:95], v[132:135], a[36:39], v[92:95]
    v_mfma_f32_16x16x32_bf16 v[92:95], v[136:139], a[40:43], v[92:95]
    v_mfma_f32_16x16x32_bf16 v[92:95], v[140:143], a[44:47], v[92:95]
    s_nop 9
    v_max3_f32 v16, v88, v89, v16
    v_max3_f32 v16, v90, v91, v16
    v_max3_f32 v16, v92, v93, v16
    v_max3_f32 v16, v94, v95, v16
    s_nop 3
    v_mfma_f32_16x16x32_bf16 v[88:91], v[112:115], a[48:51], 0
    v_mfma_f32_16x16x32_bf16 v[88:91], v[116:119], a[52:55], v[88:91]
    v_mfma_f32_16x16x32_bf16 v[88:91], v[120:123], a[56:59], v[88:91]
    v_mfma_f32_16x16x32_bf16 v[88:91], v[124:127], a[60:63], v[88:91]
    v_mfma_f32_16x16x32_bf16 v[92:95], v[128:131], a[48:51], 0
    v_mfma_f32_16x16x32_bf16 v[92:95], v[132:135], a[52:55], v[92:95]
    v_mfma_f32_16x16x32_bf16 v[92:95], v[136:139], a[56:59], v[92:95]
    v_mfma_f32_16x16x32_bf16 v[92:95], v[140:143], a[60:63], v[92:95]
    s_nop 9
    v_max3_f32 v18, v88, v89, v18
    v_max3_f32 v18, v90, v91, v18
    v_max3_f32 v18, v92, v93, v18
    v_max3_f32 v18, v94, v95, v18
    s_nop 3
    v_mfma_f32_16x16x32_bf16 v[88:91], v[112:115], a[64:67], 0
    v_mfma_f32_16x16x32_bf16 v[88:91], v[116:119], a[68:71], v[88:91]
    v_mfma_f32_16x16x32_bf16 v[88:91], v[120:123], a[72:75], v[88:91]
    v_mfma_f32_16x16x32_bf16 v[88:91], v[124:127], a[76:79], v[88:91]
    v_mfma_f32_16x16x32_bf16 v[92:95], v[128:131], a[64:67], 0
    v_mfma_f32_16x16x32_bf16 v[92:95], v[132:135], a[68:71], v[92:95]
    v_mfma_f32_16x16x32_bf16 v[92:95], v[136:139], a[72:75], v[92:95]
    v_mfma_f32_16x16x32_bf16 v[92:95], v[140:143], a[76:79], v[92:95]
    s_nop 9
    v_max3_f32 v20, v88, v89, v20
    v_max3_f32 v20, v90, v91, v20
    v_max3_f32 v20, v92, v93, v20
    v_max3_f32 v20, v94, v95, v20
    s_nop 3
    v_mfma_f32_16x16x32_bf16 v[88:91], v[112:115], a[80:83], 0
    v_mfma_f32_16x16x32_bf16 v[88:91], v[116:119], a[84:87], v[88:91]
    v_mfma_f32_16x16x32_bf16 v[88:91], v[120:123], a[88:91], v[88:91]
    v_mfma_f32_16x16x32_bf16 v[88:91], v[124:127], a[92:95], v[88:91]
    v_mfma_f32_16x16x32_bf16 v[92:95], v[128:131], a[80:83], 0
    v_mfma_f32_16x16x32_bf16 v[92:95], v[132:135], a[84:87], v[92:95]
    v_mfma_f32_16x16x32_bf16 v[92:95], v[136:139], a[88:91], v[92:95]
    v_mfma_f32_16x16x32_bf16 v[92:95], v[140:143], a[92:95], v[92:95]
    s_nop 9
    v_max3_f32 v22, v88, v89, v22
    v_max3_f32 v22, v90, v91, v22
    v_max3_f32 v22, v92, v93, v22
    v_max3_f32 v22, v94, v95, v22
    s_nop 3
    v_mfma_f32_16x16x32_bf16 v[88:91], v[112:115], a[96:99], 0
    v_mfma_f32_16x16x32_bf16 v[88:91], v[116:119], a[100:103], v[88:91]
    v_mfma_f32_16x16x32_bf16 v[88:91], v[120:123], a[104:107], v[88:91]
    v_mfma_f32_16x16x32_bf16 v[88:91], v[124:127], a[108:111], v[88:91]
    v_mfma_f32_16x16x32_bf16 v[92:95], v[128:131], a[96:99], 0
    v_mfma_f32_16x16x32_bf16 v[92:95], v[132:135], a[100:103], v[92:95]
    v_mfma_f32_16x16x32_bf16 v[92:95], v[136:139], a[104:107], v[92:95]
    v_mfma_f32_16x16x32_bf16 v[92:95], v[140:143], a[108:111], v[92:95]
    s_nop 9
    v_max3_f32 v24, v88, v89, v24
    v_max3_f32 v24, v90, v91, v24
    v_max3_f32 v24, v92, v93, v24
    v_max3_f32 v24, v94, v95, v24
    s_nop 3
    s_add_u32 s29, s29, 8192
    s_add_u32 s22, s22, 1
    s_cmp_lt_u32 s22, 32
    s_cbranch_scc1 L_at_mp
    s_branch L_at_pre
L_at_end:
    s_endpgm
.globl op_kernel
.p2align 8
.type op_kernel,@function
op_kernel:
    s_cmp_ge_u32 s2, 256
    s_cbranch_scc1 L_op_end
    s_and_b32 s3, s2, 7
    s_lshl_b32 s3, s3, 5
    s_lshr_b32 s30, s2, 3
    s_add_u32 s3, s3, s30
    s_cmp_ge_u32 s3, 250
    s_cbranch_scc1 L_op_end
    s_load_dwordx2 s[36:37], s[0:1], 32
    s_load_dwordx2 s[38:39], s[0:1], 72
    s_load_dwordx2 s[40:41], s[0:1], 80
    s_load_dwordx2 s[44:45], s[0:1], 96
    v_and_b32 v1, 63, v0
    v_lshrrev_b32 v2, 6, v0
    s_nop 0
    v_readfirstlane_b32 s20, v2
    s_mul_i32 s28, s3, 13108
    s_lshr_b32 s28, s28, 16
    s_mul_i32 s22, s28, 5
    s_sub_u32 s29, s3, s22
    s_mov_b32 s61, s28
    s_cmp_ge_u32 s28, 25
    s_cselect_b32 s30, 1, 0
    s_cselect_b32 s22, 25, 0
    s_sub_u32 s28, s28, s22
    s_mul_i32 s31, s28, 9
    s_lshl_b32 s24, s20, 10
    s_add_u32 s24, s24, 58720256
    s_mul_i32 s23, s30, 29360128
    s_add_u32 s24, s24, s23
    s_cmp_lt_u32 s20, 2
    s_cselect_b32 s58, 5, 0
    s_add_u32 s22, s31, 0
    s_add_u32 s22, s22, s58
    s_mul_i32 s23, s22, 4682
    s_lshr_b32 s23, s23, 16
    s_mul_i32 s62, s23, 1777664
    s_lshl_b32 s48, s22, 12
    s_add_u32 s48, s48, s62
    s_add_u32 s48, s48, s24
    s_add_u32 s22, s31, 1
    s_add_u32 s22, s22, s58
    s_mul_i32 s23, s22, 4682
    s_lshr_b32 s23, s23, 16
    s_mul_i32 s62, s23, 1777664
    s_lshl_b32 s49, s22, 12
    s_add_u32 s49, s49, s62
    s_add_u32 s49, s49, s24
    s_add_u32 s22, s31, 2
    s_add_u32 s22, s22, s58
    s_mul_i32 s23, s22, 4682
    s_lshr_b32 s23, s23, 16
    s_mul_i32 s62, s23, 1777664
    s_lshl_b32 s50, s22, 12
    s_add_u32 s50, s50, s62
    s_add_u32 s50, s50, s24
    s_add_u32 s22, s31, 3
    s_add_u32 s22, s22, s58
    s_mul_i32 s23, s22, 4682
    s_lshr_b32 s23, s23, 16
    s_mul_i32 s62, s23, 1777664
    s_lshl_b32 s51, s22, 12
    s_add_u32 s51, s51, s62
    s_add_u32 s51, s51, s24
    s_cmp_ge_u32 s22, 224
    s_cselect_b32 s62, 0x40000000, 0
    s_add_u32 s51, s51, s62
    s_add_u32 s22, s31, 4
    s_mul_i32 s23, s22, 4682
    s_lshr_b32 s23, s23, 16
    s_mul_i32 s62, s23, 1777664
    s_lshl_b32 s52, s22, 12
    s_add_u32 s52, s52, s62
    s_add_u32 s52, s52, s24
    s_add_u32 s22, s31, 5
    s_sub_u32 s22, s22, s58
    s_mul_i32 s23, s22, 4682
    s_lshr_b32 s23, s23, 16
    s_mul_i32 s62, s23, 1777664
    s_lshl_b32 s53, s22, 12
    s_add_u32 s53, s53, s62
    s_add_u32 s53, s53, s24
    s_add_u32 s22, s31, 6
    s_sub_u32 s22, s22, s58
    s_mul_i32 s23, s22, 4682
    s_lshr_b32 s23, s23, 16
    s_mul_i32 s62, s23, 1777664
    s_lshl_b32 s54, s22, 12
    s_add_u32 s54, s54, s62
    s_add_u32 s54, s54, s24
    s_add_u32 s22, s31, 7
    s_sub_u32 s22, s22, s58
    s_mul_i32 s23, s22, 4682
    s_lshr_b32 s23, s23, 16
    s_mul_i32 s62, s23, 1777664
    s_lshl_b32 s55, s22, 12
    s_add_u32 s55, s55, s62
    s_add_u32 s55, s55, s24
    s_add_u32 s22, s31, 8
    s_sub_u32 s22, s22, s58
    s_mul_i32 s23, s22, 4682
    s_lshr_b32 s23, s23, 16
    s_mul_i32 s62, s23, 1777664
    s_lshl_b32 s56, s22, 12
    s_add_u32 s56, s56, s62
    s_add_u32 s56, s56, s24
    s_cmp_ge_u32 s22, 224
    s_cselect_b32 s62, 0x40000000, 0
    s_add_u32 s56, s56, s62
    v_lshlrev_b32 v6, 4, v1
    v_lshrrev_b32 v2, 4, v1
    v_and_b32 v3, 15, v1
    v_lshlrev_b32 v4, 1, v2
    v_xor_b32 v3, v3, v4
    v_lshlrev_b32 v3, 4, v3
    v_mul_u32_u24 v4, 1280, v2
    v_add_u32 v5, v4, v3
    v_xor_b32 v3, 128, v3
    v_add_u32 v4, v4, v3
    v_add_u32 v10, 0, v5
    v_add_u32 v11, 4096, v4
    v_add_u32 v12, 8192, v5
    v_add_u32 v13, 12288, v4
    v_add_u32 v14, 20480, v5
    v_add_u32 v15, 24576, v4
    v_add_u32 v16, 28672, v5
    v_add_u32 v17, 32768, v4
    s_mul_i32 s27, s20, 40960
    s_waitcnt lgkmcnt(0)
    s_cmp_lg_u32 s30, 0
    s_cselect_b32 s8, s38, s36
    s_cselect_b32 s9, s39, s37
    s_mov_b32 s10, 5242880
    s_mov_b32 s11, 0x20000
    s_mov_b32 s4, s44
    s_mov_b32 s5, s45
    s_mov_b32 s6, 127926272
    s_mov_b32 s7, 0x20000
    s_mov_b32 s12, s40
    s_mov_b32 s13, s41
    s_mov_b32 s14, 9175040
    s_mov_b32 s15, 0x20000
    s_mul_i32 s22, s20, 40960
    s_lshl_b32 s23, s29, 8
    s_add_u32 s26, s22, s23
    s_mov_b32 s25, 0
    v_add_u32 v7, s25, v6
    s_add_u32 m0, s27, 0
    s_nop 0
    buffer_load_dwordx4 v10, s[8:11], s26 offen offset:0 lds
    buffer_load_dwordx4 v11, s[8:11], s26 offen offset:1024 lds
    buffer_load_dwordx4 v12, s[8:11], s26 offen offset:2048 lds
    buffer_load_dwordx4 v13, s[8:11], s26 offen offset:3072 lds
    s_add_u32 m0, s27, 4096
    s_nop 0
    buffer_load_dwordx4 v14, s[8:11], s26 offen offset:0 lds
    buffer_load_dwordx4 v15, s[8:11], s26 offen offset:1024 lds
    buffer_load_dwordx4 v16, s[8:11], s26 offen offset:2048 lds
    buffer_load_dwordx4 v17, s[8:11], s26 offen offset:3072 lds
    s_add_u32 s26, s26, 163840
    buffer_load_dwordx4 v[92:95], v7, s[4:7], s48 offen
    buffer_load_dwordx4 v[96:99], v7, s[4:7], s49 offen
    buffer_load_dwordx4 v[100:103], v7, s[4:7], s50 offen
    buffer_load_dwordx4 v[104:107], v7, s[4:7], s51 offen
    buffer_load_dwordx4 v[108:111], v7, s[4:7], s52 offen
    buffer_load_dwordx4 v[112:115], v7, s[4:7], s53 offen
    buffer_load_dwordx4 v[116:119], v7, s[4:7], s54 offen
    buffer_load_dwordx4 v[120:123], v7, s[4:7], s55 offen
    buffer_load_dwordx4 v[124:127], v7, s[4:7], s56 offen
    v_add_u32 v7, 57344, v7
    s_add_u32 m0, s27, 8192
    s_nop 0
    buffer_load_dwordx4 v10, s[8:11], s26 offen offset:0 lds
    buffer_load_dwordx4 v11, s[8:11], s26 offen offset:1024 lds
    buffer_load_dwordx4 v12, s[8:11], s26 offen offset:2048 lds
    buffer_load_dwordx4 v13, s[8:11], s26 offen offset:3072 lds
    s_add_u32 m0, s27, 12288
    s_nop 0
    buffer_load_dwordx4 v14, s[8:11], s26 offen offset:0 lds
    buffer_load_dwordx4 v15, s[8:11], s26 offen offset:1024 lds
    buffer_load_dwordx4 v16, s[8:11], s26 offen offset:2048 lds
    buffer_load_dwordx4 v17, s[8:11], s26 offen offset:3072 lds
    s_add_u32 s26, s26, 163840
    v_lshrrev_b32 v2, 4, v1
    v_bfe_u32 v3, v1, 2, 2
    v_lshl_add_u32 v4, v2, 2, v3
    v_lshlrev_b32 v4, 8, v4
    v_and_b32 v2, 1, v2
    v_lshl_add_u32 v3, v2, 2, v3
    v_lshl_add_u32 v4, v3, 5, v4
    v_and_b32 v3, 3, v1
    v_lshl_add_u32 v4, v3, 3, v4
    v_add_u32 v4, s27, v4
    s_and_b32 s62, s20, 1
    s_lshl_b32 s62, s62, 1
    s_lshr_b32 s59, s20, 1
    s_add_u32 s59, s59, s62
    s_lshl_b32 s59, s59, 6
    s_xor_b32 s62, s59, 192
    v_xor_b32 v18, s62, v4
    s_xor_b32 s62, s59, 224
    v_xor_b32 v19, s62, v4
    s_xor_b32 s62, s59, 128
    v_xor_b32 v20, s62, v4
    s_xor_b32 s62, s59, 160
    v_xor_b32 v21, s62, v4
    s_xor_b32 s62, s59, 64
    v_xor_b32 v22, s62, v4
    s_xor_b32 s62, s59, 96
    v_xor_b32 v23, s62, v4
    s_xor_b32 s62, s59, 0
    v_xor_b32 v24, s62, v4
    s_xor_b32 s62, s59, 32
    v_xor_b32 v25, s62, v4
    v_add_u32 v8, s27, v6
    v_bfe_u32 v4, v1, 4, 1
    v_lshlrev_b32 v4, 5, v4
    v_and_b32 v2, 15, v1
    v_mul_u32_u24 v2, 2560, v2
    v_add_u32 v2, v2, v4
    v_bfe_u32 v4, v1, 5, 1
    v_lshl_add_u32 v9, v4, 4, v2
    s_xor_b32 s22, s20, 3
    s_mul_i32 s22, s22, 40960
    v_add_u32 v2, s22, v6
    s_xor_b32 s22, s20, 1
    s_mul_i32 s22, s22, 40960
    v_add_u32 v3, s22, v6
    s_xor_b32 s22, s20, 2
    s_mul_i32 s22, s22, 40960
    v_add_u32 v4, s22, v6
    v_and_b32 v26, 7, v1
    v_mul_u32_u24 v26, 2560, v26
    v_bfe_u32 v27, v1, 3, 1
    s_lshr_b32 s22, s20, 1
    s_xor_b32 s22, s22, 1
    v_xor_b32 v27, s22, v27
    v_lshl_add_u32 v26, v27, 6, v26
    v_bfe_u32 v27, v1, 4, 1
    v_lshl_add_u32 v26, v27, 5, v26
    v_bfe_u32 v27, v1, 5, 1
    v_lshl_add_u32 v26, v27, 4, v26
    v_xor_b32 v27, 64, v26
    v_add_u32 v27, 20480, v27
    s_mov_b32 s64, 0x00ff00ff
    s_mov_b32 s65, 0x00ff00ff
    s_mov_b32 s66, 0xff00ff00
    s_mov_b32 s67, 0xff00ff00
    s_mul_i32 s22, s28, 368640
    s_mul_i32 s23, s30, 1280
    s_add_u32 s22, s22, s23
    s_lshl_b32 s23, s29, 8
    s_add_u32 s24, s22, s23
    s_waitcnt vmcnt(17)
    ds_read_b64_tr_b16 v[60:61], v18 offset:0
    ds_read_b64_tr_b16 v[62:63], v18 offset:4096
    ds_read_b64_tr_b16 v[64:65], v19 offset:0
    ds_read_b64_tr_b16 v[66:67], v19 offset:4096
    ds_read_b64_tr_b16 v[68:69], v20 offset:0
    ds_read_b64_tr_b16 v[70:71], v20 offset:4096
    ds_read_b64_tr_b16 v[72:73], v21 offset:0
    ds_read_b64_tr_b16 v[74:75], v21 offset:4096
    ds_read_b64_tr_b16 v[76:77], v22 offset:0
    ds_read_b64_tr_b16 v[78:79], v22 offset:4096
    ds_read_b64_tr_b16 v[80:81], v23 offset:0
    ds_read_b64_tr_b16 v[82:83], v23 offset:4096
    ds_read_b64_tr_b16 v[84:85], v24 offset:0
    ds_read_b64_tr_b16 v[86:87], v24 offset:4096
    ds_read_b64_tr_b16 v[88:89], v25 offset:0
    ds_read_b64_tr_b16 v[90:91], v25 offset:4096
    s_waitcnt vmcnt(0) lgkmcnt(12)
    v_mfma_f32_16x16x32_bf16 a[0:3], v[60:63], v[92:95], 0
    buffer_load_dwordx4 v[128:131], v7, s[4:7], s48 offen
    v_mfma_f32_16x16x32_bf16 a[4:7], v[60:63], v[96:99], 0
    buffer_load_dwordx4 v[132:135], v7, s[4:7], s49 offen
    v_mfma_f32_16x16x32_bf16 a[8:11], v[60:63], v[100:103], 0
    buffer_load_dwordx4 v[136:139], v7, s[4:7], s50 offen
    v_mfma_f32_16x16x32_bf16 a[12:15], v[60:63], v[104:107], 0
    buffer_load_dwordx4 v[140:143], v7, s[4:7], s51 offen
    v_mfma_f32_16x16x32_bf16 a[16:19], v[60:63], v[108:111], 0
    buffer_load_dwordx4 v[144:147], v7, s[4:7], s52 offen
    v_mfma_f32_16x16x32_bf16 a[20:23], v[60:63], v[112:115], 0
    buffer_load_dwordx4 v[148:151], v7, s[4:7], s53 offen
    v_mfma_f32_16x16x32_bf16 a[24:27], v[60:63], v[116:119], 0
    buffer_load_dwordx4 v[152:155], v7, s[4:7], s54 offen
    v_mfma_f32_16x16x32_bf16 a[28:31], v[60:63], v[120:123], 0
    buffer_load_dwordx4 v[156:159], v7, s[4:7], s55 offen
    v_mfma_f32_16x16x32_bf16 a[32:35], v[60:63], v[124:127], 0
    ds_read_b64_tr_b16 v[60:61], v18 offset:8192
    ds_read_b64_tr_b16 v[62:63], v18 offset:12288
    v_mfma_f32_16x16x32_bf16 a[36:39], v[64:67], v[92:95], 0
    buffer_load_dwordx4 v[160:163], v7, s[4:7], s56 offen
    v_mfma_f32_16x16x32_bf16 a[40:43], v[64:67], v[96:99], 0
    v_add_u32 v7, 57344, v7
    v_mfma_f32_16x16x32_bf16 a[44:47], v[64:67], v[100:103], 0
    s_add_u32 m0, s27, 16384
    v_mfma_f32_16x16x32_bf16 a[48:51], v[64:67], v[104:107], 0
    s_nop 0
    v_mfma_f32_16x16x32_bf16 a[52:55], v[64:67], v[108:111], 0
    buffer_load_dwordx4 v10, s[8:11], s26 offen offset:0 lds
    v_mfma_f32_16x16x32_bf16 a[56:59], v[64:67], v[112:115], 0
    buffer_load_dwordx4 v11, s[8:11], s26 offen offset:1024 lds
    v_mfma_f32_16x16x32_bf16 a[60:63], v[64:67], v[116:119], 0
    buffer_load_dwordx4 v12, s[8:11], s26 offen offset:2048 lds
    v_mfma_f32_16x16x32_bf16 a[64:67], v[64:67], v[120:123], 0
    buffer_load_dwordx4 v13, s[8:11], s26 offen offset:3072 lds
    v_mfma_f32_16x16x32_bf16 a[68:71], v[64:67], v[124:127], 0
    ds_read_b64_tr_b16 v[64:65], v19 offset:8192
    ds_read_b64_tr_b16 v[66:67], v19 offset:12288
    s_waitcnt lgkmcnt(4)
    v_mfma_f32_16x16x32_bf16 a[72:75], v[68:71], v[92:95], 0
    s_add_u32 m0, s27, 20480
    v_mfma_f32_16x16x32_bf16 a[76:79], v[68:71], v[96:99], 0
    s_nop 0
    v_mfma_f32_16x16x32_bf16 a[80:83], v[68:71], v[100:103], 0
    buffer_load_dwordx4 v14, s[8:11], s26 offen offset:0 lds
    v_mfma_f32_16x16x32_bf16 a[84:87], v[68:71], v[104:107], 0
    buffer_load_dwordx4 v15, s[8:11], s26 offen offset:1024 lds
    v_mfma_f32_16x16x32_bf16 a[88:91], v[68:71], v[108:111], 0
    buffer_load_dwordx4 v16, s[8:11], s26 offen offset:2048 lds
    v_mfma_f32_16x16x32_bf16 a[92:95], v[68:71], v[112:115], 0
    buffer_load_dwordx4 v17, s[8:11], s26 offen offset:3072 lds
    v_mfma_f32_16x16x32_bf16 a[96:99], v[68:71], v[116:119], 0
    s_add_u32 s26, s26, 163840
    v_mfma_f32_16x16x32_bf16 a[100:103], v[68:71], v[120:123], 0
    s_add_u32 m0, s27, 24576
    v_mfma_f32_16x16x32_bf16 a[104:107], v[68:71], v[124:127], 0
    ds_read_b64_tr_b16 v[68:69], v20 offset:8192
    ds_read_b64_tr_b16 v[70:71], v20 offset:12288
    v_mfma_f32_16x16x32_bf16 a[108:111], v[72:75], v[92:95], 0
    s_nop 0
    v_mfma_f32_16x16x32_bf16 a[112:115], v[72:75], v[96:99], 0
    buffer_load_dwordx4 v10, s[8:11], s26 offen offset:0 lds
    v_mfma_f32_16x16x32_bf16 a[116:119], v[72:75], v[100:103], 0
    buffer_load_dwordx4 v11, s[8:11], s26 offen offset:1024 lds
    v_mfma_f32_16x16x32_bf16 a[120:123], v[72:75], v[104:107], 0
    buffer_load_dwordx4 v12, s[8:11], s26 offen offset:2048 lds
    v_mfma_f32_16x16x32_bf16 a[124:127], v[72:75], v[108:111], 0
    buffer_load_dwordx4 v13, s[8:11], s26 offen offset:3072 lds
    v_mfma_f32_16x16x32_bf16 a[128:131], v[72:75], v[112:115], 0
    s_add_u32 m0, s27, 28672
    v_mfma_f32_16x16x32_bf16 a[132:135], v[72:75], v[116:119], 0
    s_nop 0
    v_mfma_f32_16x16x32_bf16 a[136:139], v[72:75], v[120:123], 0
    buffer_load_dwordx4 v14, s[8:11], s26 offen offset:0 lds
    v_mfma_f32_16x16x32_bf16 a[140:143], v[72:75], v[124:127], 0
    ds_read_b64_tr_b16 v[72:73], v21 offset:8192
    ds_read_b64_tr_b16 v[74:75], v21 offset:12288
    v_mfma_f32_16x16x32_bf16 a[144:147], v[76:79], v[92:95], 0
    buffer_load_dwordx4 v15, s[8:11], s26 offen offset:1024 lds
    v_mfma_f32_16x16x32_bf16 a[148:151], v[76:79], v[96:99], 0
    buffer_load_dwordx4 v16, s[8:11], s26 offen offset:2048 lds
    v_mfma_f32_16x16x32_bf16 a[152:155], v[76:79], v[100:103], 0
    buffer_load_dwordx4 v17, s[8:11], s26 offen offset:3072 lds
    v_mfma_f32_16x16x32_bf16 a[156:159], v[76:79], v[104:107], 0
    s_add_u32 s26, s26, 163840
    v_mfma_f32_16x16x32_bf16 a[160:163], v[76:79], v[108:111], 0
    buffer_load_dwordx4 v[164:167], v7, s[4:7], s48 offen
    v_mfma_f32_16x16x32_bf16 a[164:167], v[76:79], v[112:115], 0
    buffer_load_dwordx4 v[168:171], v7, s[4:7], s49 offen
    v_mfma_f32_16x16x32_bf16 a[168:171], v[76:79], v[116:119], 0
    buffer_load_dwordx4 v[172:175], v7, s[4:7], s50 offen
    v_mfma_f32_16x16x32_bf16 v[36:39], v[76:79], v[120:123], 0
    buffer_load_dwordx4 v[176:179], v7, s[4:7], s51 offen
    v_mfma_f32_16x16x32_bf16 v[52:55], v[76:79], v[124:127], 0
    ds_read_b64_tr_b16 v[76:77], v22 offset:8192
    ds_read_b64_tr_b16 v[78:79], v22 offset:12288
    v_mfma_f32_16x16x32_bf16 a[172:175], v[80:83], v[92:95], 0
    buffer_load_dwordx4 v[180:183], v7, s[4:7], s52 offen
    v_mfma_f32_16x16x32_bf16 a[176:179], v[80:83], v[96:99], 0
    buffer_load_dwordx4 v[184:187], v7, s[4:7], s53 offen
    v_mfma_f32_16x16x32_bf16 a[180:183], v[80:83], v[100:103], 0
    buffer_load_dwordx4 v[188:191], v7, s[4:7], s54 offen
    v_mfma_f32_16x16x32_bf16 a[184:187], v[80:83], v[104:107], 0
    buffer_load_dwordx4 v[192:195], v7, s[4:7], s55 offen
    v_mfma_f32_16x16x32_bf16 a[188:191], v[80:83], v[108:111], 0
    buffer_load_dwordx4 v[196:199], v7, s[4:7], s56 offen
    v_mfma_f32_16x16x32_bf16 a[192:195], v[80:83], v[112:115], 0
    v_add_u32 v7, 57344, v7
    v_mfma_f32_16x16x32_bf16 a[196:199], v[80:83], v[116:119], 0
    buffer_load_dwordx4 v[200:203], v7, s[4:7], s48 offen
    v_mfma_f32_16x16x32_bf16 v[40:43], v[80:83], v[120:123], 0
    buffer_load_dwordx4 v[204:207], v7, s[4:7], s49 offen
    v_mfma_f32_16x16x32_bf16 v[56:59], v[80:83], v[124:127], 0
    ds_read_b64_tr_b16 v[80:81], v23 offset:8192
    ds_read_b64_tr_b16 v[82:83], v23 offset:12288
    v_mfma_f32_16x16x32_bf16 a[200:203], v[84:87], v[92:95], 0
    buffer_load_dwordx4 v[208:211], v7, s[4:7], s50 offen
    v_mfma_f32_16x16x32_bf16 a[204:207], v[84:87], v[96:99], 0
    buffer_load_dwordx4 v[212:215], v7, s[4:7], s51 offen
    v_mfma_f32_16x16x32_bf16 a[208:211], v[84:87], v[100:103], 0
    buffer_load_dwordx4 v[216:219], v7, s[4:7], s52 offen
    v_mfma_f32_16x16x32_bf16 a[212:215], v[84:87], v[104:107], 0
    buffer_load_dwordx4 v[220:223], v7, s[4:7], s53 offen
    v_mfma_f32_16x16x32_bf16 v[244:247], v[84:87], v[108:111], 0
    buffer_load_dwordx4 v[224:227], v7, s[4:7], s54 offen
    v_mfma_f32_16x16x32_bf16 a[216:219], v[84:87], v[112:115], 0
    buffer_load_dwordx4 v[228:231], v7, s[4:7], s55 offen
    v_mfma_f32_16x16x32_bf16 v[28:31], v[84:87], v[116:119], 0
    buffer_load_dwordx4 v[232:235], v7, s[4:7], s56 offen
    v_mfma_f32_16x16x32_bf16 v[44:47], v[84:87], v[120:123], 0
    v_add_u32 v7, 57344, v7
    v_mfma_f32_16x16x32_bf16 v[236:239], v[84:87], v[124:127], 0
    ds_read_b64_tr_b16 v[84:85], v24 offset:8192
    ds_read_b64_tr_b16 v[86:87], v24 offset:12288
    v_mfma_f32_16x16x32_bf16 a[220:223], v[88:91], v[92:95], 0
    v_mfma_f32_16x16x32_bf16 a[224:227], v[88:91], v[96:99], 0
    v_mfma_f32_16x16x32_bf16 a[228:231], v[88:91], v[100:103], 0
    v_mfma_f32_16x16x32_bf16 a[232:235], v[88:91], v[104:107], 0
    v_mfma_f32_16x16x32_bf16 v[248:251], v[88:91], v[108:111], 0
    v_mfma_f32_16x16x32_bf16 a[236:239], v[88:91], v[112:115], 0
    v_mfma_f32_16x16x32_bf16 v[32:35], v[88:91], v[116:119], 0
    v_mfma_f32_16x16x32_bf16 v[48:51], v[88:91], v[120:123], 0
    v_mfma_f32_16x16x32_bf16 v[240:243], v[88:91], v[124:127], 0
    ds_read_b64_tr_b16 v[88:89], v25 offset:8192
    ds_read_b64_tr_b16 v[90:91], v25 offset:12288
    s_waitcnt vmcnt(34) lgkmcnt(12)
    v_mfma_f32_16x16x32_bf16 a[0:3], v[60:63], v[128:131], a[0:3]
    v_mfma_f32_16x16x32_bf16 a[4:7], v[60:63], v[132:135], a[4:7]
    v_mfma_f32_16x16x32_bf16 a[8:11], v[60:63], v[136:139], a[8:11]
    v_mfma_f32_16x16x32_bf16 a[12:15], v[60:63], v[140:143], a[12:15]
    v_mfma_f32_16x16x32_bf16 a[16:19], v[60:63], v[144:147], a[16:19]
    v_mfma_f32_16x16x32_bf16 a[20:23], v[60:63], v[148:151], a[20:23]
    v_mfma_f32_16x16x32_bf16 a[24:27], v[60:63], v[152:155], a[24:27]
    v_mfma_f32_16x16x32_bf16 a[28:31], v[60:63], v[156:159], a[28:31]
    v_mfma_f32_16x16x32_bf16 a[32:35], v[60:63], v[160:163], a[32:35]
    v_mfma_f32_16x16x32_bf16 a[36:39], v[64:67], v[128:131], a[36:39]
    v_mfma_f32_16x16x32_bf16 a[40:43], v[64:67], v[132:135], a[40:43]
    v_mfma_f32_16x16x32_bf16 a[44:47], v[64:67], v[136:139], a[44:47]
    v_mfma_f32_16x16x32_bf16 a[48:51], v[64:67], v[140:143], a[48:51]
    v_mfma_f32_16x16x32_bf16 a[52:55], v[64:67], v[144:147], a[52:55]
    v_mfma_f32_16x16x32_bf16 a[56:59], v[64:67], v[148:151], a[56:59]
    v_mfma_f32_16x16x32_bf16 a[60:63], v[64:67], v[152:155], a[60:63]
    v_mfma_f32_16x16x32_bf16 a[64:67], v[64:67], v[156:159], a[64:67]
    v_mfma_f32_16x16x32_bf16 a[68:71], v[64:67], v[160:163], a[68:71]
    s_waitcnt vmcnt(18)
    ds_read_b64_tr_b16 v[60:61], v18 offset:16384
    ds_read_b64_tr_b16 v[62:63], v18 offset:20480
    ds_read_b64_tr_b16 v[64:65], v18 offset:24576
    ds_read_b64_tr_b16 v[66:67], v18 offset:28672
    s_waitcnt lgkmcnt(4)
    v_mfma_f32_16x16x32_bf16 a[72:75], v[68:71], v[128:131], a[72:75]
    s_add_u32 m0, s27, 0
    v_mfma_f32_16x16x32_bf16 a[76:79], v[68:71], v[132:135], a[76:79]
    s_nop 0
    v_mfma_f32_16x16x32_bf16 a[80:83], v[68:71], v[136:139], a[80:83]
    buffer_load_dwordx4 v10, s[8:11], s26 offen offset:0 lds
    v_mfma_f32_16x16x32_bf16 a[84:87], v[68:71], v[140:143], a[84:87]
    buffer_load_dwordx4 v11, s[8:11], s26 offen offset:1024 lds
    v_mfma_f32_16x16x32_bf16 a[88:91], v[68:71], v[144:147], a[88:91]
    buffer_load_dwordx4 v12, s[8:11], s26 offen offset:2048 lds
    v_mfma_f32_16x16x32_bf16 a[92:95], v[68:71], v[148:151], a[92:95]
    buffer_load_dwordx4 v13, s[8:11], s26 offen offset:3072 lds
    v_mfma_f32_16x16x32_bf16 a[96:99], v[68:71], v[152:155], a[96:99]
    s_add_u32 m0, s27, 4096
    v_mfma_f32_16x16x32_bf16 a[100:103], v[68:71], v[156:159], a[100:103]
    s_nop 0
    v_mfma_f32_16x16x32_bf16 a[104:107], v[68:71], v[160:163], a[104:107]
    buffer_load_dwordx4 v14, s[8:11], s26 offen offset:0 lds
    v_mfma_f32_16x16x32_bf16 a[108:111], v[72:75], v[128:131], a[108:111]
    buffer_load_dwordx4 v15, s[8:11], s26 offen offset:1024 lds
    v_mfma_f32_16x16x32_bf16 a[112:115], v[72:75], v[132:135], a[112:115]
    buffer_load_dwordx4 v16, s[8:11], s26 offen offset:2048 lds
    v_mfma_f32_16x16x32_bf16 a[116:119], v[72:75], v[136:139], a[116:119]
    buffer_load_dwordx4 v17, s[8:11], s26 offen offset:3072 lds
    v_mfma_f32_16x16x32_bf16 a[120:123], v[72:75], v[140:143], a[120:123]
    s_add_u32 s26, s26, 163840
    v_mfma_f32_16x16x32_bf16 a[124:127], v[72:75], v[144:147], a[124:127]
    s_add_u32 m0, s27, 8192
    v_mfma_f32_16x16x32_bf16 a[128:131], v[72:75], v[148:151], a[128:131]
    s_nop 0
    v_mfma_f32_16x16x32_bf16 a[132:135], v[72:75], v[152:155], a[132:135]
    buffer_load_dwordx4 v10, s[8:11], s26 offen offset:0 lds
    v_mfma_f32_16x16x32_bf16 a[136:139], v[72:75], v[156:159], a[136:139]
    buffer_load_dwordx4 v11, s[8:11], s26 offen offset:1024 lds
    v_mfma_f32_16x16x32_bf16 a[140:143], v[72:75], v[160:163], a[140:143]
    ds_read_b64_tr_b16 v[68:69], v19 offset:16384
    ds_read_b64_tr_b16 v[70:71], v19 offset:20480
    ds_read_b64_tr_b16 v[72:73], v19 offset:24576
    ds_read_b64_tr_b16 v[74:75], v19 offset:28672
    v_mfma_f32_16x16x32_bf16 a[144:147], v[76:79], v[128:131], a[144:147]
    buffer_load_dwordx4 v12, s[8:11], s26 offen offset:2048 lds
    v_mfma_f32_16x16x32_bf16 a[148:151], v[76:79], v[132:135], a[148:151]
    buffer_load_dwordx4 v13, s[8:11], s26 offen offset:3072 lds
    v_mfma_f32_16x16x32_bf16 a[152:155], v[76:79], v[136:139], a[152:155]
    s_add_u32 m0, s27, 12288
    v_mfma_f32_16x16x32_bf16 a[156:159], v[76:79], v[140:143], a[156:159]
    s_nop 0
    v_mfma_f32_16x16x32_bf16 a[160:163], v[76:79], v[144:147], a[160:163]
    buffer_load_dwordx4 v14, s[8:11], s26 offen offset:0 lds
    v_mfma_f32_16x16x32_bf16 a[164:167], v[76:79], v[148:151], a[164:167]
    buffer_load_dwordx4 v15, s[8:11], s26 offen offset:1024 lds
    v_mfma_f32_16x16x32_bf16 a[168:171], v[76:79], v[152:155], a[168:171]
    buffer_load_dwordx4 v16, s[8:11], s26 offen offset:2048 lds
    v_mfma_f32_16x16x32_bf16 v[36:39], v[76:79], v[156:159], v[36:39]
    buffer_load_dwordx4 v17, s[8:11], s26 offen offset:3072 lds
    v_mfma_f32_16x16x32_bf16 v[52:55], v[76:79], v[160:163], v[52:55]
    s_add_u32 s26, s26, 163840
    v_mfma_f32_16x16x32_bf16 a[172:175], v[80:83], v[128:131], a[172:175]
    v_mfma_f32_16x16x32_bf16 a[176:179], v[80:83], v[132:135], a[176:179]
    v_mfma_f32_16x16x32_bf16 a[180:183], v[80:83], v[136:139], a[180:183]
    v_mfma_f32_16x16x32_bf16 a[184:187], v[80:83], v[140:143], a[184:187]
    v_mfma_f32_16x16x32_bf16 a[188:191], v[80:83], v[144:147], a[188:191]
    v_mfma_f32_16x16x32_bf16 a[192:195], v[80:83], v[148:151], a[192:195]
    v_mfma_f32_16x16x32_bf16 a[196:199], v[80:83], v[152:155], a[196:199]
    v_mfma_f32_16x16x32_bf16 v[40:43], v[80:83], v[156:159], v[40:43]
    v_mfma_f32_16x16x32_bf16 v[56:59], v[80:83], v[160:163], v[56:59]
    ds_read_b64_tr_b16 v[76:77], v20 offset:16384
    ds_read_b64_tr_b16 v[78:79], v20 offset:20480
    ds_read_b64_tr_b16 v[80:81], v20 offset:24576
    ds_read_b64_tr_b16 v[82:83], v20 offset:28672
    v_mfma_f32_16x16x32_bf16 a[200:203], v[84:87], v[128:131], a[200:203]
    v_mfma_f32_16x16x32_bf16 a[204:207], v[84:87], v[132:135], a[204:207]
    v_mfma_f32_16x16x32_bf16 a[208:211], v[84:87], v[136:139], a[208:211]
    v_mfma_f32_16x16x32_bf16 a[212:215], v[84:87], v[140:143], a[212:215]
    v_mfma_f32_16x16x32_bf16 v[244:247], v[84:87], v[144:147], v[244:247]
    v_mfma_f32_16x16x32_bf16 a[216:219], v[84:87], v[148:151], a[216:219]
    v_mfma_f32_16x16x32_bf16 v[28:31], v[84:87], v[152:155], v[28:31]
    v_mfma_f32_16x16x32_bf16 v[44:47], v[84:87], v[156:159], v[44:47]
    v_mfma_f32_16x16x32_bf16 v[236:239], v[84:87], v[160:163], v[236:239]
    v_mfma_f32_16x16x32_bf16 a[220:223], v[88:91], v[128:131], a[220:223]
    v_mfma_f32_16x16x32_bf16 a[224:227], v[88:91], v[132:135], a[224:227]
    v_mfma_f32_16x16x32_bf16 a[228:231], v[88:91], v[136:139], a[228:231]
    v_mfma_f32_16x16x32_bf16 a[232:235], v[88:91], v[140:143], a[232:235]
    v_mfma_f32_16x16x32_bf16 v[248:251], v[88:91], v[144:147], v[248:251]
    v_mfma_f32_16x16x32_bf16 a[236:239], v[88:91], v[148:151], a[236:239]
    v_mfma_f32_16x16x32_bf16 v[32:35], v[88:91], v[152:155], v[32:35]
    v_mfma_f32_16x16x32_bf16 v[48:51], v[88:91], v[156:159], v[48:51]
    v_mfma_f32_16x16x32_bf16 v[240:243], v[88:91], v[160:163], v[240:243]
    ds_read_b64_tr_b16 v[84:85], v21 offset:16384
    ds_read_b64_tr_b16 v[86:87], v21 offset:20480
    ds_read_b64_tr_b16 v[88:89], v21 offset:24576
    ds_read_b64_tr_b16 v[90:91], v21 offset:28672
    s_waitcnt vmcnt(16) lgkmcnt(12)
    v_mfma_f32_16x16x32_bf16 a[0:3], v[60:63], v[164:167], a[0:3]
    buffer_load_dwordx4 v[92:95], v7, s[4:7], s48 offen
    v_mfma_f32_16x16x32_bf16 a[0:3], v[64:67], v[200:203], a[0:3]
    buffer_load_dwordx4 v[96:99], v7, s[4:7], s49 offen
    v_mfma_f32_16x16x32_bf16 a[4:7], v[60:63], v[168:171], a[4:7]
    buffer_load_dwordx4 v[100:103], v7, s[4:7], s50 offen
    v_mfma_f32_16x16x32_bf16 a[4:7], v[64:67], v[204:207], a[4:7]
    buffer_load_dwordx4 v[104:107], v7, s[4:7], s51 offen
    v_mfma_f32_16x16x32_bf16 a[8:11], v[60:63], v[172:175], a[8:11]
    buffer_load_dwordx4 v[108:111], v7, s[4:7], s52 offen
    v_mfma_f32_16x16x32_bf16 a[8:11], v[64:67], v[208:211], a[8:11]
    buffer_load_dwordx4 v[112:115], v7, s[4:7], s53 offen
    v_mfma_f32_16x16x32_bf16 a[12:15], v[60:63], v[176:179], a[12:15]
    buffer_load_dwordx4 v[116:119], v7, s[4:7], s54 offen
    v_mfma_f32_16x16x32_bf16 a[12:15], v[64:67], v[212:215], a[12:15]
    buffer_load_dwordx4 v[120:123], v7, s[4:7], s55 offen
    v_mfma_f32_16x16x32_bf16 a[16:19], v[60:63], v[180:183], a[16:19]
    buffer_load_dwordx4 v[124:127], v7, s[4:7], s56 offen
    v_mfma_f32_16x16x32_bf16 a[16:19], v[64:67], v[216:219], a[16:19]
    v_add_u32 v7, 57344, v7
    v_mfma_f32_16x16x32_bf16 a[20:23], v[60:63], v[184:187], a[20:23]
    buffer_load_dwordx4 v[128:131], v7, s[4:7], s48 offen
    v_mfma_f32_16x16x32_bf16 a[20:23], v[64:67], v[220:223], a[20:23]
    buffer_load_dwordx4 v[132:135], v7, s[4:7], s49 offen
    v_mfma_f32_16x16x32_bf16 a[24:27], v[60:63], v[188:191], a[24:27]
    buffer_load_dwordx4 v[136:139], v7, s[4:7], s50 offen
    v_mfma_f32_16x16x32_bf16 a[24:27], v[64:67], v[224:227], a[24:27]
    buffer_load_dwordx4 v[140:143], v7, s[4:7], s51 offen
    v_mfma_f32_16x16x32_bf16 a[28:31], v[60:63], v[192:195], a[28:31]
    buffer_load_dwordx4 v[144:147], v7, s[4:7], s52 offen
    v_mfma_f32_16x16x32_bf16 a[28:31], v[64:67], v[228:231], a[28:31]
    buffer_load_dwordx4 v[148:151], v7, s[4:7], s53 offen
    v_mfma_f32_16x16x32_bf16 a[32:35], v[60:63], v[196:199], a[32:35]
    buffer_load_dwordx4 v[152:155], v7, s[4:7], s54 offen
    v_mfma_f32_16x16x32_bf16 a[32:35], v[64:67], v[232:235], a[32:35]
    ds_read_b64_tr_b16 v[60:61], v22 offset:16384
    ds_read_b64_tr_b16 v[62:63], v22 offset:20480
    ds_read_b64_tr_b16 v[64:65], v22 offset:24576
    ds_read_b64_tr_b16 v[66:67], v22 offset:28672
    s_waitcnt lgkmcnt(12)
    v_mfma_f32_16x16x32_bf16 a[36:39], v[68:71], v[164:167], a[36:39]
    buffer_load_dwordx4 v[156:159], v7, s[4:7], s55 offen
    v_mfma_f32_16x16x32_bf16 a[36:39], v[72:75], v[200:203], a[36:39]
    buffer_load_dwordx4 v[160:163], v7, s[4:7], s56 offen
    v_mfma_f32_16x16x32_bf16 a[40:43], v[68:71], v[168:171], a[40:43]
    v_add_u32 v7, 57344, v7
    v_mfma_f32_16x16x32_bf16 a[40:43], v[72:75], v[204:207], a[40:43]
    v_mfma_f32_16x16x32_bf16 a[44:47], v[68:71], v[172:175], a[44:47]
    v_mfma_f32_16x16x32_bf16 a[44:47], v[72:75], v[208:211], a[44:47]
    v_mfma_f32_16x16x32_bf16 a[48:51], v[68:71], v[176:179], a[48:51]
    v_mfma_f32_16x16x32_bf16 a[48:51], v[72:75], v[212:215], a[48:51]
    v_mfma_f32_16x16x32_bf16 a[52:55], v[68:71], v[180:183], a[52:55]
    v_mfma_f32_16x16x32_bf16 a[52:55], v[72:75], v[216:219], a[52:55]
    v_mfma_f32_16x16x32_bf16 a[56:59], v[68:71], v[184:187], a[56:59]
    v_mfma_f32_16x16x32_bf16 a[56:59], v[72:75], v[220:223], a[56:59]
    v_mfma_f32_16x16x32_bf16 a[60:63], v[68:71], v[188:191], a[60:63]
    v_mfma_f32_16x16x32_bf16 a[60:63], v[72:75], v[224:227], a[60:63]
    v_mfma_f32_16x16x32_bf16 a[64:67], v[68:71], v[192:195], a[64:67]
    v_mfma_f32_16x16x32_bf16 a[64:67], v[72:75], v[228:231], a[64:67]
    v_mfma_f32_16x16x32_bf16 a[68:71], v[68:71], v[196:199], a[68:71]
    v_mfma_f32_16x16x32_bf16 a[68:71], v[72:75], v[232:235], a[68:71]
    ds_read_b64_tr_b16 v[68:69], v23 offset:16384
    ds_read_b64_tr_b16 v[70:71], v23 offset:20480
    ds_read_b64_tr_b16 v[72:73], v23 offset:24576
    ds_read_b64_tr_b16 v[74:75], v23 offset:28672
    s_waitcnt lgkmcnt(12)
    v_mfma_f32_16x16x32_bf16 a[72:75], v[76:79], v[164:167], a[72:75]
    v_mfma_f32_16x16x32_bf16 a[72:75], v[80:83], v[200:203], a[72:75]
    v_mfma_f32_16x16x32_bf16 a[76:79], v[76:79], v[168:171], a[76:79]
    v_mfma_f32_16x16x32_bf16 a[76:79], v[80:83], v[204:207], a[76:79]
    v_mfma_f32_16x16x32_bf16 a[80:83], v[76:79], v[172:175], a[80:83]
    v_mfma_f32_16x16x32_bf16 a[80:83], v[80:83], v[208:211], a[80:83]
    v_mfma_f32_16x16x32_bf16 a[84:87], v[76:79], v[176:179], a[84:87]
    v_mfma_f32_16x16x32_bf16 a[84:87], v[80:83], v[212:215], a[84:87]
    v_mfma_f32_16x16x32_bf16 a[88:91], v[76:79], v[180:183], a[88:91]
    v_mfma_f32_16x16x32_bf16 a[88:91], v[80:83], v[216:219], a[88:91]
    v_mfma_f32_16x16x32_bf16 a[92:95], v[76:79], v[184:187], a[92:95]
    v_mfma_f32_16x16x32_bf16 a[92:95], v[80:83], v[220:223], a[92:95]
    v_mfma_f32_16x16x32_bf16 a[96:99], v[76:79], v[188:191], a[96:99]
    v_mfma_f32_16x16x32_bf16 a[96:99], v[80:83], v[224:227], a[96:99]
    v_mfma_f32_16x16x32_bf16 a[100:103], v[76:79], v[192:195], a[100:103]
    v_mfma_f32_16x16x32_bf16 a[100:103], v[80:83], v[228:231], a[100:103]
    v_mfma_f32_16x16x32_bf16 a[104:107], v[76:79], v[196:199], a[104:107]
    v_mfma_f32_16x16x32_bf16 a[104:107], v[80:83], v[232:235], a[104:107]
    ds_read_b64_tr_b16 v[76:77], v24 offset:16384
    ds_read_b64_tr_b16 v[78:79], v24 offset:20480
    ds_read_b64_tr_b16 v[80:81], v24 offset:24576
    ds_read_b64_tr_b16 v[82:83], v24 offset:28672
    s_waitcnt lgkmcnt(12)
    v_mfma_f32_16x16x32_bf16 a[108:111], v[84:87], v[164:167], a[108:111]
    v_mfma_f32_16x16x32_bf16 a[108:111], v[88:91], v[200:203], a[108:111]
    v_mfma_f32_16x16x32_bf16 a[112:115], v[84:87], v[168:171], a[112:115]
    v_mfma_f32_16x16x32_bf16 a[112:115], v[88:91], v[204:207], a[112:115]
    v_mfma_f32_16x16x32_bf16 a[116:119], v[84:87], v[172:175], a[116:119]
    v_mfma_f32_16x16x32_bf16 a[116:119], v[88:91], v[208:211], a[116:119]
    v_mfma_f32_16x16x32_bf16 a[120:123], v[84:87], v[176:179], a[120:123]
    v_mfma_f32_16x16x32_bf16 a[120:123], v[88:91], v[212:215], a[120:123]
    v_mfma_f32_16x16x32_bf16 a[124:127], v[84:87], v[180:183], a[124:127]
    v_mfma_f32_16x16x32_bf16 a[124:127], v[88:91], v[216:219], a[124:127]
    v_mfma_f32_16x16x32_bf16 a[128:131], v[84:87], v[184:187], a[128:131]
    v_mfma_f32_16x16x32_bf16 a[128:131], v[88:91], v[220:223], a[128:131]
    v_mfma_f32_16x16x32_bf16 a[132:135], v[84:87], v[188:191], a[132:135]
    v_mfma_f32_16x16x32_bf16 a[132:135], v[88:91], v[224:227], a[132:135]
    v_mfma_f32_16x16x32_bf16 a[136:139], v[84:87], v[192:195], a[136:139]
    v_mfma_f32_16x16x32_bf16 a[136:139], v[88:91], v[228:231], a[136:139]
    v_mfma_f32_16x16x32_bf16 a[140:143], v[84:87], v[196:199], a[140:143]
    v_mfma_f32_16x16x32_bf16 a[140:143], v[88:91], v[232:235], a[140:143]
    ds_read_b64_tr_b16 v[84:85], v25 offset:16384
    ds_read_b64_tr_b16 v[86:87], v25 offset:20480
    ds_read_b64_tr_b16 v[88:89], v25 offset:24576
    ds_read_b64_tr_b16 v[90:91], v25 offset:28672
    s_waitcnt lgkmcnt(12)
    v_mfma_f32_16x16x32_bf16 a[144:147], v[60:63], v[164:167], a[144:147]
    v_mfma_f32_16x16x32_bf16 a[144:147], v[64:67], v[200:203], a[144:147]
    v_mfma_f32_16x16x32_bf16 a[148:151], v[60:63], v[168:171], a[148:151]
    v_mfma_f32_16x16x32_bf16 a[148:151], v[64:67], v[204:207], a[148:151]
    v_mfma_f32_16x16x32_bf16 a[152:155], v[60:63], v[172:175], a[152:155]
    v_mfma_f32_16x16x32_bf16 a[152:155], v[64:67], v[208:211], a[152:155]
    v_mfma_f32_16x16x32_bf16 a[156:159], v[60:63], v[176:179], a[156:159]
    v_mfma_f32_16x16x32_bf16 a[156:159], v[64:67], v[212:215], a[156:159]
    v_mfma_f32_16x16x32_bf16 a[160:163], v[60:63], v[180:183], a[160:163]
    v_mfma_f32_16x16x32_bf16 a[160:163], v[64:67], v[216:219], a[160:163]
    v_mfma_f32_16x16x32_bf16 a[164:167], v[60:63], v[184:187], a[164:167]
    v_mfma_f32_16x16x32_bf16 a[164:167], v[64:67], v[220:223], a[164:167]
    v_mfma_f32_16x16x32_bf16 a[168:171], v[60:63], v[188:191], a[168:171]
    v_mfma_f32_16x16x32_bf16 a[168:171], v[64:67], v[224:227], a[168:171]
    v_mfma_f32_16x16x32_bf16 v[36:39], v[60:63], v[192:195], v[36:39]
    v_mfma_f32_16x16x32_bf16 v[36:39], v[64:67], v[228:231], v[36:39]
    v_mfma_f32_16x16x32_bf16 v[52:55], v[60:63], v[196:199], v[52:55]
    v_mfma_f32_16x16x32_bf16 v[52:55], v[64:67], v[232:235], v[52:55]
    s_waitcnt vmcnt(18)
    ds_read_b64_tr_b16 v[60:61], v18 offset:0
    ds_read_b64_tr_b16 v[62:63], v18 offset:4096
    ds_read_b64_tr_b16 v[64:65], v18 offset:8192
    ds_read_b64_tr_b16 v[66:67], v18 offset:12288
    s_waitcnt lgkmcnt(4)
    v_mfma_f32_16x16x32_bf16 a[172:175], v[68:71], v[164:167], a[172:175]
    s_add_u32 m0, s27, 16384
    v_mfma_f32_16x16x32_bf16 a[172:175], v[72:75], v[200:203], a[172:175]
    s_nop 0
    v_mfma_f32_16x16x32_bf16 a[176:179], v[68:71], v[168:171], a[176:179]
    buffer_load_dwordx4 v10, s[8:11], s26 offen offset:0 lds
    v_mfma_f32_16x16x32_bf16 a[176:179], v[72:75], v[204:207], a[176:179]
    buffer_load_dwordx4 v11, s[8:11], s26 offen offset:1024 lds
    v_mfma_f32_16x16x32_bf16 a[180:183], v[68:71], v[172:175], a[180:183]
    buffer_load_dwordx4 v12, s[8:11], s26 offen offset:2048 lds
    v_mfma_f32_16x16x32_bf16 a[180:183], v[72:75], v[208:211], a[180:183]
    buffer_load_dwordx4 v13, s[8:11], s26 offen offset:3072 lds
    v_mfma_f32_16x16x32_bf16 a[184:187], v[68:71], v[176:179], a[184:187]
    s_add_u32 m0, s27, 20480
    v_mfma_f32_16x16x32_bf16 a[184:187], v[72:75], v[212:215], a[184:187]
    s_nop 0
    v_mfma_f32_16x16x32_bf16 a[188:191], v[68:71], v[180:183], a[188:191]
    buffer_load_dwordx4 v14, s[8:11], s26 offen offset:0 lds
    v_mfma_f32_16x16x32_bf16 a[188:191], v[72:75], v[216:219], a[188:191]
    buffer_load_dwordx4 v15, s[8:11], s26 offen offset:1024 lds
    v_mfma_f32_16x16x32_bf16 a[192:195], v[68:71], v[184:187], a[192:195]
    buffer_load_dwordx4 v16, s[8:11], s26 offen offset:2048 lds
    v_mfma_f32_16x16x32_bf16 a[192:195], v[72:75], v[220:223], a[192:195]
    buffer_load_dwordx4 v17, s[8:11], s26 offen offset:3072 lds
    v_mfma_f32_16x16x32_bf16 a[196:199], v[68:71], v[188:191], a[196:199]
    s_add_u32 s26, s26, 163840
    v_mfma_f32_16x16x32_bf16 a[196:199], v[72:75], v[224:227], a[196:199]
    s_add_u32 m0, s27, 24576
    v_mfma_f32_16x16x32_bf16 v[40:43], v[68:71], v[192:195], v[40:43]
    s_nop 0
    v_mfma_f32_16x16x32_bf16 v[40:43], v[72:75], v[228:231], v[40:43]
    buffer_load_dwordx4 v10, s[8:11], s26 offen offset:0 lds
    v_mfma_f32_16x16x32_bf16 v[56:59], v[68:71], v[196:199], v[56:59]
    buffer_load_dwordx4 v11, s[8:11], s26 offen offset:1024 lds
    v_mfma_f32_16x16x32_bf16 v[56:59], v[72:75], v[232:235], v[56:59]
    ds_read_b64_tr_b16 v[68:69], v19 offset:0
    ds_read_b64_tr_b16 v[70:71], v19 offset:4096
    ds_read_b64_tr_b16 v[72:73], v19 offset:8192
    ds_read_b64_tr_b16 v[74:75], v19 offset:12288
    s_waitcnt lgkmcnt(12)
    v_mfma_f32_16x16x32_bf16 a[200:203], v[76:79], v[164:167], a[200:203]
    buffer_load_dwordx4 v12, s[8:11], s26 offen offset:2048 lds
    v_mfma_f32_16x16x32_bf16 a[200:203], v[80:83], v[200:203], a[200:203]
    buffer_load_dwordx4 v13, s[8:11], s26 offen offset:3072 lds
    v_mfma_f32_16x16x32_bf16 a[204:207], v[76:79], v[168:171], a[204:207]
    s_add_u32 m0, s27, 28672
    v_mfma_f32_16x16x32_bf16 a[204:207], v[80:83], v[204:207], a[204:207]
    s_nop 0
    v_mfma_f32_16x16x32_bf16 a[208:211], v[76:79], v[172:175], a[208:211]
    buffer_load_dwordx4 v14, s[8:11], s26 offen offset:0 lds
    v_mfma_f32_16x16x32_bf16 a[208:211], v[80:83], v[208:211], a[208:211]
    buffer_load_dwordx4 v15, s[8:11], s26 offen offset:1024 lds
    v_mfma_f32_16x16x32_bf16 a[212:215], v[76:79], v[176:179], a[212:215]
    buffer_load_dwordx4 v16, s[8:11], s26 offen offset:2048 lds
    v_mfma_f32_16x16x32_bf16 a[212:215], v[80:83], v[212:215], a[212:215]
    buffer_load_dwordx4 v17, s[8:11], s26 offen offset:3072 lds
    v_mfma_f32_16x16x32_bf16 v[244:247], v[76:79], v[180:183], v[244:247]
    s_add_u32 s26, s26, 163840
    v_mfma_f32_16x16x32_bf16 v[244:247], v[80:83], v[216:219], v[244:247]
    v_mfma_f32_16x16x32_bf16 a[216:219], v[76:79], v[184:187], a[216:219]
    v_mfma_f32_16x16x32_bf16 a[216:219], v[80:83], v[220:223], a[216:219]
    v_mfma_f32_16x16x32_bf16 v[28:31], v[76:79], v[188:191], v[28:31]
    v_mfma_f32_16x16x32_bf16 v[28:31], v[80:83], v[224:227], v[28:31]
    v_mfma_f32_16x16x32_bf16 v[44:47], v[76:79], v[192:195], v[44:47]
    v_mfma_f32_16x16x32_bf16 v[44:47], v[80:83], v[228:231], v[44:47]
    v_mfma_f32_16x16x32_bf16 v[236:239], v[76:79], v[196:199], v[236:239]
    v_mfma_f32_16x16x32_bf16 v[236:239], v[80:83], v[232:235], v[236:239]
    ds_read_b64_tr_b16 v[76:77], v20 offset:0
    ds_read_b64_tr_b16 v[78:79], v20 offset:4096
    ds_read_b64_tr_b16 v[80:81], v20 offset:8192
    ds_read_b64_tr_b16 v[82:83], v20 offset:12288
    s_waitcnt lgkmcnt(12)
    v_mfma_f32_16x16x32_bf16 a[220:223], v[84:87], v[164:167], a[220:223]
    v_mfma_f32_16x16x32_bf16 a[220:223], v[88:91], v[200:203], a[220:223]
    v_mfma_f32_16x16x32_bf16 a[224:227], v[84:87], v[168:171], a[224:227]
    v_mfma_f32_16x16x32_bf16 a[224:227], v[88:91], v[204:207], a[224:227]
    v_mfma_f32_16x16x32_bf16 a[228:231], v[84:87], v[172:175], a[228:231]
    v_mfma_f32_16x16x32_bf16 a[228:231], v[88:91], v[208:211], a[228:231]
    v_mfma_f32_16x16x32_bf16 a[232:235], v[84:87], v[176:179], a[232:235]
    v_mfma_f32_16x16x32_bf16 a[232:235], v[88:91], v[212:215], a[232:235]
    v_mfma_f32_16x16x32_bf16 v[248:251], v[84:87], v[180:183], v[248:251]
    v_mfma_f32_16x16x32_bf16 v[248:251], v[88:91], v[216:219], v[248:251]
    v_mfma_f32_16x16x32_bf16 a[236:239], v[84:87], v[184:187], a[236:239]
    v_mfma_f32_16x16x32_bf16 a[236:239], v[88:91], v[220:223], a[236:239]
    v_mfma_f32_16x16x32_bf16 v[32:35], v[84:87], v[188:191], v[32:35]
    v_mfma_f32_16x16x32_bf16 v[32:35], v[88:91], v[224:227], v[32:35]
    v_mfma_f32_16x16x32_bf16 v[48:51], v[84:87], v[192:195], v[48:51]
    v_mfma_f32_16x16x32_bf16 v[48:51], v[88:91], v[228:231], v[48:51]
    v_mfma_f32_16x16x32_bf16 v[240:243], v[84:87], v[196:199], v[240:243]
    v_mfma_f32_16x16x32_bf16 v[240:243], v[88:91], v[232:235], v[240:243]
    ds_read_b64_tr_b16 v[84:85], v21 offset:0
    ds_read_b64_tr_b16 v[86:87], v21 offset:4096
    ds_read_b64_tr_b16 v[88:89], v21 offset:8192
    ds_read_b64_tr_b16 v[90:91], v21 offset:12288
    s_mov_b32 s21, 0
L_op_loop:
    s_waitcnt vmcnt(16) lgkmcnt(12)
    v_mfma_f32_16x16x32_bf16 a[0:3], v[60:63], v[92:95], a[0:3]
    buffer_load_dwordx4 v[164:167], v7, s[4:7], s48 offen
    v_mfma_f32_16x16x32_bf16 a[0:3], v[64:67], v[128:131], a[0:3]
    buffer_load_dwordx4 v[168:171], v7, s[4:7], s49 offen
    v_mfma_f32_16x16x32_bf16 a[4:7], v[60:63], v[96:99], a[4:7]
    buffer_load_dwordx4 v[172:175], v7, s[4:7], s50 offen
    v_mfma_f32_16x16x32_bf16 a[4:7], v[64:67], v[132:135], a[4:7]
    buffer_load_dwordx4 v[176:179], v7, s[4:7], s51 offen
    v_mfma_f32_16x16x32_bf16 a[8:11], v[60:63], v[100:103], a[8:11]
    buffer_load_dwordx4 v[180:183], v7, s[4:7], s52 offen
    v_mfma_f32_16x16x32_bf16 a[8:11], v[64:67], v[136:139], a[8:11]
    buffer_load_dwordx4 v[184:187], v7, s[4:7], s53 offen
    v_mfma_f32_16x16x32_bf16 a[12:15], v[60:63], v[104:107], a[12:15]
    buffer_load_dwordx4 v[188:191], v7, s[4:7], s54 offen
    v_mfma_f32_16x16x32_bf16 a[12:15], v[64:67], v[140:143], a[12:15]
    buffer_load_dwordx4 v[192:195], v7, s[4:7], s55 offen
    v_mfma_f32_16x16x32_bf16 a[16:19], v[60:63], v[108:111], a[16:19]
    buffer_load_dwordx4 v[196:199], v7, s[4:7], s56 offen
    v_mfma_f32_16x16x32_bf16 a[16:19], v[64:67], v[144:147], a[16:19]
    v_add_u32 v7, 57344, v7
    v_mfma_f32_16x16x32_bf16 a[20:23], v[60:63], v[112:115], a[20:23]
    buffer_load_dwordx4 v[200:203], v7, s[4:7], s48 offen
    v_mfma_f32_16x16x32_bf16 a[20:23], v[64:67], v[148:151], a[20:23]
    buffer_load_dwordx4 v[204:207], v7, s[4:7], s49 offen
    v_mfma_f32_16x16x32_bf16 a[24:27], v[60:63], v[116:119], a[24:27]
    buffer_load_dwordx4 v[208:211], v7, s[4:7], s50 offen
    v_mfma_f32_16x16x32_bf16 a[24:27], v[64:67], v[152:155], a[24:27]
    buffer_load_dwordx4 v[212:215], v7, s[4:7], s51 offen
    v_mfma_f32_16x16x32_bf16 a[28:31], v[60:63], v[120:123], a[28:31]
    buffer_load_dwordx4 v[216:219], v7, s[4:7], s52 offen
    v_mfma_f32_16x16x32_bf16 a[28:31], v[64:67], v[156:159], a[28:31]
    buffer_load_dwordx4 v[220:223], v7, s[4:7], s53 offen
    v_mfma_f32_16x16x32_bf16 a[32:35], v[60:63], v[124:127], a[32:35]
    buffer_load_dwordx4 v[224:227], v7, s[4:7], s54 offen
    v_mfma_f32_16x16x32_bf16 a[32:35], v[64:67], v[160:163], a[32:35]
    ds_read_b64_tr_b16 v[60:61], v22 offset:0
    ds_read_b64_tr_b16 v[62:63], v22 offset:4096
    ds_read_b64_tr_b16 v[64:65], v22 offset:8192
    ds_read_b64_tr_b16 v[66:67], v22 offset:12288
    s_waitcnt lgkmcnt(12)
    v_mfma_f32_16x16x32_bf16 a[36:39], v[68:71], v[92:95], a[36:39]
    buffer_load_dwordx4 v[228:231], v7, s[4:7], s55 offen
    v_mfma_f32_16x16x32_bf16 a[36:39], v[72:75], v[128:131], a[36:39]
    buffer_load_dwordx4 v[232:235], v7, s[4:7], s56 offen
    v_mfma_f32_16x16x32_bf16 a[40:43], v[68:71], v[96:99], a[40:43]
    v_add_u32 v7, 57344, v7
    v_mfma_f32_16x16x32_bf16 a[40:43], v[72:75], v[132:135], a[40:43]
    v_mfma_f32_16x16x32_bf16 a[44:47], v[68:71], v[100:103], a[44:47]
    v_mfma_f32_16x16x32_bf16 a[44:47], v[72:75], v[136:139], a[44:47]
    v_mfma_f32_16x16x32_bf16 a[48:51], v[68:71], v[104:107], a[48:51]
    v_mfma_f32_16x16x32_bf16 a[48:51], v[72:75], v[140:143], a[48:51]
    v_mfma_f32_16x16x32_bf16 a[52:55], v[68:71], v[108:111], a[52:55]
    v_mfma_f32_16x16x32_bf16 a[52:55], v[72:75], v[144:147], a[52:55]
    v_mfma_f32_16x16x32_bf16 a[56:59], v[68:71], v[112:115], a[56:59]
    v_mfma_f32_16x16x32_bf16 a[56:59], v[72:75], v[148:151], a[56:59]
    v_mfma_f32_16x16x32_bf16 a[60:63], v[68:71], v[116:119], a[60:63]
    v_mfma_f32_16x16x32_bf16 a[60:63], v[72:75], v[152:155], a[60:63]
    v_mfma_f32_16x16x32_bf16 a[64:67], v[68:71], v[120:123], a[64:67]
    v_mfma_f32_16x16x32_bf16 a[64:67], v[72:75], v[156:159], a[64:67]
    v_mfma_f32_16x16x32_bf16 a[68:71], v[68:71], v[124:127], a[68:71]
    v_mfma_f32_16x16x32_bf16 a[68:71], v[72:75], v[160:163], a[68:71]
    ds_read_b64_tr_b16 v[68:69], v23 offset:0
    ds_read_b64_tr_b16 v[70:71], v23 offset:4096
    ds_read_b64_tr_b16 v[72:73], v23 offset:8192
    ds_read_b64_tr_b16 v[74:75], v23 offset:12288
    s_waitcnt lgkmcnt(12)
    v_mfma_f32_16x16x32_bf16 a[72:75], v[76:79], v[92:95], a[72:75]
    v_mfma_f32_16x16x32_bf16 a[72:75], v[80:83], v[128:131], a[72:75]
    v_mfma_f32_16x16x32_bf16 a[76:79], v[76:79], v[96:99], a[76:79]
    v_mfma_f32_16x16x32_bf16 a[76:79], v[80:83], v[132:135], a[76:79]
    v_mfma_f32_16x16x32_bf16 a[80:83], v[76:79], v[100:103], a[80:83]
    v_mfma_f32_16x16x32_bf16 a[80:83], v[80:83], v[136:139], a[80:83]
    v_mfma_f32_16x16x32_bf16 a[84:87], v[76:79], v[104:107], a[84:87]
    v_mfma_f32_16x16x32_bf16 a[84:87], v[80:83], v[140:143], a[84:87]
    v_mfma_f32_16x16x32_bf16 a[88:91], v[76:79], v[108:111], a[88:91]
    v_mfma_f32_16x16x32_bf16 a[88:91], v[80:83], v[144:147], a[88:91]
    v_mfma_f32_16x16x32_bf16 a[92:95], v[76:79], v[112:115], a[92:95]
    v_mfma_f32_16x16x32_bf16 a[92:95], v[80:83], v[148:151], a[92:95]
    v_mfma_f32_16x16x32_bf16 a[96:99], v[76:79], v[116:119], a[96:99]
    v_mfma_f32_16x16x32_bf16 a[96:99], v[80:83], v[152:155], a[96:99]
    v_mfma_f32_16x16x32_bf16 a[100:103], v[76:79], v[120:123], a[100:103]
    v_mfma_f32_16x16x32_bf16 a[100:103], v[80:83], v[156:159], a[100:103]
    v_mfma_f32_16x16x32_bf16 a[104:107], v[76:79], v[124:127], a[104:107]
    v_mfma_f32_16x16x32_bf16 a[104:107], v[80:83], v[160:163], a[104:107]
    ds_read_b64_tr_b16 v[76:77], v24 offset:0
    ds_read_b64_tr_b16 v[78:79], v24 offset:4096
    ds_read_b64_tr_b16 v[80:81], v24 offset:8192
    ds_read_b64_tr_b16 v[82:83], v24 offset:12288
    s_waitcnt lgkmcnt(12)
    v_mfma_f32_16x16x32_bf16 a[108:111], v[84:87], v[92:95], a[108:111]
    v_mfma_f32_16x16x32_bf16 a[108:111], v[88:91], v[128:131], a[108:111]
    v_mfma_f32_16x16x32_bf16 a[112:115], v[84:87], v[96:99], a[112:115]
    v_mfma_f32_16x16x32_bf16 a[112:115], v[88:91], v[132:135], a[112:115]
    v_mfma_f32_16x16x32_bf16 a[116:119], v[84:87], v[100:103], a[116:119]
    v_mfma_f32_16x16x32_bf16 a[116:119], v[88:91], v[136:139], a[116:119]
    v_mfma_f32_16x16x32_bf16 a[120:123], v[84:87], v[104:107], a[120:123]
    v_mfma_f32_16x16x32_bf16 a[120:123], v[88:91], v[140:143], a[120:123]
    v_mfma_f32_16x16x32_bf16 a[124:127], v[84:87], v[108:111], a[124:127]
    v_mfma_f32_16x16x32_bf16 a[124:127], v[88:91], v[144:147], a[124:127]
    v_mfma_f32_16x16x32_bf16 a[128:131], v[84:87], v[112:115], a[128:131]
    v_mfma_f32_16x16x32_bf16 a[128:131], v[88:91], v[148:151], a[128:131]
    v_mfma_f32_16x16x32_bf16 a[132:135], v[84:87], v[116:119], a[132:135]
    v_mfma_f32_16x16x32_bf16 a[132:135], v[88:91], v[152:155], a[132:135]
    v_mfma_f32_16x16x32_bf16 a[136:139], v[84:87], v[120:123], a[136:139]
    v_mfma_f32_16x16x32_bf16 a[136:139], v[88:91], v[156:159], a[136:139]
    v_mfma_f32_16x16x32_bf16 a[140:143], v[84:87], v[124:127], a[140:143]
    v_mfma_f32_16x16x32_bf16 a[140:143], v[88:91], v[160:163], a[140:143]
    ds_read_b64_tr_b16 v[84:85], v25 offset:0
    ds_read_b64_tr_b16 v[86:87], v25 offset:4096
    ds_read_b64_tr_b16 v[88:89], v25 offset:8192
    ds_read_b64_tr_b16 v[90:91], v25 offset:12288
    s_waitcnt lgkmcnt(12)
    v_mfma_f32_16x16x32_bf16 a[144:147], v[60:63], v[92:95], a[144:147]
    v_mfma_f32_16x16x32_bf16 a[144:147], v[64:67], v[128:131], a[144:147]
    v_mfma_f32_16x16x32_bf16 a[148:151], v[60:63], v[96:99], a[148:151]
    v_mfma_f32_16x16x32_bf16 a[148:151], v[64:67], v[132:135], a[148:151]
    v_mfma_f32_16x16x32_bf16 a[152:155], v[60:63], v[100:103], a[152:155]
    v_mfma_f32_16x16x32_bf16 a[152:155], v[64:67], v[136:139], a[152:155]
    v_mfma_f32_16x16x32_bf16 a[156:159], v[60:63], v[104:107], a[156:159]
    v_mfma_f32_16x16x32_bf16 a[156:159], v[64:67], v[140:143], a[156:159]
    v_mfma_f32_16x16x32_bf16 a[160:163], v[60:63], v[108:111], a[160:163]
    v_mfma_f32_16x16x32_bf16 a[160:163], v[64:67], v[144:147], a[160:163]
    v_mfma_f32_16x16x32_bf16 a[164:167], v[60:63], v[112:115], a[164:167]
    v_mfma_f32_16x16x32_bf16 a[164:167], v[64:67], v[148:151], a[164:167]
    v_mfma_f32_16x16x32_bf16 a[168:171], v[60:63], v[116:119], a[168:171]
    v_mfma_f32_16x16x32_bf16 a[168:171], v[64:67], v[152:155], a[168:171]
    v_mfma_f32_16x16x32_bf16 v[36:39], v[60:63], v[120:123], v[36:39]
    v_mfma_f32_16x16x32_bf16 v[36:39], v[64:67], v[156:159], v[36:39]
    v_mfma_f32_16x16x32_bf16 v[52:55], v[60:63], v[124:127], v[52:55]
    v_mfma_f32_16x16x32_bf16 v[52:55], v[64:67], v[160:163], v[52:55]
    s_waitcnt vmcnt(18)
    ds_read_b64_tr_b16 v[60:61], v18 offset:16384
    ds_read_b64_tr_b16 v[62:63], v18 offset:20480
    ds_read_b64_tr_b16 v[64:65], v18 offset:24576
    ds_read_b64_tr_b16 v[66:67], v18 offset:28672
    s_waitcnt lgkmcnt(4)
    v_mfma_f32_16x16x32_bf16 a[172:175], v[68:71], v[92:95], a[172:175]
    s_add_u32 m0, s27, 0
    v_mfma_f32_16x16x32_bf16 a[172:175], v[72:75], v[128:131], a[172:175]
    s_nop 0
    v_mfma_f32_16x16x32_bf16 a[176:179], v[68:71], v[96:99], a[176:179]
    buffer_load_dwordx4 v10, s[8:11], s26 offen offset:0 lds
    v_mfma_f32_16x16x32_bf16 a[176:179], v[72:75], v[132:135], a[176:179]
    buffer_load_dwordx4 v11, s[8:11], s26 offen offset:1024 lds
    v_mfma_f32_16x16x32_bf16 a[180:183], v[68:71], v[100:103], a[180:183]
    buffer_load_dwordx4 v12, s[8:11], s26 offen offset:2048 lds
    v_mfma_f32_16x16x32_bf16 a[180:183], v[72:75], v[136:139], a[180:183]
    buffer_load_dwordx4 v13, s[8:11], s26 offen offset:3072 lds
    v_mfma_f32_16x16x32_bf16 a[184:187], v[68:71], v[104:107], a[184:187]
    s_add_u32 m0, s27, 4096
    v_mfma_f32_16x16x32_bf16 a[184:187], v[72:75], v[140:143], a[184:187]
    s_nop 0
    v_mfma_f32_16x16x32_bf16 a[188:191], v[68:71], v[108:111], a[188:191]
    buffer_load_dwordx4 v14, s[8:11], s26 offen offset:0 lds
    v_mfma_f32_16x16x32_bf16 a[188:191], v[72:75], v[144:147], a[188:191]
    buffer_load_dwordx4 v15, s[8:11], s26 offen offset:1024 lds
    v_mfma_f32_16x16x32_bf16 a[192:195], v[68:71], v[112:115], a[192:195]
    buffer_load_dwordx4 v16, s[8:11], s26 offen offset:2048 lds
    v_mfma_f32_16x16x32_bf16 a[192:195], v[72:75], v[148:151], a[192:195]
    buffer_load_dwordx4 v17, s[8:11], s26 offen offset:3072 lds
    v_mfma_f32_16x16x32_bf16 a[196:199], v[68:71], v[116:119], a[196:199]
    s_add_u32 s26, s26, 163840
    v_mfma_f32_16x16x32_bf16 a[196:199], v[72:75], v[152:155], a[196:199]
    s_add_u32 m0, s27, 8192
    v_mfma_f32_16x16x32_bf16 v[40:43], v[68:71], v[120:123], v[40:43]
    s_nop 0
    v_mfma_f32_16x16x32_bf16 v[40:43], v[72:75], v[156:159], v[40:43]
    buffer_load_dwordx4 v10, s[8:11], s26 offen offset:0 lds
    v_mfma_f32_16x16x32_bf16 v[56:59], v[68:71], v[124:127], v[56:59]
    buffer_load_dwordx4 v11, s[8:11], s26 offen offset:1024 lds
    v_mfma_f32_16x16x32_bf16 v[56:59], v[72:75], v[160:163], v[56:59]
    ds_read_b64_tr_b16 v[68:69], v19 offset:16384
    ds_read_b64_tr_b16 v[70:71], v19 offset:20480
    ds_read_b64_tr_b16 v[72:73], v19 offset:24576
    ds_read_b64_tr_b16 v[74:75], v19 offset:28672
    s_waitcnt lgkmcnt(12)
    v_mfma_f32_16x16x32_bf16 a[200:203], v[76:79], v[92:95], a[200:203]
    buffer_load_dwordx4 v12, s[8:11], s26 offen offset:2048 lds
    v_mfma_f32_16x16x32_bf16 a[200:203], v[80:83], v[128:131], a[200:203]
    buffer_load_dwordx4 v13, s[8:11], s26 offen offset:3072 lds
    v_mfma_f32_16x16x32_bf16 a[204:207], v[76:79], v[96:99], a[204:207]
    s_add_u32 m0, s27, 12288
    v_mfma_f32_16x16x32_bf16 a[204:207], v[80:83], v[132:135], a[204:207]
    s_nop 0
    v_mfma_f32_16x16x32_bf16 a[208:211], v[76:79], v[100:103], a[208:211]
    buffer_load_dwordx4 v14, s[8:11], s26 offen offset:0 lds
    v_mfma_f32_16x16x32_bf16 a[208:211], v[80:83], v[136:139], a[208:211]
    buffer_load_dwordx4 v15, s[8:11], s26 offen offset:1024 lds
    v_mfma_f32_16x16x32_bf16 a[212:215], v[76:79], v[104:107], a[212:215]
    buffer_load_dwordx4 v16, s[8:11], s26 offen offset:2048 lds
    v_mfma_f32_16x16x32_bf16 a[212:215], v[80:83], v[140:143], a[212:215]
    buffer_load_dwordx4 v17, s[8:11], s26 offen offset:3072 lds
    v_mfma_f32_16x16x32_bf16 v[244:247], v[76:79], v[108:111], v[244:247]
    s_add_u32 s26, s26, 163840
    v_mfma_f32_16x16x32_bf16 v[244:247], v[80:83], v[144:147], v[244:247]
    v_mfma_f32_16x16x32_bf16 a[216:219], v[76:79], v[112:115], a[216:219]
    v_mfma_f32_16x16x32_bf16 a[216:219], v[80:83], v[148:151], a[216:219]
    v_mfma_f32_16x16x32_bf16 v[28:31], v[76:79], v[116:119], v[28:31]
    v_mfma_f32_16x16x32_bf16 v[28:31], v[80:83], v[152:155], v[28:31]
    v_mfma_f32_16x16x32_bf16 v[44:47], v[76:79], v[120:123], v[44:47]
    v_mfma_f32_16x16x32_bf16 v[44:47], v[80:83], v[156:159], v[44:47]
    v_mfma_f32_16x16x32_bf16 v[236:239], v[76:79], v[124:127], v[236:239]
    v_mfma_f32_16x16x32_bf16 v[236:239], v[80:83], v[160:163], v[236:239]
    ds_read_b64_tr_b16 v[76:77], v20 offset:16384
    ds_read_b64_tr_b16 v[78:79], v20 offset:20480
    ds_read_b64_tr_b16 v[80:81], v20 offset:24576
    ds_read_b64_tr_b16 v[82:83], v20 offset:28672
    s_waitcnt lgkmcnt(12)
    v_mfma_f32_16x16x32_bf16 a[220:223], v[84:87], v[92:95], a[220:223]
    v_mfma_f32_16x16x32_bf16 a[220:223], v[88:91], v[128:131], a[220:223]
    v_mfma_f32_16x16x32_bf16 a[224:227], v[84:87], v[96:99], a[224:227]
    v_mfma_f32_16x16x32_bf16 a[224:227], v[88:91], v[132:135], a[224:227]
    v_mfma_f32_16x16x32_bf16 a[228:231], v[84:87], v[100:103], a[228:231]
    v_mfma_f32_16x16x32_bf16 a[228:231], v[88:91], v[136:139], a[228:231]
    v_mfma_f32_16x16x32_bf16 a[232:235], v[84:87], v[104:107], a[232:235]
    v_mfma_f32_16x16x32_bf16 a[232:235], v[88:91], v[140:143], a[232:235]
    v_mfma_f32_16x16x32_bf16 v[248:251], v[84:87], v[108:111], v[248:251]
    v_mfma_f32_16x16x32_bf16 v[248:251], v[88:91], v[144:147], v[248:251]
    v_mfma_f32_16x16x32_bf16 a[236:239], v[84:87], v[112:115], a[236:239]
    v_mfma_f32_16x16x32_bf16 a[236:239], v[88:91], v[148:151], a[236:239]
    v_mfma_f32_16x16x32_bf16 v[32:35], v[84:87], v[116:119], v[32:35]
    v_mfma_f32_16x16x32_bf16 v[32:35], v[88:91], v[152:155], v[32:35]
    v_mfma_f32_16x16x32_bf16 v[48:51], v[84:87], v[120:123], v[48:51]
    v_mfma_f32_16x16x32_bf16 v[48:51], v[88:91], v[156:159], v[48:51]
    v_mfma_f32_16x16x32_bf16 v[240:243], v[84:87], v[124:127], v[240:243]
    v_mfma_f32_16x16x32_bf16 v[240:243], v[88:91], v[160:163], v[240:243]
    ds_read_b64_tr_b16 v[84:85], v21 offset:16384
    ds_read_b64_tr_b16 v[86:87], v21 offset:20480
    ds_read_b64_tr_b16 v[88:89], v21 offset:24576
    ds_read_b64_tr_b16 v[90:91], v21 offset:28672
    s_waitcnt vmcnt(16) lgkmcnt(12)
    v_mfma_f32_16x16x32_bf16 a[0:3], v[60:63], v[164:167], a[0:3]
    buffer_load_dwordx4 v[92:95], v7, s[4:7], s48 offen
    v_mfma_f32_16x16x32_bf16 a[0:3], v[64:67], v[200:203], a[0:3]
    buffer_load_dwordx4 v[96:99], v7, s[4:7], s49 offen
    v_mfma_f32_16x16x32_bf16 a[4:7], v[60:63], v[168:171], a[4:7]
    buffer_load_dwordx4 v[100:103], v7, s[4:7], s50 offen
    v_mfma_f32_16x16x32_bf16 a[4:7], v[64:67], v[204:207], a[4:7]
    buffer_load_dwordx4 v[104:107], v7, s[4:7], s51 offen
    v_mfma_f32_16x16x32_bf16 a[8:11], v[60:63], v[172:175], a[8:11]
    buffer_load_dwordx4 v[108:111], v7, s[4:7], s52 offen
    v_mfma_f32_16x16x32_bf16 a[8:11], v[64:67], v[208:211], a[8:11]
    buffer_load_dwordx4 v[112:115], v7, s[4:7], s53 offen
    v_mfma_f32_16x16x32_bf16 a[12:15], v[60:63], v[176:179], a[12:15]
    buffer_load_dwordx4 v[116:119], v7, s[4:7], s54 offen
    v_mfma_f32_16x16x32_bf16 a[12:15], v[64:67], v[212:215], a[12:15]
    buffer_load_dwordx4 v[120:123], v7, s[4:7], s55 offen
    v_mfma_f32_16x16x32_bf16 a[16:19], v[60:63], v[180:183], a[16:19]
    buffer_load_dwordx4 v[124:127], v7, s[4:7], s56 offen
    v_mfma_f32_16x16x32_bf16 a[16:19], v[64:67], v[216:219], a[16:19]
    v_add_u32 v7, 57344, v7
    v_mfma_f32_16x16x32_bf16 a[20:23], v[60:63], v[184:187], a[20:23]
    buffer_load_dwordx4 v[128:131], v7, s[4:7], s48 offen
    v_mfma_f32_16x16x32_bf16 a[20:23], v[64:67], v[220:223], a[20:23]
    buffer_load_dwordx4 v[132:135], v7, s[4:7], s49 offen
    v_mfma_f32_16x16x32_bf16 a[24:27], v[60:63], v[188:191], a[24:27]
    buffer_load_dwordx4 v[136:139], v7, s[4:7], s50 offen
    v_mfma_f32_16x16x32_bf16 a[24:27], v[64:67], v[224:227], a[24:27]
    buffer_load_dwordx4 v[140:143], v7, s[4:7], s51 offen
    v_mfma_f32_16x16x32_bf16 a[28:31], v[60:63], v[192:195], a[28:31]
    buffer_load_dwordx4 v[144:147], v7, s[4:7], s52 offen
    v_mfma_f32_16x16x32_bf16 a[28:31], v[64:67], v[228:231], a[28:31]
    buffer_load_dwordx4 v[148:151], v7, s[4:7], s53 offen
    v_mfma_f32_16x16x32_bf16 a[32:35], v[60:63], v[196:199], a[32:35]
    buffer_load_dwordx4 v[152:155], v7, s[4:7], s54 offen
    v_mfma_f32_16x16x32_bf16 a[32:35], v[64:67], v[232:235], a[32:35]
    ds_read_b64_tr_b16 v[60:61], v22 offset:16384
    ds_read_b64_tr_b16 v[62:63], v22 offset:20480
    ds_read_b64_tr_b16 v[64:65], v22 offset:24576
    ds_read_b64_tr_b16 v[66:67], v22 offset:28672
    s_waitcnt lgkmcnt(12)
    v_mfma_f32_16x16x32_bf16 a[36:39], v[68:71], v[164:167], a[36:39]
    buffer_load_dwordx4 v[156:159], v7, s[4:7], s55 offen
    v_mfma_f32_16x16x32_bf16 a[36:39], v[72:75], v[200:203], a[36:39]
    buffer_load_dwordx4 v[160:163], v7, s[4:7], s56 offen
    v_mfma_f32_16x16x32_bf16 a[40:43], v[68:71], v[168:171], a[40:43]
    v_add_u32 v7, 57344, v7
    v_mfma_f32_16x16x32_bf16 a[40:43], v[72:75], v[204:207], a[40:43]
    v_mfma_f32_16x16x32_bf16 a[44:47], v[68:71], v[172:175], a[44:47]
    v_mfma_f32_16x16x32_bf16 a[44:47], v[72:75], v[208:211], a[44:47]
    v_mfma_f32_16x16x32_bf16 a[48:51], v[68:71], v[176:179], a[48:51]
    v_mfma_f32_16x16x32_bf16 a[48:51], v[72:75], v[212:215], a[48:51]
    v_mfma_f32_16x16x32_bf16 a[52:55], v[68:71], v[180:183], a[52:55]
    v_mfma_f32_16x16x32_bf16 a[52:55], v[72:75], v[216:219], a[52:55]
    v_mfma_f32_16x16x32_bf16 a[56:59], v[68:71], v[184:187], a[56:59]
    v_mfma_f32_16x16x32_bf16 a[56:59], v[72:75], v[220:223], a[56:59]
    v_mfma_f32_16x16x32_bf16 a[60:63], v[68:71], v[188:191], a[60:63]
    v_mfma_f32_16x16x32_bf16 a[60:63], v[72:75], v[224:227], a[60:63]
    v_mfma_f32_16x16x32_bf16 a[64:67], v[68:71], v[192:195], a[64:67]
    v_mfma_f32_16x16x32_bf16 a[64:67], v[72:75], v[228:231], a[64:67]
    v_mfma_f32_16x16x32_bf16 a[68:71], v[68:71], v[196:199], a[68:71]
    v_mfma_f32_16x16x32_bf16 a[68:71], v[72:75], v[232:235], a[68:71]
    ds_read_b64_tr_b16 v[68:69], v23 offset:16384
    ds_read_b64_tr_b16 v[70:71], v23 offset:20480
    ds_read_b64_tr_b16 v[72:73], v23 offset:24576
    ds_read_b64_tr_b16 v[74:75], v23 offset:28672
    s_waitcnt lgkmcnt(12)
    v_mfma_f32_16x16x32_bf16 a[72:75], v[76:79], v[164:167], a[72:75]
    v_mfma_f32_16x16x32_bf16 a[72:75], v[80:83], v[200:203], a[72:75]
    v_mfma_f32_16x16x32_bf16 a[76:79], v[76:79], v[168:171], a[76:79]
    v_mfma_f32_16x16x32_bf16 a[76:79], v[80:83], v[204:207], a[76:79]
    v_mfma_f32_16x16x32_bf16 a[80:83], v[76:79], v[172:175], a[80:83]
    v_mfma_f32_16x16x32_bf16 a[80:83], v[80:83], v[208:211], a[80:83]
    v_mfma_f32_16x16x32_bf16 a[84:87], v[76:79], v[176:179], a[84:87]
    v_mfma_f32_16x16x32_bf16 a[84:87], v[80:83], v[212:215], a[84:87]
    v_mfma_f32_16x16x32_bf16 a[88:91], v[76:79], v[180:183], a[88:91]
    v_mfma_f32_16x16x32_bf16 a[88:91], v[80:83], v[216:219], a[88:91]
    v_mfma_f32_16x16x32_bf16 a[92:95], v[76:79], v[184:187], a[92:95]
    v_mfma_f32_16x16x32_bf16 a[92:95], v[80:83], v[220:223], a[92:95]
    v_mfma_f32_16x16x32_bf16 a[96:99], v[76:79], v[188:191], a[96:99]
    v_mfma_f32_16x16x32_bf16 a[96:99], v[80:83], v[224:227], a[96:99]
    v_mfma_f32_16x16x32_bf16 a[100:103], v[76:79], v[192:195], a[100:103]
    v_mfma_f32_16x16x32_bf16 a[100:103], v[80:83], v[228:231], a[100:103]
    v_mfma_f32_16x16x32_bf16 a[104:107], v[76:79], v[196:199], a[104:107]
    v_mfma_f32_16x16x32_bf16 a[104:107], v[80:83], v[232:235], a[104:107]
    ds_read_b64_tr_b16 v[76:77], v24 offset:16384
    ds_read_b64_tr_b16 v[78:79], v24 offset:20480
    ds_read_b64_tr_b16 v[80:81], v24 offset:24576
    ds_read_b64_tr_b16 v[82:83], v24 offset:28672
    s_waitcnt lgkmcnt(12)
    v_mfma_f32_16x16x32_bf16 a[108:111], v[84:87], v[164:167], a[108:111]
    v_mfma_f32_16x16x32_bf16 a[108:111], v[88:91], v[200:203], a[108:111]
    v_mfma_f32_16x16x32_bf16 a[112:115], v[84:87], v[168:171], a[112:115]
    v_mfma_f32_16x16x32_bf16 a[112:115], v[88:91], v[204:207], a[112:115]
    v_mfma_f32_16x16x32_bf16 a[116:119], v[84:87], v[172:175], a[116:119]
    v_mfma_f32_16x16x32_bf16 a[116:119], v[88:91], v[208:211], a[116:119]
    v_mfma_f32_16x16x32_bf16 a[120:123], v[84:87], v[176:179], a[120:123]
    v_mfma_f32_16x16x32_bf16 a[120:123], v[88:91], v[212:215], a[120:123]
    v_mfma_f32_16x16x32_bf16 a[124:127], v[84:87], v[180:183], a[124:127]
    v_mfma_f32_16x16x32_bf16 a[124:127], v[88:91], v[216:219], a[124:127]
    v_mfma_f32_16x16x32_bf16 a[128:131], v[84:87], v[184:187], a[128:131]
    v_mfma_f32_16x16x32_bf16 a[128:131], v[88:91], v[220:223], a[128:131]
    v_mfma_f32_16x16x32_bf16 a[132:135], v[84:87], v[188:191], a[132:135]
    v_mfma_f32_16x16x32_bf16 a[132:135], v[88:91], v[224:227], a[132:135]
    v_mfma_f32_16x16x32_bf16 a[136:139], v[84:87], v[192:195], a[136:139]
    v_mfma_f32_16x16x32_bf16 a[136:139], v[88:91], v[228:231], a[136:139]
    v_mfma_f32_16x16x32_bf16 a[140:143], v[84:87], v[196:199], a[140:143]
    v_mfma_f32_16x16x32_bf16 a[140:143], v[88:91], v[232:235], a[140:143]
    ds_read_b64_tr_b16 v[84:85], v25 offset:16384
    ds_read_b64_tr_b16 v[86:87], v25 offset:20480
    ds_read_b64_tr_b16 v[88:89], v25 offset:24576
    ds_read_b64_tr_b16 v[90:91], v25 offset:28672
    s_waitcnt lgkmcnt(12)
    v_mfma_f32_16x16x32_bf16 a[144:147], v[60:63], v[164:167], a[144:147]
    v_mfma_f32_16x16x32_bf16 a[144:147], v[64:67], v[200:203], a[144:147]
    v_mfma_f32_16x16x32_bf16 a[148:151], v[60:63], v[168:171], a[148:151]
    v_mfma_f32_16x16x32_bf16 a[148:151], v[64:67], v[204:207], a[148:151]
    v_mfma_f32_16x16x32_bf16 a[152:155], v[60:63], v[172:175], a[152:155]
    v_mfma_f32_16x16x32_bf16 a[152:155], v[64:67], v[208:211], a[152:155]
    v_mfma_f32_16x16x32_bf16 a[156:159], v[60:63], v[176:179], a[156:159]
    v_mfma_f32_16x16x32_bf16 a[156:159], v[64:67], v[212:215], a[156:159]
    v_mfma_f32_16x16x32_bf16 a[160:163], v[60:63], v[180:183], a[160:163]
    v_mfma_f32_16x16x32_bf16 a[160:163], v[64:67], v[216:219], a[160:163]
    v_mfma_f32_16x16x32_bf16 a[164:167], v[60:63], v[184:187], a[164:167]
    v_mfma_f32_16x16x32_bf16 a[164:167], v[64:67], v[220:223], a[164:167]
    v_mfma_f32_16x16x32_bf16 a[168:171], v[60:63], v[188:191], a[168:171]
    v_mfma_f32_16x16x32_bf16 a[168:171], v[64:67], v[224:227], a[168:171]
    v_mfma_f32_16x16x32_bf16 v[36:39], v[60:63], v[192:195], v[36:39]
    v_mfma_f32_16x16x32_bf16 v[36:39], v[64:67], v[228:231], v[36:39]
    v_mfma_f32_16x16x32_bf16 v[52:55], v[60:63], v[196:199], v[52:55]
    v_mfma_f32_16x16x32_bf16 v[52:55], v[64:67], v[232:235], v[52:55]
    s_waitcnt vmcnt(18)
    ds_read_b64_tr_b16 v[60:61], v18 offset:0
    ds_read_b64_tr_b16 v[62:63], v18 offset:4096
    ds_read_b64_tr_b16 v[64:65], v18 offset:8192
    ds_read_b64_tr_b16 v[66:67], v18 offset:12288
    s_waitcnt lgkmcnt(4)
    v_mfma_f32_16x16x32_bf16 a[172:175], v[68:71], v[164:167], a[172:175]
    s_add_u32 m0, s27, 16384
    v_mfma_f32_16x16x32_bf16 a[172:175], v[72:75], v[200:203], a[172:175]
    s_nop 0
    v_mfma_f32_16x16x32_bf16 a[176:179], v[68:71], v[168:171], a[176:179]
    buffer_load_dwordx4 v10, s[8:11], s26 offen offset:0 lds
    v_mfma_f32_16x16x32_bf16 a[176:179], v[72:75], v[204:207], a[176:179]
    buffer_load_dwordx4 v11, s[8:11], s26 offen offset:1024 lds
    v_mfma_f32_16x16x32_bf16 a[180:183], v[68:71], v[172:175], a[180:183]
    buffer_load_dwordx4 v12, s[8:11], s26 offen offset:2048 lds
    v_mfma_f32_16x16x32_bf16 a[180:183], v[72:75], v[208:211], a[180:183]
    buffer_load_dwordx4 v13, s[8:11], s26 offen offset:3072 lds
    v_mfma_f32_16x16x32_bf16 a[184:187], v[68:71], v[176:179], a[184:187]
    s_add_u32 m0, s27, 20480
    v_mfma_f32_16x16x32_bf16 a[184:187], v[72:75], v[212:215], a[184:187]
    s_nop 0
    v_mfma_f32_16x16x32_bf16 a[188:191], v[68:71], v[180:183], a[188:191]
    buffer_load_dwordx4 v14, s[8:11], s26 offen offset:0 lds
    v_mfma_f32_16x16x32_bf16 a[188:191], v[72:75], v[216:219], a[188:191]
    buffer_load_dwordx4 v15, s[8:11], s26 offen offset:1024 lds
    v_mfma_f32_16x16x32_bf16 a[192:195], v[68:71], v[184:187], a[192:195]
    buffer_load_dwordx4 v16, s[8:11], s26 offen offset:2048 lds
    v_mfma_f32_16x16x32_bf16 a[192:195], v[72:75], v[220:223], a[192:195]
    buffer_load_dwordx4 v17, s[8:11], s26 offen offset:3072 lds
    v_mfma_f32_16x16x32_bf16 a[196:199], v[68:71], v[188:191], a[196:199]
    s_add_u32 s26, s26, 163840
    v_mfma_f32_16x16x32_bf16 a[196:199], v[72:75], v[224:227], a[196:199]
    s_add_u32 m0, s27, 24576
    v_mfma_f32_16x16x32_bf16 v[40:43], v[68:71], v[192:195], v[40:43]
    s_nop 0
    v_mfma_f32_16x16x32_bf16 v[40:43], v[72:75], v[228:231], v[40:43]
    buffer_load_dwordx4 v10, s[8:11], s26 offen offset:0 lds
    v_mfma_f32_16x16x32_bf16 v[56:59], v[68:71], v[196:199], v[56:59]
    buffer_load_dwordx4 v11, s[8:11], s26 offen offset:1024 lds
    v_mfma_f32_16x16x32_bf16 v[56:59], v[72:75], v[232:235], v[56:59]
    ds_read_b64_tr_b16 v[68:69], v19 offset:0
    ds_read_b64_tr_b16 v[70:71], v19 offset:4096
    ds_read_b64_tr_b16 v[72:73], v19 offset:8192
    ds_read_b64_tr_b16 v[74:75], v19 offset:12288
    s_waitcnt lgkmcnt(12)
    v_mfma_f32_16x16x32_bf16 a[200:203], v[76:79], v[164:167], a[200:203]
    buffer_load_dwordx4 v12, s[8:11], s26 offen offset:2048 lds
    v_mfma_f32_16x16x32_bf16 a[200:203], v[80:83], v[200:203], a[200:203]
    buffer_load_dwordx4 v13, s[8:11], s26 offen offset:3072 lds
    v_mfma_f32_16x16x32_bf16 a[204:207], v[76:79], v[168:171], a[204:207]
    s_add_u32 m0, s27, 28672
    v_mfma_f32_16x16x32_bf16 a[204:207], v[80:83], v[204:207], a[204:207]
    s_nop 0
    v_mfma_f32_16x16x32_bf16 a[208:211], v[76:79], v[172:175], a[208:211]
    buffer_load_dwordx4 v14, s[8:11], s26 offen offset:0 lds
    v_mfma_f32_16x16x32_bf16 a[208:211], v[80:83], v[208:211], a[208:211]
    buffer_load_dwordx4 v15, s[8:11], s26 offen offset:1024 lds
    v_mfma_f32_16x16x32_bf16 a[212:215], v[76:79], v[176:179], a[212:215]
    buffer_load_dwordx4 v16, s[8:11], s26 offen offset:2048 lds
    v_mfma_f32_16x16x32_bf16 a[212:215], v[80:83], v[212:215], a[212:215]
    buffer_load_dwordx4 v17, s[8:11], s26 offen offset:3072 lds
    v_mfma_f32_16x16x32_bf16 v[244:247], v[76:79], v[180:183], v[244:247]
    s_add_u32 s26, s26, 163840
    v_mfma_f32_16x16x32_bf16 v[244:247], v[80:83], v[216:219], v[244:247]
    v_mfma_f32_16x16x32_bf16 a[216:219], v[76:79], v[184:187], a[216:219]
    v_mfma_f32_16x16x32_bf16 a[216:219], v[80:83], v[220:223], a[216:219]
    v_mfma_f32_16x16x32_bf16 v[28:31], v[76:79], v[188:191], v[28:31]
    v_mfma_f32_16x16x32_bf16 v[28:31], v[80:83], v[224:227], v[28:31]
    v_mfma_f32_16x16x32_bf16 v[44:47], v[76:79], v[192:195], v[44:47]
    v_mfma_f32_16x16x32_bf16 v[44:47], v[80:83], v[228:231], v[44:47]
    v_mfma_f32_16x16x32_bf16 v[236:239], v[76:79], v[196:199], v[236:239]
    v_mfma_f32_16x16x32_bf16 v[236:239], v[80:83], v[232:235], v[236:239]
    ds_read_b64_tr_b16 v[76:77], v20 offset:0
    ds_read_b64_tr_b16 v[78:79], v20 offset:4096
    ds_read_b64_tr_b16 v[80:81], v20 offset:8192
    ds_read_b64_tr_b16 v[82:83], v20 offset:12288
    s_waitcnt lgkmcnt(12)
    v_mfma_f32_16x16x32_bf16 a[220:223], v[84:87], v[164:167], a[220:223]
    v_mfma_f32_16x16x32_bf16 a[220:223], v[88:91], v[200:203], a[220:223]
    v_mfma_f32_16x16x32_bf16 a[224:227], v[84:87], v[168:171], a[224:227]
    v_mfma_f32_16x16x32_bf16 a[224:227], v[88:91], v[204:207], a[224:227]
    v_mfma_f32_16x16x32_bf16 a[228:231], v[84:87], v[172:175], a[228:231]
    v_mfma_f32_16x16x32_bf16 a[228:231], v[88:91], v[208:211], a[228:231]
    v_mfma_f32_16x16x32_bf16 a[232:235], v[84:87], v[176:179], a[232:235]
    v_mfma_f32_16x16x32_bf16 a[232:235], v[88:91], v[212:215], a[232:235]
    v_mfma_f32_16x16x32_bf16 v[248:251], v[84:87], v[180:183], v[248:251]
    v_mfma_f32_16x16x32_bf16 v[248:251], v[88:91], v[216:219], v[248:251]
    v_mfma_f32_16x16x32_bf16 a[236:239], v[84:87], v[184:187], a[236:239]
    v_mfma_f32_16x16x32_bf16 a[236:239], v[88:91], v[220:223], a[236:239]
    v_mfma_f32_16x16x32_bf16 v[32:35], v[84:87], v[188:191], v[32:35]
    v_mfma_f32_16x16x32_bf16 v[32:35], v[88:91], v[224:227], v[32:35]
    v_mfma_f32_16x16x32_bf16 v[48:51], v[84:87], v[192:195], v[48:51]
    v_mfma_f32_16x16x32_bf16 v[48:51], v[88:91], v[228:231], v[48:51]
    v_mfma_f32_16x16x32_bf16 v[240:243], v[84:87], v[196:199], v[240:243]
    v_mfma_f32_16x16x32_bf16 v[240:243], v[88:91], v[232:235], v[240:243]
    ds_read_b64_tr_b16 v[84:85], v21 offset:0
    ds_read_b64_tr_b16 v[86:87], v21 offset:4096
    ds_read_b64_tr_b16 v[88:89], v21 offset:8192
    ds_read_b64_tr_b16 v[90:91], v21 offset:12288
    s_add_u32 s21, s21, 1
    s_cmp_lt_u32 s21, 6
    s_cbranch_scc1 L_op_loop
    s_waitcnt vmcnt(16) lgkmcnt(12)
    v_mfma_f32_16x16x32_bf16 a[0:3], v[60:63], v[92:95], a[0:3]
    buffer_load_dwordx4 v[164:167], v7, s[4:7], s48 offen
    v_mfma_f32_16x16x32_bf16 a[0:3], v[64:67], v[128:131], a[0:3]
    buffer_load_dwordx4 v[168:171], v7, s[4:7], s49 offen
    v_mfma_f32_16x16x32_bf16 a[4:7], v[60:63], v[96:99], a[4:7]
    buffer_load_dwordx4 v[172:175], v7, s[4:7], s50 offen
    v_mfma_f32_16x16x32_bf16 a[4:7], v[64:67], v[132:135], a[4:7]
    buffer_load_dwordx4 v[176:179], v7, s[4:7], s51 offen
    v_mfma_f32_16x16x32_bf16 a[8:11], v[60:63], v[100:103], a[8:11]
    buffer_load_dwordx4 v[180:183], v7, s[4:7], s52 offen
    v_mfma_f32_16x16x32_bf16 a[8:11], v[64:67], v[136:139], a[8:11]
    buffer_load_dwordx4 v[184:187], v7, s[4:7], s53 offen
    v_mfma_f32_16x16x32_bf16 a[12:15], v[60:63], v[104:107], a[12:15]
    buffer_load_dwordx4 v[188:191], v7, s[4:7], s54 offen
    v_mfma_f32_16x16x32_bf16 a[12:15], v[64:67], v[140:143], a[12:15]
    buffer_load_dwordx4 v[192:195], v7, s[4:7], s55 offen
    v_mfma_f32_16x16x32_bf16 a[16:19], v[60:63], v[108:111], a[16:19]
    buffer_load_dwordx4 v[196:199], v7, s[4:7], s56 offen
    v_mfma_f32_16x16x32_bf16 a[16:19], v[64:67], v[144:147], a[16:19]
    v_add_u32 v7, 57344, v7
    v_mfma_f32_16x16x32_bf16 a[20:23], v[60:63], v[112:115], a[20:23]
    buffer_load_dwordx4 v[200:203], v7, s[4:7], s48 offen
    v_mfma_f32_16x16x32_bf16 a[20:23], v[64:67], v[148:151], a[20:23]
    buffer_load_dwordx4 v[204:207], v7, s[4:7], s49 offen
    v_mfma_f32_16x16x32_bf16 a[24:27], v[60:63], v[116:119], a[24:27]
    buffer_load_dwordx4 v[208:211], v7, s[4:7], s50 offen
    v_mfma_f32_16x16x32_bf16 a[24:27], v[64:67], v[152:155], a[24:27]
    buffer_load_dwordx4 v[212:215], v7, s[4:7], s51 offen
    v_mfma_f32_16x16x32_bf16 a[28:31], v[60:63], v[120:123], a[28:31]
    buffer_load_dwordx4 v[216:219], v7, s[4:7], s52 offen
    v_mfma_f32_16x16x32_bf16 a[28:31], v[64:67], v[156:159], a[28:31]
    buffer_load_dwordx4 v[220:223], v7, s[4:7], s53 offen
    v_mfma_f32_16x16x32_bf16 a[32:35], v[60:63], v[124:127], a[32:35]
    buffer_load_dwordx4 v[224:227], v7, s[4:7], s54 offen
    v_mfma_f32_16x16x32_bf16 a[32:35], v[64:67], v[160:163], a[32:35]
    ds_read_b64_tr_b16 v[60:61], v22 offset:0
    ds_read_b64_tr_b16 v[62:63], v22 offset:4096
    ds_read_b64_tr_b16 v[64:65], v22 offset:8192
    ds_read_b64_tr_b16 v[66:67], v22 offset:12288
    s_waitcnt lgkmcnt(12)
    v_mfma_f32_16x16x32_bf16 a[36:39], v[68:71], v[92:95], a[36:39]
    buffer_load_dwordx4 v[228:231], v7, s[4:7], s55 offen
    v_mfma_f32_16x16x32_bf16 a[36:39], v[72:75], v[128:131], a[36:39]
    buffer_load_dwordx4 v[232:235], v7, s[4:7], s56 offen
    v_mfma_f32_16x16x32_bf16 a[40:43], v[68:71], v[96:99], a[40:43]
    v_add_u32 v7, 57344, v7
    v_mfma_f32_16x16x32_bf16 a[40:43], v[72:75], v[132:135], a[40:43]
    v_mfma_f32_16x16x32_bf16 a[44:47], v[68:71], v[100:103], a[44:47]
    v_mfma_f32_16x16x32_bf16 a[44:47], v[72:75], v[136:139], a[44:47]
    v_mfma_f32_16x16x32_bf16 a[48:51], v[68:71], v[104:107], a[48:51]
    v_mfma_f32_16x16x32_bf16 a[48:51], v[72:75], v[140:143], a[48:51]
    v_mfma_f32_16x16x32_bf16 a[52:55], v[68:71], v[108:111], a[52:55]
    v_mfma_f32_16x16x32_bf16 a[52:55], v[72:75], v[144:147], a[52:55]
    v_mfma_f32_16x16x32_bf16 a[56:59], v[68:71], v[112:115], a[56:59]
    v_mfma_f32_16x16x32_bf16 a[56:59], v[72:75], v[148:151], a[56:59]
    v_mfma_f32_16x16x32_bf16 a[60:63], v[68:71], v[116:119], a[60:63]
    v_mfma_f32_16x16x32_bf16 a[60:63], v[72:75], v[152:155], a[60:63]
    v_mfma_f32_16x16x32_bf16 a[64:67], v[68:71], v[120:123], a[64:67]
    v_mfma_f32_16x16x32_bf16 a[64:67], v[72:75], v[156:159], a[64:67]
    v_mfma_f32_16x16x32_bf16 a[68:71], v[68:71], v[124:127], a[68:71]
    v_mfma_f32_16x16x32_bf16 a[68:71], v[72:75], v[160:163], a[68:71]
    ds_read_b64_tr_b16 v[68:69], v23 offset:0
    ds_read_b64_tr_b16 v[70:71], v23 offset:4096
    ds_read_b64_tr_b16 v[72:73], v23 offset:8192
    ds_read_b64_tr_b16 v[74:75], v23 offset:12288
    s_waitcnt lgkmcnt(12)
    v_mfma_f32_16x16x32_bf16 a[72:75], v[76:79], v[92:95], a[72:75]
    v_mfma_f32_16x16x32_bf16 a[72:75], v[80:83], v[128:131], a[72:75]
    v_mfma_f32_16x16x32_bf16 a[76:79], v[76:79], v[96:99], a[76:79]
    v_mfma_f32_16x16x32_bf16 a[76:79], v[80:83], v[132:135], a[76:79]
    v_mfma_f32_16x16x32_bf16 a[80:83], v[76:79], v[100:103], a[80:83]
    v_mfma_f32_16x16x32_bf16 a[80:83], v[80:83], v[136:139], a[80:83]
    v_mfma_f32_16x16x32_bf16 a[84:87], v[76:79], v[104:107], a[84:87]
    v_mfma_f32_16x16x32_bf16 a[84:87], v[80:83], v[140:143], a[84:87]
    v_mfma_f32_16x16x32_bf16 a[88:91], v[76:79], v[108:111], a[88:91]
    v_mfma_f32_16x16x32_bf16 a[88:91], v[80:83], v[144:147], a[88:91]
    v_mfma_f32_16x16x32_bf16 a[92:95], v[76:79], v[112:115], a[92:95]
    v_mfma_f32_16x16x32_bf16 a[92:95], v[80:83], v[148:151], a[92:95]
    v_mfma_f32_16x16x32_bf16 a[96:99], v[76:79], v[116:119], a[96:99]
    v_mfma_f32_16x16x32_bf16 a[96:99], v[80:83], v[152:155], a[96:99]
    v_mfma_f32_16x16x32_bf16 a[100:103], v[76:79], v[120:123], a[100:103]
    v_mfma_f32_16x16x32_bf16 a[100:103], v[80:83], v[156:159], a[100:103]
    v_mfma_f32_16x16x32_bf16 a[104:107], v[76:79], v[124:127], a[104:107]
    v_mfma_f32_16x16x32_bf16 a[104:107], v[80:83], v[160:163], a[104:107]
    ds_read_b64_tr_b16 v[76:77], v24 offset:0
    ds_read_b64_tr_b16 v[78:79], v24 offset:4096
    ds_read_b64_tr_b16 v[80:81], v24 offset:8192
    ds_read_b64_tr_b16 v[82:83], v24 offset:12288
    s_waitcnt lgkmcnt(12)
    v_mfma_f32_16x16x32_bf16 a[108:111], v[84:87], v[92:95], a[108:111]
    v_mfma_f32_16x16x32_bf16 a[108:111], v[88:91], v[128:131], a[108:111]
    v_mfma_f32_16x16x32_bf16 a[112:115], v[84:87], v[96:99], a[112:115]
    v_mfma_f32_16x16x32_bf16 a[112:115], v[88:91], v[132:135], a[112:115]
    v_mfma_f32_16x16x32_bf16 a[116:119], v[84:87], v[100:103], a[116:119]
    v_mfma_f32_16x16x32_bf16 a[116:119], v[88:91], v[136:139], a[116:119]
    v_mfma_f32_16x16x32_bf16 a[120:123], v[84:87], v[104:107], a[120:123]
    v_mfma_f32_16x16x32_bf16 a[120:123], v[88:91], v[140:143], a[120:123]
    v_mfma_f32_16x16x32_bf16 a[124:127], v[84:87], v[108:111], a[124:127]
    v_mfma_f32_16x16x32_bf16 a[124:127], v[88:91], v[144:147], a[124:127]
    v_mfma_f32_16x16x32_bf16 a[128:131], v[84:87], v[112:115], a[128:131]
    v_mfma_f32_16x16x32_bf16 a[128:131], v[88:91], v[148:151], a[128:131]
    v_mfma_f32_16x16x32_bf16 a[132:135], v[84:87], v[116:119], a[132:135]
    v_mfma_f32_16x16x32_bf16 a[132:135], v[88:91], v[152:155], a[132:135]
    v_mfma_f32_16x16x32_bf16 a[136:139], v[84:87], v[120:123], a[136:139]
    v_mfma_f32_16x16x32_bf16 a[136:139], v[88:91], v[156:159], a[136:139]
    v_mfma_f32_16x16x32_bf16 a[140:143], v[84:87], v[124:127], a[140:143]
    v_mfma_f32_16x16x32_bf16 a[140:143], v[88:91], v[160:163], a[140:143]
    ds_read_b64_tr_b16 v[84:85], v25 offset:0
    ds_read_b64_tr_b16 v[86:87], v25 offset:4096
    ds_read_b64_tr_b16 v[88:89], v25 offset:8192
    ds_read_b64_tr_b16 v[90:91], v25 offset:12288
    s_waitcnt lgkmcnt(12)
    v_mfma_f32_16x16x32_bf16 a[144:147], v[60:63], v[92:95], a[144:147]
    v_mfma_f32_16x16x32_bf16 a[144:147], v[64:67], v[128:131], a[144:147]
    v_mfma_f32_16x16x32_bf16 a[148:151], v[60:63], v[96:99], a[148:151]
    v_mfma_f32_16x16x32_bf16 a[148:151], v[64:67], v[132:135], a[148:151]
    v_mfma_f32_16x16x32_bf16 a[152:155], v[60:63], v[100:103], a[152:155]
    v_mfma_f32_16x16x32_bf16 a[152:155], v[64:67], v[136:139], a[152:155]
    v_mfma_f32_16x16x32_bf16 a[156:159], v[60:63], v[104:107], a[156:159]
    v_mfma_f32_16x16x32_bf16 a[156:159], v[64:67], v[140:143], a[156:159]
    v_mfma_f32_16x16x32_bf16 a[160:163], v[60:63], v[108:111], a[160:163]
    v_mfma_f32_16x16x32_bf16 a[160:163], v[64:67], v[144:147], a[160:163]
    v_mfma_f32_16x16x32_bf16 a[164:167], v[60:63], v[112:115], a[164:167]
    v_mfma_f32_16x16x32_bf16 a[164:167], v[64:67], v[148:151], a[164:167]
    v_mfma_f32_16x16x32_bf16 a[168:171], v[60:63], v[116:119], a[168:171]
    v_mfma_f32_16x16x32_bf16 a[168:171], v[64:67], v[152:155], a[168:171]
    v_mfma_f32_16x16x32_bf16 v[36:39], v[60:63], v[120:123], v[36:39]
    v_mfma_f32_16x16x32_bf16 v[36:39], v[64:67], v[156:159], v[36:39]
    v_mfma_f32_16x16x32_bf16 v[52:55], v[60:63], v[124:127], v[52:55]
    v_mfma_f32_16x16x32_bf16 v[52:55], v[64:67], v[160:163], v[52:55]
    s_waitcnt vmcnt(18)
    ds_read_b64_tr_b16 v[60:61], v18 offset:16384
    ds_read_b64_tr_b16 v[62:63], v18 offset:20480
    ds_read_b64_tr_b16 v[64:65], v18 offset:24576
    ds_read_b64_tr_b16 v[66:67], v18 offset:28672
    s_waitcnt lgkmcnt(12)
    v_mfma_f32_16x16x32_bf16 a[172:175], v[68:71], v[92:95], a[172:175]
    v_mfma_f32_16x16x32_bf16 a[172:175], v[72:75], v[128:131], a[172:175]
    v_mfma_f32_16x16x32_bf16 a[176:179], v[68:71], v[96:99], a[176:179]
    v_mfma_f32_16x16x32_bf16 a[176:179], v[72:75], v[132:135], a[176:179]
    v_mfma_f32_16x16x32_bf16 a[180:183], v[68:71], v[100:103], a[180:183]
    v_mfma_f32_16x16x32_bf16 a[180:183], v[72:75], v[136:139], a[180:183]
    v_mfma_f32_16x16x32_bf16 a[184:187], v[68:71], v[104:107], a[184:187]
    v_mfma_f32_16x16x32_bf16 a[184:187], v[72:75], v[140:143], a[184:187]
    v_mfma_f32_16x16x32_bf16 a[188:191], v[68:71], v[108:111], a[188:191]
    v_mfma_f32_16x16x32_bf16 a[188:191], v[72:75], v[144:147], a[188:191]
    v_mfma_f32_16x16x32_bf16 a[192:195], v[68:71], v[112:115], a[192:195]
    v_mfma_f32_16x16x32_bf16 a[192:195], v[72:75], v[148:151], a[192:195]
    v_mfma_f32_16x16x32_bf16 a[196:199], v[68:71], v[116:119], a[196:199]
    v_mfma_f32_16x16x32_bf16 a[196:199], v[72:75], v[152:155], a[196:199]
    v_mfma_f32_16x16x32_bf16 v[40:43], v[68:71], v[120:123], v[40:43]
    v_mfma_f32_16x16x32_bf16 v[40:43], v[72:75], v[156:159], v[40:43]
    v_mfma_f32_16x16x32_bf16 v[56:59], v[68:71], v[124:127], v[56:59]
    v_mfma_f32_16x16x32_bf16 v[56:59], v[72:75], v[160:163], v[56:59]
    ds_read_b64_tr_b16 v[68:69], v19 offset:16384
    ds_read_b64_tr_b16 v[70:71], v19 offset:20480
    ds_read_b64_tr_b16 v[72:73], v19 offset:24576
    ds_read_b64_tr_b16 v[74:75], v19 offset:28672
    s_waitcnt lgkmcnt(12)
    v_mfma_f32_16x16x32_bf16 a[200:203], v[76:79], v[92:95], a[200:203]
    v_mfma_f32_16x16x32_bf16 a[200:203], v[80:83], v[128:131], a[200:203]
    v_mfma_f32_16x16x32_bf16 a[204:207], v[76:79], v[96:99], a[204:207]
    v_mfma_f32_16x16x32_bf16 a[204:207], v[80:83], v[132:135], a[204:207]
    v_mfma_f32_16x16x32_bf16 a[208:211], v[76:79], v[100:103], a[208:211]
    v_mfma_f32_16x16x32_bf16 a[208:211], v[80:83], v[136:139], a[208:211]
    v_mfma_f32_16x16x32_bf16 a[212:215], v[76:79], v[104:107], a[212:215]
    v_mfma_f32_16x16x32_bf16 a[212:215], v[80:83], v[140:143], a[212:215]
    v_mfma_f32_16x16x32_bf16 v[244:247], v[76:79], v[108:111], v[244:247]
    v_mfma_f32_16x16x32_bf16 v[244:247], v[80:83], v[144:147], v[244:247]
    v_mfma_f32_16x16x32_bf16 a[216:219], v[76:79], v[112:115], a[216:219]
    v_mfma_f32_16x16x32_bf16 a[216:219], v[80:83], v[148:151], a[216:219]
    v_mfma_f32_16x16x32_bf16 v[28:31], v[76:79], v[116:119], v[28:31]
    v_mfma_f32_16x16x32_bf16 v[28:31], v[80:83], v[152:155], v[28:31]
    v_mfma_f32_16x16x32_bf16 v[44:47], v[76:79], v[120:123], v[44:47]
    v_mfma_f32_16x16x32_bf16 v[44:47], v[80:83], v[156:159], v[44:47]
    v_mfma_f32_16x16x32_bf16 v[236:239], v[76:79], v[124:127], v[236:239]
    v_mfma_f32_16x16x32_bf16 v[236:239], v[80:83], v[160:163], v[236:239]
    ds_read_b64_tr_b16 v[76:77], v20 offset:16384
    ds_read_b64_tr_b16 v[78:79], v20 offset:20480
    ds_read_b64_tr_b16 v[80:81], v20 offset:24576
    ds_read_b64_tr_b16 v[82:83], v20 offset:28672
    s_waitcnt lgkmcnt(12)
    v_mfma_f32_16x16x32_bf16 a[220:223], v[84:87], v[92:95], a[220:223]
    v_mfma_f32_16x16x32_bf16 a[220:223], v[88:91], v[128:131], a[220:223]
    v_mfma_f32_16x16x32_bf16 a[224:227], v[84:87], v[96:99], a[224:227]
    v_mfma_f32_16x16x32_bf16 a[224:227], v[88:91], v[132:135], a[224:227]
    v_mfma_f32_16x16x32_bf16 a[228:231], v[84:87], v[100:103], a[228:231]
    v_mfma_f32_16x16x32_bf16 a[228:231], v[88:91], v[136:139], a[228:231]
    v_mfma_f32_16x16x32_bf16 a[232:235], v[84:87], v[104:107], a[232:235]
    v_mfma_f32_16x16x32_bf16 a[232:235], v[88:91], v[140:143], a[232:235]
    v_mfma_f32_16x16x32_bf16 v[248:251], v[84:87], v[108:111], v[248:251]
    v_mfma_f32_16x16x32_bf16 v[248:251], v[88:91], v[144:147], v[248:251]
    v_mfma_f32_16x16x32_bf16 a[236:239], v[84:87], v[112:115], a[236:239]
    v_mfma_f32_16x16x32_bf16 a[236:239], v[88:91], v[148:151], a[236:239]
    v_mfma_f32_16x16x32_bf16 v[32:35], v[84:87], v[116:119], v[32:35]
    v_mfma_f32_16x16x32_bf16 v[32:35], v[88:91], v[152:155], v[32:35]
    v_mfma_f32_16x16x32_bf16 v[48:51], v[84:87], v[120:123], v[48:51]
    v_mfma_f32_16x16x32_bf16 v[48:51], v[88:91], v[156:159], v[48:51]
    v_mfma_f32_16x16x32_bf16 v[240:243], v[84:87], v[124:127], v[240:243]
    v_mfma_f32_16x16x32_bf16 v[240:243], v[88:91], v[160:163], v[240:243]
    ds_read_b64_tr_b16 v[84:85], v21 offset:16384
    ds_read_b64_tr_b16 v[86:87], v21 offset:20480
    ds_read_b64_tr_b16 v[88:89], v21 offset:24576
    ds_read_b64_tr_b16 v[90:91], v21 offset:28672
    s_waitcnt vmcnt(0) lgkmcnt(12)
    v_mfma_f32_16x16x32_bf16 a[0:3], v[60:63], v[164:167], a[0:3]
    ds_read_b64_tr_b16 v[92:93], v22 offset:16384
    ds_read_b64_tr_b16 v[94:95], v22 offset:20480
    v_mfma_f32_16x16x32_bf16 a[0:3], v[64:67], v[200:203], a[0:3]
    ds_read_b64_tr_b16 v[96:97], v22 offset:24576
    ds_read_b64_tr_b16 v[98:99], v22 offset:28672
    v_mfma_f32_16x16x32_bf16 a[4:7], v[60:63], v[168:171], a[4:7]
    ds_read_b64_tr_b16 v[100:101], v23 offset:16384
    ds_read_b64_tr_b16 v[102:103], v23 offset:20480
    v_mfma_f32_16x16x32_bf16 a[4:7], v[64:67], v[204:207], a[4:7]
    ds_read_b64_tr_b16 v[104:105], v23 offset:24576
    ds_read_b64_tr_b16 v[106:107], v23 offset:28672
    v_mfma_f32_16x16x32_bf16 a[8:11], v[60:63], v[172:175], a[8:11]
    ds_read_b64_tr_b16 v[108:109], v24 offset:16384
    ds_read_b64_tr_b16 v[110:111], v24 offset:20480
    v_mfma_f32_16x16x32_bf16 a[8:11], v[64:67], v[208:211], a[8:11]
    ds_read_b64_tr_b16 v[112:113], v24 offset:24576
    ds_read_b64_tr_b16 v[114:115], v24 offset:28672
    v_mfma_f32_16x16x32_bf16 a[20:23], v[60:63], v[184:187], a[20:23]
    ds_read_b64_tr_b16 v[116:117], v25 offset:16384
    ds_read_b64_tr_b16 v[118:119], v25 offset:20480
    v_mfma_f32_16x16x32_bf16 a[20:23], v[64:67], v[220:223], a[20:23]
    ds_read_b64_tr_b16 v[120:121], v25 offset:24576
    ds_read_b64_tr_b16 v[122:123], v25 offset:28672
    v_mfma_f32_16x16x32_bf16 a[24:27], v[60:63], v[188:191], a[24:27]
    ds_write_b128 v8, a[0:3] offset:2048
    v_mfma_f32_16x16x32_bf16 a[24:27], v[64:67], v[224:227], a[24:27]
    v_mfma_f32_16x16x32_bf16 a[28:31], v[60:63], v[192:195], a[28:31]
    v_mfma_f32_16x16x32_bf16 a[28:31], v[64:67], v[228:231], a[28:31]
    ds_write_b128 v8, a[4:7] offset:6144
    v_mfma_f32_16x16x32_bf16 a[32:35], v[60:63], v[196:199], a[32:35]
    v_mfma_f32_16x16x32_bf16 a[32:35], v[64:67], v[232:235], a[32:35]
    s_waitcnt lgkmcnt(15)
    v_mfma_f32_16x16x32_bf16 a[36:39], v[68:71], v[164:167], a[36:39]
    ds_write_b128 v8, a[8:11] offset:10240
    v_mfma_f32_16x16x32_bf16 a[36:39], v[72:75], v[200:203], a[36:39]
    v_mfma_f32_16x16x32_bf16 a[40:43], v[68:71], v[168:171], a[40:43]
    v_mfma_f32_16x16x32_bf16 a[40:43], v[72:75], v[204:207], a[40:43]
    ds_write_b128 v8, a[20:23] offset:14336
    v_mfma_f32_16x16x32_bf16 a[44:47], v[68:71], v[172:175], a[44:47]
    v_mfma_f32_16x16x32_bf16 a[44:47], v[72:75], v[208:211], a[44:47]
    v_mfma_f32_16x16x32_bf16 a[56:59], v[68:71], v[184:187], a[56:59]
    ds_write_b128 v8, a[24:27] offset:18432
    v_mfma_f32_16x16x32_bf16 a[56:59], v[72:75], v[220:223], a[56:59]
    v_mfma_f32_16x16x32_bf16 a[60:63], v[68:71], v[188:191], a[60:63]
    v_mfma_f32_16x16x32_bf16 a[60:63], v[72:75], v[224:227], a[60:63]
    ds_write_b128 v8, a[28:31] offset:22528
    v_mfma_f32_16x16x32_bf16 a[64:67], v[68:71], v[192:195], a[64:67]
    v_mfma_f32_16x16x32_bf16 a[64:67], v[72:75], v[228:231], a[64:67]
    v_mfma_f32_16x16x32_bf16 a[72:75], v[76:79], v[164:167], a[72:75]
    ds_write_b128 v8, a[32:35] offset:26624
    v_mfma_f32_16x16x32_bf16 a[72:75], v[80:83], v[200:203], a[72:75]
    v_mfma_f32_16x16x32_bf16 a[76:79], v[76:79], v[168:171], a[76:79]
    v_mfma_f32_16x16x32_bf16 a[76:79], v[80:83], v[204:207], a[76:79]
    ds_write_b128 v8, a[36:39] offset:3072
    v_mfma_f32_16x16x32_bf16 a[80:83], v[76:79], v[172:175], a[80:83]
    v_mfma_f32_16x16x32_bf16 a[80:83], v[80:83], v[208:211], a[80:83]
    v_mfma_f32_16x16x32_bf16 a[84:87], v[76:79], v[176:179], a[84:87]
    ds_write_b128 v8, a[40:43] offset:7168
    v_mfma_f32_16x16x32_bf16 a[84:87], v[80:83], v[212:215], a[84:87]
    v_mfma_f32_16x16x32_bf16 a[92:95], v[76:79], v[184:187], a[92:95]
    v_mfma_f32_16x16x32_bf16 a[92:95], v[80:83], v[220:223], a[92:95]
    ds_write_b128 v8, a[44:47] offset:11264
    v_mfma_f32_16x16x32_bf16 a[96:99], v[76:79], v[188:191], a[96:99]
    v_mfma_f32_16x16x32_bf16 a[96:99], v[80:83], v[224:227], a[96:99]
    v_mfma_f32_16x16x32_bf16 a[100:103], v[76:79], v[192:195], a[100:103]
    ds_write_b128 v8, a[56:59] offset:15360
    v_mfma_f32_16x16x32_bf16 a[100:103], v[80:83], v[228:231], a[100:103]
    v_mfma_f32_16x16x32_bf16 a[108:111], v[84:87], v[164:167], a[108:111]
    v_mfma_f32_16x16x32_bf16 a[108:111], v[88:91], v[200:203], a[108:111]
    ds_write_b128 v8, a[60:63] offset:19456
    v_mfma_f32_16x16x32_bf16 a[112:115], v[84:87], v[168:171], a[112:115]
    v_mfma_f32_16x16x32_bf16 a[112:115], v[88:91], v[204:207], a[112:115]
    v_mfma_f32_16x16x32_bf16 a[116:119], v[84:87], v[172:175], a[116:119]
    ds_write_b128 v8, a[64:67] offset:23552
    v_mfma_f32_16x16x32_bf16 a[116:119], v[88:91], v[208:211], a[116:119]
    v_mfma_f32_16x16x32_bf16 a[120:123], v[84:87], v[176:179], a[120:123]
    v_mfma_f32_16x16x32_bf16 a[120:123], v[88:91], v[212:215], a[120:123]
    ds_write_b128 v8, a[72:75] offset:0
    v_mfma_f32_16x16x32_bf16 a[128:131], v[84:87], v[184:187], a[128:131]
    v_mfma_f32_16x16x32_bf16 a[128:131], v[88:91], v[220:223], a[128:131]
    v_mfma_f32_16x16x32_bf16 a[132:135], v[84:87], v[188:191], a[132:135]
    ds_write_b128 v8, a[76:79] offset:4096
    v_mfma_f32_16x16x32_bf16 a[132:135], v[88:91], v[224:227], a[132:135]
    v_mfma_f32_16x16x32_bf16 a[136:139], v[84:87], v[192:195], a[136:139]
    v_mfma_f32_16x16x32_bf16 a[136:139], v[88:91], v[228:231], a[136:139]
    ds_write_b128 v8, a[80:83] offset:8192
    s_waitcnt lgkmcnt(15)
    v_mfma_f32_16x16x32_bf16 a[200:203], v[108:111], v[164:167], a[200:203]
    v_mfma_f32_16x16x32_bf16 a[200:203], v[112:115], v[200:203], a[200:203]
    v_mfma_f32_16x16x32_bf16 a[220:223], v[116:119], v[164:167], a[220:223]
    ds_write_b128 v8, a[84:87] offset:12288
    v_mfma_f32_16x16x32_bf16 a[220:223], v[120:123], v[200:203], a[220:223]
    v_mfma_f32_16x16x32_bf16 a[144:147], v[92:95], v[164:167], a[144:147]
    v_mfma_f32_16x16x32_bf16 a[144:147], v[96:99], v[200:203], a[144:147]
    ds_write_b128 v8, a[92:95] offset:16384
    v_mfma_f32_16x16x32_bf16 a[172:175], v[100:103], v[164:167], a[172:175]
    v_mfma_f32_16x16x32_bf16 a[172:175], v[104:107], v[200:203], a[172:175]
    v_mfma_f32_16x16x32_bf16 a[204:207], v[108:111], v[168:171], a[204:207]
    ds_write_b128 v8, a[96:99] offset:20480
    v_mfma_f32_16x16x32_bf16 a[204:207], v[112:115], v[204:207], a[204:207]
    v_mfma_f32_16x16x32_bf16 a[224:227], v[116:119], v[168:171], a[224:227]
    v_mfma_f32_16x16x32_bf16 a[224:227], v[120:123], v[204:207], a[224:227]
    ds_write_b128 v8, a[100:103] offset:24576
    v_mfma_f32_16x16x32_bf16 a[148:151], v[92:95], v[168:171], a[148:151]
    v_mfma_f32_16x16x32_bf16 a[148:151], v[96:99], v[204:207], a[148:151]
    v_mfma_f32_16x16x32_bf16 a[176:179], v[100:103], v[168:171], a[176:179]
    ds_write_b128 v8, a[108:111] offset:1024
    v_mfma_f32_16x16x32_bf16 a[176:179], v[104:107], v[204:207], a[176:179]
    v_mfma_f32_16x16x32_bf16 a[208:211], v[108:111], v[172:175], a[208:211]
    v_mfma_f32_16x16x32_bf16 a[208:211], v[112:115], v[208:211], a[208:211]
    ds_write_b128 v8, a[112:115] offset:5120
    v_mfma_f32_16x16x32_bf16 a[228:231], v[116:119], v[172:175], a[228:231]
    v_mfma_f32_16x16x32_bf16 a[228:231], v[120:123], v[208:211], a[228:231]
    v_mfma_f32_16x16x32_bf16 a[152:155], v[92:95], v[172:175], a[152:155]
    ds_write_b128 v8, a[116:119] offset:9216
    v_mfma_f32_16x16x32_bf16 a[152:155], v[96:99], v[208:211], a[152:155]
    v_mfma_f32_16x16x32_bf16 a[180:183], v[100:103], v[172:175], a[180:183]
    v_mfma_f32_16x16x32_bf16 a[180:183], v[104:107], v[208:211], a[180:183]
    ds_write_b128 v8, a[120:123] offset:13312
    v_mfma_f32_16x16x32_bf16 a[212:215], v[108:111], v[176:179], a[212:215]
    v_mfma_f32_16x16x32_bf16 a[212:215], v[112:115], v[212:215], a[212:215]
    v_mfma_f32_16x16x32_bf16 a[12:15], v[60:63], v[176:179], a[12:15]
    ds_write_b128 v8, a[128:131] offset:17408
    v_mfma_f32_16x16x32_bf16 a[12:15], v[64:67], v[212:215], a[12:15]
    v_mfma_f32_16x16x32_bf16 a[48:51], v[68:71], v[176:179], a[48:51]
    v_mfma_f32_16x16x32_bf16 a[48:51], v[72:75], v[212:215], a[48:51]
    ds_write_b128 v8, a[132:135] offset:21504
    v_mfma_f32_16x16x32_bf16 a[16:19], v[60:63], v[180:183], a[16:19]
    v_mfma_f32_16x16x32_bf16 a[16:19], v[64:67], v[216:219], a[16:19]
    v_mfma_f32_16x16x32_bf16 a[52:55], v[68:71], v[180:183], a[52:55]
    ds_write_b128 v8, a[136:139] offset:25600
    v_mfma_f32_16x16x32_bf16 a[52:55], v[72:75], v[216:219], a[52:55]
    v_mfma_f32_16x16x32_bf16 a[68:71], v[68:71], v[196:199], a[68:71]
    v_mfma_f32_16x16x32_bf16 a[68:71], v[72:75], v[232:235], a[68:71]
    ds_write_b128 v8, a[200:203] offset:27648
    v_mfma_f32_16x16x32_bf16 a[104:107], v[76:79], v[196:199], a[104:107]
    v_mfma_f32_16x16x32_bf16 a[104:107], v[80:83], v[232:235], a[104:107]
    v_mfma_f32_16x16x32_bf16 a[140:143], v[84:87], v[196:199], a[140:143]
    ds_write_b128 v8, a[220:223] offset:28672
    v_mfma_f32_16x16x32_bf16 a[140:143], v[88:91], v[232:235], a[140:143]
    v_mfma_f32_16x16x32_bf16 a[88:91], v[76:79], v[180:183], a[88:91]
    v_mfma_f32_16x16x32_bf16 a[88:91], v[80:83], v[216:219], a[88:91]
    ds_write_b128 v8, a[144:147] offset:29696
    v_mfma_f32_16x16x32_bf16 a[124:127], v[84:87], v[180:183], a[124:127]
    v_mfma_f32_16x16x32_bf16 a[124:127], v[88:91], v[216:219], a[124:127]
    v_mfma_f32_16x16x32_bf16 a[232:235], v[116:119], v[176:179], a[232:235]
    ds_write_b128 v8, a[172:175] offset:30720
    v_mfma_f32_16x16x32_bf16 a[232:235], v[120:123], v[212:215], a[232:235]
    v_mfma_f32_16x16x32_bf16 a[156:159], v[92:95], v[176:179], a[156:159]
    v_mfma_f32_16x16x32_bf16 a[156:159], v[96:99], v[212:215], a[156:159]
    ds_write_b128 v8, a[204:207] offset:31744
    v_mfma_f32_16x16x32_bf16 a[184:187], v[100:103], v[176:179], a[184:187]
    v_mfma_f32_16x16x32_bf16 a[184:187], v[104:107], v[212:215], a[184:187]
    v_mfma_f32_16x16x32_bf16 a[160:163], v[92:95], v[180:183], a[160:163]
    ds_write_b128 v8, a[224:227] offset:32768
    v_mfma_f32_16x16x32_bf16 a[160:163], v[96:99], v[216:219], a[160:163]
    v_mfma_f32_16x16x32_bf16 a[188:191], v[100:103], v[180:183], a[188:191]
    v_mfma_f32_16x16x32_bf16 a[188:191], v[104:107], v[216:219], a[188:191]
    ds_write_b128 v8, a[148:151] offset:33792
    v_mfma_f32_16x16x32_bf16 a[164:167], v[92:95], v[184:187], a[164:167]
    v_mfma_f32_16x16x32_bf16 a[164:167], v[96:99], v[220:223], a[164:167]
    v_mfma_f32_16x16x32_bf16 a[192:195], v[100:103], v[184:187], a[192:195]
    ds_write_b128 v8, a[176:179] offset:34816
    v_mfma_f32_16x16x32_bf16 a[192:195], v[104:107], v[220:223], a[192:195]
    v_mfma_f32_16x16x32_bf16 a[216:219], v[108:111], v[184:187], a[216:219]
    v_mfma_f32_16x16x32_bf16 a[216:219], v[112:115], v[220:223], a[216:219]
    ds_write_b128 v8, a[208:211] offset:35840
    v_mfma_f32_16x16x32_bf16 a[236:239], v[116:119], v[184:187], a[236:239]
    v_mfma_f32_16x16x32_bf16 a[236:239], v[120:123], v[220:223], a[236:239]
    v_mfma_f32_16x16x32_bf16 a[168:171], v[92:95], v[188:191], a[168:171]
    ds_write_b128 v8, a[228:231] offset:36864
    v_mfma_f32_16x16x32_bf16 a[168:171], v[96:99], v[224:227], a[168:171]
    v_mfma_f32_16x16x32_bf16 a[196:199], v[100:103], v[188:191], a[196:199]
    v_mfma_f32_16x16x32_bf16 a[196:199], v[104:107], v[224:227], a[196:199]
    ds_write_b128 v8, a[152:155] offset:37888
    v_mfma_f32_16x16x32_bf16 v[28:31], v[108:111], v[188:191], v[28:31]
    v_mfma_f32_16x16x32_bf16 v[28:31], v[112:115], v[224:227], v[28:31]
    v_mfma_f32_16x16x32_bf16 v[32:35], v[116:119], v[188:191], v[32:35]
    ds_write_b128 v8, a[180:183] offset:38912
    v_mfma_f32_16x16x32_bf16 v[32:35], v[120:123], v[224:227], v[32:35]
    v_mfma_f32_16x16x32_bf16 v[36:39], v[92:95], v[192:195], v[36:39]
    v_mfma_f32_16x16x32_bf16 v[36:39], v[96:99], v[228:231], v[36:39]
    ds_write_b128 v8, a[212:215] offset:39936
    v_mfma_f32_16x16x32_bf16 v[40:43], v[100:103], v[192:195], v[40:43]
    v_mfma_f32_16x16x32_bf16 v[40:43], v[104:107], v[228:231], v[40:43]
    v_mfma_f32_16x16x32_bf16 v[44:47], v[108:111], v[192:195], v[44:47]
    v_mfma_f32_16x16x32_bf16 v[44:47], v[112:115], v[228:231], v[44:47]
    v_mfma_f32_16x16x32_bf16 v[48:51], v[116:119], v[192:195], v[48:51]
    v_mfma_f32_16x16x32_bf16 v[48:51], v[120:123], v[228:231], v[48:51]
    v_mfma_f32_16x16x32_bf16 v[52:55], v[92:95], v[196:199], v[52:55]
    v_mfma_f32_16x16x32_bf16 v[52:55], v[96:99], v[232:235], v[52:55]
    v_mfma_f32_16x16x32_bf16 v[56:59], v[100:103], v[196:199], v[56:59]
    v_mfma_f32_16x16x32_bf16 v[56:59], v[104:107], v[232:235], v[56:59]
    v_mfma_f32_16x16x32_bf16 v[236:239], v[108:111], v[196:199], v[236:239]
    v_mfma_f32_16x16x32_bf16 v[236:239], v[112:115], v[232:235], v[236:239]
    v_mfma_f32_16x16x32_bf16 v[240:243], v[116:119], v[196:199], v[240:243]
    v_mfma_f32_16x16x32_bf16 v[240:243], v[120:123], v[232:235], v[240:243]
    v_mfma_f32_16x16x32_bf16 v[244:247], v[108:111], v[180:183], v[244:247]
    v_mfma_f32_16x16x32_bf16 v[244:247], v[112:115], v[216:219], v[244:247]
    v_mfma_f32_16x16x32_bf16 v[248:251], v[116:119], v[180:183], v[248:251]
    v_mfma_f32_16x16x32_bf16 v[248:251], v[120:123], v[216:219], v[248:251]
    s_and_b32 s62, s20, 1
    s_lshl_b32 s62, s62, 7
    s_add_u32 s23, s24, s62
    s_lshr_b32 s62, s20, 1
    s_lshl_b32 s59, s62, 6
    s_add_u32 s59, s59, s23
    s_add_u32 s59, s59, 163840
    s_mul_i32 s62, s62, 5
    s_mul_i32 s22, s62, 40960
    s_add_u32 s23, s23, s22
    s_add_u32 s62, s62, s31
    s_add_u32 s62, s62, 3
    s_cmp_ge_u32 s62, 224
    s_cselect_b32 s22, 0x40000000, 0
    s_add_u32 s22, s22, 122880
    s_add_u32 s22, s22, s23
    s_waitcnt lgkmcnt(0)
    s_barrier
    ds_read_b128 v[60:63], v2 offset:0
    ds_read_b128 v[64:67], v2 offset:1024
    ds_read_b128 v[68:71], v2 offset:2048
    ds_read_b128 v[72:75], v2 offset:3072
    ds_read_b128 v[76:79], v3 offset:14336
    ds_read_b128 v[80:83], v3 offset:15360
    ds_read_b128 v[84:87], v3 offset:16384
    ds_read_b128 v[88:91], v3 offset:17408
    ds_read_b128 v[92:95], v4 offset:27648
    ds_read_b128 v[96:99], v4 offset:28672
    ds_read_b128 v[100:103], v4 offset:29696
    ds_read_b128 v[104:107], v4 offset:30720
    v_accvgpr_read_b32 v220, a164
    v_accvgpr_read_b32 v221, a165
    v_accvgpr_read_b32 v222, a166
    v_accvgpr_read_b32 v223, a167
    v_accvgpr_read_b32 v224, a192
    v_accvgpr_read_b32 v225, a193
    v_accvgpr_read_b32 v226, a194
    v_accvgpr_read_b32 v227, a195
    v_accvgpr_read_b32 v228, a216
    v_accvgpr_read_b32 v229, a217
    v_accvgpr_read_b32 v230, a218
    v_accvgpr_read_b32 v231, a219
    v_accvgpr_read_b32 v232, a236
    v_accvgpr_read_b32 v233, a237
    v_accvgpr_read_b32 v234, a238
    v_accvgpr_read_b32 v235, a239
    v_accvgpr_read_b32 v10, a168
    v_accvgpr_read_b32 v11, a169
    v_accvgpr_read_b32 v12, a170
    v_accvgpr_read_b32 v13, a171
    v_accvgpr_read_b32 v14, a196
    v_accvgpr_read_b32 v15, a197
    v_accvgpr_read_b32 v16, a198
    v_accvgpr_read_b32 v17, a199
    ds_read_b128 v[108:111], v2 offset:4096
    ds_read_b128 v[112:115], v2 offset:5120
    ds_read_b128 v[116:119], v2 offset:6144
    ds_read_b128 v[120:123], v2 offset:7168
    ds_read_b128 v[124:127], v3 offset:18432
    ds_read_b128 v[128:131], v3 offset:19456
    ds_read_b128 v[132:135], v3 offset:20480
    ds_read_b128 v[136:139], v3 offset:21504
    ds_read_b128 v[140:143], v4 offset:31744
    ds_read_b128 v[144:147], v4 offset:32768
    ds_read_b128 v[148:151], v4 offset:33792
    ds_read_b128 v[152:155], v4 offset:34816
    s_waitcnt lgkmcnt(12)
    v_pk_add_f32 v[76:77], v[76:77], v[92:93]
    v_pk_add_f32 v[78:79], v[78:79], v[94:95]
    ds_read_b128 v[156:159], v2 offset:8192
    v_pk_add_f32 v[80:81], v[80:81], v[96:97]
    v_pk_add_f32 v[82:83], v[82:83], v[98:99]
    ds_read_b128 v[160:163], v2 offset:9216
    v_pk_add_f32 v[84:85], v[84:85], v[100:101]
    v_pk_add_f32 v[86:87], v[86:87], v[102:103]
    ds_read_b128 v[164:167], v2 offset:10240
    v_pk_add_f32 v[88:89], v[88:89], v[104:105]
    v_pk_add_f32 v[90:91], v[90:91], v[106:107]
    ds_read_b128 v[168:171], v2 offset:11264
    v_pk_add_f32 v[220:221], v[220:221], v[60:61]
    v_pk_add_f32 v[222:223], v[222:223], v[62:63]
    ds_read_b128 v[172:175], v3 offset:22528
    v_pk_add_f32 v[224:225], v[224:225], v[64:65]
    v_pk_add_f32 v[226:227], v[226:227], v[66:67]
    ds_read_b128 v[176:179], v3 offset:23552
    v_pk_add_f32 v[228:229], v[228:229], v[68:69]
    v_pk_add_f32 v[230:231], v[230:231], v[70:71]
    ds_read_b128 v[180:183], v3 offset:24576
    v_pk_add_f32 v[232:233], v[232:233], v[72:73]
    v_pk_add_f32 v[234:235], v[234:235], v[74:75]
    ds_read_b128 v[184:187], v3 offset:25600
    v_pk_add_f32 v[220:221], v[220:221], v[76:77]
    v_pk_add_f32 v[222:223], v[222:223], v[78:79]
    ds_read_b128 v[188:191], v4 offset:35840
    v_pk_add_f32 v[224:225], v[224:225], v[80:81]
    v_pk_add_f32 v[226:227], v[226:227], v[82:83]
    ds_read_b128 v[192:195], v4 offset:36864
    v_pk_add_f32 v[228:229], v[228:229], v[84:85]
    v_pk_add_f32 v[230:231], v[230:231], v[86:87]
    ds_read_b128 v[196:199], v4 offset:37888
    v_pk_add_f32 v[232:233], v[232:233], v[88:89]
    v_pk_add_f32 v[234:235], v[234:235], v[90:91]
    ds_read_b128 v[200:203], v4 offset:38912
    v_cvt_pk_bf16_f32 v60, v220, v221
    v_cvt_pk_bf16_f32 v61, v222, v223
    v_cvt_pk_bf16_f32 v62, v224, v225
    ds_read_b128 v[204:207], v2 offset:12288
    v_cvt_pk_bf16_f32 v63, v226, v227
    v_cvt_pk_bf16_f32 v64, v228, v229
    v_cvt_pk_bf16_f32 v65, v230, v231
    ds_read_b128 v[208:211], v3 offset:26624
    v_cvt_pk_bf16_f32 v66, v232, v233
    v_cvt_pk_bf16_f32 v67, v234, v235
    s_add_u32 s62, s23, 0
    ds_read_b128 v[212:215], v4 offset:39936
    v_permlane16_swap_b32 v60, v62
    v_permlane16_swap_b32 v61, v63
    v_permlane16_swap_b32 v64, v66
    ds_read_b128 v[216:219], v2 offset:13312
    v_permlane16_swap_b32 v65, v67
    s_mov_b64 vcc, s[64:65]
    s_nop 0
    v_cndmask_b32_dpp v68, v64, v60, vcc row_ror:8 row_mask:0xf bank_mask:0xf
    v_cndmask_b32_dpp v69, v65, v61, vcc row_ror:8 row_mask:0xf bank_mask:0xf
    v_cndmask_b32_dpp v70, v66, v62, vcc row_ror:8 row_mask:0xf bank_mask:0xf
    v_cndmask_b32_dpp v71, v67, v63, vcc row_ror:8 row_mask:0xf bank_mask:0xf
    s_mov_b64 vcc, s[66:67]
    buffer_store_dwordx4 v[68:71], v26, s[12:15], s62 offen sc0 sc1
    v_cndmask_b32_dpp v72, v64, v60, vcc row_ror:8 row_mask:0xf bank_mask:0xf
    v_cndmask_b32_dpp v73, v65, v61, vcc row_ror:8 row_mask:0xf bank_mask:0xf
    v_cndmask_b32_dpp v74, v66, v62, vcc row_ror:8 row_mask:0xf bank_mask:0xf
    v_cndmask_b32_dpp v75, v67, v63, vcc row_ror:8 row_mask:0xf bank_mask:0xf
    buffer_store_dwordx4 v[72:75], v27, s[12:15], s62 offen sc0 sc1
    s_waitcnt lgkmcnt(15)
    v_pk_add_f32 v[124:125], v[124:125], v[140:141]
    v_pk_add_f32 v[126:127], v[126:127], v[142:143]
    v_pk_add_f32 v[128:129], v[128:129], v[144:145]
    ds_write_b128 v2, a[12:15] offset:0
    v_pk_add_f32 v[130:131], v[130:131], v[146:147]
    v_pk_add_f32 v[132:133], v[132:133], v[148:149]
    v_pk_add_f32 v[134:135], v[134:135], v[150:151]
    ds_write_b128 v2, a[48:51] offset:1024
    v_pk_add_f32 v[136:137], v[136:137], v[152:153]
    v_pk_add_f32 v[138:139], v[138:139], v[154:155]
    v_pk_add_f32 v[10:11], v[10:11], v[108:109]
    ds_write_b128 v2, a[16:19] offset:2048
    v_pk_add_f32 v[12:13], v[12:13], v[110:111]
    v_pk_add_f32 v[14:15], v[14:15], v[112:113]
    v_pk_add_f32 v[16:17], v[16:17], v[114:115]
    ds_write_b128 v2, a[52:55] offset:3072
    v_pk_add_f32 v[28:29], v[28:29], v[116:117]
    v_pk_add_f32 v[30:31], v[30:31], v[118:119]
    v_pk_add_f32 v[32:33], v[32:33], v[120:121]
    ds_write_b128 v2, a[68:71] offset:4096
    v_pk_add_f32 v[34:35], v[34:35], v[122:123]
    v_pk_add_f32 v[10:11], v[10:11], v[124:125]
    v_pk_add_f32 v[12:13], v[12:13], v[126:127]
    ds_write_b128 v2, a[104:107] offset:5120
    v_pk_add_f32 v[14:15], v[14:15], v[128:129]
    v_pk_add_f32 v[16:17], v[16:17], v[130:131]
    v_pk_add_f32 v[28:29], v[28:29], v[132:133]
    ds_write_b128 v2, a[140:143] offset:6144
    v_pk_add_f32 v[30:31], v[30:31], v[134:135]
    v_pk_add_f32 v[32:33], v[32:33], v[136:137]
    v_pk_add_f32 v[34:35], v[34:35], v[138:139]
    ds_write_b128 v2, a[88:91] offset:7168
    v_cvt_pk_bf16_f32 v108, v10, v11
    v_cvt_pk_bf16_f32 v109, v12, v13
    v_cvt_pk_bf16_f32 v110, v14, v15
    ds_write_b128 v2, a[124:127] offset:8192
    v_cvt_pk_bf16_f32 v111, v16, v17
    v_cvt_pk_bf16_f32 v112, v28, v29
    v_cvt_pk_bf16_f32 v113, v30, v31
    ds_write_b128 v2, a[232:235] offset:9216
    v_cvt_pk_bf16_f32 v114, v32, v33
    v_cvt_pk_bf16_f32 v115, v34, v35
    s_add_u32 s62, s23, 40960
    ds_write_b128 v2, a[156:159] offset:10240
    v_permlane16_swap_b32 v108, v110
    v_permlane16_swap_b32 v109, v111
    v_permlane16_swap_b32 v112, v114
    ds_write_b128 v2, a[184:187] offset:11264
    v_permlane16_swap_b32 v113, v115
    s_mov_b64 vcc, s[64:65]
    s_nop 0
    ds_write_b128 v2, a[160:163] offset:12288
    v_cndmask_b32_dpp v116, v112, v108, vcc row_ror:8 row_mask:0xf bank_mask:0xf
    v_cndmask_b32_dpp v117, v113, v109, vcc row_ror:8 row_mask:0xf bank_mask:0xf
    v_cndmask_b32_dpp v118, v114, v110, vcc row_ror:8 row_mask:0xf bank_mask:0xf
    ds_write_b128 v2, a[188:191] offset:13312
    v_cndmask_b32_dpp v119, v115, v111, vcc row_ror:8 row_mask:0xf bank_mask:0xf
    s_mov_b64 vcc, s[66:67]
    buffer_store_dwordx4 v[116:119], v26, s[12:15], s62 offen sc0 sc1
    v_cndmask_b32_dpp v120, v112, v108, vcc row_ror:8 row_mask:0xf bank_mask:0xf
    v_cndmask_b32_dpp v121, v113, v109, vcc row_ror:8 row_mask:0xf bank_mask:0xf
    v_cndmask_b32_dpp v122, v114, v110, vcc row_ror:8 row_mask:0xf bank_mask:0xf
    v_cndmask_b32_dpp v123, v115, v111, vcc row_ror:8 row_mask:0xf bank_mask:0xf
    buffer_store_dwordx4 v[120:123], v27, s[12:15], s62 offen sc0 sc1
    s_waitcnt lgkmcnt(15)
    v_pk_add_f32 v[172:173], v[172:173], v[188:189]
    v_pk_add_f32 v[174:175], v[174:175], v[190:191]
    v_pk_add_f32 v[176:177], v[176:177], v[192:193]
    v_pk_add_f32 v[178:179], v[178:179], v[194:195]
    v_pk_add_f32 v[180:181], v[180:181], v[196:197]
    v_pk_add_f32 v[182:183], v[182:183], v[198:199]
    v_pk_add_f32 v[184:185], v[184:185], v[200:201]
    v_pk_add_f32 v[186:187], v[186:187], v[202:203]
    v_pk_add_f32 v[36:37], v[36:37], v[156:157]
    v_pk_add_f32 v[38:39], v[38:39], v[158:159]
    v_pk_add_f32 v[40:41], v[40:41], v[160:161]
    v_pk_add_f32 v[42:43], v[42:43], v[162:163]
    v_pk_add_f32 v[44:45], v[44:45], v[164:165]
    v_pk_add_f32 v[46:47], v[46:47], v[166:167]
    v_pk_add_f32 v[48:49], v[48:49], v[168:169]
    v_pk_add_f32 v[50:51], v[50:51], v[170:171]
    v_pk_add_f32 v[36:37], v[36:37], v[172:173]
    v_pk_add_f32 v[38:39], v[38:39], v[174:175]
    v_pk_add_f32 v[40:41], v[40:41], v[176:177]
    v_pk_add_f32 v[42:43], v[42:43], v[178:179]
    v_pk_add_f32 v[44:45], v[44:45], v[180:181]
    v_pk_add_f32 v[46:47], v[46:47], v[182:183]
    v_pk_add_f32 v[48:49], v[48:49], v[184:185]
    v_pk_add_f32 v[50:51], v[50:51], v[186:187]
    v_cvt_pk_bf16_f32 v156, v36, v37
    v_cvt_pk_bf16_f32 v157, v38, v39
    v_cvt_pk_bf16_f32 v158, v40, v41
    v_cvt_pk_bf16_f32 v159, v42, v43
    v_cvt_pk_bf16_f32 v160, v44, v45
    v_cvt_pk_bf16_f32 v161, v46, v47
    v_cvt_pk_bf16_f32 v162, v48, v49
    v_cvt_pk_bf16_f32 v163, v50, v51
    s_add_u32 s62, s23, 81920
    v_permlane16_swap_b32 v156, v158
    v_permlane16_swap_b32 v157, v159
    v_permlane16_swap_b32 v160, v162
    v_permlane16_swap_b32 v161, v163
    s_mov_b64 vcc, s[64:65]
    s_nop 0
    v_cndmask_b32_dpp v164, v160, v156, vcc row_ror:8 row_mask:0xf bank_mask:0xf
    v_cndmask_b32_dpp v165, v161, v157, vcc row_ror:8 row_mask:0xf bank_mask:0xf
    v_cndmask_b32_dpp v166, v162, v158, vcc row_ror:8 row_mask:0xf bank_mask:0xf
    v_cndmask_b32_dpp v167, v163, v159, vcc row_ror:8 row_mask:0xf bank_mask:0xf
    s_mov_b64 vcc, s[66:67]
    buffer_store_dwordx4 v[164:167], v26, s[12:15], s62 offen sc0 sc1
    v_cndmask_b32_dpp v168, v160, v156, vcc row_ror:8 row_mask:0xf bank_mask:0xf
    v_cndmask_b32_dpp v169, v161, v157, vcc row_ror:8 row_mask:0xf bank_mask:0xf
    v_cndmask_b32_dpp v170, v162, v158, vcc row_ror:8 row_mask:0xf bank_mask:0xf
    v_cndmask_b32_dpp v171, v163, v159, vcc row_ror:8 row_mask:0xf bank_mask:0xf
    buffer_store_dwordx4 v[168:171], v27, s[12:15], s62 offen sc0 sc1
    s_waitcnt lgkmcnt(14)
    v_pk_add_f32 v[208:209], v[208:209], v[212:213]
    v_pk_add_f32 v[210:211], v[210:211], v[214:215]
    v_pk_add_f32 v[52:53], v[52:53], v[204:205]
    v_pk_add_f32 v[54:55], v[54:55], v[206:207]
    v_pk_add_f32 v[52:53], v[52:53], v[208:209]
    v_pk_add_f32 v[54:55], v[54:55], v[210:211]
    v_pk_add_f32 v[56:57], v[56:57], v[216:217]
    v_pk_add_f32 v[58:59], v[58:59], v[218:219]
    s_waitcnt lgkmcnt(0)
    s_barrier
    ds_read_b128 v[76:79], v4 offset:4096
    ds_read_b128 v[80:83], v3 offset:9216
    ds_read_b128 v[84:87], v8 offset:0
    ds_read_b128 v[88:91], v4 offset:5120
    ds_read_b128 v[92:95], v3 offset:10240
    ds_read_b128 v[96:99], v8 offset:1024
    ds_read_b128 v[100:103], v4 offset:6144
    ds_read_b128 v[104:107], v3 offset:11264
    ds_read_b128 v[124:127], v8 offset:2048
    ds_read_b128 v[128:131], v4 offset:7168
    ds_read_b128 v[132:135], v3 offset:12288
    ds_read_b128 v[136:139], v8 offset:3072
    ds_read_b128 v[140:143], v4 offset:8192
    ds_read_b128 v[144:147], v3 offset:13312
    s_waitcnt lgkmcnt(6)
    v_pk_add_f32 v[76:77], v[76:77], v[80:81]
    v_pk_add_f32 v[78:79], v[78:79], v[82:83]
    v_pk_add_f32 v[56:57], v[56:57], v[76:77]
    v_pk_add_f32 v[58:59], v[58:59], v[78:79]
    v_pk_add_f32 v[88:89], v[88:89], v[92:93]
    v_pk_add_f32 v[90:91], v[90:91], v[94:95]
    v_pk_add_f32 v[100:101], v[100:101], v[104:105]
    v_pk_add_f32 v[102:103], v[102:103], v[106:107]
    v_pk_add_f32 v[236:237], v[236:237], v[84:85]
    v_pk_add_f32 v[238:239], v[238:239], v[86:87]
    v_pk_add_f32 v[240:241], v[240:241], v[96:97]
    v_pk_add_f32 v[242:243], v[242:243], v[98:99]
    v_pk_add_f32 v[236:237], v[236:237], v[88:89]
    v_pk_add_f32 v[238:239], v[238:239], v[90:91]
    v_pk_add_f32 v[240:241], v[240:241], v[100:101]
    v_pk_add_f32 v[242:243], v[242:243], v[102:103]
    v_cvt_pk_bf16_f32 v204, v52, v53
    v_cvt_pk_bf16_f32 v205, v54, v55
    v_cvt_pk_bf16_f32 v206, v56, v57
    v_cvt_pk_bf16_f32 v207, v58, v59
    v_cvt_pk_bf16_f32 v208, v236, v237
    v_cvt_pk_bf16_f32 v209, v238, v239
    v_cvt_pk_bf16_f32 v210, v240, v241
    v_cvt_pk_bf16_f32 v211, v242, v243
    s_mov_b32 s62, s22
    v_permlane16_swap_b32 v204, v206
    v_permlane16_swap_b32 v205, v207
    v_permlane16_swap_b32 v208, v210
    v_permlane16_swap_b32 v209, v211
    s_mov_b64 vcc, s[64:65]
    s_nop 0
    v_cndmask_b32_dpp v212, v208, v204, vcc row_ror:8 row_mask:0xf bank_mask:0xf
    v_cndmask_b32_dpp v213, v209, v205, vcc row_ror:8 row_mask:0xf bank_mask:0xf
    v_cndmask_b32_dpp v214, v210, v206, vcc row_ror:8 row_mask:0xf bank_mask:0xf
    v_cndmask_b32_dpp v215, v211, v207, vcc row_ror:8 row_mask:0xf bank_mask:0xf
    s_mov_b64 vcc, s[66:67]
    buffer_store_dwordx4 v[212:215], v26, s[12:15], s62 offen sc0 sc1
    v_cndmask_b32_dpp v216, v208, v204, vcc row_ror:8 row_mask:0xf bank_mask:0xf
    v_cndmask_b32_dpp v217, v209, v205, vcc row_ror:8 row_mask:0xf bank_mask:0xf
    v_cndmask_b32_dpp v218, v210, v206, vcc row_ror:8 row_mask:0xf bank_mask:0xf
    v_cndmask_b32_dpp v219, v211, v207, vcc row_ror:8 row_mask:0xf bank_mask:0xf
    buffer_store_dwordx4 v[216:219], v27, s[12:15], s62 offen sc0 sc1
    s_waitcnt lgkmcnt(0)
    v_pk_add_f32 v[128:129], v[128:129], v[132:133]
    v_pk_add_f32 v[130:131], v[130:131], v[134:135]
    v_pk_add_f32 v[140:141], v[140:141], v[144:145]
    v_pk_add_f32 v[142:143], v[142:143], v[146:147]
    v_pk_add_f32 v[244:245], v[244:245], v[124:125]
    v_pk_add_f32 v[246:247], v[246:247], v[126:127]
    v_pk_add_f32 v[248:249], v[248:249], v[136:137]
    v_pk_add_f32 v[250:251], v[250:251], v[138:139]
    v_pk_add_f32 v[244:245], v[244:245], v[128:129]
    v_pk_add_f32 v[246:247], v[246:247], v[130:131]
    v_pk_add_f32 v[248:249], v[248:249], v[140:141]
    v_pk_add_f32 v[250:251], v[250:251], v[142:143]
    v_cvt_pk_bf16_f32 v60, v244, v245
    v_cvt_pk_bf16_f32 v61, v246, v247
    v_cvt_pk_bf16_f32 v62, v248, v249
    v_cvt_pk_bf16_f32 v63, v250, v251
    s_nop 1
    v_permlane16_swap_b32 v60, v62
    v_permlane16_swap_b32 v61, v63
    buffer_store_dwordx4 v[60:63], v9, s[12:15], s59 offen sc0 sc1
L_op_end:
    s_endpgm
L_code_end:
.section .rodata,"a"
.p2align 6
.amdhsa_kernel fused_kernel
  .amdhsa_next_free_vgpr 512
  .amdhsa_next_free_sgpr 102
  .amdhsa_accum_offset 256
  .amdhsa_group_segment_fixed_size 0
  .amdhsa_kernarg_size 104
  .amdhsa_user_sgpr_count 2
  .amdhsa_user_sgpr_kernarg_segment_ptr 1
  .amdhsa_system_sgpr_workgroup_id_x 1
.end_amdhsa_kernel
.p2align 6
.amdhsa_kernel op_kernel
  .amdhsa_next_free_vgpr 512
  .amdhsa_next_free_sgpr 102
  .amdhsa_accum_offset 256
  .amdhsa_group_segment_fixed_size 0
  .amdhsa_kernarg_size 104
  .amdhsa_user_sgpr_count 2
  .amdhsa_user_sgpr_kernarg_segment_ptr 1
  .amdhsa_system_sgpr_workgroup_id_x 1
.end_amdhsa_kernel
```
